```python
import torch

def _softmax(x, axis=-1):
    return torch.softmax(x, dim=axis)
def _gelu(x):
    return torch.nn.functional.gelu(x, approximate="tanh")
def _silu(x):
    return torch.nn.functional.silu(x)
def _sigmoid(x):
    return torch.sigmoid(x)
def _layernorm(x, axis=-1, eps=1e-5):
    m = x.mean(dim=axis, keepdim=True)
    v = x.var(dim=axis, keepdim=True, unbiased=False)
    return (x - m) / torch.sqrt(v + eps)
def _scatter_add(tgt, idx, src, axis=0):
    return tgt.clone().index_add_(axis, idx, src)
def _segment_sum(src, seg, n):
    out = torch.zeros((n,) + src.shape[1:], dtype=src.dtype)
    return out.index_add_(0, seg, src)
def _pad(x, pw):
    flat = tuple(v for pair in reversed(pw) for v in pair)
    return torch.nn.functional.pad(x, flat)

kernel_name = 'recurrent_scan__ssm_conv_h3__dense_activation_gelu__prompt'

def setup_inputs():

    _w = (lambda a: (lambda t: t.to(torch.bfloat16) if t.is_floating_point() else t)(torch.as_tensor(a)))
    def _A_setup():
        B, S, D = 1, 2048, 640
        ks = 4
        return {
            "q": _w((lambda *s: torch.randn(*s, dtype=torch.bfloat16) * 0.05)(B, S, D)),
            "k": _w((lambda *s: torch.randn(*s, dtype=torch.bfloat16) * 0.8)(B, S, D)),
            "v": _w((lambda *s: torch.randn(*s, dtype=torch.bfloat16) * 0.8)(B, S, D)),
            "shift_k": _w((lambda *s: torch.randn(*s, dtype=torch.bfloat16) * 0.8)(D, ks) * 0.5),
            "ssm_k": _w((lambda *s: torch.randn(*s, dtype=torch.bfloat16) * 0.8)(D, S) * (1.0 / S ** 0.5)),
            "ssm_D": _w((lambda *s: torch.randn(*s, dtype=torch.bfloat16) * 0.8)(D)),
        }
    _A_in = _A_setup()

    def _B_setup():
        B, S, D, F = 1, 2048, 640, 1728
        return {
            "x": _w((lambda *s: torch.randn(*s, dtype=torch.bfloat16) * 0.05)(B, S, D)),
            "w1": _w((lambda *s: torch.randn(*s, dtype=torch.bfloat16) * 0.2)(D, F) * (D ** -0.5)),
            "b1": _w((lambda *s: torch.randn(*s, dtype=torch.bfloat16) * 0.2)(F) * 0.01),
            "w2": _w((lambda *s: torch.randn(*s, dtype=torch.bfloat16) * 0.2)(F, D) * (F ** -0.5)),
            "b2": _w((lambda *s: torch.randn(*s, dtype=torch.bfloat16) * 0.2)(D) * 0.01),
        }
    _B_in = _B_setup()

    return {
        "A_q": _A_in["q"],
        "A_k": _A_in["k"],
        "A_v": _A_in["v"],
        "A_shift_k": _A_in["shift_k"],
        "A_ssm_k": _A_in["ssm_k"],
        "A_ssm_D": _A_in["ssm_D"],
        "B_x": _B_in["x"],
        "B_w1": _B_in["w1"],
        "B_b1": _B_in["b1"],
        "B_w2": _B_in["w2"],
        "B_b2": _B_in["b2"],
    }

def reference(A_q, A_k, A_v, A_shift_k, A_ssm_k, A_ssm_D, B_x, B_w1, B_b1, B_w2, B_b2):
    def _A_ref(q, k, v, shift_k, ssm_k, ssm_D):
        B, S, D = q.shape
        ks = shift_k.shape[-1]
        k_pad = _pad(k, ((0, 0), (ks - 1, 0), (0, 0)))
        k_shift = torch.zeros_like(k)
        for t in range(ks):
            k_shift = k_shift + k_pad[:, t:t + S, :] * shift_k[:, ks - 1 - t][None, None, :]
        kv = k_shift * v
        L = 2 * S
        kv_pad = _pad(kv, ((0, 0), (0, S), (0, 0)))
        kf_pad = _pad(ssm_k, ((0, 0), (0, S)))
        kv_f = (lambda x, axes=(-2,-1): torch.fft.rfft2(x.float(), dim=axes))(kv_pad[:, None, :, :], axes=(1, 2))
        kf_f = (lambda x, axes=(-2,-1): torch.fft.rfft2(x.float(), dim=axes))(kf_pad[:, None, :], axes=(1, 2))
        kf_f = (lambda x, *d: x.permute(*d))(kf_f, 1, 2, 0)
        y_f = kv_f * kf_f[None, :, :, :]
        y = (lambda x, s, axes=(-2,-1): torch.fft.irfft2(x, s=s, dim=axes).to(torch.bfloat16))(y_f, (1, L), axes=(1, 2))[:, 0, :S, :]
        y = y + kv * ssm_D[None, None, :]
        return q * y

    def _B_ref(x, w1, b1, w2, b2):
        h = torch.einsum("bsd,df->bsf", x, w1) + b1
        h = _gelu(h)
        return torch.einsum("bsf,fd->bsd", h, w2) + b2

    x = A_q
    xn = _layernorm(x, axis=-1)
    s = _A_ref(xn, A_k, A_v, A_shift_k, A_ssm_k, A_ssm_D)
    g = _silu(_B_ref(xn, B_w1, B_b1, B_w2, B_b2))
    return x + s * g
```

```asm
; @launch grid=(256,1,1) block=(256,1,1) lds=156160
.amdgcn_target "amdgcn-amd-amdhsa--gfx950"
.text
.globl recurrent_scan__ssm_conv_h3__dense_activation_gelu__prompt_kernel
.p2align 12
.type recurrent_scan__ssm_conv_h3__dense_activation_gelu__prompt_kernel,@function
recurrent_scan__ssm_conv_h3__dense_activation_gelu__prompt_kernel:
    s_cmp_ge_u32 s2, 256
    s_cbranch_scc1 EXIT
    s_load_dwordx16 s[4:19], s[0:1], 0
    s_load_dwordx8 s[20:27], s[0:1], 64
    s_load_dwordx4 s[28:31], s[0:1], 96
    v_lshrrev_b32 v1, 6, v0
    s_and_b32 s57, s2, 7
    s_lshr_b32 s58, s2, 3
    s_getpc_b64 s[44:45]
PF_BASE:
    s_mov_b32 s46, CODE_END-PF_BASE
    s_mov_b32 s47, 0x20000
    s_mul_i32 s78, s58, 9
    v_add_u32 v2, s78, v0
    v_lshlrev_b32 v2, 7, v2
    v_cmp_gt_u32 vcc, 9, v0
    v_cndmask_b32 v2, -1, v2, vcc
    buffer_load_dword v47, v2, s[44:47], 0 offen
    v_and_b32 v0, 63, v0
    v_readfirstlane_b32 s3, v1
    s_cmp_ge_u32 s58, 28
    s_cbranch_scc1 IDLE
    s_lshr_b32 s75, s58, 2
    s_and_b32 s76, s58, 3
    s_lshl_b32 s76, s76, 3
    s_add_u32 s76, s76, s57
    v_lshrrev_b32 v15, 4, v0
    s_lshl_b32 s78, s3, 2
    v_add_u32 v15, s78, v15
    v_and_b32 v18, 15, v0
    v_mul_u32_u24 v14, 5120, v15
    v_lshl_add_u32 v14, v18, 3, v14
    s_mul_i32 s78, s76, 81920
    v_add_u32_e64 v14, s78, v14
    v_add_u32 v15, 0xfffff100, v14
    v_add_u32 v16, 0xfffff600, v14
    v_add_u32 v17, 0xfffffb00, v14
    v_lshlrev_b32 v18, 5, v18
    s_lshl_b32 s79, s75, 7
    v_add_u32 v248, s79, v14
    v_add_u32 v249, s79, v15
    v_add_u32 v250, s79, v16
    v_add_u32 v251, s79, v17
    v_lshl_add_u32 v252, s75, 9, v18
    s_lshl_b32 s79, s75, 18
    s_lshl_b32 s80, s76, 7
    s_add_u32 s59, s79, s80
    s_add_u32 s59, s59, 1048576
    s_lshl_b32 s84, s75, 5
    s_add_u32 s84, s84, s76
    s_lshl_b32 s84, s84, 6
    s_add_u32 s84, s84, 131072
    s_waitcnt lgkmcnt(0)
    s_load_dword s56, s[30:31], 0
    s_mov_b32 s32, s4
    s_mov_b32 s33, s5
    s_mov_b32 s34, 2621440
    s_mov_b32 s35, 0x20000
    s_mov_b32 s44, s6
    s_mov_b32 s45, s7
    s_mov_b32 s46, 2621440
    s_mov_b32 s47, 0x20000
    s_mov_b32 s48, s8
    s_mov_b32 s49, s9
    s_mov_b32 s50, 2621440
    s_mov_b32 s51, 0x20000
    s_mov_b32 s52, s10
    s_mov_b32 s53, s11
    s_mov_b32 s54, 5120
    s_mov_b32 s55, 0x20000
    buffer_load_dwordx2 v[96:97], v249, s[44:47], 0 offen nt
    s_lshr_b32 s73, s57, 1
    s_lshl_b32 s73, s73, 2
    s_and_b32 s74, s58, 3
    s_add_u32 s63, s73, s74
    buffer_load_dwordx2 v[98:99], v250, s[44:47], 0 offen nt
    s_and_b32 s73, s57, 1
    s_mul_i32 s73, s73, 7
    s_lshr_b32 s74, s58, 2
    s_add_u32 s64, s73, s74
    buffer_load_dwordx2 v[100:101], v251, s[44:47], 0 offen nt
    s_and_b32 s65, s3, 1
    s_lshr_b32 s66, s3, 1
    s_mul_i32 s73, s63, 163840
    s_mul_i32 s74, s3, 40960
    s_add_u32 s60, s73, s74
    buffer_load_dwordx2 v[102:103], v248, s[44:47], 0 offen offset:0 nt
    s_lshl_b32 s73, s64, 8
    s_mul_i32 s74, s3, 55296
    s_add_u32 s61, s73, s74
    s_lshl_b32 s62, s3, 12
    buffer_load_dwordx2 v[104:105], v248, s[44:47], 0 offen offset:1280 nt
    s_mov_b32 s85, -1152
    s_mov_b32 s86, -1990656
    s_lshr_b32 s73, s58, 2
    s_mul_i32 s73, s73, 10
    s_add_u32 s73, s73, 3
    buffer_load_dwordx2 v[106:107], v248, s[44:47], 0 offen offset:2560 nt
    s_mul_i32 s73, s73, 9363
    s_lshr_b32 s73, s73, 16
    s_and_b32 s74, s58, 3
    s_mul_i32 s74, s74, 5
    buffer_load_dwordx2 v[108:109], v248, s[44:47], 0 offen offset:3840 nt
    s_lshr_b32 s74, s74, 1
    s_add_u32 s73, s73, s74
    s_cmp_ge_u32 s73, 10
    s_cselect_b32 s74, 10, 0
    s_sub_u32 s73, s73, s74
    s_sub_u32 s74, 9, s73
    buffer_load_dwordx4 v[118:121], v252, s[52:55], 0 offen
    s_lshl_b32 s0, 1, s74
    s_lshl_b32 s74, s73, 7
    s_add_u32 s60, s60, s74
    s_mul_i32 s74, s73, 221184
    buffer_load_dwordx4 v[122:125], v252, s[52:55], 0 offen offset:16
    s_add_u32 s61, s61, s74
    v_lshrrev_b32 v1, 3, v0
    v_and_b32 v2, 7, v0
    v_xor_b32 v2, v2, v1
    v_lshlrev_b32_e64 v2, 4, v2
    buffer_load_dwordx2 v[110:111], v248, s[48:51], 0 offen offset:0 nt
    v_mul_u32_u24 v240, 1280, v1
    v_add_u32_e64 v240, v240, v2
    v_add_u32 v241, 9216, v240
    v_add_u32 v242, 18432, v240
    buffer_load_dwordx2 v[112:113], v248, s[48:51], 0 offen offset:1280 nt
    v_add_u32 v243, 27648, v240
    v_lshrrev_b32 v1, 4, v0
    v_and_b32 v2, 15, v0
    v_lshlrev_b32 v3, 1, v1
    v_xor_b32 v2, v2, v3
    buffer_load_dwordx2 v[114:115], v248, s[48:51], 0 offen offset:2560 nt
    v_lshlrev_b32 v2, 4, v2
    v_mul_u32_u24 v3, 3456, v1
    v_add_u32 v244, v3, v2
    v_add_u32 v245, 12800, v244
    buffer_load_dwordx2 v[116:117], v248, s[48:51], 0 offen offset:3840 nt
    v_xor_b32 v2, 128, v2
    v_add_u32_e64 v3, v3, v2
    v_add_u32 v246, 25600, v3
    v_add_u32 v247, 38400, v3
    s_movk_i32 s73, 1280
    s_mov_b32 s42, 0
    s_mov_b64 exec, 0
    s_cmp_eq_u32 s3, 0
    s_cbranch_scc1 PAGE1
    s_cmp_eq_u32 s3, 1
    s_cbranch_scc1 PAGE3
    s_cmp_eq_u32 s3, 2
    s_cbranch_scc1 PAGE5
    s_branch PAGE7
VISIT_RET:
    s_cmp_eq_u32 s42, 1
    s_cbranch_scc1 VISIT_RET_I
    s_mov_b64 exec, -1
    s_lshl_b32 s78, s57, 8
    s_lshl_b32 s79, s58, 3
    s_add_u32 s78, s78, s79
    s_lshl_b32 s79, s3, 1
    s_add_u32 s78, s78, s79
    v_lshrrev_b32 v226, 5, v0
    v_add_u32 v226, s78, v226
    v_and_b32 v227, 31, v0
    v_lshlrev_b32 v227, 3, v227
    v_mad_u32_u24 v227, v226, s73, v227
    v_lshlrev_b32_e64 v226, 3, v226
    buffer_load_dwordx2 v[216:217], v227, s[32:35], 0 offen offset:0
    buffer_load_dwordx2 v[218:219], v227, s[32:35], 0 offen offset:256
    buffer_load_dwordx2 v[220:221], v227, s[32:35], 0 offen offset:512
    buffer_load_dwordx2 v[222:223], v227, s[32:35], 0 offen offset:768
    buffer_load_dwordx2 v[224:225], v227, s[32:35], 0 offen offset:1024
    s_mov_b32 s44, s22
    s_mov_b32 s45, s23
    s_mov_b32 s46, 2211840
    s_mov_b32 s47, 0x20000
    s_mov_b32 s40, s18
    s_mov_b32 s41, s19
    s_mov_b32 s42, 2211840
    s_mov_b32 s43, 0x20000
    s_add_u32 m0, s62, 0
    s_nop 0
    buffer_load_dwordx4 v240, s[32:35], s60 offen offset:0 lds
    s_lshl_b32 s68, s64, 3
    s_lshl_b32 s73, s65, 2
    s_add_u32 s68, s68, s73
    s_lshl_b32 s73, s66, 1
    s_add_u32 s74, s73, 0
    s_and_b32 s74, s74, 3
    s_add_u32 s69, s74, s68
    s_add_u32 s74, s73, 1
    s_and_b32 s74, s74, 3
    s_add_u32 s70, s74, s68
    s_add_u32 s74, s73, 2
    s_and_b32 s74, s74, 3
    s_add_u32 s71, s74, s68
    s_add_u32 s74, s73, 3
    s_and_b32 s74, s74, 3
    s_add_u32 s72, s74, s68
    s_mov_b32 s36, s30
    s_mov_b32 s37, s31
    s_mov_b32 s38, 17563648
    s_mov_b32 s39, 0x20000
    v_and_b32 v203, 15, v0
    v_lshrrev_b32 v204, 5, v0
    s_lshl_b32 s78, s3, 1
    v_add_u32 v204, s78, v204
    v_xor_b32 v204, v204, v203
    v_and_b32 v204, 7, v204
    v_lshlrev_b32_e64 v204, 4, v204
    v_lshl_add_u32 v203, v203, 9, v204
    buffer_load_dwordx4 v241, s[32:35], s60 offen offset:1024 lds
    v_bfe_u32 v204, v0, 4, 1
    v_xor_b32_e64 v204, 1, v204
    v_lshl_add_u32 v203, v204, 3, v203
    v_add_u32 v203, 131584, v203
    s_lshl_b32 s78, s3, 6
    v_add_u32 v205, s78, v0
    v_lshrrev_b32 v206, 3, v205
    v_lshrrev_b32 v204, 5, v205
    v_xor_b32 v204, v204, v205
    v_and_b32 v204, 7, v204
    v_lshlrev_b32_e64 v204, 4, v204
    v_lshl_add_u32 v204, v206, 7, v204
    v_add_u32 v204, 131584, v204
    v_and_b32 v205, 7, v205
    v_lshlrev_b32 v205, 4, v205
    v_lshl_add_u32 v205, v206, 12, v205
    v_add_u32 v206, 0x20000, v205
    s_and_b32 s76, s58, 7
    s_lshl_b32 s77, s57, 2
    s_lshr_b32 s78, s58, 3
    s_add_u32 s77, s77, s78
    s_mul_i32 s78, s77, 40960
    s_mul_i32 s79, s76, 160
    s_add_u32 s78, s78, s79
    s_add_u32 s79, s78, 1310720
    s_cmp_lt_u32 s77, 22
    s_cselect_b32 s79, s79, 2211840
    s_lshl_b32 s80, s3, 6
    v_add_u32 v24, s80, v0
    buffer_load_dwordx4 v242, s[32:35], s60 offen offset:2048 lds
    v_cmp_gt_u32 vcc, 320, v24
    v_subrev_u32 v25, 320, v24
    v_mov_b32 v26, s79
    v_mov_b32 v27, s78
    v_cndmask_b32 v25, v25, v24, vcc
    v_cndmask_b32 v26, v26, v27, vcc
    v_mul_u32_u24 v27, 6554, v25
    v_lshrrev_b32 v27, 16, v27
    v_mul_u32_u24 v28, 10, v27
    v_sub_u32_e64 v28, v25, v28
    v_mul_u32_u24 v27, 1280, v27
    v_lshl_add_u32 v27, v28, 4, v27
    v_add_u32 v253, v27, v26
    v_add_u32 v24, s80, v0
    v_add_u32 v24, 256, v24
    v_cmp_gt_u32 vcc, 320, v24
    v_subrev_u32 v25, 320, v24
    v_mov_b32 v26, s79
    v_mov_b32 v27, s78
    v_cndmask_b32 v25, v25, v24, vcc
    v_cndmask_b32 v26, v26, v27, vcc
    v_mul_u32_u24 v27, 6554, v25
    v_lshrrev_b32 v27, 16, v27
    v_mul_u32_u24 v28, 10, v27
    v_sub_u32_e64 v28, v25, v28
    v_mul_u32_u24 v27, 1280, v27
    v_lshl_add_u32 v27, v28, 4, v27
    v_add_u32 v254, v27, v26
    v_add_u32 v24, s80, v0
    buffer_load_dwordx4 v243, s[32:35], s60 offen offset:3072 lds
    v_add_u32 v24, 512, v24
    v_cmp_gt_u32 vcc, 320, v24
    v_subrev_u32 v25, 320, v24
    v_mov_b32 v26, s79
    v_mov_b32 v27, s78
    v_cndmask_b32 v25, v25, v24, vcc
    v_cndmask_b32 v26, v26, v27, vcc
    v_mul_u32_u24 v27, 6554, v25
    v_lshrrev_b32 v27, 16, v27
    v_mul_u32_u24 v28, 10, v27
    v_sub_u32_e64 v28, v25, v28
    v_mul_u32_u24 v27, 1280, v27
    v_lshl_add_u32 v27, v28, 4, v27
    v_add_u32_e64 v255, v27, v26
    v_mov_b32 v26, 2211840
    v_cmp_gt_u32 vcc, 640, v24
    s_nop 1
    v_cndmask_b32 v255, v26, v255, vcc
    s_and_b32 s77, s58, 7
    s_lshl_b32 s78, s57, 2
    s_lshr_b32 s79, s58, 3
    s_add_u32 s78, s78, s79
    s_mul_i32 s77, s77, 54
    s_add_u32 s77, s77, s78
    s_mul_i32 s77, s77, 5120
    s_add_u32 s77, s77, 4194304
    v_lshrrev_b32_e64 v24, 4, v0
    v_bfe_u32 v25, v0, 2, 2
    s_add_u32 m0, s62, 16384
    s_nop 0
    buffer_load_dwordx4 v244, s[40:43], s61 offen offset:0 lds
    v_lshl_add_u32 v24, v24, 2, v25
    v_mul_u32_u24 v24, 160, v24
    v_and_b32 v25, 3, v0
    s_add_u32 s79, s3, 0
    s_cmp_ge_u32 s79, 5
    s_cselect_b32 s80, 1, 0
    s_mul_i32 s81, s80, 5
    s_sub_u32 s79, s79, s81
    s_mul_i32 s81, s80, 163840
    s_add_u32 s81, s81, s77
    s_lshl_b32 s82, s79, 10
    s_add_u32 s81, s81, s82
    s_cmp_ge_u32 s78, 22
    s_cselect_b32 s82, s80, 0
    s_cmp_ge_u32 s79, 5
    s_cselect_b32 s82, 1, s82
    s_cmp_lg_u32 s82, 0
    s_cselect_b32 s74, 17563648, s81
    s_min_u32 s79, s79, 4
    s_and_b32 s82, s79, 1
    s_lshl_b32 s82, s82, 3
    s_lshr_b32 s83, s79, 1
    s_lshl_b32 s83, s83, 6
    s_add_u32 s82, s82, s83
    s_mul_i32 s83, s80, 5120
    s_add_u32 s82, s82, s83
    s_add_u32 s82, s82, 139776
    s_cmp_eq_u32 s79, 4
    s_cselect_b32 s83, 3, 4
    v_lshlrev_b32 v200, s83, v25
    v_add3_u32 v200, v200, v24, s82
    s_add_u32 s79, s3, 4
    s_cmp_ge_u32 s79, 5
    s_cselect_b32 s80, 1, 0
    buffer_load_dwordx4 v245, s[40:43], s61 offen offset:1024 lds
    s_mul_i32 s81, s80, 5
    s_sub_u32 s79, s79, s81
    s_mul_i32 s81, s80, 163840
    s_add_u32 s81, s81, s77
    s_lshl_b32 s82, s79, 10
    s_add_u32 s81, s81, s82
    s_cmp_ge_u32 s78, 22
    s_cselect_b32 s82, s80, 0
    s_cmp_ge_u32 s79, 5
    s_cselect_b32 s82, 1, s82
    s_cmp_lg_u32 s82, 0
    s_cselect_b32 s75, 17563648, s81
    s_min_u32 s79, s79, 4
    s_and_b32 s82, s79, 1
    s_lshl_b32 s82, s82, 3
    s_lshr_b32 s83, s79, 1
    s_lshl_b32 s83, s83, 6
    s_add_u32 s82, s82, s83
    s_mul_i32 s83, s80, 5120
    s_add_u32 s82, s82, s83
    s_add_u32 s82, s82, 139776
    s_cmp_eq_u32 s79, 4
    s_cselect_b32 s83, 3, 4
    v_lshlrev_b32 v201, s83, v25
    v_add3_u32 v201, v201, v24, s82
    s_add_u32 s79, s3, 8
    s_cmp_ge_u32 s79, 5
    s_cselect_b32 s80, 1, 0
    s_mul_i32 s81, s80, 5
    s_sub_u32 s79, s79, s81
    s_mul_i32 s81, s80, 163840
    s_add_u32 s81, s81, s77
    s_lshl_b32 s82, s79, 10
    s_add_u32 s81, s81, s82
    buffer_load_dwordx4 v246, s[40:43], s61 offen offset:2048 lds
    s_cmp_ge_u32 s78, 22
    s_cselect_b32 s82, s80, 0
    s_cmp_ge_u32 s79, 5
    s_cselect_b32 s82, 1, s82
    s_cmp_lg_u32 s82, 0
    s_cselect_b32 s76, 17563648, s81
    s_min_u32 s79, s79, 4
    s_and_b32 s82, s79, 1
    s_lshl_b32 s82, s82, 3
    s_lshr_b32 s83, s79, 1
    s_lshl_b32 s83, s83, 6
    s_add_u32 s82, s82, s83
    s_mul_i32 s83, s80, 5120
    s_add_u32 s82, s82, s83
    s_add_u32 s82, s82, 139776
    s_cmp_eq_u32 s79, 4
    s_cselect_b32 s83, 3, 4
    v_lshlrev_b32 v202, s83, v25
    v_add3_u32 v202, v202, v24, s82
    v_lshlrev_b32 v14, 4, v0
    v_and_b32 v1, 15, v0
    v_lshrrev_b32 v17, 4, v0
    v_bfe_u32 v18, v0, 2, 2
    v_and_b32 v19, 3, v0
    v_and_b32 v24, 1, v17
    v_lshl_or_b32 v24, v24, 2, v18
    v_lshl_add_u32 v25, v17, 3, v18
    v_lshlrev_b32 v25, 8, v25
    v_lshl_add_u32 v25, v19, 3, v25
    s_and_b32 s73, s69, 7
    v_xor_b32_e64 v26, s73, v24
    v_lshl_add_u32 v2, v26, 5, v25
    buffer_load_dwordx4 v247, s[40:43], s61 offen offset:3072 lds
    v_add_u32 v6, 0x10000, v2
    s_and_b32 s73, s70, 7
    v_xor_b32 v26, s73, v24
    v_lshl_add_u32 v3, v26, 5, v25
    v_add_u32 v7, 0x10000, v3
    s_and_b32 s73, s71, 7
    v_xor_b32 v26, s73, v24
    v_lshl_add_u32 v4, v26, 5, v25
    v_add_u32 v8, 0x10000, v4
    s_and_b32 s73, s72, 7
    v_xor_b32 v26, s73, v24
    v_lshl_add_u32 v5, v26, 5, v25
    v_add_u32 v9, 0x10000, v5
    s_lshl_b32 s73, s66, 13
    v_and_b32 v24, 7, v1
    v_xor_b32 v24, v24, v17
    v_lshlrev_b32 v24, 4, v24
    v_lshl_add_u32 v24, v1, 7, v24
    v_add_u32 v10, s73, v24
    v_xor_b32 v11, 64, v10
    v_add_u32 v12, 0x10000, v10
    v_add_u32 v13, 0x10000, v11
    v_mov_b32 v20, 0x3f803f80
    v_mov_b32 v21, 0x3f803f80
    v_mov_b32 v22, 0x3f803f80
    v_mov_b32 v23, 0x3f803f80
    s_lshl_b32 s67, s63, 7
    s_lshl_b32 s73, s66, 6
    s_add_u32 s67, s67, s73
    s_bitcmp1_b32 s0, 0
    s_cselect_b32 s87, s85, 128
    s_cselect_b32 s88, s86, 221184
    s_add_u32 s60, s60, s87
    s_add_u32 s61, s61, s88
    s_add_u32 m0, s62, 32768
    s_nop 0
    buffer_load_dwordx4 v240, s[32:35], s60 offen offset:0 lds
    s_waitcnt vmcnt(18)
    v_lshlrev_b32 v144, 16, v118
    v_and_b32 v148, 0xffff0000, v118
    v_lshlrev_b32 v145, 16, v122
    v_and_b32 v149, 0xffff0000, v122
    v_lshlrev_b32 v146, 16, v120
    v_and_b32 v150, 0xffff0000, v120
    v_lshlrev_b32 v147, 16, v124
    v_and_b32 v151, 0xffff0000, v124
    v_lshlrev_b32 v152, 16, v119
    v_and_b32 v156, 0xffff0000, v119
    v_lshlrev_b32 v153, 16, v123
    v_and_b32 v157, 0xffff0000, v123
    v_lshlrev_b32 v154, 16, v121
    v_and_b32 v158, 0xffff0000, v121
    v_lshlrev_b32 v155, 16, v125
    buffer_load_dwordx4 v241, s[32:35], s60 offen offset:1024 lds
    v_and_b32 v159, 0xffff0000, v125
    v_lshlrev_b32 v128, 16, v96
    v_and_b32 v96, 0xffff0000, v96
    v_lshlrev_b32 v129, 16, v97
    v_and_b32 v97, 0xffff0000, v97
    v_lshlrev_b32 v130, 16, v98
    v_and_b32 v98, 0xffff0000, v98
    v_lshlrev_b32 v131, 16, v99
    v_and_b32 v99, 0xffff0000, v99
    v_lshlrev_b32 v132, 16, v100
    v_and_b32 v100, 0xffff0000, v100
    v_lshlrev_b32 v133, 16, v101
    v_and_b32 v101, 0xffff0000, v101
    v_lshlrev_b32 v134, 16, v102
    v_and_b32 v102, 0xffff0000, v102
    v_lshlrev_b32 v135, 16, v103
    buffer_load_dwordx4 v242, s[32:35], s60 offen offset:2048 lds
    v_and_b32 v103, 0xffff0000, v103
    v_lshlrev_b32 v136, 16, v104
    v_and_b32 v104, 0xffff0000, v104
    v_lshlrev_b32 v137, 16, v105
    v_and_b32 v105, 0xffff0000, v105
    v_lshlrev_b32 v138, 16, v106
    v_and_b32 v106, 0xffff0000, v106
    v_lshlrev_b32 v139, 16, v107
    v_and_b32 v107, 0xffff0000, v107
    v_lshlrev_b32 v140, 16, v108
    v_and_b32 v108, 0xffff0000, v108
    v_lshlrev_b32 v141, 16, v109
    v_and_b32 v109, 0xffff0000, v109
    v_pk_mul_f32 v[160:161], v[134:135], v[144:145]
    v_pk_mul_f32 v[162:163], v[102:103], v[146:147]
    v_pk_mul_f32 v[164:165], v[136:137], v[144:145]
    buffer_load_dwordx4 v243, s[32:35], s60 offen offset:3072 lds
    v_pk_mul_f32 v[166:167], v[104:105], v[146:147]
    v_pk_mul_f32 v[168:169], v[138:139], v[144:145]
    v_pk_mul_f32 v[170:171], v[106:107], v[146:147]
    v_pk_mul_f32 v[172:173], v[140:141], v[144:145]
    v_pk_mul_f32 v[174:175], v[108:109], v[146:147]
    v_pk_fma_f32 v[160:161], v[132:133], v[148:149], v[160:161]
    v_pk_fma_f32 v[162:163], v[100:101], v[150:151], v[162:163]
    v_pk_fma_f32 v[164:165], v[134:135], v[148:149], v[164:165]
    v_pk_fma_f32 v[166:167], v[102:103], v[150:151], v[166:167]
    v_pk_fma_f32 v[168:169], v[136:137], v[148:149], v[168:169]
    v_pk_fma_f32 v[170:171], v[104:105], v[150:151], v[170:171]
    v_pk_fma_f32 v[172:173], v[138:139], v[148:149], v[172:173]
    v_pk_fma_f32 v[174:175], v[106:107], v[150:151], v[174:175]
    v_pk_fma_f32 v[160:161], v[130:131], v[152:153], v[160:161]
    v_pk_fma_f32 v[162:163], v[98:99], v[154:155], v[162:163]
    v_pk_fma_f32 v[164:165], v[132:133], v[152:153], v[164:165]
    s_add_u32 m0, s62, 49152
    s_nop 0
    s_nop 0
    buffer_load_dwordx4 v244, s[40:43], s61 offen offset:0 lds
    v_pk_fma_f32 v[166:167], v[100:101], v[154:155], v[166:167]
    v_pk_fma_f32 v[168:169], v[134:135], v[152:153], v[168:169]
    v_pk_fma_f32 v[170:171], v[102:103], v[154:155], v[170:171]
    v_pk_fma_f32 v[172:173], v[136:137], v[152:153], v[172:173]
    v_pk_fma_f32 v[174:175], v[104:105], v[154:155], v[174:175]
    v_pk_fma_f32 v[160:161], v[128:129], v[156:157], v[160:161]
    v_pk_fma_f32 v[162:163], v[96:97], v[158:159], v[162:163]
    v_pk_fma_f32 v[164:165], v[130:131], v[156:157], v[164:165]
    v_pk_fma_f32 v[166:167], v[98:99], v[158:159], v[166:167]
    v_pk_fma_f32 v[168:169], v[132:133], v[156:157], v[168:169]
    v_pk_fma_f32 v[170:171], v[100:101], v[158:159], v[170:171]
    v_pk_fma_f32 v[172:173], v[134:135], v[156:157], v[172:173]
    v_pk_fma_f32 v[174:175], v[102:103], v[158:159], v[174:175]
    s_waitcnt vmcnt(18)
    v_lshlrev_b32 v128, 16, v110
    v_and_b32 v110, 0xffff0000, v110
    buffer_load_dwordx4 v245, s[40:43], s61 offen offset:1024 lds
    v_lshlrev_b32 v129, 16, v111
    v_and_b32 v111, 0xffff0000, v111
    v_lshlrev_b32 v130, 16, v112
    v_and_b32 v112, 0xffff0000, v112
    v_lshlrev_b32 v131, 16, v113
    v_and_b32 v113, 0xffff0000, v113
    v_lshlrev_b32 v132, 16, v114
    v_and_b32 v114, 0xffff0000, v114
    v_lshlrev_b32 v133, 16, v115
    v_and_b32 v115, 0xffff0000, v115
    v_lshlrev_b32 v134, 16, v116
    v_and_b32 v116, 0xffff0000, v116
    v_lshlrev_b32_e64 v135, 16, v117
    v_and_b32 v117, 0xffff0000, v117
    v_pk_mul_f32 v[160:161], v[160:161], v[128:129]
    v_pk_mul_f32 v[162:163], v[162:163], v[110:111]
    buffer_load_dwordx4 v246, s[40:43], s61 offen offset:2048 lds
    v_pk_mul_f32 v[164:165], v[164:165], v[130:131]
    v_pk_mul_f32 v[166:167], v[166:167], v[112:113]
    v_pk_mul_f32 v[168:169], v[168:169], v[132:133]
    v_pk_mul_f32 v[170:171], v[170:171], v[114:115]
    v_pk_mul_f32 v[172:173], v[172:173], v[134:135]
    v_pk_mul_f32 v[174:175], v[174:175], v[116:117]
    v_cvt_pk_bf16_f32 v144, v172, v168
    v_cvt_pk_bf16_f32 v145, v164, v160
    v_cvt_pk_bf16_f32 v146, v174, v170
    v_cvt_pk_bf16_f32 v147, v166, v162
    v_cvt_pk_bf16_f32 v148, v173, v169
    v_cvt_pk_bf16_f32 v149, v165, v161
    v_cvt_pk_bf16_f32 v150, v175, v171
    v_cvt_pk_bf16_f32 v151, v167, v163
    ds_write_b64 v203, v[144:145] offset:0
    ds_write_b64 v203, v[146:147] offset:128
    buffer_load_dwordx4 v247, s[40:43], s61 offen offset:3072 lds
    ds_write_b64 v203, v[148:149] offset:256
    ds_write_b64 v203, v[150:151] offset:384
    s_waitcnt vmcnt(16)
    s_mov_b32 s78, 0x3f803f80
    v_mov_b32 v228, 0
    v_mov_b32 v229, 0
    v_dot2c_f32_bf16 v228, s78, v216
    v_dot2c_f32_bf16 v229, v216, v216
    v_dot2c_f32_bf16 v228, s78, v217
    v_dot2c_f32_bf16 v229, v217, v217
    v_dot2c_f32_bf16 v228, s78, v218
    v_dot2c_f32_bf16 v229, v218, v218
    v_dot2c_f32_bf16 v228, s78, v219
    v_dot2c_f32_bf16 v229, v219, v219
    v_dot2c_f32_bf16 v228, s78, v220
PAGE1:
    s_cbranch_execz PAGE2
    v_dot2c_f32_bf16 v229, v220, v220
    v_dot2c_f32_bf16 v228, s78, v221
    s_bitcmp1_b32 s0, 1
    s_cselect_b32 s87, s85, 128
    s_cselect_b32 s88, s86, 221184
    s_add_u32 s60, s60, s87
    s_add_u32 s61, s61, s88
    v_dot2c_f32_bf16 v229, v221, v221
    v_dot2c_f32_bf16 v228, s78, v222
    v_dot2c_f32_bf16 v229, v222, v222
    v_dot2c_f32_bf16 v228, s78, v223
    v_dot2c_f32_bf16 v229, v223, v223
    v_dot2c_f32_bf16 v228, s78, v224
    v_dot2c_f32_bf16 v229, v224, v224
    v_dot2c_f32_bf16 v228, s78, v225
    v_dot2c_f32_bf16 v229, v225, v225
    s_nop 1
    v_add_f32_dpp v228, v228, v228 row_ror:8 row_mask:0xf bank_mask:0xf
    v_add_f32_dpp v229, v229, v229 row_ror:8 row_mask:0xf bank_mask:0xf
    s_nop 1
    v_add_f32_dpp v228, v228, v228 row_ror:4 row_mask:0xf bank_mask:0xf
    v_add_f32_dpp v229, v229, v229 row_ror:4 row_mask:0xf bank_mask:0xf
    s_nop 1
    v_add_f32_dpp v228, v228, v228 row_ror:2 row_mask:0xf bank_mask:0xf
    v_add_f32_dpp v229, v229, v229 row_ror:2 row_mask:0xf bank_mask:0xf
    s_nop 1
    v_add_f32_dpp v228, v228, v228 row_ror:1 row_mask:0xf bank_mask:0xf
    v_add_f32_dpp v229, v229, v229 row_ror:1 row_mask:0xf bank_mask:0xf
    s_nop 1
    v_add_f32_dpp v228, v228, v228 row_bcast:15 row_mask:0xa bank_mask:0xf
    v_add_f32_dpp v229, v229, v229 row_bcast:15 row_mask:0xa bank_mask:0xf
    s_nop 0
    v_mul_f32 v230, 0x3acccccd, v228
    v_mul_f32 v229, 0x3acccccd, v229
    v_fma_f32 v229, -v230, v230, v229
    v_max_f32 v229, 0, v229
    v_add_f32 v229, 0x3727c5ac, v229
    v_rsq_f32_e64 v231, v229
    s_mov_b32 s78, 65536
    s_mov_b32 exec_lo, 0x10000
    s_mov_b32 exec_hi, 0x10000
    buffer_store_dwordx2 v[230:231], v226, s[36:39], s78 offen sc1
    s_mov_b64 exec, -1
    s_mul_i32 s78, s57, 56
    s_lshl_b32 s79, s58, 1
    s_add_u32 s78, s78, s79
    s_lshl_b32 s78, s78, 1
    s_add_u32 s78, s78, s3
    s_lshl_b32 s78, s78, 11
    s_mov_b32 s80, s12
    s_mov_b32 s81, s13
    s_mov_b32 s82, 2621440
    s_mov_b32 s83, 0x20000
    v_min_u32 v127, 15, v0
    v_lshlrev_b32 v127, 7, v127
    buffer_load_dword v127, v127, s[80:83], s78 offen
    s_waitcnt vmcnt(10) lgkmcnt(0)
    s_barrier
    s_add_u32 s56, s56, 2654435769
    v_mov_b32 v31, s56
    ds_read_b128 v[48:51], v10 offset:0
    ds_read_b64_tr_b16 v[32:33], v2 offset:16384
    ds_read_b64_tr_b16 v[34:35], v2 offset:17408
    ds_read_b128 v[52:55], v10 offset:2048
    ds_read_b64_tr_b16 v[36:37], v3 offset:16384
    ds_read_b64_tr_b16 v[38:39], v3 offset:17408
    ds_read_b128 v[56:59], v10 offset:4096
    ds_read_b64_tr_b16 v[40:41], v4 offset:16384
    ds_read_b64_tr_b16 v[42:43], v4 offset:17408
    ds_read_b128 v[60:63], v10 offset:6144
    ds_read_b64_tr_b16 v[44:45], v5 offset:16384
    ds_read_b64_tr_b16 v[46:47], v5 offset:17408
    ds_read_b128 v[96:99], v204 offset:0
    ds_read_b128 v[100:103], v204 offset:4096
    s_add_u32 m0, s62, 65536
    s_nop 0
    buffer_load_dwordx4 v240, s[32:35], s60 offen offset:0 lds
    buffer_load_dwordx4 v241, s[32:35], s60 offen offset:1024 lds
    buffer_load_dwordx4 v242, s[32:35], s60 offen offset:2048 lds
    buffer_load_dwordx4 v243, s[32:35], s60 offen offset:3072 lds
    s_waitcnt lgkmcnt(0)
    v_mfma_f32_16x16x32_bf16 v[128:131], v[32:35], v[48:51], 0
    ds_read_b128 v[80:83], v11 offset:0
    buffer_store_dwordx4 v[96:99], v205, s[36:39], s59 offen sc1
    v_mfma_f32_16x16x32_bf16 v[132:135], v[32:35], v[52:55], 0
    ds_read_b64_tr_b16 v[64:65], v2 offset:24576
    buffer_store_dwordx4 v[100:103], v206, s[36:39], s59 offen sc1
    v_mfma_f32_16x16x32_bf16 v[136:139], v[32:35], v[56:59], 0
    ds_read_b64_tr_b16 v[66:67], v2 offset:25600
    v_mfma_f32_16x16x32_bf16 v[140:143], v[32:35], v[60:63], 0
    ds_read_b128 v[84:87], v11 offset:2048
    v_mfma_f32_16x16x32_bf16 v[192:195], v[32:35], v[20:23], 0
    ds_read_b64_tr_b16 v[68:69], v3 offset:24576
    v_mfma_f32_16x16x32_bf16 v[144:147], v[36:39], v[48:51], 0
    ds_read_b64_tr_b16 v[70:71], v3 offset:25600
    s_add_u32 m0, s62, 81920
    v_mfma_f32_16x16x32_bf16 v[148:151], v[36:39], v[52:55], 0
    ds_read_b128 v[88:91], v11 offset:4096
    v_mfma_f32_16x16x32_bf16 v[152:155], v[36:39], v[56:59], 0
    ds_read_b64_tr_b16 v[72:73], v4 offset:24576
    buffer_load_dwordx4 v244, s[40:43], s61 offen offset:0 lds
    v_mfma_f32_16x16x32_bf16 v[156:159], v[36:39], v[60:63], 0
    ds_read_b64_tr_b16 v[74:75], v4 offset:25600
    v_mfma_f32_16x16x32_bf16 v[196:199], v[36:39], v[20:23], 0
    ds_read_b128 v[92:95], v11 offset:6144
    v_mfma_f32_16x16x32_bf16 v[160:163], v[40:43], v[48:51], 0
    ds_read_b64_tr_b16 v[76:77], v5 offset:24576
    buffer_load_dwordx4 v245, s[40:43], s61 offen offset:1024 lds
    v_mfma_f32_16x16x32_bf16 v[164:167], v[40:43], v[52:55], 0
    ds_read_b64_tr_b16 v[78:79], v5 offset:25600
    v_mfma_f32_16x16x32_bf16 v[168:171], v[40:43], v[56:59], 0
    v_mfma_f32_16x16x32_bf16 v[172:175], v[40:43], v[60:63], 0
    buffer_load_dwordx4 v246, s[40:43], s61 offen offset:2048 lds
    v_mfma_f32_16x16x32_bf16 v[176:179], v[44:47], v[48:51], 0
    v_mfma_f32_16x16x32_bf16 v[180:183], v[44:47], v[52:55], 0
    buffer_load_dwordx4 v247, s[40:43], s61 offen offset:3072 lds
    s_bitcmp1_b32 s0, 2
    s_cselect_b32 s87, s85, 128
    s_cselect_b32 s88, s86, 221184
    v_mfma_f32_16x16x32_bf16 v[184:187], v[44:47], v[56:59], 0
    s_add_u32 s60, s60, s87
    v_mfma_f32_16x16x32_bf16 v[188:191], v[44:47], v[60:63], 0
    s_add_u32 s61, s61, s88
    s_waitcnt vmcnt(12) lgkmcnt(0)
    s_barrier
    s_nop 0
    v_mfma_f32_16x16x32_bf16 v[128:131], v[64:67], v[80:83], v[128:131]
    ds_read_b128 v[48:51], v10 offset:32768
    s_add_u32 m0, s62, 98304
    v_mfma_f32_16x16x32_bf16 v[132:135], v[64:67], v[84:87], v[132:135]
    ds_read_b64_tr_b16 v[32:33], v2 offset:49152
    v_mov_b32 v30, 17563648
    v_mfma_f32_16x16x32_bf16 v[136:139], v[64:67], v[88:91], v[136:139]
    ds_read_b64_tr_b16 v[34:35], v2 offset:50176
    buffer_load_dwordx4 v240, s[32:35], s60 offen offset:0 lds
    v_mfma_f32_16x16x32_bf16 v[140:143], v[64:67], v[92:95], v[140:143]
    ds_read_b128 v[52:55], v10 offset:34816
    s_cmp_eq_u32 s3, 0
    s_nop 0
    s_cselect_b32 s80, s84, 17563648
    v_mfma_f32_16x16x32_bf16 v[192:195], v[64:67], v[20:23], v[192:195]
    ds_read_b64_tr_b16 v[36:37], v3 offset:49152
    v_mfma_f32_16x16x32_bf16 v[144:147], v[68:71], v[80:83], v[144:147]
    ds_read_b64_tr_b16 v[38:39], v3 offset:50176
    v_mfma_f32_16x16x32_bf16 v[148:151], v[68:71], v[84:87], v[148:151]
    ds_read_b128 v[56:59], v10 offset:36864
    buffer_load_dwordx4 v241, s[32:35], s60 offen offset:1024 lds
    v_mfma_f32_16x16x32_bf16 v[152:155], v[68:71], v[88:91], v[152:155]
    ds_read_b64_tr_b16 v[40:41], v4 offset:49152
    v_writelane_b32 v30, s80, 1
    v_mfma_f32_16x16x32_bf16 v[156:159], v[68:71], v[92:95], v[156:159]
    ds_read_b64_tr_b16 v[42:43], v4 offset:50176
    v_mfma_f32_16x16x32_bf16 v[196:199], v[68:71], v[20:23], v[196:199]
    ds_read_b128 v[60:63], v10 offset:38912
    s_lshl_b32 s77, s57, 1
    v_mfma_f32_16x16x32_bf16 v[160:163], v[72:75], v[80:83], v[160:163]
    ds_read_b64_tr_b16 v[44:45], v5 offset:49152
    s_lshr_b32 s78, s58, 4
    v_mfma_f32_16x16x32_bf16 v[164:167], v[72:75], v[84:87], v[164:167]
    ds_read_b64_tr_b16 v[46:47], v5 offset:50176
    buffer_load_dwordx4 v242, s[32:35], s60 offen offset:2048 lds
    v_mfma_f32_16x16x32_bf16 v[168:171], v[72:75], v[88:91], v[168:171]
    s_add_u32 s77, s77, s78
    v_mfma_f32_16x16x32_bf16 v[172:175], v[72:75], v[92:95], v[172:175]
    s_lshl_b32 s77, s77, 4
    v_mfma_f32_16x16x32_bf16 v[176:179], v[76:79], v[80:83], v[176:179]
    s_and_b32 s78, s58, 15
    v_mfma_f32_16x16x32_bf16 v[180:183], v[76:79], v[84:87], v[180:183]
    buffer_load_dwordx4 v243, s[32:35], s60 offen offset:3072 lds
    s_add_u32 s77, s77, s78
    v_mfma_f32_16x16x32_bf16 v[184:187], v[76:79], v[88:91], v[184:187]
    s_lshl_b32 s77, s77, 6
    v_mfma_f32_16x16x32_bf16 v[188:191], v[76:79], v[92:95], v[188:191]
    s_add_u32 s77, s77, 196608
    s_waitcnt lgkmcnt(0)
    v_mfma_f32_16x16x32_bf16 v[128:131], v[32:35], v[48:51], v[128:131]
    ds_read_b128 v[80:83], v11 offset:32768
    s_add_u32 m0, s62, 114688
    v_mfma_f32_16x16x32_bf16 v[132:135], v[32:35], v[52:55], v[132:135]
    ds_read_b64_tr_b16 v[64:65], v2 offset:57344
    s_cmp_eq_u32 s3, 0
    s_nop 0
    s_cselect_b32 s77, s77, 17563648
    v_mfma_f32_16x16x32_bf16 v[136:139], v[32:35], v[56:59], v[136:139]
    ds_read_b64_tr_b16 v[66:67], v2 offset:58368
    buffer_load_dwordx4 v244, s[40:43], s61 offen offset:0 lds
    v_mfma_f32_16x16x32_bf16 v[140:143], v[32:35], v[60:63], v[140:143]
    ds_read_b128 v[84:87], v11 offset:34816
    v_mfma_f32_16x16x32_bf16 v[192:195], v[32:35], v[20:23], v[192:195]
    ds_read_b64_tr_b16 v[68:69], v3 offset:57344
    v_writelane_b32 v30, s77, 0
    v_mfma_f32_16x16x32_bf16 v[144:147], v[36:39], v[48:51], v[144:147]
    ds_read_b64_tr_b16 v[70:71], v3 offset:58368
    s_and_b32 s77, s58, 7
    v_mfma_f32_16x16x32_bf16 v[148:151], v[36:39], v[52:55], v[148:151]
    ds_read_b128 v[88:91], v11 offset:36864
    buffer_load_dwordx4 v245, s[40:43], s61 offen offset:1024 lds
    v_mfma_f32_16x16x32_bf16 v[152:155], v[36:39], v[56:59], v[152:155]
    ds_read_b64_tr_b16 v[72:73], v4 offset:57344
    s_lshl_b32 s77, s77, 5
    v_mfma_f32_16x16x32_bf16 v[156:159], v[36:39], v[60:63], v[156:159]
    ds_read_b64_tr_b16 v[74:75], v4 offset:58368
    s_lshl_b32 s78, s57, 2
    v_mfma_f32_16x16x32_bf16 v[196:199], v[36:39], v[20:23], v[196:199]
    ds_read_b128 v[92:95], v11 offset:38912
    s_lshr_b32 s79, s58, 3
    v_mfma_f32_16x16x32_bf16 v[160:163], v[40:43], v[48:51], v[160:163]
    ds_read_b64_tr_b16 v[76:77], v5 offset:57344
    buffer_load_dwordx4 v246, s[40:43], s61 offen offset:2048 lds
    v_mfma_f32_16x16x32_bf16 v[164:167], v[40:43], v[52:55], v[164:167]
    ds_read_b64_tr_b16 v[78:79], v5 offset:58368
    s_add_u32 s78, s78, s79
    v_mfma_f32_16x16x32_bf16 v[168:171], v[40:43], v[56:59], v[168:171]
    s_add_u32 s77, s77, s78
    s_lshl_b32 s77, s77, 6
    v_mfma_f32_16x16x32_bf16 v[172:175], v[40:43], v[60:63], v[172:175]
    buffer_load_dwordx4 v247, s[40:43], s61 offen offset:3072 lds
    s_add_u32 s77, s77, 163840
    v_mfma_f32_16x16x32_bf16 v[176:179], v[44:47], v[48:51], v[176:179]
    s_cmp_eq_u32 s3, 0
    s_cselect_b32 s77, s77, 17563648
    v_mfma_f32_16x16x32_bf16 v[180:183], v[44:47], v[52:55], v[180:183]
    s_bitcmp1_b32 s0, 3
    s_cselect_b32 s87, s85, 128
    s_cselect_b32 s88, s86, 221184
    v_mfma_f32_16x16x32_bf16 v[184:187], v[44:47], v[56:59], v[184:187]
    s_add_u32 s60, s60, s87
    v_writelane_b32 v30, s77, 2
    v_mfma_f32_16x16x32_bf16 v[188:191], v[44:47], v[60:63], v[188:191]
    s_add_u32 s61, s61, s88
    s_waitcnt vmcnt(8) lgkmcnt(0)
    s_barrier
    s_mov_b32 exec_lo, 3
    s_mov_b32 exec_hi, 0
    buffer_store_dword v31, v30, s[36:39], 0 offen sc1
    s_mov_b64 exec, -1
    v_mfma_f32_16x16x32_bf16 v[128:131], v[64:67], v[80:83], v[128:131]
    ds_read_b128 v[48:51], v12 offset:0
    s_lshl_b32 m0, s3, 10
    s_add_u32 m0, m0, 139776
    s_nop 0
    buffer_load_dwordx4 v253, s[44:47], 0 offen nt lds
    v_mfma_f32_16x16x32_bf16 v[132:135], v[64:67], v[84:87], v[132:135]
    ds_read_b64_tr_b16 v[32:33], v6 offset:16384
    s_lshl_b32 m0, s3, 10
    s_add_u32 m0, m0, 143872
    s_nop 0
    buffer_load_dwordx4 v254, s[44:47], 0 offen nt lds
    v_mfma_f32_16x16x32_bf16 v[136:139], v[64:67], v[88:91], v[136:139]
    ds_read_b64_tr_b16 v[34:35], v6 offset:17408
    s_lshl_b32 m0, s3, 10
    s_add_u32 m0, m0, 147968
    s_nop 0
    buffer_load_dwordx4 v255, s[44:47], 0 offen nt lds
    v_mfma_f32_16x16x32_bf16 v[140:143], v[64:67], v[92:95], v[140:143]
    ds_read_b128 v[52:55], v12 offset:2048
    v_min_u32_e64 v28, 15, v0
    v_mfma_f32_16x16x32_bf16 v[192:195], v[64:67], v[20:23], v[192:195]
    ds_read_b64_tr_b16 v[36:37], v7 offset:16384
    v_mfma_f32_16x16x32_bf16 v[144:147], v[68:71], v[80:83], v[144:147]
    ds_read_b64_tr_b16 v[38:39], v7 offset:17408
    s_add_u32 m0, s62, 0
    v_mfma_f32_16x16x32_bf16 v[148:151], v[68:71], v[84:87], v[148:151]
    ds_read_b128 v[56:59], v12 offset:4096
    v_lshlrev_b32 v28, 6, v28
    v_mfma_f32_16x16x32_bf16 v[152:155], v[68:71], v[88:91], v[152:155]
    ds_read_b64_tr_b16 v[40:41], v8 offset:16384
    buffer_load_dwordx4 v240, s[32:35], s60 offen offset:0 lds
    v_mfma_f32_16x16x32_bf16 v[156:159], v[68:71], v[92:95], v[156:159]
    ds_read_b64_tr_b16 v[42:43], v8 offset:17408
    v_mfma_f32_16x16x32_bf16 v[196:199], v[68:71], v[20:23], v[196:199]
    ds_read_b128 v[60:63], v12 offset:6144
    v_mfma_f32_16x16x32_bf16 v[160:163], v[72:75], v[80:83], v[160:163]
    ds_read_b64_tr_b16 v[44:45], v9 offset:16384
    buffer_load_dwordx4 v241, s[32:35], s60 offen offset:1024 lds
    v_mfma_f32_16x16x32_bf16 v[164:167], v[72:75], v[84:87], v[164:167]
    ds_read_b64_tr_b16 v[46:47], v9 offset:17408
    s_lshl_b32 s73, s63, 10
    v_mfma_f32_16x16x32_bf16 v[168:171], v[72:75], v[88:91], v[168:171]
    v_mfma_f32_16x16x32_bf16 v[172:175], v[72:75], v[92:95], v[172:175]
    buffer_load_dwordx4 v242, s[32:35], s60 offen offset:2048 lds
    s_add_u32 s73, s73, 196608
    v_mfma_f32_16x16x32_bf16 v[176:179], v[76:79], v[80:83], v[176:179]
    v_add_u32 v28, s73, v28
    v_mfma_f32_16x16x32_bf16 v[180:183], v[76:79], v[84:87], v[180:183]
    buffer_load_dwordx4 v243, s[32:35], s60 offen offset:3072 lds
    v_mfma_f32_16x16x32_bf16 v[184:187], v[76:79], v[88:91], v[184:187]
    s_mov_b32 s48, s20
    v_mfma_f32_16x16x32_bf16 v[188:191], v[76:79], v[92:95], v[188:191]
    s_waitcnt lgkmcnt(0)
    v_mfma_f32_16x16x32_bf16 v[128:131], v[32:35], v[48:51], v[128:131]
    ds_read_b128 v[80:83], v13 offset:0
    s_add_u32 m0, s62, 16384
    v_mfma_f32_16x16x32_bf16 v[132:135], v[32:35], v[52:55], v[132:135]
    ds_read_b64_tr_b16 v[64:65], v6 offset:24576
    s_mov_b32 s49, s21
    s_nop 0
    v_mfma_f32_16x16x32_bf16 v[136:139], v[32:35], v[56:59], v[136:139]
    ds_read_b64_tr_b16 v[66:67], v6 offset:25600
    buffer_load_dwordx4 v244, s[40:43], s61 offen offset:0 lds
    v_mfma_f32_16x16x32_bf16 v[140:143], v[32:35], v[60:63], v[140:143]
    ds_read_b128 v[84:87], v13 offset:2048
    v_mfma_f32_16x16x32_bf16 v[192:195], v[32:35], v[20:23], v[192:195]
    ds_read_b64_tr_b16 v[68:69], v7 offset:24576
    s_mov_b32 s50, 3456
    v_mfma_f32_16x16x32_bf16 v[144:147], v[36:39], v[48:51], v[144:147]
    ds_read_b64_tr_b16 v[70:71], v7 offset:25600
    v_mfma_f32_16x16x32_bf16 v[148:151], v[36:39], v[52:55], v[148:151]
    ds_read_b128 v[88:91], v13 offset:4096
    buffer_load_dwordx4 v245, s[40:43], s61 offen offset:1024 lds
    v_mfma_f32_16x16x32_bf16 v[152:155], v[36:39], v[56:59], v[152:155]
    ds_read_b64_tr_b16 v[72:73], v8 offset:24576
    v_mfma_f32_16x16x32_bf16 v[156:159], v[36:39], v[60:63], v[156:159]
    ds_read_b64_tr_b16 v[74:75], v8 offset:25600
    s_mov_b32 s51, 0x20000
    v_mfma_f32_16x16x32_bf16 v[196:199], v[36:39], v[20:23], v[196:199]
    ds_read_b128 v[92:95], v13 offset:6144
    v_mfma_f32_16x16x32_bf16 v[160:163], v[40:43], v[48:51], v[160:163]
    ds_read_b64_tr_b16 v[76:77], v9 offset:24576
    buffer_load_dwordx4 v246, s[40:43], s61 offen offset:2048 lds
    v_mfma_f32_16x16x32_bf16 v[164:167], v[40:43], v[52:55], v[164:167]
    ds_read_b64_tr_b16 v[78:79], v9 offset:25600
    v_lshrrev_b32 v24, 4, v0
    v_mfma_f32_16x16x32_bf16 v[168:171], v[40:43], v[56:59], v[168:171]
    v_mfma_f32_16x16x32_bf16 v[172:175], v[40:43], v[60:63], v[172:175]
    buffer_load_dwordx4 v247, s[40:43], s61 offen offset:3072 lds
    s_lshl_b32 s73, s69, 5
    v_mfma_f32_16x16x32_bf16 v[176:179], v[44:47], v[48:51], v[176:179]
    v_lshl_add_u32 v232, v24, 3, s73
    v_mfma_f32_16x16x32_bf16 v[180:183], v[44:47], v[52:55], v[180:183]
    s_bitcmp1_b32 s0, 4
    s_cselect_b32 s87, s85, 128
    s_cselect_b32 s88, s86, 221184
    v_mfma_f32_16x16x32_bf16 v[184:187], v[44:47], v[56:59], v[184:187]
    s_add_u32 s60, s60, s87
    v_mfma_f32_16x16x32_bf16 v[188:191], v[44:47], v[60:63], v[188:191]
    s_add_u32 s61, s61, s88
    s_waitcnt vmcnt(12) lgkmcnt(0)
    s_barrier
    v_mfma_f32_16x16x32_bf16 v[128:131], v[64:67], v[80:83], v[128:131]
    ds_read_b128 v[48:51], v12 offset:32768
    s_add_u32 m0, s62, 32768
    v_mfma_f32_16x16x32_bf16 v[132:135], v[64:67], v[84:87], v[132:135]
    ds_read_b64_tr_b16 v[32:33], v6 offset:49152
    s_lshl_b32 s73, s70, 5
    v_mfma_f32_16x16x32_bf16 v[136:139], v[64:67], v[88:91], v[136:139]
    ds_read_b64_tr_b16 v[34:35], v6 offset:50176
    buffer_load_dwordx4 v240, s[32:35], s60 offen offset:0 lds
    v_mfma_f32_16x16x32_bf16 v[140:143], v[64:67], v[92:95], v[140:143]
    ds_read_b128 v[52:55], v12 offset:34816
    v_mfma_f32_16x16x32_bf16 v[192:195], v[64:67], v[20:23], v[192:195]
    ds_read_b64_tr_b16 v[36:37], v7 offset:49152
    v_mfma_f32_16x16x32_bf16 v[144:147], v[68:71], v[80:83], v[144:147]
    ds_read_b64_tr_b16 v[38:39], v7 offset:50176
    v_lshl_add_u32 v233, v24, 3, s73
    v_mfma_f32_16x16x32_bf16 v[148:151], v[68:71], v[84:87], v[148:151]
    ds_read_b128 v[56:59], v12 offset:36864
    buffer_load_dwordx4 v241, s[32:35], s60 offen offset:1024 lds
    v_mfma_f32_16x16x32_bf16 v[152:155], v[68:71], v[88:91], v[152:155]
    ds_read_b64_tr_b16 v[40:41], v8 offset:49152
    v_mfma_f32_16x16x32_bf16 v[156:159], v[68:71], v[92:95], v[156:159]
    ds_read_b64_tr_b16 v[42:43], v8 offset:50176
    v_mfma_f32_16x16x32_bf16 v[196:199], v[68:71], v[20:23], v[196:199]
    ds_read_b128 v[60:63], v12 offset:38912
    s_lshl_b32 s73, s71, 5
    v_mfma_f32_16x16x32_bf16 v[160:163], v[72:75], v[80:83], v[160:163]
    ds_read_b64_tr_b16 v[44:45], v9 offset:49152
    v_mfma_f32_16x16x32_bf16 v[164:167], v[72:75], v[84:87], v[164:167]
    ds_read_b64_tr_b16 v[46:47], v9 offset:50176
    buffer_load_dwordx4 v242, s[32:35], s60 offen offset:2048 lds
    v_mfma_f32_16x16x32_bf16 v[168:171], v[72:75], v[88:91], v[168:171]
    v_lshl_add_u32 v234, v24, 3, s73
    v_mfma_f32_16x16x32_bf16 v[172:175], v[72:75], v[92:95], v[172:175]
    v_mfma_f32_16x16x32_bf16 v[176:179], v[76:79], v[80:83], v[176:179]
    s_lshl_b32 s73, s72, 5
    v_mfma_f32_16x16x32_bf16 v[180:183], v[76:79], v[84:87], v[180:183]
    buffer_load_dwordx4 v243, s[32:35], s60 offen offset:3072 lds
    v_mfma_f32_16x16x32_bf16 v[184:187], v[76:79], v[88:91], v[184:187]
    v_lshl_add_u32 v235, v24, 3, s73
    v_mfma_f32_16x16x32_bf16 v[188:191], v[76:79], v[92:95], v[188:191]
    s_waitcnt lgkmcnt(0)
    v_mfma_f32_16x16x32_bf16 v[128:131], v[32:35], v[48:51], v[128:131]
    ds_read_b128 v[80:83], v13 offset:32768
    s_add_u32 m0, s62, 49152
    v_mfma_f32_16x16x32_bf16 v[132:135], v[32:35], v[52:55], v[132:135]
    ds_read_b64_tr_b16 v[64:65], v6 offset:57344
    s_lshr_b32 s78, s57, 1
    v_mfma_f32_16x16x32_bf16 v[136:139], v[32:35], v[56:59], v[136:139]
    ds_read_b64_tr_b16 v[66:67], v6 offset:58368
    buffer_load_dwordx4 v244, s[40:43], s61 offen offset:0 lds
    v_mfma_f32_16x16x32_bf16 v[140:143], v[32:35], v[60:63], v[140:143]
    ds_read_b128 v[84:87], v13 offset:34816
    v_mfma_f32_16x16x32_bf16 v[192:195], v[32:35], v[20:23], v[192:195]
    ds_read_b64_tr_b16 v[68:69], v7 offset:57344
    s_lshl_b32 s78, s78, 3
    s_nop 0
    v_mfma_f32_16x16x32_bf16 v[144:147], v[36:39], v[48:51], v[144:147]
    ds_read_b64_tr_b16 v[70:71], v7 offset:58368
    v_mfma_f32_16x16x32_bf16 v[148:151], v[36:39], v[52:55], v[148:151]
    ds_read_b128 v[88:91], v13 offset:36864
    buffer_load_dwordx4 v245, s[40:43], s61 offen offset:1024 lds
    v_mfma_f32_16x16x32_bf16 v[152:155], v[36:39], v[56:59], v[152:155]
    ds_read_b64_tr_b16 v[72:73], v8 offset:57344
    v_mfma_f32_16x16x32_bf16 v[156:159], v[36:39], v[60:63], v[156:159]
    ds_read_b64_tr_b16 v[74:75], v8 offset:58368
    s_and_b32 s79, s58, 7
    v_mfma_f32_16x16x32_bf16 v[196:199], v[36:39], v[20:23], v[196:199]
    ds_read_b128 v[92:95], v13 offset:38912
    v_mfma_f32_16x16x32_bf16 v[160:163], v[40:43], v[48:51], v[160:163]
    ds_read_b64_tr_b16 v[76:77], v9 offset:57344
    buffer_load_dwordx4 v246, s[40:43], s61 offen offset:2048 lds
    v_mfma_f32_16x16x32_bf16 v[164:167], v[40:43], v[52:55], v[164:167]
    ds_read_b64_tr_b16 v[78:79], v9 offset:58368
    s_add_u32 s53, s78, s79
    v_mfma_f32_16x16x32_bf16 v[168:171], v[40:43], v[56:59], v[168:171]
    v_mfma_f32_16x16x32_bf16 v[172:175], v[40:43], v[60:63], v[172:175]
    buffer_load_dwordx4 v247, s[40:43], s61 offen offset:3072 lds
    s_mul_i32 s28, s79, 7
    v_mfma_f32_16x16x32_bf16 v[176:179], v[44:47], v[48:51], v[176:179]
    s_and_b32 s78, s57, 1
    v_mfma_f32_16x16x32_bf16 v[180:183], v[44:47], v[52:55], v[180:183]
    s_bitcmp1_b32 s0, 5
    s_cselect_b32 s87, s85, 128
    s_cselect_b32 s88, s86, 221184
    v_mfma_f32_16x16x32_bf16 v[184:187], v[44:47], v[56:59], v[184:187]
    s_add_u32 s60, s60, s87
    v_mfma_f32_16x16x32_bf16 v[188:191], v[44:47], v[60:63], v[188:191]
    s_add_u32 s61, s61, s88
    s_waitcnt vmcnt(8) lgkmcnt(0)
    s_barrier
    v_mfma_f32_16x16x32_bf16 v[128:131], v[64:67], v[80:83], v[128:131]
    ds_read_b128 v[48:51], v10 offset:0
    s_add_u32 m0, s62, 65536
    v_mfma_f32_16x16x32_bf16 v[132:135], v[64:67], v[84:87], v[132:135]
    ds_read_b64_tr_b16 v[32:33], v2 offset:16384
    s_lshl_b32 s78, s78, 2
    v_mfma_f32_16x16x32_bf16 v[136:139], v[64:67], v[88:91], v[136:139]
    ds_read_b64_tr_b16 v[34:35], v2 offset:17408
    buffer_load_dwordx4 v240, s[32:35], s60 offen offset:0 lds
    v_mfma_f32_16x16x32_bf16 v[140:143], v[64:67], v[92:95], v[140:143]
    ds_read_b128 v[52:55], v10 offset:2048
    v_mfma_f32_16x16x32_bf16 v[192:195], v[64:67], v[20:23], v[192:195]
    ds_read_b64_tr_b16 v[36:37], v3 offset:16384
    s_lshr_b32 s79, s58, 3
    v_mfma_f32_16x16x32_bf16 v[144:147], v[68:71], v[80:83], v[144:147]
    ds_read_b64_tr_b16 v[38:39], v3 offset:17408
    v_mfma_f32_16x16x32_bf16 v[148:151], v[68:71], v[84:87], v[148:151]
    ds_read_b128 v[56:59], v10 offset:4096
    buffer_load_dwordx4 v241, s[32:35], s60 offen offset:1024 lds
    v_mfma_f32_16x16x32_bf16 v[152:155], v[68:71], v[88:91], v[152:155]
    ds_read_b64_tr_b16 v[40:41], v4 offset:16384
    s_add_u32 s54, s78, s79
    v_mfma_f32_16x16x32_bf16 v[156:159], v[68:71], v[92:95], v[156:159]
    ds_read_b64_tr_b16 v[42:43], v4 offset:17408
    v_mfma_f32_16x16x32_bf16 v[196:199], v[68:71], v[20:23], v[196:199]
    ds_read_b128 v[60:63], v10 offset:6144
    s_mul_i32 s79, s79, 14
    v_mfma_f32_16x16x32_bf16 v[160:163], v[72:75], v[80:83], v[160:163]
    ds_read_b64_tr_b16 v[44:45], v5 offset:16384
    v_mfma_f32_16x16x32_bf16 v[164:167], v[72:75], v[84:87], v[164:167]
    ds_read_b64_tr_b16 v[46:47], v5 offset:17408
    buffer_load_dwordx4 v242, s[32:35], s60 offen offset:2048 lds
    v_mfma_f32_16x16x32_bf16 v[168:171], v[72:75], v[88:91], v[168:171]
    ds_read_b64_tr_b16 v[216:217], v200 offset:0
    s_add_u32 s28, s28, s79
    v_mfma_f32_16x16x32_bf16 v[172:175], v[72:75], v[92:95], v[172:175]
    ds_read_b64_tr_b16 v[218:219], v200 offset:2560
    v_mfma_f32_16x16x32_bf16 v[176:179], v[76:79], v[80:83], v[176:179]
    ds_read_b64_tr_b16 v[220:221], v201 offset:0
    s_lshr_b32 s28, s28, 2
    v_mfma_f32_16x16x32_bf16 v[180:183], v[76:79], v[84:87], v[180:183]
    ds_read_b64_tr_b16 v[222:223], v201 offset:2560
    buffer_load_dwordx4 v243, s[32:35], s60 offen offset:3072 lds
    v_mfma_f32_16x16x32_bf16 v[184:187], v[76:79], v[88:91], v[184:187]
    ds_read_b64_tr_b16 v[224:225], v202 offset:0
    v_mfma_f32_16x16x32_bf16 v[188:191], v[76:79], v[92:95], v[188:191]
    ds_read_b64_tr_b16 v[226:227], v202 offset:2560
    s_waitcnt lgkmcnt(0)
    v_mfma_f32_16x16x32_bf16 v[128:131], v[32:35], v[48:51], v[128:131]
    ds_read_b128 v[80:83], v11 offset:0
    buffer_store_dwordx4 v[216:219], v14, s[36:39], s74 offen sc1
    v_mfma_f32_16x16x32_bf16 v[132:135], v[32:35], v[52:55], v[132:135]
    ds_read_b64_tr_b16 v[64:65], v2 offset:24576
    buffer_store_dwordx4 v[220:223], v14, s[36:39], s75 offen sc1
    v_mfma_f32_16x16x32_bf16 v[136:139], v[32:35], v[56:59], v[136:139]
    ds_read_b64_tr_b16 v[66:67], v2 offset:25600
    buffer_store_dwordx4 v[224:227], v14, s[36:39], s76 offen sc1
    v_mfma_f32_16x16x32_bf16 v[140:143], v[32:35], v[60:63], v[140:143]
    ds_read_b128 v[84:87], v11 offset:2048
    s_cmp_ge_u32 s28, 14
    s_cselect_b32 s79, 14, 0
    v_mfma_f32_16x16x32_bf16 v[192:195], v[32:35], v[20:23], v[192:195]
    ds_read_b64_tr_b16 v[68:69], v3 offset:24576
    v_mfma_f32_16x16x32_bf16 v[144:147], v[36:39], v[48:51], v[144:147]
    ds_read_b64_tr_b16 v[70:71], v3 offset:25600
    s_add_u32 m0, s62, 81920
    v_mfma_f32_16x16x32_bf16 v[148:151], v[36:39], v[52:55], v[148:151]
    ds_read_b128 v[88:91], v11 offset:4096
    s_sub_u32 s28, s28, s79
    v_mfma_f32_16x16x32_bf16 v[152:155], v[36:39], v[56:59], v[152:155]
    ds_read_b64_tr_b16 v[72:73], v4 offset:24576
    buffer_load_dwordx4 v244, s[40:43], s61 offen offset:0 lds
    v_mfma_f32_16x16x32_bf16 v[156:159], v[36:39], v[60:63], v[156:159]
    ds_read_b64_tr_b16 v[74:75], v4 offset:25600
    v_mfma_f32_16x16x32_bf16 v[196:199], v[36:39], v[20:23], v[196:199]
    ds_read_b128 v[92:95], v11 offset:6144
    s_mov_b32 s28, 0
    v_mfma_f32_16x16x32_bf16 v[160:163], v[40:43], v[48:51], v[160:163]
    ds_read_b64_tr_b16 v[76:77], v5 offset:24576
    buffer_load_dwordx4 v245, s[40:43], s61 offen offset:1024 lds
    v_mfma_f32_16x16x32_bf16 v[164:167], v[40:43], v[52:55], v[164:167]
    ds_read_b64_tr_b16 v[78:79], v5 offset:25600
    s_mul_i32 s55, s3, 14
    v_mfma_f32_16x16x32_bf16 v[168:171], v[40:43], v[56:59], v[168:171]
    s_sub_u32 s79, s3, 1
    v_mfma_f32_16x16x32_bf16 v[172:175], v[40:43], v[60:63], v[172:175]
    buffer_load_dwordx4 v246, s[40:43], s61 offen offset:2048 lds
    s_cmp_ge_u32 s3, 2
    s_cselect_b32 s79, s79, 0
    v_mfma_f32_16x16x32_bf16 v[176:179], v[44:47], v[48:51], v[176:179]
    v_mfma_f32_16x16x32_bf16 v[180:183], v[44:47], v[52:55], v[180:183]
    buffer_load_dwordx4 v247, s[40:43], s61 offen offset:3072 lds
    s_bitcmp1_b32 s0, 6
    s_cselect_b32 s87, s85, 128
    s_cselect_b32 s88, s86, 221184
    v_mfma_f32_16x16x32_bf16 v[184:187], v[44:47], v[56:59], v[184:187]
    s_add_u32 s60, s60, s87
    s_sub_u32 s55, s55, s79
    v_mfma_f32_16x16x32_bf16 v[188:191], v[44:47], v[60:63], v[188:191]
    s_add_u32 s61, s61, s88
    s_waitcnt vmcnt(11) lgkmcnt(0)
    s_barrier
    v_mfma_f32_16x16x32_bf16 v[128:131], v[64:67], v[80:83], v[128:131]
    ds_read_b128 v[48:51], v10 offset:32768
    s_add_u32 m0, s62, 98304
    v_mfma_f32_16x16x32_bf16 v[132:135], v[64:67], v[84:87], v[132:135]
    ds_read_b64_tr_b16 v[32:33], v2 offset:49152
    s_mul_i32 s79, s54, 54
    s_nop 0
    v_mfma_f32_16x16x32_bf16 v[136:139], v[64:67], v[88:91], v[136:139]
    ds_read_b64_tr_b16 v[34:35], v2 offset:50176
    buffer_load_dwordx4 v240, s[32:35], s60 offen offset:0 lds
    v_mfma_f32_16x16x32_bf16 v[140:143], v[64:67], v[92:95], v[140:143]
    ds_read_b128 v[52:55], v10 offset:34816
    v_mfma_f32_16x16x32_bf16 v[192:195], v[64:67], v[20:23], v[192:195]
    ds_read_b64_tr_b16 v[36:37], v3 offset:49152
    v_mfma_f32_16x16x32_bf16 v[144:147], v[68:71], v[80:83], v[144:147]
    ds_read_b64_tr_b16 v[38:39], v3 offset:50176
    s_add_u32 s79, s79, s55
    s_nop 0
    v_mfma_f32_16x16x32_bf16 v[148:151], v[68:71], v[84:87], v[148:151]
    ds_read_b128 v[56:59], v10 offset:36864
    buffer_load_dwordx4 v241, s[32:35], s60 offen offset:1024 lds
    v_mfma_f32_16x16x32_bf16 v[152:155], v[68:71], v[88:91], v[152:155]
    ds_read_b64_tr_b16 v[40:41], v4 offset:49152
    v_mfma_f32_16x16x32_bf16 v[156:159], v[68:71], v[92:95], v[156:159]
    ds_read_b64_tr_b16 v[42:43], v4 offset:50176
    v_mfma_f32_16x16x32_bf16 v[196:199], v[68:71], v[20:23], v[196:199]
    ds_read_b128 v[60:63], v10 offset:38912
    s_mul_i32 s79, s79, 5120
    v_mfma_f32_16x16x32_bf16 v[160:163], v[72:75], v[80:83], v[160:163]
    ds_read_b64_tr_b16 v[44:45], v5 offset:49152
    v_mfma_f32_16x16x32_bf16 v[164:167], v[72:75], v[84:87], v[164:167]
    ds_read_b64_tr_b16 v[46:47], v5 offset:50176
    buffer_load_dwordx4 v242, s[32:35], s60 offen offset:2048 lds
    v_mfma_f32_16x16x32_bf16 v[168:171], v[72:75], v[88:91], v[168:171]
    s_add_u32 s79, s79, 4194304
    v_mfma_f32_16x16x32_bf16 v[172:175], v[72:75], v[92:95], v[172:175]
    v_mfma_f32_16x16x32_bf16 v[176:179], v[76:79], v[80:83], v[176:179]
    s_add_u32 s16, s79, 71680
    v_mfma_f32_16x16x32_bf16 v[180:183], v[76:79], v[84:87], v[180:183]
    buffer_load_dwordx4 v243, s[32:35], s60 offen offset:3072 lds
    v_mfma_f32_16x16x32_bf16 v[184:187], v[76:79], v[88:91], v[184:187]
    s_mul_i32 s52, s28, 5120
    v_mfma_f32_16x16x32_bf16 v[188:191], v[76:79], v[92:95], v[188:191]
    s_waitcnt lgkmcnt(0)
    v_mfma_f32_16x16x32_bf16 v[128:131], v[32:35], v[48:51], v[128:131]
    ds_read_b128 v[80:83], v11 offset:32768
    s_add_u32 m0, s62, 114688
PAGE2:
    s_cbranch_execz VISIT_RET
    v_mfma_f32_16x16x32_bf16 v[132:135], v[32:35], v[52:55], v[132:135]
    ds_read_b64_tr_b16 v[64:65], v2 offset:57344
    s_add_u32 s52, s52, s79
    v_mfma_f32_16x16x32_bf16 v[136:139], v[32:35], v[56:59], v[136:139]
    ds_read_b64_tr_b16 v[66:67], v2 offset:58368
    buffer_load_dwordx4 v244, s[40:43], s61 offen offset:0 lds
    v_mfma_f32_16x16x32_bf16 v[140:143], v[32:35], v[60:63], v[140:143]
    ds_read_b128 v[84:87], v11 offset:34816
    v_mfma_f32_16x16x32_bf16 v[192:195], v[32:35], v[20:23], v[192:195]
    ds_read_b64_tr_b16 v[68:69], v3 offset:57344
    v_lshlrev_b32 v14, 4, v0
    v_mfma_f32_16x16x32_bf16 v[144:147], v[36:39], v[48:51], v[144:147]
    ds_read_b64_tr_b16 v[70:71], v3 offset:58368
    v_mfma_f32_16x16x32_bf16 v[148:151], v[36:39], v[52:55], v[148:151]
    ds_read_b128 v[88:91], v11 offset:36864
    buffer_load_dwordx4 v245, s[40:43], s61 offen offset:1024 lds
    v_mfma_f32_16x16x32_bf16 v[152:155], v[36:39], v[56:59], v[152:155]
    ds_read_b64_tr_b16 v[72:73], v4 offset:57344
    v_mfma_f32_16x16x32_bf16 v[156:159], v[36:39], v[60:63], v[156:159]
    ds_read_b64_tr_b16 v[74:75], v4 offset:58368
    v_add_u32 v15, 4096, v14
    v_mfma_f32_16x16x32_bf16 v[196:199], v[36:39], v[20:23], v[196:199]
    ds_read_b128 v[92:95], v11 offset:38912
    v_mfma_f32_16x16x32_bf16 v[160:163], v[40:43], v[48:51], v[160:163]
    ds_read_b64_tr_b16 v[76:77], v5 offset:57344
    buffer_load_dwordx4 v246, s[40:43], s61 offen offset:2048 lds
    v_mfma_f32_16x16x32_bf16 v[164:167], v[40:43], v[52:55], v[164:167]
    ds_read_b64_tr_b16 v[78:79], v5 offset:58368
    s_mul_i32 s84, s57, 56
    v_mfma_f32_16x16x32_bf16 v[168:171], v[40:43], v[56:59], v[168:171]
    v_mfma_f32_16x16x32_bf16 v[172:175], v[40:43], v[60:63], v[172:175]
    buffer_load_dwordx4 v247, s[40:43], s61 offen offset:3072 lds
    s_lshl_b32 s78, s58, 1
    v_mfma_f32_16x16x32_bf16 v[176:179], v[44:47], v[48:51], v[176:179]
    s_add_u32 s84, s84, s78
    v_mfma_f32_16x16x32_bf16 v[180:183], v[44:47], v[52:55], v[180:183]
    s_bitcmp1_b32 s0, 7
    s_cselect_b32 s87, s85, 128
    s_cselect_b32 s88, s86, 221184
    v_mfma_f32_16x16x32_bf16 v[184:187], v[44:47], v[56:59], v[184:187]
    s_add_u32 s60, s60, s87
    v_mfma_f32_16x16x32_bf16 v[188:191], v[44:47], v[60:63], v[188:191]
    s_add_u32 s61, s61, s88
    s_waitcnt vmcnt(8) lgkmcnt(0)
    s_barrier
    s_mov_b32 exec_lo, 4
    s_mov_b32 exec_hi, 0
    buffer_store_dword v31, v30, s[36:39], 0 offen sc1
    s_mov_b64 exec, -1
    v_mfma_f32_16x16x32_bf16 v[128:131], v[64:67], v[80:83], v[128:131]
    ds_read_b128 v[48:51], v12 offset:0
    s_add_u32 m0, s62, 0
    v_mfma_f32_16x16x32_bf16 v[132:135], v[64:67], v[84:87], v[132:135]
    ds_read_b64_tr_b16 v[32:33], v6 offset:16384
    s_lshr_b32 s77, s84, 6
    v_mfma_f32_16x16x32_bf16 v[136:139], v[64:67], v[88:91], v[136:139]
    ds_read_b64_tr_b16 v[34:35], v6 offset:17408
    buffer_load_dwordx4 v240, s[32:35], s60 offen offset:0 lds
    v_mfma_f32_16x16x32_bf16 v[140:143], v[64:67], v[92:95], v[140:143]
    ds_read_b128 v[52:55], v12 offset:2048
    v_and_b32 v27, 31, v0
    v_mfma_f32_16x16x32_bf16 v[192:195], v[64:67], v[20:23], v[192:195]
    ds_read_b64_tr_b16 v[36:37], v7 offset:16384
    v_lshlrev_b32 v27, 6, v27
    v_mfma_f32_16x16x32_bf16 v[144:147], v[68:71], v[80:83], v[144:147]
    ds_read_b64_tr_b16 v[38:39], v7 offset:17408
    s_lshl_b32 s73, s77, 11
    v_mfma_f32_16x16x32_bf16 v[148:151], v[68:71], v[84:87], v[148:151]
    ds_read_b128 v[56:59], v12 offset:4096
    buffer_load_dwordx4 v241, s[32:35], s60 offen offset:1024 lds
    v_mfma_f32_16x16x32_bf16 v[152:155], v[68:71], v[88:91], v[152:155]
    ds_read_b64_tr_b16 v[40:41], v8 offset:16384
    v_mfma_f32_16x16x32_bf16 v[156:159], v[68:71], v[92:95], v[156:159]
    ds_read_b64_tr_b16 v[42:43], v8 offset:17408
    s_add_u32 s73, s73, 131072
    v_mfma_f32_16x16x32_bf16 v[196:199], v[68:71], v[20:23], v[196:199]
    ds_read_b128 v[60:63], v12 offset:6144
    s_lshl_b32 s78, s54, 11
    s_nop 0
    v_mfma_f32_16x16x32_bf16 v[160:163], v[72:75], v[80:83], v[160:163]
    ds_read_b64_tr_b16 v[44:45], v9 offset:16384
    v_min_u32 v26, ((C4JOIN-G1_END+511)/512)-1, v0
    v_mfma_f32_16x16x32_bf16 v[164:167], v[72:75], v[84:87], v[164:167]
    ds_read_b64_tr_b16 v[46:47], v9 offset:17408
    buffer_load_dwordx4 v242, s[32:35], s60 offen offset:2048 lds
    v_mfma_f32_16x16x32_bf16 v[168:171], v[72:75], v[88:91], v[168:171]
    s_mul_i32 s80, s3, ((C4JOIN-G1_END+511)/512)
    v_mfma_f32_16x16x32_bf16 v[172:175], v[72:75], v[92:95], v[172:175]
    v_add_u32 v26, s80, v26
    v_lshlrev_b32 v26, 7, v26
    v_mfma_f32_16x16x32_bf16 v[176:179], v[76:79], v[80:83], v[176:179]
    s_getpc_b64 s[80:81]
CT_1:
    s_nop 0
    v_add_u32 v26, G1_END-CT_1, v26
    v_mfma_f32_16x16x32_bf16 v[180:183], v[76:79], v[84:87], v[180:183]
    buffer_load_dwordx4 v243, s[32:35], s60 offen offset:3072 lds
    v_mfma_f32_16x16x32_bf16 v[184:187], v[76:79], v[88:91], v[184:187]
    s_mov_b32 s82, CODE_END-CT_1
    s_mov_b32 s83, 0x20000
    v_mfma_f32_16x16x32_bf16 v[188:191], v[76:79], v[92:95], v[188:191]
    buffer_load_dword v26, v26, s[80:83], 0 offen
    s_waitcnt lgkmcnt(0)
    s_nop 0
    v_mfma_f32_16x16x32_bf16 v[128:131], v[32:35], v[48:51], v[128:131]
    ds_read_b128 v[80:83], v13 offset:0
    s_add_u32 m0, s62, 16384
    v_mfma_f32_16x16x32_bf16 v[132:135], v[32:35], v[52:55], v[132:135]
    ds_read_b64_tr_b16 v[64:65], v6 offset:24576
    s_add_u32 s78, s78, 163840
    v_mfma_f32_16x16x32_bf16 v[136:139], v[32:35], v[56:59], v[136:139]
    ds_read_b64_tr_b16 v[66:67], v6 offset:25600
    buffer_load_dwordx4 v244, s[40:43], s61 offen offset:0 lds
    v_mfma_f32_16x16x32_bf16 v[140:143], v[32:35], v[60:63], v[140:143]
    ds_read_b128 v[84:87], v13 offset:2048
    v_mfma_f32_16x16x32_bf16 v[192:195], v[32:35], v[20:23], v[192:195]
    ds_read_b64_tr_b16 v[68:69], v7 offset:24576
    v_mov_b32_e64 v16, s73
    v_mfma_f32_16x16x32_bf16 v[144:147], v[36:39], v[48:51], v[144:147]
    ds_read_b64_tr_b16 v[70:71], v7 offset:25600
    v_mfma_f32_16x16x32_bf16 v[148:151], v[36:39], v[52:55], v[148:151]
    ds_read_b128 v[88:91], v13 offset:4096
    buffer_load_dwordx4 v245, s[40:43], s61 offen offset:1024 lds
    v_mfma_f32_16x16x32_bf16 v[152:155], v[36:39], v[56:59], v[152:155]
    ds_read_b64_tr_b16 v[72:73], v8 offset:24576
    v_mfma_f32_16x16x32_bf16 v[156:159], v[36:39], v[60:63], v[156:159]
    ds_read_b64_tr_b16 v[74:75], v8 offset:25600
    v_mov_b32_e64 v18, s78
    v_mfma_f32_16x16x32_bf16 v[196:199], v[36:39], v[20:23], v[196:199]
    ds_read_b128 v[92:95], v13 offset:6144
    v_mfma_f32_16x16x32_bf16 v[160:163], v[40:43], v[48:51], v[160:163]
    ds_read_b64_tr_b16 v[76:77], v9 offset:24576
    buffer_load_dwordx4 v246, s[40:43], s61 offen offset:2048 lds
    v_mfma_f32_16x16x32_bf16 v[164:167], v[40:43], v[52:55], v[164:167]
    ds_read_b64_tr_b16 v[78:79], v9 offset:25600
    v_and_b32 v19, 32, v0
    v_mfma_f32_16x16x32_bf16 v[168:171], v[40:43], v[56:59], v[168:171]
    v_mfma_f32_16x16x32_bf16 v[172:175], v[40:43], v[60:63], v[172:175]
    buffer_load_dwordx4 v247, s[40:43], s61 offen offset:3072 lds
    v_cmp_eq_u32 vcc, 0, v19
    v_mfma_f32_16x16x32_bf16 v[176:179], v[44:47], v[48:51], v[176:179]
    s_nop 1
    v_mfma_f32_16x16x32_bf16 v[180:183], v[44:47], v[52:55], v[180:183]
    s_bitcmp1_b32 s0, 8
    s_cselect_b32 s87, s85, 128
    s_cselect_b32 s88, s86, 221184
    v_mfma_f32_16x16x32_bf16 v[184:187], v[44:47], v[56:59], v[184:187]
    s_add_u32 s60, s60, s87
    v_mfma_f32_16x16x32_bf16 v[188:191], v[44:47], v[60:63], v[188:191]
    s_add_u32 s61, s61, s88
    s_waitcnt vmcnt(10) lgkmcnt(0)
    s_barrier
    buffer_load_dword v29, v28, s[36:39], 0 offen sc1
    v_mfma_f32_16x16x32_bf16 v[128:131], v[64:67], v[80:83], v[128:131]
    ds_read_b128 v[48:51], v12 offset:32768
    s_add_u32 m0, s62, 32768
    v_mfma_f32_16x16x32_bf16 v[132:135], v[64:67], v[84:87], v[132:135]
    ds_read_b64_tr_b16 v[32:33], v6 offset:49152
    v_cndmask_b32_e64 v16, v18, v16, vcc
    v_mfma_f32_16x16x32_bf16 v[136:139], v[64:67], v[88:91], v[136:139]
    ds_read_b64_tr_b16 v[34:35], v6 offset:50176
    buffer_load_dwordx4 v240, s[32:35], s60 offen offset:0 lds
    v_mfma_f32_16x16x32_bf16 v[140:143], v[64:67], v[92:95], v[140:143]
    ds_read_b128 v[52:55], v12 offset:34816
    v_mfma_f32_16x16x32_bf16 v[192:195], v[64:67], v[20:23], v[192:195]
    ds_read_b64_tr_b16 v[36:37], v7 offset:49152
    v_mfma_f32_16x16x32_bf16 v[144:147], v[68:71], v[80:83], v[144:147]
    ds_read_b64_tr_b16 v[38:39], v7 offset:50176
    v_add_u32_e64 v27, v16, v27
    v_mfma_f32_16x16x32_bf16 v[148:151], v[68:71], v[84:87], v[148:151]
    ds_read_b128 v[56:59], v12 offset:36864
    buffer_load_dwordx4 v241, s[32:35], s60 offen offset:1024 lds
    v_mfma_f32_16x16x32_bf16 v[152:155], v[68:71], v[88:91], v[152:155]
    ds_read_b64_tr_b16 v[40:41], v8 offset:49152
    v_mfma_f32_16x16x32_bf16 v[156:159], v[68:71], v[92:95], v[156:159]
    ds_read_b64_tr_b16 v[42:43], v8 offset:50176
    v_mfma_f32_16x16x32_bf16 v[196:199], v[68:71], v[20:23], v[196:199]
    ds_read_b128 v[60:63], v12 offset:38912
    s_lshr_b32 s78, s3, 1
    v_mfma_f32_16x16x32_bf16 v[160:163], v[72:75], v[80:83], v[160:163]
    ds_read_b64_tr_b16 v[44:45], v9 offset:49152
    v_mfma_f32_16x16x32_bf16 v[164:167], v[72:75], v[84:87], v[164:167]
    ds_read_b64_tr_b16 v[46:47], v9 offset:50176
    buffer_load_dwordx4 v242, s[32:35], s60 offen offset:2048 lds
    v_mfma_f32_16x16x32_bf16 v[168:171], v[72:75], v[88:91], v[168:171]
    s_add_u32 s84, s84, s78
    v_mfma_f32_16x16x32_bf16 v[172:175], v[72:75], v[92:95], v[172:175]
    v_mfma_f32_16x16x32_bf16 v[176:179], v[76:79], v[80:83], v[176:179]
    s_and_b32 s87, s3, 1
    v_mfma_f32_16x16x32_bf16 v[180:183], v[76:79], v[84:87], v[180:183]
    buffer_load_dwordx4 v243, s[32:35], s60 offen offset:3072 lds
    v_mfma_f32_16x16x32_bf16 v[184:187], v[76:79], v[88:91], v[184:187]
    s_mul_i32 s86, s78, 21248
    v_mfma_f32_16x16x32_bf16 v[188:191], v[76:79], v[92:95], v[188:191]
    s_waitcnt lgkmcnt(0)
    v_mfma_f32_16x16x32_bf16 v[128:131], v[32:35], v[48:51], v[128:131]
    ds_read_b128 v[80:83], v13 offset:32768
    s_add_u32 m0, s62, 49152
    v_mfma_f32_16x16x32_bf16 v[132:135], v[32:35], v[52:55], v[132:135]
    ds_read_b64_tr_b16 v[64:65], v6 offset:57344
    s_lshl_b32 s85, s84, 12
    v_mfma_f32_16x16x32_bf16 v[136:139], v[32:35], v[56:59], v[136:139]
    ds_read_b64_tr_b16 v[66:67], v6 offset:58368
    buffer_load_dwordx4 v244, s[40:43], s61 offen offset:0 lds
    v_mfma_f32_16x16x32_bf16 v[140:143], v[32:35], v[60:63], v[140:143]
    ds_read_b128 v[84:87], v13 offset:34816
    v_mfma_f32_16x16x32_bf16 v[192:195], v[32:35], v[20:23], v[192:195]
    ds_read_b64_tr_b16 v[68:69], v7 offset:57344
    s_add_u32 s44, s12, s85
    s_addc_u32 s45, s13, 0
    s_nop 0
    v_mfma_f32_16x16x32_bf16 v[144:147], v[36:39], v[48:51], v[144:147]
    ds_read_b64_tr_b16 v[70:71], v7 offset:58368
    v_mfma_f32_16x16x32_bf16 v[148:151], v[36:39], v[52:55], v[148:151]
    ds_read_b128 v[88:91], v13 offset:36864
    buffer_load_dwordx4 v245, s[40:43], s61 offen offset:1024 lds
    v_mfma_f32_16x16x32_bf16 v[152:155], v[36:39], v[56:59], v[152:155]
    ds_read_b64_tr_b16 v[72:73], v8 offset:57344
    v_mfma_f32_16x16x32_bf16 v[156:159], v[36:39], v[60:63], v[156:159]
    ds_read_b64_tr_b16 v[74:75], v8 offset:58368
    v_mfma_f32_16x16x32_bf16 v[196:199], v[36:39], v[20:23], v[196:199]
    ds_read_b128 v[92:95], v13 offset:38912
    v_mfma_f32_16x16x32_bf16 v[160:163], v[40:43], v[48:51], v[160:163]
    ds_read_b64_tr_b16 v[76:77], v9 offset:57344
    s_mov_b32 s46, 4096
    v_mfma_f32_16x16x32_bf16 v[164:167], v[40:43], v[52:55], v[164:167]
    ds_read_b64_tr_b16 v[78:79], v9 offset:58368
    buffer_load_dwordx4 v246, s[40:43], s61 offen offset:2048 lds
    v_mfma_f32_16x16x32_bf16 v[168:171], v[40:43], v[56:59], v[168:171]
    s_mov_b32 s47, 0x20000
    v_mfma_f32_16x16x32_bf16 v[172:175], v[40:43], v[60:63], v[172:175]
    s_lshl_b32 s89, s87, 11
    v_mfma_f32_16x16x32_bf16 v[176:179], v[44:47], v[48:51], v[176:179]
    v_mfma_f32_16x16x32_bf16 v[180:183], v[44:47], v[52:55], v[180:183]
    buffer_load_dwordx4 v247, s[40:43], s61 offen offset:3072 lds
    s_add_u32 s88, s85, s89
    v_mfma_f32_16x16x32_bf16 v[184:187], v[44:47], v[56:59], v[184:187]
    s_add_u32 s88, s88, 1048576
    v_mfma_f32_16x16x32_bf16 v[188:191], v[44:47], v[60:63], v[188:191]
    s_waitcnt vmcnt(9) lgkmcnt(0)
    s_barrier
    v_mfma_f32_16x16x32_bf16 v[128:131], v[64:67], v[80:83], v[128:131]
    ds_read_b128 v[48:51], v10 offset:0
    buffer_load_dwordx2 v[208:209], v232, s[48:51], 0 offen
    v_mfma_f32_16x16x32_bf16 v[132:135], v[64:67], v[84:87], v[132:135]
    ds_read_b64_tr_b16 v[32:33], v2 offset:16384
    v_mfma_f32_16x16x32_bf16 v[136:139], v[64:67], v[88:91], v[136:139]
    ds_read_b64_tr_b16 v[34:35], v2 offset:17408
    v_mfma_f32_16x16x32_bf16 v[140:143], v[64:67], v[92:95], v[140:143]
    ds_read_b128 v[52:55], v10 offset:2048
    v_mfma_f32_16x16x32_bf16 v[192:195], v[64:67], v[20:23], v[192:195]
    ds_read_b64_tr_b16 v[36:37], v3 offset:16384
    v_mfma_f32_16x16x32_bf16 v[144:147], v[68:71], v[80:83], v[144:147]
    ds_read_b64_tr_b16 v[38:39], v3 offset:17408
    v_mfma_f32_16x16x32_bf16 v[148:151], v[68:71], v[84:87], v[148:151]
    ds_read_b128 v[56:59], v10 offset:4096
    buffer_load_dwordx2 v[210:211], v233, s[48:51], 0 offen
    v_mfma_f32_16x16x32_bf16 v[152:155], v[68:71], v[88:91], v[152:155]
    ds_read_b64_tr_b16 v[40:41], v4 offset:16384
    v_mfma_f32_16x16x32_bf16 v[156:159], v[68:71], v[92:95], v[156:159]
    ds_read_b64_tr_b16 v[42:43], v4 offset:17408
    v_mfma_f32_16x16x32_bf16 v[196:199], v[68:71], v[20:23], v[196:199]
    ds_read_b128 v[60:63], v10 offset:6144
    v_mfma_f32_16x16x32_bf16 v[160:163], v[72:75], v[80:83], v[160:163]
    ds_read_b64_tr_b16 v[44:45], v5 offset:16384
    v_mfma_f32_16x16x32_bf16 v[164:167], v[72:75], v[84:87], v[164:167]
    ds_read_b64_tr_b16 v[46:47], v5 offset:17408
    v_mfma_f32_16x16x32_bf16 v[168:171], v[72:75], v[88:91], v[168:171]
    buffer_load_dwordx2 v[212:213], v234, s[48:51], 0 offen
    v_mfma_f32_16x16x32_bf16 v[172:175], v[72:75], v[92:95], v[172:175]
    v_mfma_f32_16x16x32_bf16 v[176:179], v[76:79], v[80:83], v[176:179]
    v_mfma_f32_16x16x32_bf16 v[180:183], v[76:79], v[84:87], v[180:183]
    buffer_load_dwordx2 v[214:215], v235, s[48:51], 0 offen
    v_mfma_f32_16x16x32_bf16 v[184:187], v[76:79], v[88:91], v[184:187]
    v_mfma_f32_16x16x32_bf16 v[188:191], v[76:79], v[92:95], v[188:191]
    s_waitcnt lgkmcnt(0)
    v_mfma_f32_16x16x32_bf16 v[128:131], v[32:35], v[48:51], v[128:131]
    ds_read_b128 v[80:83], v11 offset:0
    s_lshl_b32 s79, s53, 6
    v_mfma_f32_16x16x32_bf16 v[132:135], v[32:35], v[52:55], v[132:135]
    ds_read_b64_tr_b16 v[64:65], v2 offset:24576
    s_lshl_b32 s80, s3, 4
    v_mfma_f32_16x16x32_bf16 v[136:139], v[32:35], v[56:59], v[136:139]
    ds_read_b64_tr_b16 v[66:67], v2 offset:25600
    s_add_u32 s79, s79, s80
    v_mfma_f32_16x16x32_bf16 v[140:143], v[32:35], v[60:63], v[140:143]
    ds_read_b128 v[84:87], v11 offset:2048
    v_lshrrev_b32 v116, 2, v0
    v_mfma_f32_16x16x32_bf16 v[192:195], v[32:35], v[20:23], v[192:195]
    ds_read_b64_tr_b16 v[68:69], v3 offset:24576
    v_add_u32 v116, s79, v116
    v_mfma_f32_16x16x32_bf16 v[144:147], v[36:39], v[48:51], v[144:147]
    ds_read_b64_tr_b16 v[70:71], v3 offset:25600
    v_mul_u32_u24 v116, 1280, v116
    v_mfma_f32_16x16x32_bf16 v[148:151], v[36:39], v[52:55], v[148:151]
    ds_read_b128 v[88:91], v11 offset:4096
    s_mul_i32 s80, s54, 160
    v_mfma_f32_16x16x32_bf16 v[152:155], v[36:39], v[56:59], v[152:155]
    ds_read_b64_tr_b16 v[72:73], v4 offset:24576
    v_add_u32 v116, s80, v116
    v_mfma_f32_16x16x32_bf16 v[156:159], v[36:39], v[60:63], v[156:159]
    ds_read_b64_tr_b16 v[74:75], v4 offset:25600
    v_and_b32 v117, 3, v0
    v_mfma_f32_16x16x32_bf16 v[196:199], v[36:39], v[20:23], v[196:199]
    ds_read_b128 v[92:95], v11 offset:6144
    v_lshl_add_u32 v118, v117, 4, v116
    v_mfma_f32_16x16x32_bf16 v[160:163], v[40:43], v[48:51], v[160:163]
    ds_read_b64_tr_b16 v[76:77], v5 offset:24576
    v_lshl_add_u32 v119, v117, 3, v116
    v_mfma_f32_16x16x32_bf16 v[164:167], v[40:43], v[52:55], v[164:167]
    ds_read_b64_tr_b16 v[78:79], v5 offset:25600
    v_mfma_f32_16x16x32_bf16 v[168:171], v[40:43], v[56:59], v[168:171]
    s_mov_b32 s40, s24
    s_mov_b32 s41, s25
    v_mfma_f32_16x16x32_bf16 v[172:175], v[40:43], v[60:63], v[172:175]
    s_mov_b32 s42, 1280
    s_mov_b32 s43, 0x20000
    v_mfma_f32_16x16x32_bf16 v[176:179], v[44:47], v[48:51], v[176:179]
    v_lshrrev_b32 v104, 4, v0
    s_mul_i32 s60, s54, 160
    v_mfma_f32_16x16x32_bf16 v[180:183], v[44:47], v[52:55], v[180:183]
    v_lshlrev_b32 v105, 4, v104
    v_lshlrev_b32_e64 v106, 3, v104
    v_mfma_f32_16x16x32_bf16 v[184:187], v[44:47], v[56:59], v[184:187]
    buffer_load_dwordx4 a[240:243], v105, s[40:43], s60 offen
    buffer_load_dwordx4 a[244:247], v105, s[40:43], s60 offen offset:64
    v_mfma_f32_16x16x32_bf16 v[188:191], v[44:47], v[60:63], v[188:191]
    buffer_load_dwordx2 a[248:249], v106, s[40:43], s60 offen offset:128
    s_waitcnt vmcnt(7) lgkmcnt(0)
    s_waitcnt vmcnt(15)
    v_cmp_ne_u32 vcc, s56, v29
    s_mov_b64 s[82:83], vcc
    s_cmp_eq_u64 s[82:83], 0
    s_cbranch_scc0 P1_RETRY_2
P1_DONE_3:
    s_barrier
    v_mfma_f32_16x16x32_bf16 v[128:131], v[64:67], v[80:83], v[128:131]
    ds_read_b128 v[48:51], v10 offset:32768
    buffer_load_dword v24, v27, s[36:39], 0 offen sc1
    v_mfma_f32_16x16x32_bf16 v[132:135], v[64:67], v[84:87], v[132:135]
    ds_read_b64_tr_b16 v[32:33], v2 offset:49152
    v_mfma_f32_16x16x32_bf16 v[136:139], v[64:67], v[88:91], v[136:139]
    ds_read_b64_tr_b16 v[34:35], v2 offset:50176
    v_and_b32 v16, 15, v0
    v_mfma_f32_16x16x32_bf16 v[140:143], v[64:67], v[92:95], v[140:143]
    ds_read_b128 v[52:55], v10 offset:34816
    v_mfma_f32_16x16x32_bf16 v[192:195], v[64:67], v[20:23], v[192:195]
    ds_read_b64_tr_b16 v[36:37], v3 offset:49152
    v_mfma_f32_16x16x32_bf16 v[144:147], v[68:71], v[80:83], v[144:147]
    ds_read_b64_tr_b16 v[38:39], v3 offset:50176
    v_add_u32_e64 v16, s67, v16
    v_mfma_f32_16x16x32_bf16 v[148:151], v[68:71], v[84:87], v[148:151]
    ds_read_b128 v[56:59], v10 offset:36864
    v_mfma_f32_16x16x32_bf16 v[152:155], v[68:71], v[88:91], v[152:155]
    ds_read_b64_tr_b16 v[40:41], v4 offset:49152
    v_mfma_f32_16x16x32_bf16 v[156:159], v[68:71], v[92:95], v[156:159]
    ds_read_b64_tr_b16 v[42:43], v4 offset:50176
    v_lshlrev_b32_e64 v16, 3, v16
    v_mfma_f32_16x16x32_bf16 v[196:199], v[68:71], v[20:23], v[196:199]
    ds_read_b128 v[60:63], v10 offset:38912
    v_mfma_f32_16x16x32_bf16 v[160:163], v[72:75], v[80:83], v[160:163]
    ds_read_b64_tr_b16 v[44:45], v5 offset:49152
    s_mov_b32 s59, 65536
    v_mfma_f32_16x16x32_bf16 v[164:167], v[72:75], v[84:87], v[164:167]
    ds_read_b64_tr_b16 v[46:47], v5 offset:50176
    v_mfma_f32_16x16x32_bf16 v[168:171], v[72:75], v[88:91], v[168:171]
    buffer_load_dwordx2 v[200:201], v16, s[36:39], s59 offen offset:0 sc1
    v_mfma_f32_16x16x32_bf16 v[172:175], v[72:75], v[92:95], v[172:175]
    v_mfma_f32_16x16x32_bf16 v[176:179], v[76:79], v[80:83], v[176:179]
    buffer_load_dwordx2 v[202:203], v16, s[36:39], s59 offen offset:128 sc1
    v_mfma_f32_16x16x32_bf16 v[180:183], v[76:79], v[84:87], v[180:183]
    buffer_load_dwordx2 v[204:205], v16, s[36:39], s59 offen offset:256 sc1
    v_mfma_f32_16x16x32_bf16 v[184:187], v[76:79], v[88:91], v[184:187]
    buffer_load_dwordx2 v[206:207], v16, s[36:39], s59 offen offset:384 sc1
    v_mfma_f32_16x16x32_bf16 v[188:191], v[76:79], v[92:95], v[188:191]
    s_waitcnt lgkmcnt(0)
    v_mfma_f32_16x16x32_bf16 v[128:131], v[32:35], v[48:51], v[128:131]
    ds_read_b128 v[80:83], v11 offset:32768
    buffer_load_dwordx4 v[244:247], v118, s[32:35], 0 offen
    s_and_b32 s73, s69, 7
    v_mfma_f32_16x16x32_bf16 v[132:135], v[32:35], v[52:55], v[132:135]
    ds_read_b64_tr_b16 v[64:65], v2 offset:57344
    s_lshl_b32 s73, s73, 6
    v_mfma_f32_16x16x32_bf16 v[136:139], v[32:35], v[56:59], v[136:139]
    ds_read_b64_tr_b16 v[66:67], v2 offset:58368
    s_add_u32 s73, s73, 131072
    v_lshl_add_u32 v108, v17, 4, s73
    v_mfma_f32_16x16x32_bf16 v[140:143], v[32:35], v[60:63], v[140:143]
    ds_read_b128 v[84:87], v11 offset:34816
    s_and_b32 s73, s70, 7
    v_mfma_f32_16x16x32_bf16 v[192:195], v[32:35], v[20:23], v[192:195]
    ds_read_b64_tr_b16 v[68:69], v3 offset:57344
    s_lshl_b32 s73, s73, 6
    s_add_u32 s73, s73, 131072
    v_mfma_f32_16x16x32_bf16 v[144:147], v[36:39], v[48:51], v[144:147]
    ds_read_b64_tr_b16 v[70:71], v3 offset:58368
    v_lshl_add_u32 v109, v17, 4, s73
    v_mfma_f32_16x16x32_bf16 v[148:151], v[36:39], v[52:55], v[148:151]
    ds_read_b128 v[88:91], v11 offset:36864
    s_and_b32 s73, s71, 7
    v_mfma_f32_16x16x32_bf16 v[152:155], v[36:39], v[56:59], v[152:155]
    ds_read_b64_tr_b16 v[72:73], v4 offset:57344
    s_lshl_b32 s73, s73, 6
    s_add_u32 s73, s73, 131072
    v_mfma_f32_16x16x32_bf16 v[156:159], v[36:39], v[60:63], v[156:159]
    ds_read_b64_tr_b16 v[74:75], v4 offset:58368
    v_lshl_add_u32 v110, v17, 4, s73
    v_mfma_f32_16x16x32_bf16 v[196:199], v[36:39], v[20:23], v[196:199]
    ds_read_b128 v[92:95], v11 offset:38912
    s_and_b32 s73, s72, 7
    s_lshl_b32 s73, s73, 6
    s_nop 0
    v_mfma_f32_16x16x32_bf16 v[160:163], v[40:43], v[48:51], v[160:163]
    ds_read_b64_tr_b16 v[76:77], v5 offset:57344
    s_add_u32 s73, s73, 131072
    v_mfma_f32_16x16x32_bf16 v[164:167], v[40:43], v[52:55], v[164:167]
    ds_read_b64_tr_b16 v[78:79], v5 offset:58368
    v_lshl_add_u32 v111, v17, 4, s73
    v_mov_b32 v112, 0xbf8bf336
    v_mfma_f32_16x16x32_bf16 v[168:171], v[40:43], v[56:59], v[168:171]
    v_mov_b32 v113, 0xbf8bf336
    v_mov_b32 v114, 0x3eeff558
    v_mfma_f32_16x16x32_bf16 v[172:175], v[40:43], v[60:63], v[172:175]
    v_mov_b32 v115, 0x3eeff558
    v_min_u32 v19, ((G2_START-C4JOIN+511)/512)-1, v0
    v_mfma_f32_16x16x32_bf16 v[176:179], v[44:47], v[48:51], v[176:179]
    s_mul_i32 s80, s3, ((G2_START-C4JOIN+511)/512)
    v_add_u32 v19, s80, v19
    v_mfma_f32_16x16x32_bf16 v[180:183], v[44:47], v[52:55], v[180:183]
    v_lshlrev_b32 v19, 7, v19
    s_getpc_b64 s[80:81]
CT_5:
    v_mfma_f32_16x16x32_bf16 v[184:187], v[44:47], v[56:59], v[184:187]
    v_add_u32 v19, C4JOIN-CT_5, v19
    s_mov_b32 s82, CODE_END-CT_5
    v_mfma_f32_16x16x32_bf16 v[188:191], v[44:47], v[60:63], v[188:191]
    s_mov_b32 s83, 0x20000
    buffer_load_dword v19, v19, s[80:83], 0 offen
    s_waitcnt lgkmcnt(0)
    v_mfma_f32_16x16x32_bf16 v[192:195], v[64:67], v[20:23], v[192:195]
    s_waitcnt vmcnt(10)
    v_lshlrev_b32 v40, 16, v208
    v_mfma_f32_16x16x32_bf16 v[196:199], v[68:71], v[20:23], v[196:199]
    buffer_load_dwordx4 v[248:251], v118, s[32:35], 0 offen offset:64
    v_and_b32 v41, 0xffff0000, v208
    v_mfma_f32_16x16x32_bf16 v[128:131], v[64:67], v[80:83], v[128:131]
    v_lshlrev_b32 v42, 16, v209
    v_mfma_f32_16x16x32_bf16 v[132:135], v[64:67], v[84:87], v[132:135]
    v_and_b32 v43, 0xffff0000, v209
    v_lshlrev_b32 v44, 16, v210
    v_mfma_f32_16x16x32_bf16 v[136:139], v[64:67], v[88:91], v[136:139]
    v_and_b32 v45, 0xffff0000, v210
    v_lshlrev_b32 v46, 16, v211
    v_mfma_f32_16x16x32_bf16 v[140:143], v[64:67], v[92:95], v[140:143]
    v_and_b32 v47, 0xffff0000, v211
    v_mfma_f32_16x16x32_bf16 v[144:147], v[68:71], v[80:83], v[144:147]
    v_lshlrev_b32 v56, 16, v212
    v_and_b32 v57, 0xffff0000, v212
    v_mfma_f32_16x16x32_bf16 v[148:151], v[68:71], v[84:87], v[148:151]
    v_lshlrev_b32 v58, 16, v213
    v_mfma_f32_16x16x32_bf16 v[152:155], v[68:71], v[88:91], v[152:155]
    v_and_b32 v59, 0xffff0000, v213
    v_lshlrev_b32 v60, 16, v214
    v_mfma_f32_16x16x32_bf16 v[156:159], v[68:71], v[92:95], v[156:159]
    buffer_load_dwordx2 v[252:253], v119, s[32:35], 0 offen offset:128
    v_and_b32 v61, 0xffff0000, v214
    v_mfma_f32_16x16x32_bf16 v[160:163], v[72:75], v[80:83], v[160:163]
    s_mov_b32 exec_lo, 0x00010001
    s_mov_b32 exec_hi, 0x00010001
    ds_write_b128 v108, v[192:195]
    ds_write_b128 v109, v[196:199]
    s_mov_b64 exec, -1
    v_mfma_f32_16x16x32_bf16 v[164:167], v[72:75], v[84:87], v[164:167]
    v_lshlrev_b32 v62, 16, v215
    v_mfma_f32_16x16x32_bf16 v[168:171], v[72:75], v[88:91], v[168:171]
    v_and_b32 v63, 0xffff0000, v215
    s_mov_b32 s74, 0x409d30fc
    v_mfma_f32_16x16x32_bf16 v[172:175], v[72:75], v[92:95], v[172:175]
    s_mov_b32 s75, 0x409d30fc
    v_mfma_f32_16x16x32_bf16 v[176:179], v[76:79], v[80:83], v[176:179]
    s_lshr_b32 s76, s67, 4
    s_mul_i32 s76, s76, 55296
    v_mfma_f32_16x16x32_bf16 v[180:183], v[76:79], v[84:87], v[180:183]
    s_add_u32 s76, s76, 10485760
    v_mfma_f32_16x16x32_bf16 v[184:187], v[76:79], v[88:91], v[184:187]
    s_cmp_ge_u32 s68, 108
    s_cselect_b32 s76, 17563648, s76
    v_mfma_f32_16x16x32_bf16 v[188:191], v[76:79], v[92:95], v[188:191]
    v_lshlrev_b32 v18, 4, v0
G1_END:
    s_waitcnt vmcnt(8)
    v_cmp_ne_u32 vcc, s56, v24
    s_mov_b64 s[82:83], vcc
    s_cmp_eq_u64 s[82:83], 0
    s_cbranch_scc0 P2_RETRY_6
P2_DONE_7:
    s_waitcnt lgkmcnt(0)
    s_barrier
    s_nop 0
    ds_read_b128 v[216:219], v108
    ds_read_b128 v[220:223], v109
    ds_read_b128 v[224:227], v110
    ds_read_b128 v[228:231], v111
    buffer_load_dwordx4 v[96:99], v14, s[44:47], s89 offen offset:0 nt
    buffer_load_dwordx4 v[100:103], v14, s[44:47], s89 offen offset:1024 nt
    buffer_load_dwordx2 v[116:117], v14, s[44:47], s89 offen offset:2048 nt
    v_pk_mul_f32 v[40:41], v[40:41], v[114:115]
    v_pk_mul_f32 v[42:43], v[42:43], v[114:115]
    v_pk_mul_f32 v[44:45], v[44:45], v[114:115]
    v_pk_mul_f32 v[46:47], v[46:47], v[114:115]
    v_pk_mul_f32 v[56:57], v[56:57], v[114:115]
    v_pk_mul_f32 v[58:59], v[58:59], v[114:115]
    v_pk_mul_f32 v[60:61], v[60:61], v[114:115]
    v_pk_mul_f32 v[62:63], v[62:63], v[114:115]
    s_waitcnt vmcnt(7)
    v_mul_f32 v201, v114, v201
    v_mul_f32 v200, v200, v201
    v_mul_f32 v203, v114, v203
    v_mul_f32 v202, v202, v203
    v_mul_f32 v205, v114, v205
    v_mul_f32 v204, v204, v205
    v_mul_f32 v207, v114, v207
    v_mul_f32_e64 v206, v206, v207
    buffer_load_dwordx4 v[120:123], v14, s[36:39], s88 offen offset:0 sc1
    buffer_load_dwordx4 v[124:127], v14, s[36:39], s88 offen offset:1024 sc1
    s_waitcnt lgkmcnt(0)
    s_lshl_b32 s78, s84, 1
    s_and_b32 s78, s78, -4
    s_nop 0
    s_load_dword s77, s[14:15], s78
    v_pk_fma_f32 v[32:33], v[216:217], v[200:201], v[40:41] op_sel_hi:[1,0,1] neg_lo:[0,1,0] neg_hi:[0,1,0]
    v_pk_fma_f32 v[34:35], v[218:219], v[200:201], v[42:43] op_sel_hi:[1,0,1] neg_lo:[0,1,0] neg_hi:[0,1,0]
    v_pk_fma_f32 v[36:37], v[220:221], v[200:201], v[44:45] op_sel_hi:[1,0,1] neg_lo:[0,1,0] neg_hi:[0,1,0]
    buffer_load_dwordx4 a[0:3], v14, s[36:39], s52 offen offset:0 sc1
    v_pk_fma_f32 v[38:39], v[222:223], v[200:201], v[46:47] op_sel_hi:[1,0,1] neg_lo:[0,1,0] neg_hi:[0,1,0]
    v_pk_fma_f32 v[32:33], v[128:129], v[200:201], v[32:33] op_sel:[0,1,0] op_sel_hi:[1,1,1]
    v_pk_fma_f32 v[34:35], v[130:131], v[200:201], v[34:35] op_sel:[0,1,0] op_sel_hi:[1,1,1]
    v_pk_fma_f32 v[36:37], v[144:145], v[200:201], v[36:37] op_sel:[0,1,0] op_sel_hi:[1,1,1]
    v_pk_fma_f32 v[38:39], v[146:147], v[200:201], v[38:39] op_sel:[0,1,0] op_sel_hi:[1,1,1]
    v_pk_fma_f32 v[48:49], v[32:33], v[32:33], s[74:75]
    v_pk_fma_f32 v[50:51], v[34:35], v[34:35], s[74:75]
    v_pk_fma_f32 v[52:53], v[36:37], v[36:37], s[74:75]
    v_pk_fma_f32 v[54:55], v[38:39], v[38:39], s[74:75]
    v_pk_fma_f32 v[48:49], v[48:49], v[32:33], v[112:113] neg_lo:[0,1,0] neg_hi:[0,1,0]
    v_pk_fma_f32 v[50:51], v[50:51], v[34:35], v[112:113] neg_lo:[0,1,0] neg_hi:[0,1,0]
    v_pk_fma_f32 v[52:53], v[52:53], v[36:37], v[112:113] neg_lo:[0,1,0] neg_hi:[0,1,0]
    v_pk_fma_f32 v[54:55], v[54:55], v[38:39], v[112:113] neg_lo:[0,1,0] neg_hi:[0,1,0]
    v_exp_f32 v64, v48
    v_exp_f32 v65, v49
    v_exp_f32 v66, v50
    v_exp_f32 v67, v51
    v_exp_f32 v68, v52
    v_exp_f32 v69, v53
    v_exp_f32 v70, v54
    v_exp_f32 v71, v55
    v_pk_add_f32 v[64:65], v[64:65], v[114:115]
    buffer_load_dwordx4 a[4:7], v14, s[36:39], s52 offen offset:1024 sc1
    v_pk_add_f32 v[66:67], v[66:67], v[114:115]
    v_pk_add_f32 v[68:69], v[68:69], v[114:115]
    v_pk_add_f32 v[70:71], v[70:71], v[114:115]
    v_rcp_f32 v64, v64
    v_rcp_f32 v65, v65
    v_rcp_f32 v66, v66
    v_rcp_f32 v67, v67
    v_rcp_f32 v68, v68
    v_rcp_f32 v69, v69
    v_rcp_f32_e64 v70, v70
    v_rcp_f32 v71, v71
    s_nop 0
    v_pk_mul_f32 v[32:33], v[32:33], v[64:65]
    v_pk_mul_f32 v[34:35], v[34:35], v[66:67]
    v_pk_mul_f32 v[36:37], v[36:37], v[68:69]
    v_pk_mul_f32 v[38:39], v[38:39], v[70:71]
    v_cvt_pk_bf16_f32 v128, v32, v33
    v_cvt_pk_bf16_f32 v129, v34, v35
    v_cvt_pk_bf16_f32 v130, v36, v37
    v_cvt_pk_bf16_f32 v131, v38, v39
    s_lshr_b32 s73, s69, 1
    s_lshl_b32 s73, s73, 10
    s_add_u32 s73, s73, s76
    s_nop 0
    buffer_store_dwordx4 v[128:131], v18, s[36:39], s73 offen sc1
PAGE3:
    s_cbranch_execz PAGE4
    s_nop 0
    v_pk_fma_f32 v[32:33], v[224:225], v[200:201], v[56:57] op_sel_hi:[1,0,1] neg_lo:[0,1,0] neg_hi:[0,1,0]
    v_pk_fma_f32 v[34:35], v[226:227], v[200:201], v[58:59] op_sel_hi:[1,0,1] neg_lo:[0,1,0] neg_hi:[0,1,0]
    v_pk_fma_f32 v[36:37], v[228:229], v[200:201], v[60:61] op_sel_hi:[1,0,1] neg_lo:[0,1,0] neg_hi:[0,1,0]
    buffer_load_dwordx4 a[8:11], v14, s[36:39], s52 offen offset:2048 sc1
    v_pk_fma_f32 v[38:39], v[230:231], v[200:201], v[62:63] op_sel_hi:[1,0,1] neg_lo:[0,1,0] neg_hi:[0,1,0]
    v_pk_fma_f32 v[32:33], v[160:161], v[200:201], v[32:33] op_sel:[0,1,0] op_sel_hi:[1,1,1]
    v_pk_fma_f32 v[34:35], v[162:163], v[200:201], v[34:35] op_sel:[0,1,0] op_sel_hi:[1,1,1]
    v_pk_fma_f32 v[36:37], v[176:177], v[200:201], v[36:37] op_sel:[0,1,0] op_sel_hi:[1,1,1]
    v_pk_fma_f32 v[38:39], v[178:179], v[200:201], v[38:39] op_sel:[0,1,0] op_sel_hi:[1,1,1]
    v_pk_fma_f32 v[48:49], v[32:33], v[32:33], s[74:75]
    v_pk_fma_f32 v[50:51], v[34:35], v[34:35], s[74:75]
    v_pk_fma_f32 v[52:53], v[36:37], v[36:37], s[74:75]
    v_pk_fma_f32 v[54:55], v[38:39], v[38:39], s[74:75]
    v_pk_fma_f32 v[48:49], v[48:49], v[32:33], v[112:113] neg_lo:[0,1,0] neg_hi:[0,1,0]
    v_pk_fma_f32 v[50:51], v[50:51], v[34:35], v[112:113] neg_lo:[0,1,0] neg_hi:[0,1,0]
    v_pk_fma_f32 v[52:53], v[52:53], v[36:37], v[112:113] neg_lo:[0,1,0] neg_hi:[0,1,0]
    v_pk_fma_f32 v[54:55], v[54:55], v[38:39], v[112:113] neg_lo:[0,1,0] neg_hi:[0,1,0]
    v_exp_f32 v64, v48
    v_exp_f32 v65, v49
    v_exp_f32 v66, v50
    v_exp_f32 v67, v51
    v_exp_f32 v68, v52
    v_exp_f32 v69, v53
    v_exp_f32 v70, v54
    v_exp_f32 v71, v55
    v_pk_add_f32 v[64:65], v[64:65], v[114:115]
    buffer_load_dwordx4 a[12:15], v14, s[36:39], s52 offen offset:3072 sc1
    v_pk_add_f32 v[66:67], v[66:67], v[114:115]
    v_pk_add_f32 v[68:69], v[68:69], v[114:115]
    v_pk_add_f32 v[70:71], v[70:71], v[114:115]
    v_rcp_f32 v64, v64
    v_rcp_f32 v65, v65
    v_rcp_f32 v66, v66
    v_rcp_f32 v67, v67
    v_rcp_f32 v68, v68
    v_rcp_f32 v69, v69
    v_rcp_f32_e64 v70, v70
    v_rcp_f32 v71, v71
    s_nop 0
    v_pk_mul_f32 v[32:33], v[32:33], v[64:65]
    v_pk_mul_f32 v[34:35], v[34:35], v[66:67]
    v_pk_mul_f32 v[36:37], v[36:37], v[68:69]
    v_pk_mul_f32 v[38:39], v[38:39], v[70:71]
    v_cvt_pk_bf16_f32 v160, v32, v33
    v_cvt_pk_bf16_f32 v161, v34, v35
    v_cvt_pk_bf16_f32 v162, v36, v37
    v_cvt_pk_bf16_f32 v163, v38, v39
    s_lshr_b32 s73, s71, 1
    s_lshl_b32 s73, s73, 10
    s_add_u32 s73, s73, s76
    s_nop 0
    buffer_store_dwordx4 v[160:163], v18, s[36:39], s73 offen sc1
    v_pk_fma_f32 v[32:33], v[216:217], v[202:203], v[40:41] op_sel_hi:[1,0,1] neg_lo:[0,1,0] neg_hi:[0,1,0]
    v_pk_fma_f32 v[34:35], v[218:219], v[202:203], v[42:43] op_sel_hi:[1,0,1] neg_lo:[0,1,0] neg_hi:[0,1,0]
    v_pk_fma_f32 v[36:37], v[220:221], v[202:203], v[44:45] op_sel_hi:[1,0,1] neg_lo:[0,1,0] neg_hi:[0,1,0]
    buffer_load_dwordx4 a[16:19], v15, s[36:39], s52 offen offset:0 sc1
    s_add_u32 s52, s52, 5120
    v_pk_fma_f32 v[38:39], v[222:223], v[202:203], v[46:47] op_sel_hi:[1,0,1] neg_lo:[0,1,0] neg_hi:[0,1,0]
    v_pk_fma_f32 v[32:33], v[132:133], v[202:203], v[32:33] op_sel:[0,1,0] op_sel_hi:[1,1,1]
    v_pk_fma_f32 v[34:35], v[134:135], v[202:203], v[34:35] op_sel:[0,1,0] op_sel_hi:[1,1,1]
    v_pk_fma_f32 v[36:37], v[148:149], v[202:203], v[36:37] op_sel:[0,1,0] op_sel_hi:[1,1,1]
    v_pk_fma_f32 v[38:39], v[150:151], v[202:203], v[38:39] op_sel:[0,1,0] op_sel_hi:[1,1,1]
    v_pk_fma_f32 v[48:49], v[32:33], v[32:33], s[74:75]
    v_pk_fma_f32 v[50:51], v[34:35], v[34:35], s[74:75]
    v_pk_fma_f32 v[52:53], v[36:37], v[36:37], s[74:75]
    v_pk_fma_f32 v[54:55], v[38:39], v[38:39], s[74:75]
    v_pk_fma_f32 v[48:49], v[48:49], v[32:33], v[112:113] neg_lo:[0,1,0] neg_hi:[0,1,0]
    v_pk_fma_f32 v[50:51], v[50:51], v[34:35], v[112:113] neg_lo:[0,1,0] neg_hi:[0,1,0]
    v_pk_fma_f32 v[52:53], v[52:53], v[36:37], v[112:113] neg_lo:[0,1,0] neg_hi:[0,1,0]
    v_pk_fma_f32 v[54:55], v[54:55], v[38:39], v[112:113] neg_lo:[0,1,0] neg_hi:[0,1,0]
    v_exp_f32 v64, v48
    v_exp_f32 v65, v49
    v_exp_f32 v66, v50
    v_exp_f32 v67, v51
    v_exp_f32 v68, v52
    v_exp_f32 v69, v53
    v_exp_f32 v70, v54
    v_exp_f32 v71, v55
    v_pk_add_f32 v[64:65], v[64:65], v[114:115]
    buffer_load_dwordx4 a[20:23], v14, s[36:39], s52 offen offset:0 sc1
    v_pk_add_f32 v[66:67], v[66:67], v[114:115]
    v_pk_add_f32 v[68:69], v[68:69], v[114:115]
    v_pk_add_f32 v[70:71], v[70:71], v[114:115]
    v_rcp_f32 v64, v64
    v_rcp_f32 v65, v65
    v_rcp_f32 v66, v66
    v_rcp_f32 v67, v67
    v_rcp_f32 v68, v68
    v_rcp_f32 v69, v69
    v_rcp_f32_e64 v70, v70
    v_rcp_f32 v71, v71
    s_nop 0
    v_pk_mul_f32 v[32:33], v[32:33], v[64:65]
    v_pk_mul_f32 v[34:35], v[34:35], v[66:67]
    v_pk_mul_f32 v[36:37], v[36:37], v[68:69]
    v_pk_mul_f32 v[38:39], v[38:39], v[70:71]
    v_cvt_pk_bf16_f32 v132, v32, v33
    v_cvt_pk_bf16_f32 v133, v34, v35
    v_cvt_pk_bf16_f32 v134, v36, v37
    v_cvt_pk_bf16_f32 v135, v38, v39
    s_lshr_b32 s73, s69, 1
    s_lshl_b32 s73, s73, 10
    s_add_u32 s73, s73, s76
    s_nop 0
    s_add_u32 s73, s73, 55296
    buffer_store_dwordx4 v[132:135], v18, s[36:39], s73 offen sc1
    v_pk_fma_f32 v[32:33], v[224:225], v[202:203], v[56:57] op_sel_hi:[1,0,1] neg_lo:[0,1,0] neg_hi:[0,1,0]
    v_pk_fma_f32 v[34:35], v[226:227], v[202:203], v[58:59] op_sel_hi:[1,0,1] neg_lo:[0,1,0] neg_hi:[0,1,0]
    v_pk_fma_f32 v[36:37], v[228:229], v[202:203], v[60:61] op_sel_hi:[1,0,1] neg_lo:[0,1,0] neg_hi:[0,1,0]
    buffer_load_dwordx4 a[24:27], v14, s[36:39], s52 offen offset:1024 sc1
    v_pk_fma_f32 v[38:39], v[230:231], v[202:203], v[62:63] op_sel_hi:[1,0,1] neg_lo:[0,1,0] neg_hi:[0,1,0]
    v_pk_fma_f32 v[32:33], v[164:165], v[202:203], v[32:33] op_sel:[0,1,0] op_sel_hi:[1,1,1]
    v_pk_fma_f32 v[34:35], v[166:167], v[202:203], v[34:35] op_sel:[0,1,0] op_sel_hi:[1,1,1]
    v_pk_fma_f32 v[36:37], v[180:181], v[202:203], v[36:37] op_sel:[0,1,0] op_sel_hi:[1,1,1]
    v_pk_fma_f32 v[38:39], v[182:183], v[202:203], v[38:39] op_sel:[0,1,0] op_sel_hi:[1,1,1]
    v_pk_fma_f32 v[48:49], v[32:33], v[32:33], s[74:75]
    v_pk_fma_f32 v[50:51], v[34:35], v[34:35], s[74:75]
    v_pk_fma_f32 v[52:53], v[36:37], v[36:37], s[74:75]
    v_pk_fma_f32 v[54:55], v[38:39], v[38:39], s[74:75]
    v_pk_fma_f32 v[48:49], v[48:49], v[32:33], v[112:113] neg_lo:[0,1,0] neg_hi:[0,1,0]
    v_pk_fma_f32 v[50:51], v[50:51], v[34:35], v[112:113] neg_lo:[0,1,0] neg_hi:[0,1,0]
    v_pk_fma_f32 v[52:53], v[52:53], v[36:37], v[112:113] neg_lo:[0,1,0] neg_hi:[0,1,0]
    v_pk_fma_f32 v[54:55], v[54:55], v[38:39], v[112:113] neg_lo:[0,1,0] neg_hi:[0,1,0]
    v_exp_f32 v64, v48
    v_exp_f32 v65, v49
    v_exp_f32 v66, v50
    v_exp_f32 v67, v51
    v_exp_f32 v68, v52
    v_exp_f32 v69, v53
    v_exp_f32 v70, v54
    v_exp_f32 v71, v55
    v_pk_add_f32 v[64:65], v[64:65], v[114:115]
    buffer_load_dwordx4 a[28:31], v14, s[36:39], s52 offen offset:2048 sc1
    v_pk_add_f32 v[66:67], v[66:67], v[114:115]
    v_pk_add_f32 v[68:69], v[68:69], v[114:115]
    v_pk_add_f32 v[70:71], v[70:71], v[114:115]
    v_rcp_f32 v64, v64
    v_rcp_f32 v65, v65
    v_rcp_f32 v66, v66
    v_rcp_f32 v67, v67
    v_rcp_f32 v68, v68
    v_rcp_f32 v69, v69
    v_rcp_f32_e64 v70, v70
    v_rcp_f32 v71, v71
    s_nop 0
    v_pk_mul_f32 v[32:33], v[32:33], v[64:65]
    v_pk_mul_f32 v[34:35], v[34:35], v[66:67]
    v_pk_mul_f32 v[36:37], v[36:37], v[68:69]
    v_pk_mul_f32 v[38:39], v[38:39], v[70:71]
    v_cvt_pk_bf16_f32 v164, v32, v33
    v_cvt_pk_bf16_f32 v165, v34, v35
    v_cvt_pk_bf16_f32 v166, v36, v37
    v_cvt_pk_bf16_f32 v167, v38, v39
    s_lshr_b32 s73, s71, 1
    s_lshl_b32 s73, s73, 10
    s_add_u32 s73, s73, s76
    s_nop 0
    s_add_u32 s73, s73, 55296
    buffer_store_dwordx4 v[164:167], v18, s[36:39], s73 offen sc1
    v_pk_fma_f32 v[32:33], v[216:217], v[204:205], v[40:41] op_sel_hi:[1,0,1] neg_lo:[0,1,0] neg_hi:[0,1,0]
    v_pk_fma_f32 v[34:35], v[218:219], v[204:205], v[42:43] op_sel_hi:[1,0,1] neg_lo:[0,1,0] neg_hi:[0,1,0]
    v_pk_fma_f32 v[36:37], v[220:221], v[204:205], v[44:45] op_sel_hi:[1,0,1] neg_lo:[0,1,0] neg_hi:[0,1,0]
    buffer_load_dwordx4 a[32:35], v14, s[36:39], s52 offen offset:3072 sc1
    v_pk_fma_f32 v[38:39], v[222:223], v[204:205], v[46:47] op_sel_hi:[1,0,1] neg_lo:[0,1,0] neg_hi:[0,1,0]
    v_pk_fma_f32 v[32:33], v[136:137], v[204:205], v[32:33] op_sel:[0,1,0] op_sel_hi:[1,1,1]
    v_pk_fma_f32 v[34:35], v[138:139], v[204:205], v[34:35] op_sel:[0,1,0] op_sel_hi:[1,1,1]
    v_pk_fma_f32 v[36:37], v[152:153], v[204:205], v[36:37] op_sel:[0,1,0] op_sel_hi:[1,1,1]
    v_pk_fma_f32 v[38:39], v[154:155], v[204:205], v[38:39] op_sel:[0,1,0] op_sel_hi:[1,1,1]
    v_pk_fma_f32 v[48:49], v[32:33], v[32:33], s[74:75]
    v_pk_fma_f32 v[50:51], v[34:35], v[34:35], s[74:75]
    v_pk_fma_f32 v[52:53], v[36:37], v[36:37], s[74:75]
    v_pk_fma_f32 v[54:55], v[38:39], v[38:39], s[74:75]
    v_pk_fma_f32 v[48:49], v[48:49], v[32:33], v[112:113] neg_lo:[0,1,0] neg_hi:[0,1,0]
    v_pk_fma_f32 v[50:51], v[50:51], v[34:35], v[112:113] neg_lo:[0,1,0] neg_hi:[0,1,0]
    v_pk_fma_f32 v[52:53], v[52:53], v[36:37], v[112:113] neg_lo:[0,1,0] neg_hi:[0,1,0]
    v_pk_fma_f32 v[54:55], v[54:55], v[38:39], v[112:113] neg_lo:[0,1,0] neg_hi:[0,1,0]
    v_exp_f32 v64, v48
    v_exp_f32 v65, v49
    v_exp_f32 v66, v50
    v_exp_f32 v67, v51
    v_exp_f32 v68, v52
    v_exp_f32 v69, v53
    v_exp_f32 v70, v54
    v_exp_f32 v71, v55
    v_pk_add_f32 v[64:65], v[64:65], v[114:115]
    buffer_load_dwordx4 a[36:39], v15, s[36:39], s52 offen offset:0 sc1
    s_add_u32 s52, s52, 5120
    v_pk_add_f32 v[66:67], v[66:67], v[114:115]
    v_pk_add_f32 v[68:69], v[68:69], v[114:115]
    v_pk_add_f32 v[70:71], v[70:71], v[114:115]
    v_rcp_f32 v64, v64
    v_rcp_f32 v65, v65
    v_rcp_f32 v66, v66
    v_rcp_f32 v67, v67
    v_rcp_f32 v68, v68
    v_rcp_f32 v69, v69
    v_rcp_f32_e64 v70, v70
    v_rcp_f32 v71, v71
    s_nop 0
    v_pk_mul_f32 v[32:33], v[32:33], v[64:65]
    v_pk_mul_f32 v[34:35], v[34:35], v[66:67]
    v_pk_mul_f32 v[36:37], v[36:37], v[68:69]
    v_pk_mul_f32 v[38:39], v[38:39], v[70:71]
    v_cvt_pk_bf16_f32 v136, v32, v33
    v_cvt_pk_bf16_f32 v137, v34, v35
    v_cvt_pk_bf16_f32 v138, v36, v37
    v_cvt_pk_bf16_f32 v139, v38, v39
    s_lshr_b32 s73, s69, 1
    s_lshl_b32 s73, s73, 10
    s_add_u32 s73, s73, s76
    s_nop 0
    s_add_u32 s73, s73, 110592
    buffer_store_dwordx4 v[136:139], v18, s[36:39], s73 offen sc1
    v_pk_fma_f32 v[32:33], v[224:225], v[204:205], v[56:57] op_sel_hi:[1,0,1] neg_lo:[0,1,0] neg_hi:[0,1,0]
    v_pk_fma_f32 v[34:35], v[226:227], v[204:205], v[58:59] op_sel_hi:[1,0,1] neg_lo:[0,1,0] neg_hi:[0,1,0]
    v_pk_fma_f32 v[36:37], v[228:229], v[204:205], v[60:61] op_sel_hi:[1,0,1] neg_lo:[0,1,0] neg_hi:[0,1,0]
    buffer_load_dwordx4 a[40:43], v14, s[36:39], s52 offen offset:0 sc1
    v_pk_fma_f32 v[38:39], v[230:231], v[204:205], v[62:63] op_sel_hi:[1,0,1] neg_lo:[0,1,0] neg_hi:[0,1,0]
    v_pk_fma_f32 v[32:33], v[168:169], v[204:205], v[32:33] op_sel:[0,1,0] op_sel_hi:[1,1,1]
    v_pk_fma_f32 v[34:35], v[170:171], v[204:205], v[34:35] op_sel:[0,1,0] op_sel_hi:[1,1,1]
    v_pk_fma_f32 v[36:37], v[184:185], v[204:205], v[36:37] op_sel:[0,1,0] op_sel_hi:[1,1,1]
    v_pk_fma_f32 v[38:39], v[186:187], v[204:205], v[38:39] op_sel:[0,1,0] op_sel_hi:[1,1,1]
    v_pk_fma_f32 v[48:49], v[32:33], v[32:33], s[74:75]
    v_pk_fma_f32 v[50:51], v[34:35], v[34:35], s[74:75]
    v_pk_fma_f32 v[52:53], v[36:37], v[36:37], s[74:75]
    v_pk_fma_f32 v[54:55], v[38:39], v[38:39], s[74:75]
    v_pk_fma_f32 v[48:49], v[48:49], v[32:33], v[112:113] neg_lo:[0,1,0] neg_hi:[0,1,0]
    v_pk_fma_f32 v[50:51], v[50:51], v[34:35], v[112:113] neg_lo:[0,1,0] neg_hi:[0,1,0]
    v_pk_fma_f32 v[52:53], v[52:53], v[36:37], v[112:113] neg_lo:[0,1,0] neg_hi:[0,1,0]
    v_pk_fma_f32 v[54:55], v[54:55], v[38:39], v[112:113] neg_lo:[0,1,0] neg_hi:[0,1,0]
    v_exp_f32 v64, v48
    v_exp_f32 v65, v49
    v_exp_f32 v66, v50
    v_exp_f32 v67, v51
    v_exp_f32 v68, v52
    v_exp_f32 v69, v53
    v_exp_f32 v70, v54
    v_exp_f32 v71, v55
    v_pk_add_f32 v[64:65], v[64:65], v[114:115]
    buffer_load_dwordx4 a[44:47], v14, s[36:39], s52 offen offset:1024 sc1
    v_pk_add_f32 v[66:67], v[66:67], v[114:115]
    v_pk_add_f32 v[68:69], v[68:69], v[114:115]
    v_pk_add_f32 v[70:71], v[70:71], v[114:115]
    v_rcp_f32 v64, v64
    v_rcp_f32 v65, v65
    v_rcp_f32 v66, v66
    v_rcp_f32 v67, v67
    v_rcp_f32 v68, v68
    v_rcp_f32 v69, v69
    v_rcp_f32_e64 v70, v70
    v_rcp_f32 v71, v71
    s_nop 0
    v_pk_mul_f32 v[32:33], v[32:33], v[64:65]
    v_pk_mul_f32 v[34:35], v[34:35], v[66:67]
    v_pk_mul_f32 v[36:37], v[36:37], v[68:69]
    v_pk_mul_f32 v[38:39], v[38:39], v[70:71]
    v_cvt_pk_bf16_f32 v168, v32, v33
    v_cvt_pk_bf16_f32 v169, v34, v35
    v_cvt_pk_bf16_f32 v170, v36, v37
    v_cvt_pk_bf16_f32 v171, v38, v39
    s_lshr_b32 s73, s71, 1
    s_lshl_b32 s73, s73, 10
    s_add_u32 s73, s73, s76
    s_nop 0
    s_add_u32 s73, s73, 110592
    buffer_store_dwordx4 v[168:171], v18, s[36:39], s73 offen sc1
    v_pk_fma_f32 v[32:33], v[216:217], v[206:207], v[40:41] op_sel_hi:[1,0,1] neg_lo:[0,1,0] neg_hi:[0,1,0]
    v_pk_fma_f32 v[34:35], v[218:219], v[206:207], v[42:43] op_sel_hi:[1,0,1] neg_lo:[0,1,0] neg_hi:[0,1,0]
    v_pk_fma_f32 v[36:37], v[220:221], v[206:207], v[44:45] op_sel_hi:[1,0,1] neg_lo:[0,1,0] neg_hi:[0,1,0]
    buffer_load_dwordx4 a[48:51], v14, s[36:39], s52 offen offset:2048 sc1
    v_pk_fma_f32 v[38:39], v[222:223], v[206:207], v[46:47] op_sel_hi:[1,0,1] neg_lo:[0,1,0] neg_hi:[0,1,0]
    v_pk_fma_f32 v[32:33], v[140:141], v[206:207], v[32:33] op_sel:[0,1,0] op_sel_hi:[1,1,1]
    v_pk_fma_f32 v[34:35], v[142:143], v[206:207], v[34:35] op_sel:[0,1,0] op_sel_hi:[1,1,1]
    v_pk_fma_f32 v[36:37], v[156:157], v[206:207], v[36:37] op_sel:[0,1,0] op_sel_hi:[1,1,1]
    v_pk_fma_f32 v[38:39], v[158:159], v[206:207], v[38:39] op_sel:[0,1,0] op_sel_hi:[1,1,1]
    v_pk_fma_f32 v[48:49], v[32:33], v[32:33], s[74:75]
    v_pk_fma_f32 v[50:51], v[34:35], v[34:35], s[74:75]
    v_pk_fma_f32 v[52:53], v[36:37], v[36:37], s[74:75]
    v_pk_fma_f32 v[54:55], v[38:39], v[38:39], s[74:75]
    v_pk_fma_f32 v[48:49], v[48:49], v[32:33], v[112:113] neg_lo:[0,1,0] neg_hi:[0,1,0]
    v_pk_fma_f32 v[50:51], v[50:51], v[34:35], v[112:113] neg_lo:[0,1,0] neg_hi:[0,1,0]
    v_pk_fma_f32 v[52:53], v[52:53], v[36:37], v[112:113] neg_lo:[0,1,0] neg_hi:[0,1,0]
    v_pk_fma_f32 v[54:55], v[54:55], v[38:39], v[112:113] neg_lo:[0,1,0] neg_hi:[0,1,0]
    v_exp_f32 v64, v48
    v_exp_f32 v65, v49
    v_exp_f32 v66, v50
    v_exp_f32 v67, v51
    v_exp_f32 v68, v52
    v_exp_f32 v69, v53
    v_exp_f32 v70, v54
    v_exp_f32 v71, v55
    v_pk_add_f32 v[64:65], v[64:65], v[114:115]
    buffer_load_dwordx4 a[52:55], v14, s[36:39], s52 offen offset:3072 sc1
    v_pk_add_f32 v[66:67], v[66:67], v[114:115]
    v_pk_add_f32 v[68:69], v[68:69], v[114:115]
    v_pk_add_f32 v[70:71], v[70:71], v[114:115]
    v_rcp_f32 v64, v64
    v_rcp_f32 v65, v65
    v_rcp_f32 v66, v66
    v_rcp_f32 v67, v67
    v_rcp_f32 v68, v68
    v_rcp_f32 v69, v69
    v_rcp_f32_e64 v70, v70
    v_rcp_f32 v71, v71
    s_nop 0
    v_pk_mul_f32 v[32:33], v[32:33], v[64:65]
    v_pk_mul_f32 v[34:35], v[34:35], v[66:67]
    v_pk_mul_f32 v[36:37], v[36:37], v[68:69]
    v_pk_mul_f32 v[38:39], v[38:39], v[70:71]
    v_cvt_pk_bf16_f32 v140, v32, v33
    v_cvt_pk_bf16_f32 v141, v34, v35
    v_cvt_pk_bf16_f32 v142, v36, v37
    v_cvt_pk_bf16_f32 v143, v38, v39
    s_lshr_b32 s73, s69, 1
    s_lshl_b32 s73, s73, 10
    s_add_u32 s73, s73, s76
    s_nop 0
    s_add_u32 s73, s73, 165888
    buffer_store_dwordx4 v[140:143], v18, s[36:39], s73 offen sc1
    v_pk_fma_f32 v[32:33], v[224:225], v[206:207], v[56:57] op_sel_hi:[1,0,1] neg_lo:[0,1,0] neg_hi:[0,1,0]
    v_pk_fma_f32 v[34:35], v[226:227], v[206:207], v[58:59] op_sel_hi:[1,0,1] neg_lo:[0,1,0] neg_hi:[0,1,0]
    v_pk_fma_f32 v[36:37], v[228:229], v[206:207], v[60:61] op_sel_hi:[1,0,1] neg_lo:[0,1,0] neg_hi:[0,1,0]
    buffer_load_dwordx4 a[56:59], v15, s[36:39], s52 offen offset:0 sc1
    s_add_u32 s52, s52, 5120
    v_pk_fma_f32 v[38:39], v[230:231], v[206:207], v[62:63] op_sel_hi:[1,0,1] neg_lo:[0,1,0] neg_hi:[0,1,0]
    v_pk_fma_f32 v[32:33], v[172:173], v[206:207], v[32:33] op_sel:[0,1,0] op_sel_hi:[1,1,1]
    v_pk_fma_f32 v[34:35], v[174:175], v[206:207], v[34:35] op_sel:[0,1,0] op_sel_hi:[1,1,1]
    v_pk_fma_f32 v[36:37], v[188:189], v[206:207], v[36:37] op_sel:[0,1,0] op_sel_hi:[1,1,1]
    v_pk_fma_f32 v[38:39], v[190:191], v[206:207], v[38:39] op_sel:[0,1,0] op_sel_hi:[1,1,1]
    v_pk_fma_f32 v[48:49], v[32:33], v[32:33], s[74:75]
    v_pk_fma_f32 v[50:51], v[34:35], v[34:35], s[74:75]
    v_pk_fma_f32 v[52:53], v[36:37], v[36:37], s[74:75]
    v_pk_fma_f32 v[54:55], v[38:39], v[38:39], s[74:75]
    v_pk_fma_f32 v[48:49], v[48:49], v[32:33], v[112:113] neg_lo:[0,1,0] neg_hi:[0,1,0]
    v_pk_fma_f32 v[50:51], v[50:51], v[34:35], v[112:113] neg_lo:[0,1,0] neg_hi:[0,1,0]
    v_pk_fma_f32 v[52:53], v[52:53], v[36:37], v[112:113] neg_lo:[0,1,0] neg_hi:[0,1,0]
    v_pk_fma_f32 v[54:55], v[54:55], v[38:39], v[112:113] neg_lo:[0,1,0] neg_hi:[0,1,0]
    v_exp_f32 v64, v48
    v_exp_f32 v65, v49
    v_exp_f32 v66, v50
    v_exp_f32 v67, v51
    v_exp_f32 v68, v52
    v_exp_f32 v69, v53
    v_exp_f32 v70, v54
    v_exp_f32 v71, v55
    v_pk_add_f32 v[64:65], v[64:65], v[114:115]
    buffer_load_dwordx4 a[60:63], v14, s[36:39], s52 offen offset:0 sc1
    v_pk_add_f32 v[66:67], v[66:67], v[114:115]
    v_pk_add_f32 v[68:69], v[68:69], v[114:115]
    v_pk_add_f32 v[70:71], v[70:71], v[114:115]
    v_rcp_f32 v64, v64
    v_rcp_f32 v65, v65
    v_rcp_f32 v66, v66
    v_rcp_f32 v67, v67
    v_rcp_f32 v68, v68
    v_rcp_f32 v69, v69
    v_rcp_f32_e64 v70, v70
    v_rcp_f32 v71, v71
    s_nop 0
    v_pk_mul_f32 v[32:33], v[32:33], v[64:65]
    v_pk_mul_f32 v[34:35], v[34:35], v[66:67]
    v_pk_mul_f32 v[36:37], v[36:37], v[68:69]
    v_pk_mul_f32 v[38:39], v[38:39], v[70:71]
    v_cvt_pk_bf16_f32 v172, v32, v33
    v_cvt_pk_bf16_f32 v173, v34, v35
    v_cvt_pk_bf16_f32 v174, v36, v37
    v_cvt_pk_bf16_f32 v175, v38, v39
    s_lshr_b32 s73, s71, 1
    s_lshl_b32 s73, s73, 10
    s_add_u32 s73, s73, s76
    s_add_u32 s73, s73, 165888
    buffer_store_dwordx4 v[172:175], v18, s[36:39], s73 offen sc1
    s_lshl_b32 s48, s63, 4
    s_add_u32 s48, s48, s64
    s_lshl_b32 s48, s48, 6
    s_add_u32 s48, s48, 229376
    s_cmp_eq_u32 s3, 0
    s_cselect_b32 s48, s48, 17563648
    s_mov_b32 s50, 1
    s_lshr_b32 s78, s68, 1
    s_lshl_b32 s78, s78, 10
    s_add_u32 s29, s76, s78
C4JOIN:
    s_lshr_b32 s49, s53, 1
    s_lshl_b32 s49, s49, 10
    s_add_u32 s49, s49, 229376
    s_mul_i32 s79, s53, 216
    s_add_u32 s79, s79, s55
    s_lshl_b32 s79, s79, 10
    s_add_u32 s79, s79, 10485760
    s_add_u32 s61, s79, 14336
    s_cmp_ge_u32 s3, 2
    s_cselect_b32 s62, s79, 1
    s_lshl_b32 s60, s28, 10
    s_add_u32 s60, s60, s79
    s_add_u32 s78, s3, 0
    s_and_b32 s78, s78, 3
    s_mul_i32 s78, s78, 55296
    v_add_u32 v24, s78, v14
    s_add_u32 s78, s3, 1
    s_and_b32 s78, s78, 3
    s_mul_i32 s78, s78, 55296
    v_add_u32 v25, s78, v14
    s_add_u32 s78, s3, 2
    s_and_b32 s78, s78, 3
    s_mul_i32 s78, s78, 55296
    v_add_u32 v26, s78, v14
    s_add_u32 s78, s3, 3
    s_and_b32 s78, s78, 3
    s_mul_i32 s78, s78, 55296
    v_add_u32 v27, s78, v14
    s_mul_i32 s68, s54, 160
    v_min_u32 v18, 13, v0
    v_lshlrev_b32 v18, 6, v18
    s_waitcnt vmcnt(24) lgkmcnt(0)
    v_mov_b32_dpp v107, v100 wave_rol:1 row_mask:0xf bank_mask:0xf
    v_mov_b32_dpp v112, v101 wave_rol:1 row_mask:0xf bank_mask:0xf
    v_mov_b32_dpp v111, v116 wave_rol:1 row_mask:0xf bank_mask:0xf
    v_mov_b32_dpp v113, v117 wave_rol:1 row_mask:0xf bank_mask:0xf
    v_mov_b32 v104, v97
    v_mov_b32 v105, v98
    v_mov_b32 v106, v99
    v_mov_b32 v108, v101
    v_mov_b32 v109, v102
    v_mov_b32 v110, v103
    v_mov_b32_dpp v107, v96 wave_shl:1 row_mask:0xf bank_mask:0xf
    v_mov_b32_dpp v112, v97 wave_shl:1 row_mask:0xf bank_mask:0xf
    v_mov_b32_dpp v111, v100 wave_shl:1 row_mask:0xf bank_mask:0xf
    v_mov_b32_dpp v113, v101 wave_shl:1 row_mask:0xf bank_mask:0xf
    s_nop 1
    v_lshlrev_b32 v1, 4, v0
    v_add_u32 v5, s86, v1
    s_cmp_lg_u32 s87, 0
    s_cbranch_scc1 CV_NOPRE_10
    v_mov_b32 v20, 0
    v_mov_b32 v21, 0
    v_mov_b32 v22, 0
    v_mov_b32 v23, 0
    v_lshrrev_b32 v4, 1, v0
    v_mul_u32_u24 v4, 4160, v4
    v_and_b32 v6, 1, v0
    v_lshl_add_u32 v4, v6, 4, v4
    v_add_u32 v4, s86, v4
    s_mov_b32 exec_lo, 0xff
    s_mov_b32 exec_hi, 0
    ds_write_b128 v4, v[20:23]
    s_mov_b32 exec_lo, -1
    ds_write_b128 v5, v[20:23] offset:16640
    v_lshlrev_b32 v12, 16, v96
    v_alignbit_b32 v13, v104, v96, 16
    s_mov_b32 exec_lo, 1
    ds_write_b32 v5, v12 offset:4188
    ds_write_b32 v5, v96 offset:8348
    ds_write_b64 v5, v[12:13] offset:12504
    s_mov_b64 exec, -1
CV_NOPRE_10:
    s_lshl_b32 s78, s87, 11
    v_add_u32_e64 v5, s78, v5
    v_alignbit_b32 v32, v104, v96, 16
    v_alignbit_b32 v36, v105, v104, 16
    v_alignbit_b32 v33, v105, v97, 16
    v_alignbit_b32 v37, v106, v105, 16
    v_alignbit_b32 v34, v106, v98, 16
    v_alignbit_b32 v38, v107, v106, 16
    v_alignbit_b32 v35, v107, v99, 16
    v_alignbit_b32 v39, v112, v107, 16
    v_min_u32 v19, ((IDLE-G2_START+511)/512)-1, v0
    s_mul_i32 s80, s3, ((IDLE-G2_START+511)/512)
    v_add_u32 v19, s80, v19
    v_lshlrev_b32 v19, 7, v19
    s_getpc_b64 s[80:81]
CT_9:
    s_nop 0
    v_add_u32 v19, G2_START-CT_9, v19
    s_mov_b32 s82, CODE_END-CT_9
    s_mov_b32 s83, 0x20000
    buffer_load_dword v19, v19, s[80:83], 0 offen
    buffer_load_dwordx4 a[64:67], v14, s[36:39], s52 offen offset:1024 sc1
    ds_write_b128 v5, v[96:99] offset:32
    ds_write_b128 v5, v[32:35] offset:4192
    buffer_load_dwordx4 a[68:71], v14, s[36:39], s52 offen offset:2048 sc1
    buffer_load_dwordx4 a[72:75], v14, s[36:39], s52 offen offset:3072 sc1
    ds_write_b128 v5, v[104:107] offset:8352
    ds_write_b128 v5, v[36:39] offset:12512
    ds_write_b128 v5, v[120:123] offset:17152
    buffer_load_dwordx4 a[76:79], v15, s[36:39], s52 offen offset:0 sc1
    s_add_u32 s52, s52, 5120
    buffer_load_dwordx4 a[80:83], v14, s[36:39], s52 offen offset:0 sc1
    v_alignbit_b32 v40, v108, v100, 16
    v_alignbit_b32 v44, v109, v108, 16
    v_alignbit_b32 v41, v109, v101, 16
    v_alignbit_b32 v45, v110, v109, 16
    v_alignbit_b32 v42, v110, v102, 16
    v_alignbit_b32 v46, v111, v110, 16
    v_alignbit_b32 v43, v111, v103, 16
    v_alignbit_b32 v47, v113, v111, 16
    buffer_load_dwordx4 a[84:87], v14, s[36:39], s52 offen offset:1024 sc1
    ds_write_b128 v5, v[100:103] offset:1056
    ds_write_b128 v5, v[40:43] offset:5216
    buffer_load_dwordx4 a[88:91], v14, s[36:39], s52 offen offset:2048 sc1
    ds_write_b128 v5, v[108:111] offset:9376
    ds_write_b128 v5, v[44:47] offset:13536
    ds_write_b128 v5, v[124:127] offset:18176
    buffer_load_dwordx4 a[92:95], v14, s[36:39], s52 offen offset:3072 sc1
    v_and_b32 v6, 15, v0
    v_lshrrev_b32 v7, 4, v0
    v_add_u32 v8, 1, v6
    v_and_b32 v9, 3, v8
    v_and_b32_e64 v8, 28, v8
    v_mul_u32_u24 v9, 4160, v9
    v_lshl_add_u32 v9, v8, 1, v9
    v_lshl_add_u32 v9, v7, 4, v9
    v_add_u32 v2, s86, v9
    v_lshlrev_b32 v8, 1, v6
    v_sub_u32 v8, v8, v7
    v_lshlrev_b32 v8, 4, v8
    v_add_u32 v8, 16720, v8
    v_add_u32 v3, s86, v8
    s_lshl_b32 s78, s87, 8
    v_add_u32 v2, s78, v2
    v_subrev_u32 v3, s78, v3
    buffer_load_dwordx4 a[96:99], v15, s[36:39], s52 offen offset:0 sc1
    s_add_u32 s52, s52, 5120
    v_sub_u32 v8, 15, v6
    v_lshrrev_b32 v9, 3, v8
    v_cmp_eq_u32 s[80:81], v9, v7
    v_bfe_u32 v9, v8, 1, 2
    v_and_b32 v10, 1, v8
    v_lshlrev_b32 v10, 4, v10
    s_and_b32 s78, s84, 1
    s_lshl_b32 s78, s78, 4
    s_lshr_b32 s77, s77, s78
    s_and_b32 s77, s77, 0xffff
    s_cmp_eq_u32 s87, 0
    s_cselect_b32 s77, s77, 0
    buffer_load_dwordx4 a[100:103], v14, s[36:39], s52 offen offset:0 sc1
    v_mov_b32 v11, s77
    v_lshlrev_b32 v11, v10, v11
    v_cndmask_b32 v11, 0, v11, s[80:81]
    v_cmp_eq_u32 vcc, 0, v9
    s_nop 1
    v_cndmask_b32 v192, 0, v11, vcc
    v_cmp_eq_u32 vcc, 1, v9
    s_nop 1
    v_cndmask_b32 v193, 0, v11, vcc
    buffer_load_dwordx4 a[104:107], v14, s[36:39], s52 offen offset:1024 sc1
    v_cmp_eq_u32 vcc, 2, v9
    s_nop 1
    v_cndmask_b32 v194, 0, v11, vcc
    v_cmp_eq_u32 vcc, 3, v9
    s_nop 1
    v_cndmask_b32_e64 v195, 0, v11, vcc
    buffer_load_dwordx4 a[108:111], v14, s[36:39], s52 offen offset:2048 sc1
    buffer_load_dwordx4 a[112:115], v14, s[36:39], s52 offen offset:3072 sc1
    s_waitcnt vmcnt(14) lgkmcnt(0)
    s_barrier
    v_mov_b32 v16, s56
    v_lshlrev_b32 v17, 6, v0
    s_mov_b32 exec_lo, s50
    s_mov_b32 exec_hi, 0
    buffer_store_dword v16, v17, s[36:39], s48 offen sc1
    s_mov_b64 exec, -1
    s_nop 0
    ds_read_b128 v[64:67], v3 offset:448
    ds_read_b64 v[32:33], v2 offset:0
    ds_read_b64 v[34:35], v2 offset:8
    ds_read_b128 v[68:71], v3 offset:960
    ds_read_b64 v[36:37], v2 offset:512
    ds_read_b64 v[38:39], v2 offset:520
    ds_read_b128 v[72:75], v3 offset:1472
    ds_read_b64 v[40:41], v2 offset:1024
    ds_read_b64 v[42:43], v2 offset:1032
    ds_read_b128 v[76:79], v3 offset:1984
    ds_read_b64 v[44:45], v2 offset:1536
    ds_read_b64 v[46:47], v2 offset:1544
    ds_read_b128 v[80:83], v3 offset:2496
    ds_read_b64 v[48:49], v2 offset:2048
    ds_read_b64 v[50:51], v2 offset:2056
    ds_read_b128 v[84:87], v3 offset:3008
    ds_read_b64 v[52:53], v2 offset:2560
    ds_read_b64 v[54:55], v2 offset:2568
    ds_read_b128 v[88:91], v3 offset:3520
    ds_read_b64 v[56:57], v2 offset:3072
    ds_read_b64 v[58:59], v2 offset:3080
    ds_read_b128 v[92:95], v3 offset:4032
    ds_read_b64 v[60:61], v2 offset:3584
    ds_read_b64 v[62:63], v2 offset:3592
    s_waitcnt lgkmcnt(15)
    s_nop 0
    v_mfma_f32_16x16x32_bf16 v[160:163], v[192:195], v[64:67], 0
    ds_read_b128 v[128:131], v3 offset:384
    v_mfma_f32_16x16x32_bf16 v[164:167], v[192:195], v[68:71], 0
    ds_read_b64 v[96:97], v2 offset:64
    v_mfma_f32_16x16x32_bf16 v[168:171], v[192:195], v[72:75], 0
    ds_read_b64 v[98:99], v2 offset:72
    buffer_load_dwordx4 a[116:119], v15, s[36:39], s52 offen offset:0 sc1
    s_add_u32 s52, s52, 5120
    s_waitcnt lgkmcnt(15)
    v_mfma_f32_16x16x32_bf16 v[172:175], v[192:195], v[76:79], 0
    ds_read_b128 v[132:135], v3 offset:896
    s_waitcnt lgkmcnt(15)
    v_mfma_f32_16x16x32_bf16 v[176:179], v[192:195], v[80:83], 0
    ds_read_b64 v[100:101], v2 offset:576
    s_waitcnt lgkmcnt(13)
    v_mfma_f32_16x16x32_bf16 v[180:183], v[192:195], v[84:87], 0
    ds_read_b64 v[102:103], v2 offset:584
    s_waitcnt lgkmcnt(11)
    v_mfma_f32_16x16x32_bf16 v[184:187], v[192:195], v[88:91], 0
    ds_read_b128 v[136:139], v3 offset:1408
    s_waitcnt lgkmcnt(9)
    v_mfma_f32_16x16x32_bf16 v[188:191], v[192:195], v[92:95], 0
    ds_read_b64 v[104:105], v2 offset:1088
    buffer_load_dwordx4 a[120:123], v14, s[36:39], s52 offen offset:0 sc1
    s_waitcnt lgkmcnt(8)
    v_mfma_f32_16x16x32_bf16 v[160:163], v[32:35], v[64:67], v[160:163]
    ds_read_b64 v[106:107], v2 offset:1096
    v_mfma_f32_16x16x32_bf16 v[164:167], v[32:35], v[68:71], v[164:167]
    ds_read_b128 v[140:143], v3 offset:1920
    v_mfma_f32_16x16x32_bf16 v[168:171], v[32:35], v[72:75], v[168:171]
    ds_read_b64 v[108:109], v2 offset:1600
    v_mfma_f32_16x16x32_bf16 v[172:175], v[32:35], v[76:79], v[172:175]
    ds_read_b64 v[110:111], v2 offset:1608
    v_mfma_f32_16x16x32_bf16 v[176:179], v[32:35], v[80:83], v[176:179]
    ds_read_b128 v[144:147], v3 offset:2432
    buffer_load_dwordx4 a[124:127], v14, s[36:39], s52 offen offset:1024 sc1
    v_mfma_f32_16x16x32_bf16 v[180:183], v[32:35], v[84:87], v[180:183]
    ds_read_b64 v[112:113], v2 offset:2112
    v_mfma_f32_16x16x32_bf16 v[184:187], v[32:35], v[88:91], v[184:187]
    ds_read_b64 v[114:115], v2 offset:2120
    v_mfma_f32_16x16x32_bf16 v[188:191], v[32:35], v[92:95], v[188:191]
    ds_read_b128 v[148:151], v3 offset:2944
    v_mfma_f32_16x16x32_bf16 v[164:167], v[36:39], v[64:67], v[164:167]
    ds_read_b64 v[116:117], v2 offset:2624
    v_mfma_f32_16x16x32_bf16 v[168:171], v[36:39], v[68:71], v[168:171]
    ds_read_b64 v[118:119], v2 offset:2632
    buffer_load_dwordx4 a[128:131], v14, s[36:39], s52 offen offset:2048 sc1
    v_mfma_f32_16x16x32_bf16 v[172:175], v[36:39], v[72:75], v[172:175]
    ds_read_b128 v[152:155], v3 offset:3456
PAGE4:
    s_cbranch_execz VISIT_RET
    s_nop 0
    v_mfma_f32_16x16x32_bf16 v[176:179], v[36:39], v[76:79], v[176:179]
    ds_read_b64 v[120:121], v2 offset:3136
    v_mfma_f32_16x16x32_bf16 v[180:183], v[36:39], v[80:83], v[180:183]
    ds_read_b64 v[122:123], v2 offset:3144
    v_mfma_f32_16x16x32_bf16 v[184:187], v[36:39], v[84:87], v[184:187]
    ds_read_b128 v[156:159], v3 offset:3968
    v_mfma_f32_16x16x32_bf16 v[188:191], v[36:39], v[88:91], v[188:191]
    ds_read_b64 v[124:125], v2 offset:3648
    buffer_load_dwordx4 a[132:135], v14, s[36:39], s52 offen offset:3072 sc1
    v_mfma_f32_16x16x32_bf16 v[168:171], v[40:43], v[64:67], v[168:171]
    ds_read_b64 v[126:127], v2 offset:3656
    v_mfma_f32_16x16x32_bf16 v[172:175], v[40:43], v[68:71], v[172:175]
    v_mfma_f32_16x16x32_bf16 v[176:179], v[40:43], v[72:75], v[176:179]
    v_mfma_f32_16x16x32_bf16 v[180:183], v[40:43], v[76:79], v[180:183]
    buffer_load_dwordx4 a[136:139], v15, s[36:39], s52 offen offset:0 sc1
    s_add_u32 s52, s52, 5120
    v_mfma_f32_16x16x32_bf16 v[184:187], v[40:43], v[80:83], v[184:187]
    v_mfma_f32_16x16x32_bf16 v[188:191], v[40:43], v[84:87], v[188:191]
    v_mfma_f32_16x16x32_bf16 v[172:175], v[44:47], v[64:67], v[172:175]
    v_mfma_f32_16x16x32_bf16 v[176:179], v[44:47], v[68:71], v[176:179]
    v_mfma_f32_16x16x32_bf16 v[180:183], v[44:47], v[72:75], v[180:183]
    buffer_load_dwordx4 a[140:143], v14, s[36:39], s52 offen offset:0 sc1
    v_mfma_f32_16x16x32_bf16 v[184:187], v[44:47], v[76:79], v[184:187]
    v_mfma_f32_16x16x32_bf16 v[188:191], v[44:47], v[80:83], v[188:191]
    v_mfma_f32_16x16x32_bf16 v[176:179], v[48:51], v[64:67], v[176:179]
    v_mfma_f32_16x16x32_bf16 v[180:183], v[48:51], v[68:71], v[180:183]
    v_mfma_f32_16x16x32_bf16 v[184:187], v[48:51], v[72:75], v[184:187]
    buffer_load_dwordx4 a[144:147], v14, s[36:39], s52 offen offset:1024 sc1
    v_mfma_f32_16x16x32_bf16 v[188:191], v[48:51], v[76:79], v[188:191]
    v_mfma_f32_16x16x32_bf16 v[180:183], v[52:55], v[64:67], v[180:183]
    v_mfma_f32_16x16x32_bf16 v[184:187], v[52:55], v[68:71], v[184:187]
    v_mfma_f32_16x16x32_bf16 v[188:191], v[52:55], v[72:75], v[188:191]
    v_mfma_f32_16x16x32_bf16 v[184:187], v[56:59], v[64:67], v[184:187]
    buffer_load_dwordx4 a[148:151], v14, s[36:39], s52 offen offset:2048 sc1
    v_mfma_f32_16x16x32_bf16 v[188:191], v[56:59], v[68:71], v[188:191]
    v_mfma_f32_16x16x32_bf16 v[188:191], v[60:63], v[64:67], v[188:191]
    s_waitcnt lgkmcnt(0)
    v_mfma_f32_16x16x32_bf16 v[160:163], v[96:99], v[128:131], v[160:163]
    ds_read_b128 v[64:67], v3 offset:320
    v_and_b32 v20, 15, v0
    v_mfma_f32_16x16x32_bf16 v[164:167], v[96:99], v[132:135], v[164:167]
    ds_read_b64 v[32:33], v2 offset:128
    buffer_load_dwordx4 a[152:155], v14, s[36:39], s52 offen offset:3072 sc1
    v_mfma_f32_16x16x32_bf16 v[168:171], v[96:99], v[136:139], v[168:171]
    ds_read_b64 v[34:35], v2 offset:136
    v_mfma_f32_16x16x32_bf16 v[172:175], v[96:99], v[140:143], v[172:175]
    ds_read_b128 v[68:71], v3 offset:832
    v_mfma_f32_16x16x32_bf16 v[176:179], v[96:99], v[144:147], v[176:179]
    ds_read_b64 v[36:37], v2 offset:640
    v_lshrrev_b32_e64 v21, 4, v0
    v_mfma_f32_16x16x32_bf16 v[180:183], v[96:99], v[148:151], v[180:183]
    ds_read_b64 v[38:39], v2 offset:648
    buffer_load_dwordx4 a[156:159], v15, s[36:39], s52 offen offset:0 sc1
    s_add_u32 s52, s52, 5120
    v_mfma_f32_16x16x32_bf16 v[184:187], v[96:99], v[152:155], v[184:187]
    ds_read_b128 v[72:75], v3 offset:1344
    v_mfma_f32_16x16x32_bf16 v[188:191], v[96:99], v[156:159], v[188:191]
    ds_read_b64 v[40:41], v2 offset:1152
    v_mfma_f32_16x16x32_bf16 v[164:167], v[100:103], v[128:131], v[164:167]
    ds_read_b64 v[42:43], v2 offset:1160
    v_mfma_f32_16x16x32_bf16 v[168:171], v[100:103], v[132:135], v[168:171]
    ds_read_b128 v[76:79], v3 offset:1856
    buffer_load_dwordx4 a[160:163], v14, s[36:39], s52 offen offset:0 sc1
    v_mfma_f32_16x16x32_bf16 v[172:175], v[100:103], v[136:139], v[172:175]
    ds_read_b64 v[44:45], v2 offset:1664
    s_lshl_b32 s69, s53, 6
    s_nop 0
    v_mfma_f32_16x16x32_bf16 v[176:179], v[100:103], v[140:143], v[176:179]
    ds_read_b64 v[46:47], v2 offset:1672
    v_mfma_f32_16x16x32_bf16 v[180:183], v[100:103], v[144:147], v[180:183]
    ds_read_b128 v[80:83], v3 offset:2368
    buffer_load_dwordx4 a[164:167], v14, s[36:39], s52 offen offset:1024 sc1
    v_mfma_f32_16x16x32_bf16 v[184:187], v[100:103], v[148:151], v[184:187]
    ds_read_b64 v[48:49], v2 offset:2176
    v_mfma_f32_16x16x32_bf16 v[188:191], v[100:103], v[152:155], v[188:191]
    ds_read_b64 v[50:51], v2 offset:2184
    v_mfma_f32_16x16x32_bf16 v[168:171], v[104:107], v[128:131], v[168:171]
    ds_read_b128 v[84:87], v3 offset:2880
    s_lshl_b32 s70, s3, 4
    s_nop 0
    v_mfma_f32_16x16x32_bf16 v[172:175], v[104:107], v[132:135], v[172:175]
    ds_read_b64 v[52:53], v2 offset:2688
    buffer_load_dwordx4 a[168:171], v14, s[36:39], s52 offen offset:2048 sc1
    v_mfma_f32_16x16x32_bf16 v[176:179], v[104:107], v[136:139], v[176:179]
    ds_read_b64 v[54:55], v2 offset:2696
    v_mfma_f32_16x16x32_bf16 v[180:183], v[104:107], v[140:143], v[180:183]
    ds_read_b128 v[88:91], v3 offset:3392
    v_mfma_f32_16x16x32_bf16 v[184:187], v[104:107], v[144:147], v[184:187]
    ds_read_b64 v[56:57], v2 offset:3200
    buffer_load_dwordx4 a[172:175], v14, s[36:39], s52 offen offset:3072 sc1
    v_mfma_f32_16x16x32_bf16 v[188:191], v[104:107], v[148:151], v[188:191]
    ds_read_b64 v[58:59], v2 offset:3208
    v_mfma_f32_16x16x32_bf16 v[172:175], v[108:111], v[128:131], v[172:175]
    ds_read_b128 v[92:95], v3 offset:3904
    s_add_u32 s70, s70, s69
    v_mfma_f32_16x16x32_bf16 v[176:179], v[108:111], v[132:135], v[176:179]
    ds_read_b64 v[60:61], v2 offset:3712
    v_mfma_f32_16x16x32_bf16 v[180:183], v[108:111], v[136:139], v[180:183]
    ds_read_b64 v[62:63], v2 offset:3720
    buffer_load_dwordx4 a[176:179], v15, s[36:39], s52 offen offset:0 sc1
    s_add_u32 s52, s52, 5120
    v_mfma_f32_16x16x32_bf16 v[184:187], v[108:111], v[140:143], v[184:187]
    v_mfma_f32_16x16x32_bf16 v[188:191], v[108:111], v[144:147], v[188:191]
    v_add_u32 v22, s70, v20
    v_mfma_f32_16x16x32_bf16 v[176:179], v[112:115], v[128:131], v[176:179]
    v_mul_u32_u24 v28, 1280, v22
    v_mfma_f32_16x16x32_bf16 v[180:183], v[112:115], v[132:135], v[180:183]
    buffer_load_dwordx4 a[180:183], v14, s[36:39], s52 offen offset:0 sc1
    v_mfma_f32_16x16x32_bf16 v[184:187], v[112:115], v[136:139], v[184:187]
    v_mfma_f32_16x16x32_bf16 v[188:191], v[112:115], v[140:143], v[188:191]
    v_lshl_add_u32 v29, v21, 3, v28
    v_mfma_f32_16x16x32_bf16 v[180:183], v[116:119], v[128:131], v[180:183]
    buffer_load_dwordx4 a[184:187], v14, s[36:39], s52 offen offset:1024 sc1
    v_mfma_f32_16x16x32_bf16 v[184:187], v[116:119], v[132:135], v[184:187]
    v_lshl_add_u32 v28, v21, 4, v28
    v_mfma_f32_16x16x32_bf16 v[188:191], v[116:119], v[136:139], v[188:191]
    v_mfma_f32_16x16x32_bf16 v[184:187], v[120:123], v[128:131], v[184:187]
    v_lshlrev_b32 v22, 3, v22
    v_mfma_f32_16x16x32_bf16 v[188:191], v[120:123], v[132:135], v[188:191]
    buffer_load_dwordx4 a[188:191], v14, s[36:39], s52 offen offset:2048 sc1
    v_mfma_f32_16x16x32_bf16 v[188:191], v[124:127], v[128:131], v[188:191]
    s_waitcnt lgkmcnt(0)
    v_mfma_f32_16x16x32_bf16 v[160:163], v[32:35], v[64:67], v[160:163]
    ds_read_b128 v[128:131], v3 offset:256
    v_mfma_f32_16x16x32_bf16 v[164:167], v[32:35], v[68:71], v[164:167]
    ds_read_b64 v[96:97], v2 offset:192
    buffer_load_dwordx4 a[192:195], v14, s[36:39], s52 offen offset:3072 sc1
    v_mfma_f32_16x16x32_bf16 v[168:171], v[32:35], v[72:75], v[168:171]
    ds_read_b64 v[98:99], v2 offset:200
    v_mfma_f32_16x16x32_bf16 v[172:175], v[32:35], v[76:79], v[172:175]
    ds_read_b128 v[132:135], v3 offset:768
    v_mfma_f32_16x16x32_bf16 v[176:179], v[32:35], v[80:83], v[176:179]
    ds_read_b64 v[100:101], v2 offset:704
    buffer_load_dwordx4 a[196:199], v15, s[36:39], s52 offen offset:0 sc1
    s_add_u32 s52, s52, 5120
    v_mfma_f32_16x16x32_bf16 v[180:183], v[32:35], v[84:87], v[180:183]
    ds_read_b64 v[102:103], v2 offset:712
    v_mfma_f32_16x16x32_bf16 v[184:187], v[32:35], v[88:91], v[184:187]
    ds_read_b128 v[136:139], v3 offset:1280
    v_mfma_f32_16x16x32_bf16 v[188:191], v[32:35], v[92:95], v[188:191]
    ds_read_b64 v[104:105], v2 offset:1216
    v_mfma_f32_16x16x32_bf16 v[164:167], v[36:39], v[64:67], v[164:167]
    ds_read_b64 v[106:107], v2 offset:1224
    buffer_load_dwordx4 a[200:203], v14, s[36:39], s52 offen offset:0 sc1
    v_mfma_f32_16x16x32_bf16 v[168:171], v[36:39], v[68:71], v[168:171]
    ds_read_b128 v[140:143], v3 offset:1792
    v_mfma_f32_16x16x32_bf16 v[172:175], v[36:39], v[72:75], v[172:175]
    ds_read_b64 v[108:109], v2 offset:1728
    v_mfma_f32_16x16x32_bf16 v[176:179], v[36:39], v[76:79], v[176:179]
    ds_read_b64 v[110:111], v2 offset:1736
    buffer_load_dwordx4 a[204:207], v14, s[36:39], s52 offen offset:1024 sc1
    v_mfma_f32_16x16x32_bf16 v[180:183], v[36:39], v[80:83], v[180:183]
    ds_read_b128 v[144:147], v3 offset:2304
    v_mfma_f32_16x16x32_bf16 v[184:187], v[36:39], v[84:87], v[184:187]
    ds_read_b64 v[112:113], v2 offset:2240
    v_mfma_f32_16x16x32_bf16 v[188:191], v[36:39], v[88:91], v[188:191]
    ds_read_b64 v[114:115], v2 offset:2248
    buffer_load_dwordx4 a[208:211], v14, s[36:39], s52 offen offset:2048 sc1
    v_mfma_f32_16x16x32_bf16 v[168:171], v[40:43], v[64:67], v[168:171]
    ds_read_b128 v[148:151], v3 offset:2816
    v_mfma_f32_16x16x32_bf16 v[172:175], v[40:43], v[68:71], v[172:175]
    ds_read_b64 v[116:117], v2 offset:2752
    v_mfma_f32_16x16x32_bf16 v[176:179], v[40:43], v[72:75], v[176:179]
    ds_read_b64 v[118:119], v2 offset:2760
    v_mfma_f32_16x16x32_bf16 v[180:183], v[40:43], v[76:79], v[180:183]
    ds_read_b128 v[152:155], v3 offset:3328
    buffer_load_dwordx4 a[212:215], v14, s[36:39], s52 offen offset:3072 sc1
    v_mfma_f32_16x16x32_bf16 v[184:187], v[40:43], v[80:83], v[184:187]
    ds_read_b64 v[120:121], v2 offset:3264
    v_mfma_f32_16x16x32_bf16 v[188:191], v[40:43], v[84:87], v[188:191]
    ds_read_b64 v[122:123], v2 offset:3272
    v_mfma_f32_16x16x32_bf16 v[172:175], v[44:47], v[64:67], v[172:175]
    ds_read_b128 v[156:159], v3 offset:3840
    buffer_load_dwordx4 a[216:219], v15, s[36:39], s52 offen offset:0 sc1
    s_add_u32 s52, s52, 5120
    v_mfma_f32_16x16x32_bf16 v[176:179], v[44:47], v[68:71], v[176:179]
    ds_read_b64 v[124:125], v2 offset:3776
    v_mfma_f32_16x16x32_bf16 v[180:183], v[44:47], v[72:75], v[180:183]
    ds_read_b64 v[126:127], v2 offset:3784
    v_mfma_f32_16x16x32_bf16 v[184:187], v[44:47], v[76:79], v[184:187]
    buffer_load_dwordx4 a[220:223], v14, s[36:39], s52 offen offset:0 sc1
    v_mfma_f32_16x16x32_bf16 v[188:191], v[44:47], v[80:83], v[188:191]
    v_mfma_f32_16x16x32_bf16 v[176:179], v[48:51], v[64:67], v[176:179]
    v_mfma_f32_16x16x32_bf16 v[180:183], v[48:51], v[68:71], v[180:183]
    buffer_load_dwordx4 a[224:227], v14, s[36:39], s52 offen offset:1024 sc1
    v_mfma_f32_16x16x32_bf16 v[184:187], v[48:51], v[72:75], v[184:187]
    v_mfma_f32_16x16x32_bf16 v[188:191], v[48:51], v[76:79], v[188:191]
    v_mfma_f32_16x16x32_bf16 v[180:183], v[52:55], v[64:67], v[180:183]
    v_mfma_f32_16x16x32_bf16 v[184:187], v[52:55], v[68:71], v[184:187]
    buffer_load_dwordx4 a[228:231], v14, s[36:39], s52 offen offset:2048 sc1
    v_mfma_f32_16x16x32_bf16 v[188:191], v[52:55], v[72:75], v[188:191]
    v_mfma_f32_16x16x32_bf16 v[184:187], v[56:59], v[64:67], v[184:187]
    v_mfma_f32_16x16x32_bf16 v[188:191], v[56:59], v[68:71], v[188:191]
    buffer_load_dwordx4 a[232:235], v14, s[36:39], s52 offen offset:3072 sc1
    v_mfma_f32_16x16x32_bf16 v[188:191], v[60:63], v[64:67], v[188:191]
    s_waitcnt lgkmcnt(0)
    s_nop 0
    v_mfma_f32_16x16x32_bf16 v[160:163], v[96:99], v[128:131], v[160:163]
    v_mfma_f32_16x16x32_bf16 v[164:167], v[96:99], v[132:135], v[164:167]
    buffer_load_dwordx4 a[236:239], v15, s[36:39], s52 offen offset:0 sc1
    s_add_u32 s52, s52, 5120
    v_mfma_f32_16x16x32_bf16 v[168:171], v[96:99], v[136:139], v[168:171]
    v_mfma_f32_16x16x32_bf16 v[172:175], v[96:99], v[140:143], v[172:175]
    v_mfma_f32_16x16x32_bf16 v[176:179], v[96:99], v[144:147], v[176:179]
    buffer_load_dwordx4 v[196:199], v14, s[36:39], s52 offen offset:0 sc1
    v_mfma_f32_16x16x32_bf16 v[180:183], v[96:99], v[148:151], v[180:183]
    v_mfma_f32_16x16x32_bf16 v[184:187], v[96:99], v[152:155], v[184:187]
    v_mfma_f32_16x16x32_bf16 v[188:191], v[96:99], v[156:159], v[188:191]
    v_mfma_f32_16x16x32_bf16 v[164:167], v[100:103], v[128:131], v[164:167]
    buffer_load_dwordx4 v[200:203], v14, s[36:39], s52 offen offset:1024 sc1
    v_mfma_f32_16x16x32_bf16 v[168:171], v[100:103], v[132:135], v[168:171]
    v_mfma_f32_16x16x32_bf16 v[172:175], v[100:103], v[136:139], v[172:175]
    buffer_load_dword v19, v18, s[36:39], s49 offen sc1
    v_mfma_f32_16x16x32_bf16 v[176:179], v[100:103], v[140:143], v[176:179]
    buffer_load_dwordx4 v[204:207], v14, s[36:39], s52 offen offset:2048 sc1
    v_mfma_f32_16x16x32_bf16 v[180:183], v[100:103], v[144:147], v[180:183]
    v_mfma_f32_16x16x32_bf16 v[184:187], v[100:103], v[148:151], v[184:187]
    v_mfma_f32_16x16x32_bf16 v[188:191], v[100:103], v[152:155], v[188:191]
    buffer_load_dwordx4 v[208:211], v14, s[36:39], s52 offen offset:3072 sc1
    v_mfma_f32_16x16x32_bf16 v[168:171], v[104:107], v[128:131], v[168:171]
    v_mfma_f32_16x16x32_bf16 v[172:175], v[104:107], v[132:135], v[172:175]
    v_mfma_f32_16x16x32_bf16 v[176:179], v[104:107], v[136:139], v[176:179]
    v_mfma_f32_16x16x32_bf16 v[180:183], v[104:107], v[140:143], v[180:183]
    buffer_load_dwordx4 v[212:215], v15, s[36:39], s52 offen offset:0 sc1
    s_add_u32 s52, s52, 5120
    v_mfma_f32_16x16x32_bf16 v[184:187], v[104:107], v[144:147], v[184:187]
    v_mfma_f32_16x16x32_bf16 v[188:191], v[104:107], v[148:151], v[188:191]
    v_mfma_f32_16x16x32_bf16 v[172:175], v[108:111], v[128:131], v[172:175]
    buffer_load_dwordx4 v[216:219], v14, s[36:39], s52 offen offset:0 sc1
    v_mfma_f32_16x16x32_bf16 v[176:179], v[108:111], v[132:135], v[176:179]
    v_mfma_f32_16x16x32_bf16 v[180:183], v[108:111], v[136:139], v[180:183]
    v_mfma_f32_16x16x32_bf16 v[184:187], v[108:111], v[140:143], v[184:187]
    buffer_load_dwordx4 v[220:223], v14, s[36:39], s52 offen offset:1024 sc1
    v_mfma_f32_16x16x32_bf16 v[188:191], v[108:111], v[144:147], v[188:191]
    v_mfma_f32_16x16x32_bf16 v[176:179], v[112:115], v[128:131], v[176:179]
    v_mfma_f32_16x16x32_bf16 v[180:183], v[112:115], v[132:135], v[180:183]
    buffer_load_dwordx4 v[224:227], v14, s[36:39], s52 offen offset:2048 sc1
    v_mfma_f32_16x16x32_bf16 v[184:187], v[112:115], v[136:139], v[184:187]
    v_mfma_f32_16x16x32_bf16 v[188:191], v[112:115], v[140:143], v[188:191]
    v_mfma_f32_16x16x32_bf16 v[180:183], v[116:119], v[128:131], v[180:183]
    v_mfma_f32_16x16x32_bf16 v[184:187], v[116:119], v[132:135], v[184:187]
    buffer_load_dwordx4 v[228:231], v14, s[36:39], s52 offen offset:3072 sc1
    v_mfma_f32_16x16x32_bf16 v[188:191], v[116:119], v[136:139], v[188:191]
    v_mfma_f32_16x16x32_bf16 v[184:187], v[120:123], v[128:131], v[184:187]
    v_mfma_f32_16x16x32_bf16 v[188:191], v[120:123], v[132:135], v[188:191]
    buffer_load_dwordx4 v[232:235], v15, s[36:39], s52 offen offset:0 sc1
    v_mfma_f32_16x16x32_bf16 v[188:191], v[124:127], v[128:131], v[188:191]
    s_nop 3
    s_waitcnt vmcnt(8)
    v_cmp_ne_u32 vcc, s56, v19
    s_mov_b64 s[82:83], vcc
    s_cmp_eq_u64 s[82:83], 0
    s_cbranch_scc0 FH_RETRY_11
FH_DONE_12:
    s_mov_b32 s71, 65536
    buffer_load_dwordx2 v[254:255], v22, s[36:39], s71 offen sc1
    s_cmp_eq_u32 s60, s62
    s_cselect_b32 s63, 17563648, s60
    buffer_load_dwordx4 v[48:51], v24, s[36:39], s63 offen offset:0 sc1
    v_lshlrev_b32 v9, 4, v0
    buffer_load_dwordx4 v[52:55], v25, s[36:39], s63 offen offset:0 sc1
    s_lshl_b32 s78, s3, 12
    buffer_load_dwordx4 v[56:59], v26, s[36:39], s63 offen offset:0 sc1
    s_add_u32 s78, s78, 84992
    v_add_u32 v10, s78, v9
    buffer_load_dwordx4 v[60:63], v27, s[36:39], s63 offen offset:0 sc1
    s_xor_b32 s78, s3, 1
    buffer_load_dwordx4 v[64:67], v24, s[36:39], s60 offen offset:1024 sc1
    s_lshl_b32 s78, s78, 12
    s_add_u32 s78, s78, 84992
    buffer_load_dwordx4 v[68:71], v25, s[36:39], s60 offen offset:1024 sc1
    v_add_u32 v11, s78, v9
    buffer_load_dwordx4 v[72:75], v26, s[36:39], s60 offen offset:1024 sc1
    s_cmp_lg_u32 s87, 0
    s_cselect_b32 s78, -1, 0
    buffer_load_dwordx4 v[76:79], v27, s[36:39], s60 offen offset:1024 sc1
    s_mov_b32 exec_lo, s78
    s_mov_b32 exec_hi, s78
    v_swap_b32 v160, v176
    v_swap_b32 v161, v177
    v_swap_b32 v162, v178
    v_swap_b32 v163, v179
    s_mov_b64 exec, -1
    ds_write_b128 v10, v[176:179] offset:0
    buffer_load_dwordx4 v[80:83], v24, s[36:39], s60 offen offset:2048 sc1
    s_mov_b32 exec_lo, s78
    s_mov_b32 exec_hi, s78
    v_swap_b32 v164, v180
    v_swap_b32 v165, v181
    v_swap_b32 v166, v182
    v_swap_b32 v167, v183
    s_mov_b64 exec, -1
    buffer_load_dwordx4 v[84:87], v25, s[36:39], s60 offen offset:2048 sc1
    ds_write_b128 v10, v[180:183] offset:1024
    s_mov_b32 exec_lo, s78
    s_mov_b32 exec_hi, s78
    v_swap_b32 v168, v184
    v_swap_b32 v169, v185
    v_swap_b32 v170, v186
    v_swap_b32 v171, v187
    s_mov_b64 exec, -1
    buffer_load_dwordx4 v[88:91], v26, s[36:39], s60 offen offset:2048 sc1
    ds_write_b128 v10, v[184:187] offset:2048
    buffer_load_dwordx4 v[92:95], v27, s[36:39], s60 offen offset:2048 sc1
    s_mov_b32 exec_lo, s78
    s_mov_b32 exec_hi, s78
    v_swap_b32 v172, v188
    v_swap_b32 v173, v189
    v_swap_b32 v174, v190
    v_swap_b32 v175, v191
    s_mov_b64 exec, -1
    ds_write_b128 v10, v[188:191] offset:3072
    s_waitcnt lgkmcnt(0)
    s_barrier
    s_nop 0
    buffer_load_dwordx4 v[96:99], v24, s[36:39], s60 offen offset:3072 sc1
    ds_read_b128 v[32:35], v11 offset:0
    ds_read_b128 v[36:39], v11 offset:1024
    ds_read_b128 v[40:43], v11 offset:2048
    ds_read_b128 v[44:47], v11 offset:3072
    s_waitcnt lgkmcnt(0)
    s_nop 0
    v_pk_add_f32 v[160:161], v[160:161], v[32:33]
    v_pk_add_f32 v[162:163], v[162:163], v[34:35]
    v_pk_add_f32 v[164:165], v[164:165], v[36:37]
    buffer_load_dwordx4 v[100:103], v25, s[36:39], s60 offen offset:3072 sc1
    v_pk_add_f32 v[166:167], v[166:167], v[38:39]
    v_pk_add_f32 v[168:169], v[168:169], v[40:41]
    v_pk_add_f32 v[170:171], v[170:171], v[42:43]
    v_pk_add_f32 v[172:173], v[172:173], v[44:45]
    v_pk_add_f32 v[174:175], v[174:175], v[46:47]
    s_lshl_b32 s79, s87, 11
    s_add_u32 s79, s79, s85
    s_add_u32 s79, s79, 7340032
    v_bfe_u32 v8, v0, 4, 1
    buffer_load_dwordx4 v[236:239], v26, s[36:39], s60 offen offset:3072 sc1
    v_lshlrev_b32 v8, 9, v8
    v_and_b32 v9, 15, v0
    v_lshl_add_u32 v8, v9, 5, v8
    v_lshrrev_b32_e64 v9, 5, v0
    v_lshl_add_u32 v8, v9, 4, v8
    v_cvt_pk_bf16_f32 v32, v160, v161
    v_cvt_pk_bf16_f32 v33, v162, v163
    v_cvt_pk_bf16_f32 v34, v164, v165
    v_cvt_pk_bf16_f32 v35, v166, v167
    buffer_load_dwordx4 v[240:243], v27, s[36:39], s60 offen offset:3072 sc1
    s_add_u32 s60, s60, 4096
    v_cvt_pk_bf16_f32 v36, v168, v169
    v_cvt_pk_bf16_f32 v37, v170, v171
    v_cvt_pk_bf16_f32 v38, v172, v173
    v_cvt_pk_bf16_f32 v39, v174, v175
    s_nop 1
    v_permlane16_swap_b32 v32, v34
    v_permlane16_swap_b32 v33, v35
    v_permlane16_swap_b32 v36, v38
    v_permlane16_swap_b32 v37, v39
    buffer_store_dwordx4 v[32:35], v8, s[36:39], s79 offen offset:0 sc1
    buffer_store_dwordx4 v[36:39], v8, s[36:39], s79 offen offset:1024 sc1
G2_START:
    s_lshr_b32 s72, s84, 1
    s_lshl_b32 s72, s72, 6
    s_add_u32 s72, s72, 262144
    s_cmp_eq_u32 s3, 0
    s_cselect_b32 s72, s72, 17563648
    s_mul_i32 s59, s54, 2560
    s_add_u32 s59, s59, 262144
    v_min_u32 v18, 39, v0
    v_lshlrev_b32 v18, 6, v18
    v_accvgpr_read_b32 v105, a240
    v_accvgpr_read_b32 v107, a241
    v_accvgpr_read_b32 v109, a242
    v_accvgpr_read_b32 v111, a243
    v_accvgpr_read_b32 v113, a244
    v_accvgpr_read_b32 v115, a245
    v_accvgpr_read_b32 v117, a246
    v_accvgpr_read_b32 v119, a247
    v_accvgpr_read_b32 v121, a248
    v_accvgpr_read_b32 v123, a249
    v_lshlrev_b32 v104, 16, v105
    v_and_b32 v105, 0xffff0000, v105
    v_lshlrev_b32 v106, 16, v107
    v_and_b32 v107, 0xffff0000, v107
    v_lshlrev_b32 v108, 16, v109
    v_and_b32 v109, 0xffff0000, v109
    v_lshlrev_b32 v110, 16, v111
    v_and_b32 v111, 0xffff0000, v111
    v_lshlrev_b32 v112, 16, v113
    v_and_b32 v113, 0xffff0000, v113
    v_lshlrev_b32 v114, 16, v115
    v_and_b32 v115, 0xffff0000, v115
    v_lshlrev_b32 v116, 16, v117
    v_and_b32 v117, 0xffff0000, v117
    v_lshlrev_b32 v118, 16, v119
    v_and_b32 v119, 0xffff0000, v119
    v_lshlrev_b32 v120, 16, v121
    v_and_b32 v121, 0xffff0000, v121
    v_lshlrev_b32 v122, 16, v123
    v_and_b32 v123, 0xffff0000, v123
    s_waitcnt vmcnt(14)
    v_mfma_f32_16x16x32_bf16 v[104:107], a[0:3], v[48:51], v[104:107]
    v_mfma_f32_16x16x32_bf16 v[124:127], a[0:3], v[52:55], 0
    buffer_load_dwordx4 v[32:35], v24, s[36:39], s60 offen offset:0 sc1
    v_mfma_f32_16x16x32_bf16 v[144:147], a[0:3], v[56:59], 0
    v_mfma_f32_16x16x32_bf16 v[164:167], a[0:3], v[60:63], 0
    v_mfma_f32_16x16x32_bf16 v[108:111], a[4:7], v[48:51], v[108:111]
    v_mfma_f32_16x16x32_bf16 v[128:131], a[4:7], v[52:55], 0
    buffer_load_dwordx4 v[36:39], v25, s[36:39], s60 offen offset:0 sc1
    v_mfma_f32_16x16x32_bf16 v[148:151], a[4:7], v[56:59], 0
    v_mfma_f32_16x16x32_bf16 v[168:171], a[4:7], v[60:63], 0
    v_mfma_f32_16x16x32_bf16 v[112:115], a[8:11], v[48:51], v[112:115]
    v_mfma_f32_16x16x32_bf16 v[132:135], a[8:11], v[52:55], 0
    buffer_load_dwordx4 v[40:43], v26, s[36:39], s60 offen offset:0 sc1
    v_mfma_f32_16x16x32_bf16 v[152:155], a[8:11], v[56:59], 0
    v_mfma_f32_16x16x32_bf16 v[172:175], a[8:11], v[60:63], 0
    v_mfma_f32_16x16x32_bf16 v[116:119], a[12:15], v[48:51], v[116:119]
    v_mfma_f32_16x16x32_bf16 v[136:139], a[12:15], v[52:55], 0
    buffer_load_dwordx4 v[44:47], v27, s[36:39], s60 offen offset:0 sc1
    v_mfma_f32_16x16x32_bf16 v[156:159], a[12:15], v[56:59], 0
    v_mfma_f32_16x16x32_bf16 v[176:179], a[12:15], v[60:63], 0
    v_mfma_f32_16x16x32_bf16 v[120:123], a[16:19], v[48:51], v[120:123]
    v_mfma_f32_16x16x32_bf16 v[140:143], a[16:19], v[52:55], 0
    v_mfma_f32_16x16x32_bf16 v[160:163], a[16:19], v[56:59], 0
    v_mfma_f32_16x16x32_bf16 v[180:183], a[16:19], v[60:63], 0
    s_waitcnt vmcnt(14)
    v_mfma_f32_16x16x32_bf16 v[104:107], a[20:23], v[64:67], v[104:107]
    v_mfma_f32_16x16x32_bf16 v[124:127], a[20:23], v[68:71], v[124:127]
    buffer_load_dwordx4 v[48:51], v24, s[36:39], s60 offen offset:1024 sc1
    v_mfma_f32_16x16x32_bf16 v[144:147], a[20:23], v[72:75], v[144:147]
    v_mfma_f32_16x16x32_bf16 v[164:167], a[20:23], v[76:79], v[164:167]
    v_mfma_f32_16x16x32_bf16 v[108:111], a[24:27], v[64:67], v[108:111]
    v_mfma_f32_16x16x32_bf16 v[128:131], a[24:27], v[68:71], v[128:131]
    buffer_load_dwordx4 v[52:55], v25, s[36:39], s60 offen offset:1024 sc1
    v_mfma_f32_16x16x32_bf16 v[148:151], a[24:27], v[72:75], v[148:151]
    v_mfma_f32_16x16x32_bf16 v[168:171], a[24:27], v[76:79], v[168:171]
    v_mfma_f32_16x16x32_bf16 v[112:115], a[28:31], v[64:67], v[112:115]
    v_mfma_f32_16x16x32_bf16 v[132:135], a[28:31], v[68:71], v[132:135]
    buffer_load_dwordx4 v[56:59], v26, s[36:39], s60 offen offset:1024 sc1
    v_mfma_f32_16x16x32_bf16 v[152:155], a[28:31], v[72:75], v[152:155]
    v_mfma_f32_16x16x32_bf16 v[172:175], a[28:31], v[76:79], v[172:175]
    v_mfma_f32_16x16x32_bf16 v[116:119], a[32:35], v[64:67], v[116:119]
    v_mfma_f32_16x16x32_bf16 v[136:139], a[32:35], v[68:71], v[136:139]
    buffer_load_dwordx4 v[60:63], v27, s[36:39], s60 offen offset:1024 sc1
    v_mfma_f32_16x16x32_bf16 v[156:159], a[32:35], v[72:75], v[156:159]
    v_mfma_f32_16x16x32_bf16 v[176:179], a[32:35], v[76:79], v[176:179]
    v_mfma_f32_16x16x32_bf16 v[120:123], a[36:39], v[64:67], v[120:123]
    v_mfma_f32_16x16x32_bf16 v[140:143], a[36:39], v[68:71], v[140:143]
    v_mfma_f32_16x16x32_bf16 v[160:163], a[36:39], v[72:75], v[160:163]
    v_mfma_f32_16x16x32_bf16 v[180:183], a[36:39], v[76:79], v[180:183]
    s_waitcnt vmcnt(8)
    s_barrier
    v_mov_b32 v16, s56
    v_lshlrev_b32 v17, 2, v0
    s_mov_b32 exec_lo, 1
    s_mov_b32 exec_hi, 0
    buffer_store_dword v16, v17, s[36:39], s72 offen sc1
    s_mov_b64 exec, -1
    v_mfma_f32_16x16x32_bf16 v[104:107], a[40:43], v[80:83], v[104:107]
    v_mfma_f32_16x16x32_bf16 v[124:127], a[40:43], v[84:87], v[124:127]
    buffer_load_dwordx4 v[64:67], v24, s[36:39], s60 offen offset:2048 sc1
    v_mfma_f32_16x16x32_bf16 v[144:147], a[40:43], v[88:91], v[144:147]
    v_lshrrev_b32 v4, 4, v0
    v_mfma_f32_16x16x32_bf16 v[164:167], a[40:43], v[92:95], v[164:167]
    v_mfma_f32_16x16x32_bf16 v[108:111], a[44:47], v[80:83], v[108:111]
    v_mfma_f32_16x16x32_bf16 v[128:131], a[44:47], v[84:87], v[128:131]
    buffer_load_dwordx4 v[68:71], v25, s[36:39], s60 offen offset:2048 sc1
    v_mfma_f32_16x16x32_bf16 v[148:151], a[44:47], v[88:91], v[148:151]
    v_mfma_f32_16x16x32_bf16 v[168:171], a[44:47], v[92:95], v[168:171]
    v_mfma_f32_16x16x32_bf16 v[112:115], a[48:51], v[80:83], v[112:115]
    v_mfma_f32_16x16x32_bf16 v[132:135], a[48:51], v[84:87], v[132:135]
    buffer_load_dwordx4 v[72:75], v26, s[36:39], s60 offen offset:2048 sc1
    v_mfma_f32_16x16x32_bf16 v[152:155], a[48:51], v[88:91], v[152:155]
    v_mfma_f32_16x16x32_bf16 v[172:175], a[48:51], v[92:95], v[172:175]
    v_mfma_f32_16x16x32_bf16 v[116:119], a[52:55], v[80:83], v[116:119]
    v_mfma_f32_16x16x32_bf16 v[136:139], a[52:55], v[84:87], v[136:139]
    buffer_load_dwordx4 v[76:79], v27, s[36:39], s60 offen offset:2048 sc1
    v_mfma_f32_16x16x32_bf16 v[156:159], a[52:55], v[88:91], v[156:159]
    v_mfma_f32_16x16x32_bf16 v[176:179], a[52:55], v[92:95], v[176:179]
    v_mfma_f32_16x16x32_bf16 v[120:123], a[56:59], v[80:83], v[120:123]
    v_mfma_f32_16x16x32_bf16 v[140:143], a[56:59], v[84:87], v[140:143]
    v_mfma_f32_16x16x32_bf16 v[160:163], a[56:59], v[88:91], v[160:163]
    v_mfma_f32_16x16x32_bf16 v[180:183], a[56:59], v[92:95], v[180:183]
    s_waitcnt vmcnt(15)
    s_nop 0
    v_mfma_f32_16x16x32_bf16 v[104:107], a[60:63], v[96:99], v[104:107]
    v_mfma_f32_16x16x32_bf16 v[124:127], a[60:63], v[100:103], v[124:127]
    buffer_load_dwordx4 v[80:83], v24, s[36:39], s60 offen offset:3072 sc1
    v_mfma_f32_16x16x32_bf16 v[144:147], a[60:63], v[236:239], v[144:147]
    v_mfma_f32_16x16x32_bf16 v[164:167], a[60:63], v[240:243], v[164:167]
    v_mfma_f32_16x16x32_bf16 v[108:111], a[64:67], v[96:99], v[108:111]
    v_mfma_f32_16x16x32_bf16 v[128:131], a[64:67], v[100:103], v[128:131]
    buffer_load_dwordx4 v[84:87], v25, s[36:39], s60 offen offset:3072 sc1
    v_mfma_f32_16x16x32_bf16 v[148:151], a[64:67], v[236:239], v[148:151]
    v_mfma_f32_16x16x32_bf16 v[168:171], a[64:67], v[240:243], v[168:171]
    v_mfma_f32_16x16x32_bf16 v[112:115], a[68:71], v[96:99], v[112:115]
    v_mfma_f32_16x16x32_bf16 v[132:135], a[68:71], v[100:103], v[132:135]
    buffer_load_dwordx4 v[88:91], v26, s[36:39], s60 offen offset:3072 sc1
    v_mfma_f32_16x16x32_bf16 v[152:155], a[68:71], v[236:239], v[152:155]
    v_mfma_f32_16x16x32_bf16 v[172:175], a[68:71], v[240:243], v[172:175]
    v_mfma_f32_16x16x32_bf16 v[116:119], a[72:75], v[96:99], v[116:119]
    v_mfma_f32_16x16x32_bf16 v[136:139], a[72:75], v[100:103], v[136:139]
    buffer_load_dwordx4 v[92:95], v27, s[36:39], s60 offen offset:3072 sc1
    s_add_u32 s60, s60, 4096
    v_mfma_f32_16x16x32_bf16 v[156:159], a[72:75], v[236:239], v[156:159]
    v_mfma_f32_16x16x32_bf16 v[176:179], a[72:75], v[240:243], v[176:179]
    v_mfma_f32_16x16x32_bf16 v[120:123], a[76:79], v[96:99], v[120:123]
    v_mfma_f32_16x16x32_bf16 v[140:143], a[76:79], v[100:103], v[140:143]
    v_mfma_f32_16x16x32_bf16 v[160:163], a[76:79], v[236:239], v[160:163]
    v_mfma_f32_16x16x32_bf16 v[180:183], a[76:79], v[240:243], v[180:183]
    s_waitcnt vmcnt(13)
    v_mfma_f32_16x16x32_bf16 v[104:107], a[80:83], v[32:35], v[104:107]
    v_mfma_f32_16x16x32_bf16 v[124:127], a[80:83], v[36:39], v[124:127]
    buffer_load_dwordx4 v[96:99], v24, s[36:39], s60 offen offset:0 sc1
    v_mfma_f32_16x16x32_bf16 v[144:147], a[80:83], v[40:43], v[144:147]
    v_mfma_f32_16x16x32_bf16 v[164:167], a[80:83], v[44:47], v[164:167]
    v_mfma_f32_16x16x32_bf16 v[108:111], a[84:87], v[32:35], v[108:111]
    v_mfma_f32_16x16x32_bf16 v[128:131], a[84:87], v[36:39], v[128:131]
    buffer_load_dwordx4 v[100:103], v25, s[36:39], s60 offen offset:0 sc1
    v_mfma_f32_16x16x32_bf16 v[148:151], a[84:87], v[40:43], v[148:151]
    v_mfma_f32_16x16x32_bf16 v[168:171], a[84:87], v[44:47], v[168:171]
    v_mfma_f32_16x16x32_bf16 v[112:115], a[88:91], v[32:35], v[112:115]
    v_mfma_f32_16x16x32_bf16 v[132:135], a[88:91], v[36:39], v[132:135]
    buffer_load_dwordx4 v[236:239], v26, s[36:39], s60 offen offset:0 sc1
    v_mfma_f32_16x16x32_bf16 v[152:155], a[88:91], v[40:43], v[152:155]
    v_mfma_f32_16x16x32_bf16 v[172:175], a[88:91], v[44:47], v[172:175]
    v_mfma_f32_16x16x32_bf16 v[116:119], a[92:95], v[32:35], v[116:119]
    v_mfma_f32_16x16x32_bf16 v[136:139], a[92:95], v[36:39], v[136:139]
    buffer_load_dwordx4 v[240:243], v27, s[36:39], s60 offen offset:0 sc1
    v_mfma_f32_16x16x32_bf16 v[156:159], a[92:95], v[40:43], v[156:159]
    v_mfma_f32_16x16x32_bf16 v[176:179], a[92:95], v[44:47], v[176:179]
    v_mfma_f32_16x16x32_bf16 v[120:123], a[96:99], v[32:35], v[120:123]
    v_mfma_f32_16x16x32_bf16 v[140:143], a[96:99], v[36:39], v[140:143]
    v_mfma_f32_16x16x32_bf16 v[160:163], a[96:99], v[40:43], v[160:163]
    v_mfma_f32_16x16x32_bf16 v[180:183], a[96:99], v[44:47], v[180:183]
    s_waitcnt vmcnt(13)
    v_mfma_f32_16x16x32_bf16 v[104:107], a[100:103], v[48:51], v[104:107]
    s_mul_i32 s65, s54, 327680
    s_lshl_b32 s66, s53, 7
    v_mfma_f32_16x16x32_bf16 v[124:127], a[100:103], v[52:55], v[124:127]
    buffer_load_dwordx4 v[32:35], v24, s[36:39], s60 offen offset:1024 sc1
    v_mfma_f32_16x16x32_bf16 v[144:147], a[100:103], v[56:59], v[144:147]
    s_add_u32 s65, s65, s66
    s_add_u32 s65, s65, 7340032
    v_mfma_f32_16x16x32_bf16 v[164:167], a[100:103], v[60:63], v[164:167]
    s_add_u32 s66, s65, 0x20000
    v_mfma_f32_16x16x32_bf16 v[108:111], a[104:107], v[48:51], v[108:111]
    s_add_u32 s67, s65, 0x40000
    v_mfma_f32_16x16x32_bf16 v[128:131], a[104:107], v[52:55], v[128:131]
    buffer_load_dwordx4 v[36:39], v25, s[36:39], s60 offen offset:1024 sc1
    s_cmp_ge_u32 s3, 2
    s_cselect_b32 s67, 17563648, s67
    v_mfma_f32_16x16x32_bf16 v[148:151], a[104:107], v[56:59], v[148:151]
    v_mfma_f32_16x16x32_bf16 v[168:171], a[104:107], v[60:63], v[168:171]
    s_lshl_b32 s79, s3, 3
    v_mfma_f32_16x16x32_bf16 v[112:115], a[108:111], v[48:51], v[112:115]
    v_lshrrev_b32 v10, 3, v0
    v_mfma_f32_16x16x32_bf16 v[132:135], a[108:111], v[52:55], v[132:135]
    buffer_load_dwordx4 v[40:43], v26, s[36:39], s60 offen offset:1024 sc1
    v_add_u32 v10, s79, v10
    v_mfma_f32_16x16x32_bf16 v[152:155], a[108:111], v[56:59], v[152:155]
    v_and_b32 v11, 7, v0
    v_mfma_f32_16x16x32_bf16 v[172:175], a[108:111], v[60:63], v[172:175]
    v_lshlrev_b32 v13, 12, v10
    v_mfma_f32_16x16x32_bf16 v[116:119], a[112:115], v[48:51], v[116:119]
    v_lshl_add_u32 v13, v11, 4, v13
    v_and_b32 v12, 2, v10
    v_mfma_f32_16x16x32_bf16 v[136:139], a[112:115], v[52:55], v[136:139]
    buffer_load_dwordx4 v[44:47], v27, s[36:39], s60 offen offset:1024 sc1
PAGE5:
    s_cbranch_execz PAGE6
    v_mfma_f32_16x16x32_bf16 v[156:159], a[112:115], v[56:59], v[156:159]
    v_xor_b32 v11, v11, v12
    v_mfma_f32_16x16x32_bf16 v[176:179], a[112:115], v[60:63], v[176:179]
    v_lshrrev_b32 v12, 1, v10
    v_and_b32 v12, 4, v12
    v_mfma_f32_16x16x32_bf16 v[120:123], a[116:119], v[48:51], v[120:123]
    v_xor_b32 v11, v11, v12
    v_mfma_f32_16x16x32_bf16 v[140:143], a[116:119], v[52:55], v[140:143]
    v_lshlrev_b32_e64 v10, 7, v10
    v_mfma_f32_16x16x32_bf16 v[160:163], a[116:119], v[56:59], v[160:163]
    v_lshl_add_u32 v10, v11, 4, v10
    v_mfma_f32_16x16x32_bf16 v[180:183], a[116:119], v[60:63], v[180:183]
    v_add_u32 v10, 120832, v10
    s_waitcnt vmcnt(12)
    v_mfma_f32_16x16x32_bf16 v[104:107], a[120:123], v[64:67], v[104:107]
    v_mfma_f32_16x16x32_bf16 v[124:127], a[120:123], v[68:71], v[124:127]
    buffer_load_dwordx4 v[48:51], v24, s[36:39], s60 offen offset:2048 sc1
    v_mfma_f32_16x16x32_bf16 v[144:147], a[120:123], v[72:75], v[144:147]
    s_add_u32 s69, s3, 1
    v_mfma_f32_16x16x32_bf16 v[164:167], a[120:123], v[76:79], v[164:167]
    s_and_b32 s69, s69, 3
    v_mfma_f32_16x16x32_bf16 v[108:111], a[124:127], v[64:67], v[108:111]
    s_mul_i32 s69, s69, 15360
    v_mfma_f32_16x16x32_bf16 v[128:131], a[124:127], v[68:71], v[128:131]
    buffer_load_dwordx4 v[52:55], v25, s[36:39], s60 offen offset:2048 sc1
    s_add_u32 s69, s69, 0
    v_mfma_f32_16x16x32_bf16 v[148:151], a[124:127], v[72:75], v[148:151]
    v_add_u32 v7, s69, v14
    v_mfma_f32_16x16x32_bf16 v[168:171], a[124:127], v[76:79], v[168:171]
    v_mfma_f32_16x16x32_bf16 v[112:115], a[128:131], v[64:67], v[112:115]
    s_add_u32 s69, s3, 2
    v_mfma_f32_16x16x32_bf16 v[132:135], a[128:131], v[68:71], v[132:135]
    buffer_load_dwordx4 v[56:59], v26, s[36:39], s60 offen offset:2048 sc1
    s_and_b32 s69, s69, 3
    v_mfma_f32_16x16x32_bf16 v[152:155], a[128:131], v[72:75], v[152:155]
    s_mul_i32 s69, s69, 15360
    v_mfma_f32_16x16x32_bf16 v[172:175], a[128:131], v[76:79], v[172:175]
    s_add_u32 s69, s69, 5120
    v_mfma_f32_16x16x32_bf16 v[116:119], a[132:135], v[64:67], v[116:119]
    v_add_u32 v8, s69, v14
    v_mfma_f32_16x16x32_bf16 v[136:139], a[132:135], v[68:71], v[136:139]
    buffer_load_dwordx4 v[60:63], v27, s[36:39], s60 offen offset:2048 sc1
    v_mfma_f32_16x16x32_bf16 v[156:159], a[132:135], v[72:75], v[156:159]
    s_add_u32 s69, s3, 3
    v_mfma_f32_16x16x32_bf16 v[176:179], a[132:135], v[76:79], v[176:179]
    s_and_b32 s69, s69, 3
    v_mfma_f32_16x16x32_bf16 v[120:123], a[136:139], v[64:67], v[120:123]
    s_mul_i32 s69, s69, 15360
    v_mfma_f32_16x16x32_bf16 v[140:143], a[136:139], v[68:71], v[140:143]
    s_add_u32 s69, s69, 10240
    v_mfma_f32_16x16x32_bf16 v[160:163], a[136:139], v[72:75], v[160:163]
    v_add_u32 v9, s69, v14
    v_mfma_f32_16x16x32_bf16 v[180:183], a[136:139], v[76:79], v[180:183]
    s_waitcnt vmcnt(12)
    v_mfma_f32_16x16x32_bf16 v[104:107], a[140:143], v[80:83], v[104:107]
    v_and_b32 v2, 15, v0
    v_mfma_f32_16x16x32_bf16 v[124:127], a[140:143], v[84:87], v[124:127]
    buffer_load_dwordx4 v[64:67], v24, s[36:39], s60 offen offset:3072 sc1
    v_mfma_f32_16x16x32_bf16 v[144:147], a[140:143], v[88:91], v[144:147]
    v_lshrrev_b32 v3, 4, v0
    v_mfma_f32_16x16x32_bf16 v[164:167], a[140:143], v[92:95], v[164:167]
    v_lshl_add_u32 v2, v2, 2, v3
    v_mfma_f32_16x16x32_bf16 v[108:111], a[144:147], v[80:83], v[108:111]
    v_mfma_f32_16x16x32_bf16 v[128:131], a[144:147], v[84:87], v[128:131]
    buffer_load_dwordx4 v[68:71], v25, s[36:39], s60 offen offset:3072 sc1
    v_mfma_f32_16x16x32_bf16 v[148:151], a[144:147], v[88:91], v[148:151]
    v_lshlrev_b32 v2, 2, v2
    v_mfma_f32_16x16x32_bf16 v[168:171], a[144:147], v[92:95], v[168:171]
    v_and_b32 v3, 3, v0
    v_mfma_f32_16x16x32_bf16 v[112:115], a[148:151], v[80:83], v[112:115]
    v_mfma_f32_16x16x32_bf16 v[132:135], a[148:151], v[84:87], v[132:135]
    buffer_load_dwordx4 v[72:75], v26, s[36:39], s60 offen offset:3072 sc1
    v_lshlrev_b32 v3, 6, v3
    v_mfma_f32_16x16x32_bf16 v[152:155], a[148:151], v[88:91], v[152:155]
    v_mfma_f32_16x16x32_bf16 v[172:175], a[148:151], v[92:95], v[172:175]
    v_and_b32 v11, 60, v0
    v_mfma_f32_16x16x32_bf16 v[116:119], a[152:155], v[80:83], v[116:119]
    v_mfma_f32_16x16x32_bf16 v[136:139], a[152:155], v[84:87], v[136:139]
    buffer_load_dwordx4 v[76:79], v27, s[36:39], s60 offen offset:3072 sc1
    s_add_u32 s60, s60, 4096
    v_mfma_f32_16x16x32_bf16 v[156:159], a[152:155], v[88:91], v[156:159]
    v_or_b32 v3, v3, v11
    v_mfma_f32_16x16x32_bf16 v[176:179], a[152:155], v[92:95], v[176:179]
    v_mfma_f32_16x16x32_bf16 v[120:123], a[156:159], v[80:83], v[120:123]
    v_mfma_f32_16x16x32_bf16 v[140:143], a[156:159], v[84:87], v[140:143]
    v_mfma_f32_16x16x32_bf16 v[160:163], a[156:159], v[88:91], v[160:163]
    buffer_load_dword v20, v18, s[36:39], s59 offen sc1
    v_mfma_f32_16x16x32_bf16 v[180:183], a[156:159], v[92:95], v[180:183]
    s_waitcnt vmcnt(13)
    v_mfma_f32_16x16x32_bf16 v[104:107], a[160:163], v[96:99], v[104:107]
    v_mfma_f32_16x16x32_bf16 v[124:127], a[160:163], v[100:103], v[124:127]
    buffer_load_dwordx4 v[80:83], v24, s[36:39], s60 offen offset:0 sc1
    v_mfma_f32_16x16x32_bf16 v[144:147], a[160:163], v[236:239], v[144:147]
    ds_bpermute_b32 v244, v2, v244
    v_mfma_f32_16x16x32_bf16 v[164:167], a[160:163], v[240:243], v[164:167]
    ds_bpermute_b32 v245, v2, v245
    v_mfma_f32_16x16x32_bf16 v[108:111], a[164:167], v[96:99], v[108:111]
    v_mfma_f32_16x16x32_bf16 v[128:131], a[164:167], v[100:103], v[128:131]
    buffer_load_dwordx4 v[84:87], v25, s[36:39], s60 offen offset:0 sc1
    ds_bpermute_b32 v246, v2, v246
    v_mfma_f32_16x16x32_bf16 v[148:151], a[164:167], v[236:239], v[148:151]
    v_mfma_f32_16x16x32_bf16 v[168:171], a[164:167], v[240:243], v[168:171]
    ds_bpermute_b32 v247, v2, v247
    v_mfma_f32_16x16x32_bf16 v[112:115], a[168:171], v[96:99], v[112:115]
    v_mfma_f32_16x16x32_bf16 v[132:135], a[168:171], v[100:103], v[132:135]
    buffer_load_dwordx4 v[88:91], v26, s[36:39], s60 offen offset:0 sc1
    ds_bpermute_b32 v248, v2, v248
    v_mfma_f32_16x16x32_bf16 v[152:155], a[168:171], v[236:239], v[152:155]
    v_mfma_f32_16x16x32_bf16 v[172:175], a[168:171], v[240:243], v[172:175]
    ds_bpermute_b32 v249, v2, v249
    v_mfma_f32_16x16x32_bf16 v[116:119], a[172:175], v[96:99], v[116:119]
    ds_bpermute_b32 v250, v2, v250
    v_mfma_f32_16x16x32_bf16 v[136:139], a[172:175], v[100:103], v[136:139]
    buffer_load_dwordx4 v[92:95], v27, s[36:39], s60 offen offset:0 sc1
    v_mfma_f32_16x16x32_bf16 v[156:159], a[172:175], v[236:239], v[156:159]
    v_mfma_f32_16x16x32_bf16 v[176:179], a[172:175], v[240:243], v[176:179]
    ds_bpermute_b32 v251, v2, v251
    v_mfma_f32_16x16x32_bf16 v[120:123], a[176:179], v[96:99], v[120:123]
    ds_bpermute_b32 v252, v2, v252
    v_mfma_f32_16x16x32_bf16 v[140:143], a[176:179], v[100:103], v[140:143]
    v_mfma_f32_16x16x32_bf16 v[160:163], a[176:179], v[236:239], v[160:163]
    ds_bpermute_b32 v253, v2, v253
    v_mfma_f32_16x16x32_bf16 v[180:183], a[176:179], v[240:243], v[180:183]
    s_waitcnt vmcnt(13)
    v_mfma_f32_16x16x32_bf16 v[104:107], a[180:183], v[32:35], v[104:107]
    v_mfma_f32_16x16x32_bf16 v[124:127], a[180:183], v[36:39], v[124:127]
    buffer_load_dwordx4 v[100:103], v25, s[36:39], s60 offen offset:1024 sc1
    v_mfma_f32_16x16x32_bf16 v[144:147], a[180:183], v[40:43], v[144:147]
    s_mov_b32 s48, s26
    v_mfma_f32_16x16x32_bf16 v[164:167], a[180:183], v[44:47], v[164:167]
    v_mfma_f32_16x16x32_bf16 v[108:111], a[184:187], v[32:35], v[108:111]
    s_mov_b32 s49, s27
    s_nop 0
    v_mfma_f32_16x16x32_bf16 v[128:131], a[184:187], v[36:39], v[128:131]
    buffer_load_dwordx4 v[236:239], v26, s[36:39], s60 offen offset:1024 sc1
    v_mfma_f32_16x16x32_bf16 v[148:151], a[184:187], v[40:43], v[148:151]
    v_mfma_f32_16x16x32_bf16 v[168:171], a[184:187], v[44:47], v[168:171]
    s_mov_b32 s50, 2621440
    v_mfma_f32_16x16x32_bf16 v[112:115], a[188:191], v[32:35], v[112:115]
    v_mfma_f32_16x16x32_bf16 v[132:135], a[188:191], v[36:39], v[132:135]
    buffer_load_dwordx4 v[240:243], v27, s[36:39], s60 offen offset:1024 sc1
    v_mfma_f32_16x16x32_bf16 v[152:155], a[188:191], v[40:43], v[152:155]
    s_mov_b32 s51, 0x20000
    v_mfma_f32_16x16x32_bf16 v[172:175], a[188:191], v[44:47], v[172:175]
    v_mfma_f32_16x16x32_bf16 v[116:119], a[192:195], v[32:35], v[116:119]
    v_mfma_f32_16x16x32_bf16 v[136:139], a[192:195], v[36:39], v[136:139]
    buffer_load_dwordx4 v[96:99], v24, s[36:39], s60 offen offset:1024 sc1
    v_mfma_f32_16x16x32_bf16 v[156:159], a[192:195], v[40:43], v[156:159]
    v_mfma_f32_16x16x32_bf16 v[176:179], a[192:195], v[44:47], v[176:179]
    v_mfma_f32_16x16x32_bf16 v[120:123], a[196:199], v[32:35], v[120:123]
    v_mfma_f32_16x16x32_bf16 v[140:143], a[196:199], v[36:39], v[140:143]
    v_mfma_f32_16x16x32_bf16 v[160:163], a[196:199], v[40:43], v[160:163]
    v_mfma_f32_16x16x32_bf16 v[180:183], a[196:199], v[44:47], v[180:183]
    s_waitcnt vmcnt(13)
    v_mfma_f32_16x16x32_bf16 v[104:107], a[200:203], v[48:51], v[104:107]
    s_waitcnt vmcnt(8)
    v_cmp_ne_u32 vcc, s56, v20
    v_mfma_f32_16x16x32_bf16 v[124:127], a[200:203], v[52:55], v[124:127]
    s_mov_b64 s[82:83], vcc
    s_cmp_eq_u64 s[82:83], 0
    s_cbranch_scc0 FY_RETRY_14
FY_DONE_15:
    v_mfma_f32_16x16x32_bf16 v[144:147], a[200:203], v[56:59], v[144:147]
    buffer_load_dwordx4 v[184:187], v13, s[36:39], s65 offen sc1
    v_mfma_f32_16x16x32_bf16 v[164:167], a[200:203], v[60:63], v[164:167]
    buffer_load_dwordx4 v[188:191], v13, s[36:39], s66 offen sc1
    v_mfma_f32_16x16x32_bf16 v[108:111], a[204:207], v[48:51], v[108:111]
    buffer_load_dwordx4 v[192:195], v13, s[36:39], s67 offen sc1
    v_mfma_f32_16x16x32_bf16 v[128:131], a[204:207], v[52:55], v[128:131]
    s_lshl_b32 s76, s3, 12
    s_add_u32 s76, s76, 131072
    s_cmp_eq_u32 s2, 0
    s_cselect_b32 s76, s76, 17563648
    v_mfma_f32_16x16x32_bf16 v[148:151], a[204:207], v[56:59], v[148:151]
    v_lshlrev_b32_e64 v16, 6, v0
    v_mfma_f32_16x16x32_bf16 v[168:171], a[204:207], v[60:63], v[168:171]
    buffer_load_dword v24, v16, s[36:39], s76 offen sc1
    s_mul_i32 s79, s3, 15360
    v_mfma_f32_16x16x32_bf16 v[112:115], a[208:211], v[48:51], v[112:115]
    v_add_u32 v26, s79, v14
    v_bfe_u32 v17, v0, 2, 2
    v_and_b32 v18, 3, v0
    v_mfma_f32_16x16x32_bf16 v[132:135], a[208:211], v[52:55], v[132:135]
    v_lshrrev_b32 v19, 1, v18
    s_lshl_b32 s78, s3, 1
    v_mfma_f32_16x16x32_bf16 v[152:155], a[208:211], v[56:59], v[152:155]
    v_or_b32 v19, s78, v19
    v_and_b32 v18, 1, v18
    v_mfma_f32_16x16x32_bf16 v[172:175], a[208:211], v[60:63], v[172:175]
    v_lshlrev_b32 v18, 3, v18
    v_add_u32 v18, 120832, v18
    v_and_b32 v27, 2, v17
    v_mfma_f32_16x16x32_bf16 v[116:119], a[212:215], v[48:51], v[116:119]
    v_and_b32 v20, 1, v4
    v_lshl_or_b32 v27, v20, 2, v27
    v_mfma_f32_16x16x32_bf16 v[136:139], a[212:215], v[52:55], v[136:139]
    v_xor_b32 v27, v27, v19
    v_lshl_add_u32 v27, v27, 4, v18
    v_mfma_f32_16x16x32_bf16 v[156:159], a[212:215], v[56:59], v[156:159]
    v_lshl_add_u32 v20, v4, 3, v17
    v_lshl_add_u32 v27, v20, 7, v27
    v_lshl_add_u32 v20, v4, 2, v17
    v_mfma_f32_16x16x32_bf16 v[176:179], a[212:215], v[60:63], v[176:179]
    v_and_b32 v23, 2, v20
    v_lshrrev_b32 v21, 1, v20
    v_mfma_f32_16x16x32_bf16 v[120:123], a[216:219], v[48:51], v[120:123]
    v_and_b32 v21, 4, v21
    v_or_b32 v23, v23, v21
    v_mfma_f32_16x16x32_bf16 v[140:143], a[216:219], v[52:55], v[140:143]
    v_xor_b32_e64 v23, v23, v19
    v_lshl_add_u32 v23, v23, 4, v18
    v_lshl_add_u32 v23, v20, 7, v23
    v_mfma_f32_16x16x32_bf16 v[160:163], a[216:219], v[56:59], v[160:163]
    s_mov_b32 s74, 0xbfb8aa3b
    s_mov_b32 s75, 0xbfb8aa3b
    v_mfma_f32_16x16x32_bf16 v[180:183], a[216:219], v[60:63], v[180:183]
    v_mov_b32 v30, 1.0
    v_mov_b32 v31, 1.0
    s_waitcnt vmcnt(8) lgkmcnt(0)
    v_mfma_f32_16x16x32_bf16 v[124:127], a[220:223], v[68:71], v[124:127]
    v_lshlrev_b32 v32, 16, v244
    v_and_b32 v33, 0xffff0000, v244
    v_mfma_f32_16x16x32_bf16 v[128:131], a[224:227], v[68:71], v[128:131]
    v_lshlrev_b32 v34, 16, v245
    v_mfma_f32_16x16x32_bf16 v[124:127], v[196:199], v[84:87], v[124:127]
    v_and_b32 v35, 0xffff0000, v245
    v_mfma_f32_16x16x32_bf16 v[128:131], v[200:203], v[84:87], v[128:131]
    s_waitcnt vmcnt(7)
    v_lshlrev_b32 v36, 16, v246
    v_mfma_f32_16x16x32_bf16 v[124:127], v[216:219], v[100:103], v[124:127]
    v_and_b32 v37, 0xffff0000, v246
    v_mfma_f32_16x16x32_bf16 v[128:131], v[220:223], v[100:103], v[128:131]
    v_lshlrev_b32 v38, 16, v247
    v_mfma_f32_16x16x32_bf16 v[132:135], a[228:231], v[68:71], v[132:135]
    v_and_b32 v39, 0xffff0000, v247
    v_lshlrev_b32_e64 v40, 16, v248
    v_mfma_f32_16x16x32_bf16 v[136:139], a[232:235], v[68:71], v[136:139]
    v_and_b32 v41, 0xffff0000, v248
    v_mfma_f32_16x16x32_bf16 v[132:135], v[204:207], v[84:87], v[132:135]
    ds_write_b128 v7, v[124:127] offset:0
    v_mfma_f32_16x16x32_bf16 v[136:139], v[208:211], v[84:87], v[136:139]
    v_lshlrev_b32_e64 v42, 16, v249
    v_mfma_f32_16x16x32_bf16 v[132:135], v[224:227], v[100:103], v[132:135]
    v_and_b32 v43, 0xffff0000, v249
    v_mfma_f32_16x16x32_bf16 v[136:139], v[228:231], v[100:103], v[136:139]
    ds_write_b128 v7, v[128:131] offset:1024
    v_mfma_f32_16x16x32_bf16 v[140:143], a[236:239], v[68:71], v[140:143]
    v_lshlrev_b32 v44, 16, v250
    v_mfma_f32_16x16x32_bf16 v[144:147], a[220:223], v[72:75], v[144:147]
    v_and_b32 v45, 0xffff0000, v250
    v_mfma_f32_16x16x32_bf16 v[140:143], v[212:215], v[84:87], v[140:143]
    v_lshlrev_b32 v46, 16, v251
    v_and_b32 v47, 0xffff0000, v251
    v_mfma_f32_16x16x32_bf16 v[144:147], v[196:199], v[88:91], v[144:147]
    ds_write_b128 v7, v[132:135] offset:2048
    v_mfma_f32_16x16x32_bf16 v[140:143], v[232:235], v[100:103], v[140:143]
    s_waitcnt vmcnt(6)
    v_lshlrev_b32 v48, 16, v252
    v_mfma_f32_16x16x32_bf16 v[144:147], v[216:219], v[236:239], v[144:147]
    v_and_b32 v49, 0xffff0000, v252
    v_mfma_f32_16x16x32_bf16 v[148:151], a[224:227], v[72:75], v[148:151]
    ds_write_b128 v7, v[136:139] offset:3072
    v_mfma_f32_16x16x32_bf16 v[152:155], a[228:231], v[72:75], v[152:155]
    v_lshlrev_b32_e64 v50, 16, v253
    v_mfma_f32_16x16x32_bf16 v[148:151], v[200:203], v[88:91], v[148:151]
    v_and_b32 v51, 0xffff0000, v253
    v_mfma_f32_16x16x32_bf16 v[152:155], v[204:207], v[88:91], v[152:155]
    ds_write_b128 v7, v[140:143] offset:4096
    v_mfma_f32_16x16x32_bf16 v[148:151], v[220:223], v[236:239], v[148:151]
    v_mul_f32 v254, v254, v255
    v_mfma_f32_16x16x32_bf16 v[152:155], v[224:227], v[236:239], v[152:155]
    v_sub_f32 v254, 0, v254
    v_fma_f32 v52, v32, v255, v254
    v_mfma_f32_16x16x32_bf16 v[156:159], a[232:235], v[72:75], v[156:159]
    ds_write_b128 v8, v[144:147] offset:0
    v_mfma_f32_16x16x32_bf16 v[160:163], a[236:239], v[72:75], v[160:163]
    v_fma_f32 v53, v33, v255, v254
    v_mfma_f32_16x16x32_bf16 v[156:159], v[208:211], v[88:91], v[156:159]
    v_fma_f32 v54, v34, v255, v254
    v_mfma_f32_16x16x32_bf16 v[160:163], v[212:215], v[88:91], v[160:163]
    ds_write_b128 v8, v[148:151] offset:1024
    v_mfma_f32_16x16x32_bf16 v[156:159], v[228:231], v[236:239], v[156:159]
    v_fma_f32 v55, v35, v255, v254
    v_mfma_f32_16x16x32_bf16 v[160:163], v[232:235], v[236:239], v[160:163]
    v_fma_f32 v56, v36, v255, v254
    v_mfma_f32_16x16x32_bf16 v[164:167], a[220:223], v[76:79], v[164:167]
    ds_write_b128 v8, v[152:155] offset:2048
    v_mfma_f32_16x16x32_bf16 v[168:171], a[224:227], v[76:79], v[168:171]
    v_fma_f32 v57, v37, v255, v254
    v_mfma_f32_16x16x32_bf16 v[164:167], v[196:199], v[92:95], v[164:167]
    v_fma_f32 v58, v38, v255, v254
    v_fma_f32 v59, v39, v255, v254
    v_mfma_f32_16x16x32_bf16 v[168:171], v[200:203], v[92:95], v[168:171]
    ds_write_b128 v8, v[156:159] offset:3072
    s_waitcnt vmcnt(5)
    s_nop 0
    v_mfma_f32_16x16x32_bf16 v[164:167], v[216:219], v[240:243], v[164:167]
    v_fma_f32 v60, v40, v255, v254
    v_mfma_f32_16x16x32_bf16 v[168:171], v[220:223], v[240:243], v[168:171]
    v_fma_f32 v61, v41, v255, v254
    v_mfma_f32_16x16x32_bf16 v[172:175], a[228:231], v[76:79], v[172:175]
    ds_write_b128 v8, v[160:163] offset:4096
    v_mfma_f32_16x16x32_bf16 v[176:179], a[232:235], v[76:79], v[176:179]
    v_fma_f32 v62, v42, v255, v254
    v_mfma_f32_16x16x32_bf16 v[172:175], v[204:207], v[92:95], v[172:175]
    v_fma_f32 v63, v43, v255, v254
    v_mfma_f32_16x16x32_bf16 v[176:179], v[208:211], v[92:95], v[176:179]
    ds_write_b128 v9, v[164:167] offset:0
    v_mfma_f32_16x16x32_bf16 v[172:175], v[224:227], v[240:243], v[172:175]
    v_fma_f32 v244, v44, v255, v254
    v_mfma_f32_16x16x32_bf16 v[176:179], v[228:231], v[240:243], v[176:179]
    v_fma_f32 v245, v45, v255, v254
    v_fma_f32 v246, v46, v255, v254
    v_mfma_f32_16x16x32_bf16 v[180:183], a[236:239], v[76:79], v[180:183]
    ds_write_b128 v9, v[168:171] offset:1024
    v_mfma_f32_16x16x32_bf16 v[104:107], a[220:223], v[64:67], v[104:107]
    v_fma_f32 v247, v47, v255, v254
    v_mfma_f32_16x16x32_bf16 v[180:183], v[212:215], v[92:95], v[180:183]
    v_fma_f32 v248, v48, v255, v254
    v_mfma_f32_16x16x32_bf16 v[104:107], v[196:199], v[80:83], v[104:107]
    ds_write_b128 v9, v[172:175] offset:2048
    v_mfma_f32_16x16x32_bf16 v[180:183], v[232:235], v[240:243], v[180:183]
    s_waitcnt vmcnt(4)
    s_nop 0
    v_fma_f32 v249, v49, v255, v254
    v_mfma_f32_16x16x32_bf16 v[104:107], v[216:219], v[96:99], v[104:107]
    v_fma_f32 v250, v50, v255, v254
    v_mfma_f32_16x16x32_bf16 v[108:111], a[224:227], v[64:67], v[108:111]
    ds_write_b128 v9, v[176:179] offset:3072
    v_mfma_f32_16x16x32_bf16 v[112:115], a[228:231], v[64:67], v[112:115]
    v_fma_f32 v251, v51, v255, v254
    v_mfma_f32_16x16x32_bf16 v[108:111], v[200:203], v[80:83], v[108:111]
    v_mfma_f32_16x16x32_bf16 v[112:115], v[204:207], v[80:83], v[112:115]
    ds_write_b128 v9, v[180:183] offset:4096
    v_mfma_f32_16x16x32_bf16 v[108:111], v[220:223], v[96:99], v[108:111]
    v_mfma_f32_16x16x32_bf16 v[112:115], v[224:227], v[96:99], v[112:115]
    v_mfma_f32_16x16x32_bf16 v[116:119], a[232:235], v[64:67], v[116:119]
    s_waitcnt vmcnt(1)
    ds_write_b128 v10, v[184:187] offset:0
    v_mfma_f32_16x16x32_bf16 v[120:123], a[236:239], v[64:67], v[120:123]
    v_mfma_f32_16x16x32_bf16 v[116:119], v[208:211], v[80:83], v[116:119]
    ds_write_b128 v10, v[188:191] offset:4096
    v_mfma_f32_16x16x32_bf16 v[120:123], v[212:215], v[80:83], v[120:123]
    v_mfma_f32_16x16x32_bf16 v[116:119], v[228:231], v[96:99], v[116:119]
    ds_write_b128 v10, v[192:195] offset:8192
    v_mfma_f32_16x16x32_bf16 v[120:123], v[232:235], v[96:99], v[120:123]
    s_cmp_eq_u32 s2, 0
    s_cbranch_scc1 EP_CHECK
EP_BACK:
    s_or_b32 s73, s2, s3
    s_cmp_eq_u32 s73, 0
    s_waitcnt lgkmcnt(0)
    s_barrier
    s_cbranch_scc1 EP_STORE
EP_STORED:
    ds_read_b64_tr_b16 v[220:221], v27 offset:0
    ds_read_b64_tr_b16 v[222:223], v27 offset:512
    ds_read_b64_tr_b16 v[224:225], v27 offset:4096
    ds_read_b64_tr_b16 v[226:227], v27 offset:4608
    ds_read_b64_tr_b16 v[228:229], v23 offset:8192
    ds_read_b128 v[124:127], v26 offset:0
    ds_read_b128 v[144:147], v26 offset:5120
    ds_read_b128 v[164:167], v26 offset:10240
    ds_read_b128 v[128:131], v26 offset:1024
    ds_read_b128 v[148:151], v26 offset:6144
    ds_read_b128 v[168:171], v26 offset:11264
    ds_read_b128 v[132:135], v26 offset:2048
    ds_read_b128 v[152:155], v26 offset:7168
    ds_read_b128 v[172:175], v26 offset:12288
    ds_read_b128 v[136:139], v26 offset:3072
    ds_read_b128 v[156:159], v26 offset:8192
    ds_read_b128 v[176:179], v26 offset:13312
    ds_read_b128 v[140:143], v26 offset:4096
    ds_read_b128 v[160:163], v26 offset:9216
    ds_read_b128 v[180:183], v26 offset:14336
    s_waitcnt lgkmcnt(15)
    v_lshlrev_b32 v92, 16, v220
    v_and_b32 v93, 0xffff0000, v220
    v_lshlrev_b32 v94, 16, v221
    v_and_b32 v95, 0xffff0000, v221
    v_lshlrev_b32 v96, 16, v222
    v_and_b32 v97, 0xffff0000, v222
    v_lshlrev_b32_e64 v98, 16, v223
    v_and_b32 v99, 0xffff0000, v223
    v_pk_mul_f32 v[52:53], v[52:53], v[92:93]
    v_pk_mul_f32 v[54:55], v[54:55], v[94:95]
    v_pk_mul_f32 v[56:57], v[56:57], v[96:97]
    v_pk_mul_f32 v[58:59], v[58:59], v[98:99]
    s_waitcnt lgkmcnt(9)
    s_nop 0
    v_pk_add_f32 v[104:105], v[104:105], v[124:125]
    v_pk_add_f32 v[106:107], v[106:107], v[126:127]
    v_pk_add_f32 v[108:109], v[108:109], v[128:129]
    v_pk_add_f32 v[110:111], v[110:111], v[130:131]
    v_pk_add_f32 v[104:105], v[104:105], v[144:145]
    v_pk_add_f32 v[106:107], v[106:107], v[146:147]
    v_pk_add_f32 v[108:109], v[108:109], v[148:149]
    v_pk_add_f32 v[110:111], v[110:111], v[150:151]
    v_pk_add_f32 v[104:105], v[104:105], v[164:165]
    v_pk_add_f32 v[106:107], v[106:107], v[166:167]
    v_pk_add_f32 v[108:109], v[108:109], v[168:169]
    v_pk_add_f32 v[110:111], v[110:111], v[170:171]
    v_pk_mul_f32 v[72:73], v[104:105], s[74:75]
    v_pk_mul_f32 v[74:75], v[106:107], s[74:75]
    v_pk_mul_f32 v[76:77], v[108:109], s[74:75]
    v_pk_mul_f32 v[78:79], v[110:111], s[74:75]
    v_exp_f32 v72, v72
    v_exp_f32 v73, v73
    v_exp_f32 v74, v74
    v_exp_f32 v75, v75
    v_exp_f32 v76, v76
    v_exp_f32 v77, v77
    v_exp_f32 v78, v78
    v_exp_f32 v79, v79
    v_lshlrev_b32 v100, 16, v224
    v_and_b32 v101, 0xffff0000, v224
    v_lshlrev_b32 v102, 16, v225
    v_and_b32 v103, 0xffff0000, v225
    v_lshlrev_b32 v230, 16, v226
    v_and_b32 v231, 0xffff0000, v226
    v_lshlrev_b32 v232, 16, v227
    v_and_b32 v233, 0xffff0000, v227
    v_pk_add_f32 v[72:73], v[72:73], v[30:31]
    v_pk_add_f32 v[74:75], v[74:75], v[30:31]
    v_pk_add_f32 v[76:77], v[76:77], v[30:31]
    v_pk_add_f32 v[78:79], v[78:79], v[30:31]
    v_rcp_f32 v72, v72
    v_rcp_f32 v73, v73
    v_rcp_f32 v74, v74
    v_rcp_f32 v75, v75
    v_rcp_f32 v76, v76
    v_rcp_f32 v77, v77
    v_rcp_f32 v78, v78
    v_rcp_f32 v79, v79
    v_pk_mul_f32 v[60:61], v[60:61], v[100:101]
    v_pk_mul_f32 v[62:63], v[62:63], v[102:103]
    v_pk_mul_f32 v[244:245], v[244:245], v[230:231]
    v_pk_mul_f32 v[246:247], v[246:247], v[232:233]
    v_pk_mul_f32 v[72:73], v[72:73], v[104:105]
    v_pk_mul_f32 v[74:75], v[74:75], v[106:107]
    v_pk_mul_f32 v[76:77], v[76:77], v[108:109]
    v_pk_mul_f32 v[78:79], v[78:79], v[110:111]
    v_pk_fma_f32 v[72:73], v[72:73], v[52:53], v[32:33]
    v_pk_fma_f32 v[74:75], v[74:75], v[54:55], v[34:35]
    v_pk_fma_f32 v[76:77], v[76:77], v[56:57], v[36:37]
    v_pk_fma_f32 v[78:79], v[78:79], v[58:59], v[38:39]
    v_cvt_pk_bf16_f32 v184, v72, v73
    v_cvt_pk_bf16_f32 v185, v74, v75
    v_cvt_pk_bf16_f32 v186, v76, v77
    v_cvt_pk_bf16_f32 v187, v78, v79
    buffer_store_dwordx4 v[184:187], v28, s[48:51], s68 offen offset:0
    s_waitcnt lgkmcnt(3)
    s_nop 0
    v_pk_add_f32 v[112:113], v[112:113], v[132:133]
    v_pk_add_f32 v[114:115], v[114:115], v[134:135]
    v_pk_add_f32 v[116:117], v[116:117], v[136:137]
    v_pk_add_f32 v[118:119], v[118:119], v[138:139]
    v_pk_add_f32 v[112:113], v[112:113], v[152:153]
    v_pk_add_f32 v[114:115], v[114:115], v[154:155]
    v_pk_add_f32 v[116:117], v[116:117], v[156:157]
    v_pk_add_f32 v[118:119], v[118:119], v[158:159]
    v_pk_add_f32 v[112:113], v[112:113], v[172:173]
    v_pk_add_f32 v[114:115], v[114:115], v[174:175]
    v_pk_add_f32 v[116:117], v[116:117], v[176:177]
    v_pk_add_f32 v[118:119], v[118:119], v[178:179]
    v_pk_mul_f32 v[80:81], v[112:113], s[74:75]
    v_pk_mul_f32 v[82:83], v[114:115], s[74:75]
    v_pk_mul_f32 v[84:85], v[116:117], s[74:75]
    v_pk_mul_f32 v[86:87], v[118:119], s[74:75]
    v_exp_f32 v80, v80
    v_exp_f32 v81, v81
    v_exp_f32 v82, v82
    v_exp_f32 v83, v83
    v_exp_f32 v84, v84
    v_exp_f32 v85, v85
    v_exp_f32 v86, v86
    v_exp_f32 v87, v87
    v_lshlrev_b32 v234, 16, v228
    v_and_b32 v235, 0xffff0000, v228
    v_lshlrev_b32 v236, 16, v229
    v_and_b32 v237, 0xffff0000, v229
    v_pk_add_f32 v[80:81], v[80:81], v[30:31]
    v_pk_add_f32 v[82:83], v[82:83], v[30:31]
    v_pk_add_f32 v[84:85], v[84:85], v[30:31]
    v_pk_add_f32 v[86:87], v[86:87], v[30:31]
    v_rcp_f32 v80, v80
    v_rcp_f32 v81, v81
    v_rcp_f32 v82, v82
    v_rcp_f32 v83, v83
    v_rcp_f32 v84, v84
    v_rcp_f32 v85, v85
    v_rcp_f32 v86, v86
    v_rcp_f32 v87, v87
    v_pk_mul_f32 v[248:249], v[248:249], v[234:235]
    v_pk_mul_f32 v[250:251], v[250:251], v[236:237]
    v_pk_mul_f32 v[80:81], v[80:81], v[112:113]
    v_pk_mul_f32 v[82:83], v[82:83], v[114:115]
    v_pk_mul_f32 v[84:85], v[84:85], v[116:117]
    v_pk_mul_f32 v[86:87], v[86:87], v[118:119]
    v_pk_fma_f32 v[80:81], v[80:81], v[60:61], v[40:41]
    v_pk_fma_f32 v[82:83], v[82:83], v[62:63], v[42:43]
    v_pk_fma_f32 v[84:85], v[84:85], v[244:245], v[44:45]
    v_pk_fma_f32 v[86:87], v[86:87], v[246:247], v[46:47]
    v_cvt_pk_bf16_f32 v188, v80, v81
    v_cvt_pk_bf16_f32 v189, v82, v83
    v_cvt_pk_bf16_f32 v190, v84, v85
    v_cvt_pk_bf16_f32 v191, v86, v87
    buffer_store_dwordx4 v[188:191], v28, s[48:51], s68 offen offset:64
    s_waitcnt lgkmcnt(0)
    s_nop 0
    v_pk_add_f32 v[120:121], v[120:121], v[140:141]
    v_pk_add_f32 v[122:123], v[122:123], v[142:143]
    v_pk_add_f32 v[120:121], v[120:121], v[160:161]
    v_pk_add_f32 v[122:123], v[122:123], v[162:163]
    v_pk_add_f32 v[120:121], v[120:121], v[180:181]
    v_pk_add_f32 v[122:123], v[122:123], v[182:183]
    v_pk_mul_f32 v[88:89], v[120:121], s[74:75]
    v_pk_mul_f32 v[90:91], v[122:123], s[74:75]
    v_exp_f32 v88, v88
    v_exp_f32 v89, v89
    v_exp_f32_e64 v90, v90
    v_exp_f32 v91, v91
    s_nop 0
    v_pk_add_f32 v[88:89], v[88:89], v[30:31]
    v_pk_add_f32 v[90:91], v[90:91], v[30:31]
    v_rcp_f32 v88, v88
    v_rcp_f32 v89, v89
    v_rcp_f32_e64 v90, v90
    v_rcp_f32 v91, v91
    s_nop 0
    v_pk_mul_f32 v[88:89], v[88:89], v[120:121]
    v_pk_mul_f32 v[90:91], v[90:91], v[122:123]
    v_pk_fma_f32 v[88:89], v[88:89], v[248:249], v[48:49]
    v_pk_fma_f32 v[90:91], v[90:91], v[250:251], v[50:51]
    v_cvt_pk_bf16_f32 v192, v88, v89
    v_cvt_pk_bf16_f32 v193, v90, v91
    buffer_store_dwordx2 v[192:193], v29, s[48:51], s68 offen offset:128
    s_branch DONE
IDLE:
    s_movk_i32 s73, 1280
    s_sub_u32 s76, s58, 28
    s_lshl_b32 s76, s76, 3
    s_add_u32 s76, s76, s57
    v_lshrrev_b32 v15, 4, v0
    s_lshl_b32 s78, s3, 2
    v_add_u32 v15, s78, v15
    v_and_b32_e64 v18, 15, v0
    v_mul_u32_u24 v14, 5120, v15
    v_lshl_add_u32 v14, v18, 3, v14
    s_mul_i32 s78, s76, 81920
    v_add_u32_e64 v14, s78, v14
    v_add_u32 v15, 0xfffff100, v14
    v_add_u32 v16, 0xfffff600, v14
    v_add_u32 v17, 0xfffffb00, v14
    v_lshlrev_b32 v18, 5, v18
    s_waitcnt lgkmcnt(0)
    s_load_dword s56, s[30:31], 0
    s_mov_b32 s32, s4
    s_mov_b32 s33, s5
    s_mov_b32 s34, 2621440
    s_mov_b32 s35, 0x20000
    s_mov_b32 s44, s6
    s_mov_b32 s45, s7
    s_mov_b32 s46, 2621440
    s_mov_b32 s47, 0x20000
    s_mov_b32 s48, s8
    s_mov_b32 s49, s9
    s_mov_b32 s50, 2621440
    s_mov_b32 s51, 0x20000
    s_mov_b32 s52, s10
    s_mov_b32 s53, s11
    s_mov_b32 s54, 5120
    s_mov_b32 s55, 0x20000
    s_movk_i32 s79, 896
    s_movk_i32 s80, 3584
    v_add_u32 v22, s79, v14
    v_add_u32 v23, s79, v15
    v_add_u32 v24, s79, v16
    v_add_u32 v25, s79, v17
    buffer_load_dwordx2 v[96:97], v23, s[44:47], 0 offen nt
    buffer_load_dwordx2 v[98:99], v24, s[44:47], 0 offen nt
    buffer_load_dwordx2 v[100:101], v25, s[44:47], 0 offen nt
    buffer_load_dwordx2 v[102:103], v22, s[44:47], 0 offen offset:0 nt
    buffer_load_dwordx2 v[104:105], v22, s[44:47], 0 offen offset:1280 nt
    buffer_load_dwordx2 v[106:107], v22, s[44:47], 0 offen offset:2560 nt
    buffer_load_dwordx2 v[108:109], v22, s[44:47], 0 offen offset:3840 nt
    buffer_load_dwordx4 v[118:121], v18, s[52:55], s80 offen
    buffer_load_dwordx4 v[122:125], v18, s[52:55], s80 offen offset:16
    buffer_load_dwordx2 v[110:111], v22, s[48:51], 0 offen offset:0 nt
    buffer_load_dwordx2 v[112:113], v22, s[48:51], 0 offen offset:1280 nt
    buffer_load_dwordx2 v[114:115], v22, s[48:51], 0 offen offset:2560 nt
    buffer_load_dwordx2 v[116:117], v22, s[48:51], 0 offen offset:3840 nt
    s_mov_b32 s42, 1
    s_mov_b64 exec, 0
PAGE6:
    s_cbranch_execz VISIT_RET
    s_cmp_eq_u32 s3, 0
    s_cbranch_scc1 PAGE1
    s_cmp_eq_u32 s3, 1
    s_cbranch_scc1 PAGE3
    s_cmp_eq_u32 s3, 2
    s_cbranch_scc1 PAGE5
    s_branch PAGE7
VISIT_RET_I:
    s_mov_b64 exec, -1
    s_lshl_b32 s80, s76, 7
    s_add_u32 s59, s80, 2883584
    s_lshl_b32 s68, s76, 6
    s_add_u32 s68, s68, 145408
    s_and_b32 s76, s58, 7
    s_lshl_b32 s77, s57, 2
    s_lshr_b32 s78, s58, 3
    s_add_u32 s77, s77, s78
    s_mul_i32 s78, s77, 40960
    s_mul_i32 s79, s76, 160
    s_add_u32 s78, s78, s79
    s_add_u32 s79, s78, 1310720
    s_cmp_lt_u32 s77, 22
    s_cselect_b32 s79, s79, 2211840
    s_lshl_b32 s80, s3, 6
    v_add_u32_e64 v24, s80, v0
    v_cmp_gt_u32 vcc, 320, v24
    v_subrev_u32 v25, 320, v24
    v_mov_b32 v26, s79
    v_mov_b32 v27, s78
    v_cndmask_b32 v25, v25, v24, vcc
    v_cndmask_b32 v26, v26, v27, vcc
    v_mul_u32_u24 v27, 6554, v25
    v_lshrrev_b32 v27, 16, v27
    v_mul_u32_u24 v28, 10, v27
    v_sub_u32_e64 v28, v25, v28
    v_mul_u32_u24 v27, 1280, v27
    v_lshl_add_u32 v27, v28, 4, v27
    v_add_u32 v80, v27, v26
    v_add_u32 v24, s80, v0
    v_add_u32 v24, 256, v24
    v_cmp_gt_u32 vcc, 320, v24
    v_subrev_u32 v25, 320, v24
    v_mov_b32 v26, s79
    v_mov_b32 v27, s78
    v_cndmask_b32 v25, v25, v24, vcc
    v_cndmask_b32 v26, v26, v27, vcc
    v_mul_u32_u24 v27, 6554, v25
    v_lshrrev_b32 v27, 16, v27
    v_mul_u32_u24 v28, 10, v27
    v_sub_u32_e64 v28, v25, v28
    v_mul_u32_u24 v27, 1280, v27
    v_lshl_add_u32 v27, v28, 4, v27
    v_add_u32 v81, v27, v26
    v_add_u32 v24, s80, v0
    v_add_u32 v24, 512, v24
    v_cmp_gt_u32 vcc, 320, v24
    v_subrev_u32 v25, 320, v24
    v_mov_b32 v26, s79
    v_mov_b32 v27, s78
    v_cndmask_b32 v25, v25, v24, vcc
    v_cndmask_b32 v26, v26, v27, vcc
    v_mul_u32_u24 v27, 6554, v25
    v_lshrrev_b32 v27, 16, v27
    v_mul_u32_u24 v28, 10, v27
    v_sub_u32_e64 v28, v25, v28
    v_mul_u32_u24 v27, 1280, v27
    v_lshl_add_u32 v27, v28, 4, v27
    v_add_u32_e64 v82, v27, v26
    v_mov_b32 v26, 2211840
    v_cmp_gt_u32 vcc, 640, v24
    s_nop 1
    v_cndmask_b32 v82, v26, v82, vcc
    v_and_b32 v203, 15, v0
    v_lshrrev_b32 v204, 5, v0
    s_lshl_b32 s78, s3, 1
    v_add_u32 v204, s78, v204
    v_xor_b32 v204, v204, v203
    v_and_b32 v204, 7, v204
    v_lshlrev_b32_e64 v204, 4, v204
    v_lshl_add_u32 v203, v203, 9, v204
    v_bfe_u32 v204, v0, 4, 1
    v_xor_b32_e64 v204, 1, v204
    v_lshl_add_u32 v203, v204, 3, v203
    v_add_u32 v203, 131584, v203
    s_lshl_b32 s78, s3, 6
    v_add_u32 v205, s78, v0
    v_lshrrev_b32 v206, 3, v205
    v_lshrrev_b32 v204, 5, v205
    v_xor_b32 v204, v204, v205
    v_and_b32 v204, 7, v204
    v_lshlrev_b32_e64 v204, 4, v204
    v_lshl_add_u32 v204, v206, 7, v204
    v_add_u32 v204, 131584, v204
    v_and_b32 v205, 7, v205
    v_lshlrev_b32 v205, 4, v205
    v_lshl_add_u32 v205, v206, 12, v205
    v_add_u32 v206, 0x20000, v205
    s_movk_i32 s79, 1024
    s_movk_i32 s80, 4096
    v_add_u32 v22, s79, v14
    v_add_u32 v23, s79, v15
    v_add_u32 v24, s79, v16
    v_add_u32 v25, s79, v17
    buffer_load_dwordx2 v[126:127], v23, s[44:47], 0 offen nt
    buffer_load_dwordx2 v[128:129], v24, s[44:47], 0 offen nt
    buffer_load_dwordx2 v[130:131], v25, s[44:47], 0 offen nt
    buffer_load_dwordx2 v[132:133], v22, s[44:47], 0 offen offset:0 nt
    buffer_load_dwordx2 v[134:135], v22, s[44:47], 0 offen offset:1280 nt
    buffer_load_dwordx2 v[136:137], v22, s[44:47], 0 offen offset:2560 nt
    buffer_load_dwordx2 v[138:139], v22, s[44:47], 0 offen offset:3840 nt
    buffer_load_dwordx4 v[148:151], v18, s[52:55], s80 offen
    buffer_load_dwordx4 v[152:155], v18, s[52:55], s80 offen offset:16
    buffer_load_dwordx2 v[140:141], v22, s[48:51], 0 offen offset:0 nt
    buffer_load_dwordx2 v[142:143], v22, s[48:51], 0 offen offset:1280 nt
    buffer_load_dwordx2 v[144:145], v22, s[48:51], 0 offen offset:2560 nt
    buffer_load_dwordx2 v[146:147], v22, s[48:51], 0 offen offset:3840 nt
    s_waitcnt vmcnt(17)
    v_lshlrev_b32 v224, 16, v118
    v_and_b32 v228, 0xffff0000, v118
    v_lshlrev_b32 v225, 16, v122
    v_and_b32 v229, 0xffff0000, v122
    v_lshlrev_b32 v226, 16, v120
    v_and_b32 v230, 0xffff0000, v120
    v_lshlrev_b32 v227, 16, v124
    v_and_b32 v231, 0xffff0000, v124
    v_lshlrev_b32 v232, 16, v119
    v_and_b32 v236, 0xffff0000, v119
    v_lshlrev_b32 v233, 16, v123
    v_and_b32 v237, 0xffff0000, v123
    v_lshlrev_b32 v234, 16, v121
    v_and_b32 v238, 0xffff0000, v121
    v_lshlrev_b32 v235, 16, v125
    v_and_b32 v239, 0xffff0000, v125
    v_lshlrev_b32 v208, 16, v96
    v_and_b32 v96, 0xffff0000, v96
    v_lshlrev_b32 v209, 16, v97
    v_and_b32 v97, 0xffff0000, v97
    v_lshlrev_b32 v210, 16, v98
    v_and_b32 v98, 0xffff0000, v98
    v_lshlrev_b32 v211, 16, v99
    v_and_b32 v99, 0xffff0000, v99
    v_lshlrev_b32 v212, 16, v100
    v_and_b32 v100, 0xffff0000, v100
    v_lshlrev_b32 v213, 16, v101
    v_and_b32 v101, 0xffff0000, v101
    v_lshlrev_b32 v214, 16, v102
    v_and_b32 v102, 0xffff0000, v102
    v_lshlrev_b32 v215, 16, v103
    v_and_b32 v103, 0xffff0000, v103
    v_lshlrev_b32 v216, 16, v104
    v_and_b32 v104, 0xffff0000, v104
    v_lshlrev_b32 v217, 16, v105
    v_and_b32 v105, 0xffff0000, v105
    v_lshlrev_b32 v218, 16, v106
    v_and_b32 v106, 0xffff0000, v106
    v_lshlrev_b32 v219, 16, v107
    v_and_b32 v107, 0xffff0000, v107
    v_lshlrev_b32 v220, 16, v108
    v_and_b32 v108, 0xffff0000, v108
    v_lshlrev_b32_e64 v221, 16, v109
    v_and_b32 v109, 0xffff0000, v109
    v_pk_mul_f32 v[240:241], v[214:215], v[224:225]
    v_pk_mul_f32 v[242:243], v[102:103], v[226:227]
    v_pk_mul_f32 v[244:245], v[216:217], v[224:225]
    v_pk_mul_f32 v[246:247], v[104:105], v[226:227]
    v_pk_mul_f32 v[248:249], v[218:219], v[224:225]
    v_pk_mul_f32 v[250:251], v[106:107], v[226:227]
    v_pk_mul_f32 v[252:253], v[220:221], v[224:225]
    v_pk_mul_f32 v[254:255], v[108:109], v[226:227]
    v_pk_fma_f32 v[240:241], v[212:213], v[228:229], v[240:241]
    v_pk_fma_f32 v[242:243], v[100:101], v[230:231], v[242:243]
    v_pk_fma_f32 v[244:245], v[214:215], v[228:229], v[244:245]
    v_pk_fma_f32 v[246:247], v[102:103], v[230:231], v[246:247]
    v_pk_fma_f32 v[248:249], v[216:217], v[228:229], v[248:249]
    v_pk_fma_f32 v[250:251], v[104:105], v[230:231], v[250:251]
    v_pk_fma_f32 v[252:253], v[218:219], v[228:229], v[252:253]
    v_pk_fma_f32 v[254:255], v[106:107], v[230:231], v[254:255]
    v_pk_fma_f32 v[240:241], v[210:211], v[232:233], v[240:241]
    v_pk_fma_f32 v[242:243], v[98:99], v[234:235], v[242:243]
    v_pk_fma_f32 v[244:245], v[212:213], v[232:233], v[244:245]
    v_pk_fma_f32 v[246:247], v[100:101], v[234:235], v[246:247]
    v_pk_fma_f32 v[248:249], v[214:215], v[232:233], v[248:249]
    v_pk_fma_f32 v[250:251], v[102:103], v[234:235], v[250:251]
    v_pk_fma_f32 v[252:253], v[216:217], v[232:233], v[252:253]
    v_pk_fma_f32 v[254:255], v[104:105], v[234:235], v[254:255]
    v_pk_fma_f32 v[240:241], v[208:209], v[236:237], v[240:241]
    v_pk_fma_f32 v[242:243], v[96:97], v[238:239], v[242:243]
    v_pk_fma_f32 v[244:245], v[210:211], v[236:237], v[244:245]
    v_pk_fma_f32 v[246:247], v[98:99], v[238:239], v[246:247]
    v_pk_fma_f32 v[248:249], v[212:213], v[236:237], v[248:249]
    v_pk_fma_f32 v[250:251], v[100:101], v[238:239], v[250:251]
    v_pk_fma_f32 v[252:253], v[214:215], v[236:237], v[252:253]
    v_pk_fma_f32 v[254:255], v[102:103], v[238:239], v[254:255]
    s_waitcnt vmcnt(13)
    v_lshlrev_b32 v208, 16, v110
    v_and_b32 v110, 0xffff0000, v110
    v_lshlrev_b32 v209, 16, v111
    v_and_b32 v111, 0xffff0000, v111
    v_lshlrev_b32 v210, 16, v112
    v_and_b32 v112, 0xffff0000, v112
    v_lshlrev_b32 v211, 16, v113
    v_and_b32 v113, 0xffff0000, v113
    v_lshlrev_b32 v212, 16, v114
    v_and_b32 v114, 0xffff0000, v114
    v_lshlrev_b32 v213, 16, v115
    v_and_b32 v115, 0xffff0000, v115
    v_lshlrev_b32 v214, 16, v116
    v_and_b32 v116, 0xffff0000, v116
    v_lshlrev_b32_e64 v215, 16, v117
    v_and_b32 v117, 0xffff0000, v117
    v_pk_mul_f32 v[240:241], v[240:241], v[208:209]
    v_pk_mul_f32 v[242:243], v[242:243], v[110:111]
    v_pk_mul_f32 v[244:245], v[244:245], v[210:211]
    v_pk_mul_f32 v[246:247], v[246:247], v[112:113]
    v_pk_mul_f32 v[248:249], v[248:249], v[212:213]
    v_pk_mul_f32 v[250:251], v[250:251], v[114:115]
    v_pk_mul_f32 v[252:253], v[252:253], v[214:215]
    v_pk_mul_f32 v[254:255], v[254:255], v[116:117]
    v_cvt_pk_bf16_f32 v224, v252, v248
    v_cvt_pk_bf16_f32 v225, v244, v240
    v_cvt_pk_bf16_f32 v226, v254, v250
    v_cvt_pk_bf16_f32 v227, v246, v242
    v_cvt_pk_bf16_f32 v228, v253, v249
    v_cvt_pk_bf16_f32 v229, v245, v241
    v_cvt_pk_bf16_f32 v230, v255, v251
    v_cvt_pk_bf16_f32 v231, v247, v243
    ds_write_b64 v203, v[224:225] offset:0
    ds_write_b64 v203, v[226:227] offset:128
    ds_write_b64 v203, v[228:229] offset:256
    ds_write_b64 v203, v[230:231] offset:384
    s_movk_i32 s79, 1152
    s_movk_i32 s80, 4608
    v_add_u32 v22, s79, v14
    v_add_u32 v23, s79, v15
    v_add_u32 v24, s79, v16
    v_add_u32 v25, s79, v17
    buffer_load_dwordx2 v[156:157], v23, s[44:47], 0 offen nt
    buffer_load_dwordx2 v[158:159], v24, s[44:47], 0 offen nt
    buffer_load_dwordx2 v[160:161], v25, s[44:47], 0 offen nt
    buffer_load_dwordx2 v[162:163], v22, s[44:47], 0 offen offset:0 nt
    buffer_load_dwordx2 v[164:165], v22, s[44:47], 0 offen offset:1280 nt
    buffer_load_dwordx2 v[166:167], v22, s[44:47], 0 offen offset:2560 nt
    buffer_load_dwordx2 v[168:169], v22, s[44:47], 0 offen offset:3840 nt
    buffer_load_dwordx4 v[178:181], v18, s[52:55], s80 offen
    buffer_load_dwordx4 v[182:185], v18, s[52:55], s80 offen offset:16
    buffer_load_dwordx2 v[170:171], v22, s[48:51], 0 offen offset:0 nt
    buffer_load_dwordx2 v[172:173], v22, s[48:51], 0 offen offset:1280 nt
    buffer_load_dwordx2 v[174:175], v22, s[48:51], 0 offen offset:2560 nt
    buffer_load_dwordx2 v[176:177], v22, s[48:51], 0 offen offset:3840 nt
    s_mov_b32 s36, s30
    s_mov_b32 s37, s31
    s_mov_b32 s38, 17563648
    s_mov_b32 s39, 0x20000
    v_mov_b32 v30, 17563648
    s_cmp_eq_u32 s3, 0
    s_cselect_b32 s80, s68, 17563648
    v_writelane_b32 v30, s80, 1
    s_lshl_b32 s77, s57, 1
    s_lshr_b32 s78, s58, 4
    s_add_u32 s77, s77, s78
    s_lshl_b32 s77, s77, 4
    s_and_b32 s78, s58, 15
    s_add_u32 s77, s77, s78
    s_lshl_b32 s77, s77, 6
    s_add_u32 s77, s77, 196608
    s_cmp_eq_u32 s3, 0
    s_cselect_b32 s77, s77, 17563648
    v_writelane_b32 v30, s77, 0
    s_and_b32 s77, s58, 7
    s_lshl_b32 s77, s77, 5
    s_lshl_b32 s78, s57, 2
    s_lshr_b32 s79, s58, 3
    s_add_u32 s78, s78, s79
    s_add_u32 s77, s77, s78
    s_lshl_b32 s77, s77, 6
    s_add_u32 s77, s77, 163840
    s_cmp_eq_u32 s3, 0
    s_cselect_b32 s77, s77, 17563648
    v_writelane_b32 v30, s77, 2
    s_waitcnt lgkmcnt(0)
    s_add_u32 s56, s56, 2654435769
    v_mov_b32 v31, s56
    s_waitcnt vmcnt(17)
    v_lshlrev_b32 v224, 16, v148
    v_and_b32 v228, 0xffff0000, v148
    v_lshlrev_b32 v225, 16, v152
    v_and_b32 v229, 0xffff0000, v152
    v_lshlrev_b32 v226, 16, v150
    v_and_b32 v230, 0xffff0000, v150
    v_lshlrev_b32 v227, 16, v154
    v_and_b32 v231, 0xffff0000, v154
    v_lshlrev_b32 v232, 16, v149
    v_and_b32 v236, 0xffff0000, v149
    v_lshlrev_b32 v233, 16, v153
    v_and_b32 v237, 0xffff0000, v153
    v_lshlrev_b32 v234, 16, v151
    v_and_b32 v238, 0xffff0000, v151
    v_lshlrev_b32 v235, 16, v155
    v_and_b32 v239, 0xffff0000, v155
    v_lshlrev_b32 v208, 16, v126
    v_and_b32 v126, 0xffff0000, v126
    v_lshlrev_b32 v209, 16, v127
    v_and_b32 v127, 0xffff0000, v127
    v_lshlrev_b32 v210, 16, v128
    v_and_b32 v128, 0xffff0000, v128
    v_lshlrev_b32 v211, 16, v129
    v_and_b32 v129, 0xffff0000, v129
    v_lshlrev_b32 v212, 16, v130
    v_and_b32 v130, 0xffff0000, v130
    v_lshlrev_b32 v213, 16, v131
    v_and_b32 v131, 0xffff0000, v131
    v_lshlrev_b32 v214, 16, v132
    v_and_b32 v132, 0xffff0000, v132
    v_lshlrev_b32 v215, 16, v133
    v_and_b32 v133, 0xffff0000, v133
    v_lshlrev_b32 v216, 16, v134
    v_and_b32 v134, 0xffff0000, v134
    v_lshlrev_b32 v217, 16, v135
    v_and_b32 v135, 0xffff0000, v135
    v_lshlrev_b32 v218, 16, v136
    v_and_b32 v136, 0xffff0000, v136
    v_lshlrev_b32 v219, 16, v137
    v_and_b32 v137, 0xffff0000, v137
    v_lshlrev_b32 v220, 16, v138
    v_and_b32 v138, 0xffff0000, v138
    v_lshlrev_b32 v221, 16, v139
    v_and_b32 v139, 0xffff0000, v139
    v_pk_mul_f32 v[240:241], v[214:215], v[224:225]
    v_pk_mul_f32 v[242:243], v[132:133], v[226:227]
    v_pk_mul_f32 v[244:245], v[216:217], v[224:225]
    v_pk_mul_f32 v[246:247], v[134:135], v[226:227]
    v_pk_mul_f32 v[248:249], v[218:219], v[224:225]
    v_pk_mul_f32 v[250:251], v[136:137], v[226:227]
    v_pk_mul_f32 v[252:253], v[220:221], v[224:225]
    v_pk_mul_f32 v[254:255], v[138:139], v[226:227]
    v_pk_fma_f32 v[240:241], v[212:213], v[228:229], v[240:241]
    v_pk_fma_f32 v[242:243], v[130:131], v[230:231], v[242:243]
    v_pk_fma_f32 v[244:245], v[214:215], v[228:229], v[244:245]
    v_pk_fma_f32 v[246:247], v[132:133], v[230:231], v[246:247]
    v_pk_fma_f32 v[248:249], v[216:217], v[228:229], v[248:249]
    v_pk_fma_f32 v[250:251], v[134:135], v[230:231], v[250:251]
    v_pk_fma_f32 v[252:253], v[218:219], v[228:229], v[252:253]
    v_pk_fma_f32 v[254:255], v[136:137], v[230:231], v[254:255]
    v_pk_fma_f32 v[240:241], v[210:211], v[232:233], v[240:241]
    v_pk_fma_f32 v[242:243], v[128:129], v[234:235], v[242:243]
    v_pk_fma_f32 v[244:245], v[212:213], v[232:233], v[244:245]
    v_pk_fma_f32 v[246:247], v[130:131], v[234:235], v[246:247]
    v_pk_fma_f32 v[248:249], v[214:215], v[232:233], v[248:249]
    v_pk_fma_f32 v[250:251], v[132:133], v[234:235], v[250:251]
    v_pk_fma_f32 v[252:253], v[216:217], v[232:233], v[252:253]
    v_pk_fma_f32 v[254:255], v[134:135], v[234:235], v[254:255]
    v_pk_fma_f32 v[240:241], v[208:209], v[236:237], v[240:241]
    v_pk_fma_f32 v[242:243], v[126:127], v[238:239], v[242:243]
    v_pk_fma_f32 v[244:245], v[210:211], v[236:237], v[244:245]
    v_pk_fma_f32 v[246:247], v[128:129], v[238:239], v[246:247]
    v_pk_fma_f32 v[248:249], v[212:213], v[236:237], v[248:249]
    v_pk_fma_f32 v[250:251], v[130:131], v[238:239], v[250:251]
    v_pk_fma_f32 v[252:253], v[214:215], v[236:237], v[252:253]
    v_pk_fma_f32 v[254:255], v[132:133], v[238:239], v[254:255]
    s_waitcnt vmcnt(13)
    v_lshlrev_b32 v208, 16, v140
    v_and_b32 v140, 0xffff0000, v140
    v_lshlrev_b32 v209, 16, v141
    v_and_b32 v141, 0xffff0000, v141
    v_lshlrev_b32 v210, 16, v142
    v_and_b32 v142, 0xffff0000, v142
    v_lshlrev_b32 v211, 16, v143
    v_and_b32 v143, 0xffff0000, v143
    v_lshlrev_b32 v212, 16, v144
    v_and_b32 v144, 0xffff0000, v144
    v_lshlrev_b32 v213, 16, v145
    v_and_b32 v145, 0xffff0000, v145
    v_lshlrev_b32 v214, 16, v146
    v_and_b32 v146, 0xffff0000, v146
    v_lshlrev_b32_e64 v215, 16, v147
    v_and_b32 v147, 0xffff0000, v147
    v_pk_mul_f32 v[240:241], v[240:241], v[208:209]
    v_pk_mul_f32 v[242:243], v[242:243], v[140:141]
    v_pk_mul_f32 v[244:245], v[244:245], v[210:211]
    v_pk_mul_f32 v[246:247], v[246:247], v[142:143]
    v_pk_mul_f32 v[248:249], v[248:249], v[212:213]
    v_pk_mul_f32 v[250:251], v[250:251], v[144:145]
    v_pk_mul_f32 v[252:253], v[252:253], v[214:215]
    v_pk_mul_f32 v[254:255], v[254:255], v[146:147]
    v_cvt_pk_bf16_f32 v224, v252, v248
    v_cvt_pk_bf16_f32 v225, v244, v240
    v_cvt_pk_bf16_f32 v226, v254, v250
    v_cvt_pk_bf16_f32 v227, v246, v242
    v_cvt_pk_bf16_f32 v228, v253, v249
    v_cvt_pk_bf16_f32 v229, v245, v241
    v_cvt_pk_bf16_f32 v230, v255, v251
    v_cvt_pk_bf16_f32 v231, v247, v243
    ds_write_b64 v203, v[224:225] offset:8192
    ds_write_b64 v203, v[226:227] offset:8320
    ds_write_b64 v203, v[228:229] offset:8448
    ds_write_b64 v203, v[230:231] offset:8576
    s_mul_i32 s84, s57, 24
    s_sub_u32 s78, s58, 28
    s_mul_i32 s78, s78, 6
    s_add_u32 s84, s84, s78
    s_add_u32 s84, s84, 448
    s_add_u32 s84, s84, s3
    s_mul_i32 s86, s3, 21248
    s_lshl_b32 s85, s84, 12
    s_add_u32 s44, s12, s85
    s_addc_u32 s45, s13, 0
    s_mov_b32 s46, 4096
    s_mov_b32 s47, 0x20000
    s_add_u32 s88, s85, 1048576
    v_lshlrev_b32_e64 v1, 4, v0
    buffer_load_dwordx4 v[32:35], v1, s[44:47], 0 offen offset:0 nt
    buffer_load_dwordx4 v[36:39], v1, s[44:47], 0 offen offset:1024 nt
    buffer_load_dwordx4 v[40:43], v1, s[44:47], 0 offen offset:2048 nt
    buffer_load_dwordx4 v[44:47], v1, s[44:47], 0 offen offset:3072 nt
    s_lshl_b32 s78, s57, 8
    s_lshl_b32 s79, s58, 3
    s_add_u32 s78, s78, s79
    s_lshl_b32 s79, s3, 1
    s_add_u32 s78, s78, s79
    v_lshrrev_b32 v196, 5, v0
    v_add_u32 v196, s78, v196
    v_and_b32 v197, 31, v0
    v_lshlrev_b32 v197, 3, v197
    v_mad_u32_u24 v197, v196, s73, v197
    v_lshlrev_b32 v196, 3, v196
    buffer_load_dwordx2 v[186:187], v197, s[32:35], 0 offen offset:0
    buffer_load_dwordx2 v[188:189], v197, s[32:35], 0 offen offset:256
    buffer_load_dwordx2 v[190:191], v197, s[32:35], 0 offen offset:512
    buffer_load_dwordx2 v[192:193], v197, s[32:35], 0 offen offset:768
    buffer_load_dwordx2 v[194:195], v197, s[32:35], 0 offen offset:1024
    s_mov_b32 s52, s22
    s_mov_b32 s53, s23
    s_mov_b32 s54, 2211840
    s_mov_b32 s55, 0x20000
    v_min_u32 v29, ((DONE-I_LATE+511)/512)-1, v0
    s_mul_i32 s80, s3, ((DONE-I_LATE+511)/512)
    v_add_u32 v29, s80, v29
    v_lshlrev_b32 v29, 7, v29
    s_getpc_b64 s[80:81]
CT_20:
    v_add_u32 v29, I_LATE-CT_20, v29
    s_mov_b32 s82, CODE_END-CT_20
    s_mov_b32 s83, 0x20000
    buffer_load_dword v29, v29, s[80:83], 0 offen
    s_and_b32 s77, s58, 7
    s_lshl_b32 s78, s57, 2
    s_lshr_b32 s79, s58, 3
    s_add_u32 s78, s78, s79
    s_mul_i32 s77, s77, 54
    s_add_u32 s77, s77, s78
    s_mul_i32 s77, s77, 5120
    s_add_u32 s77, s77, 4194304
    v_lshrrev_b32 v24, 4, v0
    v_bfe_u32 v25, v0, 2, 2
    v_lshl_add_u32 v24, v24, 2, v25
    v_mul_u32_u24 v24, 160, v24
    v_and_b32 v25, 3, v0
    s_add_u32 s79, s3, 0
    s_cmp_ge_u32 s79, 5
    s_cselect_b32 s80, 1, 0
    s_mul_i32 s81, s80, 5
    s_sub_u32 s79, s79, s81
    s_mul_i32 s81, s80, 163840
    s_add_u32 s81, s81, s77
    s_lshl_b32 s82, s79, 10
    s_add_u32 s81, s81, s82
    s_cmp_ge_u32 s78, 22
    s_cselect_b32 s82, s80, 0
    s_cmp_ge_u32 s79, 5
    s_cselect_b32 s82, 1, s82
    s_cmp_lg_u32 s82, 0
    s_cselect_b32 s74, 17563648, s81
    s_min_u32 s79, s79, 4
    s_and_b32 s82, s79, 1
    s_lshl_b32 s82, s82, 3
    s_lshr_b32 s83, s79, 1
    s_lshl_b32 s83, s83, 6
    s_add_u32 s82, s82, s83
    s_mul_i32 s83, s80, 5120
    s_add_u32 s82, s82, s83
    s_add_u32 s82, s82, 114688
    s_cmp_eq_u32 s79, 4
    s_cselect_b32 s83, 3, 4
    v_lshlrev_b32 v200, s83, v25
    v_add3_u32 v200, v200, v24, s82
    s_add_u32 s79, s3, 4
    s_cmp_ge_u32 s79, 5
    s_cselect_b32 s80, 1, 0
    s_mul_i32 s81, s80, 5
    s_sub_u32 s79, s79, s81
    s_mul_i32 s81, s80, 163840
    s_add_u32 s81, s81, s77
    s_lshl_b32 s82, s79, 10
    s_add_u32 s81, s81, s82
    s_cmp_ge_u32 s78, 22
    s_cselect_b32 s82, s80, 0
    s_cmp_ge_u32 s79, 5
    s_cselect_b32 s82, 1, s82
    s_cmp_lg_u32 s82, 0
    s_cselect_b32 s75, 17563648, s81
    s_min_u32 s79, s79, 4
    s_and_b32 s82, s79, 1
    s_lshl_b32 s82, s82, 3
    s_lshr_b32 s83, s79, 1
    s_lshl_b32 s83, s83, 6
    s_add_u32 s82, s82, s83
    s_mul_i32 s83, s80, 5120
    s_add_u32 s82, s82, s83
    s_add_u32 s82, s82, 114688
    s_cmp_eq_u32 s79, 4
    s_cselect_b32 s83, 3, 4
    v_lshlrev_b32 v201, s83, v25
    v_add3_u32 v201, v201, v24, s82
    s_add_u32 s79, s3, 8
    s_cmp_ge_u32 s79, 5
    s_cselect_b32 s80, 1, 0
    s_mul_i32 s81, s80, 5
    s_sub_u32 s79, s79, s81
    s_mul_i32 s81, s80, 163840
    s_add_u32 s81, s81, s77
    s_lshl_b32 s82, s79, 10
    s_add_u32 s81, s81, s82
    s_cmp_ge_u32 s78, 22
    s_cselect_b32 s82, s80, 0
    s_cmp_ge_u32 s79, 5
    s_cselect_b32 s82, 1, s82
    s_cmp_lg_u32 s82, 0
    s_cselect_b32 s76, 17563648, s81
    s_min_u32 s79, s79, 4
    s_and_b32 s82, s79, 1
    s_lshl_b32 s82, s82, 3
    s_lshr_b32 s83, s79, 1
    s_lshl_b32 s83, s83, 6
    s_add_u32 s82, s82, s83
    s_mul_i32 s83, s80, 5120
    s_add_u32 s82, s82, s83
    s_add_u32 s82, s82, 114688
    s_cmp_eq_u32 s79, 4
    s_cselect_b32 s83, 3, 4
    v_lshlrev_b32 v202, s83, v25
    v_add3_u32 v202, v202, v24, s82
    s_waitcnt vmcnt(14)
    v_lshlrev_b32 v224, 16, v178
    v_and_b32 v228, 0xffff0000, v178
    v_lshlrev_b32 v225, 16, v182
    v_and_b32 v229, 0xffff0000, v182
    v_lshlrev_b32 v226, 16, v180
    v_and_b32 v230, 0xffff0000, v180
    v_lshlrev_b32 v227, 16, v184
    v_and_b32 v231, 0xffff0000, v184
    v_lshlrev_b32 v232, 16, v179
    v_and_b32 v236, 0xffff0000, v179
    v_lshlrev_b32 v233, 16, v183
    v_and_b32 v237, 0xffff0000, v183
    v_lshlrev_b32 v234, 16, v181
    v_and_b32 v238, 0xffff0000, v181
    v_lshlrev_b32 v235, 16, v185
    v_and_b32 v239, 0xffff0000, v185
    v_lshlrev_b32 v208, 16, v156
    v_and_b32 v156, 0xffff0000, v156
    v_lshlrev_b32 v209, 16, v157
    v_and_b32 v157, 0xffff0000, v157
    v_lshlrev_b32 v210, 16, v158
    v_and_b32 v158, 0xffff0000, v158
    v_lshlrev_b32 v211, 16, v159
    v_and_b32 v159, 0xffff0000, v159
    v_lshlrev_b32 v212, 16, v160
    v_and_b32 v160, 0xffff0000, v160
    v_lshlrev_b32 v213, 16, v161
    v_and_b32 v161, 0xffff0000, v161
    v_lshlrev_b32 v214, 16, v162
    v_and_b32 v162, 0xffff0000, v162
    v_lshlrev_b32 v215, 16, v163
    v_and_b32 v163, 0xffff0000, v163
    v_lshlrev_b32 v216, 16, v164
    v_and_b32 v164, 0xffff0000, v164
    v_lshlrev_b32 v217, 16, v165
    v_and_b32 v165, 0xffff0000, v165
    v_lshlrev_b32 v218, 16, v166
    v_and_b32 v166, 0xffff0000, v166
    v_lshlrev_b32 v219, 16, v167
    v_and_b32 v167, 0xffff0000, v167
    v_lshlrev_b32 v220, 16, v168
    v_and_b32 v168, 0xffff0000, v168
    v_lshlrev_b32_e64 v221, 16, v169
    v_and_b32 v169, 0xffff0000, v169
    v_pk_mul_f32 v[240:241], v[214:215], v[224:225]
    v_pk_mul_f32 v[242:243], v[162:163], v[226:227]
    v_pk_mul_f32 v[244:245], v[216:217], v[224:225]
    v_pk_mul_f32 v[246:247], v[164:165], v[226:227]
    v_pk_mul_f32 v[248:249], v[218:219], v[224:225]
    v_pk_mul_f32 v[250:251], v[166:167], v[226:227]
    v_pk_mul_f32 v[252:253], v[220:221], v[224:225]
    v_pk_mul_f32 v[254:255], v[168:169], v[226:227]
    v_pk_fma_f32 v[240:241], v[212:213], v[228:229], v[240:241]
    v_pk_fma_f32 v[242:243], v[160:161], v[230:231], v[242:243]
    v_pk_fma_f32 v[244:245], v[214:215], v[228:229], v[244:245]
    v_pk_fma_f32 v[246:247], v[162:163], v[230:231], v[246:247]
    v_pk_fma_f32 v[248:249], v[216:217], v[228:229], v[248:249]
    v_pk_fma_f32 v[250:251], v[164:165], v[230:231], v[250:251]
    v_pk_fma_f32 v[252:253], v[218:219], v[228:229], v[252:253]
    v_pk_fma_f32 v[254:255], v[166:167], v[230:231], v[254:255]
    v_pk_fma_f32 v[240:241], v[210:211], v[232:233], v[240:241]
    v_pk_fma_f32 v[242:243], v[158:159], v[234:235], v[242:243]
    v_pk_fma_f32 v[244:245], v[212:213], v[232:233], v[244:245]
    v_pk_fma_f32 v[246:247], v[160:161], v[234:235], v[246:247]
    v_pk_fma_f32 v[248:249], v[214:215], v[232:233], v[248:249]
    v_pk_fma_f32 v[250:251], v[162:163], v[234:235], v[250:251]
    v_pk_fma_f32 v[252:253], v[216:217], v[232:233], v[252:253]
    v_pk_fma_f32 v[254:255], v[164:165], v[234:235], v[254:255]
    v_pk_fma_f32 v[240:241], v[208:209], v[236:237], v[240:241]
    v_pk_fma_f32 v[242:243], v[156:157], v[238:239], v[242:243]
    v_pk_fma_f32 v[244:245], v[210:211], v[236:237], v[244:245]
    v_pk_fma_f32 v[246:247], v[158:159], v[238:239], v[246:247]
    v_pk_fma_f32 v[248:249], v[212:213], v[236:237], v[248:249]
    v_pk_fma_f32 v[250:251], v[160:161], v[238:239], v[250:251]
    v_pk_fma_f32 v[252:253], v[214:215], v[236:237], v[252:253]
    v_pk_fma_f32 v[254:255], v[162:163], v[238:239], v[254:255]
    s_waitcnt vmcnt(10)
    v_lshlrev_b32 v208, 16, v170
    v_and_b32 v170, 0xffff0000, v170
    v_lshlrev_b32 v209, 16, v171
    v_and_b32 v171, 0xffff0000, v171
    v_lshlrev_b32 v210, 16, v172
    v_and_b32 v172, 0xffff0000, v172
    v_lshlrev_b32 v211, 16, v173
    v_and_b32 v173, 0xffff0000, v173
    v_lshlrev_b32 v212, 16, v174
    v_and_b32 v174, 0xffff0000, v174
    v_lshlrev_b32 v213, 16, v175
    v_and_b32 v175, 0xffff0000, v175
    v_lshlrev_b32 v214, 16, v176
    v_and_b32 v176, 0xffff0000, v176
    v_lshlrev_b32_e64 v215, 16, v177
    v_and_b32 v177, 0xffff0000, v177
    v_pk_mul_f32 v[240:241], v[240:241], v[208:209]
    v_pk_mul_f32 v[242:243], v[242:243], v[170:171]
    v_pk_mul_f32 v[244:245], v[244:245], v[210:211]
    v_pk_mul_f32 v[246:247], v[246:247], v[172:173]
    v_pk_mul_f32 v[248:249], v[248:249], v[212:213]
    v_pk_mul_f32 v[250:251], v[250:251], v[174:175]
    v_pk_mul_f32 v[252:253], v[252:253], v[214:215]
    v_pk_mul_f32 v[254:255], v[254:255], v[176:177]
    v_cvt_pk_bf16_f32 v224, v252, v248
    v_cvt_pk_bf16_f32 v225, v244, v240
    v_cvt_pk_bf16_f32 v226, v254, v250
    v_cvt_pk_bf16_f32 v227, v246, v242
    v_cvt_pk_bf16_f32 v228, v253, v249
    v_cvt_pk_bf16_f32 v229, v245, v241
    v_cvt_pk_bf16_f32 v230, v255, v251
    v_cvt_pk_bf16_f32 v231, v247, v243
    ds_write_b64 v203, v[224:225] offset:16384
    ds_write_b64 v203, v[226:227] offset:16512
PAGE7:
    s_cbranch_execz PAGE8
    ds_write_b64 v203, v[228:229] offset:16640
    ds_write_b64 v203, v[230:231] offset:16768
    s_waitcnt lgkmcnt(0)
    s_barrier
    s_nop 0
    ds_read_b128 v[208:211], v204 offset:0
    ds_read_b128 v[212:215], v204 offset:4096
    ds_read_b128 v[216:219], v204 offset:8192
    ds_read_b128 v[220:223], v204 offset:12288
    ds_read_b128 v[224:227], v204 offset:16384
    ds_read_b128 v[228:231], v204 offset:20480
    s_waitcnt lgkmcnt(4)
    buffer_store_dwordx4 v[208:211], v205, s[36:39], s59 offen sc1
    buffer_store_dwordx4 v[212:215], v206, s[36:39], s59 offen sc1
    s_add_u32 s59, s59, 262144
    s_waitcnt lgkmcnt(2)
    buffer_store_dwordx4 v[216:219], v205, s[36:39], s59 offen sc1
    buffer_store_dwordx4 v[220:223], v206, s[36:39], s59 offen sc1
    s_add_u32 s59, s59, 262144
    s_waitcnt lgkmcnt(0)
    buffer_store_dwordx4 v[224:227], v205, s[36:39], s59 offen sc1
    buffer_store_dwordx4 v[228:231], v206, s[36:39], s59 offen sc1
    s_add_u32 s59, s59, 262144
    s_waitcnt vmcnt(7)
    s_mov_b32 s78, 0x3f803f80
    v_mov_b32_e64 v232, 0
    v_mov_b32 v233, 0
    v_dot2c_f32_bf16 v232, s78, v186
    v_dot2c_f32_bf16 v233, v186, v186
    v_dot2c_f32_bf16 v232, s78, v187
    v_dot2c_f32_bf16 v233, v187, v187
    v_dot2c_f32_bf16 v232, s78, v188
    v_dot2c_f32_bf16 v233, v188, v188
    v_dot2c_f32_bf16 v232, s78, v189
    v_dot2c_f32_bf16 v233, v189, v189
    v_dot2c_f32_bf16 v232, s78, v190
    v_dot2c_f32_bf16 v233, v190, v190
    v_dot2c_f32_bf16 v232, s78, v191
    v_dot2c_f32_bf16 v233, v191, v191
    v_dot2c_f32_bf16 v232, s78, v192
    v_dot2c_f32_bf16 v233, v192, v192
    v_dot2c_f32_bf16 v232, s78, v193
    v_dot2c_f32_bf16 v233, v193, v193
    v_dot2c_f32_bf16 v232, s78, v194
    v_dot2c_f32_bf16 v233, v194, v194
    v_dot2c_f32_bf16 v232, s78, v195
    v_dot2c_f32_bf16 v233, v195, v195
    s_nop 1
    v_add_f32_dpp v232, v232, v232 row_ror:8 row_mask:0xf bank_mask:0xf
    v_add_f32_dpp v233, v233, v233 row_ror:8 row_mask:0xf bank_mask:0xf
    s_nop 1
    v_add_f32_dpp v232, v232, v232 row_ror:4 row_mask:0xf bank_mask:0xf
    v_add_f32_dpp v233, v233, v233 row_ror:4 row_mask:0xf bank_mask:0xf
    s_nop 1
    v_add_f32_dpp v232, v232, v232 row_ror:2 row_mask:0xf bank_mask:0xf
    v_add_f32_dpp v233, v233, v233 row_ror:2 row_mask:0xf bank_mask:0xf
    s_nop 1
    v_add_f32_dpp v232, v232, v232 row_ror:1 row_mask:0xf bank_mask:0xf
    v_add_f32_dpp v233, v233, v233 row_ror:1 row_mask:0xf bank_mask:0xf
    s_nop 1
    v_add_f32_dpp v232, v232, v232 row_bcast:15 row_mask:0xa bank_mask:0xf
    v_add_f32_dpp v233, v233, v233 row_bcast:15 row_mask:0xa bank_mask:0xf
    s_nop 0
    v_mul_f32 v234, 0x3acccccd, v232
    v_mul_f32 v233, 0x3acccccd, v233
    v_fma_f32 v233, -v234, v234, v233
    v_max_f32 v233, 0, v233
    v_add_f32 v233, 0x3727c5ac, v233
    v_rsq_f32_e64 v235, v233
    s_mov_b32 s78, 65536
    s_mov_b32 exec_lo, 0x10000
    s_mov_b32 exec_hi, 0x10000
    buffer_store_dwordx2 v[234:235], v196, s[36:39], s78 offen sc1
    s_mov_b64 exec, -1
    s_waitcnt vmcnt(1)
    s_barrier
    s_mov_b32 exec_lo, 2
    s_mov_b32 exec_hi, 0
    buffer_store_dword v31, v30, s[36:39], 0 offen sc1
    s_mov_b64 exec, -1
    s_lshl_b32 s81, s3, 10
    s_add_u32 m0, s81, 114688
    s_nop 0
    buffer_load_dwordx4 v80, s[52:55], 0 offen nt lds
    s_add_u32 m0, s81, 118784
    s_nop 0
    buffer_load_dwordx4 v81, s[52:55], 0 offen nt lds
    s_add_u32 m0, s81, 122880
    s_nop 0
    buffer_load_dwordx4 v82, s[52:55], 0 offen nt lds
    s_waitcnt vmcnt(17)
I_LATE:
    s_nop 0
    v_mov_b32_dpp v51, v36 wave_rol:1 row_mask:0xf bank_mask:0xf
    v_mov_b32_dpp v64, v37 wave_rol:1 row_mask:0xf bank_mask:0xf
    v_mov_b32_dpp v55, v40 wave_rol:1 row_mask:0xf bank_mask:0xf
    v_mov_b32_dpp v65, v41 wave_rol:1 row_mask:0xf bank_mask:0xf
    v_mov_b32_dpp v59, v44 wave_rol:1 row_mask:0xf bank_mask:0xf
    v_mov_b32_dpp v66, v45 wave_rol:1 row_mask:0xf bank_mask:0xf
    v_mov_b32 v48, v33
    v_mov_b32 v49, v34
    v_mov_b32 v50, v35
    v_mov_b32 v52, v37
    v_mov_b32 v53, v38
    v_mov_b32 v54, v39
    v_mov_b32 v56, v41
    v_mov_b32 v57, v42
    v_mov_b32 v58, v43
    v_mov_b32 v60, v45
    v_mov_b32 v61, v46
    v_mov_b32 v62, v47
    v_mov_b32_dpp v51, v32 wave_shl:1 row_mask:0xf bank_mask:0xf
    v_mov_b32_dpp v64, v33 wave_shl:1 row_mask:0xf bank_mask:0xf
    v_mov_b32_dpp v55, v36 wave_shl:1 row_mask:0xf bank_mask:0xf
    v_mov_b32_dpp v65, v37 wave_shl:1 row_mask:0xf bank_mask:0xf
    v_mov_b32_dpp v59, v40 wave_shl:1 row_mask:0xf bank_mask:0xf
    v_mov_b32_dpp v66, v41 wave_shl:1 row_mask:0xf bank_mask:0xf
    v_mov_b32_dpp v63, v44 wave_shl:1 row_mask:0xf bank_mask:0xf bound_ctrl:0
    v_mov_b32_dpp v67, v45 wave_shl:1 row_mask:0xf bank_mask:0xf bound_ctrl:0
    s_nop 1
    v_lshlrev_b32 v1, 4, v0
    v_add_u32 v5, s86, v1
    v_mov_b32 v20, 0
    v_mov_b32 v21, 0
    v_mov_b32 v22, 0
    v_mov_b32 v23, 0
    v_lshrrev_b32 v4, 1, v0
    v_mul_u32_u24 v4, 4160, v4
    v_and_b32 v6, 1, v0
    v_lshl_add_u32 v4, v6, 4, v4
    v_add_u32 v4, s86, v4
    s_mov_b32 exec_lo, 0xff
    s_mov_b32 exec_hi, 0
    ds_write_b128 v4, v[20:23]
    s_mov_b32 exec_lo, -1
    ds_write_b128 v5, v[20:23] offset:16640
    v_lshlrev_b32 v12, 16, v32
    v_alignbit_b32 v13, v48, v32, 16
    s_mov_b32 exec_lo, 1
    ds_write_b32 v5, v12 offset:4188
    ds_write_b32 v5, v32 offset:8348
    ds_write_b64 v5, v[12:13] offset:12504
    s_mov_b64 exec, -1
    s_nop 0
    v_alignbit_b32 v96, v48, v32, 16
    v_alignbit_b32 v100, v49, v48, 16
    v_alignbit_b32 v97, v49, v33, 16
    v_alignbit_b32 v101, v50, v49, 16
    v_alignbit_b32 v98, v50, v34, 16
    v_alignbit_b32 v102, v51, v50, 16
    v_alignbit_b32 v99, v51, v35, 16
    v_alignbit_b32 v103, v64, v51, 16
    ds_write_b128 v5, v[32:35] offset:32
    ds_write_b128 v5, v[96:99] offset:4192
    ds_write_b128 v5, v[48:51] offset:8352
    ds_write_b128 v5, v[100:103] offset:12512
    v_alignbit_b32 v104, v52, v36, 16
    v_alignbit_b32 v108, v53, v52, 16
    v_alignbit_b32 v105, v53, v37, 16
    v_alignbit_b32 v109, v54, v53, 16
    v_alignbit_b32 v106, v54, v38, 16
    v_alignbit_b32 v110, v55, v54, 16
    v_alignbit_b32 v107, v55, v39, 16
    v_alignbit_b32 v111, v65, v55, 16
    ds_write_b128 v5, v[36:39] offset:1056
    ds_write_b128 v5, v[104:107] offset:5216
    ds_write_b128 v5, v[52:55] offset:9376
    ds_write_b128 v5, v[108:111] offset:13536
    v_alignbit_b32 v112, v56, v40, 16
    v_alignbit_b32 v116, v57, v56, 16
    v_alignbit_b32 v113, v57, v41, 16
    v_alignbit_b32 v117, v58, v57, 16
    v_alignbit_b32 v114, v58, v42, 16
    v_alignbit_b32 v118, v59, v58, 16
    v_alignbit_b32 v115, v59, v43, 16
    v_alignbit_b32 v119, v66, v59, 16
    ds_write_b128 v5, v[40:43] offset:2080
    ds_write_b128 v5, v[112:115] offset:6240
    ds_write_b128 v5, v[56:59] offset:10400
    ds_write_b128 v5, v[116:119] offset:14560
    v_alignbit_b32 v120, v60, v44, 16
    v_alignbit_b32 v124, v61, v60, 16
    v_alignbit_b32 v121, v61, v45, 16
    v_alignbit_b32 v125, v62, v61, 16
    v_alignbit_b32 v122, v62, v46, 16
    v_alignbit_b32 v126, v63, v62, 16
    v_alignbit_b32 v123, v63, v47, 16
    v_alignbit_b32 v127, v67, v63, 16
    ds_write_b128 v5, v[44:47] offset:3104
    ds_write_b128 v5, v[120:123] offset:7264
    ds_write_b128 v5, v[60:63] offset:11424
    ds_write_b128 v5, v[124:127] offset:15584
    s_lshl_b32 s78, s84, 1
    s_and_b32 s78, s78, -4
    s_load_dword s77, s[14:15], s78
    s_lshr_b32 s78, s57, 1
    s_lshl_b32 s78, s78, 3
    s_and_b32 s79, s58, 7
    s_add_u32 s53, s78, s79
    s_mul_i32 s28, s79, 7
    s_and_b32 s78, s57, 1
    s_lshl_b32 s78, s78, 2
    s_lshr_b32 s79, s58, 3
    s_add_u32 s54, s78, s79
    s_mul_i32 s79, s79, 14
    s_add_u32 s28, s28, s79
    s_lshr_b32 s28, s28, 2
    s_cmp_ge_u32 s28, 14
    s_cselect_b32 s79, 14, 0
    s_sub_u32 s28, s28, s79
    s_mov_b32 s28, 0
    s_mul_i32 s55, s3, 14
    s_sub_u32 s79, s3, 1
    s_cmp_ge_u32 s3, 2
    s_cselect_b32 s79, s79, 0
    s_sub_u32 s55, s55, s79
    s_mul_i32 s79, s54, 54
    s_add_u32 s79, s79, s55
    s_mul_i32 s79, s79, 5120
    s_add_u32 s79, s79, 4194304
    s_add_u32 s16, s79, 71680
    s_mul_i32 s52, s28, 5120
    s_add_u32 s52, s52, s79
    v_lshlrev_b32 v14, 4, v0
    v_add_u32 v15, 4096, v14
    s_mov_b32 s40, s24
    s_mov_b32 s41, s25
    s_mov_b32 s42, 1280
    s_mov_b32 s43, 0x20000
    v_lshrrev_b32 v16, 4, v0
    s_mul_i32 s78, s54, 160
    v_lshlrev_b32 v17, 4, v16
    v_lshlrev_b32 v18, 3, v16
    buffer_load_dwordx4 a[240:243], v17, s[40:43], s78 offen
    buffer_load_dwordx4 a[244:247], v17, s[40:43], s78 offen offset:64
    buffer_load_dwordx2 a[248:249], v18, s[40:43], s78 offen offset:128
    s_mov_b32 s68, 7
    v_and_b32 v27, 31, v0
    v_lshlrev_b32 v27, 6, v27
    s_lshl_b32 s73, s68, 11
    s_add_u32 s73, s73, 131072
    s_lshl_b32 s78, s54, 11
    s_add_u32 s78, s78, 163840
    v_mov_b32 v16, s73
    v_mov_b32 v18, s78
    v_and_b32 v19, 32, v0
    v_cmp_eq_u32 vcc, 0, v19
    s_nop 1
    v_cndmask_b32 v16, v18, v16, vcc
    v_add_u32 v27, v16, v27
    buffer_load_dword v24, v27, s[36:39], 0 offen sc1
    s_waitcnt vmcnt(4)
    s_barrier
    s_mov_b32 exec_lo, 1
    s_mov_b32 exec_hi, 0
    buffer_store_dword v31, v30, s[36:39], 0 offen sc1
    s_mov_b64 exec, -1
    s_nop 0
    ds_read_b64_tr_b16 v[236:237], v200 offset:0
    ds_read_b64_tr_b16 v[238:239], v200 offset:2560
    ds_read_b64_tr_b16 v[240:241], v201 offset:0
    ds_read_b64_tr_b16 v[242:243], v201 offset:2560
    ds_read_b64_tr_b16 v[244:245], v202 offset:0
    ds_read_b64_tr_b16 v[246:247], v202 offset:2560
    v_lshlrev_b32 v26, 4, v0
    s_waitcnt lgkmcnt(0)
    buffer_store_dwordx4 v[236:239], v26, s[36:39], s74 offen sc1
    buffer_store_dwordx4 v[240:243], v26, s[36:39], s75 offen sc1
    buffer_store_dwordx4 v[244:247], v26, s[36:39], s76 offen sc1
    s_mov_b32 s50, -1
    s_mov_b32 s51, 0
    s_waitcnt vmcnt(4)
    v_cmp_ne_u32 vcc, s56, v24
    s_mov_b64 s[82:83], vcc
    s_and_b64 s[82:83], s[82:83], s[50:51]
    s_cmp_eq_u64 s[82:83], 0
    s_cbranch_scc0 FAI_RETRY_21
FAI_DONE_22:
    v_lshlrev_b32_e64 v1, 4, v0
    buffer_load_dwordx4 v[80:83], v1, s[36:39], s88 offen offset:0 sc1
    buffer_load_dwordx4 v[84:87], v1, s[36:39], s88 offen offset:1024 sc1
    buffer_load_dwordx4 v[88:91], v1, s[36:39], s88 offen offset:2048 sc1
    buffer_load_dwordx4 v[92:95], v1, s[36:39], s88 offen offset:3072 sc1
    s_waitcnt lgkmcnt(0)
    v_and_b32 v6, 15, v0
    v_lshrrev_b32 v7, 4, v0
    v_add_u32 v8, 1, v6
    v_and_b32 v9, 3, v8
    v_and_b32 v8, 28, v8
    v_mul_u32_u24 v9, 4160, v9
    v_lshl_add_u32 v9, v8, 1, v9
    v_lshl_add_u32 v9, v7, 4, v9
    v_add_u32 v2, s86, v9
    v_lshlrev_b32 v8, 1, v6
    v_sub_u32 v8, v8, v7
    v_lshlrev_b32 v8, 4, v8
    v_add_u32 v8, 16720, v8
    v_add_u32 v3, s86, v8
    v_sub_u32 v8, 15, v6
    v_lshrrev_b32_e64 v9, 3, v8
    v_cmp_eq_u32 s[80:81], v9, v7
    v_bfe_u32 v9, v8, 1, 2
    v_and_b32 v10, 1, v8
    v_lshlrev_b32 v10, 4, v10
    s_and_b32 s78, s84, 1
    s_lshl_b32 s78, s78, 4
    s_lshr_b32 s77, s77, s78
    s_and_b32 s77, s77, 0xffff
    v_mov_b32 v11, s77
    v_lshlrev_b32 v11, v10, v11
    v_cndmask_b32 v11, 0, v11, s[80:81]
    v_cmp_eq_u32 vcc, 0, v9
    s_nop 1
    v_cndmask_b32 v192, 0, v11, vcc
    v_cmp_eq_u32 vcc, 1, v9
    s_nop 1
    v_cndmask_b32 v193, 0, v11, vcc
    v_cmp_eq_u32 vcc, 2, v9
    s_nop 1
    v_cndmask_b32 v194, 0, v11, vcc
    v_cmp_eq_u32 vcc, 3, v9
    s_nop 1
    v_cndmask_b32 v195, 0, v11, vcc
    s_waitcnt vmcnt(4)
    s_barrier
    s_mov_b32 exec_lo, 4
    s_mov_b32 exec_hi, 0
    buffer_store_dword v31, v30, s[36:39], 0 offen sc1
    s_mov_b64 exec, -1
    s_waitcnt vmcnt(1)
    v_lshlrev_b32 v1, 4, v0
    v_add_u32_e64 v5, s86, v1
    ds_write_b128 v5, v[80:83] offset:17152
    ds_write_b128 v5, v[84:87] offset:18176
    ds_write_b128 v5, v[88:91] offset:19200
    ds_write_b128 v5, v[92:95] offset:20224
    s_add_u32 s18, s85, 7340032
    s_sub_u32 s84, s84, s3
    s_lshl_b32 s48, s84, 5
    s_add_u32 s48, s48, 262144
    s_cmp_eq_u32 s3, 0
    s_cselect_b32 s48, s48, 17563648
    s_mov_b32 s50, 3
    s_add_u32 s84, s84, 4
    s_lshr_b32 s78, s3, 1
    s_add_u32 s84, s84, s78
    s_and_b32 s87, s3, 1
    s_mul_i32 s86, s78, 21248
    s_lshl_b32 s85, s84, 12
    s_add_u32 s44, s12, s85
    s_addc_u32 s45, s13, 0
    s_mov_b32 s46, 4096
    s_mov_b32 s47, 0x20000
    s_lshl_b32 s89, s87, 11
    s_add_u32 s88, s85, s89
    s_add_u32 s88, s88, 1048576
    s_lshl_b32 s78, s84, 1
    s_and_b32 s78, s78, -4
    s_load_dword s77, s[14:15], s78
    s_waitcnt lgkmcnt(0)
    ds_read_b128 v[64:67], v3 offset:448
    ds_read_b64 v[32:33], v2 offset:0
    ds_read_b64 v[34:35], v2 offset:8
    ds_read_b128 v[68:71], v3 offset:960
    ds_read_b64 v[36:37], v2 offset:512
    ds_read_b64 v[38:39], v2 offset:520
    ds_read_b128 v[72:75], v3 offset:1472
    ds_read_b64 v[40:41], v2 offset:1024
    ds_read_b64 v[42:43], v2 offset:1032
    ds_read_b128 v[76:79], v3 offset:1984
    ds_read_b64 v[44:45], v2 offset:1536
    ds_read_b64 v[46:47], v2 offset:1544
    ds_read_b128 v[80:83], v3 offset:2496
    ds_read_b64 v[48:49], v2 offset:2048
    ds_read_b64 v[50:51], v2 offset:2056
    ds_read_b128 v[84:87], v3 offset:3008
    ds_read_b64 v[52:53], v2 offset:2560
    ds_read_b64 v[54:55], v2 offset:2568
    ds_read_b128 v[88:91], v3 offset:3520
    ds_read_b64 v[56:57], v2 offset:3072
    ds_read_b64 v[58:59], v2 offset:3080
    ds_read_b128 v[92:95], v3 offset:4032
    ds_read_b64 v[60:61], v2 offset:3584
    ds_read_b64 v[62:63], v2 offset:3592
    s_waitcnt lgkmcnt(15)
    v_mfma_f32_16x16x32_bf16 v[160:163], v[192:195], v[64:67], 0
    ds_read_b128 v[128:131], v3 offset:384
    v_mfma_f32_16x16x32_bf16 v[164:167], v[192:195], v[68:71], 0
    ds_read_b64 v[96:97], v2 offset:64
    v_mfma_f32_16x16x32_bf16 v[168:171], v[192:195], v[72:75], 0
    ds_read_b64 v[98:99], v2 offset:72
    s_waitcnt lgkmcnt(15)
    v_mfma_f32_16x16x32_bf16 v[172:175], v[192:195], v[76:79], 0
    ds_read_b128 v[132:135], v3 offset:896
    s_waitcnt lgkmcnt(15)
    v_mfma_f32_16x16x32_bf16 v[176:179], v[192:195], v[80:83], 0
    ds_read_b64 v[100:101], v2 offset:576
    buffer_load_dwordx4 v[200:203], v14, s[44:47], s89 offen offset:0 nt
    s_waitcnt lgkmcnt(13)
    v_mfma_f32_16x16x32_bf16 v[180:183], v[192:195], v[84:87], 0
    ds_read_b64 v[102:103], v2 offset:584
    s_waitcnt lgkmcnt(11)
    v_mfma_f32_16x16x32_bf16 v[184:187], v[192:195], v[88:91], 0
    ds_read_b128 v[136:139], v3 offset:1408
    s_waitcnt lgkmcnt(9)
    v_mfma_f32_16x16x32_bf16 v[188:191], v[192:195], v[92:95], 0
    ds_read_b64 v[104:105], v2 offset:1088
    s_waitcnt lgkmcnt(8)
    s_nop 0
    v_mfma_f32_16x16x32_bf16 v[160:163], v[32:35], v[64:67], v[160:163]
    ds_read_b64 v[106:107], v2 offset:1096
    v_mfma_f32_16x16x32_bf16 v[164:167], v[32:35], v[68:71], v[164:167]
    ds_read_b128 v[140:143], v3 offset:1920
    v_mfma_f32_16x16x32_bf16 v[168:171], v[32:35], v[72:75], v[168:171]
    ds_read_b64 v[108:109], v2 offset:1600
    v_mfma_f32_16x16x32_bf16 v[172:175], v[32:35], v[76:79], v[172:175]
    ds_read_b64 v[110:111], v2 offset:1608
    v_mfma_f32_16x16x32_bf16 v[176:179], v[32:35], v[80:83], v[176:179]
    ds_read_b128 v[144:147], v3 offset:2432
    v_mfma_f32_16x16x32_bf16 v[180:183], v[32:35], v[84:87], v[180:183]
    ds_read_b64 v[112:113], v2 offset:2112
    buffer_load_dwordx4 v[204:207], v14, s[44:47], s89 offen offset:1024 nt
    v_mfma_f32_16x16x32_bf16 v[184:187], v[32:35], v[88:91], v[184:187]
    ds_read_b64 v[114:115], v2 offset:2120
    v_mfma_f32_16x16x32_bf16 v[188:191], v[32:35], v[92:95], v[188:191]
    ds_read_b128 v[148:151], v3 offset:2944
    v_mfma_f32_16x16x32_bf16 v[164:167], v[36:39], v[64:67], v[164:167]
    ds_read_b64 v[116:117], v2 offset:2624
    v_mfma_f32_16x16x32_bf16 v[168:171], v[36:39], v[68:71], v[168:171]
    ds_read_b64 v[118:119], v2 offset:2632
    v_mfma_f32_16x16x32_bf16 v[172:175], v[36:39], v[72:75], v[172:175]
    ds_read_b128 v[152:155], v3 offset:3456
    v_mfma_f32_16x16x32_bf16 v[176:179], v[36:39], v[76:79], v[176:179]
    ds_read_b64 v[120:121], v2 offset:3136
    v_mfma_f32_16x16x32_bf16 v[180:183], v[36:39], v[80:83], v[180:183]
    ds_read_b64 v[122:123], v2 offset:3144
    v_mfma_f32_16x16x32_bf16 v[184:187], v[36:39], v[84:87], v[184:187]
    ds_read_b128 v[156:159], v3 offset:3968
    v_mfma_f32_16x16x32_bf16 v[188:191], v[36:39], v[88:91], v[188:191]
    ds_read_b64 v[124:125], v2 offset:3648
    buffer_load_dwordx2 v[220:221], v14, s[44:47], s89 offen offset:2048 nt
    v_mfma_f32_16x16x32_bf16 v[168:171], v[40:43], v[64:67], v[168:171]
    ds_read_b64 v[126:127], v2 offset:3656
    v_mfma_f32_16x16x32_bf16 v[172:175], v[40:43], v[68:71], v[172:175]
    v_mfma_f32_16x16x32_bf16 v[176:179], v[40:43], v[72:75], v[176:179]
    v_mfma_f32_16x16x32_bf16 v[180:183], v[40:43], v[76:79], v[180:183]
    v_mfma_f32_16x16x32_bf16 v[184:187], v[40:43], v[80:83], v[184:187]
    v_mfma_f32_16x16x32_bf16 v[188:191], v[40:43], v[84:87], v[188:191]
    v_mfma_f32_16x16x32_bf16 v[172:175], v[44:47], v[64:67], v[172:175]
    v_mfma_f32_16x16x32_bf16 v[176:179], v[44:47], v[68:71], v[176:179]
    buffer_load_dwordx4 v[224:227], v14, s[36:39], s88 offen offset:0 sc1
    v_mfma_f32_16x16x32_bf16 v[180:183], v[44:47], v[72:75], v[180:183]
    v_mfma_f32_16x16x32_bf16 v[184:187], v[44:47], v[76:79], v[184:187]
    v_mfma_f32_16x16x32_bf16 v[188:191], v[44:47], v[80:83], v[188:191]
    v_mfma_f32_16x16x32_bf16 v[176:179], v[48:51], v[64:67], v[176:179]
    v_mfma_f32_16x16x32_bf16 v[180:183], v[48:51], v[68:71], v[180:183]
    v_mfma_f32_16x16x32_bf16 v[184:187], v[48:51], v[72:75], v[184:187]
    v_mfma_f32_16x16x32_bf16 v[188:191], v[48:51], v[76:79], v[188:191]
    v_mfma_f32_16x16x32_bf16 v[180:183], v[52:55], v[64:67], v[180:183]
    v_mfma_f32_16x16x32_bf16 v[184:187], v[52:55], v[68:71], v[184:187]
    buffer_load_dwordx4 v[228:231], v14, s[36:39], s88 offen offset:1024 sc1
    v_mfma_f32_16x16x32_bf16 v[188:191], v[52:55], v[72:75], v[188:191]
    v_mfma_f32_16x16x32_bf16 v[184:187], v[56:59], v[64:67], v[184:187]
    v_mfma_f32_16x16x32_bf16 v[188:191], v[56:59], v[68:71], v[188:191]
    v_mfma_f32_16x16x32_bf16 v[188:191], v[60:63], v[64:67], v[188:191]
    s_waitcnt lgkmcnt(0)
    s_nop 0
    v_mfma_f32_16x16x32_bf16 v[160:163], v[96:99], v[128:131], v[160:163]
    ds_read_b128 v[64:67], v3 offset:320
    v_mfma_f32_16x16x32_bf16 v[164:167], v[96:99], v[132:135], v[164:167]
    ds_read_b64 v[32:33], v2 offset:128
    v_mfma_f32_16x16x32_bf16 v[168:171], v[96:99], v[136:139], v[168:171]
    ds_read_b64 v[34:35], v2 offset:136
    v_mfma_f32_16x16x32_bf16 v[172:175], v[96:99], v[140:143], v[172:175]
    ds_read_b128 v[68:71], v3 offset:832
    v_mfma_f32_16x16x32_bf16 v[176:179], v[96:99], v[144:147], v[176:179]
    ds_read_b64 v[36:37], v2 offset:640
    v_mfma_f32_16x16x32_bf16 v[180:183], v[96:99], v[148:151], v[180:183]
    ds_read_b64 v[38:39], v2 offset:648
    v_mfma_f32_16x16x32_bf16 v[184:187], v[96:99], v[152:155], v[184:187]
    ds_read_b128 v[72:75], v3 offset:1344
    v_mfma_f32_16x16x32_bf16 v[188:191], v[96:99], v[156:159], v[188:191]
    ds_read_b64 v[40:41], v2 offset:1152
    v_mfma_f32_16x16x32_bf16 v[164:167], v[100:103], v[128:131], v[164:167]
    ds_read_b64 v[42:43], v2 offset:1160
    v_mfma_f32_16x16x32_bf16 v[168:171], v[100:103], v[132:135], v[168:171]
    ds_read_b128 v[76:79], v3 offset:1856
    v_mfma_f32_16x16x32_bf16 v[172:175], v[100:103], v[136:139], v[172:175]
    ds_read_b64 v[44:45], v2 offset:1664
    v_mfma_f32_16x16x32_bf16 v[176:179], v[100:103], v[140:143], v[176:179]
    ds_read_b64 v[46:47], v2 offset:1672
    v_mfma_f32_16x16x32_bf16 v[180:183], v[100:103], v[144:147], v[180:183]
    ds_read_b128 v[80:83], v3 offset:2368
    v_mfma_f32_16x16x32_bf16 v[184:187], v[100:103], v[148:151], v[184:187]
    ds_read_b64 v[48:49], v2 offset:2176
    v_mfma_f32_16x16x32_bf16 v[188:191], v[100:103], v[152:155], v[188:191]
    ds_read_b64 v[50:51], v2 offset:2184
    v_mfma_f32_16x16x32_bf16 v[168:171], v[104:107], v[128:131], v[168:171]
    ds_read_b128 v[84:87], v3 offset:2880
    v_mfma_f32_16x16x32_bf16 v[172:175], v[104:107], v[132:135], v[172:175]
    ds_read_b64 v[52:53], v2 offset:2688
    v_mfma_f32_16x16x32_bf16 v[176:179], v[104:107], v[136:139], v[176:179]
    ds_read_b64 v[54:55], v2 offset:2696
    v_mfma_f32_16x16x32_bf16 v[180:183], v[104:107], v[140:143], v[180:183]
    ds_read_b128 v[88:91], v3 offset:3392
    v_mfma_f32_16x16x32_bf16 v[184:187], v[104:107], v[144:147], v[184:187]
    ds_read_b64 v[56:57], v2 offset:3200
    v_mfma_f32_16x16x32_bf16 v[188:191], v[104:107], v[148:151], v[188:191]
    ds_read_b64 v[58:59], v2 offset:3208
    v_mfma_f32_16x16x32_bf16 v[172:175], v[108:111], v[128:131], v[172:175]
    ds_read_b128 v[92:95], v3 offset:3904
    v_mfma_f32_16x16x32_bf16 v[176:179], v[108:111], v[132:135], v[176:179]
    ds_read_b64 v[60:61], v2 offset:3712
    v_mfma_f32_16x16x32_bf16 v[180:183], v[108:111], v[136:139], v[180:183]
    ds_read_b64 v[62:63], v2 offset:3720
    v_mfma_f32_16x16x32_bf16 v[184:187], v[108:111], v[140:143], v[184:187]
    v_mfma_f32_16x16x32_bf16 v[188:191], v[108:111], v[144:147], v[188:191]
    v_mfma_f32_16x16x32_bf16 v[176:179], v[112:115], v[128:131], v[176:179]
    v_mfma_f32_16x16x32_bf16 v[180:183], v[112:115], v[132:135], v[180:183]
    v_mfma_f32_16x16x32_bf16 v[184:187], v[112:115], v[136:139], v[184:187]
    v_mfma_f32_16x16x32_bf16 v[188:191], v[112:115], v[140:143], v[188:191]
    v_mfma_f32_16x16x32_bf16 v[180:183], v[116:119], v[128:131], v[180:183]
    v_mfma_f32_16x16x32_bf16 v[184:187], v[116:119], v[132:135], v[184:187]
    v_mfma_f32_16x16x32_bf16 v[188:191], v[116:119], v[136:139], v[188:191]
    v_mfma_f32_16x16x32_bf16 v[184:187], v[120:123], v[128:131], v[184:187]
    v_mfma_f32_16x16x32_bf16 v[188:191], v[120:123], v[132:135], v[188:191]
    v_mfma_f32_16x16x32_bf16 v[188:191], v[124:127], v[128:131], v[188:191]
    s_waitcnt lgkmcnt(0)
    s_nop 0
    v_mfma_f32_16x16x32_bf16 v[160:163], v[32:35], v[64:67], v[160:163]
    ds_read_b128 v[128:131], v3 offset:256
    v_mfma_f32_16x16x32_bf16 v[164:167], v[32:35], v[68:71], v[164:167]
    ds_read_b64 v[96:97], v2 offset:192
    v_mfma_f32_16x16x32_bf16 v[168:171], v[32:35], v[72:75], v[168:171]
    ds_read_b64 v[98:99], v2 offset:200
    v_mfma_f32_16x16x32_bf16 v[172:175], v[32:35], v[76:79], v[172:175]
    ds_read_b128 v[132:135], v3 offset:768
    v_mfma_f32_16x16x32_bf16 v[176:179], v[32:35], v[80:83], v[176:179]
    ds_read_b64 v[100:101], v2 offset:704
    v_mfma_f32_16x16x32_bf16 v[180:183], v[32:35], v[84:87], v[180:183]
    ds_read_b64 v[102:103], v2 offset:712
    v_mfma_f32_16x16x32_bf16 v[184:187], v[32:35], v[88:91], v[184:187]
    ds_read_b128 v[136:139], v3 offset:1280
    v_mfma_f32_16x16x32_bf16 v[188:191], v[32:35], v[92:95], v[188:191]
    ds_read_b64 v[104:105], v2 offset:1216
    v_mfma_f32_16x16x32_bf16 v[164:167], v[36:39], v[64:67], v[164:167]
    ds_read_b64 v[106:107], v2 offset:1224
    v_mfma_f32_16x16x32_bf16 v[168:171], v[36:39], v[68:71], v[168:171]
    ds_read_b128 v[140:143], v3 offset:1792
    v_mfma_f32_16x16x32_bf16 v[172:175], v[36:39], v[72:75], v[172:175]
    ds_read_b64 v[108:109], v2 offset:1728
    v_mfma_f32_16x16x32_bf16 v[176:179], v[36:39], v[76:79], v[176:179]
    ds_read_b64 v[110:111], v2 offset:1736
    v_mfma_f32_16x16x32_bf16 v[180:183], v[36:39], v[80:83], v[180:183]
    ds_read_b128 v[144:147], v3 offset:2304
    v_mfma_f32_16x16x32_bf16 v[184:187], v[36:39], v[84:87], v[184:187]
    ds_read_b64 v[112:113], v2 offset:2240
    v_mfma_f32_16x16x32_bf16 v[188:191], v[36:39], v[88:91], v[188:191]
    ds_read_b64 v[114:115], v2 offset:2248
    v_mfma_f32_16x16x32_bf16 v[168:171], v[40:43], v[64:67], v[168:171]
    ds_read_b128 v[148:151], v3 offset:2816
    v_mfma_f32_16x16x32_bf16 v[172:175], v[40:43], v[68:71], v[172:175]
    ds_read_b64 v[116:117], v2 offset:2752
    v_mfma_f32_16x16x32_bf16 v[176:179], v[40:43], v[72:75], v[176:179]
    ds_read_b64 v[118:119], v2 offset:2760
    v_mfma_f32_16x16x32_bf16 v[180:183], v[40:43], v[76:79], v[180:183]
    ds_read_b128 v[152:155], v3 offset:3328
    v_mfma_f32_16x16x32_bf16 v[184:187], v[40:43], v[80:83], v[184:187]
    ds_read_b64 v[120:121], v2 offset:3264
    v_mfma_f32_16x16x32_bf16 v[188:191], v[40:43], v[84:87], v[188:191]
    ds_read_b64 v[122:123], v2 offset:3272
    v_mfma_f32_16x16x32_bf16 v[172:175], v[44:47], v[64:67], v[172:175]
    ds_read_b128 v[156:159], v3 offset:3840
    v_mfma_f32_16x16x32_bf16 v[176:179], v[44:47], v[68:71], v[176:179]
    ds_read_b64 v[124:125], v2 offset:3776
    v_mfma_f32_16x16x32_bf16 v[180:183], v[44:47], v[72:75], v[180:183]
    ds_read_b64 v[126:127], v2 offset:3784
    v_mfma_f32_16x16x32_bf16 v[184:187], v[44:47], v[76:79], v[184:187]
    v_mfma_f32_16x16x32_bf16 v[188:191], v[44:47], v[80:83], v[188:191]
    v_mfma_f32_16x16x32_bf16 v[176:179], v[48:51], v[64:67], v[176:179]
    v_mfma_f32_16x16x32_bf16 v[180:183], v[48:51], v[68:71], v[180:183]
    v_mfma_f32_16x16x32_bf16 v[184:187], v[48:51], v[72:75], v[184:187]
    v_mfma_f32_16x16x32_bf16 v[188:191], v[48:51], v[76:79], v[188:191]
    v_mfma_f32_16x16x32_bf16 v[180:183], v[52:55], v[64:67], v[180:183]
    v_mfma_f32_16x16x32_bf16 v[184:187], v[52:55], v[68:71], v[184:187]
    v_mfma_f32_16x16x32_bf16 v[188:191], v[52:55], v[72:75], v[188:191]
    v_mfma_f32_16x16x32_bf16 v[184:187], v[56:59], v[64:67], v[184:187]
    v_mfma_f32_16x16x32_bf16 v[188:191], v[56:59], v[68:71], v[188:191]
    v_mfma_f32_16x16x32_bf16 v[188:191], v[60:63], v[64:67], v[188:191]
    s_waitcnt lgkmcnt(0)
    s_nop 0
    v_mfma_f32_16x16x32_bf16 v[160:163], v[96:99], v[128:131], v[160:163]
    ds_read_b128 v[64:67], v3 offset:192
    v_mfma_f32_16x16x32_bf16 v[164:167], v[96:99], v[132:135], v[164:167]
    ds_read_b64 v[32:33], v2 offset:256
    v_mfma_f32_16x16x32_bf16 v[168:171], v[96:99], v[136:139], v[168:171]
    ds_read_b64 v[34:35], v2 offset:264
    v_mfma_f32_16x16x32_bf16 v[172:175], v[96:99], v[140:143], v[172:175]
    ds_read_b128 v[68:71], v3 offset:704
    v_mfma_f32_16x16x32_bf16 v[176:179], v[96:99], v[144:147], v[176:179]
    ds_read_b64 v[36:37], v2 offset:768
    v_mfma_f32_16x16x32_bf16 v[180:183], v[96:99], v[148:151], v[180:183]
    ds_read_b64 v[38:39], v2 offset:776
    v_mfma_f32_16x16x32_bf16 v[184:187], v[96:99], v[152:155], v[184:187]
    ds_read_b128 v[72:75], v3 offset:1216
    v_mfma_f32_16x16x32_bf16 v[188:191], v[96:99], v[156:159], v[188:191]
    ds_read_b64 v[40:41], v2 offset:1280
    v_mfma_f32_16x16x32_bf16 v[164:167], v[100:103], v[128:131], v[164:167]
    ds_read_b64 v[42:43], v2 offset:1288
    v_mfma_f32_16x16x32_bf16 v[168:171], v[100:103], v[132:135], v[168:171]
    ds_read_b128 v[76:79], v3 offset:1728
    v_mfma_f32_16x16x32_bf16 v[172:175], v[100:103], v[136:139], v[172:175]
    ds_read_b64 v[44:45], v2 offset:1792
    v_mfma_f32_16x16x32_bf16 v[176:179], v[100:103], v[140:143], v[176:179]
    ds_read_b64 v[46:47], v2 offset:1800
PAGE8:
    s_cbranch_execz VISIT_RET
    s_nop 0
    v_mfma_f32_16x16x32_bf16 v[180:183], v[100:103], v[144:147], v[180:183]
    ds_read_b128 v[80:83], v3 offset:2240
    v_mfma_f32_16x16x32_bf16 v[184:187], v[100:103], v[148:151], v[184:187]
    ds_read_b64 v[48:49], v2 offset:2304
    v_mfma_f32_16x16x32_bf16 v[188:191], v[100:103], v[152:155], v[188:191]
    ds_read_b64 v[50:51], v2 offset:2312
    v_mfma_f32_16x16x32_bf16 v[168:171], v[104:107], v[128:131], v[168:171]
    ds_read_b128 v[84:87], v3 offset:2752
    v_mfma_f32_16x16x32_bf16 v[172:175], v[104:107], v[132:135], v[172:175]
    ds_read_b64 v[52:53], v2 offset:2816
    v_mfma_f32_16x16x32_bf16 v[176:179], v[104:107], v[136:139], v[176:179]
    ds_read_b64 v[54:55], v2 offset:2824
    v_mfma_f32_16x16x32_bf16 v[180:183], v[104:107], v[140:143], v[180:183]
    ds_read_b128 v[88:91], v3 offset:3264
    v_mfma_f32_16x16x32_bf16 v[184:187], v[104:107], v[144:147], v[184:187]
    ds_read_b64 v[56:57], v2 offset:3328
    v_mfma_f32_16x16x32_bf16 v[188:191], v[104:107], v[148:151], v[188:191]
    ds_read_b64 v[58:59], v2 offset:3336
    v_mfma_f32_16x16x32_bf16 v[172:175], v[108:111], v[128:131], v[172:175]
    ds_read_b128 v[92:95], v3 offset:3776
    v_mfma_f32_16x16x32_bf16 v[176:179], v[108:111], v[132:135], v[176:179]
    ds_read_b64 v[60:61], v2 offset:3840
    v_mfma_f32_16x16x32_bf16 v[180:183], v[108:111], v[136:139], v[180:183]
    ds_read_b64 v[62:63], v2 offset:3848
    v_mfma_f32_16x16x32_bf16 v[184:187], v[108:111], v[140:143], v[184:187]
    v_mfma_f32_16x16x32_bf16 v[188:191], v[108:111], v[144:147], v[188:191]
    v_mfma_f32_16x16x32_bf16 v[176:179], v[112:115], v[128:131], v[176:179]
    v_mfma_f32_16x16x32_bf16 v[180:183], v[112:115], v[132:135], v[180:183]
    v_mfma_f32_16x16x32_bf16 v[184:187], v[112:115], v[136:139], v[184:187]
    v_mfma_f32_16x16x32_bf16 v[188:191], v[112:115], v[140:143], v[188:191]
    v_mfma_f32_16x16x32_bf16 v[180:183], v[116:119], v[128:131], v[180:183]
    v_mfma_f32_16x16x32_bf16 v[184:187], v[116:119], v[132:135], v[184:187]
    v_mfma_f32_16x16x32_bf16 v[188:191], v[116:119], v[136:139], v[188:191]
    v_mfma_f32_16x16x32_bf16 v[184:187], v[120:123], v[128:131], v[184:187]
    v_mfma_f32_16x16x32_bf16 v[188:191], v[120:123], v[132:135], v[188:191]
    v_mfma_f32_16x16x32_bf16 v[188:191], v[124:127], v[128:131], v[188:191]
    s_waitcnt lgkmcnt(0)
    s_nop 0
    v_mfma_f32_16x16x32_bf16 v[160:163], v[32:35], v[64:67], v[160:163]
    ds_read_b128 v[128:131], v3 offset:128
    v_mfma_f32_16x16x32_bf16 v[164:167], v[32:35], v[68:71], v[164:167]
    ds_read_b64 v[96:97], v2 offset:320
    v_mfma_f32_16x16x32_bf16 v[168:171], v[32:35], v[72:75], v[168:171]
    ds_read_b64 v[98:99], v2 offset:328
    v_mfma_f32_16x16x32_bf16 v[172:175], v[32:35], v[76:79], v[172:175]
    ds_read_b128 v[132:135], v3 offset:640
    v_mfma_f32_16x16x32_bf16 v[176:179], v[32:35], v[80:83], v[176:179]
    ds_read_b64 v[100:101], v2 offset:832
    v_mfma_f32_16x16x32_bf16 v[180:183], v[32:35], v[84:87], v[180:183]
    ds_read_b64 v[102:103], v2 offset:840
    v_mfma_f32_16x16x32_bf16 v[184:187], v[32:35], v[88:91], v[184:187]
    ds_read_b128 v[136:139], v3 offset:1152
    v_mfma_f32_16x16x32_bf16 v[188:191], v[32:35], v[92:95], v[188:191]
    ds_read_b64 v[104:105], v2 offset:1344
    v_mfma_f32_16x16x32_bf16 v[164:167], v[36:39], v[64:67], v[164:167]
    ds_read_b64 v[106:107], v2 offset:1352
    v_mfma_f32_16x16x32_bf16 v[168:171], v[36:39], v[68:71], v[168:171]
    ds_read_b128 v[140:143], v3 offset:1664
    v_mfma_f32_16x16x32_bf16 v[172:175], v[36:39], v[72:75], v[172:175]
    ds_read_b64 v[108:109], v2 offset:1856
    v_mfma_f32_16x16x32_bf16 v[176:179], v[36:39], v[76:79], v[176:179]
    ds_read_b64 v[110:111], v2 offset:1864
    v_mfma_f32_16x16x32_bf16 v[180:183], v[36:39], v[80:83], v[180:183]
    ds_read_b128 v[144:147], v3 offset:2176
    v_mfma_f32_16x16x32_bf16 v[184:187], v[36:39], v[84:87], v[184:187]
    ds_read_b64 v[112:113], v2 offset:2368
    v_mfma_f32_16x16x32_bf16 v[188:191], v[36:39], v[88:91], v[188:191]
    ds_read_b64 v[114:115], v2 offset:2376
    v_mfma_f32_16x16x32_bf16 v[168:171], v[40:43], v[64:67], v[168:171]
    ds_read_b128 v[148:151], v3 offset:2688
    v_mfma_f32_16x16x32_bf16 v[172:175], v[40:43], v[68:71], v[172:175]
    ds_read_b64 v[116:117], v2 offset:2880
    v_mfma_f32_16x16x32_bf16 v[176:179], v[40:43], v[72:75], v[176:179]
    ds_read_b64 v[118:119], v2 offset:2888
    v_mfma_f32_16x16x32_bf16 v[180:183], v[40:43], v[76:79], v[180:183]
    ds_read_b128 v[152:155], v3 offset:3200
    buffer_load_dword v24, v27, s[36:39], 0 offen sc1
    v_mfma_f32_16x16x32_bf16 v[184:187], v[40:43], v[80:83], v[184:187]
    ds_read_b64 v[120:121], v2 offset:3392
    v_mfma_f32_16x16x32_bf16 v[188:191], v[40:43], v[84:87], v[188:191]
    ds_read_b64 v[122:123], v2 offset:3400
    v_mfma_f32_16x16x32_bf16 v[172:175], v[44:47], v[64:67], v[172:175]
    ds_read_b128 v[156:159], v3 offset:3712
    v_mfma_f32_16x16x32_bf16 v[176:179], v[44:47], v[68:71], v[176:179]
    ds_read_b64 v[124:125], v2 offset:3904
    v_mfma_f32_16x16x32_bf16 v[180:183], v[44:47], v[72:75], v[180:183]
    ds_read_b64 v[126:127], v2 offset:3912
    v_mfma_f32_16x16x32_bf16 v[184:187], v[44:47], v[76:79], v[184:187]
    v_mfma_f32_16x16x32_bf16 v[188:191], v[44:47], v[80:83], v[188:191]
    v_mfma_f32_16x16x32_bf16 v[176:179], v[48:51], v[64:67], v[176:179]
    v_mfma_f32_16x16x32_bf16 v[180:183], v[48:51], v[68:71], v[180:183]
    v_mfma_f32_16x16x32_bf16 v[184:187], v[48:51], v[72:75], v[184:187]
    v_mfma_f32_16x16x32_bf16 v[188:191], v[48:51], v[76:79], v[188:191]
    v_mfma_f32_16x16x32_bf16 v[180:183], v[52:55], v[64:67], v[180:183]
    v_mfma_f32_16x16x32_bf16 v[184:187], v[52:55], v[68:71], v[184:187]
    v_mfma_f32_16x16x32_bf16 v[188:191], v[52:55], v[72:75], v[188:191]
    v_mfma_f32_16x16x32_bf16 v[184:187], v[56:59], v[64:67], v[184:187]
    v_mfma_f32_16x16x32_bf16 v[188:191], v[56:59], v[68:71], v[188:191]
    v_mfma_f32_16x16x32_bf16 v[188:191], v[60:63], v[64:67], v[188:191]
    s_waitcnt lgkmcnt(0)
    v_mfma_f32_16x16x32_bf16 v[160:163], v[96:99], v[128:131], v[160:163]
    ds_read_b128 v[64:67], v3 offset:64
    v_mfma_f32_16x16x32_bf16 v[164:167], v[96:99], v[132:135], v[164:167]
    ds_read_b64 v[32:33], v2 offset:384
    s_lshl_b32 s79, s53, 6
    s_lshl_b32 s80, s3, 4
    s_add_u32 s79, s79, s80
    v_lshrrev_b32 v236, 2, v0
    v_add_u32 v236, s79, v236
    v_mfma_f32_16x16x32_bf16 v[168:171], v[96:99], v[136:139], v[168:171]
    ds_read_b64 v[34:35], v2 offset:392
    v_mul_u32_u24 v236, 1280, v236
    s_mul_i32 s80, s54, 160
    v_add_u32 v236, s80, v236
    v_mfma_f32_16x16x32_bf16 v[172:175], v[96:99], v[140:143], v[172:175]
    ds_read_b128 v[68:71], v3 offset:576
    v_and_b32 v237, 3, v0
    v_mfma_f32_16x16x32_bf16 v[176:179], v[96:99], v[144:147], v[176:179]
    ds_read_b64 v[36:37], v2 offset:896
    v_lshl_add_u32 v238, v237, 4, v236
    v_mfma_f32_16x16x32_bf16 v[180:183], v[96:99], v[148:151], v[180:183]
    ds_read_b64 v[38:39], v2 offset:904
    v_lshl_add_u32 v239, v237, 3, v236
    v_mfma_f32_16x16x32_bf16 v[184:187], v[96:99], v[152:155], v[184:187]
    ds_read_b128 v[72:75], v3 offset:1088
    buffer_load_dwordx4 v[244:247], v238, s[32:35], 0 offen
    v_mfma_f32_16x16x32_bf16 v[188:191], v[96:99], v[156:159], v[188:191]
    ds_read_b64 v[40:41], v2 offset:1408
    v_mfma_f32_16x16x32_bf16 v[164:167], v[100:103], v[128:131], v[164:167]
    ds_read_b64 v[42:43], v2 offset:1416
    v_mfma_f32_16x16x32_bf16 v[168:171], v[100:103], v[132:135], v[168:171]
    ds_read_b128 v[76:79], v3 offset:1600
    v_mfma_f32_16x16x32_bf16 v[172:175], v[100:103], v[136:139], v[172:175]
    ds_read_b64 v[44:45], v2 offset:1920
    v_mfma_f32_16x16x32_bf16 v[176:179], v[100:103], v[140:143], v[176:179]
    ds_read_b64 v[46:47], v2 offset:1928
    v_mfma_f32_16x16x32_bf16 v[180:183], v[100:103], v[144:147], v[180:183]
    ds_read_b128 v[80:83], v3 offset:2112
    v_mfma_f32_16x16x32_bf16 v[184:187], v[100:103], v[148:151], v[184:187]
    ds_read_b64 v[48:49], v2 offset:2432
    v_mfma_f32_16x16x32_bf16 v[188:191], v[100:103], v[152:155], v[188:191]
    ds_read_b64 v[50:51], v2 offset:2440
    v_mfma_f32_16x16x32_bf16 v[168:171], v[104:107], v[128:131], v[168:171]
    ds_read_b128 v[84:87], v3 offset:2624
    v_mfma_f32_16x16x32_bf16 v[172:175], v[104:107], v[132:135], v[172:175]
    ds_read_b64 v[52:53], v2 offset:2944
    v_mfma_f32_16x16x32_bf16 v[176:179], v[104:107], v[136:139], v[176:179]
    ds_read_b64 v[54:55], v2 offset:2952
    v_mfma_f32_16x16x32_bf16 v[180:183], v[104:107], v[140:143], v[180:183]
    ds_read_b128 v[88:91], v3 offset:3136
    buffer_load_dwordx4 v[248:251], v238, s[32:35], 0 offen offset:64
    v_mfma_f32_16x16x32_bf16 v[184:187], v[104:107], v[144:147], v[184:187]
    ds_read_b64 v[56:57], v2 offset:3456
    v_mfma_f32_16x16x32_bf16 v[188:191], v[104:107], v[148:151], v[188:191]
    ds_read_b64 v[58:59], v2 offset:3464
    v_mfma_f32_16x16x32_bf16 v[172:175], v[108:111], v[128:131], v[172:175]
    ds_read_b128 v[92:95], v3 offset:3648
    v_mfma_f32_16x16x32_bf16 v[176:179], v[108:111], v[132:135], v[176:179]
    ds_read_b64 v[60:61], v2 offset:3968
    v_mfma_f32_16x16x32_bf16 v[180:183], v[108:111], v[136:139], v[180:183]
    ds_read_b64 v[62:63], v2 offset:3976
    v_mfma_f32_16x16x32_bf16 v[184:187], v[108:111], v[140:143], v[184:187]
    v_mfma_f32_16x16x32_bf16 v[188:191], v[108:111], v[144:147], v[188:191]
    v_mfma_f32_16x16x32_bf16 v[176:179], v[112:115], v[128:131], v[176:179]
    v_mfma_f32_16x16x32_bf16 v[180:183], v[112:115], v[132:135], v[180:183]
    v_mfma_f32_16x16x32_bf16 v[184:187], v[112:115], v[136:139], v[184:187]
    v_mfma_f32_16x16x32_bf16 v[188:191], v[112:115], v[140:143], v[188:191]
    v_mfma_f32_16x16x32_bf16 v[180:183], v[116:119], v[128:131], v[180:183]
    buffer_load_dwordx2 v[252:253], v239, s[32:35], 0 offen offset:128
    v_mfma_f32_16x16x32_bf16 v[184:187], v[116:119], v[132:135], v[184:187]
    v_mfma_f32_16x16x32_bf16 v[188:191], v[116:119], v[136:139], v[188:191]
    v_mfma_f32_16x16x32_bf16 v[184:187], v[120:123], v[128:131], v[184:187]
    v_mfma_f32_16x16x32_bf16 v[188:191], v[120:123], v[132:135], v[188:191]
    v_mfma_f32_16x16x32_bf16 v[188:191], v[124:127], v[128:131], v[188:191]
    s_waitcnt lgkmcnt(0)
    s_waitcnt vmcnt(3)
    v_cmp_ne_u32 vcc, s56, v24
    s_mov_b64 s[82:83], vcc
    s_cmp_eq_u64 s[82:83], 0
    s_cbranch_scc0 P2I_RETRY_24
P2I_DONE_25:
    v_mfma_f32_16x16x32_bf16 v[160:163], v[32:35], v[64:67], v[160:163]
    ds_read_b128 v[128:131], v3 offset:0
    v_mfma_f32_16x16x32_bf16 v[164:167], v[32:35], v[68:71], v[164:167]
    ds_read_b64 v[96:97], v2 offset:448
    v_mfma_f32_16x16x32_bf16 v[168:171], v[32:35], v[72:75], v[168:171]
    ds_read_b64 v[98:99], v2 offset:456
    buffer_load_dwordx4 a[0:3], v14, s[36:39], s52 offen offset:0 sc1
    v_mfma_f32_16x16x32_bf16 v[172:175], v[32:35], v[76:79], v[172:175]
    ds_read_b128 v[132:135], v3 offset:512
    v_mfma_f32_16x16x32_bf16 v[176:179], v[32:35], v[80:83], v[176:179]
    ds_read_b64 v[100:101], v2 offset:960
    v_mfma_f32_16x16x32_bf16 v[180:183], v[32:35], v[84:87], v[180:183]
    ds_read_b64 v[102:103], v2 offset:968
    v_mfma_f32_16x16x32_bf16 v[184:187], v[32:35], v[88:91], v[184:187]
    ds_read_b128 v[136:139], v3 offset:1024
    buffer_load_dwordx4 a[4:7], v14, s[36:39], s52 offen offset:1024 sc1
    v_mfma_f32_16x16x32_bf16 v[188:191], v[32:35], v[92:95], v[188:191]
    ds_read_b64 v[104:105], v2 offset:1472
    v_mfma_f32_16x16x32_bf16 v[164:167], v[36:39], v[64:67], v[164:167]
    ds_read_b64 v[106:107], v2 offset:1480
    v_mfma_f32_16x16x32_bf16 v[168:171], v[36:39], v[68:71], v[168:171]
    ds_read_b128 v[140:143], v3 offset:1536
    v_mfma_f32_16x16x32_bf16 v[172:175], v[36:39], v[72:75], v[172:175]
    ds_read_b64 v[108:109], v2 offset:1984
    v_mfma_f32_16x16x32_bf16 v[176:179], v[36:39], v[76:79], v[176:179]
    ds_read_b64 v[110:111], v2 offset:1992
    buffer_load_dwordx4 a[8:11], v14, s[36:39], s52 offen offset:2048 sc1
    v_mfma_f32_16x16x32_bf16 v[180:183], v[36:39], v[80:83], v[180:183]
    ds_read_b128 v[144:147], v3 offset:2048
    v_mfma_f32_16x16x32_bf16 v[184:187], v[36:39], v[84:87], v[184:187]
    ds_read_b64 v[112:113], v2 offset:2496
    v_mfma_f32_16x16x32_bf16 v[188:191], v[36:39], v[88:91], v[188:191]
    ds_read_b64 v[114:115], v2 offset:2504
    v_mfma_f32_16x16x32_bf16 v[168:171], v[40:43], v[64:67], v[168:171]
    ds_read_b128 v[148:151], v3 offset:2560
    buffer_load_dwordx4 a[12:15], v14, s[36:39], s52 offen offset:3072 sc1
    v_mfma_f32_16x16x32_bf16 v[172:175], v[40:43], v[68:71], v[172:175]
    ds_read_b64 v[116:117], v2 offset:3008
    v_mfma_f32_16x16x32_bf16 v[176:179], v[40:43], v[72:75], v[176:179]
    ds_read_b64 v[118:119], v2 offset:3016
    v_mfma_f32_16x16x32_bf16 v[180:183], v[40:43], v[76:79], v[180:183]
    ds_read_b128 v[152:155], v3 offset:3072
    v_mfma_f32_16x16x32_bf16 v[184:187], v[40:43], v[80:83], v[184:187]
    ds_read_b64 v[120:121], v2 offset:3520
    v_mfma_f32_16x16x32_bf16 v[188:191], v[40:43], v[84:87], v[188:191]
    ds_read_b64 v[122:123], v2 offset:3528
    buffer_load_dwordx4 a[16:19], v15, s[36:39], s52 offen offset:0 sc1
    s_add_u32 s52, s52, 5120
    v_mfma_f32_16x16x32_bf16 v[172:175], v[44:47], v[64:67], v[172:175]
    ds_read_b128 v[156:159], v3 offset:3584
    v_mfma_f32_16x16x32_bf16 v[176:179], v[44:47], v[68:71], v[176:179]
    ds_read_b64 v[124:125], v2 offset:4032
    v_mfma_f32_16x16x32_bf16 v[180:183], v[44:47], v[72:75], v[180:183]
    ds_read_b64 v[126:127], v2 offset:4040
    v_mfma_f32_16x16x32_bf16 v[184:187], v[44:47], v[76:79], v[184:187]
    buffer_load_dwordx4 a[20:23], v14, s[36:39], s52 offen offset:0 sc1
    v_mfma_f32_16x16x32_bf16 v[188:191], v[44:47], v[80:83], v[188:191]
    v_mfma_f32_16x16x32_bf16 v[176:179], v[48:51], v[64:67], v[176:179]
    v_mfma_f32_16x16x32_bf16 v[180:183], v[48:51], v[68:71], v[180:183]
    v_mfma_f32_16x16x32_bf16 v[184:187], v[48:51], v[72:75], v[184:187]
    v_mfma_f32_16x16x32_bf16 v[188:191], v[48:51], v[76:79], v[188:191]
    buffer_load_dwordx4 a[24:27], v14, s[36:39], s52 offen offset:1024 sc1
    v_mfma_f32_16x16x32_bf16 v[180:183], v[52:55], v[64:67], v[180:183]
    v_mfma_f32_16x16x32_bf16 v[184:187], v[52:55], v[68:71], v[184:187]
    v_mfma_f32_16x16x32_bf16 v[188:191], v[52:55], v[72:75], v[188:191]
    v_mfma_f32_16x16x32_bf16 v[184:187], v[56:59], v[64:67], v[184:187]
    buffer_load_dwordx4 a[28:31], v14, s[36:39], s52 offen offset:2048 sc1
    v_mfma_f32_16x16x32_bf16 v[188:191], v[56:59], v[68:71], v[188:191]
    v_mfma_f32_16x16x32_bf16 v[188:191], v[60:63], v[64:67], v[188:191]
    s_waitcnt lgkmcnt(0)
    s_nop 0
    v_mfma_f32_16x16x32_bf16 v[160:163], v[96:99], v[128:131], v[160:163]
    v_mfma_f32_16x16x32_bf16 v[164:167], v[96:99], v[132:135], v[164:167]
    v_mfma_f32_16x16x32_bf16 v[168:171], v[96:99], v[136:139], v[168:171]
    buffer_load_dwordx4 a[32:35], v14, s[36:39], s52 offen offset:3072 sc1
    v_mfma_f32_16x16x32_bf16 v[172:175], v[96:99], v[140:143], v[172:175]
    v_mfma_f32_16x16x32_bf16 v[176:179], v[96:99], v[144:147], v[176:179]
    v_mfma_f32_16x16x32_bf16 v[180:183], v[96:99], v[148:151], v[180:183]
    v_mfma_f32_16x16x32_bf16 v[184:187], v[96:99], v[152:155], v[184:187]
    buffer_load_dwordx4 a[36:39], v15, s[36:39], s52 offen offset:0 sc1
    s_add_u32 s52, s52, 5120
    v_mfma_f32_16x16x32_bf16 v[188:191], v[96:99], v[156:159], v[188:191]
    v_mfma_f32_16x16x32_bf16 v[164:167], v[100:103], v[128:131], v[164:167]
    v_mfma_f32_16x16x32_bf16 v[168:171], v[100:103], v[132:135], v[168:171]
    v_mfma_f32_16x16x32_bf16 v[172:175], v[100:103], v[136:139], v[172:175]
    v_mfma_f32_16x16x32_bf16 v[176:179], v[100:103], v[140:143], v[176:179]
    buffer_load_dwordx4 a[40:43], v14, s[36:39], s52 offen offset:0 sc1
    v_mfma_f32_16x16x32_bf16 v[180:183], v[100:103], v[144:147], v[180:183]
    v_mfma_f32_16x16x32_bf16 v[184:187], v[100:103], v[148:151], v[184:187]
    v_mfma_f32_16x16x32_bf16 v[188:191], v[100:103], v[152:155], v[188:191]
    v_mfma_f32_16x16x32_bf16 v[168:171], v[104:107], v[128:131], v[168:171]
    buffer_load_dwordx4 a[44:47], v14, s[36:39], s52 offen offset:1024 sc1
    v_mfma_f32_16x16x32_bf16 v[172:175], v[104:107], v[132:135], v[172:175]
    v_mfma_f32_16x16x32_bf16 v[176:179], v[104:107], v[136:139], v[176:179]
    v_mfma_f32_16x16x32_bf16 v[180:183], v[104:107], v[140:143], v[180:183]
    v_mfma_f32_16x16x32_bf16 v[184:187], v[104:107], v[144:147], v[184:187]
    v_mfma_f32_16x16x32_bf16 v[188:191], v[104:107], v[148:151], v[188:191]
    buffer_load_dwordx4 a[48:51], v14, s[36:39], s52 offen offset:2048 sc1
    v_mfma_f32_16x16x32_bf16 v[172:175], v[108:111], v[128:131], v[172:175]
    v_mfma_f32_16x16x32_bf16 v[176:179], v[108:111], v[132:135], v[176:179]
    v_mfma_f32_16x16x32_bf16 v[180:183], v[108:111], v[136:139], v[180:183]
    v_mfma_f32_16x16x32_bf16 v[184:187], v[108:111], v[140:143], v[184:187]
    buffer_load_dwordx4 a[52:55], v14, s[36:39], s52 offen offset:3072 sc1
    v_mfma_f32_16x16x32_bf16 v[188:191], v[108:111], v[144:147], v[188:191]
    v_mfma_f32_16x16x32_bf16 v[176:179], v[112:115], v[128:131], v[176:179]
    v_mfma_f32_16x16x32_bf16 v[180:183], v[112:115], v[132:135], v[180:183]
    v_mfma_f32_16x16x32_bf16 v[184:187], v[112:115], v[136:139], v[184:187]
    v_mfma_f32_16x16x32_bf16 v[188:191], v[112:115], v[140:143], v[188:191]
    buffer_load_dwordx4 a[56:59], v15, s[36:39], s52 offen offset:0 sc1
    s_add_u32 s52, s52, 5120
    v_mfma_f32_16x16x32_bf16 v[180:183], v[116:119], v[128:131], v[180:183]
    v_mfma_f32_16x16x32_bf16 v[184:187], v[116:119], v[132:135], v[184:187]
    v_mfma_f32_16x16x32_bf16 v[188:191], v[116:119], v[136:139], v[188:191]
    v_mfma_f32_16x16x32_bf16 v[184:187], v[120:123], v[128:131], v[184:187]
    buffer_load_dwordx4 a[60:63], v14, s[36:39], s52 offen offset:0 sc1
    v_mfma_f32_16x16x32_bf16 v[188:191], v[120:123], v[132:135], v[188:191]
    v_mfma_f32_16x16x32_bf16 v[188:191], v[124:127], v[128:131], v[188:191]
    s_nop 7
    v_bfe_u32 v8, v0, 4, 1
    v_lshlrev_b32 v8, 9, v8
    v_and_b32 v9, 15, v0
    v_lshl_add_u32 v8, v9, 5, v8
    v_lshrrev_b32 v9, 5, v0
    v_lshl_add_u32 v8, v9, 4, v8
    v_cvt_pk_bf16_f32 v32, v160, v161
    v_cvt_pk_bf16_f32 v33, v162, v163
    v_cvt_pk_bf16_f32 v34, v164, v165
    v_cvt_pk_bf16_f32 v35, v166, v167
    v_cvt_pk_bf16_f32 v36, v168, v169
    v_cvt_pk_bf16_f32 v37, v170, v171
    v_cvt_pk_bf16_f32 v38, v172, v173
    v_cvt_pk_bf16_f32 v39, v174, v175
    v_cvt_pk_bf16_f32 v40, v176, v177
    v_cvt_pk_bf16_f32 v41, v178, v179
    v_cvt_pk_bf16_f32 v42, v180, v181
    v_cvt_pk_bf16_f32 v43, v182, v183
    v_cvt_pk_bf16_f32 v44, v184, v185
    v_cvt_pk_bf16_f32 v45, v186, v187
    v_cvt_pk_bf16_f32 v46, v188, v189
    v_cvt_pk_bf16_f32 v47, v190, v191
    s_nop 1
    v_permlane16_swap_b32 v32, v34
    v_permlane16_swap_b32 v33, v35
    v_permlane16_swap_b32 v36, v38
    v_permlane16_swap_b32 v37, v39
    v_permlane16_swap_b32 v40, v42
    v_permlane16_swap_b32 v41, v43
    v_permlane16_swap_b32 v44, v46
    v_permlane16_swap_b32 v45, v47
    buffer_store_dwordx4 v[32:35], v8, s[36:39], s18 offen offset:0 sc1
    buffer_store_dwordx4 v[36:39], v8, s[36:39], s18 offen offset:1024 sc1
    buffer_store_dwordx4 v[40:43], v8, s[36:39], s18 offen offset:2048 sc1
    buffer_store_dwordx4 v[44:47], v8, s[36:39], s18 offen offset:3072 sc1
    s_waitcnt vmcnt(24)
    v_mov_b32 v96, v200
    v_mov_b32 v97, v201
    v_mov_b32 v98, v202
    v_mov_b32 v99, v203
    v_mov_b32 v100, v204
    v_mov_b32 v101, v205
    v_mov_b32 v102, v206
    v_mov_b32 v103, v207
    v_mov_b32 v104, v208
    v_mov_b32 v105, v209
    v_mov_b32 v106, v210
    v_mov_b32 v107, v211
    v_mov_b32 v108, v212
    v_mov_b32 v109, v213
    v_mov_b32 v110, v214
    v_mov_b32 v111, v215
    v_mov_b32 v112, v216
    v_mov_b32 v113, v217
    v_mov_b32 v114, v218
    v_mov_b32 v115, v219
    v_mov_b32 v116, v220
    v_mov_b32 v117, v221
    v_mov_b32 v118, v222
    v_mov_b32 v119, v223
    v_mov_b32 v120, v224
    v_mov_b32 v121, v225
    v_mov_b32 v122, v226
    v_mov_b32 v123, v227
    v_mov_b32 v124, v228
    v_mov_b32 v125, v229
    v_mov_b32 v126, v230
    v_mov_b32 v127, v231
    s_mov_b32 s29, 17563648
    s_barrier
    s_branch C4JOIN
DONE:
EXIT:
    s_endpgm
P1_RETRY_2:
    s_mov_b32 s81, 0x40000
P1_LOOP_4:
    buffer_load_dword v29, v28, s[36:39], 0 offen sc1
    s_waitcnt vmcnt(0)
    v_cmp_ne_u32 vcc, s56, v29
    s_mov_b64 s[82:83], vcc
    s_cmp_eq_u64 s[82:83], 0
    s_cbranch_scc1 P1_DONE_3
    s_sub_u32 s81, s81, 1
    s_cmp_lg_u32 s81, 0
    s_cbranch_scc1 P1_LOOP_4
    s_branch P1_DONE_3
P2_RETRY_6:
    s_mov_b32 s81, 0x40000
P2_LOOP_8:
    buffer_load_dword v24, v27, s[36:39], 0 offen sc1
    s_waitcnt vmcnt(0)
    v_cmp_ne_u32 vcc, s56, v24
    s_mov_b64 s[82:83], vcc
    s_cmp_eq_u64 s[82:83], 0
    s_cbranch_scc1 P2_DONE_7
    s_sub_u32 s81, s81, 1
    s_cmp_lg_u32 s81, 0
    s_cbranch_scc1 P2_LOOP_8
    s_branch P2_DONE_7
FH_RETRY_11:
    s_mov_b32 s81, 0x40000
FH_LOOP_13:
    buffer_load_dword v19, v18, s[36:39], s49 offen sc1
    s_waitcnt vmcnt(0)
    v_cmp_ne_u32 vcc, s56, v19
    s_mov_b64 s[82:83], vcc
    s_cmp_eq_u64 s[82:83], 0
    s_cbranch_scc1 FH_DONE_12
    s_sub_u32 s81, s81, 1
    s_cmp_lg_u32 s81, 0
    s_cbranch_scc1 FH_LOOP_13
    s_branch FH_DONE_12
FY_RETRY_14:
    s_mov_b32 s81, 0x40000
FY_LOOP_16:
    buffer_load_dword v20, v18, s[36:39], s59 offen sc1
    s_waitcnt vmcnt(0)
    v_cmp_ne_u32 vcc, s56, v20
    s_mov_b64 s[82:83], vcc
    s_cmp_eq_u64 s[82:83], 0
    s_cbranch_scc1 FY_DONE_15
    s_sub_u32 s81, s81, 1
    s_cmp_lg_u32 s81, 0
    s_cbranch_scc1 FY_LOOP_16
    s_branch FY_DONE_15
EP_RETRY_17:
    s_mov_b32 s81, 0x40000
EP_LOOP_19:
    buffer_load_dword v24, v16, s[36:39], s76 offen sc1
    s_waitcnt vmcnt(0)
    v_cmp_ne_u32 vcc, s56, v24
    s_mov_b64 s[82:83], vcc
    s_cmp_eq_u64 s[82:83], 0
    s_cbranch_scc1 EP_DONE_18
    s_sub_u32 s81, s81, 1
    s_cmp_lg_u32 s81, 0
    s_cbranch_scc1 EP_LOOP_19
    s_branch EP_DONE_18
EP_CHECK:
    s_waitcnt vmcnt(0)
    v_cmp_ne_u32 vcc, s56, v24
    s_mov_b64 s[82:83], vcc
    s_cmp_eq_u64 s[82:83], 0
    s_cbranch_scc0 EP_RETRY_17
EP_DONE_18:
    s_branch EP_BACK
EP_STORE:
    s_sub_u32 s73, s56, 2654435768
    v_mov_b32 v16, s73
    v_mov_b32 v17, 0
    s_mov_b32 exec_lo, 1
    s_mov_b32 exec_hi, 0
    buffer_store_dword v16, v17, s[36:39], 0 offen sc1
    s_mov_b64 exec, -1
    s_branch EP_STORED
FAI_RETRY_21:
    s_mov_b32 s81, 0x40000
FAI_LOOP_23:
    buffer_load_dword v24, v27, s[36:39], 0 offen sc1
    s_waitcnt vmcnt(0)
    v_cmp_ne_u32 vcc, s56, v24
    s_mov_b64 s[82:83], vcc
    s_and_b64 s[82:83], s[82:83], s[50:51]
    s_cmp_eq_u64 s[82:83], 0
    s_cbranch_scc1 FAI_DONE_22
    s_sub_u32 s81, s81, 1
    s_cmp_lg_u32 s81, 0
    s_cbranch_scc1 FAI_LOOP_23
    s_branch FAI_DONE_22
P2I_RETRY_24:
    s_mov_b32 s81, 0x40000
P2I_LOOP_26:
    buffer_load_dword v24, v27, s[36:39], 0 offen sc1
    s_waitcnt vmcnt(0)
    v_cmp_ne_u32 vcc, s56, v24
    s_mov_b64 s[82:83], vcc
    s_cmp_eq_u64 s[82:83], 0
    s_cbranch_scc1 P2I_DONE_25
    s_sub_u32 s81, s81, 1
    s_cmp_lg_u32 s81, 0
    s_cbranch_scc1 P2I_LOOP_26
    s_branch P2I_DONE_25
CODE_END:
.section .rodata,"a"
.p2align 6
.amdhsa_kernel recurrent_scan__ssm_conv_h3__dense_activation_gelu__prompt_kernel
  .amdhsa_next_free_vgpr 512
  .amdhsa_next_free_sgpr 102
  .amdhsa_accum_offset 256
  .amdhsa_group_segment_fixed_size 0
  .amdhsa_kernarg_size 112
  .amdhsa_user_sgpr_count 2
  .amdhsa_user_sgpr_kernarg_segment_ptr 1
  .amdhsa_system_sgpr_workgroup_id_x 1
.end_amdhsa_kernel
```

```asm
; @launch grid=(256,1,1) block=(256,1,1) lds=156160
.amdgcn_target "amdgcn-amd-amdhsa--gfx950"
.text
.globl recurrent_scan__ssm_conv_h3__dense_activation_gelu__prompt_kernel
.p2align 12
.type recurrent_scan__ssm_conv_h3__dense_activation_gelu__prompt_kernel,@function
recurrent_scan__ssm_conv_h3__dense_activation_gelu__prompt_kernel:
    s_cmp_ge_u32 s2, 256
    s_cbranch_scc1 EXIT
    s_load_dwordx16 s[4:19], s[0:1], 0
    s_load_dwordx8 s[20:27], s[0:1], 64
    s_load_dwordx4 s[28:31], s[0:1], 96
    v_lshrrev_b32 v1, 6, v0
    s_and_b32 s57, s2, 7
    s_lshr_b32 s58, s2, 3
    s_getpc_b64 s[44:45]
PF_BASE:
    s_mov_b32 s46, CODE_END-PF_BASE
    s_mov_b32 s47, 0x20000
    s_mul_i32 s78, s58, 9
    v_add_u32 v2, s78, v0
    v_lshlrev_b32 v2, 7, v2
    v_cmp_gt_u32 vcc, 9, v0
    v_cndmask_b32 v2, -1, v2, vcc
    buffer_load_dword v47, v2, s[44:47], 0 offen
    v_and_b32 v0, 63, v0
    v_readfirstlane_b32 s3, v1
    s_cmp_ge_u32 s58, 28
    s_cbranch_scc1 IDLE
    s_lshr_b32 s75, s58, 2
    s_and_b32 s76, s58, 3
    s_lshl_b32 s76, s76, 3
    s_add_u32 s76, s76, s57
    v_lshrrev_b32 v15, 4, v0
    s_lshl_b32 s78, s3, 2
    v_add_u32 v15, s78, v15
    v_and_b32 v18, 15, v0
    v_mul_u32_u24 v14, 5120, v15
    v_lshl_add_u32 v14, v18, 3, v14
    s_mul_i32 s78, s76, 81920
    v_add_u32_e64 v14, s78, v14
    v_add_u32 v15, 0xfffff100, v14
    v_add_u32 v16, 0xfffff600, v14
    v_add_u32 v17, 0xfffffb00, v14
    v_lshlrev_b32 v18, 5, v18
    s_lshl_b32 s79, s75, 7
    v_add_u32 v248, s79, v14
    v_add_u32 v249, s79, v15
    v_add_u32 v250, s79, v16
    v_add_u32 v251, s79, v17
    v_lshl_add_u32 v252, s75, 9, v18
    s_lshl_b32 s79, s75, 18
    s_lshl_b32 s80, s76, 7
    s_add_u32 s59, s79, s80
    s_add_u32 s59, s59, 1048576
    s_lshl_b32 s84, s75, 5
    s_add_u32 s84, s84, s76
    s_lshl_b32 s84, s84, 6
    s_add_u32 s84, s84, 131072
    s_waitcnt lgkmcnt(0)
    s_load_dword s56, s[30:31], 0
    s_mov_b32 s32, s4
    s_mov_b32 s33, s5
    s_mov_b32 s34, 2621440
    s_mov_b32 s35, 0x20000
    s_mov_b32 s44, s6
    s_mov_b32 s45, s7
    s_mov_b32 s46, 2621440
    s_mov_b32 s47, 0x20000
    s_mov_b32 s48, s8
    s_mov_b32 s49, s9
    s_mov_b32 s50, 2621440
    s_mov_b32 s51, 0x20000
    s_mov_b32 s52, s10
    s_mov_b32 s53, s11
    s_mov_b32 s54, 5120
    s_mov_b32 s55, 0x20000
    buffer_load_dwordx2 v[96:97], v249, s[44:47], 0 offen nt
    s_lshr_b32 s73, s57, 1
    s_lshl_b32 s73, s73, 2
    s_and_b32 s74, s58, 3
    s_add_u32 s63, s73, s74
    buffer_load_dwordx2 v[98:99], v250, s[44:47], 0 offen nt
    s_and_b32 s73, s57, 1
    s_mul_i32 s73, s73, 7
    s_lshr_b32 s74, s58, 2
    s_add_u32 s64, s73, s74
    buffer_load_dwordx2 v[100:101], v251, s[44:47], 0 offen nt
    s_and_b32 s65, s3, 1
    s_lshr_b32 s66, s3, 1
    s_mul_i32 s73, s63, 163840
    s_mul_i32 s74, s3, 40960
    s_add_u32 s60, s73, s74
    buffer_load_dwordx2 v[102:103], v248, s[44:47], 0 offen offset:0 nt
    s_lshl_b32 s73, s64, 8
    s_mul_i32 s74, s3, 55296
    s_add_u32 s61, s73, s74
    s_lshl_b32 s62, s3, 12
    buffer_load_dwordx2 v[104:105], v248, s[44:47], 0 offen offset:1280 nt
    s_mov_b32 s85, -1152
    s_mov_b32 s86, -1990656
    s_lshr_b32 s73, s58, 2
    s_mul_i32 s73, s73, 10
    s_add_u32 s73, s73, 3
    buffer_load_dwordx2 v[106:107], v248, s[44:47], 0 offen offset:2560 nt
    s_mul_i32 s73, s73, 9363
    s_lshr_b32 s73, s73, 16
    s_and_b32 s74, s58, 3
    s_mul_i32 s74, s74, 5
    buffer_load_dwordx2 v[108:109], v248, s[44:47], 0 offen offset:3840 nt
    s_lshr_b32 s74, s74, 1
    s_add_u32 s73, s73, s74
    s_cmp_ge_u32 s73, 10
    s_cselect_b32 s74, 10, 0
    s_sub_u32 s73, s73, s74
    s_sub_u32 s74, 9, s73
    buffer_load_dwordx4 v[118:121], v252, s[52:55], 0 offen
    s_lshl_b32 s0, 1, s74
    s_lshl_b32 s74, s73, 7
    s_add_u32 s60, s60, s74
    s_mul_i32 s74, s73, 221184
    buffer_load_dwordx4 v[122:125], v252, s[52:55], 0 offen offset:16
    s_add_u32 s61, s61, s74
    v_lshrrev_b32 v1, 3, v0
    v_and_b32 v2, 7, v0
    v_xor_b32 v2, v2, v1
    v_lshlrev_b32_e64 v2, 4, v2
    buffer_load_dwordx2 v[110:111], v248, s[48:51], 0 offen offset:0 nt
    v_mul_u32_u24 v240, 1280, v1
    v_add_u32_e64 v240, v240, v2
    v_add_u32 v241, 9216, v240
    v_add_u32 v242, 18432, v240
    buffer_load_dwordx2 v[112:113], v248, s[48:51], 0 offen offset:1280 nt
    v_add_u32 v243, 27648, v240
    v_lshrrev_b32 v1, 4, v0
    v_and_b32 v2, 15, v0
    v_lshlrev_b32 v3, 1, v1
    v_xor_b32 v2, v2, v3
    buffer_load_dwordx2 v[114:115], v248, s[48:51], 0 offen offset:2560 nt
    v_lshlrev_b32 v2, 4, v2
    v_mul_u32_u24 v3, 3456, v1
    v_add_u32 v244, v3, v2
    v_add_u32 v245, 12800, v244
    buffer_load_dwordx2 v[116:117], v248, s[48:51], 0 offen offset:3840 nt
    v_xor_b32 v2, 128, v2
    v_add_u32_e64 v3, v3, v2
    v_add_u32 v246, 25600, v3
    v_add_u32 v247, 38400, v3
    s_movk_i32 s73, 1280
    s_mov_b32 s42, 0
    s_mov_b64 exec, 0
    s_cmp_eq_u32 s3, 0
    s_cbranch_scc1 PAGE1
    s_cmp_eq_u32 s3, 1
    s_cbranch_scc1 PAGE3
    s_cmp_eq_u32 s3, 2
    s_cbranch_scc1 PAGE5
    s_branch PAGE7
VISIT_RET:
    s_cmp_eq_u32 s42, 1
    s_cbranch_scc1 VISIT_RET_I
    s_mov_b64 exec, -1
    s_lshl_b32 s78, s57, 8
    s_lshl_b32 s79, s58, 3
    s_add_u32 s78, s78, s79
    s_lshl_b32 s79, s3, 1
    s_add_u32 s78, s78, s79
    v_lshrrev_b32 v226, 5, v0
    v_add_u32 v226, s78, v226
    v_and_b32 v227, 31, v0
    v_lshlrev_b32 v227, 3, v227
    v_mad_u32_u24 v227, v226, s73, v227
    v_lshlrev_b32_e64 v226, 3, v226
    buffer_load_dwordx2 v[216:217], v227, s[32:35], 0 offen offset:0
    buffer_load_dwordx2 v[218:219], v227, s[32:35], 0 offen offset:256
    buffer_load_dwordx2 v[220:221], v227, s[32:35], 0 offen offset:512
    buffer_load_dwordx2 v[222:223], v227, s[32:35], 0 offen offset:768
    buffer_load_dwordx2 v[224:225], v227, s[32:35], 0 offen offset:1024
    s_mov_b32 s44, s22
    s_mov_b32 s45, s23
    s_mov_b32 s46, 2211840
    s_mov_b32 s47, 0x20000
    s_mov_b32 s40, s18
    s_mov_b32 s41, s19
    s_mov_b32 s42, 2211840
    s_mov_b32 s43, 0x20000
    s_add_u32 m0, s62, 0
    s_nop 0
    buffer_load_dwordx4 v240, s[32:35], s60 offen offset:0 lds
    s_lshl_b32 s68, s64, 3
    s_lshl_b32 s73, s65, 2
    s_add_u32 s68, s68, s73
    s_lshl_b32 s73, s66, 1
    s_add_u32 s74, s73, 0
    s_and_b32 s74, s74, 3
    s_add_u32 s69, s74, s68
    s_add_u32 s74, s73, 1
    s_and_b32 s74, s74, 3
    s_add_u32 s70, s74, s68
    s_add_u32 s74, s73, 2
    s_and_b32 s74, s74, 3
    s_add_u32 s71, s74, s68
    s_add_u32 s74, s73, 3
    s_and_b32 s74, s74, 3
    s_add_u32 s72, s74, s68
    s_mov_b32 s36, s30
    s_mov_b32 s37, s31
    s_mov_b32 s38, 17563648
    s_mov_b32 s39, 0x20000
    v_and_b32 v203, 15, v0
    v_lshrrev_b32 v204, 5, v0
    s_lshl_b32 s78, s3, 1
    v_add_u32 v204, s78, v204
    v_xor_b32 v204, v204, v203
    v_and_b32 v204, 7, v204
    v_lshlrev_b32_e64 v204, 4, v204
    v_lshl_add_u32 v203, v203, 9, v204
    buffer_load_dwordx4 v241, s[32:35], s60 offen offset:1024 lds
    v_bfe_u32 v204, v0, 4, 1
    v_xor_b32_e64 v204, 1, v204
    v_lshl_add_u32 v203, v204, 3, v203
    v_add_u32 v203, 131584, v203
    s_lshl_b32 s78, s3, 6
    v_add_u32 v205, s78, v0
    v_lshrrev_b32 v206, 3, v205
    v_lshrrev_b32 v204, 5, v205
    v_xor_b32 v204, v204, v205
    v_and_b32 v204, 7, v204
    v_lshlrev_b32_e64 v204, 4, v204
    v_lshl_add_u32 v204, v206, 7, v204
    v_add_u32 v204, 131584, v204
    v_and_b32 v205, 7, v205
    v_lshlrev_b32 v205, 4, v205
    v_lshl_add_u32 v205, v206, 12, v205
    v_add_u32 v206, 0x20000, v205
    s_and_b32 s76, s58, 7
    s_lshl_b32 s77, s57, 2
    s_lshr_b32 s78, s58, 3
    s_add_u32 s77, s77, s78
    s_mul_i32 s78, s77, 40960
    s_mul_i32 s79, s76, 160
    s_add_u32 s78, s78, s79
    s_add_u32 s79, s78, 1310720
    s_cmp_lt_u32 s77, 22
    s_cselect_b32 s79, s79, 2211840
    s_lshl_b32 s80, s3, 6
    v_add_u32 v24, s80, v0
    buffer_load_dwordx4 v242, s[32:35], s60 offen offset:2048 lds
    v_cmp_gt_u32 vcc, 320, v24
    v_subrev_u32 v25, 320, v24
    v_mov_b32 v26, s79
    v_mov_b32 v27, s78
    v_cndmask_b32 v25, v25, v24, vcc
    v_cndmask_b32 v26, v26, v27, vcc
    v_mul_u32_u24 v27, 6554, v25
    v_lshrrev_b32 v27, 16, v27
    v_mul_u32_u24 v28, 10, v27
    v_sub_u32_e64 v28, v25, v28
    v_mul_u32_u24 v27, 1280, v27
    v_lshl_add_u32 v27, v28, 4, v27
    v_add_u32 v253, v27, v26
    v_add_u32 v24, s80, v0
    v_add_u32 v24, 256, v24
    v_cmp_gt_u32 vcc, 320, v24
    v_subrev_u32 v25, 320, v24
    v_mov_b32 v26, s79
    v_mov_b32 v27, s78
    v_cndmask_b32 v25, v25, v24, vcc
    v_cndmask_b32 v26, v26, v27, vcc
    v_mul_u32_u24 v27, 6554, v25
    v_lshrrev_b32 v27, 16, v27
    v_mul_u32_u24 v28, 10, v27
    v_sub_u32_e64 v28, v25, v28
    v_mul_u32_u24 v27, 1280, v27
    v_lshl_add_u32 v27, v28, 4, v27
    v_add_u32 v254, v27, v26
    v_add_u32 v24, s80, v0
    buffer_load_dwordx4 v243, s[32:35], s60 offen offset:3072 lds
    v_add_u32 v24, 512, v24
    v_cmp_gt_u32 vcc, 320, v24
    v_subrev_u32 v25, 320, v24
    v_mov_b32 v26, s79
    v_mov_b32 v27, s78
    v_cndmask_b32 v25, v25, v24, vcc
    v_cndmask_b32 v26, v26, v27, vcc
    v_mul_u32_u24 v27, 6554, v25
    v_lshrrev_b32 v27, 16, v27
    v_mul_u32_u24 v28, 10, v27
    v_sub_u32_e64 v28, v25, v28
    v_mul_u32_u24 v27, 1280, v27
    v_lshl_add_u32 v27, v28, 4, v27
    v_add_u32_e64 v255, v27, v26
    v_mov_b32 v26, 2211840
    v_cmp_gt_u32 vcc, 640, v24
    s_nop 1
    v_cndmask_b32 v255, v26, v255, vcc
    s_and_b32 s77, s58, 7
    s_lshl_b32 s78, s57, 2
    s_lshr_b32 s79, s58, 3
    s_add_u32 s78, s78, s79
    s_mul_i32 s77, s77, 54
    s_add_u32 s77, s77, s78
    s_mul_i32 s77, s77, 5120
    s_add_u32 s77, s77, 4194304
    v_lshrrev_b32_e64 v24, 4, v0
    v_bfe_u32 v25, v0, 2, 2
    s_add_u32 m0, s62, 16384
    s_nop 0
    buffer_load_dwordx4 v244, s[40:43], s61 offen offset:0 lds
    v_lshl_add_u32 v24, v24, 2, v25
    v_mul_u32_u24 v24, 160, v24
    v_and_b32 v25, 3, v0
    s_add_u32 s79, s3, 0
    s_cmp_ge_u32 s79, 5
    s_cselect_b32 s80, 1, 0
    s_mul_i32 s81, s80, 5
    s_sub_u32 s79, s79, s81
    s_mul_i32 s81, s80, 163840
    s_add_u32 s81, s81, s77
    s_lshl_b32 s82, s79, 10
    s_add_u32 s81, s81, s82
    s_cmp_ge_u32 s78, 22
    s_cselect_b32 s82, s80, 0
    s_cmp_ge_u32 s79, 5
    s_cselect_b32 s82, 1, s82
    s_cmp_lg_u32 s82, 0
    s_cselect_b32 s74, 17563648, s81
    s_min_u32 s79, s79, 4
    s_and_b32 s82, s79, 1
    s_lshl_b32 s82, s82, 3
    s_lshr_b32 s83, s79, 1
    s_lshl_b32 s83, s83, 6
    s_add_u32 s82, s82, s83
    s_mul_i32 s83, s80, 5120
    s_add_u32 s82, s82, s83
    s_add_u32 s82, s82, 139776
    s_cmp_eq_u32 s79, 4
    s_cselect_b32 s83, 3, 4
    v_lshlrev_b32 v200, s83, v25
    v_add3_u32 v200, v200, v24, s82
    s_add_u32 s79, s3, 4
    s_cmp_ge_u32 s79, 5
    s_cselect_b32 s80, 1, 0
    buffer_load_dwordx4 v245, s[40:43], s61 offen offset:1024 lds
    s_mul_i32 s81, s80, 5
    s_sub_u32 s79, s79, s81
    s_mul_i32 s81, s80, 163840
    s_add_u32 s81, s81, s77
    s_lshl_b32 s82, s79, 10
    s_add_u32 s81, s81, s82
    s_cmp_ge_u32 s78, 22
    s_cselect_b32 s82, s80, 0
    s_cmp_ge_u32 s79, 5
    s_cselect_b32 s82, 1, s82
    s_cmp_lg_u32 s82, 0
    s_cselect_b32 s75, 17563648, s81
    s_min_u32 s79, s79, 4
    s_and_b32 s82, s79, 1
    s_lshl_b32 s82, s82, 3
    s_lshr_b32 s83, s79, 1
    s_lshl_b32 s83, s83, 6
    s_add_u32 s82, s82, s83
    s_mul_i32 s83, s80, 5120
    s_add_u32 s82, s82, s83
    s_add_u32 s82, s82, 139776
    s_cmp_eq_u32 s79, 4
    s_cselect_b32 s83, 3, 4
    v_lshlrev_b32 v201, s83, v25
    v_add3_u32 v201, v201, v24, s82
    s_add_u32 s79, s3, 8
    s_cmp_ge_u32 s79, 5
    s_cselect_b32 s80, 1, 0
    s_mul_i32 s81, s80, 5
    s_sub_u32 s79, s79, s81
    s_mul_i32 s81, s80, 163840
    s_add_u32 s81, s81, s77
    s_lshl_b32 s82, s79, 10
    s_add_u32 s81, s81, s82
    buffer_load_dwordx4 v246, s[40:43], s61 offen offset:2048 lds
    s_cmp_ge_u32 s78, 22
    s_cselect_b32 s82, s80, 0
    s_cmp_ge_u32 s79, 5
    s_cselect_b32 s82, 1, s82
    s_cmp_lg_u32 s82, 0
    s_cselect_b32 s76, 17563648, s81
    s_min_u32 s79, s79, 4
    s_and_b32 s82, s79, 1
    s_lshl_b32 s82, s82, 3
    s_lshr_b32 s83, s79, 1
    s_lshl_b32 s83, s83, 6
    s_add_u32 s82, s82, s83
    s_mul_i32 s83, s80, 5120
    s_add_u32 s82, s82, s83
    s_add_u32 s82, s82, 139776
    s_cmp_eq_u32 s79, 4
    s_cselect_b32 s83, 3, 4
    v_lshlrev_b32 v202, s83, v25
    v_add3_u32 v202, v202, v24, s82
    v_lshlrev_b32 v14, 4, v0
    v_and_b32 v1, 15, v0
    v_lshrrev_b32 v17, 4, v0
    v_bfe_u32 v18, v0, 2, 2
    v_and_b32 v19, 3, v0
    v_and_b32 v24, 1, v17
    v_lshl_or_b32 v24, v24, 2, v18
    v_lshl_add_u32 v25, v17, 3, v18
    v_lshlrev_b32 v25, 8, v25
    v_lshl_add_u32 v25, v19, 3, v25
    s_and_b32 s73, s69, 7
    v_xor_b32_e64 v26, s73, v24
    v_lshl_add_u32 v2, v26, 5, v25
    buffer_load_dwordx4 v247, s[40:43], s61 offen offset:3072 lds
    v_add_u32 v6, 0x10000, v2
    s_and_b32 s73, s70, 7
    v_xor_b32 v26, s73, v24
    v_lshl_add_u32 v3, v26, 5, v25
    v_add_u32 v7, 0x10000, v3
    s_and_b32 s73, s71, 7
    v_xor_b32 v26, s73, v24
    v_lshl_add_u32 v4, v26, 5, v25
    v_add_u32 v8, 0x10000, v4
    s_and_b32 s73, s72, 7
    v_xor_b32 v26, s73, v24
    v_lshl_add_u32 v5, v26, 5, v25
    v_add_u32 v9, 0x10000, v5
    s_lshl_b32 s73, s66, 13
    v_and_b32 v24, 7, v1
    v_xor_b32 v24, v24, v17
    v_lshlrev_b32 v24, 4, v24
    v_lshl_add_u32 v24, v1, 7, v24
    v_add_u32 v10, s73, v24
    v_xor_b32 v11, 64, v10
    v_add_u32 v12, 0x10000, v10
    v_add_u32 v13, 0x10000, v11
    v_mov_b32 v20, 0x3f803f80
    v_mov_b32 v21, 0x3f803f80
    v_mov_b32 v22, 0x3f803f80
    v_mov_b32 v23, 0x3f803f80
    s_lshl_b32 s67, s63, 7
    s_lshl_b32 s73, s66, 6
    s_add_u32 s67, s67, s73
    s_bitcmp1_b32 s0, 0
    s_cselect_b32 s87, s85, 128
    s_cselect_b32 s88, s86, 221184
    s_add_u32 s60, s60, s87
    s_add_u32 s61, s61, s88
    s_add_u32 m0, s62, 32768
    s_nop 0
    buffer_load_dwordx4 v240, s[32:35], s60 offen offset:0 lds
    s_waitcnt vmcnt(18)
    v_lshlrev_b32 v144, 16, v118
    v_and_b32 v148, 0xffff0000, v118
    v_lshlrev_b32 v145, 16, v122
    v_and_b32 v149, 0xffff0000, v122
    v_lshlrev_b32 v146, 16, v120
    v_and_b32 v150, 0xffff0000, v120
    v_lshlrev_b32 v147, 16, v124
    v_and_b32 v151, 0xffff0000, v124
    v_lshlrev_b32 v152, 16, v119
    v_and_b32 v156, 0xffff0000, v119
    v_lshlrev_b32 v153, 16, v123
    v_and_b32 v157, 0xffff0000, v123
    v_lshlrev_b32 v154, 16, v121
    v_and_b32 v158, 0xffff0000, v121
    v_lshlrev_b32 v155, 16, v125
    buffer_load_dwordx4 v241, s[32:35], s60 offen offset:1024 lds
    v_and_b32 v159, 0xffff0000, v125
    v_lshlrev_b32 v128, 16, v96
    v_and_b32 v96, 0xffff0000, v96
    v_lshlrev_b32 v129, 16, v97
    v_and_b32 v97, 0xffff0000, v97
    v_lshlrev_b32 v130, 16, v98
    v_and_b32 v98, 0xffff0000, v98
    v_lshlrev_b32 v131, 16, v99
    v_and_b32 v99, 0xffff0000, v99
    v_lshlrev_b32 v132, 16, v100
    v_and_b32 v100, 0xffff0000, v100
    v_lshlrev_b32 v133, 16, v101
    v_and_b32 v101, 0xffff0000, v101
    v_lshlrev_b32 v134, 16, v102
    v_and_b32 v102, 0xffff0000, v102
    v_lshlrev_b32 v135, 16, v103
    buffer_load_dwordx4 v242, s[32:35], s60 offen offset:2048 lds
    v_and_b32 v103, 0xffff0000, v103
    v_lshlrev_b32 v136, 16, v104
    v_and_b32 v104, 0xffff0000, v104
    v_lshlrev_b32 v137, 16, v105
    v_and_b32 v105, 0xffff0000, v105
    v_lshlrev_b32 v138, 16, v106
    v_and_b32 v106, 0xffff0000, v106
    v_lshlrev_b32 v139, 16, v107
    v_and_b32 v107, 0xffff0000, v107
    v_lshlrev_b32 v140, 16, v108
    v_and_b32 v108, 0xffff0000, v108
    v_lshlrev_b32 v141, 16, v109
    v_and_b32 v109, 0xffff0000, v109
    v_pk_mul_f32 v[160:161], v[134:135], v[144:145]
    v_pk_mul_f32 v[162:163], v[102:103], v[146:147]
    v_pk_mul_f32 v[164:165], v[136:137], v[144:145]
    buffer_load_dwordx4 v243, s[32:35], s60 offen offset:3072 lds
    v_pk_mul_f32 v[166:167], v[104:105], v[146:147]
    v_pk_mul_f32 v[168:169], v[138:139], v[144:145]
    v_pk_mul_f32 v[170:171], v[106:107], v[146:147]
    v_pk_mul_f32 v[172:173], v[140:141], v[144:145]
    v_pk_mul_f32 v[174:175], v[108:109], v[146:147]
    v_pk_fma_f32 v[160:161], v[132:133], v[148:149], v[160:161]
    v_pk_fma_f32 v[162:163], v[100:101], v[150:151], v[162:163]
    v_pk_fma_f32 v[164:165], v[134:135], v[148:149], v[164:165]
    v_pk_fma_f32 v[166:167], v[102:103], v[150:151], v[166:167]
    v_pk_fma_f32 v[168:169], v[136:137], v[148:149], v[168:169]
    v_pk_fma_f32 v[170:171], v[104:105], v[150:151], v[170:171]
    v_pk_fma_f32 v[172:173], v[138:139], v[148:149], v[172:173]
    v_pk_fma_f32 v[174:175], v[106:107], v[150:151], v[174:175]
    v_pk_fma_f32 v[160:161], v[130:131], v[152:153], v[160:161]
    v_pk_fma_f32 v[162:163], v[98:99], v[154:155], v[162:163]
    v_pk_fma_f32 v[164:165], v[132:133], v[152:153], v[164:165]
    s_add_u32 m0, s62, 49152
    s_nop 0
    s_nop 0
    buffer_load_dwordx4 v244, s[40:43], s61 offen offset:0 lds
    v_pk_fma_f32 v[166:167], v[100:101], v[154:155], v[166:167]
    v_pk_fma_f32 v[168:169], v[134:135], v[152:153], v[168:169]
    v_pk_fma_f32 v[170:171], v[102:103], v[154:155], v[170:171]
    v_pk_fma_f32 v[172:173], v[136:137], v[152:153], v[172:173]
    v_pk_fma_f32 v[174:175], v[104:105], v[154:155], v[174:175]
    v_pk_fma_f32 v[160:161], v[128:129], v[156:157], v[160:161]
    v_pk_fma_f32 v[162:163], v[96:97], v[158:159], v[162:163]
    v_pk_fma_f32 v[164:165], v[130:131], v[156:157], v[164:165]
    v_pk_fma_f32 v[166:167], v[98:99], v[158:159], v[166:167]
    v_pk_fma_f32 v[168:169], v[132:133], v[156:157], v[168:169]
    v_pk_fma_f32 v[170:171], v[100:101], v[158:159], v[170:171]
    v_pk_fma_f32 v[172:173], v[134:135], v[156:157], v[172:173]
    v_pk_fma_f32 v[174:175], v[102:103], v[158:159], v[174:175]
    s_waitcnt vmcnt(18)
    v_lshlrev_b32 v128, 16, v110
    v_and_b32 v110, 0xffff0000, v110
    buffer_load_dwordx4 v245, s[40:43], s61 offen offset:1024 lds
    v_lshlrev_b32 v129, 16, v111
    v_and_b32 v111, 0xffff0000, v111
    v_lshlrev_b32 v130, 16, v112
    v_and_b32 v112, 0xffff0000, v112
    v_lshlrev_b32 v131, 16, v113
    v_and_b32 v113, 0xffff0000, v113
    v_lshlrev_b32 v132, 16, v114
    v_and_b32 v114, 0xffff0000, v114
    v_lshlrev_b32 v133, 16, v115
    v_and_b32 v115, 0xffff0000, v115
    v_lshlrev_b32 v134, 16, v116
    v_and_b32 v116, 0xffff0000, v116
    v_lshlrev_b32_e64 v135, 16, v117
    v_and_b32 v117, 0xffff0000, v117
    v_pk_mul_f32 v[160:161], v[160:161], v[128:129]
    v_pk_mul_f32 v[162:163], v[162:163], v[110:111]
    buffer_load_dwordx4 v246, s[40:43], s61 offen offset:2048 lds
    v_pk_mul_f32 v[164:165], v[164:165], v[130:131]
    v_pk_mul_f32 v[166:167], v[166:167], v[112:113]
    v_pk_mul_f32 v[168:169], v[168:169], v[132:133]
    v_pk_mul_f32 v[170:171], v[170:171], v[114:115]
    v_pk_mul_f32 v[172:173], v[172:173], v[134:135]
    v_pk_mul_f32 v[174:175], v[174:175], v[116:117]
    v_cvt_pk_bf16_f32 v144, v172, v168
    v_cvt_pk_bf16_f32 v145, v164, v160
    v_cvt_pk_bf16_f32 v146, v174, v170
    v_cvt_pk_bf16_f32 v147, v166, v162
    v_cvt_pk_bf16_f32 v148, v173, v169
    v_cvt_pk_bf16_f32 v149, v165, v161
    v_cvt_pk_bf16_f32 v150, v175, v171
    v_cvt_pk_bf16_f32 v151, v167, v163
    ds_write_b64 v203, v[144:145] offset:0
    ds_write_b64 v203, v[146:147] offset:128
    buffer_load_dwordx4 v247, s[40:43], s61 offen offset:3072 lds
    ds_write_b64 v203, v[148:149] offset:256
    ds_write_b64 v203, v[150:151] offset:384
    s_waitcnt vmcnt(16)
    s_mov_b32 s78, 0x3f803f80
    v_mov_b32 v228, 0
    v_mov_b32 v229, 0
    v_dot2c_f32_bf16 v228, s78, v216
    v_dot2c_f32_bf16 v229, v216, v216
    v_dot2c_f32_bf16 v228, s78, v217
    v_dot2c_f32_bf16 v229, v217, v217
    v_dot2c_f32_bf16 v228, s78, v218
    v_dot2c_f32_bf16 v229, v218, v218
    v_dot2c_f32_bf16 v228, s78, v219
    v_dot2c_f32_bf16 v229, v219, v219
    v_dot2c_f32_bf16 v228, s78, v220
PAGE1:
    s_cbranch_execz PAGE2
    v_dot2c_f32_bf16 v229, v220, v220
    v_dot2c_f32_bf16 v228, s78, v221
    s_bitcmp1_b32 s0, 1
    s_cselect_b32 s87, s85, 128
    s_cselect_b32 s88, s86, 221184
    s_add_u32 s60, s60, s87
    s_add_u32 s61, s61, s88
    v_dot2c_f32_bf16 v229, v221, v221
    v_dot2c_f32_bf16 v228, s78, v222
    v_dot2c_f32_bf16 v229, v222, v222
    v_dot2c_f32_bf16 v228, s78, v223
    v_dot2c_f32_bf16 v229, v223, v223
    v_dot2c_f32_bf16 v228, s78, v224
    v_dot2c_f32_bf16 v229, v224, v224
    v_dot2c_f32_bf16 v228, s78, v225
    v_dot2c_f32_bf16 v229, v225, v225
    s_nop 1
    v_add_f32_dpp v228, v228, v228 row_ror:8 row_mask:0xf bank_mask:0xf
    v_add_f32_dpp v229, v229, v229 row_ror:8 row_mask:0xf bank_mask:0xf
    s_nop 1
    v_add_f32_dpp v228, v228, v228 row_ror:4 row_mask:0xf bank_mask:0xf
    v_add_f32_dpp v229, v229, v229 row_ror:4 row_mask:0xf bank_mask:0xf
    s_nop 1
    v_add_f32_dpp v228, v228, v228 row_ror:2 row_mask:0xf bank_mask:0xf
    v_add_f32_dpp v229, v229, v229 row_ror:2 row_mask:0xf bank_mask:0xf
    s_nop 1
    v_add_f32_dpp v228, v228, v228 row_ror:1 row_mask:0xf bank_mask:0xf
    v_add_f32_dpp v229, v229, v229 row_ror:1 row_mask:0xf bank_mask:0xf
    s_nop 1
    v_add_f32_dpp v228, v228, v228 row_bcast:15 row_mask:0xa bank_mask:0xf
    v_add_f32_dpp v229, v229, v229 row_bcast:15 row_mask:0xa bank_mask:0xf
    s_nop 0
    v_mul_f32 v230, 0x3acccccd, v228
    v_mul_f32 v229, 0x3acccccd, v229
    v_fma_f32 v229, -v230, v230, v229
    v_max_f32 v229, 0, v229
    v_add_f32 v229, 0x3727c5ac, v229
    v_rsq_f32_e64 v231, v229
    s_mov_b32 s78, 65536
    s_mov_b32 exec_lo, 0x10000
    s_mov_b32 exec_hi, 0x10000
    buffer_store_dwordx2 v[230:231], v226, s[36:39], s78 offen sc1
    s_mov_b64 exec, -1
    s_waitcnt vmcnt(9) lgkmcnt(0)
    s_barrier
    s_add_u32 s56, s56, 2654435769
    v_mov_b32 v31, s56
    ds_read_b128 v[48:51], v10 offset:0
    ds_read_b64_tr_b16 v[32:33], v2 offset:16384
    ds_read_b64_tr_b16 v[34:35], v2 offset:17408
    ds_read_b128 v[52:55], v10 offset:2048
    ds_read_b64_tr_b16 v[36:37], v3 offset:16384
    ds_read_b64_tr_b16 v[38:39], v3 offset:17408
    ds_read_b128 v[56:59], v10 offset:4096
    ds_read_b64_tr_b16 v[40:41], v4 offset:16384
    ds_read_b64_tr_b16 v[42:43], v4 offset:17408
    ds_read_b128 v[60:63], v10 offset:6144
    ds_read_b64_tr_b16 v[44:45], v5 offset:16384
    ds_read_b64_tr_b16 v[46:47], v5 offset:17408
    ds_read_b128 v[96:99], v204 offset:0
    ds_read_b128 v[100:103], v204 offset:4096
    s_add_u32 m0, s62, 65536
    s_nop 0
    buffer_load_dwordx4 v240, s[32:35], s60 offen offset:0 lds
    buffer_load_dwordx4 v241, s[32:35], s60 offen offset:1024 lds
    buffer_load_dwordx4 v242, s[32:35], s60 offen offset:2048 lds
    buffer_load_dwordx4 v243, s[32:35], s60 offen offset:3072 lds
    s_waitcnt lgkmcnt(0)
    v_mfma_f32_16x16x32_bf16 v[128:131], v[32:35], v[48:51], 0
    ds_read_b128 v[80:83], v11 offset:0
    buffer_store_dwordx4 v[96:99], v205, s[36:39], s59 offen sc1
    v_mfma_f32_16x16x32_bf16 v[132:135], v[32:35], v[52:55], 0
    ds_read_b64_tr_b16 v[64:65], v2 offset:24576
    buffer_store_dwordx4 v[100:103], v206, s[36:39], s59 offen sc1
    v_mfma_f32_16x16x32_bf16 v[136:139], v[32:35], v[56:59], 0
    ds_read_b64_tr_b16 v[66:67], v2 offset:25600
    v_mfma_f32_16x16x32_bf16 v[140:143], v[32:35], v[60:63], 0
    ds_read_b128 v[84:87], v11 offset:2048
    v_mfma_f32_16x16x32_bf16 v[192:195], v[32:35], v[20:23], 0
    ds_read_b64_tr_b16 v[68:69], v3 offset:24576
    v_mfma_f32_16x16x32_bf16 v[144:147], v[36:39], v[48:51], 0
    ds_read_b64_tr_b16 v[70:71], v3 offset:25600
    s_add_u32 m0, s62, 81920
    v_mfma_f32_16x16x32_bf16 v[148:151], v[36:39], v[52:55], 0
    ds_read_b128 v[88:91], v11 offset:4096
    v_mfma_f32_16x16x32_bf16 v[152:155], v[36:39], v[56:59], 0
    ds_read_b64_tr_b16 v[72:73], v4 offset:24576
    buffer_load_dwordx4 v244, s[40:43], s61 offen offset:0 lds
    v_mfma_f32_16x16x32_bf16 v[156:159], v[36:39], v[60:63], 0
    ds_read_b64_tr_b16 v[74:75], v4 offset:25600
    v_mfma_f32_16x16x32_bf16 v[196:199], v[36:39], v[20:23], 0
    ds_read_b128 v[92:95], v11 offset:6144
    v_mfma_f32_16x16x32_bf16 v[160:163], v[40:43], v[48:51], 0
    ds_read_b64_tr_b16 v[76:77], v5 offset:24576
    buffer_load_dwordx4 v245, s[40:43], s61 offen offset:1024 lds
    v_mfma_f32_16x16x32_bf16 v[164:167], v[40:43], v[52:55], 0
    ds_read_b64_tr_b16 v[78:79], v5 offset:25600
    v_mfma_f32_16x16x32_bf16 v[168:171], v[40:43], v[56:59], 0
    v_mfma_f32_16x16x32_bf16 v[172:175], v[40:43], v[60:63], 0
    buffer_load_dwordx4 v246, s[40:43], s61 offen offset:2048 lds
    v_mfma_f32_16x16x32_bf16 v[176:179], v[44:47], v[48:51], 0
    v_mfma_f32_16x16x32_bf16 v[180:183], v[44:47], v[52:55], 0
    buffer_load_dwordx4 v247, s[40:43], s61 offen offset:3072 lds
    s_bitcmp1_b32 s0, 2
    s_cselect_b32 s87, s85, 128
    s_cselect_b32 s88, s86, 221184
    v_mfma_f32_16x16x32_bf16 v[184:187], v[44:47], v[56:59], 0
    s_add_u32 s60, s60, s87
    v_mfma_f32_16x16x32_bf16 v[188:191], v[44:47], v[60:63], 0
    s_add_u32 s61, s61, s88
    s_waitcnt vmcnt(11) lgkmcnt(0)
    s_barrier
    s_nop 0
    v_mfma_f32_16x16x32_bf16 v[128:131], v[64:67], v[80:83], v[128:131]
    ds_read_b128 v[48:51], v10 offset:32768
    s_add_u32 m0, s62, 98304
    v_mfma_f32_16x16x32_bf16 v[132:135], v[64:67], v[84:87], v[132:135]
    ds_read_b64_tr_b16 v[32:33], v2 offset:49152
    v_mov_b32 v30, 17563648
    v_mfma_f32_16x16x32_bf16 v[136:139], v[64:67], v[88:91], v[136:139]
    ds_read_b64_tr_b16 v[34:35], v2 offset:50176
    buffer_load_dwordx4 v240, s[32:35], s60 offen offset:0 lds
    v_mfma_f32_16x16x32_bf16 v[140:143], v[64:67], v[92:95], v[140:143]
    ds_read_b128 v[52:55], v10 offset:34816
    s_cmp_eq_u32 s3, 0
    s_nop 0
    s_cselect_b32 s80, s84, 17563648
    v_mfma_f32_16x16x32_bf16 v[192:195], v[64:67], v[20:23], v[192:195]
    ds_read_b64_tr_b16 v[36:37], v3 offset:49152
    v_mfma_f32_16x16x32_bf16 v[144:147], v[68:71], v[80:83], v[144:147]
    ds_read_b64_tr_b16 v[38:39], v3 offset:50176
    v_mfma_f32_16x16x32_bf16 v[148:151], v[68:71], v[84:87], v[148:151]
    ds_read_b128 v[56:59], v10 offset:36864
    buffer_load_dwordx4 v241, s[32:35], s60 offen offset:1024 lds
    v_mfma_f32_16x16x32_bf16 v[152:155], v[68:71], v[88:91], v[152:155]
    ds_read_b64_tr_b16 v[40:41], v4 offset:49152
    v_writelane_b32 v30, s80, 1
    v_mfma_f32_16x16x32_bf16 v[156:159], v[68:71], v[92:95], v[156:159]
    ds_read_b64_tr_b16 v[42:43], v4 offset:50176
    v_mfma_f32_16x16x32_bf16 v[196:199], v[68:71], v[20:23], v[196:199]
    ds_read_b128 v[60:63], v10 offset:38912
    s_lshl_b32 s77, s57, 1
    v_mfma_f32_16x16x32_bf16 v[160:163], v[72:75], v[80:83], v[160:163]
    ds_read_b64_tr_b16 v[44:45], v5 offset:49152
    s_lshr_b32 s78, s58, 4
    v_mfma_f32_16x16x32_bf16 v[164:167], v[72:75], v[84:87], v[164:167]
    ds_read_b64_tr_b16 v[46:47], v5 offset:50176
    buffer_load_dwordx4 v242, s[32:35], s60 offen offset:2048 lds
    v_mfma_f32_16x16x32_bf16 v[168:171], v[72:75], v[88:91], v[168:171]
    s_add_u32 s77, s77, s78
    v_mfma_f32_16x16x32_bf16 v[172:175], v[72:75], v[92:95], v[172:175]
    s_lshl_b32 s77, s77, 4
    v_mfma_f32_16x16x32_bf16 v[176:179], v[76:79], v[80:83], v[176:179]
    s_and_b32 s78, s58, 15
    v_mfma_f32_16x16x32_bf16 v[180:183], v[76:79], v[84:87], v[180:183]
    buffer_load_dwordx4 v243, s[32:35], s60 offen offset:3072 lds
    s_add_u32 s77, s77, s78
    v_mfma_f32_16x16x32_bf16 v[184:187], v[76:79], v[88:91], v[184:187]
    s_lshl_b32 s77, s77, 6
    v_mfma_f32_16x16x32_bf16 v[188:191], v[76:79], v[92:95], v[188:191]
    s_add_u32 s77, s77, 196608
    s_waitcnt lgkmcnt(0)
    v_mfma_f32_16x16x32_bf16 v[128:131], v[32:35], v[48:51], v[128:131]
    ds_read_b128 v[80:83], v11 offset:32768
    s_add_u32 m0, s62, 114688
    v_mfma_f32_16x16x32_bf16 v[132:135], v[32:35], v[52:55], v[132:135]
    ds_read_b64_tr_b16 v[64:65], v2 offset:57344
    s_cmp_eq_u32 s3, 0
    s_nop 0
    s_cselect_b32 s77, s77, 17563648
    v_mfma_f32_16x16x32_bf16 v[136:139], v[32:35], v[56:59], v[136:139]
    ds_read_b64_tr_b16 v[66:67], v2 offset:58368
    buffer_load_dwordx4 v244, s[40:43], s61 offen offset:0 lds
    v_mfma_f32_16x16x32_bf16 v[140:143], v[32:35], v[60:63], v[140:143]
    ds_read_b128 v[84:87], v11 offset:34816
    v_mfma_f32_16x16x32_bf16 v[192:195], v[32:35], v[20:23], v[192:195]
    ds_read_b64_tr_b16 v[68:69], v3 offset:57344
    v_writelane_b32 v30, s77, 0
    v_mfma_f32_16x16x32_bf16 v[144:147], v[36:39], v[48:51], v[144:147]
    ds_read_b64_tr_b16 v[70:71], v3 offset:58368
    s_and_b32 s77, s58, 7
    v_mfma_f32_16x16x32_bf16 v[148:151], v[36:39], v[52:55], v[148:151]
    ds_read_b128 v[88:91], v11 offset:36864
    buffer_load_dwordx4 v245, s[40:43], s61 offen offset:1024 lds
    v_mfma_f32_16x16x32_bf16 v[152:155], v[36:39], v[56:59], v[152:155]
    ds_read_b64_tr_b16 v[72:73], v4 offset:57344
    s_lshl_b32 s77, s77, 5
    v_mfma_f32_16x16x32_bf16 v[156:159], v[36:39], v[60:63], v[156:159]
    ds_read_b64_tr_b16 v[74:75], v4 offset:58368
    s_lshl_b32 s78, s57, 2
    v_mfma_f32_16x16x32_bf16 v[196:199], v[36:39], v[20:23], v[196:199]
    ds_read_b128 v[92:95], v11 offset:38912
    s_lshr_b32 s79, s58, 3
    v_mfma_f32_16x16x32_bf16 v[160:163], v[40:43], v[48:51], v[160:163]
    ds_read_b64_tr_b16 v[76:77], v5 offset:57344
    buffer_load_dwordx4 v246, s[40:43], s61 offen offset:2048 lds
    v_mfma_f32_16x16x32_bf16 v[164:167], v[40:43], v[52:55], v[164:167]
    ds_read_b64_tr_b16 v[78:79], v5 offset:58368
    s_add_u32 s78, s78, s79
    v_mfma_f32_16x16x32_bf16 v[168:171], v[40:43], v[56:59], v[168:171]
    s_add_u32 s77, s77, s78
    s_lshl_b32 s77, s77, 6
    v_mfma_f32_16x16x32_bf16 v[172:175], v[40:43], v[60:63], v[172:175]
    buffer_load_dwordx4 v247, s[40:43], s61 offen offset:3072 lds
    s_add_u32 s77, s77, 163840
    v_mfma_f32_16x16x32_bf16 v[176:179], v[44:47], v[48:51], v[176:179]
    s_cmp_eq_u32 s3, 0
    s_cselect_b32 s77, s77, 17563648
    v_mfma_f32_16x16x32_bf16 v[180:183], v[44:47], v[52:55], v[180:183]
    s_bitcmp1_b32 s0, 3
    s_cselect_b32 s87, s85, 128
    s_cselect_b32 s88, s86, 221184
    v_mfma_f32_16x16x32_bf16 v[184:187], v[44:47], v[56:59], v[184:187]
    s_add_u32 s60, s60, s87
    v_writelane_b32 v30, s77, 2
    v_mfma_f32_16x16x32_bf16 v[188:191], v[44:47], v[60:63], v[188:191]
    s_add_u32 s61, s61, s88
    s_waitcnt vmcnt(8) lgkmcnt(0)
    s_barrier
    s_mov_b32 exec_lo, 3
    s_mov_b32 exec_hi, 0
    buffer_store_dword v31, v30, s[36:39], 0 offen sc1
    s_mov_b64 exec, -1
    v_mfma_f32_16x16x32_bf16 v[128:131], v[64:67], v[80:83], v[128:131]
    ds_read_b128 v[48:51], v12 offset:0
    s_lshl_b32 m0, s3, 10
    s_add_u32 m0, m0, 139776
    s_nop 0
    buffer_load_dwordx4 v253, s[44:47], 0 offen nt lds
    v_mfma_f32_16x16x32_bf16 v[132:135], v[64:67], v[84:87], v[132:135]
    ds_read_b64_tr_b16 v[32:33], v6 offset:16384
    s_lshl_b32 m0, s3, 10
    s_add_u32 m0, m0, 143872
    s_nop 0
    buffer_load_dwordx4 v254, s[44:47], 0 offen nt lds
    v_mfma_f32_16x16x32_bf16 v[136:139], v[64:67], v[88:91], v[136:139]
    ds_read_b64_tr_b16 v[34:35], v6 offset:17408
    s_lshl_b32 m0, s3, 10
    s_add_u32 m0, m0, 147968
    s_nop 0
    buffer_load_dwordx4 v255, s[44:47], 0 offen nt lds
    v_mfma_f32_16x16x32_bf16 v[140:143], v[64:67], v[92:95], v[140:143]
    ds_read_b128 v[52:55], v12 offset:2048
    v_min_u32_e64 v28, 15, v0
    v_mfma_f32_16x16x32_bf16 v[192:195], v[64:67], v[20:23], v[192:195]
    ds_read_b64_tr_b16 v[36:37], v7 offset:16384
    v_mfma_f32_16x16x32_bf16 v[144:147], v[68:71], v[80:83], v[144:147]
    ds_read_b64_tr_b16 v[38:39], v7 offset:17408
    s_add_u32 m0, s62, 0
    v_mfma_f32_16x16x32_bf16 v[148:151], v[68:71], v[84:87], v[148:151]
    ds_read_b128 v[56:59], v12 offset:4096
    v_lshlrev_b32 v28, 6, v28
    v_mfma_f32_16x16x32_bf16 v[152:155], v[68:71], v[88:91], v[152:155]
    ds_read_b64_tr_b16 v[40:41], v8 offset:16384
    buffer_load_dwordx4 v240, s[32:35], s60 offen offset:0 lds
    v_mfma_f32_16x16x32_bf16 v[156:159], v[68:71], v[92:95], v[156:159]
    ds_read_b64_tr_b16 v[42:43], v8 offset:17408
    v_mfma_f32_16x16x32_bf16 v[196:199], v[68:71], v[20:23], v[196:199]
    ds_read_b128 v[60:63], v12 offset:6144
    v_mfma_f32_16x16x32_bf16 v[160:163], v[72:75], v[80:83], v[160:163]
    ds_read_b64_tr_b16 v[44:45], v9 offset:16384
    buffer_load_dwordx4 v241, s[32:35], s60 offen offset:1024 lds
    v_mfma_f32_16x16x32_bf16 v[164:167], v[72:75], v[84:87], v[164:167]
    ds_read_b64_tr_b16 v[46:47], v9 offset:17408
    s_lshl_b32 s73, s63, 10
    v_mfma_f32_16x16x32_bf16 v[168:171], v[72:75], v[88:91], v[168:171]
    v_mfma_f32_16x16x32_bf16 v[172:175], v[72:75], v[92:95], v[172:175]
    buffer_load_dwordx4 v242, s[32:35], s60 offen offset:2048 lds
    s_add_u32 s73, s73, 196608
    v_mfma_f32_16x16x32_bf16 v[176:179], v[76:79], v[80:83], v[176:179]
    v_add_u32 v28, s73, v28
    v_mfma_f32_16x16x32_bf16 v[180:183], v[76:79], v[84:87], v[180:183]
    buffer_load_dwordx4 v243, s[32:35], s60 offen offset:3072 lds
    v_mfma_f32_16x16x32_bf16 v[184:187], v[76:79], v[88:91], v[184:187]
    s_mov_b32 s48, s20
    v_mfma_f32_16x16x32_bf16 v[188:191], v[76:79], v[92:95], v[188:191]
    s_waitcnt lgkmcnt(0)
    v_mfma_f32_16x16x32_bf16 v[128:131], v[32:35], v[48:51], v[128:131]
    ds_read_b128 v[80:83], v13 offset:0
    s_add_u32 m0, s62, 16384
    v_mfma_f32_16x16x32_bf16 v[132:135], v[32:35], v[52:55], v[132:135]
    ds_read_b64_tr_b16 v[64:65], v6 offset:24576
    s_mov_b32 s49, s21
    s_nop 0
    v_mfma_f32_16x16x32_bf16 v[136:139], v[32:35], v[56:59], v[136:139]
    ds_read_b64_tr_b16 v[66:67], v6 offset:25600
    buffer_load_dwordx4 v244, s[40:43], s61 offen offset:0 lds
    v_mfma_f32_16x16x32_bf16 v[140:143], v[32:35], v[60:63], v[140:143]
    ds_read_b128 v[84:87], v13 offset:2048
    v_mfma_f32_16x16x32_bf16 v[192:195], v[32:35], v[20:23], v[192:195]
    ds_read_b64_tr_b16 v[68:69], v7 offset:24576
    s_mov_b32 s50, 3456
    v_mfma_f32_16x16x32_bf16 v[144:147], v[36:39], v[48:51], v[144:147]
    ds_read_b64_tr_b16 v[70:71], v7 offset:25600
    v_mfma_f32_16x16x32_bf16 v[148:151], v[36:39], v[52:55], v[148:151]
    ds_read_b128 v[88:91], v13 offset:4096
    buffer_load_dwordx4 v245, s[40:43], s61 offen offset:1024 lds
    v_mfma_f32_16x16x32_bf16 v[152:155], v[36:39], v[56:59], v[152:155]
    ds_read_b64_tr_b16 v[72:73], v8 offset:24576
    v_mfma_f32_16x16x32_bf16 v[156:159], v[36:39], v[60:63], v[156:159]
    ds_read_b64_tr_b16 v[74:75], v8 offset:25600
    s_mov_b32 s51, 0x20000
    v_mfma_f32_16x16x32_bf16 v[196:199], v[36:39], v[20:23], v[196:199]
    ds_read_b128 v[92:95], v13 offset:6144
    v_mfma_f32_16x16x32_bf16 v[160:163], v[40:43], v[48:51], v[160:163]
    ds_read_b64_tr_b16 v[76:77], v9 offset:24576
    buffer_load_dwordx4 v246, s[40:43], s61 offen offset:2048 lds
    v_mfma_f32_16x16x32_bf16 v[164:167], v[40:43], v[52:55], v[164:167]
    ds_read_b64_tr_b16 v[78:79], v9 offset:25600
    v_lshrrev_b32 v24, 4, v0
    v_mfma_f32_16x16x32_bf16 v[168:171], v[40:43], v[56:59], v[168:171]
    v_mfma_f32_16x16x32_bf16 v[172:175], v[40:43], v[60:63], v[172:175]
    buffer_load_dwordx4 v247, s[40:43], s61 offen offset:3072 lds
    s_lshl_b32 s73, s69, 5
    v_mfma_f32_16x16x32_bf16 v[176:179], v[44:47], v[48:51], v[176:179]
    v_lshl_add_u32 v232, v24, 3, s73
    v_mfma_f32_16x16x32_bf16 v[180:183], v[44:47], v[52:55], v[180:183]
    s_bitcmp1_b32 s0, 4
    s_cselect_b32 s87, s85, 128
    s_cselect_b32 s88, s86, 221184
    v_mfma_f32_16x16x32_bf16 v[184:187], v[44:47], v[56:59], v[184:187]
    s_add_u32 s60, s60, s87
    v_mfma_f32_16x16x32_bf16 v[188:191], v[44:47], v[60:63], v[188:191]
    s_add_u32 s61, s61, s88
    s_waitcnt vmcnt(12) lgkmcnt(0)
    s_barrier
    v_mfma_f32_16x16x32_bf16 v[128:131], v[64:67], v[80:83], v[128:131]
    ds_read_b128 v[48:51], v12 offset:32768
    s_add_u32 m0, s62, 32768
    v_mfma_f32_16x16x32_bf16 v[132:135], v[64:67], v[84:87], v[132:135]
    ds_read_b64_tr_b16 v[32:33], v6 offset:49152
    s_lshl_b32 s73, s70, 5
    v_mfma_f32_16x16x32_bf16 v[136:139], v[64:67], v[88:91], v[136:139]
    ds_read_b64_tr_b16 v[34:35], v6 offset:50176
    buffer_load_dwordx4 v240, s[32:35], s60 offen offset:0 lds
    v_mfma_f32_16x16x32_bf16 v[140:143], v[64:67], v[92:95], v[140:143]
    ds_read_b128 v[52:55], v12 offset:34816
    v_mfma_f32_16x16x32_bf16 v[192:195], v[64:67], v[20:23], v[192:195]
    ds_read_b64_tr_b16 v[36:37], v7 offset:49152
    v_mfma_f32_16x16x32_bf16 v[144:147], v[68:71], v[80:83], v[144:147]
    ds_read_b64_tr_b16 v[38:39], v7 offset:50176
    v_lshl_add_u32 v233, v24, 3, s73
    v_mfma_f32_16x16x32_bf16 v[148:151], v[68:71], v[84:87], v[148:151]
    ds_read_b128 v[56:59], v12 offset:36864
    buffer_load_dwordx4 v241, s[32:35], s60 offen offset:1024 lds
    v_mfma_f32_16x16x32_bf16 v[152:155], v[68:71], v[88:91], v[152:155]
    ds_read_b64_tr_b16 v[40:41], v8 offset:49152
    v_mfma_f32_16x16x32_bf16 v[156:159], v[68:71], v[92:95], v[156:159]
    ds_read_b64_tr_b16 v[42:43], v8 offset:50176
    v_mfma_f32_16x16x32_bf16 v[196:199], v[68:71], v[20:23], v[196:199]
    ds_read_b128 v[60:63], v12 offset:38912
    s_lshl_b32 s73, s71, 5
    v_mfma_f32_16x16x32_bf16 v[160:163], v[72:75], v[80:83], v[160:163]
    ds_read_b64_tr_b16 v[44:45], v9 offset:49152
    v_mfma_f32_16x16x32_bf16 v[164:167], v[72:75], v[84:87], v[164:167]
    ds_read_b64_tr_b16 v[46:47], v9 offset:50176
    buffer_load_dwordx4 v242, s[32:35], s60 offen offset:2048 lds
    v_mfma_f32_16x16x32_bf16 v[168:171], v[72:75], v[88:91], v[168:171]
    v_lshl_add_u32 v234, v24, 3, s73
    v_mfma_f32_16x16x32_bf16 v[172:175], v[72:75], v[92:95], v[172:175]
    v_mfma_f32_16x16x32_bf16 v[176:179], v[76:79], v[80:83], v[176:179]
    s_lshl_b32 s73, s72, 5
    v_mfma_f32_16x16x32_bf16 v[180:183], v[76:79], v[84:87], v[180:183]
    buffer_load_dwordx4 v243, s[32:35], s60 offen offset:3072 lds
    v_mfma_f32_16x16x32_bf16 v[184:187], v[76:79], v[88:91], v[184:187]
    v_lshl_add_u32 v235, v24, 3, s73
    v_mfma_f32_16x16x32_bf16 v[188:191], v[76:79], v[92:95], v[188:191]
    s_waitcnt lgkmcnt(0)
    v_mfma_f32_16x16x32_bf16 v[128:131], v[32:35], v[48:51], v[128:131]
    ds_read_b128 v[80:83], v13 offset:32768
    s_add_u32 m0, s62, 49152
    v_mfma_f32_16x16x32_bf16 v[132:135], v[32:35], v[52:55], v[132:135]
    ds_read_b64_tr_b16 v[64:65], v6 offset:57344
    s_lshr_b32 s78, s57, 1
    v_mfma_f32_16x16x32_bf16 v[136:139], v[32:35], v[56:59], v[136:139]
    ds_read_b64_tr_b16 v[66:67], v6 offset:58368
    buffer_load_dwordx4 v244, s[40:43], s61 offen offset:0 lds
    v_mfma_f32_16x16x32_bf16 v[140:143], v[32:35], v[60:63], v[140:143]
    ds_read_b128 v[84:87], v13 offset:34816
    v_mfma_f32_16x16x32_bf16 v[192:195], v[32:35], v[20:23], v[192:195]
    ds_read_b64_tr_b16 v[68:69], v7 offset:57344
    s_lshl_b32 s78, s78, 3
    s_nop 0
    v_mfma_f32_16x16x32_bf16 v[144:147], v[36:39], v[48:51], v[144:147]
    ds_read_b64_tr_b16 v[70:71], v7 offset:58368
    v_mfma_f32_16x16x32_bf16 v[148:151], v[36:39], v[52:55], v[148:151]
    ds_read_b128 v[88:91], v13 offset:36864
    buffer_load_dwordx4 v245, s[40:43], s61 offen offset:1024 lds
    v_mfma_f32_16x16x32_bf16 v[152:155], v[36:39], v[56:59], v[152:155]
    ds_read_b64_tr_b16 v[72:73], v8 offset:57344
    v_mfma_f32_16x16x32_bf16 v[156:159], v[36:39], v[60:63], v[156:159]
    ds_read_b64_tr_b16 v[74:75], v8 offset:58368
    s_and_b32 s79, s58, 7
    v_mfma_f32_16x16x32_bf16 v[196:199], v[36:39], v[20:23], v[196:199]
    ds_read_b128 v[92:95], v13 offset:38912
    v_mfma_f32_16x16x32_bf16 v[160:163], v[40:43], v[48:51], v[160:163]
    ds_read_b64_tr_b16 v[76:77], v9 offset:57344
    buffer_load_dwordx4 v246, s[40:43], s61 offen offset:2048 lds
    v_mfma_f32_16x16x32_bf16 v[164:167], v[40:43], v[52:55], v[164:167]
    ds_read_b64_tr_b16 v[78:79], v9 offset:58368
    s_add_u32 s53, s78, s79
    v_mfma_f32_16x16x32_bf16 v[168:171], v[40:43], v[56:59], v[168:171]
    v_mfma_f32_16x16x32_bf16 v[172:175], v[40:43], v[60:63], v[172:175]
    buffer_load_dwordx4 v247, s[40:43], s61 offen offset:3072 lds
    s_mul_i32 s28, s79, 7
    v_mfma_f32_16x16x32_bf16 v[176:179], v[44:47], v[48:51], v[176:179]
    s_and_b32 s78, s57, 1
    v_mfma_f32_16x16x32_bf16 v[180:183], v[44:47], v[52:55], v[180:183]
    s_bitcmp1_b32 s0, 5
    s_cselect_b32 s87, s85, 128
    s_cselect_b32 s88, s86, 221184
    v_mfma_f32_16x16x32_bf16 v[184:187], v[44:47], v[56:59], v[184:187]
    s_add_u32 s60, s60, s87
    v_mfma_f32_16x16x32_bf16 v[188:191], v[44:47], v[60:63], v[188:191]
    s_add_u32 s61, s61, s88
    s_waitcnt vmcnt(8) lgkmcnt(0)
    s_barrier
    v_mfma_f32_16x16x32_bf16 v[128:131], v[64:67], v[80:83], v[128:131]
    ds_read_b128 v[48:51], v10 offset:0
    s_add_u32 m0, s62, 65536
    v_mfma_f32_16x16x32_bf16 v[132:135], v[64:67], v[84:87], v[132:135]
    ds_read_b64_tr_b16 v[32:33], v2 offset:16384
    s_lshl_b32 s78, s78, 2
    v_mfma_f32_16x16x32_bf16 v[136:139], v[64:67], v[88:91], v[136:139]
    ds_read_b64_tr_b16 v[34:35], v2 offset:17408
    buffer_load_dwordx4 v240, s[32:35], s60 offen offset:0 lds
    v_mfma_f32_16x16x32_bf16 v[140:143], v[64:67], v[92:95], v[140:143]
    ds_read_b128 v[52:55], v10 offset:2048
    v_mfma_f32_16x16x32_bf16 v[192:195], v[64:67], v[20:23], v[192:195]
    ds_read_b64_tr_b16 v[36:37], v3 offset:16384
    s_lshr_b32 s79, s58, 3
    v_mfma_f32_16x16x32_bf16 v[144:147], v[68:71], v[80:83], v[144:147]
    ds_read_b64_tr_b16 v[38:39], v3 offset:17408
    v_mfma_f32_16x16x32_bf16 v[148:151], v[68:71], v[84:87], v[148:151]
    ds_read_b128 v[56:59], v10 offset:4096
    buffer_load_dwordx4 v241, s[32:35], s60 offen offset:1024 lds
    v_mfma_f32_16x16x32_bf16 v[152:155], v[68:71], v[88:91], v[152:155]
    ds_read_b64_tr_b16 v[40:41], v4 offset:16384
    s_add_u32 s54, s78, s79
    v_mfma_f32_16x16x32_bf16 v[156:159], v[68:71], v[92:95], v[156:159]
    ds_read_b64_tr_b16 v[42:43], v4 offset:17408
    v_mfma_f32_16x16x32_bf16 v[196:199], v[68:71], v[20:23], v[196:199]
    ds_read_b128 v[60:63], v10 offset:6144
    s_mul_i32 s79, s79, 14
    v_mfma_f32_16x16x32_bf16 v[160:163], v[72:75], v[80:83], v[160:163]
    ds_read_b64_tr_b16 v[44:45], v5 offset:16384
    v_mfma_f32_16x16x32_bf16 v[164:167], v[72:75], v[84:87], v[164:167]
    ds_read_b64_tr_b16 v[46:47], v5 offset:17408
    buffer_load_dwordx4 v242, s[32:35], s60 offen offset:2048 lds
    v_mfma_f32_16x16x32_bf16 v[168:171], v[72:75], v[88:91], v[168:171]
    ds_read_b64_tr_b16 v[216:217], v200 offset:0
    s_add_u32 s28, s28, s79
    v_mfma_f32_16x16x32_bf16 v[172:175], v[72:75], v[92:95], v[172:175]
    ds_read_b64_tr_b16 v[218:219], v200 offset:2560
    v_mfma_f32_16x16x32_bf16 v[176:179], v[76:79], v[80:83], v[176:179]
    ds_read_b64_tr_b16 v[220:221], v201 offset:0
    s_lshr_b32 s28, s28, 2
    v_mfma_f32_16x16x32_bf16 v[180:183], v[76:79], v[84:87], v[180:183]
    ds_read_b64_tr_b16 v[222:223], v201 offset:2560
    buffer_load_dwordx4 v243, s[32:35], s60 offen offset:3072 lds
    v_mfma_f32_16x16x32_bf16 v[184:187], v[76:79], v[88:91], v[184:187]
    ds_read_b64_tr_b16 v[224:225], v202 offset:0
    v_mfma_f32_16x16x32_bf16 v[188:191], v[76:79], v[92:95], v[188:191]
    ds_read_b64_tr_b16 v[226:227], v202 offset:2560
    s_waitcnt lgkmcnt(0)
    v_mfma_f32_16x16x32_bf16 v[128:131], v[32:35], v[48:51], v[128:131]
    ds_read_b128 v[80:83], v11 offset:0
    buffer_store_dwordx4 v[216:219], v14, s[36:39], s74 offen sc1
    v_mfma_f32_16x16x32_bf16 v[132:135], v[32:35], v[52:55], v[132:135]
    ds_read_b64_tr_b16 v[64:65], v2 offset:24576
    buffer_store_dwordx4 v[220:223], v14, s[36:39], s75 offen sc1
    v_mfma_f32_16x16x32_bf16 v[136:139], v[32:35], v[56:59], v[136:139]
    ds_read_b64_tr_b16 v[66:67], v2 offset:25600
    buffer_store_dwordx4 v[224:227], v14, s[36:39], s76 offen sc1
    v_mfma_f32_16x16x32_bf16 v[140:143], v[32:35], v[60:63], v[140:143]
    ds_read_b128 v[84:87], v11 offset:2048
    s_cmp_ge_u32 s28, 14
    s_cselect_b32 s79, 14, 0
    v_mfma_f32_16x16x32_bf16 v[192:195], v[32:35], v[20:23], v[192:195]
    ds_read_b64_tr_b16 v[68:69], v3 offset:24576
    v_mfma_f32_16x16x32_bf16 v[144:147], v[36:39], v[48:51], v[144:147]
    ds_read_b64_tr_b16 v[70:71], v3 offset:25600
    s_add_u32 m0, s62, 81920
    v_mfma_f32_16x16x32_bf16 v[148:151], v[36:39], v[52:55], v[148:151]
    ds_read_b128 v[88:91], v11 offset:4096
    s_sub_u32 s28, s28, s79
    v_mfma_f32_16x16x32_bf16 v[152:155], v[36:39], v[56:59], v[152:155]
    ds_read_b64_tr_b16 v[72:73], v4 offset:24576
    buffer_load_dwordx4 v244, s[40:43], s61 offen offset:0 lds
    v_mfma_f32_16x16x32_bf16 v[156:159], v[36:39], v[60:63], v[156:159]
    ds_read_b64_tr_b16 v[74:75], v4 offset:25600
    v_mfma_f32_16x16x32_bf16 v[196:199], v[36:39], v[20:23], v[196:199]
    ds_read_b128 v[92:95], v11 offset:6144
    s_mov_b32 s28, 0
    v_mfma_f32_16x16x32_bf16 v[160:163], v[40:43], v[48:51], v[160:163]
    ds_read_b64_tr_b16 v[76:77], v5 offset:24576
    buffer_load_dwordx4 v245, s[40:43], s61 offen offset:1024 lds
    v_mfma_f32_16x16x32_bf16 v[164:167], v[40:43], v[52:55], v[164:167]
    ds_read_b64_tr_b16 v[78:79], v5 offset:25600
    s_mul_i32 s55, s3, 14
    v_mfma_f32_16x16x32_bf16 v[168:171], v[40:43], v[56:59], v[168:171]
    s_sub_u32 s79, s3, 1
    v_mfma_f32_16x16x32_bf16 v[172:175], v[40:43], v[60:63], v[172:175]
    buffer_load_dwordx4 v246, s[40:43], s61 offen offset:2048 lds
    s_cmp_ge_u32 s3, 2
    s_cselect_b32 s79, s79, 0
    v_mfma_f32_16x16x32_bf16 v[176:179], v[44:47], v[48:51], v[176:179]
    v_mfma_f32_16x16x32_bf16 v[180:183], v[44:47], v[52:55], v[180:183]
    buffer_load_dwordx4 v247, s[40:43], s61 offen offset:3072 lds
    s_bitcmp1_b32 s0, 6
    s_cselect_b32 s87, s85, 128
    s_cselect_b32 s88, s86, 221184
    v_mfma_f32_16x16x32_bf16 v[184:187], v[44:47], v[56:59], v[184:187]
    s_add_u32 s60, s60, s87
    s_sub_u32 s55, s55, s79
    v_mfma_f32_16x16x32_bf16 v[188:191], v[44:47], v[60:63], v[188:191]
    s_add_u32 s61, s61, s88
    s_waitcnt vmcnt(11) lgkmcnt(0)
    s_barrier
    v_mfma_f32_16x16x32_bf16 v[128:131], v[64:67], v[80:83], v[128:131]
    ds_read_b128 v[48:51], v10 offset:32768
    s_add_u32 m0, s62, 98304
    v_mfma_f32_16x16x32_bf16 v[132:135], v[64:67], v[84:87], v[132:135]
    ds_read_b64_tr_b16 v[32:33], v2 offset:49152
    s_mul_i32 s79, s54, 54
    s_nop 0
    v_mfma_f32_16x16x32_bf16 v[136:139], v[64:67], v[88:91], v[136:139]
    ds_read_b64_tr_b16 v[34:35], v2 offset:50176
    buffer_load_dwordx4 v240, s[32:35], s60 offen offset:0 lds
    v_mfma_f32_16x16x32_bf16 v[140:143], v[64:67], v[92:95], v[140:143]
    ds_read_b128 v[52:55], v10 offset:34816
    v_mfma_f32_16x16x32_bf16 v[192:195], v[64:67], v[20:23], v[192:195]
    ds_read_b64_tr_b16 v[36:37], v3 offset:49152
    v_mfma_f32_16x16x32_bf16 v[144:147], v[68:71], v[80:83], v[144:147]
    ds_read_b64_tr_b16 v[38:39], v3 offset:50176
    s_add_u32 s79, s79, s55
    s_nop 0
    v_mfma_f32_16x16x32_bf16 v[148:151], v[68:71], v[84:87], v[148:151]
    ds_read_b128 v[56:59], v10 offset:36864
    buffer_load_dwordx4 v241, s[32:35], s60 offen offset:1024 lds
    v_mfma_f32_16x16x32_bf16 v[152:155], v[68:71], v[88:91], v[152:155]
    ds_read_b64_tr_b16 v[40:41], v4 offset:49152
    v_mfma_f32_16x16x32_bf16 v[156:159], v[68:71], v[92:95], v[156:159]
    ds_read_b64_tr_b16 v[42:43], v4 offset:50176
    v_mfma_f32_16x16x32_bf16 v[196:199], v[68:71], v[20:23], v[196:199]
    ds_read_b128 v[60:63], v10 offset:38912
    s_mul_i32 s79, s79, 5120
    v_mfma_f32_16x16x32_bf16 v[160:163], v[72:75], v[80:83], v[160:163]
    ds_read_b64_tr_b16 v[44:45], v5 offset:49152
    v_mfma_f32_16x16x32_bf16 v[164:167], v[72:75], v[84:87], v[164:167]
    ds_read_b64_tr_b16 v[46:47], v5 offset:50176
    buffer_load_dwordx4 v242, s[32:35], s60 offen offset:2048 lds
    v_mfma_f32_16x16x32_bf16 v[168:171], v[72:75], v[88:91], v[168:171]
    s_add_u32 s79, s79, 4194304
    v_mfma_f32_16x16x32_bf16 v[172:175], v[72:75], v[92:95], v[172:175]
    v_mfma_f32_16x16x32_bf16 v[176:179], v[76:79], v[80:83], v[176:179]
    s_add_u32 s16, s79, 71680
    v_mfma_f32_16x16x32_bf16 v[180:183], v[76:79], v[84:87], v[180:183]
    buffer_load_dwordx4 v243, s[32:35], s60 offen offset:3072 lds
    v_mfma_f32_16x16x32_bf16 v[184:187], v[76:79], v[88:91], v[184:187]
    s_mul_i32 s52, s28, 5120
    v_mfma_f32_16x16x32_bf16 v[188:191], v[76:79], v[92:95], v[188:191]
    s_waitcnt lgkmcnt(0)
    v_mfma_f32_16x16x32_bf16 v[128:131], v[32:35], v[48:51], v[128:131]
    ds_read_b128 v[80:83], v11 offset:32768
    s_add_u32 m0, s62, 114688
    s_add_u32 s52, s52, s79
    v_mfma_f32_16x16x32_bf16 v[132:135], v[32:35], v[52:55], v[132:135]
    ds_read_b64_tr_b16 v[64:65], v2 offset:57344
    v_lshlrev_b32_e64 v14, 4, v0
    v_mfma_f32_16x16x32_bf16 v[136:139], v[32:35], v[56:59], v[136:139]
    ds_read_b64_tr_b16 v[66:67], v2 offset:58368
    buffer_load_dwordx4 v244, s[40:43], s61 offen offset:0 lds
    v_add_u32 v15, 4096, v14
PAGE2:
    s_cbranch_execz VISIT_RET
    v_mfma_f32_16x16x32_bf16 v[140:143], v[32:35], v[60:63], v[140:143]
    ds_read_b128 v[84:87], v11 offset:34816
    s_mul_i32 s84, s57, 56
    v_mfma_f32_16x16x32_bf16 v[192:195], v[32:35], v[20:23], v[192:195]
    ds_read_b64_tr_b16 v[68:69], v3 offset:57344
    s_lshl_b32 s78, s58, 1
    v_mfma_f32_16x16x32_bf16 v[144:147], v[36:39], v[48:51], v[144:147]
    ds_read_b64_tr_b16 v[70:71], v3 offset:58368
    s_add_u32 s84, s84, s78
    v_mfma_f32_16x16x32_bf16 v[148:151], v[36:39], v[52:55], v[148:151]
    ds_read_b128 v[88:91], v11 offset:36864
    buffer_load_dwordx4 v245, s[40:43], s61 offen offset:1024 lds
    s_mul_i32 s1, s57, 28
    v_mfma_f32_16x16x32_bf16 v[152:155], v[36:39], v[56:59], v[152:155]
    ds_read_b64_tr_b16 v[72:73], v4 offset:57344
    s_add_u32 s1, s1, s58
    v_mfma_f32_16x16x32_bf16 v[156:159], v[36:39], v[60:63], v[156:159]
    ds_read_b64_tr_b16 v[74:75], v4 offset:58368
    s_lshl_b32 s1, s1, 2
    v_mfma_f32_16x16x32_bf16 v[196:199], v[36:39], v[20:23], v[196:199]
    ds_read_b128 v[92:95], v11 offset:38912
    s_add_u32 s1, s1, s3
    v_mfma_f32_16x16x32_bf16 v[160:163], v[40:43], v[48:51], v[160:163]
    ds_read_b64_tr_b16 v[76:77], v5 offset:57344
    buffer_load_dwordx4 v246, s[40:43], s61 offen offset:2048 lds
    s_lshl_b32 s1, s1, 11
    v_mfma_f32_16x16x32_bf16 v[164:167], v[40:43], v[52:55], v[164:167]
    ds_read_b64_tr_b16 v[78:79], v5 offset:58368
    s_mov_b32 s80, s12
    v_mfma_f32_16x16x32_bf16 v[168:171], v[40:43], v[56:59], v[168:171]
    s_mov_b32 s81, s13
    s_mov_b32 s82, 2621440
    v_mfma_f32_16x16x32_bf16 v[172:175], v[40:43], v[60:63], v[172:175]
    buffer_load_dwordx4 v247, s[40:43], s61 offen offset:3072 lds
    s_mov_b32 s83, 0x20000
    v_mfma_f32_16x16x32_bf16 v[176:179], v[44:47], v[48:51], v[176:179]
    v_min_u32 v127, 15, v0
    v_mfma_f32_16x16x32_bf16 v[180:183], v[44:47], v[52:55], v[180:183]
    s_bitcmp1_b32 s0, 7
    s_cselect_b32 s87, s85, 128
    s_cselect_b32 s88, s86, 221184
    v_mfma_f32_16x16x32_bf16 v[184:187], v[44:47], v[56:59], v[184:187]
    s_add_u32 s60, s60, s87
    v_lshlrev_b32 v127, 7, v127
    v_mfma_f32_16x16x32_bf16 v[188:191], v[44:47], v[60:63], v[188:191]
    s_add_u32 s61, s61, s88
    buffer_load_dword v127, v127, s[80:83], s1 offen
    s_waitcnt vmcnt(9) lgkmcnt(0)
    s_barrier
    s_mov_b32 exec_lo, 4
    s_mov_b32 exec_hi, 0
    buffer_store_dword v31, v30, s[36:39], 0 offen sc1
    s_mov_b64 exec, -1
    v_mfma_f32_16x16x32_bf16 v[128:131], v[64:67], v[80:83], v[128:131]
    ds_read_b128 v[48:51], v12 offset:0
    s_add_u32 m0, s62, 0
    v_mfma_f32_16x16x32_bf16 v[132:135], v[64:67], v[84:87], v[132:135]
    ds_read_b64_tr_b16 v[32:33], v6 offset:16384
    s_lshr_b32 s77, s84, 6
    v_mfma_f32_16x16x32_bf16 v[136:139], v[64:67], v[88:91], v[136:139]
    ds_read_b64_tr_b16 v[34:35], v6 offset:17408
    buffer_load_dwordx4 v240, s[32:35], s60 offen offset:0 lds
    v_mfma_f32_16x16x32_bf16 v[140:143], v[64:67], v[92:95], v[140:143]
    ds_read_b128 v[52:55], v12 offset:2048
    v_and_b32 v27, 31, v0
    v_mfma_f32_16x16x32_bf16 v[192:195], v[64:67], v[20:23], v[192:195]
    ds_read_b64_tr_b16 v[36:37], v7 offset:16384
    v_lshlrev_b32 v27, 6, v27
    v_mfma_f32_16x16x32_bf16 v[144:147], v[68:71], v[80:83], v[144:147]
    ds_read_b64_tr_b16 v[38:39], v7 offset:17408
    s_lshl_b32 s73, s77, 11
    v_mfma_f32_16x16x32_bf16 v[148:151], v[68:71], v[84:87], v[148:151]
    ds_read_b128 v[56:59], v12 offset:4096
    buffer_load_dwordx4 v241, s[32:35], s60 offen offset:1024 lds
    v_mfma_f32_16x16x32_bf16 v[152:155], v[68:71], v[88:91], v[152:155]
    ds_read_b64_tr_b16 v[40:41], v8 offset:16384
    v_mfma_f32_16x16x32_bf16 v[156:159], v[68:71], v[92:95], v[156:159]
    ds_read_b64_tr_b16 v[42:43], v8 offset:17408
    s_add_u32 s73, s73, 131072
    v_mfma_f32_16x16x32_bf16 v[196:199], v[68:71], v[20:23], v[196:199]
    ds_read_b128 v[60:63], v12 offset:6144
    s_lshl_b32 s78, s54, 11
    s_nop 0
    v_mfma_f32_16x16x32_bf16 v[160:163], v[72:75], v[80:83], v[160:163]
    ds_read_b64_tr_b16 v[44:45], v9 offset:16384
    v_min_u32 v26, ((C4JOIN-G1_END+511)/512)-1, v0
    v_mfma_f32_16x16x32_bf16 v[164:167], v[72:75], v[84:87], v[164:167]
    ds_read_b64_tr_b16 v[46:47], v9 offset:17408
    buffer_load_dwordx4 v242, s[32:35], s60 offen offset:2048 lds
    v_mfma_f32_16x16x32_bf16 v[168:171], v[72:75], v[88:91], v[168:171]
    s_mul_i32 s80, s3, ((C4JOIN-G1_END+511)/512)
    v_mfma_f32_16x16x32_bf16 v[172:175], v[72:75], v[92:95], v[172:175]
    v_add_u32 v26, s80, v26
    v_lshlrev_b32 v26, 7, v26
    v_mfma_f32_16x16x32_bf16 v[176:179], v[76:79], v[80:83], v[176:179]
    s_getpc_b64 s[80:81]
CT_1:
    s_nop 0
    v_add_u32 v26, G1_END-CT_1, v26
    v_mfma_f32_16x16x32_bf16 v[180:183], v[76:79], v[84:87], v[180:183]
    buffer_load_dwordx4 v243, s[32:35], s60 offen offset:3072 lds
    v_mfma_f32_16x16x32_bf16 v[184:187], v[76:79], v[88:91], v[184:187]
    s_mov_b32 s82, CODE_END-CT_1
    s_mov_b32 s83, 0x20000
    v_mfma_f32_16x16x32_bf16 v[188:191], v[76:79], v[92:95], v[188:191]
    buffer_load_dword v26, v26, s[80:83], 0 offen
    s_waitcnt lgkmcnt(0)
    s_nop 0
    v_mfma_f32_16x16x32_bf16 v[128:131], v[32:35], v[48:51], v[128:131]
    ds_read_b128 v[80:83], v13 offset:0
    s_add_u32 m0, s62, 16384
    v_mfma_f32_16x16x32_bf16 v[132:135], v[32:35], v[52:55], v[132:135]
    ds_read_b64_tr_b16 v[64:65], v6 offset:24576
    s_add_u32 s78, s78, 163840
    v_mfma_f32_16x16x32_bf16 v[136:139], v[32:35], v[56:59], v[136:139]
    ds_read_b64_tr_b16 v[66:67], v6 offset:25600
    buffer_load_dwordx4 v244, s[40:43], s61 offen offset:0 lds
    v_mfma_f32_16x16x32_bf16 v[140:143], v[32:35], v[60:63], v[140:143]
    ds_read_b128 v[84:87], v13 offset:2048
    v_mfma_f32_16x16x32_bf16 v[192:195], v[32:35], v[20:23], v[192:195]
    ds_read_b64_tr_b16 v[68:69], v7 offset:24576
    v_mov_b32_e64 v16, s73
    v_mfma_f32_16x16x32_bf16 v[144:147], v[36:39], v[48:51], v[144:147]
    ds_read_b64_tr_b16 v[70:71], v7 offset:25600
    v_mfma_f32_16x16x32_bf16 v[148:151], v[36:39], v[52:55], v[148:151]
    ds_read_b128 v[88:91], v13 offset:4096
    buffer_load_dwordx4 v245, s[40:43], s61 offen offset:1024 lds
    v_mfma_f32_16x16x32_bf16 v[152:155], v[36:39], v[56:59], v[152:155]
    ds_read_b64_tr_b16 v[72:73], v8 offset:24576
    v_mfma_f32_16x16x32_bf16 v[156:159], v[36:39], v[60:63], v[156:159]
    ds_read_b64_tr_b16 v[74:75], v8 offset:25600
    v_mov_b32_e64 v18, s78
    v_mfma_f32_16x16x32_bf16 v[196:199], v[36:39], v[20:23], v[196:199]
    ds_read_b128 v[92:95], v13 offset:6144
    v_mfma_f32_16x16x32_bf16 v[160:163], v[40:43], v[48:51], v[160:163]
    ds_read_b64_tr_b16 v[76:77], v9 offset:24576
    buffer_load_dwordx4 v246, s[40:43], s61 offen offset:2048 lds
    v_mfma_f32_16x16x32_bf16 v[164:167], v[40:43], v[52:55], v[164:167]
    ds_read_b64_tr_b16 v[78:79], v9 offset:25600
    v_and_b32 v19, 32, v0
    v_mfma_f32_16x16x32_bf16 v[168:171], v[40:43], v[56:59], v[168:171]
    v_mfma_f32_16x16x32_bf16 v[172:175], v[40:43], v[60:63], v[172:175]
    buffer_load_dwordx4 v247, s[40:43], s61 offen offset:3072 lds
    v_cmp_eq_u32 vcc, 0, v19
    v_mfma_f32_16x16x32_bf16 v[176:179], v[44:47], v[48:51], v[176:179]
    s_nop 1
    v_mfma_f32_16x16x32_bf16 v[180:183], v[44:47], v[52:55], v[180:183]
    s_bitcmp1_b32 s0, 8
    s_cselect_b32 s87, s85, 128
    s_cselect_b32 s88, s86, 221184
    v_mfma_f32_16x16x32_bf16 v[184:187], v[44:47], v[56:59], v[184:187]
    s_add_u32 s60, s60, s87
    v_mfma_f32_16x16x32_bf16 v[188:191], v[44:47], v[60:63], v[188:191]
    s_add_u32 s61, s61, s88
    s_waitcnt vmcnt(11) lgkmcnt(0)
    s_barrier
    buffer_load_dword v29, v28, s[36:39], 0 offen sc1
    v_mfma_f32_16x16x32_bf16 v[128:131], v[64:67], v[80:83], v[128:131]
    ds_read_b128 v[48:51], v12 offset:32768
    s_add_u32 m0, s62, 32768
    v_mfma_f32_16x16x32_bf16 v[132:135], v[64:67], v[84:87], v[132:135]
    ds_read_b64_tr_b16 v[32:33], v6 offset:49152
    v_cndmask_b32_e64 v16, v18, v16, vcc
    v_mfma_f32_16x16x32_bf16 v[136:139], v[64:67], v[88:91], v[136:139]
    ds_read_b64_tr_b16 v[34:35], v6 offset:50176
    buffer_load_dwordx4 v240, s[32:35], s60 offen offset:0 lds
    v_mfma_f32_16x16x32_bf16 v[140:143], v[64:67], v[92:95], v[140:143]
    ds_read_b128 v[52:55], v12 offset:34816
    v_mfma_f32_16x16x32_bf16 v[192:195], v[64:67], v[20:23], v[192:195]
    ds_read_b64_tr_b16 v[36:37], v7 offset:49152
    v_mfma_f32_16x16x32_bf16 v[144:147], v[68:71], v[80:83], v[144:147]
    ds_read_b64_tr_b16 v[38:39], v7 offset:50176
    v_add_u32_e64 v27, v16, v27
    v_mfma_f32_16x16x32_bf16 v[148:151], v[68:71], v[84:87], v[148:151]
    ds_read_b128 v[56:59], v12 offset:36864
    buffer_load_dwordx4 v241, s[32:35], s60 offen offset:1024 lds
    v_mfma_f32_16x16x32_bf16 v[152:155], v[68:71], v[88:91], v[152:155]
    ds_read_b64_tr_b16 v[40:41], v8 offset:49152
    v_mfma_f32_16x16x32_bf16 v[156:159], v[68:71], v[92:95], v[156:159]
    ds_read_b64_tr_b16 v[42:43], v8 offset:50176
    v_mfma_f32_16x16x32_bf16 v[196:199], v[68:71], v[20:23], v[196:199]
    ds_read_b128 v[60:63], v12 offset:38912
    s_lshr_b32 s78, s3, 1
    v_mfma_f32_16x16x32_bf16 v[160:163], v[72:75], v[80:83], v[160:163]
    ds_read_b64_tr_b16 v[44:45], v9 offset:49152
    v_mfma_f32_16x16x32_bf16 v[164:167], v[72:75], v[84:87], v[164:167]
    ds_read_b64_tr_b16 v[46:47], v9 offset:50176
    buffer_load_dwordx4 v242, s[32:35], s60 offen offset:2048 lds
    v_mfma_f32_16x16x32_bf16 v[168:171], v[72:75], v[88:91], v[168:171]
    s_add_u32 s84, s84, s78
    v_mfma_f32_16x16x32_bf16 v[172:175], v[72:75], v[92:95], v[172:175]
    v_mfma_f32_16x16x32_bf16 v[176:179], v[76:79], v[80:83], v[176:179]
    s_and_b32 s87, s3, 1
    v_mfma_f32_16x16x32_bf16 v[180:183], v[76:79], v[84:87], v[180:183]
    buffer_load_dwordx4 v243, s[32:35], s60 offen offset:3072 lds
    v_mfma_f32_16x16x32_bf16 v[184:187], v[76:79], v[88:91], v[184:187]
    s_mul_i32 s86, s78, 21248
    v_mfma_f32_16x16x32_bf16 v[188:191], v[76:79], v[92:95], v[188:191]
    s_waitcnt lgkmcnt(0)
    v_mfma_f32_16x16x32_bf16 v[128:131], v[32:35], v[48:51], v[128:131]
    ds_read_b128 v[80:83], v13 offset:32768
    s_add_u32 m0, s62, 49152
    v_mfma_f32_16x16x32_bf16 v[132:135], v[32:35], v[52:55], v[132:135]
    ds_read_b64_tr_b16 v[64:65], v6 offset:57344
    s_lshl_b32 s85, s84, 12
    v_mfma_f32_16x16x32_bf16 v[136:139], v[32:35], v[56:59], v[136:139]
    ds_read_b64_tr_b16 v[66:67], v6 offset:58368
    buffer_load_dwordx4 v244, s[40:43], s61 offen offset:0 lds
    v_mfma_f32_16x16x32_bf16 v[140:143], v[32:35], v[60:63], v[140:143]
    ds_read_b128 v[84:87], v13 offset:34816
    v_mfma_f32_16x16x32_bf16 v[192:195], v[32:35], v[20:23], v[192:195]
    ds_read_b64_tr_b16 v[68:69], v7 offset:57344
    s_add_u32 s44, s12, s85
    s_addc_u32 s45, s13, 0
    s_nop 0
    v_mfma_f32_16x16x32_bf16 v[144:147], v[36:39], v[48:51], v[144:147]
    ds_read_b64_tr_b16 v[70:71], v7 offset:58368
    v_mfma_f32_16x16x32_bf16 v[148:151], v[36:39], v[52:55], v[148:151]
    ds_read_b128 v[88:91], v13 offset:36864
    buffer_load_dwordx4 v245, s[40:43], s61 offen offset:1024 lds
    v_mfma_f32_16x16x32_bf16 v[152:155], v[36:39], v[56:59], v[152:155]
    ds_read_b64_tr_b16 v[72:73], v8 offset:57344
    v_mfma_f32_16x16x32_bf16 v[156:159], v[36:39], v[60:63], v[156:159]
    ds_read_b64_tr_b16 v[74:75], v8 offset:58368
    v_mfma_f32_16x16x32_bf16 v[196:199], v[36:39], v[20:23], v[196:199]
    ds_read_b128 v[92:95], v13 offset:38912
    v_mfma_f32_16x16x32_bf16 v[160:163], v[40:43], v[48:51], v[160:163]
    ds_read_b64_tr_b16 v[76:77], v9 offset:57344
    s_mov_b32 s46, 4096
    v_mfma_f32_16x16x32_bf16 v[164:167], v[40:43], v[52:55], v[164:167]
    ds_read_b64_tr_b16 v[78:79], v9 offset:58368
    buffer_load_dwordx4 v246, s[40:43], s61 offen offset:2048 lds
    v_mfma_f32_16x16x32_bf16 v[168:171], v[40:43], v[56:59], v[168:171]
    s_mov_b32 s47, 0x20000
    v_mfma_f32_16x16x32_bf16 v[172:175], v[40:43], v[60:63], v[172:175]
    s_lshl_b32 s89, s87, 11
    v_mfma_f32_16x16x32_bf16 v[176:179], v[44:47], v[48:51], v[176:179]
    v_mfma_f32_16x16x32_bf16 v[180:183], v[44:47], v[52:55], v[180:183]
    buffer_load_dwordx4 v247, s[40:43], s61 offen offset:3072 lds
    s_add_u32 s88, s85, s89
    v_mfma_f32_16x16x32_bf16 v[184:187], v[44:47], v[56:59], v[184:187]
    s_add_u32 s88, s88, 1048576
    v_mfma_f32_16x16x32_bf16 v[188:191], v[44:47], v[60:63], v[188:191]
    s_waitcnt vmcnt(9) lgkmcnt(0)
    s_barrier
    v_mfma_f32_16x16x32_bf16 v[128:131], v[64:67], v[80:83], v[128:131]
    ds_read_b128 v[48:51], v10 offset:0
    buffer_load_dwordx2 v[208:209], v232, s[48:51], 0 offen
    v_mfma_f32_16x16x32_bf16 v[132:135], v[64:67], v[84:87], v[132:135]
    ds_read_b64_tr_b16 v[32:33], v2 offset:16384
    v_mfma_f32_16x16x32_bf16 v[136:139], v[64:67], v[88:91], v[136:139]
    ds_read_b64_tr_b16 v[34:35], v2 offset:17408
    v_mfma_f32_16x16x32_bf16 v[140:143], v[64:67], v[92:95], v[140:143]
    ds_read_b128 v[52:55], v10 offset:2048
    v_mfma_f32_16x16x32_bf16 v[192:195], v[64:67], v[20:23], v[192:195]
    ds_read_b64_tr_b16 v[36:37], v3 offset:16384
    v_mfma_f32_16x16x32_bf16 v[144:147], v[68:71], v[80:83], v[144:147]
    ds_read_b64_tr_b16 v[38:39], v3 offset:17408
    v_mfma_f32_16x16x32_bf16 v[148:151], v[68:71], v[84:87], v[148:151]
    ds_read_b128 v[56:59], v10 offset:4096
    buffer_load_dwordx2 v[210:211], v233, s[48:51], 0 offen
    v_mfma_f32_16x16x32_bf16 v[152:155], v[68:71], v[88:91], v[152:155]
    ds_read_b64_tr_b16 v[40:41], v4 offset:16384
    v_mfma_f32_16x16x32_bf16 v[156:159], v[68:71], v[92:95], v[156:159]
    ds_read_b64_tr_b16 v[42:43], v4 offset:17408
    v_mfma_f32_16x16x32_bf16 v[196:199], v[68:71], v[20:23], v[196:199]
    ds_read_b128 v[60:63], v10 offset:6144
    v_mfma_f32_16x16x32_bf16 v[160:163], v[72:75], v[80:83], v[160:163]
    ds_read_b64_tr_b16 v[44:45], v5 offset:16384
    v_mfma_f32_16x16x32_bf16 v[164:167], v[72:75], v[84:87], v[164:167]
    ds_read_b64_tr_b16 v[46:47], v5 offset:17408
    v_mfma_f32_16x16x32_bf16 v[168:171], v[72:75], v[88:91], v[168:171]
    buffer_load_dwordx2 v[212:213], v234, s[48:51], 0 offen
    v_mfma_f32_16x16x32_bf16 v[172:175], v[72:75], v[92:95], v[172:175]
    v_mfma_f32_16x16x32_bf16 v[176:179], v[76:79], v[80:83], v[176:179]
    v_mfma_f32_16x16x32_bf16 v[180:183], v[76:79], v[84:87], v[180:183]
    buffer_load_dwordx2 v[214:215], v235, s[48:51], 0 offen
    v_mfma_f32_16x16x32_bf16 v[184:187], v[76:79], v[88:91], v[184:187]
    v_mfma_f32_16x16x32_bf16 v[188:191], v[76:79], v[92:95], v[188:191]
    s_waitcnt lgkmcnt(0)
    v_mfma_f32_16x16x32_bf16 v[128:131], v[32:35], v[48:51], v[128:131]
    ds_read_b128 v[80:83], v11 offset:0
    s_lshl_b32 s79, s53, 6
    v_mfma_f32_16x16x32_bf16 v[132:135], v[32:35], v[52:55], v[132:135]
    ds_read_b64_tr_b16 v[64:65], v2 offset:24576
    s_lshl_b32 s80, s3, 4
    v_mfma_f32_16x16x32_bf16 v[136:139], v[32:35], v[56:59], v[136:139]
    ds_read_b64_tr_b16 v[66:67], v2 offset:25600
    s_add_u32 s79, s79, s80
    v_mfma_f32_16x16x32_bf16 v[140:143], v[32:35], v[60:63], v[140:143]
    ds_read_b128 v[84:87], v11 offset:2048
    v_lshrrev_b32 v116, 2, v0
    v_mfma_f32_16x16x32_bf16 v[192:195], v[32:35], v[20:23], v[192:195]
    ds_read_b64_tr_b16 v[68:69], v3 offset:24576
    v_add_u32 v116, s79, v116
    v_mfma_f32_16x16x32_bf16 v[144:147], v[36:39], v[48:51], v[144:147]
    ds_read_b64_tr_b16 v[70:71], v3 offset:25600
    v_mul_u32_u24 v116, 1280, v116
    v_mfma_f32_16x16x32_bf16 v[148:151], v[36:39], v[52:55], v[148:151]
    ds_read_b128 v[88:91], v11 offset:4096
    s_mul_i32 s80, s54, 160
    v_mfma_f32_16x16x32_bf16 v[152:155], v[36:39], v[56:59], v[152:155]
    ds_read_b64_tr_b16 v[72:73], v4 offset:24576
    v_add_u32 v116, s80, v116
    v_mfma_f32_16x16x32_bf16 v[156:159], v[36:39], v[60:63], v[156:159]
    ds_read_b64_tr_b16 v[74:75], v4 offset:25600
    v_and_b32 v117, 3, v0
    v_mfma_f32_16x16x32_bf16 v[196:199], v[36:39], v[20:23], v[196:199]
    ds_read_b128 v[92:95], v11 offset:6144
    v_lshl_add_u32 v118, v117, 4, v116
    v_mfma_f32_16x16x32_bf16 v[160:163], v[40:43], v[48:51], v[160:163]
    ds_read_b64_tr_b16 v[76:77], v5 offset:24576
    v_lshl_add_u32 v119, v117, 3, v116
    v_mfma_f32_16x16x32_bf16 v[164:167], v[40:43], v[52:55], v[164:167]
    ds_read_b64_tr_b16 v[78:79], v5 offset:25600
    v_mfma_f32_16x16x32_bf16 v[168:171], v[40:43], v[56:59], v[168:171]
    s_mov_b32 s40, s24
    s_mov_b32 s41, s25
    v_mfma_f32_16x16x32_bf16 v[172:175], v[40:43], v[60:63], v[172:175]
    s_mov_b32 s42, 1280
    s_mov_b32 s43, 0x20000
    v_mfma_f32_16x16x32_bf16 v[176:179], v[44:47], v[48:51], v[176:179]
    v_lshrrev_b32 v104, 4, v0
    s_mul_i32 s60, s54, 160
    v_mfma_f32_16x16x32_bf16 v[180:183], v[44:47], v[52:55], v[180:183]
    v_lshlrev_b32 v105, 4, v104
    v_lshlrev_b32_e64 v106, 3, v104
    v_mfma_f32_16x16x32_bf16 v[184:187], v[44:47], v[56:59], v[184:187]
    buffer_load_dwordx4 a[240:243], v105, s[40:43], s60 offen
    buffer_load_dwordx4 a[244:247], v105, s[40:43], s60 offen offset:64
    v_mfma_f32_16x16x32_bf16 v[188:191], v[44:47], v[60:63], v[188:191]
    buffer_load_dwordx2 a[248:249], v106, s[40:43], s60 offen offset:128
    s_waitcnt vmcnt(7) lgkmcnt(0)
    s_waitcnt vmcnt(15)
    v_cmp_ne_u32 vcc, s56, v29
    s_mov_b64 s[82:83], vcc
    s_cmp_eq_u64 s[82:83], 0
    s_cbranch_scc0 P1_RETRY_2
P1_DONE_3:
    s_barrier
    v_mfma_f32_16x16x32_bf16 v[128:131], v[64:67], v[80:83], v[128:131]
    ds_read_b128 v[48:51], v10 offset:32768
    buffer_load_dword v24, v27, s[36:39], 0 offen sc1
    v_mfma_f32_16x16x32_bf16 v[132:135], v[64:67], v[84:87], v[132:135]
    ds_read_b64_tr_b16 v[32:33], v2 offset:49152
    v_mfma_f32_16x16x32_bf16 v[136:139], v[64:67], v[88:91], v[136:139]
    ds_read_b64_tr_b16 v[34:35], v2 offset:50176
    v_and_b32 v16, 15, v0
    v_mfma_f32_16x16x32_bf16 v[140:143], v[64:67], v[92:95], v[140:143]
    ds_read_b128 v[52:55], v10 offset:34816
    v_mfma_f32_16x16x32_bf16 v[192:195], v[64:67], v[20:23], v[192:195]
    ds_read_b64_tr_b16 v[36:37], v3 offset:49152
    v_mfma_f32_16x16x32_bf16 v[144:147], v[68:71], v[80:83], v[144:147]
    ds_read_b64_tr_b16 v[38:39], v3 offset:50176
    v_add_u32_e64 v16, s67, v16
    v_mfma_f32_16x16x32_bf16 v[148:151], v[68:71], v[84:87], v[148:151]
    ds_read_b128 v[56:59], v10 offset:36864
    v_mfma_f32_16x16x32_bf16 v[152:155], v[68:71], v[88:91], v[152:155]
    ds_read_b64_tr_b16 v[40:41], v4 offset:49152
    v_mfma_f32_16x16x32_bf16 v[156:159], v[68:71], v[92:95], v[156:159]
    ds_read_b64_tr_b16 v[42:43], v4 offset:50176
    v_lshlrev_b32_e64 v16, 3, v16
    v_mfma_f32_16x16x32_bf16 v[196:199], v[68:71], v[20:23], v[196:199]
    ds_read_b128 v[60:63], v10 offset:38912
    v_mfma_f32_16x16x32_bf16 v[160:163], v[72:75], v[80:83], v[160:163]
    ds_read_b64_tr_b16 v[44:45], v5 offset:49152
    s_mov_b32 s59, 65536
    v_mfma_f32_16x16x32_bf16 v[164:167], v[72:75], v[84:87], v[164:167]
    ds_read_b64_tr_b16 v[46:47], v5 offset:50176
    v_mfma_f32_16x16x32_bf16 v[168:171], v[72:75], v[88:91], v[168:171]
    buffer_load_dwordx2 v[200:201], v16, s[36:39], s59 offen offset:0 sc1
    v_mfma_f32_16x16x32_bf16 v[172:175], v[72:75], v[92:95], v[172:175]
    v_mfma_f32_16x16x32_bf16 v[176:179], v[76:79], v[80:83], v[176:179]
    buffer_load_dwordx2 v[202:203], v16, s[36:39], s59 offen offset:128 sc1
    v_mfma_f32_16x16x32_bf16 v[180:183], v[76:79], v[84:87], v[180:183]
    buffer_load_dwordx2 v[204:205], v16, s[36:39], s59 offen offset:256 sc1
    v_mfma_f32_16x16x32_bf16 v[184:187], v[76:79], v[88:91], v[184:187]
    buffer_load_dwordx2 v[206:207], v16, s[36:39], s59 offen offset:384 sc1
    v_mfma_f32_16x16x32_bf16 v[188:191], v[76:79], v[92:95], v[188:191]
    s_waitcnt lgkmcnt(0)
    v_mfma_f32_16x16x32_bf16 v[128:131], v[32:35], v[48:51], v[128:131]
    ds_read_b128 v[80:83], v11 offset:32768
    buffer_load_dwordx4 v[244:247], v118, s[32:35], 0 offen
    s_and_b32 s73, s69, 7
    v_mfma_f32_16x16x32_bf16 v[132:135], v[32:35], v[52:55], v[132:135]
    ds_read_b64_tr_b16 v[64:65], v2 offset:57344
    s_lshl_b32 s73, s73, 6
    v_mfma_f32_16x16x32_bf16 v[136:139], v[32:35], v[56:59], v[136:139]
    ds_read_b64_tr_b16 v[66:67], v2 offset:58368
    s_add_u32 s73, s73, 131072
    v_lshl_add_u32 v108, v17, 4, s73
    v_mfma_f32_16x16x32_bf16 v[140:143], v[32:35], v[60:63], v[140:143]
    ds_read_b128 v[84:87], v11 offset:34816
    s_and_b32 s73, s70, 7
    v_mfma_f32_16x16x32_bf16 v[192:195], v[32:35], v[20:23], v[192:195]
    ds_read_b64_tr_b16 v[68:69], v3 offset:57344
    s_lshl_b32 s73, s73, 6
    s_add_u32 s73, s73, 131072
    v_mfma_f32_16x16x32_bf16 v[144:147], v[36:39], v[48:51], v[144:147]
    ds_read_b64_tr_b16 v[70:71], v3 offset:58368
    v_lshl_add_u32 v109, v17, 4, s73
    v_mfma_f32_16x16x32_bf16 v[148:151], v[36:39], v[52:55], v[148:151]
    ds_read_b128 v[88:91], v11 offset:36864
    s_and_b32 s73, s71, 7
    v_mfma_f32_16x16x32_bf16 v[152:155], v[36:39], v[56:59], v[152:155]
    ds_read_b64_tr_b16 v[72:73], v4 offset:57344
    s_lshl_b32 s73, s73, 6
    s_add_u32 s73, s73, 131072
    v_mfma_f32_16x16x32_bf16 v[156:159], v[36:39], v[60:63], v[156:159]
    ds_read_b64_tr_b16 v[74:75], v4 offset:58368
    v_lshl_add_u32 v110, v17, 4, s73
    v_mfma_f32_16x16x32_bf16 v[196:199], v[36:39], v[20:23], v[196:199]
    ds_read_b128 v[92:95], v11 offset:38912
    s_and_b32 s73, s72, 7
    s_lshl_b32 s73, s73, 6
    s_nop 0
    v_mfma_f32_16x16x32_bf16 v[160:163], v[40:43], v[48:51], v[160:163]
    ds_read_b64_tr_b16 v[76:77], v5 offset:57344
    s_add_u32 s73, s73, 131072
    v_mfma_f32_16x16x32_bf16 v[164:167], v[40:43], v[52:55], v[164:167]
    ds_read_b64_tr_b16 v[78:79], v5 offset:58368
    v_lshl_add_u32 v111, v17, 4, s73
    v_mov_b32 v112, 0xbf8bf336
    v_mfma_f32_16x16x32_bf16 v[168:171], v[40:43], v[56:59], v[168:171]
    v_mov_b32 v113, 0xbf8bf336
    v_mov_b32 v114, 0x3eeff558
    v_mfma_f32_16x16x32_bf16 v[172:175], v[40:43], v[60:63], v[172:175]
    v_mov_b32 v115, 0x3eeff558
    v_min_u32 v19, ((G2_START-C4JOIN+511)/512)-1, v0
    v_mfma_f32_16x16x32_bf16 v[176:179], v[44:47], v[48:51], v[176:179]
    s_mul_i32 s80, s3, ((G2_START-C4JOIN+511)/512)
    v_add_u32 v19, s80, v19
    v_mfma_f32_16x16x32_bf16 v[180:183], v[44:47], v[52:55], v[180:183]
    v_lshlrev_b32 v19, 7, v19
    s_getpc_b64 s[80:81]
CT_5:
    v_mfma_f32_16x16x32_bf16 v[184:187], v[44:47], v[56:59], v[184:187]
    v_add_u32 v19, C4JOIN-CT_5, v19
    s_mov_b32 s82, CODE_END-CT_5
    v_mfma_f32_16x16x32_bf16 v[188:191], v[44:47], v[60:63], v[188:191]
    s_mov_b32 s83, 0x20000
    buffer_load_dword v19, v19, s[80:83], 0 offen
    s_waitcnt lgkmcnt(0)
    v_mfma_f32_16x16x32_bf16 v[192:195], v[64:67], v[20:23], v[192:195]
    s_waitcnt vmcnt(10)
    v_lshlrev_b32 v40, 16, v208
    v_mfma_f32_16x16x32_bf16 v[196:199], v[68:71], v[20:23], v[196:199]
    buffer_load_dwordx4 v[248:251], v118, s[32:35], 0 offen offset:64
    v_and_b32 v41, 0xffff0000, v208
    v_mfma_f32_16x16x32_bf16 v[128:131], v[64:67], v[80:83], v[128:131]
    v_lshlrev_b32 v42, 16, v209
    v_mfma_f32_16x16x32_bf16 v[132:135], v[64:67], v[84:87], v[132:135]
    v_and_b32 v43, 0xffff0000, v209
    v_lshlrev_b32 v44, 16, v210
    v_mfma_f32_16x16x32_bf16 v[136:139], v[64:67], v[88:91], v[136:139]
    v_and_b32 v45, 0xffff0000, v210
    v_lshlrev_b32 v46, 16, v211
    v_mfma_f32_16x16x32_bf16 v[140:143], v[64:67], v[92:95], v[140:143]
    v_and_b32 v47, 0xffff0000, v211
    v_mfma_f32_16x16x32_bf16 v[144:147], v[68:71], v[80:83], v[144:147]
    v_lshlrev_b32 v56, 16, v212
    v_and_b32 v57, 0xffff0000, v212
    v_mfma_f32_16x16x32_bf16 v[148:151], v[68:71], v[84:87], v[148:151]
    v_lshlrev_b32 v58, 16, v213
    v_mfma_f32_16x16x32_bf16 v[152:155], v[68:71], v[88:91], v[152:155]
    v_and_b32 v59, 0xffff0000, v213
    v_lshlrev_b32 v60, 16, v214
    v_mfma_f32_16x16x32_bf16 v[156:159], v[68:71], v[92:95], v[156:159]
    buffer_load_dwordx2 v[252:253], v119, s[32:35], 0 offen offset:128
    v_and_b32 v61, 0xffff0000, v214
    v_mfma_f32_16x16x32_bf16 v[160:163], v[72:75], v[80:83], v[160:163]
    s_mov_b32 exec_lo, 0x00010001
    s_mov_b32 exec_hi, 0x00010001
    ds_write_b128 v108, v[192:195]
    ds_write_b128 v109, v[196:199]
    s_mov_b64 exec, -1
    v_mfma_f32_16x16x32_bf16 v[164:167], v[72:75], v[84:87], v[164:167]
    v_lshlrev_b32 v62, 16, v215
    v_mfma_f32_16x16x32_bf16 v[168:171], v[72:75], v[88:91], v[168:171]
    v_and_b32 v63, 0xffff0000, v215
    s_mov_b32 s74, 0x409d30fc
    v_mfma_f32_16x16x32_bf16 v[172:175], v[72:75], v[92:95], v[172:175]
    s_mov_b32 s75, 0x409d30fc
    v_mfma_f32_16x16x32_bf16 v[176:179], v[76:79], v[80:83], v[176:179]
    s_lshr_b32 s76, s67, 4
    s_mul_i32 s76, s76, 55296
    v_mfma_f32_16x16x32_bf16 v[180:183], v[76:79], v[84:87], v[180:183]
    s_add_u32 s76, s76, 10485760
    v_mfma_f32_16x16x32_bf16 v[184:187], v[76:79], v[88:91], v[184:187]
    s_cmp_ge_u32 s68, 108
    s_cselect_b32 s76, 17563648, s76
    v_mfma_f32_16x16x32_bf16 v[188:191], v[76:79], v[92:95], v[188:191]
    v_lshlrev_b32 v18, 4, v0
G1_END:
    s_waitcnt vmcnt(8)
    v_cmp_ne_u32 vcc, s56, v24
    s_mov_b64 s[82:83], vcc
    s_cmp_eq_u64 s[82:83], 0
    s_cbranch_scc0 P2_RETRY_6
P2_DONE_7:
    s_waitcnt lgkmcnt(0)
    s_barrier
    s_nop 0
    ds_read_b128 v[216:219], v108
    ds_read_b128 v[220:223], v109
    ds_read_b128 v[224:227], v110
    ds_read_b128 v[228:231], v111
    buffer_load_dwordx4 v[96:99], v14, s[44:47], s89 offen offset:0 nt
    buffer_load_dwordx4 v[100:103], v14, s[44:47], s89 offen offset:1024 nt
    buffer_load_dwordx2 v[116:117], v14, s[44:47], s89 offen offset:2048 nt
    v_pk_mul_f32 v[40:41], v[40:41], v[114:115]
    v_pk_mul_f32 v[42:43], v[42:43], v[114:115]
    v_pk_mul_f32 v[44:45], v[44:45], v[114:115]
    v_pk_mul_f32 v[46:47], v[46:47], v[114:115]
    v_pk_mul_f32 v[56:57], v[56:57], v[114:115]
    v_pk_mul_f32 v[58:59], v[58:59], v[114:115]
    v_pk_mul_f32 v[60:61], v[60:61], v[114:115]
    v_pk_mul_f32 v[62:63], v[62:63], v[114:115]
    s_waitcnt vmcnt(7)
    v_mul_f32 v201, v114, v201
    v_mul_f32 v200, v200, v201
    v_mul_f32 v203, v114, v203
    v_mul_f32 v202, v202, v203
    v_mul_f32 v205, v114, v205
    v_mul_f32 v204, v204, v205
    v_mul_f32 v207, v114, v207
    v_mul_f32_e64 v206, v206, v207
    buffer_load_dwordx4 v[120:123], v14, s[36:39], s88 offen offset:0 sc1
    buffer_load_dwordx4 v[124:127], v14, s[36:39], s88 offen offset:1024 sc1
    s_waitcnt lgkmcnt(0)
    s_lshl_b32 s78, s84, 1
    s_and_b32 s78, s78, -4
    s_nop 0
    s_load_dword s77, s[14:15], s78
    v_pk_fma_f32 v[32:33], v[216:217], v[200:201], v[40:41] op_sel_hi:[1,0,1] neg_lo:[0,1,0] neg_hi:[0,1,0]
    v_pk_fma_f32 v[34:35], v[218:219], v[200:201], v[42:43] op_sel_hi:[1,0,1] neg_lo:[0,1,0] neg_hi:[0,1,0]
    v_pk_fma_f32 v[36:37], v[220:221], v[200:201], v[44:45] op_sel_hi:[1,0,1] neg_lo:[0,1,0] neg_hi:[0,1,0]
    buffer_load_dwordx4 a[0:3], v14, s[36:39], s52 offen offset:0 sc1
    v_pk_fma_f32 v[38:39], v[222:223], v[200:201], v[46:47] op_sel_hi:[1,0,1] neg_lo:[0,1,0] neg_hi:[0,1,0]
    v_pk_fma_f32 v[32:33], v[128:129], v[200:201], v[32:33] op_sel:[0,1,0] op_sel_hi:[1,1,1]
    v_pk_fma_f32 v[34:35], v[130:131], v[200:201], v[34:35] op_sel:[0,1,0] op_sel_hi:[1,1,1]
    v_pk_fma_f32 v[36:37], v[144:145], v[200:201], v[36:37] op_sel:[0,1,0] op_sel_hi:[1,1,1]
    v_pk_fma_f32 v[38:39], v[146:147], v[200:201], v[38:39] op_sel:[0,1,0] op_sel_hi:[1,1,1]
    v_pk_fma_f32 v[48:49], v[32:33], v[32:33], s[74:75]
    v_pk_fma_f32 v[50:51], v[34:35], v[34:35], s[74:75]
    v_pk_fma_f32 v[52:53], v[36:37], v[36:37], s[74:75]
    v_pk_fma_f32 v[54:55], v[38:39], v[38:39], s[74:75]
    v_pk_fma_f32 v[48:49], v[48:49], v[32:33], v[112:113] neg_lo:[0,1,0] neg_hi:[0,1,0]
    v_pk_fma_f32 v[50:51], v[50:51], v[34:35], v[112:113] neg_lo:[0,1,0] neg_hi:[0,1,0]
    v_pk_fma_f32 v[52:53], v[52:53], v[36:37], v[112:113] neg_lo:[0,1,0] neg_hi:[0,1,0]
    v_pk_fma_f32 v[54:55], v[54:55], v[38:39], v[112:113] neg_lo:[0,1,0] neg_hi:[0,1,0]
    v_exp_f32 v64, v48
    v_exp_f32 v65, v49
    v_exp_f32 v66, v50
    v_exp_f32 v67, v51
    v_exp_f32 v68, v52
    v_exp_f32 v69, v53
    v_exp_f32 v70, v54
    v_exp_f32 v71, v55
    v_pk_add_f32 v[64:65], v[64:65], v[114:115]
    buffer_load_dwordx4 a[4:7], v14, s[36:39], s52 offen offset:1024 sc1
    v_pk_add_f32 v[66:67], v[66:67], v[114:115]
    v_pk_add_f32 v[68:69], v[68:69], v[114:115]
    v_pk_add_f32 v[70:71], v[70:71], v[114:115]
    v_rcp_f32 v64, v64
    v_rcp_f32 v65, v65
    v_rcp_f32 v66, v66
    v_rcp_f32 v67, v67
    v_rcp_f32 v68, v68
    v_rcp_f32 v69, v69
    v_rcp_f32_e64 v70, v70
    v_rcp_f32 v71, v71
    s_nop 0
    v_pk_mul_f32 v[32:33], v[32:33], v[64:65]
    v_pk_mul_f32 v[34:35], v[34:35], v[66:67]
    v_pk_mul_f32 v[36:37], v[36:37], v[68:69]
    v_pk_mul_f32 v[38:39], v[38:39], v[70:71]
    v_cvt_pk_bf16_f32 v128, v32, v33
    v_cvt_pk_bf16_f32 v129, v34, v35
    v_cvt_pk_bf16_f32 v130, v36, v37
    v_cvt_pk_bf16_f32 v131, v38, v39
    s_lshr_b32 s73, s69, 1
    s_lshl_b32 s73, s73, 10
    s_add_u32 s73, s73, s76
    s_nop 0
    buffer_store_dwordx4 v[128:131], v18, s[36:39], s73 offen sc1
PAGE3:
    s_cbranch_execz PAGE4
    s_nop 0
    v_pk_fma_f32 v[32:33], v[224:225], v[200:201], v[56:57] op_sel_hi:[1,0,1] neg_lo:[0,1,0] neg_hi:[0,1,0]
    v_pk_fma_f32 v[34:35], v[226:227], v[200:201], v[58:59] op_sel_hi:[1,0,1] neg_lo:[0,1,0] neg_hi:[0,1,0]
    v_pk_fma_f32 v[36:37], v[228:229], v[200:201], v[60:61] op_sel_hi:[1,0,1] neg_lo:[0,1,0] neg_hi:[0,1,0]
    buffer_load_dwordx4 a[8:11], v14, s[36:39], s52 offen offset:2048 sc1
    v_pk_fma_f32 v[38:39], v[230:231], v[200:201], v[62:63] op_sel_hi:[1,0,1] neg_lo:[0,1,0] neg_hi:[0,1,0]
    v_pk_fma_f32 v[32:33], v[160:161], v[200:201], v[32:33] op_sel:[0,1,0] op_sel_hi:[1,1,1]
    v_pk_fma_f32 v[34:35], v[162:163], v[200:201], v[34:35] op_sel:[0,1,0] op_sel_hi:[1,1,1]
    v_pk_fma_f32 v[36:37], v[176:177], v[200:201], v[36:37] op_sel:[0,1,0] op_sel_hi:[1,1,1]
    v_pk_fma_f32 v[38:39], v[178:179], v[200:201], v[38:39] op_sel:[0,1,0] op_sel_hi:[1,1,1]
    v_pk_fma_f32 v[48:49], v[32:33], v[32:33], s[74:75]
    v_pk_fma_f32 v[50:51], v[34:35], v[34:35], s[74:75]
    v_pk_fma_f32 v[52:53], v[36:37], v[36:37], s[74:75]
    v_pk_fma_f32 v[54:55], v[38:39], v[38:39], s[74:75]
    v_pk_fma_f32 v[48:49], v[48:49], v[32:33], v[112:113] neg_lo:[0,1,0] neg_hi:[0,1,0]
    v_pk_fma_f32 v[50:51], v[50:51], v[34:35], v[112:113] neg_lo:[0,1,0] neg_hi:[0,1,0]
    v_pk_fma_f32 v[52:53], v[52:53], v[36:37], v[112:113] neg_lo:[0,1,0] neg_hi:[0,1,0]
    v_pk_fma_f32 v[54:55], v[54:55], v[38:39], v[112:113] neg_lo:[0,1,0] neg_hi:[0,1,0]
    v_exp_f32 v64, v48
    v_exp_f32 v65, v49
    v_exp_f32 v66, v50
    v_exp_f32 v67, v51
    v_exp_f32 v68, v52
    v_exp_f32 v69, v53
    v_exp_f32 v70, v54
    v_exp_f32 v71, v55
    v_pk_add_f32 v[64:65], v[64:65], v[114:115]
    buffer_load_dwordx4 a[12:15], v14, s[36:39], s52 offen offset:3072 sc1
    v_pk_add_f32 v[66:67], v[66:67], v[114:115]
    v_pk_add_f32 v[68:69], v[68:69], v[114:115]
    v_pk_add_f32 v[70:71], v[70:71], v[114:115]
    v_rcp_f32 v64, v64
    v_rcp_f32 v65, v65
    v_rcp_f32 v66, v66
    v_rcp_f32 v67, v67
    v_rcp_f32 v68, v68
    v_rcp_f32 v69, v69
    v_rcp_f32_e64 v70, v70
    v_rcp_f32 v71, v71
    s_nop 0
    v_pk_mul_f32 v[32:33], v[32:33], v[64:65]
    v_pk_mul_f32 v[34:35], v[34:35], v[66:67]
    v_pk_mul_f32 v[36:37], v[36:37], v[68:69]
    v_pk_mul_f32 v[38:39], v[38:39], v[70:71]
    v_cvt_pk_bf16_f32 v160, v32, v33
    v_cvt_pk_bf16_f32 v161, v34, v35
    v_cvt_pk_bf16_f32 v162, v36, v37
    v_cvt_pk_bf16_f32 v163, v38, v39
    s_lshr_b32 s73, s71, 1
    s_lshl_b32 s73, s73, 10
    s_add_u32 s73, s73, s76
    s_nop 0
    buffer_store_dwordx4 v[160:163], v18, s[36:39], s73 offen sc1
    v_pk_fma_f32 v[32:33], v[216:217], v[202:203], v[40:41] op_sel_hi:[1,0,1] neg_lo:[0,1,0] neg_hi:[0,1,0]
    v_pk_fma_f32 v[34:35], v[218:219], v[202:203], v[42:43] op_sel_hi:[1,0,1] neg_lo:[0,1,0] neg_hi:[0,1,0]
    v_pk_fma_f32 v[36:37], v[220:221], v[202:203], v[44:45] op_sel_hi:[1,0,1] neg_lo:[0,1,0] neg_hi:[0,1,0]
    buffer_load_dwordx4 a[16:19], v15, s[36:39], s52 offen offset:0 sc1
    s_add_u32 s52, s52, 5120
    v_pk_fma_f32 v[38:39], v[222:223], v[202:203], v[46:47] op_sel_hi:[1,0,1] neg_lo:[0,1,0] neg_hi:[0,1,0]
    v_pk_fma_f32 v[32:33], v[132:133], v[202:203], v[32:33] op_sel:[0,1,0] op_sel_hi:[1,1,1]
    v_pk_fma_f32 v[34:35], v[134:135], v[202:203], v[34:35] op_sel:[0,1,0] op_sel_hi:[1,1,1]
    v_pk_fma_f32 v[36:37], v[148:149], v[202:203], v[36:37] op_sel:[0,1,0] op_sel_hi:[1,1,1]
    v_pk_fma_f32 v[38:39], v[150:151], v[202:203], v[38:39] op_sel:[0,1,0] op_sel_hi:[1,1,1]
    v_pk_fma_f32 v[48:49], v[32:33], v[32:33], s[74:75]
    v_pk_fma_f32 v[50:51], v[34:35], v[34:35], s[74:75]
    v_pk_fma_f32 v[52:53], v[36:37], v[36:37], s[74:75]
    v_pk_fma_f32 v[54:55], v[38:39], v[38:39], s[74:75]
    v_pk_fma_f32 v[48:49], v[48:49], v[32:33], v[112:113] neg_lo:[0,1,0] neg_hi:[0,1,0]
    v_pk_fma_f32 v[50:51], v[50:51], v[34:35], v[112:113] neg_lo:[0,1,0] neg_hi:[0,1,0]
    v_pk_fma_f32 v[52:53], v[52:53], v[36:37], v[112:113] neg_lo:[0,1,0] neg_hi:[0,1,0]
    v_pk_fma_f32 v[54:55], v[54:55], v[38:39], v[112:113] neg_lo:[0,1,0] neg_hi:[0,1,0]
    v_exp_f32 v64, v48
    v_exp_f32 v65, v49
    v_exp_f32 v66, v50
    v_exp_f32 v67, v51
    v_exp_f32 v68, v52
    v_exp_f32 v69, v53
    v_exp_f32 v70, v54
    v_exp_f32 v71, v55
    v_pk_add_f32 v[64:65], v[64:65], v[114:115]
    buffer_load_dwordx4 a[20:23], v14, s[36:39], s52 offen offset:0 sc1
    v_pk_add_f32 v[66:67], v[66:67], v[114:115]
    v_pk_add_f32 v[68:69], v[68:69], v[114:115]
    v_pk_add_f32 v[70:71], v[70:71], v[114:115]
    v_rcp_f32 v64, v64
    v_rcp_f32 v65, v65
    v_rcp_f32 v66, v66
    v_rcp_f32 v67, v67
    v_rcp_f32 v68, v68
    v_rcp_f32 v69, v69
    v_rcp_f32_e64 v70, v70
    v_rcp_f32 v71, v71
    s_nop 0
    v_pk_mul_f32 v[32:33], v[32:33], v[64:65]
    v_pk_mul_f32 v[34:35], v[34:35], v[66:67]
    v_pk_mul_f32 v[36:37], v[36:37], v[68:69]
    v_pk_mul_f32 v[38:39], v[38:39], v[70:71]
    v_cvt_pk_bf16_f32 v132, v32, v33
    v_cvt_pk_bf16_f32 v133, v34, v35
    v_cvt_pk_bf16_f32 v134, v36, v37
    v_cvt_pk_bf16_f32 v135, v38, v39
    s_lshr_b32 s73, s69, 1
    s_lshl_b32 s73, s73, 10
    s_add_u32 s73, s73, s76
    s_nop 0
    s_add_u32 s73, s73, 55296
    buffer_store_dwordx4 v[132:135], v18, s[36:39], s73 offen sc1
    v_pk_fma_f32 v[32:33], v[224:225], v[202:203], v[56:57] op_sel_hi:[1,0,1] neg_lo:[0,1,0] neg_hi:[0,1,0]
    v_pk_fma_f32 v[34:35], v[226:227], v[202:203], v[58:59] op_sel_hi:[1,0,1] neg_lo:[0,1,0] neg_hi:[0,1,0]
    v_pk_fma_f32 v[36:37], v[228:229], v[202:203], v[60:61] op_sel_hi:[1,0,1] neg_lo:[0,1,0] neg_hi:[0,1,0]
    buffer_load_dwordx4 a[24:27], v14, s[36:39], s52 offen offset:1024 sc1
    v_pk_fma_f32 v[38:39], v[230:231], v[202:203], v[62:63] op_sel_hi:[1,0,1] neg_lo:[0,1,0] neg_hi:[0,1,0]
    v_pk_fma_f32 v[32:33], v[164:165], v[202:203], v[32:33] op_sel:[0,1,0] op_sel_hi:[1,1,1]
    v_pk_fma_f32 v[34:35], v[166:167], v[202:203], v[34:35] op_sel:[0,1,0] op_sel_hi:[1,1,1]
    v_pk_fma_f32 v[36:37], v[180:181], v[202:203], v[36:37] op_sel:[0,1,0] op_sel_hi:[1,1,1]
    v_pk_fma_f32 v[38:39], v[182:183], v[202:203], v[38:39] op_sel:[0,1,0] op_sel_hi:[1,1,1]
    v_pk_fma_f32 v[48:49], v[32:33], v[32:33], s[74:75]
    v_pk_fma_f32 v[50:51], v[34:35], v[34:35], s[74:75]
    v_pk_fma_f32 v[52:53], v[36:37], v[36:37], s[74:75]
    v_pk_fma_f32 v[54:55], v[38:39], v[38:39], s[74:75]
    v_pk_fma_f32 v[48:49], v[48:49], v[32:33], v[112:113] neg_lo:[0,1,0] neg_hi:[0,1,0]
    v_pk_fma_f32 v[50:51], v[50:51], v[34:35], v[112:113] neg_lo:[0,1,0] neg_hi:[0,1,0]
    v_pk_fma_f32 v[52:53], v[52:53], v[36:37], v[112:113] neg_lo:[0,1,0] neg_hi:[0,1,0]
    v_pk_fma_f32 v[54:55], v[54:55], v[38:39], v[112:113] neg_lo:[0,1,0] neg_hi:[0,1,0]
    v_exp_f32 v64, v48
    v_exp_f32 v65, v49
    v_exp_f32 v66, v50
    v_exp_f32 v67, v51
    v_exp_f32 v68, v52
    v_exp_f32 v69, v53
    v_exp_f32 v70, v54
    v_exp_f32 v71, v55
    v_pk_add_f32 v[64:65], v[64:65], v[114:115]
    buffer_load_dwordx4 a[28:31], v14, s[36:39], s52 offen offset:2048 sc1
    v_pk_add_f32 v[66:67], v[66:67], v[114:115]
    v_pk_add_f32 v[68:69], v[68:69], v[114:115]
    v_pk_add_f32 v[70:71], v[70:71], v[114:115]
    v_rcp_f32 v64, v64
    v_rcp_f32 v65, v65
    v_rcp_f32 v66, v66
    v_rcp_f32 v67, v67
    v_rcp_f32 v68, v68
    v_rcp_f32 v69, v69
    v_rcp_f32_e64 v70, v70
    v_rcp_f32 v71, v71
    s_nop 0
    v_pk_mul_f32 v[32:33], v[32:33], v[64:65]
    v_pk_mul_f32 v[34:35], v[34:35], v[66:67]
    v_pk_mul_f32 v[36:37], v[36:37], v[68:69]
    v_pk_mul_f32 v[38:39], v[38:39], v[70:71]
    v_cvt_pk_bf16_f32 v164, v32, v33
    v_cvt_pk_bf16_f32 v165, v34, v35
    v_cvt_pk_bf16_f32 v166, v36, v37
    v_cvt_pk_bf16_f32 v167, v38, v39
    s_lshr_b32 s73, s71, 1
    s_lshl_b32 s73, s73, 10
    s_add_u32 s73, s73, s76
    s_nop 0
    s_add_u32 s73, s73, 55296
    buffer_store_dwordx4 v[164:167], v18, s[36:39], s73 offen sc1
    v_pk_fma_f32 v[32:33], v[216:217], v[204:205], v[40:41] op_sel_hi:[1,0,1] neg_lo:[0,1,0] neg_hi:[0,1,0]
    v_pk_fma_f32 v[34:35], v[218:219], v[204:205], v[42:43] op_sel_hi:[1,0,1] neg_lo:[0,1,0] neg_hi:[0,1,0]
    v_pk_fma_f32 v[36:37], v[220:221], v[204:205], v[44:45] op_sel_hi:[1,0,1] neg_lo:[0,1,0] neg_hi:[0,1,0]
    buffer_load_dwordx4 a[32:35], v14, s[36:39], s52 offen offset:3072 sc1
    v_pk_fma_f32 v[38:39], v[222:223], v[204:205], v[46:47] op_sel_hi:[1,0,1] neg_lo:[0,1,0] neg_hi:[0,1,0]
    v_pk_fma_f32 v[32:33], v[136:137], v[204:205], v[32:33] op_sel:[0,1,0] op_sel_hi:[1,1,1]
    v_pk_fma_f32 v[34:35], v[138:139], v[204:205], v[34:35] op_sel:[0,1,0] op_sel_hi:[1,1,1]
    v_pk_fma_f32 v[36:37], v[152:153], v[204:205], v[36:37] op_sel:[0,1,0] op_sel_hi:[1,1,1]
    v_pk_fma_f32 v[38:39], v[154:155], v[204:205], v[38:39] op_sel:[0,1,0] op_sel_hi:[1,1,1]
    v_pk_fma_f32 v[48:49], v[32:33], v[32:33], s[74:75]
    v_pk_fma_f32 v[50:51], v[34:35], v[34:35], s[74:75]
    v_pk_fma_f32 v[52:53], v[36:37], v[36:37], s[74:75]
    v_pk_fma_f32 v[54:55], v[38:39], v[38:39], s[74:75]
    v_pk_fma_f32 v[48:49], v[48:49], v[32:33], v[112:113] neg_lo:[0,1,0] neg_hi:[0,1,0]
    v_pk_fma_f32 v[50:51], v[50:51], v[34:35], v[112:113] neg_lo:[0,1,0] neg_hi:[0,1,0]
    v_pk_fma_f32 v[52:53], v[52:53], v[36:37], v[112:113] neg_lo:[0,1,0] neg_hi:[0,1,0]
    v_pk_fma_f32 v[54:55], v[54:55], v[38:39], v[112:113] neg_lo:[0,1,0] neg_hi:[0,1,0]
    v_exp_f32 v64, v48
    v_exp_f32 v65, v49
    v_exp_f32 v66, v50
    v_exp_f32 v67, v51
    v_exp_f32 v68, v52
    v_exp_f32 v69, v53
    v_exp_f32 v70, v54
    v_exp_f32 v71, v55
    v_pk_add_f32 v[64:65], v[64:65], v[114:115]
    buffer_load_dwordx4 a[36:39], v15, s[36:39], s52 offen offset:0 sc1
    s_add_u32 s52, s52, 5120
    v_pk_add_f32 v[66:67], v[66:67], v[114:115]
    v_pk_add_f32 v[68:69], v[68:69], v[114:115]
    v_pk_add_f32 v[70:71], v[70:71], v[114:115]
    v_rcp_f32 v64, v64
    v_rcp_f32 v65, v65
    v_rcp_f32 v66, v66
    v_rcp_f32 v67, v67
    v_rcp_f32 v68, v68
    v_rcp_f32 v69, v69
    v_rcp_f32_e64 v70, v70
    v_rcp_f32 v71, v71
    s_nop 0
    v_pk_mul_f32 v[32:33], v[32:33], v[64:65]
    v_pk_mul_f32 v[34:35], v[34:35], v[66:67]
    v_pk_mul_f32 v[36:37], v[36:37], v[68:69]
    v_pk_mul_f32 v[38:39], v[38:39], v[70:71]
    v_cvt_pk_bf16_f32 v136, v32, v33
    v_cvt_pk_bf16_f32 v137, v34, v35
    v_cvt_pk_bf16_f32 v138, v36, v37
    v_cvt_pk_bf16_f32 v139, v38, v39
    s_lshr_b32 s73, s69, 1
    s_lshl_b32 s73, s73, 10
    s_add_u32 s73, s73, s76
    s_nop 0
    s_add_u32 s73, s73, 110592
    buffer_store_dwordx4 v[136:139], v18, s[36:39], s73 offen sc1
    v_pk_fma_f32 v[32:33], v[224:225], v[204:205], v[56:57] op_sel_hi:[1,0,1] neg_lo:[0,1,0] neg_hi:[0,1,0]
    v_pk_fma_f32 v[34:35], v[226:227], v[204:205], v[58:59] op_sel_hi:[1,0,1] neg_lo:[0,1,0] neg_hi:[0,1,0]
    v_pk_fma_f32 v[36:37], v[228:229], v[204:205], v[60:61] op_sel_hi:[1,0,1] neg_lo:[0,1,0] neg_hi:[0,1,0]
    buffer_load_dwordx4 a[40:43], v14, s[36:39], s52 offen offset:0 sc1
    v_pk_fma_f32 v[38:39], v[230:231], v[204:205], v[62:63] op_sel_hi:[1,0,1] neg_lo:[0,1,0] neg_hi:[0,1,0]
    v_pk_fma_f32 v[32:33], v[168:169], v[204:205], v[32:33] op_sel:[0,1,0] op_sel_hi:[1,1,1]
    v_pk_fma_f32 v[34:35], v[170:171], v[204:205], v[34:35] op_sel:[0,1,0] op_sel_hi:[1,1,1]
    v_pk_fma_f32 v[36:37], v[184:185], v[204:205], v[36:37] op_sel:[0,1,0] op_sel_hi:[1,1,1]
    v_pk_fma_f32 v[38:39], v[186:187], v[204:205], v[38:39] op_sel:[0,1,0] op_sel_hi:[1,1,1]
    v_pk_fma_f32 v[48:49], v[32:33], v[32:33], s[74:75]
    v_pk_fma_f32 v[50:51], v[34:35], v[34:35], s[74:75]
    v_pk_fma_f32 v[52:53], v[36:37], v[36:37], s[74:75]
    v_pk_fma_f32 v[54:55], v[38:39], v[38:39], s[74:75]
    v_pk_fma_f32 v[48:49], v[48:49], v[32:33], v[112:113] neg_lo:[0,1,0] neg_hi:[0,1,0]
    v_pk_fma_f32 v[50:51], v[50:51], v[34:35], v[112:113] neg_lo:[0,1,0] neg_hi:[0,1,0]
    v_pk_fma_f32 v[52:53], v[52:53], v[36:37], v[112:113] neg_lo:[0,1,0] neg_hi:[0,1,0]
    v_pk_fma_f32 v[54:55], v[54:55], v[38:39], v[112:113] neg_lo:[0,1,0] neg_hi:[0,1,0]
    v_exp_f32 v64, v48
    v_exp_f32 v65, v49
    v_exp_f32 v66, v50
    v_exp_f32 v67, v51
    v_exp_f32 v68, v52
    v_exp_f32 v69, v53
    v_exp_f32 v70, v54
    v_exp_f32 v71, v55
    v_pk_add_f32 v[64:65], v[64:65], v[114:115]
    buffer_load_dwordx4 a[44:47], v14, s[36:39], s52 offen offset:1024 sc1
    v_pk_add_f32 v[66:67], v[66:67], v[114:115]
    v_pk_add_f32 v[68:69], v[68:69], v[114:115]
    v_pk_add_f32 v[70:71], v[70:71], v[114:115]
    v_rcp_f32 v64, v64
    v_rcp_f32 v65, v65
    v_rcp_f32 v66, v66
    v_rcp_f32 v67, v67
    v_rcp_f32 v68, v68
    v_rcp_f32 v69, v69
    v_rcp_f32_e64 v70, v70
    v_rcp_f32 v71, v71
    s_nop 0
    v_pk_mul_f32 v[32:33], v[32:33], v[64:65]
    v_pk_mul_f32 v[34:35], v[34:35], v[66:67]
    v_pk_mul_f32 v[36:37], v[36:37], v[68:69]
    v_pk_mul_f32 v[38:39], v[38:39], v[70:71]
    v_cvt_pk_bf16_f32 v168, v32, v33
    v_cvt_pk_bf16_f32 v169, v34, v35
    v_cvt_pk_bf16_f32 v170, v36, v37
    v_cvt_pk_bf16_f32 v171, v38, v39
    s_lshr_b32 s73, s71, 1
    s_lshl_b32 s73, s73, 10
    s_add_u32 s73, s73, s76
    s_nop 0
    s_add_u32 s73, s73, 110592
    buffer_store_dwordx4 v[168:171], v18, s[36:39], s73 offen sc1
    v_pk_fma_f32 v[32:33], v[216:217], v[206:207], v[40:41] op_sel_hi:[1,0,1] neg_lo:[0,1,0] neg_hi:[0,1,0]
    v_pk_fma_f32 v[34:35], v[218:219], v[206:207], v[42:43] op_sel_hi:[1,0,1] neg_lo:[0,1,0] neg_hi:[0,1,0]
    v_pk_fma_f32 v[36:37], v[220:221], v[206:207], v[44:45] op_sel_hi:[1,0,1] neg_lo:[0,1,0] neg_hi:[0,1,0]
    buffer_load_dwordx4 a[48:51], v14, s[36:39], s52 offen offset:2048 sc1
    v_pk_fma_f32 v[38:39], v[222:223], v[206:207], v[46:47] op_sel_hi:[1,0,1] neg_lo:[0,1,0] neg_hi:[0,1,0]
    v_pk_fma_f32 v[32:33], v[140:141], v[206:207], v[32:33] op_sel:[0,1,0] op_sel_hi:[1,1,1]
    v_pk_fma_f32 v[34:35], v[142:143], v[206:207], v[34:35] op_sel:[0,1,0] op_sel_hi:[1,1,1]
    v_pk_fma_f32 v[36:37], v[156:157], v[206:207], v[36:37] op_sel:[0,1,0] op_sel_hi:[1,1,1]
    v_pk_fma_f32 v[38:39], v[158:159], v[206:207], v[38:39] op_sel:[0,1,0] op_sel_hi:[1,1,1]
    v_pk_fma_f32 v[48:49], v[32:33], v[32:33], s[74:75]
    v_pk_fma_f32 v[50:51], v[34:35], v[34:35], s[74:75]
    v_pk_fma_f32 v[52:53], v[36:37], v[36:37], s[74:75]
    v_pk_fma_f32 v[54:55], v[38:39], v[38:39], s[74:75]
    v_pk_fma_f32 v[48:49], v[48:49], v[32:33], v[112:113] neg_lo:[0,1,0] neg_hi:[0,1,0]
    v_pk_fma_f32 v[50:51], v[50:51], v[34:35], v[112:113] neg_lo:[0,1,0] neg_hi:[0,1,0]
    v_pk_fma_f32 v[52:53], v[52:53], v[36:37], v[112:113] neg_lo:[0,1,0] neg_hi:[0,1,0]
    v_pk_fma_f32 v[54:55], v[54:55], v[38:39], v[112:113] neg_lo:[0,1,0] neg_hi:[0,1,0]
    v_exp_f32 v64, v48
    v_exp_f32 v65, v49
    v_exp_f32 v66, v50
    v_exp_f32 v67, v51
    v_exp_f32 v68, v52
    v_exp_f32 v69, v53
    v_exp_f32 v70, v54
    v_exp_f32 v71, v55
    v_pk_add_f32 v[64:65], v[64:65], v[114:115]
    buffer_load_dwordx4 a[52:55], v14, s[36:39], s52 offen offset:3072 sc1
    v_pk_add_f32 v[66:67], v[66:67], v[114:115]
    v_pk_add_f32 v[68:69], v[68:69], v[114:115]
    v_pk_add_f32 v[70:71], v[70:71], v[114:115]
    v_rcp_f32 v64, v64
    v_rcp_f32 v65, v65
    v_rcp_f32 v66, v66
    v_rcp_f32 v67, v67
    v_rcp_f32 v68, v68
    v_rcp_f32 v69, v69
    v_rcp_f32_e64 v70, v70
    v_rcp_f32 v71, v71
    s_nop 0
    v_pk_mul_f32 v[32:33], v[32:33], v[64:65]
    v_pk_mul_f32 v[34:35], v[34:35], v[66:67]
    v_pk_mul_f32 v[36:37], v[36:37], v[68:69]
    v_pk_mul_f32 v[38:39], v[38:39], v[70:71]
    v_cvt_pk_bf16_f32 v140, v32, v33
    v_cvt_pk_bf16_f32 v141, v34, v35
    v_cvt_pk_bf16_f32 v142, v36, v37
    v_cvt_pk_bf16_f32 v143, v38, v39
    s_lshr_b32 s73, s69, 1
    s_lshl_b32 s73, s73, 10
    s_add_u32 s73, s73, s76
    s_nop 0
    s_add_u32 s73, s73, 165888
    buffer_store_dwordx4 v[140:143], v18, s[36:39], s73 offen sc1
    v_pk_fma_f32 v[32:33], v[224:225], v[206:207], v[56:57] op_sel_hi:[1,0,1] neg_lo:[0,1,0] neg_hi:[0,1,0]
    v_pk_fma_f32 v[34:35], v[226:227], v[206:207], v[58:59] op_sel_hi:[1,0,1] neg_lo:[0,1,0] neg_hi:[0,1,0]
    v_pk_fma_f32 v[36:37], v[228:229], v[206:207], v[60:61] op_sel_hi:[1,0,1] neg_lo:[0,1,0] neg_hi:[0,1,0]
    buffer_load_dwordx4 a[56:59], v15, s[36:39], s52 offen offset:0 sc1
    s_add_u32 s52, s52, 5120
    v_pk_fma_f32 v[38:39], v[230:231], v[206:207], v[62:63] op_sel_hi:[1,0,1] neg_lo:[0,1,0] neg_hi:[0,1,0]
    v_pk_fma_f32 v[32:33], v[172:173], v[206:207], v[32:33] op_sel:[0,1,0] op_sel_hi:[1,1,1]
    v_pk_fma_f32 v[34:35], v[174:175], v[206:207], v[34:35] op_sel:[0,1,0] op_sel_hi:[1,1,1]
    v_pk_fma_f32 v[36:37], v[188:189], v[206:207], v[36:37] op_sel:[0,1,0] op_sel_hi:[1,1,1]
    v_pk_fma_f32 v[38:39], v[190:191], v[206:207], v[38:39] op_sel:[0,1,0] op_sel_hi:[1,1,1]
    v_pk_fma_f32 v[48:49], v[32:33], v[32:33], s[74:75]
    v_pk_fma_f32 v[50:51], v[34:35], v[34:35], s[74:75]
    v_pk_fma_f32 v[52:53], v[36:37], v[36:37], s[74:75]
    v_pk_fma_f32 v[54:55], v[38:39], v[38:39], s[74:75]
    v_pk_fma_f32 v[48:49], v[48:49], v[32:33], v[112:113] neg_lo:[0,1,0] neg_hi:[0,1,0]
    v_pk_fma_f32 v[50:51], v[50:51], v[34:35], v[112:113] neg_lo:[0,1,0] neg_hi:[0,1,0]
    v_pk_fma_f32 v[52:53], v[52:53], v[36:37], v[112:113] neg_lo:[0,1,0] neg_hi:[0,1,0]
    v_pk_fma_f32 v[54:55], v[54:55], v[38:39], v[112:113] neg_lo:[0,1,0] neg_hi:[0,1,0]
    v_exp_f32 v64, v48
    v_exp_f32 v65, v49
    v_exp_f32 v66, v50
    v_exp_f32 v67, v51
    v_exp_f32 v68, v52
    v_exp_f32 v69, v53
    v_exp_f32 v70, v54
    v_exp_f32 v71, v55
    v_pk_add_f32 v[64:65], v[64:65], v[114:115]
    buffer_load_dwordx4 a[60:63], v14, s[36:39], s52 offen offset:0 sc1
    v_pk_add_f32 v[66:67], v[66:67], v[114:115]
    v_pk_add_f32 v[68:69], v[68:69], v[114:115]
    v_pk_add_f32 v[70:71], v[70:71], v[114:115]
    v_rcp_f32 v64, v64
    v_rcp_f32 v65, v65
    v_rcp_f32 v66, v66
    v_rcp_f32 v67, v67
    v_rcp_f32 v68, v68
    v_rcp_f32 v69, v69
    v_rcp_f32_e64 v70, v70
    v_rcp_f32 v71, v71
    s_nop 0
    v_pk_mul_f32 v[32:33], v[32:33], v[64:65]
    v_pk_mul_f32 v[34:35], v[34:35], v[66:67]
    v_pk_mul_f32 v[36:37], v[36:37], v[68:69]
    v_pk_mul_f32 v[38:39], v[38:39], v[70:71]
    v_cvt_pk_bf16_f32 v172, v32, v33
    v_cvt_pk_bf16_f32 v173, v34, v35
    v_cvt_pk_bf16_f32 v174, v36, v37
    v_cvt_pk_bf16_f32 v175, v38, v39
    s_lshr_b32 s73, s71, 1
    s_lshl_b32 s73, s73, 10
    s_add_u32 s73, s73, s76
    s_add_u32 s73, s73, 165888
    buffer_store_dwordx4 v[172:175], v18, s[36:39], s73 offen sc1
    s_lshl_b32 s48, s63, 4
    s_add_u32 s48, s48, s64
    s_lshl_b32 s48, s48, 6
    s_add_u32 s48, s48, 229376
    s_cmp_eq_u32 s3, 0
    s_cselect_b32 s48, s48, 17563648
    s_mov_b32 s50, 1
    s_lshr_b32 s78, s68, 1
    s_lshl_b32 s78, s78, 10
    s_add_u32 s29, s76, s78
C4JOIN:
    s_lshr_b32 s49, s53, 1
    s_lshl_b32 s49, s49, 10
    s_add_u32 s49, s49, 229376
    s_mul_i32 s79, s53, 216
    s_add_u32 s79, s79, s55
    s_lshl_b32 s79, s79, 10
    s_add_u32 s79, s79, 10485760
    s_add_u32 s61, s79, 14336
    s_cmp_ge_u32 s3, 2
    s_cselect_b32 s62, s79, 1
    s_lshl_b32 s60, s28, 10
    s_add_u32 s60, s60, s79
    s_add_u32 s78, s3, 0
    s_and_b32 s78, s78, 3
    s_mul_i32 s78, s78, 55296
    v_add_u32 v24, s78, v14
    s_add_u32 s78, s3, 1
    s_and_b32 s78, s78, 3
    s_mul_i32 s78, s78, 55296
    v_add_u32 v25, s78, v14
    s_add_u32 s78, s3, 2
    s_and_b32 s78, s78, 3
    s_mul_i32 s78, s78, 55296
    v_add_u32 v26, s78, v14
    s_add_u32 s78, s3, 3
    s_and_b32 s78, s78, 3
    s_mul_i32 s78, s78, 55296
    v_add_u32 v27, s78, v14
    s_mul_i32 s68, s54, 160
    v_min_u32 v18, 13, v0
    v_lshlrev_b32 v18, 6, v18
    s_waitcnt vmcnt(24) lgkmcnt(0)
    v_mov_b32_dpp v107, v100 wave_rol:1 row_mask:0xf bank_mask:0xf
    v_mov_b32_dpp v112, v101 wave_rol:1 row_mask:0xf bank_mask:0xf
    v_mov_b32_dpp v111, v116 wave_rol:1 row_mask:0xf bank_mask:0xf
    v_mov_b32_dpp v113, v117 wave_rol:1 row_mask:0xf bank_mask:0xf
    v_mov_b32 v104, v97
    v_mov_b32 v105, v98
    v_mov_b32 v106, v99
    v_mov_b32 v108, v101
    v_mov_b32 v109, v102
    v_mov_b32 v110, v103
    v_mov_b32_dpp v107, v96 wave_shl:1 row_mask:0xf bank_mask:0xf
    v_mov_b32_dpp v112, v97 wave_shl:1 row_mask:0xf bank_mask:0xf
    v_mov_b32_dpp v111, v100 wave_shl:1 row_mask:0xf bank_mask:0xf
    v_mov_b32_dpp v113, v101 wave_shl:1 row_mask:0xf bank_mask:0xf
    s_nop 1
    v_lshlrev_b32 v1, 4, v0
    v_add_u32 v5, s86, v1
    s_cmp_lg_u32 s87, 0
    s_cbranch_scc1 CV_NOPRE_10
    v_mov_b32 v20, 0
    v_mov_b32 v21, 0
    v_mov_b32 v22, 0
    v_mov_b32 v23, 0
    v_lshrrev_b32 v4, 1, v0
    v_mul_u32_u24 v4, 4160, v4
    v_and_b32 v6, 1, v0
    v_lshl_add_u32 v4, v6, 4, v4
    v_add_u32 v4, s86, v4
    s_mov_b32 exec_lo, 0xff
    s_mov_b32 exec_hi, 0
    ds_write_b128 v4, v[20:23]
    s_mov_b32 exec_lo, -1
    ds_write_b128 v5, v[20:23] offset:16640
    v_lshlrev_b32 v12, 16, v96
    v_alignbit_b32 v13, v104, v96, 16
    s_mov_b32 exec_lo, 1
    ds_write_b32 v5, v12 offset:4188
    ds_write_b32 v5, v96 offset:8348
    ds_write_b64 v5, v[12:13] offset:12504
    s_mov_b64 exec, -1
CV_NOPRE_10:
    s_lshl_b32 s78, s87, 11
    v_add_u32_e64 v5, s78, v5
    v_alignbit_b32 v32, v104, v96, 16
    v_alignbit_b32 v36, v105, v104, 16
    v_alignbit_b32 v33, v105, v97, 16
    v_alignbit_b32 v37, v106, v105, 16
    v_alignbit_b32 v34, v106, v98, 16
    v_alignbit_b32 v38, v107, v106, 16
    v_alignbit_b32 v35, v107, v99, 16
    v_alignbit_b32 v39, v112, v107, 16
    v_min_u32 v19, ((IDLE-G2_START+511)/512)-1, v0
    s_mul_i32 s80, s3, ((IDLE-G2_START+511)/512)
    v_add_u32 v19, s80, v19
    v_lshlrev_b32 v19, 7, v19
    s_getpc_b64 s[80:81]
CT_9:
    s_nop 0
    v_add_u32 v19, G2_START-CT_9, v19
    s_mov_b32 s82, CODE_END-CT_9
    s_mov_b32 s83, 0x20000
    buffer_load_dword v19, v19, s[80:83], 0 offen
    buffer_load_dwordx4 a[64:67], v14, s[36:39], s52 offen offset:1024 sc1
    ds_write_b128 v5, v[96:99] offset:32
    ds_write_b128 v5, v[32:35] offset:4192
    buffer_load_dwordx4 a[68:71], v14, s[36:39], s52 offen offset:2048 sc1
    buffer_load_dwordx4 a[72:75], v14, s[36:39], s52 offen offset:3072 sc1
    ds_write_b128 v5, v[104:107] offset:8352
    ds_write_b128 v5, v[36:39] offset:12512
    ds_write_b128 v5, v[120:123] offset:17152
    buffer_load_dwordx4 a[76:79], v15, s[36:39], s52 offen offset:0 sc1
    s_add_u32 s52, s52, 5120
    buffer_load_dwordx4 a[80:83], v14, s[36:39], s52 offen offset:0 sc1
    v_alignbit_b32 v40, v108, v100, 16
    v_alignbit_b32 v44, v109, v108, 16
    v_alignbit_b32 v41, v109, v101, 16
    v_alignbit_b32 v45, v110, v109, 16
    v_alignbit_b32 v42, v110, v102, 16
    v_alignbit_b32 v46, v111, v110, 16
    v_alignbit_b32 v43, v111, v103, 16
    v_alignbit_b32 v47, v113, v111, 16
    buffer_load_dwordx4 a[84:87], v14, s[36:39], s52 offen offset:1024 sc1
    ds_write_b128 v5, v[100:103] offset:1056
    ds_write_b128 v5, v[40:43] offset:5216
    buffer_load_dwordx4 a[88:91], v14, s[36:39], s52 offen offset:2048 sc1
    ds_write_b128 v5, v[108:111] offset:9376
    ds_write_b128 v5, v[44:47] offset:13536
    ds_write_b128 v5, v[124:127] offset:18176
    buffer_load_dwordx4 a[92:95], v14, s[36:39], s52 offen offset:3072 sc1
    v_and_b32 v6, 15, v0
    v_lshrrev_b32 v7, 4, v0
    v_add_u32 v8, 1, v6
    v_and_b32 v9, 3, v8
    v_and_b32_e64 v8, 28, v8
    v_mul_u32_u24 v9, 4160, v9
    v_lshl_add_u32 v9, v8, 1, v9
    v_lshl_add_u32 v9, v7, 4, v9
    v_add_u32 v2, s86, v9
    v_lshlrev_b32 v8, 1, v6
    v_sub_u32 v8, v8, v7
    v_lshlrev_b32 v8, 4, v8
    v_add_u32 v8, 16720, v8
    v_add_u32 v3, s86, v8
    s_lshl_b32 s78, s87, 8
    v_add_u32 v2, s78, v2
    v_subrev_u32 v3, s78, v3
    buffer_load_dwordx4 a[96:99], v15, s[36:39], s52 offen offset:0 sc1
    s_add_u32 s52, s52, 5120
    v_sub_u32 v8, 15, v6
    v_lshrrev_b32 v9, 3, v8
    v_cmp_eq_u32 s[80:81], v9, v7
    v_bfe_u32 v9, v8, 1, 2
    v_and_b32 v10, 1, v8
    v_lshlrev_b32 v10, 4, v10
    s_and_b32 s78, s84, 1
    s_lshl_b32 s78, s78, 4
    s_lshr_b32 s77, s77, s78
    s_and_b32 s77, s77, 0xffff
    s_cmp_eq_u32 s87, 0
    s_cselect_b32 s77, s77, 0
    buffer_load_dwordx4 a[100:103], v14, s[36:39], s52 offen offset:0 sc1
    v_mov_b32 v11, s77
    v_lshlrev_b32 v11, v10, v11
    v_cndmask_b32 v11, 0, v11, s[80:81]
    v_cmp_eq_u32 vcc, 0, v9
    s_nop 1
    v_cndmask_b32 v192, 0, v11, vcc
    v_cmp_eq_u32 vcc, 1, v9
    s_nop 1
    v_cndmask_b32 v193, 0, v11, vcc
    buffer_load_dwordx4 a[104:107], v14, s[36:39], s52 offen offset:1024 sc1
    v_cmp_eq_u32 vcc, 2, v9
    s_nop 1
    v_cndmask_b32 v194, 0, v11, vcc
    v_cmp_eq_u32 vcc, 3, v9
    s_nop 1
    v_cndmask_b32_e64 v195, 0, v11, vcc
    buffer_load_dwordx4 a[108:111], v14, s[36:39], s52 offen offset:2048 sc1
    buffer_load_dwordx4 a[112:115], v14, s[36:39], s52 offen offset:3072 sc1
    s_waitcnt vmcnt(14) lgkmcnt(0)
    s_barrier
    v_mov_b32 v16, s56
    v_lshlrev_b32 v17, 6, v0
    s_mov_b32 exec_lo, s50
    s_mov_b32 exec_hi, 0
    buffer_store_dword v16, v17, s[36:39], s48 offen sc1
    s_mov_b64 exec, -1
    s_nop 0
    ds_read_b128 v[64:67], v3 offset:448
    ds_read_b64 v[32:33], v2 offset:0
    ds_read_b64 v[34:35], v2 offset:8
    ds_read_b128 v[68:71], v3 offset:960
    ds_read_b64 v[36:37], v2 offset:512
    ds_read_b64 v[38:39], v2 offset:520
    ds_read_b128 v[72:75], v3 offset:1472
    ds_read_b64 v[40:41], v2 offset:1024
    ds_read_b64 v[42:43], v2 offset:1032
    ds_read_b128 v[76:79], v3 offset:1984
    ds_read_b64 v[44:45], v2 offset:1536
    ds_read_b64 v[46:47], v2 offset:1544
    ds_read_b128 v[80:83], v3 offset:2496
    ds_read_b64 v[48:49], v2 offset:2048
    ds_read_b64 v[50:51], v2 offset:2056
    ds_read_b128 v[84:87], v3 offset:3008
    ds_read_b64 v[52:53], v2 offset:2560
    ds_read_b64 v[54:55], v2 offset:2568
    ds_read_b128 v[88:91], v3 offset:3520
    ds_read_b64 v[56:57], v2 offset:3072
    ds_read_b64 v[58:59], v2 offset:3080
    ds_read_b128 v[92:95], v3 offset:4032
    ds_read_b64 v[60:61], v2 offset:3584
    ds_read_b64 v[62:63], v2 offset:3592
    s_waitcnt lgkmcnt(15)
    s_nop 0
    v_mfma_f32_16x16x32_bf16 v[160:163], v[192:195], v[64:67], 0
    ds_read_b128 v[128:131], v3 offset:384
    v_mfma_f32_16x16x32_bf16 v[164:167], v[192:195], v[68:71], 0
    ds_read_b64 v[96:97], v2 offset:64
    v_mfma_f32_16x16x32_bf16 v[168:171], v[192:195], v[72:75], 0
    ds_read_b64 v[98:99], v2 offset:72
    buffer_load_dwordx4 a[116:119], v15, s[36:39], s52 offen offset:0 sc1
    s_add_u32 s52, s52, 5120
    s_waitcnt lgkmcnt(15)
    v_mfma_f32_16x16x32_bf16 v[172:175], v[192:195], v[76:79], 0
    ds_read_b128 v[132:135], v3 offset:896
    s_waitcnt lgkmcnt(15)
    v_mfma_f32_16x16x32_bf16 v[176:179], v[192:195], v[80:83], 0
    ds_read_b64 v[100:101], v2 offset:576
    s_waitcnt lgkmcnt(13)
    v_mfma_f32_16x16x32_bf16 v[180:183], v[192:195], v[84:87], 0
    ds_read_b64 v[102:103], v2 offset:584
    s_waitcnt lgkmcnt(11)
    v_mfma_f32_16x16x32_bf16 v[184:187], v[192:195], v[88:91], 0
    ds_read_b128 v[136:139], v3 offset:1408
    s_waitcnt lgkmcnt(9)
    v_mfma_f32_16x16x32_bf16 v[188:191], v[192:195], v[92:95], 0
    ds_read_b64 v[104:105], v2 offset:1088
    buffer_load_dwordx4 a[120:123], v14, s[36:39], s52 offen offset:0 sc1
    s_waitcnt lgkmcnt(8)
    v_mfma_f32_16x16x32_bf16 v[160:163], v[32:35], v[64:67], v[160:163]
    ds_read_b64 v[106:107], v2 offset:1096
    v_mfma_f32_16x16x32_bf16 v[164:167], v[32:35], v[68:71], v[164:167]
    ds_read_b128 v[140:143], v3 offset:1920
    v_mfma_f32_16x16x32_bf16 v[168:171], v[32:35], v[72:75], v[168:171]
    ds_read_b64 v[108:109], v2 offset:1600
    v_mfma_f32_16x16x32_bf16 v[172:175], v[32:35], v[76:79], v[172:175]
    ds_read_b64 v[110:111], v2 offset:1608
    v_mfma_f32_16x16x32_bf16 v[176:179], v[32:35], v[80:83], v[176:179]
    ds_read_b128 v[144:147], v3 offset:2432
    buffer_load_dwordx4 a[124:127], v14, s[36:39], s52 offen offset:1024 sc1
    v_mfma_f32_16x16x32_bf16 v[180:183], v[32:35], v[84:87], v[180:183]
    ds_read_b64 v[112:113], v2 offset:2112
    v_mfma_f32_16x16x32_bf16 v[184:187], v[32:35], v[88:91], v[184:187]
    ds_read_b64 v[114:115], v2 offset:2120
    v_mfma_f32_16x16x32_bf16 v[188:191], v[32:35], v[92:95], v[188:191]
    ds_read_b128 v[148:151], v3 offset:2944
    v_mfma_f32_16x16x32_bf16 v[164:167], v[36:39], v[64:67], v[164:167]
    ds_read_b64 v[116:117], v2 offset:2624
    v_mfma_f32_16x16x32_bf16 v[168:171], v[36:39], v[68:71], v[168:171]
    ds_read_b64 v[118:119], v2 offset:2632
    buffer_load_dwordx4 a[128:131], v14, s[36:39], s52 offen offset:2048 sc1
    v_mfma_f32_16x16x32_bf16 v[172:175], v[36:39], v[72:75], v[172:175]
    ds_read_b128 v[152:155], v3 offset:3456
PAGE4:
    s_cbranch_execz VISIT_RET
    s_nop 0
    v_mfma_f32_16x16x32_bf16 v[176:179], v[36:39], v[76:79], v[176:179]
    ds_read_b64 v[120:121], v2 offset:3136
    v_mfma_f32_16x16x32_bf16 v[180:183], v[36:39], v[80:83], v[180:183]
    ds_read_b64 v[122:123], v2 offset:3144
    v_mfma_f32_16x16x32_bf16 v[184:187], v[36:39], v[84:87], v[184:187]
    ds_read_b128 v[156:159], v3 offset:3968
    v_mfma_f32_16x16x32_bf16 v[188:191], v[36:39], v[88:91], v[188:191]
    ds_read_b64 v[124:125], v2 offset:3648
    buffer_load_dwordx4 a[132:135], v14, s[36:39], s52 offen offset:3072 sc1
    v_mfma_f32_16x16x32_bf16 v[168:171], v[40:43], v[64:67], v[168:171]
    ds_read_b64 v[126:127], v2 offset:3656
    v_mfma_f32_16x16x32_bf16 v[172:175], v[40:43], v[68:71], v[172:175]
    v_mfma_f32_16x16x32_bf16 v[176:179], v[40:43], v[72:75], v[176:179]
    v_mfma_f32_16x16x32_bf16 v[180:183], v[40:43], v[76:79], v[180:183]
    buffer_load_dwordx4 a[136:139], v15, s[36:39], s52 offen offset:0 sc1
    s_add_u32 s52, s52, 5120
    v_mfma_f32_16x16x32_bf16 v[184:187], v[40:43], v[80:83], v[184:187]
    v_mfma_f32_16x16x32_bf16 v[188:191], v[40:43], v[84:87], v[188:191]
    v_mfma_f32_16x16x32_bf16 v[172:175], v[44:47], v[64:67], v[172:175]
    v_mfma_f32_16x16x32_bf16 v[176:179], v[44:47], v[68:71], v[176:179]
    v_mfma_f32_16x16x32_bf16 v[180:183], v[44:47], v[72:75], v[180:183]
    buffer_load_dwordx4 a[140:143], v14, s[36:39], s52 offen offset:0 sc1
    v_mfma_f32_16x16x32_bf16 v[184:187], v[44:47], v[76:79], v[184:187]
    v_mfma_f32_16x16x32_bf16 v[188:191], v[44:47], v[80:83], v[188:191]
    v_mfma_f32_16x16x32_bf16 v[176:179], v[48:51], v[64:67], v[176:179]
    v_mfma_f32_16x16x32_bf16 v[180:183], v[48:51], v[68:71], v[180:183]
    v_mfma_f32_16x16x32_bf16 v[184:187], v[48:51], v[72:75], v[184:187]
    buffer_load_dwordx4 a[144:147], v14, s[36:39], s52 offen offset:1024 sc1
    v_mfma_f32_16x16x32_bf16 v[188:191], v[48:51], v[76:79], v[188:191]
    v_mfma_f32_16x16x32_bf16 v[180:183], v[52:55], v[64:67], v[180:183]
    v_mfma_f32_16x16x32_bf16 v[184:187], v[52:55], v[68:71], v[184:187]
    v_mfma_f32_16x16x32_bf16 v[188:191], v[52:55], v[72:75], v[188:191]
    v_mfma_f32_16x16x32_bf16 v[184:187], v[56:59], v[64:67], v[184:187]
    buffer_load_dwordx4 a[148:151], v14, s[36:39], s52 offen offset:2048 sc1
    v_mfma_f32_16x16x32_bf16 v[188:191], v[56:59], v[68:71], v[188:191]
    v_mfma_f32_16x16x32_bf16 v[188:191], v[60:63], v[64:67], v[188:191]
    s_waitcnt lgkmcnt(0)
    v_mfma_f32_16x16x32_bf16 v[160:163], v[96:99], v[128:131], v[160:163]
    ds_read_b128 v[64:67], v3 offset:320
    v_and_b32 v20, 15, v0
    v_mfma_f32_16x16x32_bf16 v[164:167], v[96:99], v[132:135], v[164:167]
    ds_read_b64 v[32:33], v2 offset:128
    buffer_load_dwordx4 a[152:155], v14, s[36:39], s52 offen offset:3072 sc1
    v_mfma_f32_16x16x32_bf16 v[168:171], v[96:99], v[136:139], v[168:171]
    ds_read_b64 v[34:35], v2 offset:136
    v_mfma_f32_16x16x32_bf16 v[172:175], v[96:99], v[140:143], v[172:175]
    ds_read_b128 v[68:71], v3 offset:832
    v_mfma_f32_16x16x32_bf16 v[176:179], v[96:99], v[144:147], v[176:179]
    ds_read_b64 v[36:37], v2 offset:640
    v_lshrrev_b32_e64 v21, 4, v0
    v_mfma_f32_16x16x32_bf16 v[180:183], v[96:99], v[148:151], v[180:183]
    ds_read_b64 v[38:39], v2 offset:648
    buffer_load_dwordx4 a[156:159], v15, s[36:39], s52 offen offset:0 sc1
    s_add_u32 s52, s52, 5120
    v_mfma_f32_16x16x32_bf16 v[184:187], v[96:99], v[152:155], v[184:187]
    ds_read_b128 v[72:75], v3 offset:1344
    v_mfma_f32_16x16x32_bf16 v[188:191], v[96:99], v[156:159], v[188:191]
    ds_read_b64 v[40:41], v2 offset:1152
    v_mfma_f32_16x16x32_bf16 v[164:167], v[100:103], v[128:131], v[164:167]
    ds_read_b64 v[42:43], v2 offset:1160
    v_mfma_f32_16x16x32_bf16 v[168:171], v[100:103], v[132:135], v[168:171]
    ds_read_b128 v[76:79], v3 offset:1856
    buffer_load_dwordx4 a[160:163], v14, s[36:39], s52 offen offset:0 sc1
    v_mfma_f32_16x16x32_bf16 v[172:175], v[100:103], v[136:139], v[172:175]
    ds_read_b64 v[44:45], v2 offset:1664
    s_lshl_b32 s69, s53, 6
    s_nop 0
    v_mfma_f32_16x16x32_bf16 v[176:179], v[100:103], v[140:143], v[176:179]
    ds_read_b64 v[46:47], v2 offset:1672
    v_mfma_f32_16x16x32_bf16 v[180:183], v[100:103], v[144:147], v[180:183]
    ds_read_b128 v[80:83], v3 offset:2368
    buffer_load_dwordx4 a[164:167], v14, s[36:39], s52 offen offset:1024 sc1
    v_mfma_f32_16x16x32_bf16 v[184:187], v[100:103], v[148:151], v[184:187]
    ds_read_b64 v[48:49], v2 offset:2176
    v_mfma_f32_16x16x32_bf16 v[188:191], v[100:103], v[152:155], v[188:191]
    ds_read_b64 v[50:51], v2 offset:2184
    v_mfma_f32_16x16x32_bf16 v[168:171], v[104:107], v[128:131], v[168:171]
    ds_read_b128 v[84:87], v3 offset:2880
    s_lshl_b32 s70, s3, 4
    s_nop 0
    v_mfma_f32_16x16x32_bf16 v[172:175], v[104:107], v[132:135], v[172:175]
    ds_read_b64 v[52:53], v2 offset:2688
    buffer_load_dwordx4 a[168:171], v14, s[36:39], s52 offen offset:2048 sc1
    v_mfma_f32_16x16x32_bf16 v[176:179], v[104:107], v[136:139], v[176:179]
    ds_read_b64 v[54:55], v2 offset:2696
    v_mfma_f32_16x16x32_bf16 v[180:183], v[104:107], v[140:143], v[180:183]
    ds_read_b128 v[88:91], v3 offset:3392
    v_mfma_f32_16x16x32_bf16 v[184:187], v[104:107], v[144:147], v[184:187]
    ds_read_b64 v[56:57], v2 offset:3200
    buffer_load_dwordx4 a[172:175], v14, s[36:39], s52 offen offset:3072 sc1
    v_mfma_f32_16x16x32_bf16 v[188:191], v[104:107], v[148:151], v[188:191]
    ds_read_b64 v[58:59], v2 offset:3208
    v_mfma_f32_16x16x32_bf16 v[172:175], v[108:111], v[128:131], v[172:175]
    ds_read_b128 v[92:95], v3 offset:3904
    s_add_u32 s70, s70, s69
    v_mfma_f32_16x16x32_bf16 v[176:179], v[108:111], v[132:135], v[176:179]
    ds_read_b64 v[60:61], v2 offset:3712
    v_mfma_f32_16x16x32_bf16 v[180:183], v[108:111], v[136:139], v[180:183]
    ds_read_b64 v[62:63], v2 offset:3720
    buffer_load_dwordx4 a[176:179], v15, s[36:39], s52 offen offset:0 sc1
    s_add_u32 s52, s52, 5120
    v_mfma_f32_16x16x32_bf16 v[184:187], v[108:111], v[140:143], v[184:187]
    v_mfma_f32_16x16x32_bf16 v[188:191], v[108:111], v[144:147], v[188:191]
    v_add_u32 v22, s70, v20
    v_mfma_f32_16x16x32_bf16 v[176:179], v[112:115], v[128:131], v[176:179]
    v_mul_u32_u24 v28, 1280, v22
    v_mfma_f32_16x16x32_bf16 v[180:183], v[112:115], v[132:135], v[180:183]
    buffer_load_dwordx4 a[180:183], v14, s[36:39], s52 offen offset:0 sc1
    v_mfma_f32_16x16x32_bf16 v[184:187], v[112:115], v[136:139], v[184:187]
    v_mfma_f32_16x16x32_bf16 v[188:191], v[112:115], v[140:143], v[188:191]
    v_lshl_add_u32 v29, v21, 3, v28
    v_mfma_f32_16x16x32_bf16 v[180:183], v[116:119], v[128:131], v[180:183]
    buffer_load_dwordx4 a[184:187], v14, s[36:39], s52 offen offset:1024 sc1
    v_mfma_f32_16x16x32_bf16 v[184:187], v[116:119], v[132:135], v[184:187]
    v_lshl_add_u32 v28, v21, 4, v28
    v_mfma_f32_16x16x32_bf16 v[188:191], v[116:119], v[136:139], v[188:191]
    v_mfma_f32_16x16x32_bf16 v[184:187], v[120:123], v[128:131], v[184:187]
    v_lshlrev_b32 v22, 3, v22
    v_mfma_f32_16x16x32_bf16 v[188:191], v[120:123], v[132:135], v[188:191]
    buffer_load_dwordx4 a[188:191], v14, s[36:39], s52 offen offset:2048 sc1
    v_mfma_f32_16x16x32_bf16 v[188:191], v[124:127], v[128:131], v[188:191]
    s_waitcnt lgkmcnt(0)
    v_mfma_f32_16x16x32_bf16 v[160:163], v[32:35], v[64:67], v[160:163]
    ds_read_b128 v[128:131], v3 offset:256
    v_mfma_f32_16x16x32_bf16 v[164:167], v[32:35], v[68:71], v[164:167]
    ds_read_b64 v[96:97], v2 offset:192
    buffer_load_dwordx4 a[192:195], v14, s[36:39], s52 offen offset:3072 sc1
    v_mfma_f32_16x16x32_bf16 v[168:171], v[32:35], v[72:75], v[168:171]
    ds_read_b64 v[98:99], v2 offset:200
    v_mfma_f32_16x16x32_bf16 v[172:175], v[32:35], v[76:79], v[172:175]
    ds_read_b128 v[132:135], v3 offset:768
    v_mfma_f32_16x16x32_bf16 v[176:179], v[32:35], v[80:83], v[176:179]
    ds_read_b64 v[100:101], v2 offset:704
    buffer_load_dwordx4 a[196:199], v15, s[36:39], s52 offen offset:0 sc1
    s_add_u32 s52, s52, 5120
    v_mfma_f32_16x16x32_bf16 v[180:183], v[32:35], v[84:87], v[180:183]
    ds_read_b64 v[102:103], v2 offset:712
    v_mfma_f32_16x16x32_bf16 v[184:187], v[32:35], v[88:91], v[184:187]
    ds_read_b128 v[136:139], v3 offset:1280
    v_mfma_f32_16x16x32_bf16 v[188:191], v[32:35], v[92:95], v[188:191]
    ds_read_b64 v[104:105], v2 offset:1216
    v_mfma_f32_16x16x32_bf16 v[164:167], v[36:39], v[64:67], v[164:167]
    ds_read_b64 v[106:107], v2 offset:1224
    buffer_load_dwordx4 a[200:203], v14, s[36:39], s52 offen offset:0 sc1
    v_mfma_f32_16x16x32_bf16 v[168:171], v[36:39], v[68:71], v[168:171]
    ds_read_b128 v[140:143], v3 offset:1792
    v_mfma_f32_16x16x32_bf16 v[172:175], v[36:39], v[72:75], v[172:175]
    ds_read_b64 v[108:109], v2 offset:1728
    v_mfma_f32_16x16x32_bf16 v[176:179], v[36:39], v[76:79], v[176:179]
    ds_read_b64 v[110:111], v2 offset:1736
    buffer_load_dwordx4 a[204:207], v14, s[36:39], s52 offen offset:1024 sc1
    v_mfma_f32_16x16x32_bf16 v[180:183], v[36:39], v[80:83], v[180:183]
    ds_read_b128 v[144:147], v3 offset:2304
    v_mfma_f32_16x16x32_bf16 v[184:187], v[36:39], v[84:87], v[184:187]
    ds_read_b64 v[112:113], v2 offset:2240
    v_mfma_f32_16x16x32_bf16 v[188:191], v[36:39], v[88:91], v[188:191]
    ds_read_b64 v[114:115], v2 offset:2248
    buffer_load_dwordx4 a[208:211], v14, s[36:39], s52 offen offset:2048 sc1
    v_mfma_f32_16x16x32_bf16 v[168:171], v[40:43], v[64:67], v[168:171]
    ds_read_b128 v[148:151], v3 offset:2816
    v_mfma_f32_16x16x32_bf16 v[172:175], v[40:43], v[68:71], v[172:175]
    ds_read_b64 v[116:117], v2 offset:2752
    v_mfma_f32_16x16x32_bf16 v[176:179], v[40:43], v[72:75], v[176:179]
    ds_read_b64 v[118:119], v2 offset:2760
    v_mfma_f32_16x16x32_bf16 v[180:183], v[40:43], v[76:79], v[180:183]
    ds_read_b128 v[152:155], v3 offset:3328
    buffer_load_dwordx4 a[212:215], v14, s[36:39], s52 offen offset:3072 sc1
    v_mfma_f32_16x16x32_bf16 v[184:187], v[40:43], v[80:83], v[184:187]
    ds_read_b64 v[120:121], v2 offset:3264
    v_mfma_f32_16x16x32_bf16 v[188:191], v[40:43], v[84:87], v[188:191]
    ds_read_b64 v[122:123], v2 offset:3272
    v_mfma_f32_16x16x32_bf16 v[172:175], v[44:47], v[64:67], v[172:175]
    ds_read_b128 v[156:159], v3 offset:3840
    buffer_load_dwordx4 a[216:219], v15, s[36:39], s52 offen offset:0 sc1
    s_add_u32 s52, s52, 5120
    v_mfma_f32_16x16x32_bf16 v[176:179], v[44:47], v[68:71], v[176:179]
    ds_read_b64 v[124:125], v2 offset:3776
    v_mfma_f32_16x16x32_bf16 v[180:183], v[44:47], v[72:75], v[180:183]
    ds_read_b64 v[126:127], v2 offset:3784
    v_mfma_f32_16x16x32_bf16 v[184:187], v[44:47], v[76:79], v[184:187]
    buffer_load_dwordx4 a[220:223], v14, s[36:39], s52 offen offset:0 sc1
    v_mfma_f32_16x16x32_bf16 v[188:191], v[44:47], v[80:83], v[188:191]
    v_mfma_f32_16x16x32_bf16 v[176:179], v[48:51], v[64:67], v[176:179]
    v_mfma_f32_16x16x32_bf16 v[180:183], v[48:51], v[68:71], v[180:183]
    buffer_load_dwordx4 a[224:227], v14, s[36:39], s52 offen offset:1024 sc1
    v_mfma_f32_16x16x32_bf16 v[184:187], v[48:51], v[72:75], v[184:187]
    v_mfma_f32_16x16x32_bf16 v[188:191], v[48:51], v[76:79], v[188:191]
    v_mfma_f32_16x16x32_bf16 v[180:183], v[52:55], v[64:67], v[180:183]
    v_mfma_f32_16x16x32_bf16 v[184:187], v[52:55], v[68:71], v[184:187]
    buffer_load_dwordx4 a[228:231], v14, s[36:39], s52 offen offset:2048 sc1
    v_mfma_f32_16x16x32_bf16 v[188:191], v[52:55], v[72:75], v[188:191]
    v_mfma_f32_16x16x32_bf16 v[184:187], v[56:59], v[64:67], v[184:187]
    v_mfma_f32_16x16x32_bf16 v[188:191], v[56:59], v[68:71], v[188:191]
    buffer_load_dwordx4 a[232:235], v14, s[36:39], s52 offen offset:3072 sc1
    v_mfma_f32_16x16x32_bf16 v[188:191], v[60:63], v[64:67], v[188:191]
    s_waitcnt lgkmcnt(0)
    s_nop 0
    v_mfma_f32_16x16x32_bf16 v[160:163], v[96:99], v[128:131], v[160:163]
    v_mfma_f32_16x16x32_bf16 v[164:167], v[96:99], v[132:135], v[164:167]
    buffer_load_dwordx4 a[236:239], v15, s[36:39], s52 offen offset:0 sc1
    s_add_u32 s52, s52, 5120
    v_mfma_f32_16x16x32_bf16 v[168:171], v[96:99], v[136:139], v[168:171]
    v_mfma_f32_16x16x32_bf16 v[172:175], v[96:99], v[140:143], v[172:175]
    v_mfma_f32_16x16x32_bf16 v[176:179], v[96:99], v[144:147], v[176:179]
    buffer_load_dwordx4 v[196:199], v14, s[36:39], s52 offen offset:0 sc1
    v_mfma_f32_16x16x32_bf16 v[180:183], v[96:99], v[148:151], v[180:183]
    v_mfma_f32_16x16x32_bf16 v[184:187], v[96:99], v[152:155], v[184:187]
    v_mfma_f32_16x16x32_bf16 v[188:191], v[96:99], v[156:159], v[188:191]
    v_mfma_f32_16x16x32_bf16 v[164:167], v[100:103], v[128:131], v[164:167]
    buffer_load_dwordx4 v[200:203], v14, s[36:39], s52 offen offset:1024 sc1
    v_mfma_f32_16x16x32_bf16 v[168:171], v[100:103], v[132:135], v[168:171]
    v_mfma_f32_16x16x32_bf16 v[172:175], v[100:103], v[136:139], v[172:175]
    buffer_load_dword v19, v18, s[36:39], s49 offen sc1
    v_mfma_f32_16x16x32_bf16 v[176:179], v[100:103], v[140:143], v[176:179]
    buffer_load_dwordx4 v[204:207], v14, s[36:39], s52 offen offset:2048 sc1
    v_mfma_f32_16x16x32_bf16 v[180:183], v[100:103], v[144:147], v[180:183]
    v_mfma_f32_16x16x32_bf16 v[184:187], v[100:103], v[148:151], v[184:187]
    v_mfma_f32_16x16x32_bf16 v[188:191], v[100:103], v[152:155], v[188:191]
    buffer_load_dwordx4 v[208:211], v14, s[36:39], s52 offen offset:3072 sc1
    v_mfma_f32_16x16x32_bf16 v[168:171], v[104:107], v[128:131], v[168:171]
    v_mfma_f32_16x16x32_bf16 v[172:175], v[104:107], v[132:135], v[172:175]
    v_mfma_f32_16x16x32_bf16 v[176:179], v[104:107], v[136:139], v[176:179]
    v_mfma_f32_16x16x32_bf16 v[180:183], v[104:107], v[140:143], v[180:183]
    buffer_load_dwordx4 v[212:215], v15, s[36:39], s52 offen offset:0 sc1
    s_add_u32 s52, s52, 5120
    v_mfma_f32_16x16x32_bf16 v[184:187], v[104:107], v[144:147], v[184:187]
    v_mfma_f32_16x16x32_bf16 v[188:191], v[104:107], v[148:151], v[188:191]
    v_mfma_f32_16x16x32_bf16 v[172:175], v[108:111], v[128:131], v[172:175]
    buffer_load_dwordx4 v[216:219], v14, s[36:39], s52 offen offset:0 sc1
    v_mfma_f32_16x16x32_bf16 v[176:179], v[108:111], v[132:135], v[176:179]
    v_mfma_f32_16x16x32_bf16 v[180:183], v[108:111], v[136:139], v[180:183]
    v_mfma_f32_16x16x32_bf16 v[184:187], v[108:111], v[140:143], v[184:187]
    buffer_load_dwordx4 v[220:223], v14, s[36:39], s52 offen offset:1024 sc1
    v_mfma_f32_16x16x32_bf16 v[188:191], v[108:111], v[144:147], v[188:191]
    v_mfma_f32_16x16x32_bf16 v[176:179], v[112:115], v[128:131], v[176:179]
    v_mfma_f32_16x16x32_bf16 v[180:183], v[112:115], v[132:135], v[180:183]
    buffer_load_dwordx4 v[224:227], v14, s[36:39], s52 offen offset:2048 sc1
    v_mfma_f32_16x16x32_bf16 v[184:187], v[112:115], v[136:139], v[184:187]
    v_mfma_f32_16x16x32_bf16 v[188:191], v[112:115], v[140:143], v[188:191]
    v_mfma_f32_16x16x32_bf16 v[180:183], v[116:119], v[128:131], v[180:183]
    v_mfma_f32_16x16x32_bf16 v[184:187], v[116:119], v[132:135], v[184:187]
    buffer_load_dwordx4 v[228:231], v14, s[36:39], s52 offen offset:3072 sc1
    v_mfma_f32_16x16x32_bf16 v[188:191], v[116:119], v[136:139], v[188:191]
    v_mfma_f32_16x16x32_bf16 v[184:187], v[120:123], v[128:131], v[184:187]
    v_mfma_f32_16x16x32_bf16 v[188:191], v[120:123], v[132:135], v[188:191]
    buffer_load_dwordx4 v[232:235], v15, s[36:39], s52 offen offset:0 sc1
    v_mfma_f32_16x16x32_bf16 v[188:191], v[124:127], v[128:131], v[188:191]
    s_nop 3
    s_waitcnt vmcnt(8)
    v_cmp_ne_u32 vcc, s56, v19
    s_mov_b64 s[82:83], vcc
    s_cmp_eq_u64 s[82:83], 0
    s_cbranch_scc0 FH_RETRY_11
FH_DONE_12:
    s_mov_b32 s71, 65536
    buffer_load_dwordx2 v[254:255], v22, s[36:39], s71 offen sc1
    s_cmp_eq_u32 s60, s62
    s_cselect_b32 s63, 17563648, s60
    buffer_load_dwordx4 v[48:51], v24, s[36:39], s63 offen offset:0 sc1
    v_lshlrev_b32 v9, 4, v0
    buffer_load_dwordx4 v[52:55], v25, s[36:39], s63 offen offset:0 sc1
    s_lshl_b32 s78, s3, 12
    buffer_load_dwordx4 v[56:59], v26, s[36:39], s63 offen offset:0 sc1
    s_add_u32 s78, s78, 84992
    v_add_u32 v10, s78, v9
    buffer_load_dwordx4 v[60:63], v27, s[36:39], s63 offen offset:0 sc1
    s_xor_b32 s78, s3, 1
    buffer_load_dwordx4 v[64:67], v24, s[36:39], s60 offen offset:1024 sc1
    s_lshl_b32 s78, s78, 12
    s_add_u32 s78, s78, 84992
    buffer_load_dwordx4 v[68:71], v25, s[36:39], s60 offen offset:1024 sc1
    v_add_u32 v11, s78, v9
    buffer_load_dwordx4 v[72:75], v26, s[36:39], s60 offen offset:1024 sc1
    s_cmp_lg_u32 s87, 0
    s_cselect_b32 s78, -1, 0
    buffer_load_dwordx4 v[76:79], v27, s[36:39], s60 offen offset:1024 sc1
    s_mov_b32 exec_lo, s78
    s_mov_b32 exec_hi, s78
    v_swap_b32 v160, v176
    v_swap_b32 v161, v177
    v_swap_b32 v162, v178
    v_swap_b32 v163, v179
    s_mov_b64 exec, -1
    ds_write_b128 v10, v[176:179] offset:0
    buffer_load_dwordx4 v[80:83], v24, s[36:39], s60 offen offset:2048 sc1
    s_mov_b32 exec_lo, s78
    s_mov_b32 exec_hi, s78
    v_swap_b32 v164, v180
    v_swap_b32 v165, v181
    v_swap_b32 v166, v182
    v_swap_b32 v167, v183
    s_mov_b64 exec, -1
    buffer_load_dwordx4 v[84:87], v25, s[36:39], s60 offen offset:2048 sc1
    ds_write_b128 v10, v[180:183] offset:1024
    s_mov_b32 exec_lo, s78
    s_mov_b32 exec_hi, s78
    v_swap_b32 v168, v184
    v_swap_b32 v169, v185
    v_swap_b32 v170, v186
    v_swap_b32 v171, v187
    s_mov_b64 exec, -1
    buffer_load_dwordx4 v[88:91], v26, s[36:39], s60 offen offset:2048 sc1
    ds_write_b128 v10, v[184:187] offset:2048
    buffer_load_dwordx4 v[92:95], v27, s[36:39], s60 offen offset:2048 sc1
    s_mov_b32 exec_lo, s78
    s_mov_b32 exec_hi, s78
    v_swap_b32 v172, v188
    v_swap_b32 v173, v189
    v_swap_b32 v174, v190
    v_swap_b32 v175, v191
    s_mov_b64 exec, -1
    ds_write_b128 v10, v[188:191] offset:3072
    s_waitcnt lgkmcnt(0)
    s_barrier
    s_nop 0
    buffer_load_dwordx4 v[96:99], v24, s[36:39], s60 offen offset:3072 sc1
    ds_read_b128 v[32:35], v11 offset:0
    ds_read_b128 v[36:39], v11 offset:1024
    ds_read_b128 v[40:43], v11 offset:2048
    ds_read_b128 v[44:47], v11 offset:3072
    s_waitcnt lgkmcnt(0)
    s_nop 0
    v_pk_add_f32 v[160:161], v[160:161], v[32:33]
    v_pk_add_f32 v[162:163], v[162:163], v[34:35]
    v_pk_add_f32 v[164:165], v[164:165], v[36:37]
    buffer_load_dwordx4 v[100:103], v25, s[36:39], s60 offen offset:3072 sc1
    v_pk_add_f32 v[166:167], v[166:167], v[38:39]
    v_pk_add_f32 v[168:169], v[168:169], v[40:41]
    v_pk_add_f32 v[170:171], v[170:171], v[42:43]
    v_pk_add_f32 v[172:173], v[172:173], v[44:45]
    v_pk_add_f32 v[174:175], v[174:175], v[46:47]
    s_lshl_b32 s79, s87, 11
    s_add_u32 s79, s79, s85
    s_add_u32 s79, s79, 7340032
    v_bfe_u32 v8, v0, 4, 1
    buffer_load_dwordx4 v[236:239], v26, s[36:39], s60 offen offset:3072 sc1
    v_lshlrev_b32 v8, 9, v8
    v_and_b32 v9, 15, v0
    v_lshl_add_u32 v8, v9, 5, v8
    v_lshrrev_b32_e64 v9, 5, v0
    v_lshl_add_u32 v8, v9, 4, v8
    v_cvt_pk_bf16_f32 v32, v160, v161
    v_cvt_pk_bf16_f32 v33, v162, v163
    v_cvt_pk_bf16_f32 v34, v164, v165
    v_cvt_pk_bf16_f32 v35, v166, v167
    buffer_load_dwordx4 v[240:243], v27, s[36:39], s60 offen offset:3072 sc1
    s_add_u32 s60, s60, 4096
    v_cvt_pk_bf16_f32 v36, v168, v169
    v_cvt_pk_bf16_f32 v37, v170, v171
    v_cvt_pk_bf16_f32 v38, v172, v173
    v_cvt_pk_bf16_f32 v39, v174, v175
    s_nop 1
    v_permlane16_swap_b32 v32, v34
    v_permlane16_swap_b32 v33, v35
    v_permlane16_swap_b32 v36, v38
    v_permlane16_swap_b32 v37, v39
    buffer_store_dwordx4 v[32:35], v8, s[36:39], s79 offen offset:0 sc1
    buffer_store_dwordx4 v[36:39], v8, s[36:39], s79 offen offset:1024 sc1
G2_START:
    s_lshr_b32 s72, s84, 1
    s_lshl_b32 s72, s72, 6
    s_add_u32 s72, s72, 262144
    s_cmp_eq_u32 s3, 0
    s_cselect_b32 s72, s72, 17563648
    s_mul_i32 s59, s54, 2560
    s_add_u32 s59, s59, 262144
    v_min_u32 v18, 39, v0
    v_lshlrev_b32 v18, 6, v18
    v_accvgpr_read_b32 v105, a240
    v_accvgpr_read_b32 v107, a241
    v_accvgpr_read_b32 v109, a242
    v_accvgpr_read_b32 v111, a243
    v_accvgpr_read_b32 v113, a244
    v_accvgpr_read_b32 v115, a245
    v_accvgpr_read_b32 v117, a246
    v_accvgpr_read_b32 v119, a247
    v_accvgpr_read_b32 v121, a248
    v_accvgpr_read_b32 v123, a249
    v_lshlrev_b32 v104, 16, v105
    v_and_b32 v105, 0xffff0000, v105
    v_lshlrev_b32 v106, 16, v107
    v_and_b32 v107, 0xffff0000, v107
    v_lshlrev_b32 v108, 16, v109
    v_and_b32 v109, 0xffff0000, v109
    v_lshlrev_b32 v110, 16, v111
    v_and_b32 v111, 0xffff0000, v111
    v_lshlrev_b32 v112, 16, v113
    v_and_b32 v113, 0xffff0000, v113
    v_lshlrev_b32 v114, 16, v115
    v_and_b32 v115, 0xffff0000, v115
    v_lshlrev_b32 v116, 16, v117
    v_and_b32 v117, 0xffff0000, v117
    v_lshlrev_b32 v118, 16, v119
    v_and_b32 v119, 0xffff0000, v119
    v_lshlrev_b32 v120, 16, v121
    v_and_b32 v121, 0xffff0000, v121
    v_lshlrev_b32 v122, 16, v123
    v_and_b32 v123, 0xffff0000, v123
    s_waitcnt vmcnt(14)
    v_mfma_f32_16x16x32_bf16 v[104:107], a[0:3], v[48:51], v[104:107]
    v_mfma_f32_16x16x32_bf16 v[124:127], a[0:3], v[52:55], 0
    buffer_load_dwordx4 v[32:35], v24, s[36:39], s60 offen offset:0 sc1
    v_mfma_f32_16x16x32_bf16 v[144:147], a[0:3], v[56:59], 0
    v_mfma_f32_16x16x32_bf16 v[164:167], a[0:3], v[60:63], 0
    v_mfma_f32_16x16x32_bf16 v[108:111], a[4:7], v[48:51], v[108:111]
    v_mfma_f32_16x16x32_bf16 v[128:131], a[4:7], v[52:55], 0
    buffer_load_dwordx4 v[36:39], v25, s[36:39], s60 offen offset:0 sc1
    v_mfma_f32_16x16x32_bf16 v[148:151], a[4:7], v[56:59], 0
    v_mfma_f32_16x16x32_bf16 v[168:171], a[4:7], v[60:63], 0
    v_mfma_f32_16x16x32_bf16 v[112:115], a[8:11], v[48:51], v[112:115]
    v_mfma_f32_16x16x32_bf16 v[132:135], a[8:11], v[52:55], 0
    buffer_load_dwordx4 v[40:43], v26, s[36:39], s60 offen offset:0 sc1
    v_mfma_f32_16x16x32_bf16 v[152:155], a[8:11], v[56:59], 0
    v_mfma_f32_16x16x32_bf16 v[172:175], a[8:11], v[60:63], 0
    v_mfma_f32_16x16x32_bf16 v[116:119], a[12:15], v[48:51], v[116:119]
    v_mfma_f32_16x16x32_bf16 v[136:139], a[12:15], v[52:55], 0
    buffer_load_dwordx4 v[44:47], v27, s[36:39], s60 offen offset:0 sc1
    v_mfma_f32_16x16x32_bf16 v[156:159], a[12:15], v[56:59], 0
    v_mfma_f32_16x16x32_bf16 v[176:179], a[12:15], v[60:63], 0
    v_mfma_f32_16x16x32_bf16 v[120:123], a[16:19], v[48:51], v[120:123]
    v_mfma_f32_16x16x32_bf16 v[140:143], a[16:19], v[52:55], 0
    v_mfma_f32_16x16x32_bf16 v[160:163], a[16:19], v[56:59], 0
    v_mfma_f32_16x16x32_bf16 v[180:183], a[16:19], v[60:63], 0
    s_waitcnt vmcnt(14)
    v_mfma_f32_16x16x32_bf16 v[104:107], a[20:23], v[64:67], v[104:107]
    v_mfma_f32_16x16x32_bf16 v[124:127], a[20:23], v[68:71], v[124:127]
    buffer_load_dwordx4 v[48:51], v24, s[36:39], s60 offen offset:1024 sc1
    v_mfma_f32_16x16x32_bf16 v[144:147], a[20:23], v[72:75], v[144:147]
    v_mfma_f32_16x16x32_bf16 v[164:167], a[20:23], v[76:79], v[164:167]
    v_mfma_f32_16x16x32_bf16 v[108:111], a[24:27], v[64:67], v[108:111]
    v_mfma_f32_16x16x32_bf16 v[128:131], a[24:27], v[68:71], v[128:131]
    buffer_load_dwordx4 v[52:55], v25, s[36:39], s60 offen offset:1024 sc1
    v_mfma_f32_16x16x32_bf16 v[148:151], a[24:27], v[72:75], v[148:151]
    v_mfma_f32_16x16x32_bf16 v[168:171], a[24:27], v[76:79], v[168:171]
    v_mfma_f32_16x16x32_bf16 v[112:115], a[28:31], v[64:67], v[112:115]
    v_mfma_f32_16x16x32_bf16 v[132:135], a[28:31], v[68:71], v[132:135]
    buffer_load_dwordx4 v[56:59], v26, s[36:39], s60 offen offset:1024 sc1
    v_mfma_f32_16x16x32_bf16 v[152:155], a[28:31], v[72:75], v[152:155]
    v_mfma_f32_16x16x32_bf16 v[172:175], a[28:31], v[76:79], v[172:175]
    v_mfma_f32_16x16x32_bf16 v[116:119], a[32:35], v[64:67], v[116:119]
    v_mfma_f32_16x16x32_bf16 v[136:139], a[32:35], v[68:71], v[136:139]
    buffer_load_dwordx4 v[60:63], v27, s[36:39], s60 offen offset:1024 sc1
    v_mfma_f32_16x16x32_bf16 v[156:159], a[32:35], v[72:75], v[156:159]
    v_mfma_f32_16x16x32_bf16 v[176:179], a[32:35], v[76:79], v[176:179]
    v_mfma_f32_16x16x32_bf16 v[120:123], a[36:39], v[64:67], v[120:123]
    v_mfma_f32_16x16x32_bf16 v[140:143], a[36:39], v[68:71], v[140:143]
    v_mfma_f32_16x16x32_bf16 v[160:163], a[36:39], v[72:75], v[160:163]
    v_mfma_f32_16x16x32_bf16 v[180:183], a[36:39], v[76:79], v[180:183]
    s_waitcnt vmcnt(8)
    s_barrier
    v_mov_b32 v16, s56
    v_lshlrev_b32 v17, 2, v0
    s_mov_b32 exec_lo, 1
    s_mov_b32 exec_hi, 0
    buffer_store_dword v16, v17, s[36:39], s72 offen sc1
    s_mov_b64 exec, -1
    v_mfma_f32_16x16x32_bf16 v[104:107], a[40:43], v[80:83], v[104:107]
    v_mfma_f32_16x16x32_bf16 v[124:127], a[40:43], v[84:87], v[124:127]
    buffer_load_dwordx4 v[64:67], v24, s[36:39], s60 offen offset:2048 sc1
    v_mfma_f32_16x16x32_bf16 v[144:147], a[40:43], v[88:91], v[144:147]
    v_lshrrev_b32 v4, 4, v0
    v_mfma_f32_16x16x32_bf16 v[164:167], a[40:43], v[92:95], v[164:167]
    v_mfma_f32_16x16x32_bf16 v[108:111], a[44:47], v[80:83], v[108:111]
    v_mfma_f32_16x16x32_bf16 v[128:131], a[44:47], v[84:87], v[128:131]
    buffer_load_dwordx4 v[68:71], v25, s[36:39], s60 offen offset:2048 sc1
    v_mfma_f32_16x16x32_bf16 v[148:151], a[44:47], v[88:91], v[148:151]
    v_mfma_f32_16x16x32_bf16 v[168:171], a[44:47], v[92:95], v[168:171]
    v_mfma_f32_16x16x32_bf16 v[112:115], a[48:51], v[80:83], v[112:115]
    v_mfma_f32_16x16x32_bf16 v[132:135], a[48:51], v[84:87], v[132:135]
    buffer_load_dwordx4 v[72:75], v26, s[36:39], s60 offen offset:2048 sc1
    v_mfma_f32_16x16x32_bf16 v[152:155], a[48:51], v[88:91], v[152:155]
    v_mfma_f32_16x16x32_bf16 v[172:175], a[48:51], v[92:95], v[172:175]
    v_mfma_f32_16x16x32_bf16 v[116:119], a[52:55], v[80:83], v[116:119]
    v_mfma_f32_16x16x32_bf16 v[136:139], a[52:55], v[84:87], v[136:139]
    buffer_load_dwordx4 v[76:79], v27, s[36:39], s60 offen offset:2048 sc1
    v_mfma_f32_16x16x32_bf16 v[156:159], a[52:55], v[88:91], v[156:159]
    v_mfma_f32_16x16x32_bf16 v[176:179], a[52:55], v[92:95], v[176:179]
    v_mfma_f32_16x16x32_bf16 v[120:123], a[56:59], v[80:83], v[120:123]
    v_mfma_f32_16x16x32_bf16 v[140:143], a[56:59], v[84:87], v[140:143]
    v_mfma_f32_16x16x32_bf16 v[160:163], a[56:59], v[88:91], v[160:163]
    v_mfma_f32_16x16x32_bf16 v[180:183], a[56:59], v[92:95], v[180:183]
    s_waitcnt vmcnt(15)
    s_nop 0
    v_mfma_f32_16x16x32_bf16 v[104:107], a[60:63], v[96:99], v[104:107]
    v_mfma_f32_16x16x32_bf16 v[124:127], a[60:63], v[100:103], v[124:127]
    buffer_load_dwordx4 v[80:83], v24, s[36:39], s60 offen offset:3072 sc1
    v_mfma_f32_16x16x32_bf16 v[144:147], a[60:63], v[236:239], v[144:147]
    v_mfma_f32_16x16x32_bf16 v[164:167], a[60:63], v[240:243], v[164:167]
    v_mfma_f32_16x16x32_bf16 v[108:111], a[64:67], v[96:99], v[108:111]
    v_mfma_f32_16x16x32_bf16 v[128:131], a[64:67], v[100:103], v[128:131]
    buffer_load_dwordx4 v[84:87], v25, s[36:39], s60 offen offset:3072 sc1
    v_mfma_f32_16x16x32_bf16 v[148:151], a[64:67], v[236:239], v[148:151]
    v_mfma_f32_16x16x32_bf16 v[168:171], a[64:67], v[240:243], v[168:171]
    v_mfma_f32_16x16x32_bf16 v[112:115], a[68:71], v[96:99], v[112:115]
    v_mfma_f32_16x16x32_bf16 v[132:135], a[68:71], v[100:103], v[132:135]
    buffer_load_dwordx4 v[88:91], v26, s[36:39], s60 offen offset:3072 sc1
    v_mfma_f32_16x16x32_bf16 v[152:155], a[68:71], v[236:239], v[152:155]
    v_mfma_f32_16x16x32_bf16 v[172:175], a[68:71], v[240:243], v[172:175]
    v_mfma_f32_16x16x32_bf16 v[116:119], a[72:75], v[96:99], v[116:119]
    v_mfma_f32_16x16x32_bf16 v[136:139], a[72:75], v[100:103], v[136:139]
    buffer_load_dwordx4 v[92:95], v27, s[36:39], s60 offen offset:3072 sc1
    s_add_u32 s60, s60, 4096
    v_mfma_f32_16x16x32_bf16 v[156:159], a[72:75], v[236:239], v[156:159]
    v_mfma_f32_16x16x32_bf16 v[176:179], a[72:75], v[240:243], v[176:179]
    v_mfma_f32_16x16x32_bf16 v[120:123], a[76:79], v[96:99], v[120:123]
    v_mfma_f32_16x16x32_bf16 v[140:143], a[76:79], v[100:103], v[140:143]
    v_mfma_f32_16x16x32_bf16 v[160:163], a[76:79], v[236:239], v[160:163]
    v_mfma_f32_16x16x32_bf16 v[180:183], a[76:79], v[240:243], v[180:183]
    s_waitcnt vmcnt(13)
    v_mfma_f32_16x16x32_bf16 v[104:107], a[80:83], v[32:35], v[104:107]
    v_mfma_f32_16x16x32_bf16 v[124:127], a[80:83], v[36:39], v[124:127]
    buffer_load_dwordx4 v[96:99], v24, s[36:39], s60 offen offset:0 sc1
    v_mfma_f32_16x16x32_bf16 v[144:147], a[80:83], v[40:43], v[144:147]
    v_mfma_f32_16x16x32_bf16 v[164:167], a[80:83], v[44:47], v[164:167]
    v_mfma_f32_16x16x32_bf16 v[108:111], a[84:87], v[32:35], v[108:111]
    v_mfma_f32_16x16x32_bf16 v[128:131], a[84:87], v[36:39], v[128:131]
    buffer_load_dwordx4 v[100:103], v25, s[36:39], s60 offen offset:0 sc1
    v_mfma_f32_16x16x32_bf16 v[148:151], a[84:87], v[40:43], v[148:151]
    v_mfma_f32_16x16x32_bf16 v[168:171], a[84:87], v[44:47], v[168:171]
    v_mfma_f32_16x16x32_bf16 v[112:115], a[88:91], v[32:35], v[112:115]
    v_mfma_f32_16x16x32_bf16 v[132:135], a[88:91], v[36:39], v[132:135]
    buffer_load_dwordx4 v[236:239], v26, s[36:39], s60 offen offset:0 sc1
    v_mfma_f32_16x16x32_bf16 v[152:155], a[88:91], v[40:43], v[152:155]
    v_mfma_f32_16x16x32_bf16 v[172:175], a[88:91], v[44:47], v[172:175]
    v_mfma_f32_16x16x32_bf16 v[116:119], a[92:95], v[32:35], v[116:119]
    v_mfma_f32_16x16x32_bf16 v[136:139], a[92:95], v[36:39], v[136:139]
    buffer_load_dwordx4 v[240:243], v27, s[36:39], s60 offen offset:0 sc1
    v_mfma_f32_16x16x32_bf16 v[156:159], a[92:95], v[40:43], v[156:159]
    v_mfma_f32_16x16x32_bf16 v[176:179], a[92:95], v[44:47], v[176:179]
    v_mfma_f32_16x16x32_bf16 v[120:123], a[96:99], v[32:35], v[120:123]
    v_mfma_f32_16x16x32_bf16 v[140:143], a[96:99], v[36:39], v[140:143]
    v_mfma_f32_16x16x32_bf16 v[160:163], a[96:99], v[40:43], v[160:163]
    v_mfma_f32_16x16x32_bf16 v[180:183], a[96:99], v[44:47], v[180:183]
    s_waitcnt vmcnt(13)
    v_mfma_f32_16x16x32_bf16 v[104:107], a[100:103], v[48:51], v[104:107]
    s_mul_i32 s65, s54, 327680
    s_lshl_b32 s66, s53, 7
    v_mfma_f32_16x16x32_bf16 v[124:127], a[100:103], v[52:55], v[124:127]
    buffer_load_dwordx4 v[32:35], v24, s[36:39], s60 offen offset:1024 sc1
    v_mfma_f32_16x16x32_bf16 v[144:147], a[100:103], v[56:59], v[144:147]
    s_add_u32 s65, s65, s66
    s_add_u32 s65, s65, 7340032
    v_mfma_f32_16x16x32_bf16 v[164:167], a[100:103], v[60:63], v[164:167]
    s_add_u32 s66, s65, 0x20000
    v_mfma_f32_16x16x32_bf16 v[108:111], a[104:107], v[48:51], v[108:111]
    s_add_u32 s67, s65, 0x40000
    v_mfma_f32_16x16x32_bf16 v[128:131], a[104:107], v[52:55], v[128:131]
    buffer_load_dwordx4 v[36:39], v25, s[36:39], s60 offen offset:1024 sc1
    s_cmp_ge_u32 s3, 2
    s_cselect_b32 s67, 17563648, s67
    v_mfma_f32_16x16x32_bf16 v[148:151], a[104:107], v[56:59], v[148:151]
    v_mfma_f32_16x16x32_bf16 v[168:171], a[104:107], v[60:63], v[168:171]
    s_lshl_b32 s79, s3, 3
    v_mfma_f32_16x16x32_bf16 v[112:115], a[108:111], v[48:51], v[112:115]
    v_lshrrev_b32 v10, 3, v0
    v_mfma_f32_16x16x32_bf16 v[132:135], a[108:111], v[52:55], v[132:135]
    buffer_load_dwordx4 v[40:43], v26, s[36:39], s60 offen offset:1024 sc1
    v_add_u32 v10, s79, v10
    v_mfma_f32_16x16x32_bf16 v[152:155], a[108:111], v[56:59], v[152:155]
    v_and_b32 v11, 7, v0
    v_mfma_f32_16x16x32_bf16 v[172:175], a[108:111], v[60:63], v[172:175]
    v_lshlrev_b32 v13, 12, v10
    v_mfma_f32_16x16x32_bf16 v[116:119], a[112:115], v[48:51], v[116:119]
    v_lshl_add_u32 v13, v11, 4, v13
    v_and_b32 v12, 2, v10
    v_mfma_f32_16x16x32_bf16 v[136:139], a[112:115], v[52:55], v[136:139]
    buffer_load_dwordx4 v[44:47], v27, s[36:39], s60 offen offset:1024 sc1
PAGE5:
    s_cbranch_execz PAGE6
    v_mfma_f32_16x16x32_bf16 v[156:159], a[112:115], v[56:59], v[156:159]
    v_xor_b32 v11, v11, v12
    v_mfma_f32_16x16x32_bf16 v[176:179], a[112:115], v[60:63], v[176:179]
    v_lshrrev_b32 v12, 1, v10
    v_and_b32 v12, 4, v12
    v_mfma_f32_16x16x32_bf16 v[120:123], a[116:119], v[48:51], v[120:123]
    v_xor_b32 v11, v11, v12
    v_mfma_f32_16x16x32_bf16 v[140:143], a[116:119], v[52:55], v[140:143]
    v_lshlrev_b32_e64 v10, 7, v10
    v_mfma_f32_16x16x32_bf16 v[160:163], a[116:119], v[56:59], v[160:163]
    v_lshl_add_u32 v10, v11, 4, v10
    v_mfma_f32_16x16x32_bf16 v[180:183], a[116:119], v[60:63], v[180:183]
    v_add_u32 v10, 120832, v10
    s_waitcnt vmcnt(12)
    v_mfma_f32_16x16x32_bf16 v[104:107], a[120:123], v[64:67], v[104:107]
    v_mfma_f32_16x16x32_bf16 v[124:127], a[120:123], v[68:71], v[124:127]
    buffer_load_dwordx4 v[48:51], v24, s[36:39], s60 offen offset:2048 sc1
    v_mfma_f32_16x16x32_bf16 v[144:147], a[120:123], v[72:75], v[144:147]
    s_add_u32 s69, s3, 1
    v_mfma_f32_16x16x32_bf16 v[164:167], a[120:123], v[76:79], v[164:167]
    s_and_b32 s69, s69, 3
    v_mfma_f32_16x16x32_bf16 v[108:111], a[124:127], v[64:67], v[108:111]
    s_mul_i32 s69, s69, 15360
    v_mfma_f32_16x16x32_bf16 v[128:131], a[124:127], v[68:71], v[128:131]
    buffer_load_dwordx4 v[52:55], v25, s[36:39], s60 offen offset:2048 sc1
    s_add_u32 s69, s69, 0
    v_mfma_f32_16x16x32_bf16 v[148:151], a[124:127], v[72:75], v[148:151]
    v_add_u32 v7, s69, v14
    v_mfma_f32_16x16x32_bf16 v[168:171], a[124:127], v[76:79], v[168:171]
    v_mfma_f32_16x16x32_bf16 v[112:115], a[128:131], v[64:67], v[112:115]
    s_add_u32 s69, s3, 2
    v_mfma_f32_16x16x32_bf16 v[132:135], a[128:131], v[68:71], v[132:135]
    buffer_load_dwordx4 v[56:59], v26, s[36:39], s60 offen offset:2048 sc1
    s_and_b32 s69, s69, 3
    v_mfma_f32_16x16x32_bf16 v[152:155], a[128:131], v[72:75], v[152:155]
    s_mul_i32 s69, s69, 15360
    v_mfma_f32_16x16x32_bf16 v[172:175], a[128:131], v[76:79], v[172:175]
    s_add_u32 s69, s69, 5120
    v_mfma_f32_16x16x32_bf16 v[116:119], a[132:135], v[64:67], v[116:119]
    v_add_u32 v8, s69, v14
    v_mfma_f32_16x16x32_bf16 v[136:139], a[132:135], v[68:71], v[136:139]
    buffer_load_dwordx4 v[60:63], v27, s[36:39], s60 offen offset:2048 sc1
    v_mfma_f32_16x16x32_bf16 v[156:159], a[132:135], v[72:75], v[156:159]
    s_add_u32 s69, s3, 3
    v_mfma_f32_16x16x32_bf16 v[176:179], a[132:135], v[76:79], v[176:179]
    s_and_b32 s69, s69, 3
    v_mfma_f32_16x16x32_bf16 v[120:123], a[136:139], v[64:67], v[120:123]
    s_mul_i32 s69, s69, 15360
    v_mfma_f32_16x16x32_bf16 v[140:143], a[136:139], v[68:71], v[140:143]
    s_add_u32 s69, s69, 10240
    v_mfma_f32_16x16x32_bf16 v[160:163], a[136:139], v[72:75], v[160:163]
    v_add_u32 v9, s69, v14
    v_mfma_f32_16x16x32_bf16 v[180:183], a[136:139], v[76:79], v[180:183]
    s_waitcnt vmcnt(12)
    v_mfma_f32_16x16x32_bf16 v[104:107], a[140:143], v[80:83], v[104:107]
    v_and_b32 v2, 15, v0
    v_mfma_f32_16x16x32_bf16 v[124:127], a[140:143], v[84:87], v[124:127]
    buffer_load_dwordx4 v[64:67], v24, s[36:39], s60 offen offset:3072 sc1
    v_mfma_f32_16x16x32_bf16 v[144:147], a[140:143], v[88:91], v[144:147]
    v_lshrrev_b32 v3, 4, v0
    v_mfma_f32_16x16x32_bf16 v[164:167], a[140:143], v[92:95], v[164:167]
    v_lshl_add_u32 v2, v2, 2, v3
    v_mfma_f32_16x16x32_bf16 v[108:111], a[144:147], v[80:83], v[108:111]
    v_mfma_f32_16x16x32_bf16 v[128:131], a[144:147], v[84:87], v[128:131]
    buffer_load_dwordx4 v[68:71], v25, s[36:39], s60 offen offset:3072 sc1
    v_mfma_f32_16x16x32_bf16 v[148:151], a[144:147], v[88:91], v[148:151]
    v_lshlrev_b32 v2, 2, v2
    v_mfma_f32_16x16x32_bf16 v[168:171], a[144:147], v[92:95], v[168:171]
    v_and_b32 v3, 3, v0
    v_mfma_f32_16x16x32_bf16 v[112:115], a[148:151], v[80:83], v[112:115]
    v_mfma_f32_16x16x32_bf16 v[132:135], a[148:151], v[84:87], v[132:135]
    buffer_load_dwordx4 v[72:75], v26, s[36:39], s60 offen offset:3072 sc1
    v_lshlrev_b32 v3, 6, v3
    v_mfma_f32_16x16x32_bf16 v[152:155], a[148:151], v[88:91], v[152:155]
    v_mfma_f32_16x16x32_bf16 v[172:175], a[148:151], v[92:95], v[172:175]
    v_and_b32 v11, 60, v0
    v_mfma_f32_16x16x32_bf16 v[116:119], a[152:155], v[80:83], v[116:119]
    v_mfma_f32_16x16x32_bf16 v[136:139], a[152:155], v[84:87], v[136:139]
    buffer_load_dwordx4 v[76:79], v27, s[36:39], s60 offen offset:3072 sc1
    s_add_u32 s60, s60, 4096
    v_mfma_f32_16x16x32_bf16 v[156:159], a[152:155], v[88:91], v[156:159]
    v_or_b32 v3, v3, v11
    v_mfma_f32_16x16x32_bf16 v[176:179], a[152:155], v[92:95], v[176:179]
    v_mfma_f32_16x16x32_bf16 v[120:123], a[156:159], v[80:83], v[120:123]
    v_mfma_f32_16x16x32_bf16 v[140:143], a[156:159], v[84:87], v[140:143]
    v_mfma_f32_16x16x32_bf16 v[160:163], a[156:159], v[88:91], v[160:163]
    buffer_load_dword v20, v18, s[36:39], s59 offen sc1
    v_mfma_f32_16x16x32_bf16 v[180:183], a[156:159], v[92:95], v[180:183]
    s_waitcnt vmcnt(13)
    v_mfma_f32_16x16x32_bf16 v[104:107], a[160:163], v[96:99], v[104:107]
    v_mfma_f32_16x16x32_bf16 v[124:127], a[160:163], v[100:103], v[124:127]
    buffer_load_dwordx4 v[80:83], v24, s[36:39], s60 offen offset:0 sc1
    v_mfma_f32_16x16x32_bf16 v[144:147], a[160:163], v[236:239], v[144:147]
    ds_bpermute_b32 v244, v2, v244
    v_mfma_f32_16x16x32_bf16 v[164:167], a[160:163], v[240:243], v[164:167]
    ds_bpermute_b32 v245, v2, v245
    v_mfma_f32_16x16x32_bf16 v[108:111], a[164:167], v[96:99], v[108:111]
    v_mfma_f32_16x16x32_bf16 v[128:131], a[164:167], v[100:103], v[128:131]
    buffer_load_dwordx4 v[84:87], v25, s[36:39], s60 offen offset:0 sc1
    ds_bpermute_b32 v246, v2, v246
    v_mfma_f32_16x16x32_bf16 v[148:151], a[164:167], v[236:239], v[148:151]
    v_mfma_f32_16x16x32_bf16 v[168:171], a[164:167], v[240:243], v[168:171]
    ds_bpermute_b32 v247, v2, v247
    v_mfma_f32_16x16x32_bf16 v[112:115], a[168:171], v[96:99], v[112:115]
    v_mfma_f32_16x16x32_bf16 v[132:135], a[168:171], v[100:103], v[132:135]
    buffer_load_dwordx4 v[88:91], v26, s[36:39], s60 offen offset:0 sc1
    ds_bpermute_b32 v248, v2, v248
    v_mfma_f32_16x16x32_bf16 v[152:155], a[168:171], v[236:239], v[152:155]
    v_mfma_f32_16x16x32_bf16 v[172:175], a[168:171], v[240:243], v[172:175]
    ds_bpermute_b32 v249, v2, v249
    v_mfma_f32_16x16x32_bf16 v[116:119], a[172:175], v[96:99], v[116:119]
    ds_bpermute_b32 v250, v2, v250
    v_mfma_f32_16x16x32_bf16 v[136:139], a[172:175], v[100:103], v[136:139]
    buffer_load_dwordx4 v[92:95], v27, s[36:39], s60 offen offset:0 sc1
    v_mfma_f32_16x16x32_bf16 v[156:159], a[172:175], v[236:239], v[156:159]
    v_mfma_f32_16x16x32_bf16 v[176:179], a[172:175], v[240:243], v[176:179]
    ds_bpermute_b32 v251, v2, v251
    v_mfma_f32_16x16x32_bf16 v[120:123], a[176:179], v[96:99], v[120:123]
    ds_bpermute_b32 v252, v2, v252
    v_mfma_f32_16x16x32_bf16 v[140:143], a[176:179], v[100:103], v[140:143]
    v_mfma_f32_16x16x32_bf16 v[160:163], a[176:179], v[236:239], v[160:163]
    ds_bpermute_b32 v253, v2, v253
    v_mfma_f32_16x16x32_bf16 v[180:183], a[176:179], v[240:243], v[180:183]
    s_waitcnt vmcnt(13)
    v_mfma_f32_16x16x32_bf16 v[104:107], a[180:183], v[32:35], v[104:107]
    v_mfma_f32_16x16x32_bf16 v[124:127], a[180:183], v[36:39], v[124:127]
    buffer_load_dwordx4 v[100:103], v25, s[36:39], s60 offen offset:1024 sc1
    v_mfma_f32_16x16x32_bf16 v[144:147], a[180:183], v[40:43], v[144:147]
    s_mov_b32 s48, s26
    v_mfma_f32_16x16x32_bf16 v[164:167], a[180:183], v[44:47], v[164:167]
    v_mfma_f32_16x16x32_bf16 v[108:111], a[184:187], v[32:35], v[108:111]
    s_mov_b32 s49, s27
    s_nop 0
    v_mfma_f32_16x16x32_bf16 v[128:131], a[184:187], v[36:39], v[128:131]
    buffer_load_dwordx4 v[236:239], v26, s[36:39], s60 offen offset:1024 sc1
    v_mfma_f32_16x16x32_bf16 v[148:151], a[184:187], v[40:43], v[148:151]
    v_mfma_f32_16x16x32_bf16 v[168:171], a[184:187], v[44:47], v[168:171]
    s_mov_b32 s50, 2621440
    v_mfma_f32_16x16x32_bf16 v[112:115], a[188:191], v[32:35], v[112:115]
    v_mfma_f32_16x16x32_bf16 v[132:135], a[188:191], v[36:39], v[132:135]
    buffer_load_dwordx4 v[240:243], v27, s[36:39], s60 offen offset:1024 sc1
    v_mfma_f32_16x16x32_bf16 v[152:155], a[188:191], v[40:43], v[152:155]
    s_mov_b32 s51, 0x20000
    v_mfma_f32_16x16x32_bf16 v[172:175], a[188:191], v[44:47], v[172:175]
    v_mfma_f32_16x16x32_bf16 v[116:119], a[192:195], v[32:35], v[116:119]
    v_mfma_f32_16x16x32_bf16 v[136:139], a[192:195], v[36:39], v[136:139]
    buffer_load_dwordx4 v[96:99], v24, s[36:39], s60 offen offset:1024 sc1
    v_mfma_f32_16x16x32_bf16 v[156:159], a[192:195], v[40:43], v[156:159]
    v_mfma_f32_16x16x32_bf16 v[176:179], a[192:195], v[44:47], v[176:179]
    v_mfma_f32_16x16x32_bf16 v[120:123], a[196:199], v[32:35], v[120:123]
    v_mfma_f32_16x16x32_bf16 v[140:143], a[196:199], v[36:39], v[140:143]
    v_mfma_f32_16x16x32_bf16 v[160:163], a[196:199], v[40:43], v[160:163]
    v_mfma_f32_16x16x32_bf16 v[180:183], a[196:199], v[44:47], v[180:183]
    s_waitcnt vmcnt(13)
    v_mfma_f32_16x16x32_bf16 v[104:107], a[200:203], v[48:51], v[104:107]
    s_waitcnt vmcnt(8)
    v_cmp_ne_u32 vcc, s56, v20
    v_mfma_f32_16x16x32_bf16 v[124:127], a[200:203], v[52:55], v[124:127]
    s_mov_b64 s[82:83], vcc
    s_cmp_eq_u64 s[82:83], 0
    s_cbranch_scc0 FY_RETRY_14
FY_DONE_15:
    v_mfma_f32_16x16x32_bf16 v[144:147], a[200:203], v[56:59], v[144:147]
    buffer_load_dwordx4 v[184:187], v13, s[36:39], s65 offen sc1
    v_mfma_f32_16x16x32_bf16 v[164:167], a[200:203], v[60:63], v[164:167]
    buffer_load_dwordx4 v[188:191], v13, s[36:39], s66 offen sc1
    v_mfma_f32_16x16x32_bf16 v[108:111], a[204:207], v[48:51], v[108:111]
    buffer_load_dwordx4 v[192:195], v13, s[36:39], s67 offen sc1
    v_mfma_f32_16x16x32_bf16 v[128:131], a[204:207], v[52:55], v[128:131]
    s_lshl_b32 s76, s3, 12
    s_add_u32 s76, s76, 131072
    s_cmp_eq_u32 s2, 0
    s_cselect_b32 s76, s76, 17563648
    v_mfma_f32_16x16x32_bf16 v[148:151], a[204:207], v[56:59], v[148:151]
    v_lshlrev_b32_e64 v16, 6, v0
    v_mfma_f32_16x16x32_bf16 v[168:171], a[204:207], v[60:63], v[168:171]
    buffer_load_dword v24, v16, s[36:39], s76 offen sc1
    s_mul_i32 s79, s3, 15360
    v_mfma_f32_16x16x32_bf16 v[112:115], a[208:211], v[48:51], v[112:115]
    v_add_u32 v26, s79, v14
    v_bfe_u32 v17, v0, 2, 2
    v_and_b32 v18, 3, v0
    v_mfma_f32_16x16x32_bf16 v[132:135], a[208:211], v[52:55], v[132:135]
    v_lshrrev_b32 v19, 1, v18
    s_lshl_b32 s78, s3, 1
    v_mfma_f32_16x16x32_bf16 v[152:155], a[208:211], v[56:59], v[152:155]
    v_or_b32 v19, s78, v19
    v_and_b32 v18, 1, v18
    v_mfma_f32_16x16x32_bf16 v[172:175], a[208:211], v[60:63], v[172:175]
    v_lshlrev_b32 v18, 3, v18
    v_add_u32 v18, 120832, v18
    v_and_b32 v27, 2, v17
    v_mfma_f32_16x16x32_bf16 v[116:119], a[212:215], v[48:51], v[116:119]
    v_and_b32 v20, 1, v4
    v_lshl_or_b32 v27, v20, 2, v27
    v_mfma_f32_16x16x32_bf16 v[136:139], a[212:215], v[52:55], v[136:139]
    v_xor_b32 v27, v27, v19
    v_lshl_add_u32 v27, v27, 4, v18
    v_mfma_f32_16x16x32_bf16 v[156:159], a[212:215], v[56:59], v[156:159]
    v_lshl_add_u32 v20, v4, 3, v17
    v_lshl_add_u32 v27, v20, 7, v27
    v_lshl_add_u32 v20, v4, 2, v17
    v_mfma_f32_16x16x32_bf16 v[176:179], a[212:215], v[60:63], v[176:179]
    v_and_b32 v23, 2, v20
    v_lshrrev_b32 v21, 1, v20
    v_mfma_f32_16x16x32_bf16 v[120:123], a[216:219], v[48:51], v[120:123]
    v_and_b32 v21, 4, v21
    v_or_b32 v23, v23, v21
    v_mfma_f32_16x16x32_bf16 v[140:143], a[216:219], v[52:55], v[140:143]
    v_xor_b32_e64 v23, v23, v19
    v_lshl_add_u32 v23, v23, 4, v18
    v_lshl_add_u32 v23, v20, 7, v23
    v_mfma_f32_16x16x32_bf16 v[160:163], a[216:219], v[56:59], v[160:163]
    s_mov_b32 s74, 0xbfb8aa3b
    s_mov_b32 s75, 0xbfb8aa3b
    v_mfma_f32_16x16x32_bf16 v[180:183], a[216:219], v[60:63], v[180:183]
    v_mov_b32 v30, 1.0
    v_mov_b32 v31, 1.0
    s_waitcnt vmcnt(8) lgkmcnt(0)
    v_mfma_f32_16x16x32_bf16 v[124:127], a[220:223], v[68:71], v[124:127]
    v_lshlrev_b32 v32, 16, v244
    v_and_b32 v33, 0xffff0000, v244
    v_mfma_f32_16x16x32_bf16 v[128:131], a[224:227], v[68:71], v[128:131]
    v_lshlrev_b32 v34, 16, v245
    v_mfma_f32_16x16x32_bf16 v[124:127], v[196:199], v[84:87], v[124:127]
    v_and_b32 v35, 0xffff0000, v245
    v_mfma_f32_16x16x32_bf16 v[128:131], v[200:203], v[84:87], v[128:131]
    s_waitcnt vmcnt(7)
    v_lshlrev_b32 v36, 16, v246
    v_mfma_f32_16x16x32_bf16 v[124:127], v[216:219], v[100:103], v[124:127]
    v_and_b32 v37, 0xffff0000, v246
    v_mfma_f32_16x16x32_bf16 v[128:131], v[220:223], v[100:103], v[128:131]
    v_lshlrev_b32 v38, 16, v247
    v_mfma_f32_16x16x32_bf16 v[132:135], a[228:231], v[68:71], v[132:135]
    v_and_b32 v39, 0xffff0000, v247
    v_lshlrev_b32_e64 v40, 16, v248
    v_mfma_f32_16x16x32_bf16 v[136:139], a[232:235], v[68:71], v[136:139]
    v_and_b32 v41, 0xffff0000, v248
    v_mfma_f32_16x16x32_bf16 v[132:135], v[204:207], v[84:87], v[132:135]
    ds_write_b128 v7, v[124:127] offset:0
    v_mfma_f32_16x16x32_bf16 v[136:139], v[208:211], v[84:87], v[136:139]
    v_lshlrev_b32_e64 v42, 16, v249
    v_mfma_f32_16x16x32_bf16 v[132:135], v[224:227], v[100:103], v[132:135]
    v_and_b32 v43, 0xffff0000, v249
    v_mfma_f32_16x16x32_bf16 v[136:139], v[228:231], v[100:103], v[136:139]
    ds_write_b128 v7, v[128:131] offset:1024
    v_mfma_f32_16x16x32_bf16 v[140:143], a[236:239], v[68:71], v[140:143]
    v_lshlrev_b32 v44, 16, v250
    v_mfma_f32_16x16x32_bf16 v[144:147], a[220:223], v[72:75], v[144:147]
    v_and_b32 v45, 0xffff0000, v250
    v_mfma_f32_16x16x32_bf16 v[140:143], v[212:215], v[84:87], v[140:143]
    v_lshlrev_b32 v46, 16, v251
    v_and_b32 v47, 0xffff0000, v251
    v_mfma_f32_16x16x32_bf16 v[144:147], v[196:199], v[88:91], v[144:147]
    ds_write_b128 v7, v[132:135] offset:2048
    v_mfma_f32_16x16x32_bf16 v[140:143], v[232:235], v[100:103], v[140:143]
    s_waitcnt vmcnt(6)
    v_lshlrev_b32 v48, 16, v252
    v_mfma_f32_16x16x32_bf16 v[144:147], v[216:219], v[236:239], v[144:147]
    v_and_b32 v49, 0xffff0000, v252
    v_mfma_f32_16x16x32_bf16 v[148:151], a[224:227], v[72:75], v[148:151]
    ds_write_b128 v7, v[136:139] offset:3072
    v_mfma_f32_16x16x32_bf16 v[152:155], a[228:231], v[72:75], v[152:155]
    v_lshlrev_b32_e64 v50, 16, v253
    v_mfma_f32_16x16x32_bf16 v[148:151], v[200:203], v[88:91], v[148:151]
    v_and_b32 v51, 0xffff0000, v253
    v_mfma_f32_16x16x32_bf16 v[152:155], v[204:207], v[88:91], v[152:155]
    ds_write_b128 v7, v[140:143] offset:4096
    v_mfma_f32_16x16x32_bf16 v[148:151], v[220:223], v[236:239], v[148:151]
    v_mul_f32 v254, v254, v255
    v_mfma_f32_16x16x32_bf16 v[152:155], v[224:227], v[236:239], v[152:155]
    v_sub_f32 v254, 0, v254
    v_fma_f32 v52, v32, v255, v254
    v_mfma_f32_16x16x32_bf16 v[156:159], a[232:235], v[72:75], v[156:159]
    ds_write_b128 v8, v[144:147] offset:0
    v_mfma_f32_16x16x32_bf16 v[160:163], a[236:239], v[72:75], v[160:163]
    v_fma_f32 v53, v33, v255, v254
    v_mfma_f32_16x16x32_bf16 v[156:159], v[208:211], v[88:91], v[156:159]
    v_fma_f32 v54, v34, v255, v254
    v_mfma_f32_16x16x32_bf16 v[160:163], v[212:215], v[88:91], v[160:163]
    ds_write_b128 v8, v[148:151] offset:1024
    v_mfma_f32_16x16x32_bf16 v[156:159], v[228:231], v[236:239], v[156:159]
    v_fma_f32 v55, v35, v255, v254
    v_mfma_f32_16x16x32_bf16 v[160:163], v[232:235], v[236:239], v[160:163]
    v_fma_f32 v56, v36, v255, v254
    v_mfma_f32_16x16x32_bf16 v[164:167], a[220:223], v[76:79], v[164:167]
    ds_write_b128 v8, v[152:155] offset:2048
    v_mfma_f32_16x16x32_bf16 v[168:171], a[224:227], v[76:79], v[168:171]
    v_fma_f32 v57, v37, v255, v254
    v_mfma_f32_16x16x32_bf16 v[164:167], v[196:199], v[92:95], v[164:167]
    v_fma_f32 v58, v38, v255, v254
    v_fma_f32 v59, v39, v255, v254
    v_mfma_f32_16x16x32_bf16 v[168:171], v[200:203], v[92:95], v[168:171]
    ds_write_b128 v8, v[156:159] offset:3072
    s_waitcnt vmcnt(5)
    s_nop 0
    v_mfma_f32_16x16x32_bf16 v[164:167], v[216:219], v[240:243], v[164:167]
    v_fma_f32 v60, v40, v255, v254
    v_mfma_f32_16x16x32_bf16 v[168:171], v[220:223], v[240:243], v[168:171]
    v_fma_f32 v61, v41, v255, v254
    v_mfma_f32_16x16x32_bf16 v[172:175], a[228:231], v[76:79], v[172:175]
    ds_write_b128 v8, v[160:163] offset:4096
    v_mfma_f32_16x16x32_bf16 v[176:179], a[232:235], v[76:79], v[176:179]
    v_fma_f32 v62, v42, v255, v254
    v_mfma_f32_16x16x32_bf16 v[172:175], v[204:207], v[92:95], v[172:175]
    v_fma_f32 v63, v43, v255, v254
    v_mfma_f32_16x16x32_bf16 v[176:179], v[208:211], v[92:95], v[176:179]
    ds_write_b128 v9, v[164:167] offset:0
    v_mfma_f32_16x16x32_bf16 v[172:175], v[224:227], v[240:243], v[172:175]
    v_fma_f32 v244, v44, v255, v254
    v_mfma_f32_16x16x32_bf16 v[176:179], v[228:231], v[240:243], v[176:179]
    v_fma_f32 v245, v45, v255, v254
    v_fma_f32 v246, v46, v255, v254
    v_mfma_f32_16x16x32_bf16 v[180:183], a[236:239], v[76:79], v[180:183]
    ds_write_b128 v9, v[168:171] offset:1024
    v_mfma_f32_16x16x32_bf16 v[104:107], a[220:223], v[64:67], v[104:107]
    v_fma_f32 v247, v47, v255, v254
    v_mfma_f32_16x16x32_bf16 v[180:183], v[212:215], v[92:95], v[180:183]
    v_fma_f32 v248, v48, v255, v254
    v_mfma_f32_16x16x32_bf16 v[104:107], v[196:199], v[80:83], v[104:107]
    ds_write_b128 v9, v[172:175] offset:2048
    v_mfma_f32_16x16x32_bf16 v[180:183], v[232:235], v[240:243], v[180:183]
    s_waitcnt vmcnt(4)
    s_nop 0
    v_fma_f32 v249, v49, v255, v254
    v_mfma_f32_16x16x32_bf16 v[104:107], v[216:219], v[96:99], v[104:107]
    v_fma_f32 v250, v50, v255, v254
    v_mfma_f32_16x16x32_bf16 v[108:111], a[224:227], v[64:67], v[108:111]
    ds_write_b128 v9, v[176:179] offset:3072
    v_mfma_f32_16x16x32_bf16 v[112:115], a[228:231], v[64:67], v[112:115]
    v_fma_f32 v251, v51, v255, v254
    v_mfma_f32_16x16x32_bf16 v[108:111], v[200:203], v[80:83], v[108:111]
    v_mfma_f32_16x16x32_bf16 v[112:115], v[204:207], v[80:83], v[112:115]
    ds_write_b128 v9, v[180:183] offset:4096
    v_mfma_f32_16x16x32_bf16 v[108:111], v[220:223], v[96:99], v[108:111]
    v_mfma_f32_16x16x32_bf16 v[112:115], v[224:227], v[96:99], v[112:115]
    v_mfma_f32_16x16x32_bf16 v[116:119], a[232:235], v[64:67], v[116:119]
    s_waitcnt vmcnt(1)
    ds_write_b128 v10, v[184:187] offset:0
    v_mfma_f32_16x16x32_bf16 v[120:123], a[236:239], v[64:67], v[120:123]
    v_mfma_f32_16x16x32_bf16 v[116:119], v[208:211], v[80:83], v[116:119]
    ds_write_b128 v10, v[188:191] offset:4096
    v_mfma_f32_16x16x32_bf16 v[120:123], v[212:215], v[80:83], v[120:123]
    v_mfma_f32_16x16x32_bf16 v[116:119], v[228:231], v[96:99], v[116:119]
    ds_write_b128 v10, v[192:195] offset:8192
    v_mfma_f32_16x16x32_bf16 v[120:123], v[232:235], v[96:99], v[120:123]
    s_cmp_eq_u32 s2, 0
    s_cbranch_scc1 EP_CHECK
EP_BACK:
    s_or_b32 s73, s2, s3
    s_cmp_eq_u32 s73, 0
    s_waitcnt lgkmcnt(0)
    s_barrier
    s_cbranch_scc1 EP_STORE
EP_STORED:
    ds_read_b64_tr_b16 v[220:221], v27 offset:0
    ds_read_b64_tr_b16 v[222:223], v27 offset:512
    ds_read_b64_tr_b16 v[224:225], v27 offset:4096
    ds_read_b64_tr_b16 v[226:227], v27 offset:4608
    ds_read_b64_tr_b16 v[228:229], v23 offset:8192
    ds_read_b128 v[124:127], v26 offset:0
    ds_read_b128 v[144:147], v26 offset:5120
    ds_read_b128 v[164:167], v26 offset:10240
    ds_read_b128 v[128:131], v26 offset:1024
    ds_read_b128 v[148:151], v26 offset:6144
    ds_read_b128 v[168:171], v26 offset:11264
    ds_read_b128 v[132:135], v26 offset:2048
    ds_read_b128 v[152:155], v26 offset:7168
    ds_read_b128 v[172:175], v26 offset:12288
    ds_read_b128 v[136:139], v26 offset:3072
    ds_read_b128 v[156:159], v26 offset:8192
    ds_read_b128 v[176:179], v26 offset:13312
    ds_read_b128 v[140:143], v26 offset:4096
    ds_read_b128 v[160:163], v26 offset:9216
    ds_read_b128 v[180:183], v26 offset:14336
    s_waitcnt lgkmcnt(15)
    v_lshlrev_b32 v92, 16, v220
    v_and_b32 v93, 0xffff0000, v220
    v_lshlrev_b32 v94, 16, v221
    v_and_b32 v95, 0xffff0000, v221
    v_lshlrev_b32 v96, 16, v222
    v_and_b32 v97, 0xffff0000, v222
    v_lshlrev_b32_e64 v98, 16, v223
    v_and_b32 v99, 0xffff0000, v223
    v_pk_mul_f32 v[52:53], v[52:53], v[92:93]
    v_pk_mul_f32 v[54:55], v[54:55], v[94:95]
    v_pk_mul_f32 v[56:57], v[56:57], v[96:97]
    v_pk_mul_f32 v[58:59], v[58:59], v[98:99]
    s_waitcnt lgkmcnt(9)
    s_nop 0
    v_pk_add_f32 v[104:105], v[104:105], v[124:125]
    v_pk_add_f32 v[106:107], v[106:107], v[126:127]
    v_pk_add_f32 v[108:109], v[108:109], v[128:129]
    v_pk_add_f32 v[110:111], v[110:111], v[130:131]
    v_pk_add_f32 v[104:105], v[104:105], v[144:145]
    v_pk_add_f32 v[106:107], v[106:107], v[146:147]
    v_pk_add_f32 v[108:109], v[108:109], v[148:149]
    v_pk_add_f32 v[110:111], v[110:111], v[150:151]
    v_pk_add_f32 v[104:105], v[104:105], v[164:165]
    v_pk_add_f32 v[106:107], v[106:107], v[166:167]
    v_pk_add_f32 v[108:109], v[108:109], v[168:169]
    v_pk_add_f32 v[110:111], v[110:111], v[170:171]
    v_pk_mul_f32 v[72:73], v[104:105], s[74:75]
    v_pk_mul_f32 v[74:75], v[106:107], s[74:75]
    v_pk_mul_f32 v[76:77], v[108:109], s[74:75]
    v_pk_mul_f32 v[78:79], v[110:111], s[74:75]
    v_exp_f32 v72, v72
    v_exp_f32 v73, v73
    v_exp_f32 v74, v74
    v_exp_f32 v75, v75
    v_exp_f32 v76, v76
    v_exp_f32 v77, v77
    v_exp_f32 v78, v78
    v_exp_f32 v79, v79
    v_lshlrev_b32 v100, 16, v224
    v_and_b32 v101, 0xffff0000, v224
    v_lshlrev_b32 v102, 16, v225
    v_and_b32 v103, 0xffff0000, v225
    v_lshlrev_b32 v230, 16, v226
    v_and_b32 v231, 0xffff0000, v226
    v_lshlrev_b32 v232, 16, v227
    v_and_b32 v233, 0xffff0000, v227
    v_pk_add_f32 v[72:73], v[72:73], v[30:31]
    v_pk_add_f32 v[74:75], v[74:75], v[30:31]
    v_pk_add_f32 v[76:77], v[76:77], v[30:31]
    v_pk_add_f32 v[78:79], v[78:79], v[30:31]
    v_rcp_f32 v72, v72
    v_rcp_f32 v73, v73
    v_rcp_f32 v74, v74
    v_rcp_f32 v75, v75
    v_rcp_f32 v76, v76
    v_rcp_f32 v77, v77
    v_rcp_f32 v78, v78
    v_rcp_f32 v79, v79
    v_pk_mul_f32 v[60:61], v[60:61], v[100:101]
    v_pk_mul_f32 v[62:63], v[62:63], v[102:103]
    v_pk_mul_f32 v[244:245], v[244:245], v[230:231]
    v_pk_mul_f32 v[246:247], v[246:247], v[232:233]
    v_pk_mul_f32 v[72:73], v[72:73], v[104:105]
    v_pk_mul_f32 v[74:75], v[74:75], v[106:107]
    v_pk_mul_f32 v[76:77], v[76:77], v[108:109]
    v_pk_mul_f32 v[78:79], v[78:79], v[110:111]
    v_pk_fma_f32 v[72:73], v[72:73], v[52:53], v[32:33]
    v_pk_fma_f32 v[74:75], v[74:75], v[54:55], v[34:35]
    v_pk_fma_f32 v[76:77], v[76:77], v[56:57], v[36:37]
    v_pk_fma_f32 v[78:79], v[78:79], v[58:59], v[38:39]
    v_cvt_pk_bf16_f32 v184, v72, v73
    v_cvt_pk_bf16_f32 v185, v74, v75
    v_cvt_pk_bf16_f32 v186, v76, v77
    v_cvt_pk_bf16_f32 v187, v78, v79
    buffer_store_dwordx4 v[184:187], v28, s[48:51], s68 offen offset:0
    s_waitcnt lgkmcnt(3)
    s_nop 0
    v_pk_add_f32 v[112:113], v[112:113], v[132:133]
    v_pk_add_f32 v[114:115], v[114:115], v[134:135]
    v_pk_add_f32 v[116:117], v[116:117], v[136:137]
    v_pk_add_f32 v[118:119], v[118:119], v[138:139]
    v_pk_add_f32 v[112:113], v[112:113], v[152:153]
    v_pk_add_f32 v[114:115], v[114:115], v[154:155]
    v_pk_add_f32 v[116:117], v[116:117], v[156:157]
    v_pk_add_f32 v[118:119], v[118:119], v[158:159]
    v_pk_add_f32 v[112:113], v[112:113], v[172:173]
    v_pk_add_f32 v[114:115], v[114:115], v[174:175]
    v_pk_add_f32 v[116:117], v[116:117], v[176:177]
    v_pk_add_f32 v[118:119], v[118:119], v[178:179]
    v_pk_mul_f32 v[80:81], v[112:113], s[74:75]
    v_pk_mul_f32 v[82:83], v[114:115], s[74:75]
    v_pk_mul_f32 v[84:85], v[116:117], s[74:75]
    v_pk_mul_f32 v[86:87], v[118:119], s[74:75]
    v_exp_f32 v80, v80
    v_exp_f32 v81, v81
    v_exp_f32 v82, v82
    v_exp_f32 v83, v83
    v_exp_f32 v84, v84
    v_exp_f32 v85, v85
    v_exp_f32 v86, v86
    v_exp_f32 v87, v87
    v_lshlrev_b32 v234, 16, v228
    v_and_b32 v235, 0xffff0000, v228
    v_lshlrev_b32 v236, 16, v229
    v_and_b32 v237, 0xffff0000, v229
    v_pk_add_f32 v[80:81], v[80:81], v[30:31]
    v_pk_add_f32 v[82:83], v[82:83], v[30:31]
    v_pk_add_f32 v[84:85], v[84:85], v[30:31]
    v_pk_add_f32 v[86:87], v[86:87], v[30:31]
    v_rcp_f32 v80, v80
    v_rcp_f32 v81, v81
    v_rcp_f32 v82, v82
    v_rcp_f32 v83, v83
    v_rcp_f32 v84, v84
    v_rcp_f32 v85, v85
    v_rcp_f32 v86, v86
    v_rcp_f32 v87, v87
    v_pk_mul_f32 v[248:249], v[248:249], v[234:235]
    v_pk_mul_f32 v[250:251], v[250:251], v[236:237]
    v_pk_mul_f32 v[80:81], v[80:81], v[112:113]
    v_pk_mul_f32 v[82:83], v[82:83], v[114:115]
    v_pk_mul_f32 v[84:85], v[84:85], v[116:117]
    v_pk_mul_f32 v[86:87], v[86:87], v[118:119]
    v_pk_fma_f32 v[80:81], v[80:81], v[60:61], v[40:41]
    v_pk_fma_f32 v[82:83], v[82:83], v[62:63], v[42:43]
    v_pk_fma_f32 v[84:85], v[84:85], v[244:245], v[44:45]
    v_pk_fma_f32 v[86:87], v[86:87], v[246:247], v[46:47]
    v_cvt_pk_bf16_f32 v188, v80, v81
    v_cvt_pk_bf16_f32 v189, v82, v83
    v_cvt_pk_bf16_f32 v190, v84, v85
    v_cvt_pk_bf16_f32 v191, v86, v87
    buffer_store_dwordx4 v[188:191], v28, s[48:51], s68 offen offset:64
    s_waitcnt lgkmcnt(0)
    s_nop 0
    v_pk_add_f32 v[120:121], v[120:121], v[140:141]
    v_pk_add_f32 v[122:123], v[122:123], v[142:143]
    v_pk_add_f32 v[120:121], v[120:121], v[160:161]
    v_pk_add_f32 v[122:123], v[122:123], v[162:163]
    v_pk_add_f32 v[120:121], v[120:121], v[180:181]
    v_pk_add_f32 v[122:123], v[122:123], v[182:183]
    v_pk_mul_f32 v[88:89], v[120:121], s[74:75]
    v_pk_mul_f32 v[90:91], v[122:123], s[74:75]
    v_exp_f32 v88, v88
    v_exp_f32 v89, v89
    v_exp_f32_e64 v90, v90
    v_exp_f32 v91, v91
    s_nop 0
    v_pk_add_f32 v[88:89], v[88:89], v[30:31]
    v_pk_add_f32 v[90:91], v[90:91], v[30:31]
    v_rcp_f32 v88, v88
    v_rcp_f32 v89, v89
    v_rcp_f32_e64 v90, v90
    v_rcp_f32 v91, v91
    s_nop 0
    v_pk_mul_f32 v[88:89], v[88:89], v[120:121]
    v_pk_mul_f32 v[90:91], v[90:91], v[122:123]
    v_pk_fma_f32 v[88:89], v[88:89], v[248:249], v[48:49]
    v_pk_fma_f32 v[90:91], v[90:91], v[250:251], v[50:51]
    v_cvt_pk_bf16_f32 v192, v88, v89
    v_cvt_pk_bf16_f32 v193, v90, v91
    buffer_store_dwordx2 v[192:193], v29, s[48:51], s68 offen offset:128
    s_branch DONE
IDLE:
    s_movk_i32 s73, 1280
    s_sub_u32 s76, s58, 28
    s_lshl_b32 s76, s76, 3
    s_add_u32 s76, s76, s57
    v_lshrrev_b32 v15, 4, v0
    s_lshl_b32 s78, s3, 2
    v_add_u32 v15, s78, v15
    v_and_b32_e64 v18, 15, v0
    v_mul_u32_u24 v14, 5120, v15
    v_lshl_add_u32 v14, v18, 3, v14
    s_mul_i32 s78, s76, 81920
    v_add_u32_e64 v14, s78, v14
    v_add_u32 v15, 0xfffff100, v14
    v_add_u32 v16, 0xfffff600, v14
    v_add_u32 v17, 0xfffffb00, v14
    v_lshlrev_b32 v18, 5, v18
    s_waitcnt lgkmcnt(0)
    s_load_dword s56, s[30:31], 0
    s_mov_b32 s32, s4
    s_mov_b32 s33, s5
    s_mov_b32 s34, 2621440
    s_mov_b32 s35, 0x20000
    s_mov_b32 s44, s6
    s_mov_b32 s45, s7
    s_mov_b32 s46, 2621440
    s_mov_b32 s47, 0x20000
    s_mov_b32 s48, s8
    s_mov_b32 s49, s9
    s_mov_b32 s50, 2621440
    s_mov_b32 s51, 0x20000
    s_mov_b32 s52, s10
    s_mov_b32 s53, s11
    s_mov_b32 s54, 5120
    s_mov_b32 s55, 0x20000
    s_movk_i32 s79, 896
    s_movk_i32 s80, 3584
    v_add_u32 v22, s79, v14
    v_add_u32 v23, s79, v15
    v_add_u32 v24, s79, v16
    v_add_u32 v25, s79, v17
    buffer_load_dwordx2 v[96:97], v23, s[44:47], 0 offen nt
    buffer_load_dwordx2 v[98:99], v24, s[44:47], 0 offen nt
    buffer_load_dwordx2 v[100:101], v25, s[44:47], 0 offen nt
    buffer_load_dwordx2 v[102:103], v22, s[44:47], 0 offen offset:0 nt
    buffer_load_dwordx2 v[104:105], v22, s[44:47], 0 offen offset:1280 nt
    buffer_load_dwordx2 v[106:107], v22, s[44:47], 0 offen offset:2560 nt
    buffer_load_dwordx2 v[108:109], v22, s[44:47], 0 offen offset:3840 nt
    buffer_load_dwordx4 v[118:121], v18, s[52:55], s80 offen
    buffer_load_dwordx4 v[122:125], v18, s[52:55], s80 offen offset:16
    buffer_load_dwordx2 v[110:111], v22, s[48:51], 0 offen offset:0 nt
    buffer_load_dwordx2 v[112:113], v22, s[48:51], 0 offen offset:1280 nt
    buffer_load_dwordx2 v[114:115], v22, s[48:51], 0 offen offset:2560 nt
    buffer_load_dwordx2 v[116:117], v22, s[48:51], 0 offen offset:3840 nt
    s_mov_b32 s42, 1
    s_mov_b64 exec, 0
PAGE6:
    s_cbranch_execz VISIT_RET
    s_cmp_eq_u32 s3, 0
    s_cbranch_scc1 PAGE1
    s_cmp_eq_u32 s3, 1
    s_cbranch_scc1 PAGE3
    s_cmp_eq_u32 s3, 2
    s_cbranch_scc1 PAGE5
    s_branch PAGE7
VISIT_RET_I:
    s_mov_b64 exec, -1
    s_lshl_b32 s80, s76, 7
    s_add_u32 s59, s80, 2883584
    s_lshl_b32 s68, s76, 6
    s_add_u32 s68, s68, 145408
    s_and_b32 s76, s58, 7
    s_lshl_b32 s77, s57, 2
    s_lshr_b32 s78, s58, 3
    s_add_u32 s77, s77, s78
    s_mul_i32 s78, s77, 40960
    s_mul_i32 s79, s76, 160
    s_add_u32 s78, s78, s79
    s_add_u32 s79, s78, 1310720
    s_cmp_lt_u32 s77, 22
    s_cselect_b32 s79, s79, 2211840
    s_lshl_b32 s80, s3, 6
    v_add_u32_e64 v24, s80, v0
    v_cmp_gt_u32 vcc, 320, v24
    v_subrev_u32 v25, 320, v24
    v_mov_b32 v26, s79
    v_mov_b32 v27, s78
    v_cndmask_b32 v25, v25, v24, vcc
    v_cndmask_b32 v26, v26, v27, vcc
    v_mul_u32_u24 v27, 6554, v25
    v_lshrrev_b32 v27, 16, v27
    v_mul_u32_u24 v28, 10, v27
    v_sub_u32_e64 v28, v25, v28
    v_mul_u32_u24 v27, 1280, v27
    v_lshl_add_u32 v27, v28, 4, v27
    v_add_u32 v80, v27, v26
    v_add_u32 v24, s80, v0
    v_add_u32 v24, 256, v24
    v_cmp_gt_u32 vcc, 320, v24
    v_subrev_u32 v25, 320, v24
    v_mov_b32 v26, s79
    v_mov_b32 v27, s78
    v_cndmask_b32 v25, v25, v24, vcc
    v_cndmask_b32 v26, v26, v27, vcc
    v_mul_u32_u24 v27, 6554, v25
    v_lshrrev_b32 v27, 16, v27
    v_mul_u32_u24 v28, 10, v27
    v_sub_u32_e64 v28, v25, v28
    v_mul_u32_u24 v27, 1280, v27
    v_lshl_add_u32 v27, v28, 4, v27
    v_add_u32 v81, v27, v26
    v_add_u32 v24, s80, v0
    v_add_u32 v24, 512, v24
    v_cmp_gt_u32 vcc, 320, v24
    v_subrev_u32 v25, 320, v24
    v_mov_b32 v26, s79
    v_mov_b32 v27, s78
    v_cndmask_b32 v25, v25, v24, vcc
    v_cndmask_b32 v26, v26, v27, vcc
    v_mul_u32_u24 v27, 6554, v25
    v_lshrrev_b32 v27, 16, v27
    v_mul_u32_u24 v28, 10, v27
    v_sub_u32_e64 v28, v25, v28
    v_mul_u32_u24 v27, 1280, v27
    v_lshl_add_u32 v27, v28, 4, v27
    v_add_u32_e64 v82, v27, v26
    v_mov_b32 v26, 2211840
    v_cmp_gt_u32 vcc, 640, v24
    s_nop 1
    v_cndmask_b32 v82, v26, v82, vcc
    v_and_b32 v203, 15, v0
    v_lshrrev_b32 v204, 5, v0
    s_lshl_b32 s78, s3, 1
    v_add_u32 v204, s78, v204
    v_xor_b32 v204, v204, v203
    v_and_b32 v204, 7, v204
    v_lshlrev_b32_e64 v204, 4, v204
    v_lshl_add_u32 v203, v203, 9, v204
    v_bfe_u32 v204, v0, 4, 1
    v_xor_b32_e64 v204, 1, v204
    v_lshl_add_u32 v203, v204, 3, v203
    v_add_u32 v203, 131584, v203
    s_lshl_b32 s78, s3, 6
    v_add_u32 v205, s78, v0
    v_lshrrev_b32 v206, 3, v205
    v_lshrrev_b32 v204, 5, v205
    v_xor_b32 v204, v204, v205
    v_and_b32 v204, 7, v204
    v_lshlrev_b32_e64 v204, 4, v204
    v_lshl_add_u32 v204, v206, 7, v204
    v_add_u32 v204, 131584, v204
    v_and_b32 v205, 7, v205
    v_lshlrev_b32 v205, 4, v205
    v_lshl_add_u32 v205, v206, 12, v205
    v_add_u32 v206, 0x20000, v205
    s_movk_i32 s79, 1024
    s_movk_i32 s80, 4096
    v_add_u32 v22, s79, v14
    v_add_u32 v23, s79, v15
    v_add_u32 v24, s79, v16
    v_add_u32 v25, s79, v17
    buffer_load_dwordx2 v[126:127], v23, s[44:47], 0 offen nt
    buffer_load_dwordx2 v[128:129], v24, s[44:47], 0 offen nt
    buffer_load_dwordx2 v[130:131], v25, s[44:47], 0 offen nt
    buffer_load_dwordx2 v[132:133], v22, s[44:47], 0 offen offset:0 nt
    buffer_load_dwordx2 v[134:135], v22, s[44:47], 0 offen offset:1280 nt
    buffer_load_dwordx2 v[136:137], v22, s[44:47], 0 offen offset:2560 nt
    buffer_load_dwordx2 v[138:139], v22, s[44:47], 0 offen offset:3840 nt
    buffer_load_dwordx4 v[148:151], v18, s[52:55], s80 offen
    buffer_load_dwordx4 v[152:155], v18, s[52:55], s80 offen offset:16
    buffer_load_dwordx2 v[140:141], v22, s[48:51], 0 offen offset:0 nt
    buffer_load_dwordx2 v[142:143], v22, s[48:51], 0 offen offset:1280 nt
    buffer_load_dwordx2 v[144:145], v22, s[48:51], 0 offen offset:2560 nt
    buffer_load_dwordx2 v[146:147], v22, s[48:51], 0 offen offset:3840 nt
    s_waitcnt vmcnt(17)
    v_lshlrev_b32 v224, 16, v118
    v_and_b32 v228, 0xffff0000, v118
    v_lshlrev_b32 v225, 16, v122
    v_and_b32 v229, 0xffff0000, v122
    v_lshlrev_b32 v226, 16, v120
    v_and_b32 v230, 0xffff0000, v120
    v_lshlrev_b32 v227, 16, v124
    v_and_b32 v231, 0xffff0000, v124
    v_lshlrev_b32 v232, 16, v119
    v_and_b32 v236, 0xffff0000, v119
    v_lshlrev_b32 v233, 16, v123
    v_and_b32 v237, 0xffff0000, v123
    v_lshlrev_b32 v234, 16, v121
    v_and_b32 v238, 0xffff0000, v121
    v_lshlrev_b32 v235, 16, v125
    v_and_b32 v239, 0xffff0000, v125
    v_lshlrev_b32 v208, 16, v96
    v_and_b32 v96, 0xffff0000, v96
    v_lshlrev_b32 v209, 16, v97
    v_and_b32 v97, 0xffff0000, v97
    v_lshlrev_b32 v210, 16, v98
    v_and_b32 v98, 0xffff0000, v98
    v_lshlrev_b32 v211, 16, v99
    v_and_b32 v99, 0xffff0000, v99
    v_lshlrev_b32 v212, 16, v100
    v_and_b32 v100, 0xffff0000, v100
    v_lshlrev_b32 v213, 16, v101
    v_and_b32 v101, 0xffff0000, v101
    v_lshlrev_b32 v214, 16, v102
    v_and_b32 v102, 0xffff0000, v102
    v_lshlrev_b32 v215, 16, v103
    v_and_b32 v103, 0xffff0000, v103
    v_lshlrev_b32 v216, 16, v104
    v_and_b32 v104, 0xffff0000, v104
    v_lshlrev_b32 v217, 16, v105
    v_and_b32 v105, 0xffff0000, v105
    v_lshlrev_b32 v218, 16, v106
    v_and_b32 v106, 0xffff0000, v106
    v_lshlrev_b32 v219, 16, v107
    v_and_b32 v107, 0xffff0000, v107
    v_lshlrev_b32 v220, 16, v108
    v_and_b32 v108, 0xffff0000, v108
    v_lshlrev_b32_e64 v221, 16, v109
    v_and_b32 v109, 0xffff0000, v109
    v_pk_mul_f32 v[240:241], v[214:215], v[224:225]
    v_pk_mul_f32 v[242:243], v[102:103], v[226:227]
    v_pk_mul_f32 v[244:245], v[216:217], v[224:225]
    v_pk_mul_f32 v[246:247], v[104:105], v[226:227]
    v_pk_mul_f32 v[248:249], v[218:219], v[224:225]
    v_pk_mul_f32 v[250:251], v[106:107], v[226:227]
    v_pk_mul_f32 v[252:253], v[220:221], v[224:225]
    v_pk_mul_f32 v[254:255], v[108:109], v[226:227]
    v_pk_fma_f32 v[240:241], v[212:213], v[228:229], v[240:241]
    v_pk_fma_f32 v[242:243], v[100:101], v[230:231], v[242:243]
    v_pk_fma_f32 v[244:245], v[214:215], v[228:229], v[244:245]
    v_pk_fma_f32 v[246:247], v[102:103], v[230:231], v[246:247]
    v_pk_fma_f32 v[248:249], v[216:217], v[228:229], v[248:249]
    v_pk_fma_f32 v[250:251], v[104:105], v[230:231], v[250:251]
    v_pk_fma_f32 v[252:253], v[218:219], v[228:229], v[252:253]
    v_pk_fma_f32 v[254:255], v[106:107], v[230:231], v[254:255]
    v_pk_fma_f32 v[240:241], v[210:211], v[232:233], v[240:241]
    v_pk_fma_f32 v[242:243], v[98:99], v[234:235], v[242:243]
    v_pk_fma_f32 v[244:245], v[212:213], v[232:233], v[244:245]
    v_pk_fma_f32 v[246:247], v[100:101], v[234:235], v[246:247]
    v_pk_fma_f32 v[248:249], v[214:215], v[232:233], v[248:249]
    v_pk_fma_f32 v[250:251], v[102:103], v[234:235], v[250:251]
    v_pk_fma_f32 v[252:253], v[216:217], v[232:233], v[252:253]
    v_pk_fma_f32 v[254:255], v[104:105], v[234:235], v[254:255]
    v_pk_fma_f32 v[240:241], v[208:209], v[236:237], v[240:241]
    v_pk_fma_f32 v[242:243], v[96:97], v[238:239], v[242:243]
    v_pk_fma_f32 v[244:245], v[210:211], v[236:237], v[244:245]
    v_pk_fma_f32 v[246:247], v[98:99], v[238:239], v[246:247]
    v_pk_fma_f32 v[248:249], v[212:213], v[236:237], v[248:249]
    v_pk_fma_f32 v[250:251], v[100:101], v[238:239], v[250:251]
    v_pk_fma_f32 v[252:253], v[214:215], v[236:237], v[252:253]
    v_pk_fma_f32 v[254:255], v[102:103], v[238:239], v[254:255]
    s_waitcnt vmcnt(13)
    v_lshlrev_b32 v208, 16, v110
    v_and_b32 v110, 0xffff0000, v110
    v_lshlrev_b32 v209, 16, v111
    v_and_b32 v111, 0xffff0000, v111
    v_lshlrev_b32 v210, 16, v112
    v_and_b32 v112, 0xffff0000, v112
    v_lshlrev_b32 v211, 16, v113
    v_and_b32 v113, 0xffff0000, v113
    v_lshlrev_b32 v212, 16, v114
    v_and_b32 v114, 0xffff0000, v114
    v_lshlrev_b32 v213, 16, v115
    v_and_b32 v115, 0xffff0000, v115
    v_lshlrev_b32 v214, 16, v116
    v_and_b32 v116, 0xffff0000, v116
    v_lshlrev_b32_e64 v215, 16, v117
    v_and_b32 v117, 0xffff0000, v117
    v_pk_mul_f32 v[240:241], v[240:241], v[208:209]
    v_pk_mul_f32 v[242:243], v[242:243], v[110:111]
    v_pk_mul_f32 v[244:245], v[244:245], v[210:211]
    v_pk_mul_f32 v[246:247], v[246:247], v[112:113]
    v_pk_mul_f32 v[248:249], v[248:249], v[212:213]
    v_pk_mul_f32 v[250:251], v[250:251], v[114:115]
    v_pk_mul_f32 v[252:253], v[252:253], v[214:215]
    v_pk_mul_f32 v[254:255], v[254:255], v[116:117]
    v_cvt_pk_bf16_f32 v224, v252, v248
    v_cvt_pk_bf16_f32 v225, v244, v240
    v_cvt_pk_bf16_f32 v226, v254, v250
    v_cvt_pk_bf16_f32 v227, v246, v242
    v_cvt_pk_bf16_f32 v228, v253, v249
    v_cvt_pk_bf16_f32 v229, v245, v241
    v_cvt_pk_bf16_f32 v230, v255, v251
    v_cvt_pk_bf16_f32 v231, v247, v243
    ds_write_b64 v203, v[224:225] offset:0
    ds_write_b64 v203, v[226:227] offset:128
    ds_write_b64 v203, v[228:229] offset:256
    ds_write_b64 v203, v[230:231] offset:384
    s_movk_i32 s79, 1152
    s_movk_i32 s80, 4608
    v_add_u32 v22, s79, v14
    v_add_u32 v23, s79, v15
    v_add_u32 v24, s79, v16
    v_add_u32 v25, s79, v17
    buffer_load_dwordx2 v[156:157], v23, s[44:47], 0 offen nt
    buffer_load_dwordx2 v[158:159], v24, s[44:47], 0 offen nt
    buffer_load_dwordx2 v[160:161], v25, s[44:47], 0 offen nt
    buffer_load_dwordx2 v[162:163], v22, s[44:47], 0 offen offset:0 nt
    buffer_load_dwordx2 v[164:165], v22, s[44:47], 0 offen offset:1280 nt
    buffer_load_dwordx2 v[166:167], v22, s[44:47], 0 offen offset:2560 nt
    buffer_load_dwordx2 v[168:169], v22, s[44:47], 0 offen offset:3840 nt
    buffer_load_dwordx4 v[178:181], v18, s[52:55], s80 offen
    buffer_load_dwordx4 v[182:185], v18, s[52:55], s80 offen offset:16
    buffer_load_dwordx2 v[170:171], v22, s[48:51], 0 offen offset:0 nt
    buffer_load_dwordx2 v[172:173], v22, s[48:51], 0 offen offset:1280 nt
    buffer_load_dwordx2 v[174:175], v22, s[48:51], 0 offen offset:2560 nt
    buffer_load_dwordx2 v[176:177], v22, s[48:51], 0 offen offset:3840 nt
    s_mov_b32 s36, s30
    s_mov_b32 s37, s31
    s_mov_b32 s38, 17563648
    s_mov_b32 s39, 0x20000
    v_mov_b32 v30, 17563648
    s_cmp_eq_u32 s3, 0
    s_cselect_b32 s80, s68, 17563648
    v_writelane_b32 v30, s80, 1
    s_lshl_b32 s77, s57, 1
    s_lshr_b32 s78, s58, 4
    s_add_u32 s77, s77, s78
    s_lshl_b32 s77, s77, 4
    s_and_b32 s78, s58, 15
    s_add_u32 s77, s77, s78
    s_lshl_b32 s77, s77, 6
    s_add_u32 s77, s77, 196608
    s_cmp_eq_u32 s3, 0
    s_cselect_b32 s77, s77, 17563648
    v_writelane_b32 v30, s77, 0
    s_and_b32 s77, s58, 7
    s_lshl_b32 s77, s77, 5
    s_lshl_b32 s78, s57, 2
    s_lshr_b32 s79, s58, 3
    s_add_u32 s78, s78, s79
    s_add_u32 s77, s77, s78
    s_lshl_b32 s77, s77, 6
    s_add_u32 s77, s77, 163840
    s_cmp_eq_u32 s3, 0
    s_cselect_b32 s77, s77, 17563648
    v_writelane_b32 v30, s77, 2
    s_waitcnt lgkmcnt(0)
    s_add_u32 s56, s56, 2654435769
    v_mov_b32 v31, s56
    s_waitcnt vmcnt(17)
    v_lshlrev_b32 v224, 16, v148
    v_and_b32 v228, 0xffff0000, v148
    v_lshlrev_b32 v225, 16, v152
    v_and_b32 v229, 0xffff0000, v152
    v_lshlrev_b32 v226, 16, v150
    v_and_b32 v230, 0xffff0000, v150
    v_lshlrev_b32 v227, 16, v154
    v_and_b32 v231, 0xffff0000, v154
    v_lshlrev_b32 v232, 16, v149
    v_and_b32 v236, 0xffff0000, v149
    v_lshlrev_b32 v233, 16, v153
    v_and_b32 v237, 0xffff0000, v153
    v_lshlrev_b32 v234, 16, v151
    v_and_b32 v238, 0xffff0000, v151
    v_lshlrev_b32 v235, 16, v155
    v_and_b32 v239, 0xffff0000, v155
    v_lshlrev_b32 v208, 16, v126
    v_and_b32 v126, 0xffff0000, v126
    v_lshlrev_b32 v209, 16, v127
    v_and_b32 v127, 0xffff0000, v127
    v_lshlrev_b32 v210, 16, v128
    v_and_b32 v128, 0xffff0000, v128
    v_lshlrev_b32 v211, 16, v129
    v_and_b32 v129, 0xffff0000, v129
    v_lshlrev_b32 v212, 16, v130
    v_and_b32 v130, 0xffff0000, v130
    v_lshlrev_b32 v213, 16, v131
    v_and_b32 v131, 0xffff0000, v131
    v_lshlrev_b32 v214, 16, v132
    v_and_b32 v132, 0xffff0000, v132
    v_lshlrev_b32 v215, 16, v133
    v_and_b32 v133, 0xffff0000, v133
    v_lshlrev_b32 v216, 16, v134
    v_and_b32 v134, 0xffff0000, v134
    v_lshlrev_b32 v217, 16, v135
    v_and_b32 v135, 0xffff0000, v135
    v_lshlrev_b32 v218, 16, v136
    v_and_b32 v136, 0xffff0000, v136
    v_lshlrev_b32 v219, 16, v137
    v_and_b32 v137, 0xffff0000, v137
    v_lshlrev_b32 v220, 16, v138
    v_and_b32 v138, 0xffff0000, v138
    v_lshlrev_b32 v221, 16, v139
    v_and_b32 v139, 0xffff0000, v139
    v_pk_mul_f32 v[240:241], v[214:215], v[224:225]
    v_pk_mul_f32 v[242:243], v[132:133], v[226:227]
    v_pk_mul_f32 v[244:245], v[216:217], v[224:225]
    v_pk_mul_f32 v[246:247], v[134:135], v[226:227]
    v_pk_mul_f32 v[248:249], v[218:219], v[224:225]
    v_pk_mul_f32 v[250:251], v[136:137], v[226:227]
    v_pk_mul_f32 v[252:253], v[220:221], v[224:225]
    v_pk_mul_f32 v[254:255], v[138:139], v[226:227]
    v_pk_fma_f32 v[240:241], v[212:213], v[228:229], v[240:241]
    v_pk_fma_f32 v[242:243], v[130:131], v[230:231], v[242:243]
    v_pk_fma_f32 v[244:245], v[214:215], v[228:229], v[244:245]
    v_pk_fma_f32 v[246:247], v[132:133], v[230:231], v[246:247]
    v_pk_fma_f32 v[248:249], v[216:217], v[228:229], v[248:249]
    v_pk_fma_f32 v[250:251], v[134:135], v[230:231], v[250:251]
    v_pk_fma_f32 v[252:253], v[218:219], v[228:229], v[252:253]
    v_pk_fma_f32 v[254:255], v[136:137], v[230:231], v[254:255]
    v_pk_fma_f32 v[240:241], v[210:211], v[232:233], v[240:241]
    v_pk_fma_f32 v[242:243], v[128:129], v[234:235], v[242:243]
    v_pk_fma_f32 v[244:245], v[212:213], v[232:233], v[244:245]
    v_pk_fma_f32 v[246:247], v[130:131], v[234:235], v[246:247]
    v_pk_fma_f32 v[248:249], v[214:215], v[232:233], v[248:249]
    v_pk_fma_f32 v[250:251], v[132:133], v[234:235], v[250:251]
    v_pk_fma_f32 v[252:253], v[216:217], v[232:233], v[252:253]
    v_pk_fma_f32 v[254:255], v[134:135], v[234:235], v[254:255]
    v_pk_fma_f32 v[240:241], v[208:209], v[236:237], v[240:241]
    v_pk_fma_f32 v[242:243], v[126:127], v[238:239], v[242:243]
    v_pk_fma_f32 v[244:245], v[210:211], v[236:237], v[244:245]
    v_pk_fma_f32 v[246:247], v[128:129], v[238:239], v[246:247]
    v_pk_fma_f32 v[248:249], v[212:213], v[236:237], v[248:249]
    v_pk_fma_f32 v[250:251], v[130:131], v[238:239], v[250:251]
    v_pk_fma_f32 v[252:253], v[214:215], v[236:237], v[252:253]
    v_pk_fma_f32 v[254:255], v[132:133], v[238:239], v[254:255]
    s_waitcnt vmcnt(13)
    v_lshlrev_b32 v208, 16, v140
    v_and_b32 v140, 0xffff0000, v140
    v_lshlrev_b32 v209, 16, v141
    v_and_b32 v141, 0xffff0000, v141
    v_lshlrev_b32 v210, 16, v142
    v_and_b32 v142, 0xffff0000, v142
    v_lshlrev_b32 v211, 16, v143
    v_and_b32 v143, 0xffff0000, v143
    v_lshlrev_b32 v212, 16, v144
    v_and_b32 v144, 0xffff0000, v144
    v_lshlrev_b32 v213, 16, v145
    v_and_b32 v145, 0xffff0000, v145
    v_lshlrev_b32 v214, 16, v146
    v_and_b32 v146, 0xffff0000, v146
    v_lshlrev_b32_e64 v215, 16, v147
    v_and_b32 v147, 0xffff0000, v147
    v_pk_mul_f32 v[240:241], v[240:241], v[208:209]
    v_pk_mul_f32 v[242:243], v[242:243], v[140:141]
    v_pk_mul_f32 v[244:245], v[244:245], v[210:211]
    v_pk_mul_f32 v[246:247], v[246:247], v[142:143]
    v_pk_mul_f32 v[248:249], v[248:249], v[212:213]
    v_pk_mul_f32 v[250:251], v[250:251], v[144:145]
    v_pk_mul_f32 v[252:253], v[252:253], v[214:215]
    v_pk_mul_f32 v[254:255], v[254:255], v[146:147]
    v_cvt_pk_bf16_f32 v224, v252, v248
    v_cvt_pk_bf16_f32 v225, v244, v240
    v_cvt_pk_bf16_f32 v226, v254, v250
    v_cvt_pk_bf16_f32 v227, v246, v242
    v_cvt_pk_bf16_f32 v228, v253, v249
    v_cvt_pk_bf16_f32 v229, v245, v241
    v_cvt_pk_bf16_f32 v230, v255, v251
    v_cvt_pk_bf16_f32 v231, v247, v243
    ds_write_b64 v203, v[224:225] offset:8192
    ds_write_b64 v203, v[226:227] offset:8320
    ds_write_b64 v203, v[228:229] offset:8448
    ds_write_b64 v203, v[230:231] offset:8576
    s_mul_i32 s84, s57, 24
    s_sub_u32 s78, s58, 28
    s_mul_i32 s78, s78, 6
    s_add_u32 s84, s84, s78
    s_add_u32 s84, s84, 448
    s_add_u32 s84, s84, s3
    s_mul_i32 s86, s3, 21248
    s_lshl_b32 s85, s84, 12
    s_add_u32 s44, s12, s85
    s_addc_u32 s45, s13, 0
    s_mov_b32 s46, 4096
    s_mov_b32 s47, 0x20000
    s_add_u32 s88, s85, 1048576
    v_lshlrev_b32_e64 v1, 4, v0
    buffer_load_dwordx4 v[32:35], v1, s[44:47], 0 offen offset:0 nt
    buffer_load_dwordx4 v[36:39], v1, s[44:47], 0 offen offset:1024 nt
    buffer_load_dwordx4 v[40:43], v1, s[44:47], 0 offen offset:2048 nt
    buffer_load_dwordx4 v[44:47], v1, s[44:47], 0 offen offset:3072 nt
    s_lshl_b32 s78, s57, 8
    s_lshl_b32 s79, s58, 3
    s_add_u32 s78, s78, s79
    s_lshl_b32 s79, s3, 1
    s_add_u32 s78, s78, s79
    v_lshrrev_b32 v196, 5, v0
    v_add_u32 v196, s78, v196
    v_and_b32 v197, 31, v0
    v_lshlrev_b32 v197, 3, v197
    v_mad_u32_u24 v197, v196, s73, v197
    v_lshlrev_b32 v196, 3, v196
    buffer_load_dwordx2 v[186:187], v197, s[32:35], 0 offen offset:0
    buffer_load_dwordx2 v[188:189], v197, s[32:35], 0 offen offset:256
    buffer_load_dwordx2 v[190:191], v197, s[32:35], 0 offen offset:512
    buffer_load_dwordx2 v[192:193], v197, s[32:35], 0 offen offset:768
    buffer_load_dwordx2 v[194:195], v197, s[32:35], 0 offen offset:1024
    s_mov_b32 s52, s22
    s_mov_b32 s53, s23
    s_mov_b32 s54, 2211840
    s_mov_b32 s55, 0x20000
    s_lshl_b32 s81, s3, 10
    s_add_u32 m0, s81, 114688
    s_nop 0
    buffer_load_dwordx4 v80, s[52:55], 0 offen nt lds
    s_add_u32 m0, s81, 118784
    s_nop 0
    buffer_load_dwordx4 v81, s[52:55], 0 offen nt lds
    s_add_u32 m0, s81, 122880
    s_nop 0
    buffer_load_dwordx4 v82, s[52:55], 0 offen nt lds
    v_min_u32 v29, ((DONE-I_LATE+511)/512)-1, v0
    s_mul_i32 s80, s3, ((DONE-I_LATE+511)/512)
    v_add_u32 v29, s80, v29
    v_lshlrev_b32 v29, 7, v29
    s_getpc_b64 s[80:81]
CT_20:
    v_add_u32 v29, I_LATE-CT_20, v29
    s_mov_b32 s82, CODE_END-CT_20
    s_mov_b32 s83, 0x20000
    buffer_load_dword v29, v29, s[80:83], 0 offen
    s_and_b32 s77, s58, 7
    s_lshl_b32 s78, s57, 2
    s_lshr_b32 s79, s58, 3
    s_add_u32 s78, s78, s79
    s_mul_i32 s77, s77, 54
    s_add_u32 s77, s77, s78
    s_mul_i32 s77, s77, 5120
    s_add_u32 s77, s77, 4194304
    v_lshrrev_b32 v24, 4, v0
    v_bfe_u32 v25, v0, 2, 2
    v_lshl_add_u32 v24, v24, 2, v25
    v_mul_u32_u24 v24, 160, v24
    v_and_b32 v25, 3, v0
    s_add_u32 s79, s3, 0
    s_cmp_ge_u32 s79, 5
    s_cselect_b32 s80, 1, 0
    s_mul_i32 s81, s80, 5
    s_sub_u32 s79, s79, s81
    s_mul_i32 s81, s80, 163840
    s_add_u32 s81, s81, s77
    s_lshl_b32 s82, s79, 10
    s_add_u32 s81, s81, s82
    s_cmp_ge_u32 s78, 22
    s_cselect_b32 s82, s80, 0
    s_cmp_ge_u32 s79, 5
    s_cselect_b32 s82, 1, s82
    s_cmp_lg_u32 s82, 0
    s_cselect_b32 s74, 17563648, s81
    s_min_u32 s79, s79, 4
    s_and_b32 s82, s79, 1
    s_lshl_b32 s82, s82, 3
    s_lshr_b32 s83, s79, 1
    s_lshl_b32 s83, s83, 6
    s_add_u32 s82, s82, s83
    s_mul_i32 s83, s80, 5120
    s_add_u32 s82, s82, s83
    s_add_u32 s82, s82, 114688
    s_cmp_eq_u32 s79, 4
    s_cselect_b32 s83, 3, 4
    v_lshlrev_b32 v200, s83, v25
    v_add3_u32 v200, v200, v24, s82
    s_add_u32 s79, s3, 4
    s_cmp_ge_u32 s79, 5
    s_cselect_b32 s80, 1, 0
    s_mul_i32 s81, s80, 5
    s_sub_u32 s79, s79, s81
    s_mul_i32 s81, s80, 163840
    s_add_u32 s81, s81, s77
    s_lshl_b32 s82, s79, 10
    s_add_u32 s81, s81, s82
    s_cmp_ge_u32 s78, 22
    s_cselect_b32 s82, s80, 0
    s_cmp_ge_u32 s79, 5
    s_cselect_b32 s82, 1, s82
    s_cmp_lg_u32 s82, 0
    s_cselect_b32 s75, 17563648, s81
    s_min_u32 s79, s79, 4
    s_and_b32 s82, s79, 1
    s_lshl_b32 s82, s82, 3
    s_lshr_b32 s83, s79, 1
    s_lshl_b32 s83, s83, 6
    s_add_u32 s82, s82, s83
    s_mul_i32 s83, s80, 5120
    s_add_u32 s82, s82, s83
    s_add_u32 s82, s82, 114688
    s_cmp_eq_u32 s79, 4
    s_cselect_b32 s83, 3, 4
    v_lshlrev_b32 v201, s83, v25
    v_add3_u32 v201, v201, v24, s82
    s_add_u32 s79, s3, 8
    s_cmp_ge_u32 s79, 5
    s_cselect_b32 s80, 1, 0
    s_mul_i32 s81, s80, 5
    s_sub_u32 s79, s79, s81
    s_mul_i32 s81, s80, 163840
    s_add_u32 s81, s81, s77
    s_lshl_b32 s82, s79, 10
    s_add_u32 s81, s81, s82
    s_cmp_ge_u32 s78, 22
    s_cselect_b32 s82, s80, 0
    s_cmp_ge_u32 s79, 5
    s_cselect_b32 s82, 1, s82
    s_cmp_lg_u32 s82, 0
    s_cselect_b32 s76, 17563648, s81
    s_min_u32 s79, s79, 4
    s_and_b32 s82, s79, 1
    s_lshl_b32 s82, s82, 3
    s_lshr_b32 s83, s79, 1
    s_lshl_b32 s83, s83, 6
    s_add_u32 s82, s82, s83
    s_mul_i32 s83, s80, 5120
    s_add_u32 s82, s82, s83
    s_add_u32 s82, s82, 114688
    s_cmp_eq_u32 s79, 4
    s_cselect_b32 s83, 3, 4
    v_lshlrev_b32 v202, s83, v25
    v_add3_u32 v202, v202, v24, s82
    s_waitcnt vmcnt(17)
    v_lshlrev_b32 v224, 16, v178
    v_and_b32 v228, 0xffff0000, v178
    v_lshlrev_b32 v225, 16, v182
    v_and_b32 v229, 0xffff0000, v182
    v_lshlrev_b32 v226, 16, v180
    v_and_b32 v230, 0xffff0000, v180
    v_lshlrev_b32 v227, 16, v184
    v_and_b32 v231, 0xffff0000, v184
    v_lshlrev_b32 v232, 16, v179
    v_and_b32 v236, 0xffff0000, v179
    v_lshlrev_b32 v233, 16, v183
    v_and_b32 v237, 0xffff0000, v183
    v_lshlrev_b32 v234, 16, v181
    v_and_b32 v238, 0xffff0000, v181
    v_lshlrev_b32 v235, 16, v185
    v_and_b32 v239, 0xffff0000, v185
    v_lshlrev_b32 v208, 16, v156
    v_and_b32 v156, 0xffff0000, v156
    v_lshlrev_b32 v209, 16, v157
    v_and_b32 v157, 0xffff0000, v157
    v_lshlrev_b32 v210, 16, v158
    v_and_b32 v158, 0xffff0000, v158
    v_lshlrev_b32 v211, 16, v159
    v_and_b32 v159, 0xffff0000, v159
    v_lshlrev_b32 v212, 16, v160
    v_and_b32 v160, 0xffff0000, v160
    v_lshlrev_b32 v213, 16, v161
    v_and_b32 v161, 0xffff0000, v161
    v_lshlrev_b32 v214, 16, v162
    v_and_b32 v162, 0xffff0000, v162
    v_lshlrev_b32 v215, 16, v163
    v_and_b32 v163, 0xffff0000, v163
    v_lshlrev_b32 v216, 16, v164
    v_and_b32 v164, 0xffff0000, v164
    v_lshlrev_b32 v217, 16, v165
    v_and_b32 v165, 0xffff0000, v165
    v_lshlrev_b32 v218, 16, v166
    v_and_b32 v166, 0xffff0000, v166
    v_lshlrev_b32 v219, 16, v167
    v_and_b32 v167, 0xffff0000, v167
    v_lshlrev_b32 v220, 16, v168
    v_and_b32 v168, 0xffff0000, v168
    v_lshlrev_b32_e64 v221, 16, v169
    v_and_b32 v169, 0xffff0000, v169
    v_pk_mul_f32 v[240:241], v[214:215], v[224:225]
    v_pk_mul_f32 v[242:243], v[162:163], v[226:227]
    v_pk_mul_f32 v[244:245], v[216:217], v[224:225]
    v_pk_mul_f32 v[246:247], v[164:165], v[226:227]
    v_pk_mul_f32 v[248:249], v[218:219], v[224:225]
    v_pk_mul_f32 v[250:251], v[166:167], v[226:227]
    v_pk_mul_f32 v[252:253], v[220:221], v[224:225]
    v_pk_mul_f32 v[254:255], v[168:169], v[226:227]
    v_pk_fma_f32 v[240:241], v[212:213], v[228:229], v[240:241]
    v_pk_fma_f32 v[242:243], v[160:161], v[230:231], v[242:243]
    v_pk_fma_f32 v[244:245], v[214:215], v[228:229], v[244:245]
    v_pk_fma_f32 v[246:247], v[162:163], v[230:231], v[246:247]
    v_pk_fma_f32 v[248:249], v[216:217], v[228:229], v[248:249]
    v_pk_fma_f32 v[250:251], v[164:165], v[230:231], v[250:251]
    v_pk_fma_f32 v[252:253], v[218:219], v[228:229], v[252:253]
    v_pk_fma_f32 v[254:255], v[166:167], v[230:231], v[254:255]
    v_pk_fma_f32 v[240:241], v[210:211], v[232:233], v[240:241]
    v_pk_fma_f32 v[242:243], v[158:159], v[234:235], v[242:243]
    v_pk_fma_f32 v[244:245], v[212:213], v[232:233], v[244:245]
    v_pk_fma_f32 v[246:247], v[160:161], v[234:235], v[246:247]
    v_pk_fma_f32 v[248:249], v[214:215], v[232:233], v[248:249]
    v_pk_fma_f32 v[250:251], v[162:163], v[234:235], v[250:251]
    v_pk_fma_f32 v[252:253], v[216:217], v[232:233], v[252:253]
    v_pk_fma_f32 v[254:255], v[164:165], v[234:235], v[254:255]
    v_pk_fma_f32 v[240:241], v[208:209], v[236:237], v[240:241]
    v_pk_fma_f32 v[242:243], v[156:157], v[238:239], v[242:243]
    v_pk_fma_f32 v[244:245], v[210:211], v[236:237], v[244:245]
    v_pk_fma_f32 v[246:247], v[158:159], v[238:239], v[246:247]
    v_pk_fma_f32 v[248:249], v[212:213], v[236:237], v[248:249]
    v_pk_fma_f32 v[250:251], v[160:161], v[238:239], v[250:251]
    v_pk_fma_f32 v[252:253], v[214:215], v[236:237], v[252:253]
    v_pk_fma_f32 v[254:255], v[162:163], v[238:239], v[254:255]
    s_waitcnt vmcnt(13)
    v_lshlrev_b32 v208, 16, v170
    v_and_b32 v170, 0xffff0000, v170
    v_lshlrev_b32 v209, 16, v171
    v_and_b32 v171, 0xffff0000, v171
    v_lshlrev_b32 v210, 16, v172
    v_and_b32 v172, 0xffff0000, v172
    v_lshlrev_b32 v211, 16, v173
    v_and_b32 v173, 0xffff0000, v173
    v_lshlrev_b32 v212, 16, v174
    v_and_b32 v174, 0xffff0000, v174
    v_lshlrev_b32 v213, 16, v175
    v_and_b32 v175, 0xffff0000, v175
    v_lshlrev_b32 v214, 16, v176
    v_and_b32 v176, 0xffff0000, v176
    v_lshlrev_b32_e64 v215, 16, v177
    v_and_b32 v177, 0xffff0000, v177
    v_pk_mul_f32 v[240:241], v[240:241], v[208:209]
    v_pk_mul_f32 v[242:243], v[242:243], v[170:171]
    v_pk_mul_f32 v[244:245], v[244:245], v[210:211]
    v_pk_mul_f32 v[246:247], v[246:247], v[172:173]
    v_pk_mul_f32 v[248:249], v[248:249], v[212:213]
    v_pk_mul_f32 v[250:251], v[250:251], v[174:175]
    v_pk_mul_f32 v[252:253], v[252:253], v[214:215]
    v_pk_mul_f32 v[254:255], v[254:255], v[176:177]
    v_cvt_pk_bf16_f32 v224, v252, v248
    v_cvt_pk_bf16_f32 v225, v244, v240
PAGE7:
    s_cbranch_execz PAGE8
    s_nop 0
    v_cvt_pk_bf16_f32 v226, v254, v250
    v_cvt_pk_bf16_f32 v227, v246, v242
    v_cvt_pk_bf16_f32 v228, v253, v249
    v_cvt_pk_bf16_f32 v229, v245, v241
    v_cvt_pk_bf16_f32 v230, v255, v251
    v_cvt_pk_bf16_f32 v231, v247, v243
    ds_write_b64 v203, v[224:225] offset:16384
    ds_write_b64 v203, v[226:227] offset:16512
    ds_write_b64 v203, v[228:229] offset:16640
    ds_write_b64 v203, v[230:231] offset:16768
    s_waitcnt lgkmcnt(0)
    s_barrier
    ds_read_b128 v[208:211], v204 offset:0
    ds_read_b128 v[212:215], v204 offset:4096
    ds_read_b128 v[216:219], v204 offset:8192
    ds_read_b128 v[220:223], v204 offset:12288
    ds_read_b128 v[224:227], v204 offset:16384
    ds_read_b128 v[228:231], v204 offset:20480
    s_waitcnt lgkmcnt(4)
    buffer_store_dwordx4 v[208:211], v205, s[36:39], s59 offen sc1
    buffer_store_dwordx4 v[212:215], v206, s[36:39], s59 offen sc1
    s_add_u32 s59, s59, 262144
    s_waitcnt lgkmcnt(2)
    buffer_store_dwordx4 v[216:219], v205, s[36:39], s59 offen sc1
    buffer_store_dwordx4 v[220:223], v206, s[36:39], s59 offen sc1
    s_add_u32 s59, s59, 262144
    s_waitcnt lgkmcnt(0)
    buffer_store_dwordx4 v[224:227], v205, s[36:39], s59 offen sc1
    buffer_store_dwordx4 v[228:231], v206, s[36:39], s59 offen sc1
    s_add_u32 s59, s59, 262144
    s_waitcnt vmcnt(10)
    s_mov_b32 s78, 0x3f803f80
    v_mov_b32_e64 v232, 0
    v_mov_b32 v233, 0
    v_dot2c_f32_bf16 v232, s78, v186
    v_dot2c_f32_bf16 v233, v186, v186
    v_dot2c_f32_bf16 v232, s78, v187
    v_dot2c_f32_bf16 v233, v187, v187
    v_dot2c_f32_bf16 v232, s78, v188
    v_dot2c_f32_bf16 v233, v188, v188
    v_dot2c_f32_bf16 v232, s78, v189
    v_dot2c_f32_bf16 v233, v189, v189
    v_dot2c_f32_bf16 v232, s78, v190
    v_dot2c_f32_bf16 v233, v190, v190
    v_dot2c_f32_bf16 v232, s78, v191
    v_dot2c_f32_bf16 v233, v191, v191
    v_dot2c_f32_bf16 v232, s78, v192
    v_dot2c_f32_bf16 v233, v192, v192
    v_dot2c_f32_bf16 v232, s78, v193
    v_dot2c_f32_bf16 v233, v193, v193
    v_dot2c_f32_bf16 v232, s78, v194
    v_dot2c_f32_bf16 v233, v194, v194
    v_dot2c_f32_bf16 v232, s78, v195
    v_dot2c_f32_bf16 v233, v195, v195
    s_nop 1
    v_add_f32_dpp v232, v232, v232 row_ror:8 row_mask:0xf bank_mask:0xf
    v_add_f32_dpp v233, v233, v233 row_ror:8 row_mask:0xf bank_mask:0xf
    s_nop 1
    v_add_f32_dpp v232, v232, v232 row_ror:4 row_mask:0xf bank_mask:0xf
    v_add_f32_dpp v233, v233, v233 row_ror:4 row_mask:0xf bank_mask:0xf
    s_nop 1
    v_add_f32_dpp v232, v232, v232 row_ror:2 row_mask:0xf bank_mask:0xf
    v_add_f32_dpp v233, v233, v233 row_ror:2 row_mask:0xf bank_mask:0xf
    s_nop 1
    v_add_f32_dpp v232, v232, v232 row_ror:1 row_mask:0xf bank_mask:0xf
    v_add_f32_dpp v233, v233, v233 row_ror:1 row_mask:0xf bank_mask:0xf
    s_nop 1
    v_add_f32_dpp v232, v232, v232 row_bcast:15 row_mask:0xa bank_mask:0xf
    v_add_f32_dpp v233, v233, v233 row_bcast:15 row_mask:0xa bank_mask:0xf
    s_nop 0
    v_mul_f32 v234, 0x3acccccd, v232
    v_mul_f32 v233, 0x3acccccd, v233
    v_fma_f32 v233, -v234, v234, v233
    v_max_f32 v233, 0, v233
    v_add_f32 v233, 0x3727c5ac, v233
    v_rsq_f32_e64 v235, v233
    s_mov_b32 s78, 65536
    s_mov_b32 exec_lo, 0x10000
    s_mov_b32 exec_hi, 0x10000
    buffer_store_dwordx2 v[234:235], v196, s[36:39], s78 offen sc1
    s_mov_b64 exec, -1
    s_waitcnt vmcnt(1)
    s_barrier
    s_mov_b32 exec_lo, 2
    s_mov_b32 exec_hi, 0
    buffer_store_dword v31, v30, s[36:39], 0 offen sc1
    s_mov_b64 exec, -1
    ds_read_b64_tr_b16 v[236:237], v200 offset:0
    ds_read_b64_tr_b16 v[238:239], v200 offset:2560
    ds_read_b64_tr_b16 v[240:241], v201 offset:0
    ds_read_b64_tr_b16 v[242:243], v201 offset:2560
    ds_read_b64_tr_b16 v[244:245], v202 offset:0
    ds_read_b64_tr_b16 v[246:247], v202 offset:2560
    v_lshlrev_b32 v26, 4, v0
    s_waitcnt lgkmcnt(0)
    buffer_store_dwordx4 v[236:239], v26, s[36:39], s74 offen sc1
    buffer_store_dwordx4 v[240:243], v26, s[36:39], s75 offen sc1
    buffer_store_dwordx4 v[244:247], v26, s[36:39], s76 offen sc1
    s_waitcnt vmcnt(20)
I_LATE:
    s_nop 0
    v_mov_b32_dpp v51, v36 wave_rol:1 row_mask:0xf bank_mask:0xf
    v_mov_b32_dpp v64, v37 wave_rol:1 row_mask:0xf bank_mask:0xf
    v_mov_b32_dpp v55, v40 wave_rol:1 row_mask:0xf bank_mask:0xf
    v_mov_b32_dpp v65, v41 wave_rol:1 row_mask:0xf bank_mask:0xf
    v_mov_b32_dpp v59, v44 wave_rol:1 row_mask:0xf bank_mask:0xf
    v_mov_b32_dpp v66, v45 wave_rol:1 row_mask:0xf bank_mask:0xf
    v_mov_b32 v48, v33
    v_mov_b32 v49, v34
    v_mov_b32 v50, v35
    v_mov_b32 v52, v37
    v_mov_b32 v53, v38
    v_mov_b32 v54, v39
    v_mov_b32 v56, v41
    v_mov_b32 v57, v42
    v_mov_b32 v58, v43
    v_mov_b32 v60, v45
    v_mov_b32 v61, v46
    v_mov_b32 v62, v47
    v_mov_b32_dpp v51, v32 wave_shl:1 row_mask:0xf bank_mask:0xf
    v_mov_b32_dpp v64, v33 wave_shl:1 row_mask:0xf bank_mask:0xf
    v_mov_b32_dpp v55, v36 wave_shl:1 row_mask:0xf bank_mask:0xf
    v_mov_b32_dpp v65, v37 wave_shl:1 row_mask:0xf bank_mask:0xf
    v_mov_b32_dpp v59, v40 wave_shl:1 row_mask:0xf bank_mask:0xf
    v_mov_b32_dpp v66, v41 wave_shl:1 row_mask:0xf bank_mask:0xf
    v_mov_b32_dpp v63, v44 wave_shl:1 row_mask:0xf bank_mask:0xf bound_ctrl:0
    v_mov_b32_dpp v67, v45 wave_shl:1 row_mask:0xf bank_mask:0xf bound_ctrl:0
    s_nop 1
    v_lshlrev_b32 v1, 4, v0
    v_add_u32 v5, s86, v1
    v_mov_b32 v20, 0
    v_mov_b32 v21, 0
    v_mov_b32 v22, 0
    v_mov_b32 v23, 0
    v_lshrrev_b32 v4, 1, v0
    v_mul_u32_u24 v4, 4160, v4
    v_and_b32 v6, 1, v0
    v_lshl_add_u32 v4, v6, 4, v4
    v_add_u32 v4, s86, v4
    s_mov_b32 exec_lo, 0xff
    s_mov_b32 exec_hi, 0
    ds_write_b128 v4, v[20:23]
    s_mov_b32 exec_lo, -1
    ds_write_b128 v5, v[20:23] offset:16640
    v_lshlrev_b32 v12, 16, v32
    v_alignbit_b32 v13, v48, v32, 16
    s_mov_b32 exec_lo, 1
    ds_write_b32 v5, v12 offset:4188
    ds_write_b32 v5, v32 offset:8348
    ds_write_b64 v5, v[12:13] offset:12504
    s_mov_b64 exec, -1
    s_nop 0
    v_alignbit_b32 v96, v48, v32, 16
    v_alignbit_b32 v100, v49, v48, 16
    v_alignbit_b32 v97, v49, v33, 16
    v_alignbit_b32 v101, v50, v49, 16
    v_alignbit_b32 v98, v50, v34, 16
    v_alignbit_b32 v102, v51, v50, 16
    v_alignbit_b32 v99, v51, v35, 16
    v_alignbit_b32 v103, v64, v51, 16
    ds_write_b128 v5, v[32:35] offset:32
    ds_write_b128 v5, v[96:99] offset:4192
    ds_write_b128 v5, v[48:51] offset:8352
    ds_write_b128 v5, v[100:103] offset:12512
    v_alignbit_b32 v104, v52, v36, 16
    v_alignbit_b32 v108, v53, v52, 16
    v_alignbit_b32 v105, v53, v37, 16
    v_alignbit_b32 v109, v54, v53, 16
    v_alignbit_b32 v106, v54, v38, 16
    v_alignbit_b32 v110, v55, v54, 16
    v_alignbit_b32 v107, v55, v39, 16
    v_alignbit_b32 v111, v65, v55, 16
    ds_write_b128 v5, v[36:39] offset:1056
    ds_write_b128 v5, v[104:107] offset:5216
    ds_write_b128 v5, v[52:55] offset:9376
    ds_write_b128 v5, v[108:111] offset:13536
    v_and_b32 v28, 31, v0
    v_lshlrev_b32 v28, 6, v28
    v_add_u32 v28, 145408, v28
    buffer_load_dword v25, v28, s[36:39], 0 offen sc1
    v_alignbit_b32 v112, v56, v40, 16
    v_alignbit_b32 v116, v57, v56, 16
    v_alignbit_b32 v113, v57, v41, 16
    v_alignbit_b32 v117, v58, v57, 16
    v_alignbit_b32 v114, v58, v42, 16
    v_alignbit_b32 v118, v59, v58, 16
    v_alignbit_b32 v115, v59, v43, 16
    v_alignbit_b32 v119, v66, v59, 16
    ds_write_b128 v5, v[40:43] offset:2080
    ds_write_b128 v5, v[112:115] offset:6240
    ds_write_b128 v5, v[56:59] offset:10400
    ds_write_b128 v5, v[116:119] offset:14560
    v_alignbit_b32 v120, v60, v44, 16
    v_alignbit_b32 v124, v61, v60, 16
    v_alignbit_b32 v121, v61, v45, 16
    v_alignbit_b32 v125, v62, v61, 16
    v_alignbit_b32 v122, v62, v46, 16
    v_alignbit_b32 v126, v63, v62, 16
    v_alignbit_b32 v123, v63, v47, 16
    v_alignbit_b32 v127, v67, v63, 16
    ds_write_b128 v5, v[44:47] offset:3104
    ds_write_b128 v5, v[120:123] offset:7264
    ds_write_b128 v5, v[60:63] offset:11424
    ds_write_b128 v5, v[124:127] offset:15584
    s_lshl_b32 s78, s84, 1
    s_and_b32 s78, s78, -4
    s_load_dword s77, s[14:15], s78
    s_waitcnt vmcnt(1)
    s_barrier
    s_mov_b32 exec_lo, 5
    s_mov_b32 exec_hi, 0
    buffer_store_dword v31, v30, s[36:39], 0 offen sc1
    s_mov_b64 exec, -1
    s_waitcnt vmcnt(1)
    v_cmp_ne_u32 vcc, s56, v25
    s_mov_b64 s[82:83], vcc
    s_cmp_eq_u64 s[82:83], 0
    s_cbranch_scc0 FAI_RETRY_21
FAI_DONE_22:
    v_lshlrev_b32_e64 v1, 4, v0
    buffer_load_dwordx4 v[80:83], v1, s[36:39], s88 offen offset:0 sc1
    buffer_load_dwordx4 v[84:87], v1, s[36:39], s88 offen offset:1024 sc1
    buffer_load_dwordx4 v[88:91], v1, s[36:39], s88 offen offset:2048 sc1
    buffer_load_dwordx4 v[92:95], v1, s[36:39], s88 offen offset:3072 sc1
    s_lshr_b32 s78, s57, 1
    s_lshl_b32 s78, s78, 3
    s_and_b32 s79, s58, 7
    s_add_u32 s53, s78, s79
    s_mul_i32 s28, s79, 7
    s_and_b32 s78, s57, 1
    s_lshl_b32 s78, s78, 2
    s_lshr_b32 s79, s58, 3
    s_add_u32 s54, s78, s79
    s_mul_i32 s79, s79, 14
    s_add_u32 s28, s28, s79
    s_lshr_b32 s28, s28, 2
    s_cmp_ge_u32 s28, 14
    s_cselect_b32 s79, 14, 0
    s_sub_u32 s28, s28, s79
    s_mov_b32 s28, 0
    s_mul_i32 s55, s3, 14
    s_sub_u32 s79, s3, 1
    s_cmp_ge_u32 s3, 2
    s_cselect_b32 s79, s79, 0
    s_sub_u32 s55, s55, s79
    s_mul_i32 s79, s54, 54
    s_add_u32 s79, s79, s55
    s_mul_i32 s79, s79, 5120
    s_add_u32 s79, s79, 4194304
    s_add_u32 s16, s79, 71680
    s_mul_i32 s52, s28, 5120
    s_add_u32 s52, s52, s79
    v_lshlrev_b32 v14, 4, v0
    v_add_u32 v15, 4096, v14
    s_mov_b32 s40, s24
    s_mov_b32 s41, s25
    s_mov_b32 s42, 1280
    s_mov_b32 s43, 0x20000
    v_lshrrev_b32 v16, 4, v0
    s_mul_i32 s78, s54, 160
    v_lshlrev_b32 v17, 4, v16
    v_lshlrev_b32 v18, 3, v16
    buffer_load_dwordx4 a[240:243], v17, s[40:43], s78 offen
    buffer_load_dwordx4 a[244:247], v17, s[40:43], s78 offen offset:64
    buffer_load_dwordx2 a[248:249], v18, s[40:43], s78 offen offset:128
    s_mov_b32 s68, 7
    v_and_b32 v27, 31, v0
    v_lshlrev_b32 v27, 6, v27
    s_lshl_b32 s73, s68, 11
    s_add_u32 s73, s73, 131072
    s_lshl_b32 s78, s54, 11
    s_add_u32 s78, s78, 163840
    v_mov_b32 v16, s73
    v_mov_b32 v18, s78
    v_and_b32 v19, 32, v0
    v_cmp_eq_u32 vcc, 0, v19
    s_nop 1
    v_cndmask_b32 v16, v18, v16, vcc
    v_add_u32 v27, v16, v27
    s_waitcnt lgkmcnt(0)
    v_and_b32 v6, 15, v0
    v_lshrrev_b32 v7, 4, v0
    v_add_u32 v8, 1, v6
    v_and_b32 v9, 3, v8
    v_and_b32 v8, 28, v8
    v_mul_u32_u24 v9, 4160, v9
    v_lshl_add_u32 v9, v8, 1, v9
    v_lshl_add_u32 v9, v7, 4, v9
    v_add_u32 v2, s86, v9
    v_lshlrev_b32 v8, 1, v6
    v_sub_u32 v8, v8, v7
    v_lshlrev_b32 v8, 4, v8
    v_add_u32 v8, 16720, v8
    v_add_u32 v3, s86, v8
    v_sub_u32 v8, 15, v6
    v_lshrrev_b32_e64 v9, 3, v8
    v_cmp_eq_u32 s[80:81], v9, v7
    v_bfe_u32 v9, v8, 1, 2
    v_and_b32 v10, 1, v8
    v_lshlrev_b32 v10, 4, v10
    s_and_b32 s78, s84, 1
    s_lshl_b32 s78, s78, 4
    s_lshr_b32 s77, s77, s78
    s_and_b32 s77, s77, 0xffff
    v_mov_b32 v11, s77
    v_lshlrev_b32 v11, v10, v11
    v_cndmask_b32 v11, 0, v11, s[80:81]
    v_cmp_eq_u32 vcc, 0, v9
    s_nop 1
    v_cndmask_b32 v192, 0, v11, vcc
    v_cmp_eq_u32 vcc, 1, v9
    s_nop 1
    v_cndmask_b32 v193, 0, v11, vcc
    v_cmp_eq_u32 vcc, 2, v9
    s_nop 1
    v_cndmask_b32 v194, 0, v11, vcc
    v_cmp_eq_u32 vcc, 3, v9
    s_nop 1
    v_cndmask_b32 v195, 0, v11, vcc
    s_waitcnt vmcnt(3)
    v_lshlrev_b32 v1, 4, v0
    v_add_u32 v5, s86, v1
    ds_write_b128 v5, v[80:83] offset:17152
    ds_write_b128 v5, v[84:87] offset:18176
    ds_write_b128 v5, v[88:91] offset:19200
    ds_write_b128 v5, v[92:95] offset:20224
    s_add_u32 s18, s85, 7340032
    s_sub_u32 s84, s84, s3
    s_lshl_b32 s48, s84, 5
    s_add_u32 s48, s48, 262144
    s_cmp_eq_u32 s3, 0
    s_cselect_b32 s48, s48, 17563648
    s_mov_b32 s50, 3
    s_add_u32 s84, s84, 4
    s_lshr_b32 s78, s3, 1
    s_add_u32 s84, s84, s78
    s_and_b32 s87, s3, 1
    s_mul_i32 s86, s78, 21248
    s_lshl_b32 s85, s84, 12
    s_add_u32 s44, s12, s85
    s_addc_u32 s45, s13, 0
    s_mov_b32 s46, 4096
    s_mov_b32 s47, 0x20000
    s_lshl_b32 s89, s87, 11
    s_add_u32 s88, s85, s89
    s_add_u32 s88, s88, 1048576
    s_lshl_b32 s78, s84, 1
    s_and_b32 s78, s78, -4
    s_load_dword s77, s[14:15], s78
    s_waitcnt lgkmcnt(0)
    ds_read_b128 v[64:67], v3 offset:448
    ds_read_b64 v[32:33], v2 offset:0
    ds_read_b64 v[34:35], v2 offset:8
    ds_read_b128 v[68:71], v3 offset:960
    ds_read_b64 v[36:37], v2 offset:512
    ds_read_b64 v[38:39], v2 offset:520
    ds_read_b128 v[72:75], v3 offset:1472
    ds_read_b64 v[40:41], v2 offset:1024
    ds_read_b64 v[42:43], v2 offset:1032
    ds_read_b128 v[76:79], v3 offset:1984
    ds_read_b64 v[44:45], v2 offset:1536
    ds_read_b64 v[46:47], v2 offset:1544
    ds_read_b128 v[80:83], v3 offset:2496
    ds_read_b64 v[48:49], v2 offset:2048
    ds_read_b64 v[50:51], v2 offset:2056
    ds_read_b128 v[84:87], v3 offset:3008
    ds_read_b64 v[52:53], v2 offset:2560
    ds_read_b64 v[54:55], v2 offset:2568
    ds_read_b128 v[88:91], v3 offset:3520
    ds_read_b64 v[56:57], v2 offset:3072
    ds_read_b64 v[58:59], v2 offset:3080
    ds_read_b128 v[92:95], v3 offset:4032
    ds_read_b64 v[60:61], v2 offset:3584
    ds_read_b64 v[62:63], v2 offset:3592
    s_waitcnt lgkmcnt(15)
    v_mfma_f32_16x16x32_bf16 v[160:163], v[192:195], v[64:67], 0
    ds_read_b128 v[128:131], v3 offset:384
    v_mfma_f32_16x16x32_bf16 v[164:167], v[192:195], v[68:71], 0
    ds_read_b64 v[96:97], v2 offset:64
    v_mfma_f32_16x16x32_bf16 v[168:171], v[192:195], v[72:75], 0
    ds_read_b64 v[98:99], v2 offset:72
    s_waitcnt lgkmcnt(15)
    v_mfma_f32_16x16x32_bf16 v[172:175], v[192:195], v[76:79], 0
    ds_read_b128 v[132:135], v3 offset:896
    s_waitcnt lgkmcnt(15)
    v_mfma_f32_16x16x32_bf16 v[176:179], v[192:195], v[80:83], 0
    ds_read_b64 v[100:101], v2 offset:576
    buffer_load_dwordx4 v[200:203], v14, s[44:47], s89 offen offset:0 nt
    s_waitcnt lgkmcnt(13)
    v_mfma_f32_16x16x32_bf16 v[180:183], v[192:195], v[84:87], 0
    ds_read_b64 v[102:103], v2 offset:584
    s_waitcnt lgkmcnt(11)
    v_mfma_f32_16x16x32_bf16 v[184:187], v[192:195], v[88:91], 0
    ds_read_b128 v[136:139], v3 offset:1408
    s_waitcnt lgkmcnt(9)
    v_mfma_f32_16x16x32_bf16 v[188:191], v[192:195], v[92:95], 0
    ds_read_b64 v[104:105], v2 offset:1088
    s_waitcnt lgkmcnt(8)
    s_nop 0
    v_mfma_f32_16x16x32_bf16 v[160:163], v[32:35], v[64:67], v[160:163]
    ds_read_b64 v[106:107], v2 offset:1096
    v_mfma_f32_16x16x32_bf16 v[164:167], v[32:35], v[68:71], v[164:167]
    ds_read_b128 v[140:143], v3 offset:1920
    v_mfma_f32_16x16x32_bf16 v[168:171], v[32:35], v[72:75], v[168:171]
    ds_read_b64 v[108:109], v2 offset:1600
    v_mfma_f32_16x16x32_bf16 v[172:175], v[32:35], v[76:79], v[172:175]
    ds_read_b64 v[110:111], v2 offset:1608
    v_mfma_f32_16x16x32_bf16 v[176:179], v[32:35], v[80:83], v[176:179]
    ds_read_b128 v[144:147], v3 offset:2432
    v_mfma_f32_16x16x32_bf16 v[180:183], v[32:35], v[84:87], v[180:183]
    ds_read_b64 v[112:113], v2 offset:2112
    buffer_load_dwordx4 v[204:207], v14, s[44:47], s89 offen offset:1024 nt
    v_mfma_f32_16x16x32_bf16 v[184:187], v[32:35], v[88:91], v[184:187]
    ds_read_b64 v[114:115], v2 offset:2120
    v_mfma_f32_16x16x32_bf16 v[188:191], v[32:35], v[92:95], v[188:191]
    ds_read_b128 v[148:151], v3 offset:2944
    v_mfma_f32_16x16x32_bf16 v[164:167], v[36:39], v[64:67], v[164:167]
    ds_read_b64 v[116:117], v2 offset:2624
    v_mfma_f32_16x16x32_bf16 v[168:171], v[36:39], v[68:71], v[168:171]
    ds_read_b64 v[118:119], v2 offset:2632
    v_mfma_f32_16x16x32_bf16 v[172:175], v[36:39], v[72:75], v[172:175]
    ds_read_b128 v[152:155], v3 offset:3456
    v_mfma_f32_16x16x32_bf16 v[176:179], v[36:39], v[76:79], v[176:179]
    ds_read_b64 v[120:121], v2 offset:3136
    v_mfma_f32_16x16x32_bf16 v[180:183], v[36:39], v[80:83], v[180:183]
    ds_read_b64 v[122:123], v2 offset:3144
    v_mfma_f32_16x16x32_bf16 v[184:187], v[36:39], v[84:87], v[184:187]
    ds_read_b128 v[156:159], v3 offset:3968
    v_mfma_f32_16x16x32_bf16 v[188:191], v[36:39], v[88:91], v[188:191]
    ds_read_b64 v[124:125], v2 offset:3648
    buffer_load_dwordx2 v[220:221], v14, s[44:47], s89 offen offset:2048 nt
    v_mfma_f32_16x16x32_bf16 v[168:171], v[40:43], v[64:67], v[168:171]
    ds_read_b64 v[126:127], v2 offset:3656
    v_mfma_f32_16x16x32_bf16 v[172:175], v[40:43], v[68:71], v[172:175]
    v_mfma_f32_16x16x32_bf16 v[176:179], v[40:43], v[72:75], v[176:179]
    v_mfma_f32_16x16x32_bf16 v[180:183], v[40:43], v[76:79], v[180:183]
    v_mfma_f32_16x16x32_bf16 v[184:187], v[40:43], v[80:83], v[184:187]
    v_mfma_f32_16x16x32_bf16 v[188:191], v[40:43], v[84:87], v[188:191]
    v_mfma_f32_16x16x32_bf16 v[172:175], v[44:47], v[64:67], v[172:175]
    v_mfma_f32_16x16x32_bf16 v[176:179], v[44:47], v[68:71], v[176:179]
    buffer_load_dwordx4 v[224:227], v14, s[36:39], s88 offen offset:0 sc1
    v_mfma_f32_16x16x32_bf16 v[180:183], v[44:47], v[72:75], v[180:183]
    v_mfma_f32_16x16x32_bf16 v[184:187], v[44:47], v[76:79], v[184:187]
    v_mfma_f32_16x16x32_bf16 v[188:191], v[44:47], v[80:83], v[188:191]
    v_mfma_f32_16x16x32_bf16 v[176:179], v[48:51], v[64:67], v[176:179]
    v_mfma_f32_16x16x32_bf16 v[180:183], v[48:51], v[68:71], v[180:183]
    v_mfma_f32_16x16x32_bf16 v[184:187], v[48:51], v[72:75], v[184:187]
    v_mfma_f32_16x16x32_bf16 v[188:191], v[48:51], v[76:79], v[188:191]
    v_mfma_f32_16x16x32_bf16 v[180:183], v[52:55], v[64:67], v[180:183]
    v_mfma_f32_16x16x32_bf16 v[184:187], v[52:55], v[68:71], v[184:187]
    buffer_load_dwordx4 v[228:231], v14, s[36:39], s88 offen offset:1024 sc1
    v_mfma_f32_16x16x32_bf16 v[188:191], v[52:55], v[72:75], v[188:191]
    v_mfma_f32_16x16x32_bf16 v[184:187], v[56:59], v[64:67], v[184:187]
    v_mfma_f32_16x16x32_bf16 v[188:191], v[56:59], v[68:71], v[188:191]
    v_mfma_f32_16x16x32_bf16 v[188:191], v[60:63], v[64:67], v[188:191]
    s_waitcnt lgkmcnt(0)
    s_nop 0
    v_mfma_f32_16x16x32_bf16 v[160:163], v[96:99], v[128:131], v[160:163]
    ds_read_b128 v[64:67], v3 offset:320
    v_mfma_f32_16x16x32_bf16 v[164:167], v[96:99], v[132:135], v[164:167]
    ds_read_b64 v[32:33], v2 offset:128
    v_mfma_f32_16x16x32_bf16 v[168:171], v[96:99], v[136:139], v[168:171]
    ds_read_b64 v[34:35], v2 offset:136
    v_mfma_f32_16x16x32_bf16 v[172:175], v[96:99], v[140:143], v[172:175]
    ds_read_b128 v[68:71], v3 offset:832
    v_mfma_f32_16x16x32_bf16 v[176:179], v[96:99], v[144:147], v[176:179]
    ds_read_b64 v[36:37], v2 offset:640
    v_mfma_f32_16x16x32_bf16 v[180:183], v[96:99], v[148:151], v[180:183]
    ds_read_b64 v[38:39], v2 offset:648
    v_mfma_f32_16x16x32_bf16 v[184:187], v[96:99], v[152:155], v[184:187]
    ds_read_b128 v[72:75], v3 offset:1344
    v_mfma_f32_16x16x32_bf16 v[188:191], v[96:99], v[156:159], v[188:191]
    ds_read_b64 v[40:41], v2 offset:1152
    v_mfma_f32_16x16x32_bf16 v[164:167], v[100:103], v[128:131], v[164:167]
    ds_read_b64 v[42:43], v2 offset:1160
    v_mfma_f32_16x16x32_bf16 v[168:171], v[100:103], v[132:135], v[168:171]
    ds_read_b128 v[76:79], v3 offset:1856
    v_mfma_f32_16x16x32_bf16 v[172:175], v[100:103], v[136:139], v[172:175]
    ds_read_b64 v[44:45], v2 offset:1664
    v_mfma_f32_16x16x32_bf16 v[176:179], v[100:103], v[140:143], v[176:179]
    ds_read_b64 v[46:47], v2 offset:1672
    v_mfma_f32_16x16x32_bf16 v[180:183], v[100:103], v[144:147], v[180:183]
    ds_read_b128 v[80:83], v3 offset:2368
    v_mfma_f32_16x16x32_bf16 v[184:187], v[100:103], v[148:151], v[184:187]
    ds_read_b64 v[48:49], v2 offset:2176
    v_mfma_f32_16x16x32_bf16 v[188:191], v[100:103], v[152:155], v[188:191]
    ds_read_b64 v[50:51], v2 offset:2184
    v_mfma_f32_16x16x32_bf16 v[168:171], v[104:107], v[128:131], v[168:171]
    ds_read_b128 v[84:87], v3 offset:2880
    v_mfma_f32_16x16x32_bf16 v[172:175], v[104:107], v[132:135], v[172:175]
    ds_read_b64 v[52:53], v2 offset:2688
    v_mfma_f32_16x16x32_bf16 v[176:179], v[104:107], v[136:139], v[176:179]
    ds_read_b64 v[54:55], v2 offset:2696
    v_mfma_f32_16x16x32_bf16 v[180:183], v[104:107], v[140:143], v[180:183]
    ds_read_b128 v[88:91], v3 offset:3392
    v_mfma_f32_16x16x32_bf16 v[184:187], v[104:107], v[144:147], v[184:187]
    ds_read_b64 v[56:57], v2 offset:3200
    v_mfma_f32_16x16x32_bf16 v[188:191], v[104:107], v[148:151], v[188:191]
    ds_read_b64 v[58:59], v2 offset:3208
    v_mfma_f32_16x16x32_bf16 v[172:175], v[108:111], v[128:131], v[172:175]
    ds_read_b128 v[92:95], v3 offset:3904
    v_mfma_f32_16x16x32_bf16 v[176:179], v[108:111], v[132:135], v[176:179]
    ds_read_b64 v[60:61], v2 offset:3712
    v_mfma_f32_16x16x32_bf16 v[180:183], v[108:111], v[136:139], v[180:183]
    ds_read_b64 v[62:63], v2 offset:3720
    v_mfma_f32_16x16x32_bf16 v[184:187], v[108:111], v[140:143], v[184:187]
    v_mfma_f32_16x16x32_bf16 v[188:191], v[108:111], v[144:147], v[188:191]
    v_mfma_f32_16x16x32_bf16 v[176:179], v[112:115], v[128:131], v[176:179]
    v_mfma_f32_16x16x32_bf16 v[180:183], v[112:115], v[132:135], v[180:183]
    v_mfma_f32_16x16x32_bf16 v[184:187], v[112:115], v[136:139], v[184:187]
    v_mfma_f32_16x16x32_bf16 v[188:191], v[112:115], v[140:143], v[188:191]
    v_mfma_f32_16x16x32_bf16 v[180:183], v[116:119], v[128:131], v[180:183]
    v_mfma_f32_16x16x32_bf16 v[184:187], v[116:119], v[132:135], v[184:187]
    v_mfma_f32_16x16x32_bf16 v[188:191], v[116:119], v[136:139], v[188:191]
    v_mfma_f32_16x16x32_bf16 v[184:187], v[120:123], v[128:131], v[184:187]
    v_mfma_f32_16x16x32_bf16 v[188:191], v[120:123], v[132:135], v[188:191]
    v_mfma_f32_16x16x32_bf16 v[188:191], v[124:127], v[128:131], v[188:191]
    s_waitcnt lgkmcnt(0)
    s_nop 0
    v_mfma_f32_16x16x32_bf16 v[160:163], v[32:35], v[64:67], v[160:163]
    ds_read_b128 v[128:131], v3 offset:256
    v_mfma_f32_16x16x32_bf16 v[164:167], v[32:35], v[68:71], v[164:167]
    ds_read_b64 v[96:97], v2 offset:192
    v_mfma_f32_16x16x32_bf16 v[168:171], v[32:35], v[72:75], v[168:171]
    ds_read_b64 v[98:99], v2 offset:200
    v_mfma_f32_16x16x32_bf16 v[172:175], v[32:35], v[76:79], v[172:175]
    ds_read_b128 v[132:135], v3 offset:768
    v_mfma_f32_16x16x32_bf16 v[176:179], v[32:35], v[80:83], v[176:179]
    ds_read_b64 v[100:101], v2 offset:704
    v_mfma_f32_16x16x32_bf16 v[180:183], v[32:35], v[84:87], v[180:183]
    ds_read_b64 v[102:103], v2 offset:712
    v_mfma_f32_16x16x32_bf16 v[184:187], v[32:35], v[88:91], v[184:187]
    ds_read_b128 v[136:139], v3 offset:1280
    v_mfma_f32_16x16x32_bf16 v[188:191], v[32:35], v[92:95], v[188:191]
    ds_read_b64 v[104:105], v2 offset:1216
    v_mfma_f32_16x16x32_bf16 v[164:167], v[36:39], v[64:67], v[164:167]
    ds_read_b64 v[106:107], v2 offset:1224
    v_mfma_f32_16x16x32_bf16 v[168:171], v[36:39], v[68:71], v[168:171]
    ds_read_b128 v[140:143], v3 offset:1792
    v_mfma_f32_16x16x32_bf16 v[172:175], v[36:39], v[72:75], v[172:175]
    ds_read_b64 v[108:109], v2 offset:1728
    v_mfma_f32_16x16x32_bf16 v[176:179], v[36:39], v[76:79], v[176:179]
    ds_read_b64 v[110:111], v2 offset:1736
    v_mfma_f32_16x16x32_bf16 v[180:183], v[36:39], v[80:83], v[180:183]
    ds_read_b128 v[144:147], v3 offset:2304
    v_mfma_f32_16x16x32_bf16 v[184:187], v[36:39], v[84:87], v[184:187]
    ds_read_b64 v[112:113], v2 offset:2240
    v_mfma_f32_16x16x32_bf16 v[188:191], v[36:39], v[88:91], v[188:191]
    ds_read_b64 v[114:115], v2 offset:2248
    v_mfma_f32_16x16x32_bf16 v[168:171], v[40:43], v[64:67], v[168:171]
    ds_read_b128 v[148:151], v3 offset:2816
    v_mfma_f32_16x16x32_bf16 v[172:175], v[40:43], v[68:71], v[172:175]
    ds_read_b64 v[116:117], v2 offset:2752
    v_mfma_f32_16x16x32_bf16 v[176:179], v[40:43], v[72:75], v[176:179]
    ds_read_b64 v[118:119], v2 offset:2760
    v_mfma_f32_16x16x32_bf16 v[180:183], v[40:43], v[76:79], v[180:183]
    ds_read_b128 v[152:155], v3 offset:3328
    v_mfma_f32_16x16x32_bf16 v[184:187], v[40:43], v[80:83], v[184:187]
    ds_read_b64 v[120:121], v2 offset:3264
    v_mfma_f32_16x16x32_bf16 v[188:191], v[40:43], v[84:87], v[188:191]
    ds_read_b64 v[122:123], v2 offset:3272
    v_mfma_f32_16x16x32_bf16 v[172:175], v[44:47], v[64:67], v[172:175]
    ds_read_b128 v[156:159], v3 offset:3840
    v_mfma_f32_16x16x32_bf16 v[176:179], v[44:47], v[68:71], v[176:179]
    ds_read_b64 v[124:125], v2 offset:3776
    v_mfma_f32_16x16x32_bf16 v[180:183], v[44:47], v[72:75], v[180:183]
    ds_read_b64 v[126:127], v2 offset:3784
    v_mfma_f32_16x16x32_bf16 v[184:187], v[44:47], v[76:79], v[184:187]
    v_mfma_f32_16x16x32_bf16 v[188:191], v[44:47], v[80:83], v[188:191]
    v_mfma_f32_16x16x32_bf16 v[176:179], v[48:51], v[64:67], v[176:179]
    v_mfma_f32_16x16x32_bf16 v[180:183], v[48:51], v[68:71], v[180:183]
    v_mfma_f32_16x16x32_bf16 v[184:187], v[48:51], v[72:75], v[184:187]
    v_mfma_f32_16x16x32_bf16 v[188:191], v[48:51], v[76:79], v[188:191]
    v_mfma_f32_16x16x32_bf16 v[180:183], v[52:55], v[64:67], v[180:183]
    v_mfma_f32_16x16x32_bf16 v[184:187], v[52:55], v[68:71], v[184:187]
    v_mfma_f32_16x16x32_bf16 v[188:191], v[52:55], v[72:75], v[188:191]
    v_mfma_f32_16x16x32_bf16 v[184:187], v[56:59], v[64:67], v[184:187]
    v_mfma_f32_16x16x32_bf16 v[188:191], v[56:59], v[68:71], v[188:191]
    v_mfma_f32_16x16x32_bf16 v[188:191], v[60:63], v[64:67], v[188:191]
    s_waitcnt lgkmcnt(0)
    s_nop 0
    v_mfma_f32_16x16x32_bf16 v[160:163], v[96:99], v[128:131], v[160:163]
    ds_read_b128 v[64:67], v3 offset:192
    v_mfma_f32_16x16x32_bf16 v[164:167], v[96:99], v[132:135], v[164:167]
    ds_read_b64 v[32:33], v2 offset:256
    v_mfma_f32_16x16x32_bf16 v[168:171], v[96:99], v[136:139], v[168:171]
    ds_read_b64 v[34:35], v2 offset:264
    v_mfma_f32_16x16x32_bf16 v[172:175], v[96:99], v[140:143], v[172:175]
    ds_read_b128 v[68:71], v3 offset:704
    v_mfma_f32_16x16x32_bf16 v[176:179], v[96:99], v[144:147], v[176:179]
    ds_read_b64 v[36:37], v2 offset:768
    v_mfma_f32_16x16x32_bf16 v[180:183], v[96:99], v[148:151], v[180:183]
    ds_read_b64 v[38:39], v2 offset:776
    v_mfma_f32_16x16x32_bf16 v[184:187], v[96:99], v[152:155], v[184:187]
    ds_read_b128 v[72:75], v3 offset:1216
    v_mfma_f32_16x16x32_bf16 v[188:191], v[96:99], v[156:159], v[188:191]
    ds_read_b64 v[40:41], v2 offset:1280
    v_mfma_f32_16x16x32_bf16 v[164:167], v[100:103], v[128:131], v[164:167]
    ds_read_b64 v[42:43], v2 offset:1288
    v_mfma_f32_16x16x32_bf16 v[168:171], v[100:103], v[132:135], v[168:171]
    ds_read_b128 v[76:79], v3 offset:1728
    v_mfma_f32_16x16x32_bf16 v[172:175], v[100:103], v[136:139], v[172:175]
    ds_read_b64 v[44:45], v2 offset:1792
    v_mfma_f32_16x16x32_bf16 v[176:179], v[100:103], v[140:143], v[176:179]
    ds_read_b64 v[46:47], v2 offset:1800
    v_mfma_f32_16x16x32_bf16 v[180:183], v[100:103], v[144:147], v[180:183]
    ds_read_b128 v[80:83], v3 offset:2240
    v_mfma_f32_16x16x32_bf16 v[184:187], v[100:103], v[148:151], v[184:187]
    ds_read_b64 v[48:49], v2 offset:2304
PAGE8:
    s_cbranch_execz VISIT_RET
    s_nop 0
    v_mfma_f32_16x16x32_bf16 v[188:191], v[100:103], v[152:155], v[188:191]
    ds_read_b64 v[50:51], v2 offset:2312
    v_mfma_f32_16x16x32_bf16 v[168:171], v[104:107], v[128:131], v[168:171]
    ds_read_b128 v[84:87], v3 offset:2752
    v_mfma_f32_16x16x32_bf16 v[172:175], v[104:107], v[132:135], v[172:175]
    ds_read_b64 v[52:53], v2 offset:2816
    v_mfma_f32_16x16x32_bf16 v[176:179], v[104:107], v[136:139], v[176:179]
    ds_read_b64 v[54:55], v2 offset:2824
    v_mfma_f32_16x16x32_bf16 v[180:183], v[104:107], v[140:143], v[180:183]
    ds_read_b128 v[88:91], v3 offset:3264
    v_mfma_f32_16x16x32_bf16 v[184:187], v[104:107], v[144:147], v[184:187]
    ds_read_b64 v[56:57], v2 offset:3328
    v_mfma_f32_16x16x32_bf16 v[188:191], v[104:107], v[148:151], v[188:191]
    ds_read_b64 v[58:59], v2 offset:3336
    v_mfma_f32_16x16x32_bf16 v[172:175], v[108:111], v[128:131], v[172:175]
    ds_read_b128 v[92:95], v3 offset:3776
    v_mfma_f32_16x16x32_bf16 v[176:179], v[108:111], v[132:135], v[176:179]
    ds_read_b64 v[60:61], v2 offset:3840
    v_mfma_f32_16x16x32_bf16 v[180:183], v[108:111], v[136:139], v[180:183]
    ds_read_b64 v[62:63], v2 offset:3848
    v_mfma_f32_16x16x32_bf16 v[184:187], v[108:111], v[140:143], v[184:187]
    v_mfma_f32_16x16x32_bf16 v[188:191], v[108:111], v[144:147], v[188:191]
    v_mfma_f32_16x16x32_bf16 v[176:179], v[112:115], v[128:131], v[176:179]
    v_mfma_f32_16x16x32_bf16 v[180:183], v[112:115], v[132:135], v[180:183]
    v_mfma_f32_16x16x32_bf16 v[184:187], v[112:115], v[136:139], v[184:187]
    v_mfma_f32_16x16x32_bf16 v[188:191], v[112:115], v[140:143], v[188:191]
    v_mfma_f32_16x16x32_bf16 v[180:183], v[116:119], v[128:131], v[180:183]
    v_mfma_f32_16x16x32_bf16 v[184:187], v[116:119], v[132:135], v[184:187]
    v_mfma_f32_16x16x32_bf16 v[188:191], v[116:119], v[136:139], v[188:191]
    v_mfma_f32_16x16x32_bf16 v[184:187], v[120:123], v[128:131], v[184:187]
    v_mfma_f32_16x16x32_bf16 v[188:191], v[120:123], v[132:135], v[188:191]
    v_mfma_f32_16x16x32_bf16 v[188:191], v[124:127], v[128:131], v[188:191]
    s_waitcnt lgkmcnt(0)
    s_nop 0
    v_mfma_f32_16x16x32_bf16 v[160:163], v[32:35], v[64:67], v[160:163]
    ds_read_b128 v[128:131], v3 offset:128
    v_mfma_f32_16x16x32_bf16 v[164:167], v[32:35], v[68:71], v[164:167]
    ds_read_b64 v[96:97], v2 offset:320
    v_mfma_f32_16x16x32_bf16 v[168:171], v[32:35], v[72:75], v[168:171]
    ds_read_b64 v[98:99], v2 offset:328
    v_mfma_f32_16x16x32_bf16 v[172:175], v[32:35], v[76:79], v[172:175]
    ds_read_b128 v[132:135], v3 offset:640
    v_mfma_f32_16x16x32_bf16 v[176:179], v[32:35], v[80:83], v[176:179]
    ds_read_b64 v[100:101], v2 offset:832
    v_mfma_f32_16x16x32_bf16 v[180:183], v[32:35], v[84:87], v[180:183]
    ds_read_b64 v[102:103], v2 offset:840
    v_mfma_f32_16x16x32_bf16 v[184:187], v[32:35], v[88:91], v[184:187]
    ds_read_b128 v[136:139], v3 offset:1152
    v_mfma_f32_16x16x32_bf16 v[188:191], v[32:35], v[92:95], v[188:191]
    ds_read_b64 v[104:105], v2 offset:1344
    v_mfma_f32_16x16x32_bf16 v[164:167], v[36:39], v[64:67], v[164:167]
    ds_read_b64 v[106:107], v2 offset:1352
    v_mfma_f32_16x16x32_bf16 v[168:171], v[36:39], v[68:71], v[168:171]
    ds_read_b128 v[140:143], v3 offset:1664
    v_mfma_f32_16x16x32_bf16 v[172:175], v[36:39], v[72:75], v[172:175]
    ds_read_b64 v[108:109], v2 offset:1856
    v_mfma_f32_16x16x32_bf16 v[176:179], v[36:39], v[76:79], v[176:179]
    ds_read_b64 v[110:111], v2 offset:1864
    v_mfma_f32_16x16x32_bf16 v[180:183], v[36:39], v[80:83], v[180:183]
    ds_read_b128 v[144:147], v3 offset:2176
    v_mfma_f32_16x16x32_bf16 v[184:187], v[36:39], v[84:87], v[184:187]
    ds_read_b64 v[112:113], v2 offset:2368
    v_mfma_f32_16x16x32_bf16 v[188:191], v[36:39], v[88:91], v[188:191]
    ds_read_b64 v[114:115], v2 offset:2376
    v_mfma_f32_16x16x32_bf16 v[168:171], v[40:43], v[64:67], v[168:171]
    ds_read_b128 v[148:151], v3 offset:2688
    v_mfma_f32_16x16x32_bf16 v[172:175], v[40:43], v[68:71], v[172:175]
    ds_read_b64 v[116:117], v2 offset:2880
    v_mfma_f32_16x16x32_bf16 v[176:179], v[40:43], v[72:75], v[176:179]
    ds_read_b64 v[118:119], v2 offset:2888
    v_mfma_f32_16x16x32_bf16 v[180:183], v[40:43], v[76:79], v[180:183]
    ds_read_b128 v[152:155], v3 offset:3200
    buffer_load_dword v24, v27, s[36:39], 0 offen sc1
    v_mfma_f32_16x16x32_bf16 v[184:187], v[40:43], v[80:83], v[184:187]
    ds_read_b64 v[120:121], v2 offset:3392
    v_mfma_f32_16x16x32_bf16 v[188:191], v[40:43], v[84:87], v[188:191]
    ds_read_b64 v[122:123], v2 offset:3400
    v_mfma_f32_16x16x32_bf16 v[172:175], v[44:47], v[64:67], v[172:175]
    ds_read_b128 v[156:159], v3 offset:3712
    v_mfma_f32_16x16x32_bf16 v[176:179], v[44:47], v[68:71], v[176:179]
    ds_read_b64 v[124:125], v2 offset:3904
    v_mfma_f32_16x16x32_bf16 v[180:183], v[44:47], v[72:75], v[180:183]
    ds_read_b64 v[126:127], v2 offset:3912
    v_mfma_f32_16x16x32_bf16 v[184:187], v[44:47], v[76:79], v[184:187]
    v_mfma_f32_16x16x32_bf16 v[188:191], v[44:47], v[80:83], v[188:191]
    v_mfma_f32_16x16x32_bf16 v[176:179], v[48:51], v[64:67], v[176:179]
    v_mfma_f32_16x16x32_bf16 v[180:183], v[48:51], v[68:71], v[180:183]
    v_mfma_f32_16x16x32_bf16 v[184:187], v[48:51], v[72:75], v[184:187]
    v_mfma_f32_16x16x32_bf16 v[188:191], v[48:51], v[76:79], v[188:191]
    v_mfma_f32_16x16x32_bf16 v[180:183], v[52:55], v[64:67], v[180:183]
    v_mfma_f32_16x16x32_bf16 v[184:187], v[52:55], v[68:71], v[184:187]
    v_mfma_f32_16x16x32_bf16 v[188:191], v[52:55], v[72:75], v[188:191]
    v_mfma_f32_16x16x32_bf16 v[184:187], v[56:59], v[64:67], v[184:187]
    v_mfma_f32_16x16x32_bf16 v[188:191], v[56:59], v[68:71], v[188:191]
    v_mfma_f32_16x16x32_bf16 v[188:191], v[60:63], v[64:67], v[188:191]
    s_waitcnt lgkmcnt(0)
    v_mfma_f32_16x16x32_bf16 v[160:163], v[96:99], v[128:131], v[160:163]
    ds_read_b128 v[64:67], v3 offset:64
    v_mfma_f32_16x16x32_bf16 v[164:167], v[96:99], v[132:135], v[164:167]
    ds_read_b64 v[32:33], v2 offset:384
    s_lshl_b32 s79, s53, 6
    s_lshl_b32 s80, s3, 4
    s_add_u32 s79, s79, s80
    v_lshrrev_b32 v236, 2, v0
    v_add_u32 v236, s79, v236
    v_mfma_f32_16x16x32_bf16 v[168:171], v[96:99], v[136:139], v[168:171]
    ds_read_b64 v[34:35], v2 offset:392
    v_mul_u32_u24 v236, 1280, v236
    s_mul_i32 s80, s54, 160
    v_add_u32 v236, s80, v236
    v_mfma_f32_16x16x32_bf16 v[172:175], v[96:99], v[140:143], v[172:175]
    ds_read_b128 v[68:71], v3 offset:576
    v_and_b32 v237, 3, v0
    v_mfma_f32_16x16x32_bf16 v[176:179], v[96:99], v[144:147], v[176:179]
    ds_read_b64 v[36:37], v2 offset:896
    v_lshl_add_u32 v238, v237, 4, v236
    v_mfma_f32_16x16x32_bf16 v[180:183], v[96:99], v[148:151], v[180:183]
    ds_read_b64 v[38:39], v2 offset:904
    v_lshl_add_u32 v239, v237, 3, v236
    v_mfma_f32_16x16x32_bf16 v[184:187], v[96:99], v[152:155], v[184:187]
    ds_read_b128 v[72:75], v3 offset:1088
    buffer_load_dwordx4 v[244:247], v238, s[32:35], 0 offen
    v_mfma_f32_16x16x32_bf16 v[188:191], v[96:99], v[156:159], v[188:191]
    ds_read_b64 v[40:41], v2 offset:1408
    v_mfma_f32_16x16x32_bf16 v[164:167], v[100:103], v[128:131], v[164:167]
    ds_read_b64 v[42:43], v2 offset:1416
    v_mfma_f32_16x16x32_bf16 v[168:171], v[100:103], v[132:135], v[168:171]
    ds_read_b128 v[76:79], v3 offset:1600
    v_mfma_f32_16x16x32_bf16 v[172:175], v[100:103], v[136:139], v[172:175]
    ds_read_b64 v[44:45], v2 offset:1920
    v_mfma_f32_16x16x32_bf16 v[176:179], v[100:103], v[140:143], v[176:179]
    ds_read_b64 v[46:47], v2 offset:1928
    v_mfma_f32_16x16x32_bf16 v[180:183], v[100:103], v[144:147], v[180:183]
    ds_read_b128 v[80:83], v3 offset:2112
    v_mfma_f32_16x16x32_bf16 v[184:187], v[100:103], v[148:151], v[184:187]
    ds_read_b64 v[48:49], v2 offset:2432
    v_mfma_f32_16x16x32_bf16 v[188:191], v[100:103], v[152:155], v[188:191]
    ds_read_b64 v[50:51], v2 offset:2440
    v_mfma_f32_16x16x32_bf16 v[168:171], v[104:107], v[128:131], v[168:171]
    ds_read_b128 v[84:87], v3 offset:2624
    v_mfma_f32_16x16x32_bf16 v[172:175], v[104:107], v[132:135], v[172:175]
    ds_read_b64 v[52:53], v2 offset:2944
    v_mfma_f32_16x16x32_bf16 v[176:179], v[104:107], v[136:139], v[176:179]
    ds_read_b64 v[54:55], v2 offset:2952
    v_mfma_f32_16x16x32_bf16 v[180:183], v[104:107], v[140:143], v[180:183]
    ds_read_b128 v[88:91], v3 offset:3136
    buffer_load_dwordx4 v[248:251], v238, s[32:35], 0 offen offset:64
    v_mfma_f32_16x16x32_bf16 v[184:187], v[104:107], v[144:147], v[184:187]
    ds_read_b64 v[56:57], v2 offset:3456
    v_mfma_f32_16x16x32_bf16 v[188:191], v[104:107], v[148:151], v[188:191]
    ds_read_b64 v[58:59], v2 offset:3464
    v_mfma_f32_16x16x32_bf16 v[172:175], v[108:111], v[128:131], v[172:175]
    ds_read_b128 v[92:95], v3 offset:3648
    v_mfma_f32_16x16x32_bf16 v[176:179], v[108:111], v[132:135], v[176:179]
    ds_read_b64 v[60:61], v2 offset:3968
    v_mfma_f32_16x16x32_bf16 v[180:183], v[108:111], v[136:139], v[180:183]
    ds_read_b64 v[62:63], v2 offset:3976
    v_mfma_f32_16x16x32_bf16 v[184:187], v[108:111], v[140:143], v[184:187]
    v_mfma_f32_16x16x32_bf16 v[188:191], v[108:111], v[144:147], v[188:191]
    v_mfma_f32_16x16x32_bf16 v[176:179], v[112:115], v[128:131], v[176:179]
    v_mfma_f32_16x16x32_bf16 v[180:183], v[112:115], v[132:135], v[180:183]
    v_mfma_f32_16x16x32_bf16 v[184:187], v[112:115], v[136:139], v[184:187]
    v_mfma_f32_16x16x32_bf16 v[188:191], v[112:115], v[140:143], v[188:191]
    v_mfma_f32_16x16x32_bf16 v[180:183], v[116:119], v[128:131], v[180:183]
    buffer_load_dwordx2 v[252:253], v239, s[32:35], 0 offen offset:128
    v_mfma_f32_16x16x32_bf16 v[184:187], v[116:119], v[132:135], v[184:187]
    v_mfma_f32_16x16x32_bf16 v[188:191], v[116:119], v[136:139], v[188:191]
    v_mfma_f32_16x16x32_bf16 v[184:187], v[120:123], v[128:131], v[184:187]
    v_mfma_f32_16x16x32_bf16 v[188:191], v[120:123], v[132:135], v[188:191]
    v_mfma_f32_16x16x32_bf16 v[188:191], v[124:127], v[128:131], v[188:191]
    s_waitcnt lgkmcnt(0)
    s_waitcnt vmcnt(3)
    v_cmp_ne_u32 vcc, s56, v24
    s_mov_b64 s[82:83], vcc
    s_cmp_eq_u64 s[82:83], 0
    s_cbranch_scc0 P2I_RETRY_24
P2I_DONE_25:
    v_mfma_f32_16x16x32_bf16 v[160:163], v[32:35], v[64:67], v[160:163]
    ds_read_b128 v[128:131], v3 offset:0
    v_mfma_f32_16x16x32_bf16 v[164:167], v[32:35], v[68:71], v[164:167]
    ds_read_b64 v[96:97], v2 offset:448
    v_mfma_f32_16x16x32_bf16 v[168:171], v[32:35], v[72:75], v[168:171]
    ds_read_b64 v[98:99], v2 offset:456
    buffer_load_dwordx4 a[0:3], v14, s[36:39], s52 offen offset:0 sc1
    v_mfma_f32_16x16x32_bf16 v[172:175], v[32:35], v[76:79], v[172:175]
    ds_read_b128 v[132:135], v3 offset:512
    v_mfma_f32_16x16x32_bf16 v[176:179], v[32:35], v[80:83], v[176:179]
    ds_read_b64 v[100:101], v2 offset:960
    v_mfma_f32_16x16x32_bf16 v[180:183], v[32:35], v[84:87], v[180:183]
    ds_read_b64 v[102:103], v2 offset:968
    v_mfma_f32_16x16x32_bf16 v[184:187], v[32:35], v[88:91], v[184:187]
    ds_read_b128 v[136:139], v3 offset:1024
    buffer_load_dwordx4 a[4:7], v14, s[36:39], s52 offen offset:1024 sc1
    v_mfma_f32_16x16x32_bf16 v[188:191], v[32:35], v[92:95], v[188:191]
    ds_read_b64 v[104:105], v2 offset:1472
    v_mfma_f32_16x16x32_bf16 v[164:167], v[36:39], v[64:67], v[164:167]
    ds_read_b64 v[106:107], v2 offset:1480
    v_mfma_f32_16x16x32_bf16 v[168:171], v[36:39], v[68:71], v[168:171]
    ds_read_b128 v[140:143], v3 offset:1536
    v_mfma_f32_16x16x32_bf16 v[172:175], v[36:39], v[72:75], v[172:175]
    ds_read_b64 v[108:109], v2 offset:1984
    v_mfma_f32_16x16x32_bf16 v[176:179], v[36:39], v[76:79], v[176:179]
    ds_read_b64 v[110:111], v2 offset:1992
    buffer_load_dwordx4 a[8:11], v14, s[36:39], s52 offen offset:2048 sc1
    v_mfma_f32_16x16x32_bf16 v[180:183], v[36:39], v[80:83], v[180:183]
    ds_read_b128 v[144:147], v3 offset:2048
    v_mfma_f32_16x16x32_bf16 v[184:187], v[36:39], v[84:87], v[184:187]
    ds_read_b64 v[112:113], v2 offset:2496
    v_mfma_f32_16x16x32_bf16 v[188:191], v[36:39], v[88:91], v[188:191]
    ds_read_b64 v[114:115], v2 offset:2504
    v_mfma_f32_16x16x32_bf16 v[168:171], v[40:43], v[64:67], v[168:171]
    ds_read_b128 v[148:151], v3 offset:2560
    buffer_load_dwordx4 a[12:15], v14, s[36:39], s52 offen offset:3072 sc1
    v_mfma_f32_16x16x32_bf16 v[172:175], v[40:43], v[68:71], v[172:175]
    ds_read_b64 v[116:117], v2 offset:3008
    v_mfma_f32_16x16x32_bf16 v[176:179], v[40:43], v[72:75], v[176:179]
    ds_read_b64 v[118:119], v2 offset:3016
    v_mfma_f32_16x16x32_bf16 v[180:183], v[40:43], v[76:79], v[180:183]
    ds_read_b128 v[152:155], v3 offset:3072
    v_mfma_f32_16x16x32_bf16 v[184:187], v[40:43], v[80:83], v[184:187]
    ds_read_b64 v[120:121], v2 offset:3520
    v_mfma_f32_16x16x32_bf16 v[188:191], v[40:43], v[84:87], v[188:191]
    ds_read_b64 v[122:123], v2 offset:3528
    buffer_load_dwordx4 a[16:19], v15, s[36:39], s52 offen offset:0 sc1
    s_add_u32 s52, s52, 5120
    v_mfma_f32_16x16x32_bf16 v[172:175], v[44:47], v[64:67], v[172:175]
    ds_read_b128 v[156:159], v3 offset:3584
    v_mfma_f32_16x16x32_bf16 v[176:179], v[44:47], v[68:71], v[176:179]
    ds_read_b64 v[124:125], v2 offset:4032
    v_mfma_f32_16x16x32_bf16 v[180:183], v[44:47], v[72:75], v[180:183]
    ds_read_b64 v[126:127], v2 offset:4040
    v_mfma_f32_16x16x32_bf16 v[184:187], v[44:47], v[76:79], v[184:187]
    buffer_load_dwordx4 a[20:23], v14, s[36:39], s52 offen offset:0 sc1
    v_mfma_f32_16x16x32_bf16 v[188:191], v[44:47], v[80:83], v[188:191]
    v_mfma_f32_16x16x32_bf16 v[176:179], v[48:51], v[64:67], v[176:179]
    v_mfma_f32_16x16x32_bf16 v[180:183], v[48:51], v[68:71], v[180:183]
    v_mfma_f32_16x16x32_bf16 v[184:187], v[48:51], v[72:75], v[184:187]
    v_mfma_f32_16x16x32_bf16 v[188:191], v[48:51], v[76:79], v[188:191]
    buffer_load_dwordx4 a[24:27], v14, s[36:39], s52 offen offset:1024 sc1
    v_mfma_f32_16x16x32_bf16 v[180:183], v[52:55], v[64:67], v[180:183]
    v_mfma_f32_16x16x32_bf16 v[184:187], v[52:55], v[68:71], v[184:187]
    v_mfma_f32_16x16x32_bf16 v[188:191], v[52:55], v[72:75], v[188:191]
    v_mfma_f32_16x16x32_bf16 v[184:187], v[56:59], v[64:67], v[184:187]
    buffer_load_dwordx4 a[28:31], v14, s[36:39], s52 offen offset:2048 sc1
    v_mfma_f32_16x16x32_bf16 v[188:191], v[56:59], v[68:71], v[188:191]
    v_mfma_f32_16x16x32_bf16 v[188:191], v[60:63], v[64:67], v[188:191]
    s_waitcnt lgkmcnt(0)
    s_nop 0
    v_mfma_f32_16x16x32_bf16 v[160:163], v[96:99], v[128:131], v[160:163]
    v_mfma_f32_16x16x32_bf16 v[164:167], v[96:99], v[132:135], v[164:167]
    v_mfma_f32_16x16x32_bf16 v[168:171], v[96:99], v[136:139], v[168:171]
    buffer_load_dwordx4 a[32:35], v14, s[36:39], s52 offen offset:3072 sc1
    v_mfma_f32_16x16x32_bf16 v[172:175], v[96:99], v[140:143], v[172:175]
    v_mfma_f32_16x16x32_bf16 v[176:179], v[96:99], v[144:147], v[176:179]
    v_mfma_f32_16x16x32_bf16 v[180:183], v[96:99], v[148:151], v[180:183]
    v_mfma_f32_16x16x32_bf16 v[184:187], v[96:99], v[152:155], v[184:187]
    buffer_load_dwordx4 a[36:39], v15, s[36:39], s52 offen offset:0 sc1
    s_add_u32 s52, s52, 5120
    v_mfma_f32_16x16x32_bf16 v[188:191], v[96:99], v[156:159], v[188:191]
    v_mfma_f32_16x16x32_bf16 v[164:167], v[100:103], v[128:131], v[164:167]
    v_mfma_f32_16x16x32_bf16 v[168:171], v[100:103], v[132:135], v[168:171]
    v_mfma_f32_16x16x32_bf16 v[172:175], v[100:103], v[136:139], v[172:175]
    v_mfma_f32_16x16x32_bf16 v[176:179], v[100:103], v[140:143], v[176:179]
    buffer_load_dwordx4 a[40:43], v14, s[36:39], s52 offen offset:0 sc1
    v_mfma_f32_16x16x32_bf16 v[180:183], v[100:103], v[144:147], v[180:183]
    v_mfma_f32_16x16x32_bf16 v[184:187], v[100:103], v[148:151], v[184:187]
    v_mfma_f32_16x16x32_bf16 v[188:191], v[100:103], v[152:155], v[188:191]
    v_mfma_f32_16x16x32_bf16 v[168:171], v[104:107], v[128:131], v[168:171]
    buffer_load_dwordx4 a[44:47], v14, s[36:39], s52 offen offset:1024 sc1
    v_mfma_f32_16x16x32_bf16 v[172:175], v[104:107], v[132:135], v[172:175]
    v_mfma_f32_16x16x32_bf16 v[176:179], v[104:107], v[136:139], v[176:179]
    v_mfma_f32_16x16x32_bf16 v[180:183], v[104:107], v[140:143], v[180:183]
    v_mfma_f32_16x16x32_bf16 v[184:187], v[104:107], v[144:147], v[184:187]
    v_mfma_f32_16x16x32_bf16 v[188:191], v[104:107], v[148:151], v[188:191]
    buffer_load_dwordx4 a[48:51], v14, s[36:39], s52 offen offset:2048 sc1
    v_mfma_f32_16x16x32_bf16 v[172:175], v[108:111], v[128:131], v[172:175]
    v_mfma_f32_16x16x32_bf16 v[176:179], v[108:111], v[132:135], v[176:179]
    v_mfma_f32_16x16x32_bf16 v[180:183], v[108:111], v[136:139], v[180:183]
    v_mfma_f32_16x16x32_bf16 v[184:187], v[108:111], v[140:143], v[184:187]
    buffer_load_dwordx4 a[52:55], v14, s[36:39], s52 offen offset:3072 sc1
    v_mfma_f32_16x16x32_bf16 v[188:191], v[108:111], v[144:147], v[188:191]
    v_mfma_f32_16x16x32_bf16 v[176:179], v[112:115], v[128:131], v[176:179]
    v_mfma_f32_16x16x32_bf16 v[180:183], v[112:115], v[132:135], v[180:183]
    v_mfma_f32_16x16x32_bf16 v[184:187], v[112:115], v[136:139], v[184:187]
    v_mfma_f32_16x16x32_bf16 v[188:191], v[112:115], v[140:143], v[188:191]
    buffer_load_dwordx4 a[56:59], v15, s[36:39], s52 offen offset:0 sc1
    s_add_u32 s52, s52, 5120
    v_mfma_f32_16x16x32_bf16 v[180:183], v[116:119], v[128:131], v[180:183]
    v_mfma_f32_16x16x32_bf16 v[184:187], v[116:119], v[132:135], v[184:187]
    v_mfma_f32_16x16x32_bf16 v[188:191], v[116:119], v[136:139], v[188:191]
    v_mfma_f32_16x16x32_bf16 v[184:187], v[120:123], v[128:131], v[184:187]
    buffer_load_dwordx4 a[60:63], v14, s[36:39], s52 offen offset:0 sc1
    v_mfma_f32_16x16x32_bf16 v[188:191], v[120:123], v[132:135], v[188:191]
    v_mfma_f32_16x16x32_bf16 v[188:191], v[124:127], v[128:131], v[188:191]
    s_nop 7
    v_bfe_u32 v8, v0, 4, 1
    v_lshlrev_b32 v8, 9, v8
    v_and_b32 v9, 15, v0
    v_lshl_add_u32 v8, v9, 5, v8
    v_lshrrev_b32 v9, 5, v0
    v_lshl_add_u32 v8, v9, 4, v8
    v_cvt_pk_bf16_f32 v32, v160, v161
    v_cvt_pk_bf16_f32 v33, v162, v163
    v_cvt_pk_bf16_f32 v34, v164, v165
    v_cvt_pk_bf16_f32 v35, v166, v167
    v_cvt_pk_bf16_f32 v36, v168, v169
    v_cvt_pk_bf16_f32 v37, v170, v171
    v_cvt_pk_bf16_f32 v38, v172, v173
    v_cvt_pk_bf16_f32 v39, v174, v175
    v_cvt_pk_bf16_f32 v40, v176, v177
    v_cvt_pk_bf16_f32 v41, v178, v179
    v_cvt_pk_bf16_f32 v42, v180, v181
    v_cvt_pk_bf16_f32 v43, v182, v183
    v_cvt_pk_bf16_f32 v44, v184, v185
    v_cvt_pk_bf16_f32 v45, v186, v187
    v_cvt_pk_bf16_f32 v46, v188, v189
    v_cvt_pk_bf16_f32 v47, v190, v191
    s_nop 1
    v_permlane16_swap_b32 v32, v34
    v_permlane16_swap_b32 v33, v35
    v_permlane16_swap_b32 v36, v38
    v_permlane16_swap_b32 v37, v39
    v_permlane16_swap_b32 v40, v42
    v_permlane16_swap_b32 v41, v43
    v_permlane16_swap_b32 v44, v46
    v_permlane16_swap_b32 v45, v47
    buffer_store_dwordx4 v[32:35], v8, s[36:39], s18 offen offset:0 sc1
    buffer_store_dwordx4 v[36:39], v8, s[36:39], s18 offen offset:1024 sc1
    buffer_store_dwordx4 v[40:43], v8, s[36:39], s18 offen offset:2048 sc1
    buffer_store_dwordx4 v[44:47], v8, s[36:39], s18 offen offset:3072 sc1
    s_waitcnt vmcnt(24)
    v_mov_b32 v96, v200
    v_mov_b32 v97, v201
    v_mov_b32 v98, v202
    v_mov_b32 v99, v203
    v_mov_b32 v100, v204
    v_mov_b32 v101, v205
    v_mov_b32 v102, v206
    v_mov_b32 v103, v207
    v_mov_b32 v104, v208
    v_mov_b32 v105, v209
    v_mov_b32 v106, v210
    v_mov_b32 v107, v211
    v_mov_b32 v108, v212
    v_mov_b32 v109, v213
    v_mov_b32 v110, v214
    v_mov_b32 v111, v215
    v_mov_b32 v112, v216
    v_mov_b32 v113, v217
    v_mov_b32 v114, v218
    v_mov_b32 v115, v219
    v_mov_b32 v116, v220
    v_mov_b32 v117, v221
    v_mov_b32 v118, v222
    v_mov_b32 v119, v223
    v_mov_b32 v120, v224
    v_mov_b32 v121, v225
    v_mov_b32 v122, v226
    v_mov_b32 v123, v227
    v_mov_b32 v124, v228
    v_mov_b32 v125, v229
    v_mov_b32 v126, v230
    v_mov_b32 v127, v231
    s_mov_b32 s29, 17563648
    s_barrier
    s_branch C4JOIN
DONE:
EXIT:
    s_endpgm
P1_RETRY_2:
    s_mov_b32 s81, 0x40000
P1_LOOP_4:
    buffer_load_dword v29, v28, s[36:39], 0 offen sc1
    s_waitcnt vmcnt(0)
    v_cmp_ne_u32 vcc, s56, v29
    s_mov_b64 s[82:83], vcc
    s_cmp_eq_u64 s[82:83], 0
    s_cbranch_scc1 P1_DONE_3
    s_sub_u32 s81, s81, 1
    s_cmp_lg_u32 s81, 0
    s_cbranch_scc1 P1_LOOP_4
    s_branch P1_DONE_3
P2_RETRY_6:
    s_mov_b32 s81, 0x40000
P2_LOOP_8:
    buffer_load_dword v24, v27, s[36:39], 0 offen sc1
    s_waitcnt vmcnt(0)
    v_cmp_ne_u32 vcc, s56, v24
    s_mov_b64 s[82:83], vcc
    s_cmp_eq_u64 s[82:83], 0
    s_cbranch_scc1 P2_DONE_7
    s_sub_u32 s81, s81, 1
    s_cmp_lg_u32 s81, 0
    s_cbranch_scc1 P2_LOOP_8
    s_branch P2_DONE_7
FH_RETRY_11:
    s_mov_b32 s81, 0x40000
FH_LOOP_13:
    buffer_load_dword v19, v18, s[36:39], s49 offen sc1
    s_waitcnt vmcnt(0)
    v_cmp_ne_u32 vcc, s56, v19
    s_mov_b64 s[82:83], vcc
    s_cmp_eq_u64 s[82:83], 0
    s_cbranch_scc1 FH_DONE_12
    s_sub_u32 s81, s81, 1
    s_cmp_lg_u32 s81, 0
    s_cbranch_scc1 FH_LOOP_13
    s_branch FH_DONE_12
FY_RETRY_14:
    s_mov_b32 s81, 0x40000
FY_LOOP_16:
    buffer_load_dword v20, v18, s[36:39], s59 offen sc1
    s_waitcnt vmcnt(0)
    v_cmp_ne_u32 vcc, s56, v20
    s_mov_b64 s[82:83], vcc
    s_cmp_eq_u64 s[82:83], 0
    s_cbranch_scc1 FY_DONE_15
    s_sub_u32 s81, s81, 1
    s_cmp_lg_u32 s81, 0
    s_cbranch_scc1 FY_LOOP_16
    s_branch FY_DONE_15
EP_RETRY_17:
    s_mov_b32 s81, 0x40000
EP_LOOP_19:
    buffer_load_dword v24, v16, s[36:39], s76 offen sc1
    s_waitcnt vmcnt(0)
    v_cmp_ne_u32 vcc, s56, v24
    s_mov_b64 s[82:83], vcc
    s_cmp_eq_u64 s[82:83], 0
    s_cbranch_scc1 EP_DONE_18
    s_sub_u32 s81, s81, 1
    s_cmp_lg_u32 s81, 0
    s_cbranch_scc1 EP_LOOP_19
    s_branch EP_DONE_18
EP_CHECK:
    s_waitcnt vmcnt(0)
    v_cmp_ne_u32 vcc, s56, v24
    s_mov_b64 s[82:83], vcc
    s_cmp_eq_u64 s[82:83], 0
    s_cbranch_scc0 EP_RETRY_17
EP_DONE_18:
    s_branch EP_BACK
EP_STORE:
    s_sub_u32 s73, s56, 2654435768
    v_mov_b32 v16, s73
    v_mov_b32 v17, 0
    s_mov_b32 exec_lo, 1
    s_mov_b32 exec_hi, 0
    buffer_store_dword v16, v17, s[36:39], 0 offen sc1
    s_mov_b64 exec, -1
    s_branch EP_STORED
FAI_RETRY_21:
    s_mov_b32 s81, 0x40000
FAI_LOOP_23:
    buffer_load_dword v25, v28, s[36:39], 0 offen sc1
    s_waitcnt vmcnt(0)
    v_cmp_ne_u32 vcc, s56, v25
    s_mov_b64 s[82:83], vcc
    s_cmp_eq_u64 s[82:83], 0
    s_cbranch_scc1 FAI_DONE_22
    s_sub_u32 s81, s81, 1
    s_cmp_lg_u32 s81, 0
    s_cbranch_scc1 FAI_LOOP_23
    s_branch FAI_DONE_22
P2I_RETRY_24:
    s_mov_b32 s81, 0x40000
P2I_LOOP_26:
    buffer_load_dword v24, v27, s[36:39], 0 offen sc1
    s_waitcnt vmcnt(0)
    v_cmp_ne_u32 vcc, s56, v24
    s_mov_b64 s[82:83], vcc
    s_cmp_eq_u64 s[82:83], 0
    s_cbranch_scc1 P2I_DONE_25
    s_sub_u32 s81, s81, 1
    s_cmp_lg_u32 s81, 0
    s_cbranch_scc1 P2I_LOOP_26
    s_branch P2I_DONE_25
CODE_END:
.section .rodata,"a"
.p2align 6
.amdhsa_kernel recurrent_scan__ssm_conv_h3__dense_activation_gelu__prompt_kernel
  .amdhsa_next_free_vgpr 512
  .amdhsa_next_free_sgpr 102
  .amdhsa_accum_offset 256
  .amdhsa_group_segment_fixed_size 0
  .amdhsa_kernarg_size 112
  .amdhsa_user_sgpr_count 2
  .amdhsa_user_sgpr_kernarg_segment_ptr 1
  .amdhsa_system_sgpr_workgroup_id_x 1
.end_amdhsa_kernel
```

```asm
; @launch grid=(256,1,1) block=(256,1,1) lds=156160
.amdgcn_target "amdgcn-amd-amdhsa--gfx950"
.text
.globl recurrent_scan__ssm_conv_h3__dense_activation_gelu__prompt_kernel
.p2align 12
.type recurrent_scan__ssm_conv_h3__dense_activation_gelu__prompt_kernel,@function
recurrent_scan__ssm_conv_h3__dense_activation_gelu__prompt_kernel:
    s_cmp_ge_u32 s2, 256
    s_cbranch_scc1 EXIT
    s_load_dwordx16 s[4:19], s[0:1], 0
    s_load_dwordx8 s[20:27], s[0:1], 64
    s_load_dwordx4 s[28:31], s[0:1], 96
    v_lshrrev_b32 v1, 6, v0
    s_and_b32 s57, s2, 7
    s_lshr_b32 s58, s2, 3
    s_getpc_b64 s[44:45]
PF_BASE:
    s_mov_b32 s46, CODE_END-PF_BASE
    s_mov_b32 s47, 0x20000
    s_mul_i32 s78, s58, 9
    v_add_u32 v2, s78, v0
    v_lshlrev_b32 v2, 7, v2
    v_cmp_gt_u32 vcc, 9, v0
    v_cndmask_b32 v2, -1, v2, vcc
    buffer_load_dword v47, v2, s[44:47], 0 offen
    v_and_b32 v0, 63, v0
    v_readfirstlane_b32 s3, v1
    s_cmp_ge_u32 s58, 28
    s_cbranch_scc1 IDLE
    s_lshr_b32 s75, s58, 2
    s_and_b32 s76, s58, 3
    s_lshl_b32 s76, s76, 3
    s_add_u32 s76, s76, s57
    v_lshrrev_b32 v15, 4, v0
    s_lshl_b32 s78, s3, 2
    v_add_u32 v15, s78, v15
    v_and_b32 v18, 15, v0
    v_mul_u32_u24 v14, 5120, v15
    v_lshl_add_u32 v14, v18, 3, v14
    s_mul_i32 s78, s76, 81920
    v_add_u32_e64 v14, s78, v14
    v_add_u32 v15, 0xfffff100, v14
    v_add_u32 v16, 0xfffff600, v14
    v_add_u32 v17, 0xfffffb00, v14
    v_lshlrev_b32 v18, 5, v18
    s_lshl_b32 s79, s75, 7
    v_add_u32 v248, s79, v14
    v_add_u32 v249, s79, v15
    v_add_u32 v250, s79, v16
    v_add_u32 v251, s79, v17
    v_lshl_add_u32 v252, s75, 9, v18
    s_lshl_b32 s79, s75, 18
    s_lshl_b32 s80, s76, 7
    s_add_u32 s59, s79, s80
    s_add_u32 s59, s59, 1048576
    s_lshl_b32 s84, s75, 5
    s_add_u32 s84, s84, s76
    s_lshl_b32 s84, s84, 6
    s_add_u32 s84, s84, 131072
    s_waitcnt lgkmcnt(0)
    s_load_dword s56, s[30:31], 0
    s_mov_b32 s32, s4
    s_mov_b32 s33, s5
    s_mov_b32 s34, 2621440
    s_mov_b32 s35, 0x20000
    s_mov_b32 s44, s6
    s_mov_b32 s45, s7
    s_mov_b32 s46, 2621440
    s_mov_b32 s47, 0x20000
    s_mov_b32 s48, s8
    s_mov_b32 s49, s9
    s_mov_b32 s50, 2621440
    s_mov_b32 s51, 0x20000
    s_mov_b32 s52, s10
    s_mov_b32 s53, s11
    s_mov_b32 s54, 5120
    s_mov_b32 s55, 0x20000
    buffer_load_dwordx2 v[96:97], v249, s[44:47], 0 offen nt
    s_lshr_b32 s73, s57, 1
    s_lshl_b32 s73, s73, 2
    s_and_b32 s74, s58, 3
    s_add_u32 s63, s73, s74
    buffer_load_dwordx2 v[98:99], v250, s[44:47], 0 offen nt
    s_and_b32 s73, s57, 1
    s_mul_i32 s73, s73, 7
    s_lshr_b32 s74, s58, 2
    s_add_u32 s64, s73, s74
    buffer_load_dwordx2 v[100:101], v251, s[44:47], 0 offen nt
    s_and_b32 s65, s3, 1
    s_lshr_b32 s66, s3, 1
    s_mul_i32 s73, s63, 163840
    s_mul_i32 s74, s3, 40960
    s_add_u32 s60, s73, s74
    buffer_load_dwordx2 v[102:103], v248, s[44:47], 0 offen offset:0 nt
    s_lshl_b32 s73, s64, 8
    s_mul_i32 s74, s3, 55296
    s_add_u32 s61, s73, s74
    s_lshl_b32 s62, s3, 12
    buffer_load_dwordx2 v[104:105], v248, s[44:47], 0 offen offset:1280 nt
    s_mov_b32 s85, -1152
    s_mov_b32 s86, -1990656
    s_lshr_b32 s73, s58, 2
    s_mul_i32 s73, s73, 10
    s_add_u32 s73, s73, 3
    buffer_load_dwordx2 v[106:107], v248, s[44:47], 0 offen offset:2560 nt
    s_mul_i32 s73, s73, 9363
    s_lshr_b32 s73, s73, 16
    s_and_b32 s74, s58, 3
    s_mul_i32 s74, s74, 5
    buffer_load_dwordx2 v[108:109], v248, s[44:47], 0 offen offset:3840 nt
    s_lshr_b32 s74, s74, 1
    s_add_u32 s73, s73, s74
    s_cmp_ge_u32 s73, 10
    s_cselect_b32 s74, 10, 0
    s_sub_u32 s73, s73, s74
    s_sub_u32 s74, 9, s73
    buffer_load_dwordx4 v[118:121], v252, s[52:55], 0 offen
    s_lshl_b32 s0, 1, s74
    s_lshl_b32 s74, s73, 7
    s_add_u32 s60, s60, s74
    s_mul_i32 s74, s73, 221184
    buffer_load_dwordx4 v[122:125], v252, s[52:55], 0 offen offset:16
    s_add_u32 s61, s61, s74
    v_lshrrev_b32 v1, 3, v0
    v_and_b32 v2, 7, v0
    v_xor_b32 v2, v2, v1
    v_lshlrev_b32_e64 v2, 4, v2
    buffer_load_dwordx2 v[110:111], v248, s[48:51], 0 offen offset:0 nt
    v_mul_u32_u24 v240, 1280, v1
    v_add_u32_e64 v240, v240, v2
    v_add_u32 v241, 9216, v240
    v_add_u32 v242, 18432, v240
    buffer_load_dwordx2 v[112:113], v248, s[48:51], 0 offen offset:1280 nt
    v_add_u32 v243, 27648, v240
    v_lshrrev_b32 v1, 4, v0
    v_and_b32 v2, 15, v0
    v_lshlrev_b32 v3, 1, v1
    v_xor_b32 v2, v2, v3
    buffer_load_dwordx2 v[114:115], v248, s[48:51], 0 offen offset:2560 nt
    v_lshlrev_b32 v2, 4, v2
    v_mul_u32_u24 v3, 3456, v1
    v_add_u32 v244, v3, v2
    v_add_u32 v245, 12800, v244
    buffer_load_dwordx2 v[116:117], v248, s[48:51], 0 offen offset:3840 nt
    v_xor_b32 v2, 128, v2
    v_add_u32_e64 v3, v3, v2
    v_add_u32 v246, 25600, v3
    v_add_u32 v247, 38400, v3
    s_movk_i32 s73, 1280
    s_mov_b32 s42, 0
    s_mov_b64 exec, 0
    s_cmp_eq_u32 s3, 0
    s_cbranch_scc1 PAGE1
    s_cmp_eq_u32 s3, 1
    s_cbranch_scc1 PAGE3
    s_cmp_eq_u32 s3, 2
    s_cbranch_scc1 PAGE5
    s_branch PAGE7
VISIT_RET:
    s_cmp_eq_u32 s42, 1
    s_cbranch_scc1 VISIT_RET_I
    s_mov_b64 exec, -1
    s_lshl_b32 s78, s57, 8
    s_lshl_b32 s79, s58, 3
    s_add_u32 s78, s78, s79
    s_lshl_b32 s79, s3, 1
    s_add_u32 s78, s78, s79
    v_lshrrev_b32 v226, 5, v0
    v_add_u32 v226, s78, v226
    v_and_b32 v227, 31, v0
    v_lshlrev_b32 v227, 3, v227
    v_mad_u32_u24 v227, v226, s73, v227
    v_lshlrev_b32_e64 v226, 3, v226
    buffer_load_dwordx2 v[216:217], v227, s[32:35], 0 offen offset:0
    buffer_load_dwordx2 v[218:219], v227, s[32:35], 0 offen offset:256
    buffer_load_dwordx2 v[220:221], v227, s[32:35], 0 offen offset:512
    buffer_load_dwordx2 v[222:223], v227, s[32:35], 0 offen offset:768
    buffer_load_dwordx2 v[224:225], v227, s[32:35], 0 offen offset:1024
    s_mov_b32 s44, s22
    s_mov_b32 s45, s23
    s_mov_b32 s46, 2211840
    s_mov_b32 s47, 0x20000
    s_mov_b32 s40, s18
    s_mov_b32 s41, s19
    s_mov_b32 s42, 2211840
    s_mov_b32 s43, 0x20000
    s_add_u32 m0, s62, 0
    s_nop 0
    buffer_load_dwordx4 v240, s[32:35], s60 offen offset:0 lds
    s_lshl_b32 s68, s64, 3
    s_lshl_b32 s73, s65, 2
    s_add_u32 s68, s68, s73
    s_lshl_b32 s73, s66, 1
    s_add_u32 s74, s73, 0
    s_and_b32 s74, s74, 3
    s_add_u32 s69, s74, s68
    s_add_u32 s74, s73, 1
    s_and_b32 s74, s74, 3
    s_add_u32 s70, s74, s68
    s_add_u32 s74, s73, 2
    s_and_b32 s74, s74, 3
    s_add_u32 s71, s74, s68
    s_add_u32 s74, s73, 3
    s_and_b32 s74, s74, 3
    s_add_u32 s72, s74, s68
    s_mov_b32 s36, s30
    s_mov_b32 s37, s31
    s_mov_b32 s38, 17563648
    s_mov_b32 s39, 0x20000
    v_and_b32 v203, 15, v0
    v_lshrrev_b32 v204, 5, v0
    s_lshl_b32 s78, s3, 1
    v_add_u32 v204, s78, v204
    v_xor_b32 v204, v204, v203
    v_and_b32 v204, 7, v204
    v_lshlrev_b32_e64 v204, 4, v204
    v_lshl_add_u32 v203, v203, 9, v204
    buffer_load_dwordx4 v241, s[32:35], s60 offen offset:1024 lds
    v_bfe_u32 v204, v0, 4, 1
    v_xor_b32_e64 v204, 1, v204
    v_lshl_add_u32 v203, v204, 3, v203
    v_add_u32 v203, 131584, v203
    s_lshl_b32 s78, s3, 6
    v_add_u32 v205, s78, v0
    v_lshrrev_b32 v206, 3, v205
    v_lshrrev_b32 v204, 5, v205
    v_xor_b32 v204, v204, v205
    v_and_b32 v204, 7, v204
    v_lshlrev_b32_e64 v204, 4, v204
    v_lshl_add_u32 v204, v206, 7, v204
    v_add_u32 v204, 131584, v204
    v_and_b32 v205, 7, v205
    v_lshlrev_b32 v205, 4, v205
    v_lshl_add_u32 v205, v206, 12, v205
    v_add_u32 v206, 0x20000, v205
    s_and_b32 s76, s58, 7
    s_lshl_b32 s77, s57, 2
    s_lshr_b32 s78, s58, 3
    s_add_u32 s77, s77, s78
    s_mul_i32 s78, s77, 40960
    s_mul_i32 s79, s76, 160
    s_add_u32 s78, s78, s79
    s_add_u32 s79, s78, 1310720
    s_cmp_lt_u32 s77, 22
    s_cselect_b32 s79, s79, 2211840
    s_lshl_b32 s80, s3, 6
    v_add_u32 v24, s80, v0
    buffer_load_dwordx4 v242, s[32:35], s60 offen offset:2048 lds
    v_cmp_gt_u32 vcc, 320, v24
    v_subrev_u32 v25, 320, v24
    v_mov_b32 v26, s79
    v_mov_b32 v27, s78
    v_cndmask_b32 v25, v25, v24, vcc
    v_cndmask_b32 v26, v26, v27, vcc
    v_mul_u32_u24 v27, 6554, v25
    v_lshrrev_b32 v27, 16, v27
    v_mul_u32_u24 v28, 10, v27
    v_sub_u32_e64 v28, v25, v28
    v_mul_u32_u24 v27, 1280, v27
    v_lshl_add_u32 v27, v28, 4, v27
    v_add_u32 v253, v27, v26
    v_add_u32 v24, s80, v0
    v_add_u32 v24, 256, v24
    v_cmp_gt_u32 vcc, 320, v24
    v_subrev_u32 v25, 320, v24
    v_mov_b32 v26, s79
    v_mov_b32 v27, s78
    v_cndmask_b32 v25, v25, v24, vcc
    v_cndmask_b32 v26, v26, v27, vcc
    v_mul_u32_u24 v27, 6554, v25
    v_lshrrev_b32 v27, 16, v27
    v_mul_u32_u24 v28, 10, v27
    v_sub_u32_e64 v28, v25, v28
    v_mul_u32_u24 v27, 1280, v27
    v_lshl_add_u32 v27, v28, 4, v27
    v_add_u32 v254, v27, v26
    v_add_u32 v24, s80, v0
    buffer_load_dwordx4 v243, s[32:35], s60 offen offset:3072 lds
    v_add_u32 v24, 512, v24
    v_cmp_gt_u32 vcc, 320, v24
    v_subrev_u32 v25, 320, v24
    v_mov_b32 v26, s79
    v_mov_b32 v27, s78
    v_cndmask_b32 v25, v25, v24, vcc
    v_cndmask_b32 v26, v26, v27, vcc
    v_mul_u32_u24 v27, 6554, v25
    v_lshrrev_b32 v27, 16, v27
    v_mul_u32_u24 v28, 10, v27
    v_sub_u32_e64 v28, v25, v28
    v_mul_u32_u24 v27, 1280, v27
    v_lshl_add_u32 v27, v28, 4, v27
    v_add_u32_e64 v255, v27, v26
    v_mov_b32 v26, 2211840
    v_cmp_gt_u32 vcc, 640, v24
    s_nop 1
    v_cndmask_b32 v255, v26, v255, vcc
    s_and_b32 s77, s58, 7
    s_lshl_b32 s78, s57, 2
    s_lshr_b32 s79, s58, 3
    s_add_u32 s78, s78, s79
    s_mul_i32 s77, s77, 54
    s_add_u32 s77, s77, s78
    s_mul_i32 s77, s77, 5120
    s_add_u32 s77, s77, 4194304
    v_lshrrev_b32_e64 v24, 4, v0
    v_bfe_u32 v25, v0, 2, 2
    s_add_u32 m0, s62, 16384
    s_nop 0
    buffer_load_dwordx4 v244, s[40:43], s61 offen offset:0 lds
    v_lshl_add_u32 v24, v24, 2, v25
    v_mul_u32_u24 v24, 160, v24
    v_and_b32 v25, 3, v0
    s_add_u32 s79, s3, 0
    s_cmp_ge_u32 s79, 5
    s_cselect_b32 s80, 1, 0
    s_mul_i32 s81, s80, 5
    s_sub_u32 s79, s79, s81
    s_mul_i32 s81, s80, 163840
    s_add_u32 s81, s81, s77
    s_lshl_b32 s82, s79, 10
    s_add_u32 s81, s81, s82
    s_cmp_ge_u32 s78, 22
    s_cselect_b32 s82, s80, 0
    s_cmp_ge_u32 s79, 5
    s_cselect_b32 s82, 1, s82
    s_cmp_lg_u32 s82, 0
    s_cselect_b32 s74, 17563648, s81
    s_min_u32 s79, s79, 4
    s_and_b32 s82, s79, 1
    s_lshl_b32 s82, s82, 3
    s_lshr_b32 s83, s79, 1
    s_lshl_b32 s83, s83, 6
    s_add_u32 s82, s82, s83
    s_mul_i32 s83, s80, 5120
    s_add_u32 s82, s82, s83
    s_add_u32 s82, s82, 139776
    s_cmp_eq_u32 s79, 4
    s_cselect_b32 s83, 3, 4
    v_lshlrev_b32 v200, s83, v25
    v_add3_u32 v200, v200, v24, s82
    s_add_u32 s79, s3, 4
    s_cmp_ge_u32 s79, 5
    s_cselect_b32 s80, 1, 0
    buffer_load_dwordx4 v245, s[40:43], s61 offen offset:1024 lds
    s_mul_i32 s81, s80, 5
    s_sub_u32 s79, s79, s81
    s_mul_i32 s81, s80, 163840
    s_add_u32 s81, s81, s77
    s_lshl_b32 s82, s79, 10
    s_add_u32 s81, s81, s82
    s_cmp_ge_u32 s78, 22
    s_cselect_b32 s82, s80, 0
    s_cmp_ge_u32 s79, 5
    s_cselect_b32 s82, 1, s82
    s_cmp_lg_u32 s82, 0
    s_cselect_b32 s75, 17563648, s81
    s_min_u32 s79, s79, 4
    s_and_b32 s82, s79, 1
    s_lshl_b32 s82, s82, 3
    s_lshr_b32 s83, s79, 1
    s_lshl_b32 s83, s83, 6
    s_add_u32 s82, s82, s83
    s_mul_i32 s83, s80, 5120
    s_add_u32 s82, s82, s83
    s_add_u32 s82, s82, 139776
    s_cmp_eq_u32 s79, 4
    s_cselect_b32 s83, 3, 4
    v_lshlrev_b32 v201, s83, v25
    v_add3_u32 v201, v201, v24, s82
    s_add_u32 s79, s3, 8
    s_cmp_ge_u32 s79, 5
    s_cselect_b32 s80, 1, 0
    s_mul_i32 s81, s80, 5
    s_sub_u32 s79, s79, s81
    s_mul_i32 s81, s80, 163840
    s_add_u32 s81, s81, s77
    s_lshl_b32 s82, s79, 10
    s_add_u32 s81, s81, s82
    buffer_load_dwordx4 v246, s[40:43], s61 offen offset:2048 lds
    s_cmp_ge_u32 s78, 22
    s_cselect_b32 s82, s80, 0
    s_cmp_ge_u32 s79, 5
    s_cselect_b32 s82, 1, s82
    s_cmp_lg_u32 s82, 0
    s_cselect_b32 s76, 17563648, s81
    s_min_u32 s79, s79, 4
    s_and_b32 s82, s79, 1
    s_lshl_b32 s82, s82, 3
    s_lshr_b32 s83, s79, 1
    s_lshl_b32 s83, s83, 6
    s_add_u32 s82, s82, s83
    s_mul_i32 s83, s80, 5120
    s_add_u32 s82, s82, s83
    s_add_u32 s82, s82, 139776
    s_cmp_eq_u32 s79, 4
    s_cselect_b32 s83, 3, 4
    v_lshlrev_b32 v202, s83, v25
    v_add3_u32 v202, v202, v24, s82
    v_lshlrev_b32 v14, 4, v0
    v_and_b32 v1, 15, v0
    v_lshrrev_b32 v17, 4, v0
    v_bfe_u32 v18, v0, 2, 2
    v_and_b32 v19, 3, v0
    v_and_b32 v24, 1, v17
    v_lshl_or_b32 v24, v24, 2, v18
    v_lshl_add_u32 v25, v17, 3, v18
    v_lshlrev_b32 v25, 8, v25
    v_lshl_add_u32 v25, v19, 3, v25
    s_and_b32 s73, s69, 7
    v_xor_b32_e64 v26, s73, v24
    v_lshl_add_u32 v2, v26, 5, v25
    buffer_load_dwordx4 v247, s[40:43], s61 offen offset:3072 lds
    v_add_u32 v6, 0x10000, v2
    s_and_b32 s73, s70, 7
    v_xor_b32 v26, s73, v24
    v_lshl_add_u32 v3, v26, 5, v25
    v_add_u32 v7, 0x10000, v3
    s_and_b32 s73, s71, 7
    v_xor_b32 v26, s73, v24
    v_lshl_add_u32 v4, v26, 5, v25
    v_add_u32 v8, 0x10000, v4
    s_and_b32 s73, s72, 7
    v_xor_b32 v26, s73, v24
    v_lshl_add_u32 v5, v26, 5, v25
    v_add_u32 v9, 0x10000, v5
    s_lshl_b32 s73, s66, 13
    v_and_b32 v24, 7, v1
    v_xor_b32 v24, v24, v17
    v_lshlrev_b32 v24, 4, v24
    v_lshl_add_u32 v24, v1, 7, v24
    v_add_u32 v10, s73, v24
    v_xor_b32 v11, 64, v10
    v_add_u32 v12, 0x10000, v10
    v_add_u32 v13, 0x10000, v11
    v_mov_b32 v20, 0x3f803f80
    v_mov_b32 v21, 0x3f803f80
    v_mov_b32 v22, 0x3f803f80
    v_mov_b32 v23, 0x3f803f80
    s_lshl_b32 s67, s63, 7
    s_lshl_b32 s73, s66, 6
    s_add_u32 s67, s67, s73
    s_bitcmp1_b32 s0, 0
    s_cselect_b32 s87, s85, 128
    s_cselect_b32 s88, s86, 221184
    s_add_u32 s60, s60, s87
    s_add_u32 s61, s61, s88
    s_add_u32 m0, s62, 32768
    s_nop 0
    buffer_load_dwordx4 v240, s[32:35], s60 offen offset:0 lds
    s_waitcnt vmcnt(18)
    v_lshlrev_b32 v144, 16, v118
    v_and_b32 v148, 0xffff0000, v118
    v_lshlrev_b32 v145, 16, v122
    v_and_b32 v149, 0xffff0000, v122
    v_lshlrev_b32 v146, 16, v120
    v_and_b32 v150, 0xffff0000, v120
    v_lshlrev_b32 v147, 16, v124
    v_and_b32 v151, 0xffff0000, v124
    v_lshlrev_b32 v152, 16, v119
    v_and_b32 v156, 0xffff0000, v119
    v_lshlrev_b32 v153, 16, v123
    v_and_b32 v157, 0xffff0000, v123
    v_lshlrev_b32 v154, 16, v121
    v_and_b32 v158, 0xffff0000, v121
    v_lshlrev_b32 v155, 16, v125
    buffer_load_dwordx4 v241, s[32:35], s60 offen offset:1024 lds
    v_and_b32 v159, 0xffff0000, v125
    v_lshlrev_b32 v128, 16, v96
    v_and_b32 v96, 0xffff0000, v96
    v_lshlrev_b32 v129, 16, v97
    v_and_b32 v97, 0xffff0000, v97
    v_lshlrev_b32 v130, 16, v98
    v_and_b32 v98, 0xffff0000, v98
    v_lshlrev_b32 v131, 16, v99
    v_and_b32 v99, 0xffff0000, v99
    v_lshlrev_b32 v132, 16, v100
    v_and_b32 v100, 0xffff0000, v100
    v_lshlrev_b32 v133, 16, v101
    v_and_b32 v101, 0xffff0000, v101
    v_lshlrev_b32 v134, 16, v102
    v_and_b32 v102, 0xffff0000, v102
    v_lshlrev_b32 v135, 16, v103
    buffer_load_dwordx4 v242, s[32:35], s60 offen offset:2048 lds
    v_and_b32 v103, 0xffff0000, v103
    v_lshlrev_b32 v136, 16, v104
    v_and_b32 v104, 0xffff0000, v104
    v_lshlrev_b32 v137, 16, v105
    v_and_b32 v105, 0xffff0000, v105
    v_lshlrev_b32 v138, 16, v106
    v_and_b32 v106, 0xffff0000, v106
    v_lshlrev_b32 v139, 16, v107
    v_and_b32 v107, 0xffff0000, v107
    v_lshlrev_b32 v140, 16, v108
    v_and_b32 v108, 0xffff0000, v108
    v_lshlrev_b32 v141, 16, v109
    v_and_b32 v109, 0xffff0000, v109
    v_pk_mul_f32 v[160:161], v[134:135], v[144:145]
    v_pk_mul_f32 v[162:163], v[102:103], v[146:147]
    v_pk_mul_f32 v[164:165], v[136:137], v[144:145]
    buffer_load_dwordx4 v243, s[32:35], s60 offen offset:3072 lds
    v_pk_mul_f32 v[166:167], v[104:105], v[146:147]
    v_pk_mul_f32 v[168:169], v[138:139], v[144:145]
    v_pk_mul_f32 v[170:171], v[106:107], v[146:147]
    v_pk_mul_f32 v[172:173], v[140:141], v[144:145]
    v_pk_mul_f32 v[174:175], v[108:109], v[146:147]
    v_pk_fma_f32 v[160:161], v[132:133], v[148:149], v[160:161]
    v_pk_fma_f32 v[162:163], v[100:101], v[150:151], v[162:163]
    v_pk_fma_f32 v[164:165], v[134:135], v[148:149], v[164:165]
    v_pk_fma_f32 v[166:167], v[102:103], v[150:151], v[166:167]
    v_pk_fma_f32 v[168:169], v[136:137], v[148:149], v[168:169]
    v_pk_fma_f32 v[170:171], v[104:105], v[150:151], v[170:171]
    v_pk_fma_f32 v[172:173], v[138:139], v[148:149], v[172:173]
    v_pk_fma_f32 v[174:175], v[106:107], v[150:151], v[174:175]
    v_pk_fma_f32 v[160:161], v[130:131], v[152:153], v[160:161]
    v_pk_fma_f32 v[162:163], v[98:99], v[154:155], v[162:163]
    v_pk_fma_f32 v[164:165], v[132:133], v[152:153], v[164:165]
    s_add_u32 m0, s62, 49152
    s_nop 0
    s_nop 0
    buffer_load_dwordx4 v244, s[40:43], s61 offen offset:0 lds
    v_pk_fma_f32 v[166:167], v[100:101], v[154:155], v[166:167]
    v_pk_fma_f32 v[168:169], v[134:135], v[152:153], v[168:169]
    v_pk_fma_f32 v[170:171], v[102:103], v[154:155], v[170:171]
    v_pk_fma_f32 v[172:173], v[136:137], v[152:153], v[172:173]
    v_pk_fma_f32 v[174:175], v[104:105], v[154:155], v[174:175]
    v_pk_fma_f32 v[160:161], v[128:129], v[156:157], v[160:161]
    v_pk_fma_f32 v[162:163], v[96:97], v[158:159], v[162:163]
    v_pk_fma_f32 v[164:165], v[130:131], v[156:157], v[164:165]
    v_pk_fma_f32 v[166:167], v[98:99], v[158:159], v[166:167]
    v_pk_fma_f32 v[168:169], v[132:133], v[156:157], v[168:169]
    v_pk_fma_f32 v[170:171], v[100:101], v[158:159], v[170:171]
    v_pk_fma_f32 v[172:173], v[134:135], v[156:157], v[172:173]
    v_pk_fma_f32 v[174:175], v[102:103], v[158:159], v[174:175]
    s_waitcnt vmcnt(18)
    v_lshlrev_b32 v128, 16, v110
    v_and_b32 v110, 0xffff0000, v110
    buffer_load_dwordx4 v245, s[40:43], s61 offen offset:1024 lds
    v_lshlrev_b32 v129, 16, v111
    v_and_b32 v111, 0xffff0000, v111
    v_lshlrev_b32 v130, 16, v112
    v_and_b32 v112, 0xffff0000, v112
    v_lshlrev_b32 v131, 16, v113
    v_and_b32 v113, 0xffff0000, v113
    v_lshlrev_b32 v132, 16, v114
    v_and_b32 v114, 0xffff0000, v114
    v_lshlrev_b32 v133, 16, v115
    v_and_b32 v115, 0xffff0000, v115
    v_lshlrev_b32 v134, 16, v116
    v_and_b32 v116, 0xffff0000, v116
    v_lshlrev_b32_e64 v135, 16, v117
    v_and_b32 v117, 0xffff0000, v117
    v_pk_mul_f32 v[160:161], v[160:161], v[128:129]
    v_pk_mul_f32 v[162:163], v[162:163], v[110:111]
    buffer_load_dwordx4 v246, s[40:43], s61 offen offset:2048 lds
    v_pk_mul_f32 v[164:165], v[164:165], v[130:131]
    v_pk_mul_f32 v[166:167], v[166:167], v[112:113]
    v_pk_mul_f32 v[168:169], v[168:169], v[132:133]
    v_pk_mul_f32 v[170:171], v[170:171], v[114:115]
    v_pk_mul_f32 v[172:173], v[172:173], v[134:135]
    v_pk_mul_f32 v[174:175], v[174:175], v[116:117]
    v_cvt_pk_bf16_f32 v144, v172, v168
    v_cvt_pk_bf16_f32 v145, v164, v160
    v_cvt_pk_bf16_f32 v146, v174, v170
    v_cvt_pk_bf16_f32 v147, v166, v162
    v_cvt_pk_bf16_f32 v148, v173, v169
    v_cvt_pk_bf16_f32 v149, v165, v161
    v_cvt_pk_bf16_f32 v150, v175, v171
    v_cvt_pk_bf16_f32 v151, v167, v163
    ds_write_b64 v203, v[144:145] offset:0
    ds_write_b64 v203, v[146:147] offset:128
    buffer_load_dwordx4 v247, s[40:43], s61 offen offset:3072 lds
    ds_write_b64 v203, v[148:149] offset:256
    ds_write_b64 v203, v[150:151] offset:384
    s_waitcnt vmcnt(16)
    s_mov_b32 s78, 0x3f803f80
    v_mov_b32 v228, 0
    v_mov_b32 v229, 0
    v_dot2c_f32_bf16 v228, s78, v216
    v_dot2c_f32_bf16 v229, v216, v216
    v_dot2c_f32_bf16 v228, s78, v217
    v_dot2c_f32_bf16 v229, v217, v217
    v_dot2c_f32_bf16 v228, s78, v218
    v_dot2c_f32_bf16 v229, v218, v218
    v_dot2c_f32_bf16 v228, s78, v219
    v_dot2c_f32_bf16 v229, v219, v219
    v_dot2c_f32_bf16 v228, s78, v220
PAGE1:
    s_cbranch_execz PAGE2
    v_dot2c_f32_bf16 v229, v220, v220
    v_dot2c_f32_bf16 v228, s78, v221
    s_bitcmp1_b32 s0, 1
    s_cselect_b32 s87, s85, 128
    s_cselect_b32 s88, s86, 221184
    s_add_u32 s60, s60, s87
    s_add_u32 s61, s61, s88
    v_dot2c_f32_bf16 v229, v221, v221
    v_dot2c_f32_bf16 v228, s78, v222
    v_dot2c_f32_bf16 v229, v222, v222
    v_dot2c_f32_bf16 v228, s78, v223
    v_dot2c_f32_bf16 v229, v223, v223
    v_dot2c_f32_bf16 v228, s78, v224
    v_dot2c_f32_bf16 v229, v224, v224
    v_dot2c_f32_bf16 v228, s78, v225
    v_dot2c_f32_bf16 v229, v225, v225
    s_nop 1
    v_add_f32_dpp v228, v228, v228 row_ror:8 row_mask:0xf bank_mask:0xf
    v_add_f32_dpp v229, v229, v229 row_ror:8 row_mask:0xf bank_mask:0xf
    s_nop 1
    v_add_f32_dpp v228, v228, v228 row_ror:4 row_mask:0xf bank_mask:0xf
    v_add_f32_dpp v229, v229, v229 row_ror:4 row_mask:0xf bank_mask:0xf
    s_nop 1
    v_add_f32_dpp v228, v228, v228 row_ror:2 row_mask:0xf bank_mask:0xf
    v_add_f32_dpp v229, v229, v229 row_ror:2 row_mask:0xf bank_mask:0xf
    s_nop 1
    v_add_f32_dpp v228, v228, v228 row_ror:1 row_mask:0xf bank_mask:0xf
    v_add_f32_dpp v229, v229, v229 row_ror:1 row_mask:0xf bank_mask:0xf
    s_nop 1
    v_add_f32_dpp v228, v228, v228 row_bcast:15 row_mask:0xa bank_mask:0xf
    v_add_f32_dpp v229, v229, v229 row_bcast:15 row_mask:0xa bank_mask:0xf
    s_nop 0
    v_mul_f32 v230, 0x3acccccd, v228
    v_mul_f32 v229, 0x3acccccd, v229
    v_fma_f32 v229, -v230, v230, v229
    v_max_f32 v229, 0, v229
    v_add_f32 v229, 0x3727c5ac, v229
    v_rsq_f32_e64 v231, v229
    s_mov_b32 s78, 65536
    s_mov_b32 exec_lo, 0x10000
    s_mov_b32 exec_hi, 0x10000
    buffer_store_dwordx2 v[230:231], v226, s[36:39], s78 offen sc1
    s_mov_b64 exec, -1
    s_waitcnt vmcnt(9) lgkmcnt(0)
    s_barrier
    s_add_u32 s56, s56, 2654435769
    v_mov_b32 v31, s56
    ds_read_b128 v[48:51], v10 offset:0
    ds_read_b64_tr_b16 v[32:33], v2 offset:16384
    ds_read_b64_tr_b16 v[34:35], v2 offset:17408
    ds_read_b128 v[52:55], v10 offset:2048
    ds_read_b64_tr_b16 v[36:37], v3 offset:16384
    ds_read_b64_tr_b16 v[38:39], v3 offset:17408
    ds_read_b128 v[56:59], v10 offset:4096
    ds_read_b64_tr_b16 v[40:41], v4 offset:16384
    ds_read_b64_tr_b16 v[42:43], v4 offset:17408
    ds_read_b128 v[60:63], v10 offset:6144
    ds_read_b64_tr_b16 v[44:45], v5 offset:16384
    ds_read_b64_tr_b16 v[46:47], v5 offset:17408
    ds_read_b128 v[96:99], v204 offset:0
    ds_read_b128 v[100:103], v204 offset:4096
    s_add_u32 m0, s62, 65536
    s_nop 0
    buffer_load_dwordx4 v240, s[32:35], s60 offen offset:0 lds
    buffer_load_dwordx4 v241, s[32:35], s60 offen offset:1024 lds
    buffer_load_dwordx4 v242, s[32:35], s60 offen offset:2048 lds
    buffer_load_dwordx4 v243, s[32:35], s60 offen offset:3072 lds
    s_waitcnt lgkmcnt(0)
    v_mfma_f32_16x16x32_bf16 v[128:131], v[32:35], v[48:51], 0
    ds_read_b128 v[80:83], v11 offset:0
    buffer_store_dwordx4 v[96:99], v205, s[36:39], s59 offen sc1
    v_mfma_f32_16x16x32_bf16 v[132:135], v[32:35], v[52:55], 0
    ds_read_b64_tr_b16 v[64:65], v2 offset:24576
    buffer_store_dwordx4 v[100:103], v206, s[36:39], s59 offen sc1
    v_mfma_f32_16x16x32_bf16 v[136:139], v[32:35], v[56:59], 0
    ds_read_b64_tr_b16 v[66:67], v2 offset:25600
    v_mfma_f32_16x16x32_bf16 v[140:143], v[32:35], v[60:63], 0
    ds_read_b128 v[84:87], v11 offset:2048
    v_mfma_f32_16x16x32_bf16 v[192:195], v[32:35], v[20:23], 0
    ds_read_b64_tr_b16 v[68:69], v3 offset:24576
    v_mfma_f32_16x16x32_bf16 v[144:147], v[36:39], v[48:51], 0
    ds_read_b64_tr_b16 v[70:71], v3 offset:25600
    s_add_u32 m0, s62, 81920
    v_mfma_f32_16x16x32_bf16 v[148:151], v[36:39], v[52:55], 0
    ds_read_b128 v[88:91], v11 offset:4096
    v_mfma_f32_16x16x32_bf16 v[152:155], v[36:39], v[56:59], 0
    ds_read_b64_tr_b16 v[72:73], v4 offset:24576
    buffer_load_dwordx4 v244, s[40:43], s61 offen offset:0 lds
    v_mfma_f32_16x16x32_bf16 v[156:159], v[36:39], v[60:63], 0
    ds_read_b64_tr_b16 v[74:75], v4 offset:25600
    v_mfma_f32_16x16x32_bf16 v[196:199], v[36:39], v[20:23], 0
    ds_read_b128 v[92:95], v11 offset:6144
    v_mfma_f32_16x16x32_bf16 v[160:163], v[40:43], v[48:51], 0
    ds_read_b64_tr_b16 v[76:77], v5 offset:24576
    buffer_load_dwordx4 v245, s[40:43], s61 offen offset:1024 lds
    v_mfma_f32_16x16x32_bf16 v[164:167], v[40:43], v[52:55], 0
    ds_read_b64_tr_b16 v[78:79], v5 offset:25600
    v_mfma_f32_16x16x32_bf16 v[168:171], v[40:43], v[56:59], 0
    v_mfma_f32_16x16x32_bf16 v[172:175], v[40:43], v[60:63], 0
    buffer_load_dwordx4 v246, s[40:43], s61 offen offset:2048 lds
    v_mfma_f32_16x16x32_bf16 v[176:179], v[44:47], v[48:51], 0
    v_mfma_f32_16x16x32_bf16 v[180:183], v[44:47], v[52:55], 0
    buffer_load_dwordx4 v247, s[40:43], s61 offen offset:3072 lds
    s_bitcmp1_b32 s0, 2
    s_cselect_b32 s87, s85, 128
    s_cselect_b32 s88, s86, 221184
    v_mfma_f32_16x16x32_bf16 v[184:187], v[44:47], v[56:59], 0
    s_add_u32 s60, s60, s87
    v_mfma_f32_16x16x32_bf16 v[188:191], v[44:47], v[60:63], 0
    s_add_u32 s61, s61, s88
    s_waitcnt vmcnt(11) lgkmcnt(0)
    s_barrier
    s_nop 0
    v_mfma_f32_16x16x32_bf16 v[128:131], v[64:67], v[80:83], v[128:131]
    ds_read_b128 v[48:51], v10 offset:32768
    s_add_u32 m0, s62, 98304
    v_mfma_f32_16x16x32_bf16 v[132:135], v[64:67], v[84:87], v[132:135]
    ds_read_b64_tr_b16 v[32:33], v2 offset:49152
    v_mov_b32 v30, 17563648
    v_mfma_f32_16x16x32_bf16 v[136:139], v[64:67], v[88:91], v[136:139]
    ds_read_b64_tr_b16 v[34:35], v2 offset:50176
    buffer_load_dwordx4 v240, s[32:35], s60 offen offset:0 lds
    v_mfma_f32_16x16x32_bf16 v[140:143], v[64:67], v[92:95], v[140:143]
    ds_read_b128 v[52:55], v10 offset:34816
    s_cmp_eq_u32 s3, 0
    s_nop 0
    s_cselect_b32 s80, s84, 17563648
    v_mfma_f32_16x16x32_bf16 v[192:195], v[64:67], v[20:23], v[192:195]
    ds_read_b64_tr_b16 v[36:37], v3 offset:49152
    v_mfma_f32_16x16x32_bf16 v[144:147], v[68:71], v[80:83], v[144:147]
    ds_read_b64_tr_b16 v[38:39], v3 offset:50176
    v_mfma_f32_16x16x32_bf16 v[148:151], v[68:71], v[84:87], v[148:151]
    ds_read_b128 v[56:59], v10 offset:36864
    buffer_load_dwordx4 v241, s[32:35], s60 offen offset:1024 lds
    v_mfma_f32_16x16x32_bf16 v[152:155], v[68:71], v[88:91], v[152:155]
    ds_read_b64_tr_b16 v[40:41], v4 offset:49152
    v_writelane_b32 v30, s80, 1
    v_mfma_f32_16x16x32_bf16 v[156:159], v[68:71], v[92:95], v[156:159]
    ds_read_b64_tr_b16 v[42:43], v4 offset:50176
    v_mfma_f32_16x16x32_bf16 v[196:199], v[68:71], v[20:23], v[196:199]
    ds_read_b128 v[60:63], v10 offset:38912
    s_lshl_b32 s77, s57, 1
    v_mfma_f32_16x16x32_bf16 v[160:163], v[72:75], v[80:83], v[160:163]
    ds_read_b64_tr_b16 v[44:45], v5 offset:49152
    s_lshr_b32 s78, s58, 4
    v_mfma_f32_16x16x32_bf16 v[164:167], v[72:75], v[84:87], v[164:167]
    ds_read_b64_tr_b16 v[46:47], v5 offset:50176
    buffer_load_dwordx4 v242, s[32:35], s60 offen offset:2048 lds
    v_mfma_f32_16x16x32_bf16 v[168:171], v[72:75], v[88:91], v[168:171]
    s_add_u32 s77, s77, s78
    v_mfma_f32_16x16x32_bf16 v[172:175], v[72:75], v[92:95], v[172:175]
    s_lshl_b32 s77, s77, 4
    v_mfma_f32_16x16x32_bf16 v[176:179], v[76:79], v[80:83], v[176:179]
    s_and_b32 s78, s58, 15
    v_mfma_f32_16x16x32_bf16 v[180:183], v[76:79], v[84:87], v[180:183]
    buffer_load_dwordx4 v243, s[32:35], s60 offen offset:3072 lds
    s_add_u32 s77, s77, s78
    v_mfma_f32_16x16x32_bf16 v[184:187], v[76:79], v[88:91], v[184:187]
    s_lshl_b32 s77, s77, 6
    v_mfma_f32_16x16x32_bf16 v[188:191], v[76:79], v[92:95], v[188:191]
    s_add_u32 s77, s77, 196608
    s_waitcnt lgkmcnt(0)
    v_mfma_f32_16x16x32_bf16 v[128:131], v[32:35], v[48:51], v[128:131]
    ds_read_b128 v[80:83], v11 offset:32768
    s_add_u32 m0, s62, 114688
    v_mfma_f32_16x16x32_bf16 v[132:135], v[32:35], v[52:55], v[132:135]
    ds_read_b64_tr_b16 v[64:65], v2 offset:57344
    s_cmp_eq_u32 s3, 0
    s_nop 0
    s_cselect_b32 s77, s77, 17563648
    v_mfma_f32_16x16x32_bf16 v[136:139], v[32:35], v[56:59], v[136:139]
    ds_read_b64_tr_b16 v[66:67], v2 offset:58368
    buffer_load_dwordx4 v244, s[40:43], s61 offen offset:0 lds
    v_mfma_f32_16x16x32_bf16 v[140:143], v[32:35], v[60:63], v[140:143]
    ds_read_b128 v[84:87], v11 offset:34816
    v_mfma_f32_16x16x32_bf16 v[192:195], v[32:35], v[20:23], v[192:195]
    ds_read_b64_tr_b16 v[68:69], v3 offset:57344
    v_writelane_b32 v30, s77, 0
    v_mfma_f32_16x16x32_bf16 v[144:147], v[36:39], v[48:51], v[144:147]
    ds_read_b64_tr_b16 v[70:71], v3 offset:58368
    s_and_b32 s77, s58, 7
    v_mfma_f32_16x16x32_bf16 v[148:151], v[36:39], v[52:55], v[148:151]
    ds_read_b128 v[88:91], v11 offset:36864
    buffer_load_dwordx4 v245, s[40:43], s61 offen offset:1024 lds
    v_mfma_f32_16x16x32_bf16 v[152:155], v[36:39], v[56:59], v[152:155]
    ds_read_b64_tr_b16 v[72:73], v4 offset:57344
    s_lshl_b32 s77, s77, 5
    v_mfma_f32_16x16x32_bf16 v[156:159], v[36:39], v[60:63], v[156:159]
    ds_read_b64_tr_b16 v[74:75], v4 offset:58368
    s_lshl_b32 s78, s57, 2
    v_mfma_f32_16x16x32_bf16 v[196:199], v[36:39], v[20:23], v[196:199]
    ds_read_b128 v[92:95], v11 offset:38912
    s_lshr_b32 s79, s58, 3
    v_mfma_f32_16x16x32_bf16 v[160:163], v[40:43], v[48:51], v[160:163]
    ds_read_b64_tr_b16 v[76:77], v5 offset:57344
    buffer_load_dwordx4 v246, s[40:43], s61 offen offset:2048 lds
    v_mfma_f32_16x16x32_bf16 v[164:167], v[40:43], v[52:55], v[164:167]
    ds_read_b64_tr_b16 v[78:79], v5 offset:58368
    s_add_u32 s78, s78, s79
    v_mfma_f32_16x16x32_bf16 v[168:171], v[40:43], v[56:59], v[168:171]
    s_add_u32 s77, s77, s78
    s_lshl_b32 s77, s77, 6
    v_mfma_f32_16x16x32_bf16 v[172:175], v[40:43], v[60:63], v[172:175]
    buffer_load_dwordx4 v247, s[40:43], s61 offen offset:3072 lds
    s_add_u32 s77, s77, 163840
    v_mfma_f32_16x16x32_bf16 v[176:179], v[44:47], v[48:51], v[176:179]
    s_cmp_eq_u32 s3, 0
    s_cselect_b32 s77, s77, 17563648
    v_mfma_f32_16x16x32_bf16 v[180:183], v[44:47], v[52:55], v[180:183]
    s_bitcmp1_b32 s0, 3
    s_cselect_b32 s87, s85, 128
    s_cselect_b32 s88, s86, 221184
    v_mfma_f32_16x16x32_bf16 v[184:187], v[44:47], v[56:59], v[184:187]
    s_add_u32 s60, s60, s87
    v_writelane_b32 v30, s77, 2
    v_mfma_f32_16x16x32_bf16 v[188:191], v[44:47], v[60:63], v[188:191]
    s_add_u32 s61, s61, s88
    s_waitcnt vmcnt(8) lgkmcnt(0)
    s_barrier
    s_mov_b32 exec_lo, 3
    s_mov_b32 exec_hi, 0
    buffer_store_dword v31, v30, s[36:39], 0 offen sc1
    s_mov_b64 exec, -1
    v_mfma_f32_16x16x32_bf16 v[128:131], v[64:67], v[80:83], v[128:131]
    ds_read_b128 v[48:51], v12 offset:0
    s_lshl_b32 m0, s3, 10
    s_add_u32 m0, m0, 139776
    s_nop 0
    buffer_load_dwordx4 v253, s[44:47], 0 offen nt lds
    v_mfma_f32_16x16x32_bf16 v[132:135], v[64:67], v[84:87], v[132:135]
    ds_read_b64_tr_b16 v[32:33], v6 offset:16384
    s_lshl_b32 m0, s3, 10
    s_add_u32 m0, m0, 143872
    s_nop 0
    buffer_load_dwordx4 v254, s[44:47], 0 offen nt lds
    v_mfma_f32_16x16x32_bf16 v[136:139], v[64:67], v[88:91], v[136:139]
    ds_read_b64_tr_b16 v[34:35], v6 offset:17408
    s_lshl_b32 m0, s3, 10
    s_add_u32 m0, m0, 147968
    s_nop 0
    buffer_load_dwordx4 v255, s[44:47], 0 offen nt lds
    v_mfma_f32_16x16x32_bf16 v[140:143], v[64:67], v[92:95], v[140:143]
    ds_read_b128 v[52:55], v12 offset:2048
    v_min_u32_e64 v28, 15, v0
    v_mfma_f32_16x16x32_bf16 v[192:195], v[64:67], v[20:23], v[192:195]
    ds_read_b64_tr_b16 v[36:37], v7 offset:16384
    v_mfma_f32_16x16x32_bf16 v[144:147], v[68:71], v[80:83], v[144:147]
    ds_read_b64_tr_b16 v[38:39], v7 offset:17408
    s_add_u32 m0, s62, 0
    v_mfma_f32_16x16x32_bf16 v[148:151], v[68:71], v[84:87], v[148:151]
    ds_read_b128 v[56:59], v12 offset:4096
    v_lshlrev_b32 v28, 6, v28
    v_mfma_f32_16x16x32_bf16 v[152:155], v[68:71], v[88:91], v[152:155]
    ds_read_b64_tr_b16 v[40:41], v8 offset:16384
    buffer_load_dwordx4 v240, s[32:35], s60 offen offset:0 lds
    v_mfma_f32_16x16x32_bf16 v[156:159], v[68:71], v[92:95], v[156:159]
    ds_read_b64_tr_b16 v[42:43], v8 offset:17408
    v_mfma_f32_16x16x32_bf16 v[196:199], v[68:71], v[20:23], v[196:199]
    ds_read_b128 v[60:63], v12 offset:6144
    v_mfma_f32_16x16x32_bf16 v[160:163], v[72:75], v[80:83], v[160:163]
    ds_read_b64_tr_b16 v[44:45], v9 offset:16384
    buffer_load_dwordx4 v241, s[32:35], s60 offen offset:1024 lds
    v_mfma_f32_16x16x32_bf16 v[164:167], v[72:75], v[84:87], v[164:167]
    ds_read_b64_tr_b16 v[46:47], v9 offset:17408
    s_lshl_b32 s73, s63, 10
    v_mfma_f32_16x16x32_bf16 v[168:171], v[72:75], v[88:91], v[168:171]
    v_mfma_f32_16x16x32_bf16 v[172:175], v[72:75], v[92:95], v[172:175]
    buffer_load_dwordx4 v242, s[32:35], s60 offen offset:2048 lds
    s_add_u32 s73, s73, 196608
    v_mfma_f32_16x16x32_bf16 v[176:179], v[76:79], v[80:83], v[176:179]
    v_add_u32 v28, s73, v28
    v_mfma_f32_16x16x32_bf16 v[180:183], v[76:79], v[84:87], v[180:183]
    buffer_load_dwordx4 v243, s[32:35], s60 offen offset:3072 lds
    v_mfma_f32_16x16x32_bf16 v[184:187], v[76:79], v[88:91], v[184:187]
    s_mov_b32 s48, s20
    v_mfma_f32_16x16x32_bf16 v[188:191], v[76:79], v[92:95], v[188:191]
    s_waitcnt lgkmcnt(0)
    v_mfma_f32_16x16x32_bf16 v[128:131], v[32:35], v[48:51], v[128:131]
    ds_read_b128 v[80:83], v13 offset:0
    s_add_u32 m0, s62, 16384
    v_mfma_f32_16x16x32_bf16 v[132:135], v[32:35], v[52:55], v[132:135]
    ds_read_b64_tr_b16 v[64:65], v6 offset:24576
    s_mov_b32 s49, s21
    s_nop 0
    v_mfma_f32_16x16x32_bf16 v[136:139], v[32:35], v[56:59], v[136:139]
    ds_read_b64_tr_b16 v[66:67], v6 offset:25600
    buffer_load_dwordx4 v244, s[40:43], s61 offen offset:0 lds
    v_mfma_f32_16x16x32_bf16 v[140:143], v[32:35], v[60:63], v[140:143]
    ds_read_b128 v[84:87], v13 offset:2048
    v_mfma_f32_16x16x32_bf16 v[192:195], v[32:35], v[20:23], v[192:195]
    ds_read_b64_tr_b16 v[68:69], v7 offset:24576
    s_mov_b32 s50, 3456
    v_mfma_f32_16x16x32_bf16 v[144:147], v[36:39], v[48:51], v[144:147]
    ds_read_b64_tr_b16 v[70:71], v7 offset:25600
    v_mfma_f32_16x16x32_bf16 v[148:151], v[36:39], v[52:55], v[148:151]
    ds_read_b128 v[88:91], v13 offset:4096
    buffer_load_dwordx4 v245, s[40:43], s61 offen offset:1024 lds
    v_mfma_f32_16x16x32_bf16 v[152:155], v[36:39], v[56:59], v[152:155]
    ds_read_b64_tr_b16 v[72:73], v8 offset:24576
    v_mfma_f32_16x16x32_bf16 v[156:159], v[36:39], v[60:63], v[156:159]
    ds_read_b64_tr_b16 v[74:75], v8 offset:25600
    s_mov_b32 s51, 0x20000
    v_mfma_f32_16x16x32_bf16 v[196:199], v[36:39], v[20:23], v[196:199]
    ds_read_b128 v[92:95], v13 offset:6144
    v_mfma_f32_16x16x32_bf16 v[160:163], v[40:43], v[48:51], v[160:163]
    ds_read_b64_tr_b16 v[76:77], v9 offset:24576
    buffer_load_dwordx4 v246, s[40:43], s61 offen offset:2048 lds
    v_mfma_f32_16x16x32_bf16 v[164:167], v[40:43], v[52:55], v[164:167]
    ds_read_b64_tr_b16 v[78:79], v9 offset:25600
    v_lshrrev_b32 v24, 4, v0
    v_mfma_f32_16x16x32_bf16 v[168:171], v[40:43], v[56:59], v[168:171]
    v_mfma_f32_16x16x32_bf16 v[172:175], v[40:43], v[60:63], v[172:175]
    buffer_load_dwordx4 v247, s[40:43], s61 offen offset:3072 lds
    s_lshl_b32 s73, s69, 5
    v_mfma_f32_16x16x32_bf16 v[176:179], v[44:47], v[48:51], v[176:179]
    v_lshl_add_u32 v232, v24, 3, s73
    v_mfma_f32_16x16x32_bf16 v[180:183], v[44:47], v[52:55], v[180:183]
    s_bitcmp1_b32 s0, 4
    s_cselect_b32 s87, s85, 128
    s_cselect_b32 s88, s86, 221184
    v_mfma_f32_16x16x32_bf16 v[184:187], v[44:47], v[56:59], v[184:187]
    s_add_u32 s60, s60, s87
    v_mfma_f32_16x16x32_bf16 v[188:191], v[44:47], v[60:63], v[188:191]
    s_add_u32 s61, s61, s88
    s_waitcnt vmcnt(12) lgkmcnt(0)
    s_barrier
    v_mfma_f32_16x16x32_bf16 v[128:131], v[64:67], v[80:83], v[128:131]
    ds_read_b128 v[48:51], v12 offset:32768
    s_add_u32 m0, s62, 32768
    v_mfma_f32_16x16x32_bf16 v[132:135], v[64:67], v[84:87], v[132:135]
    ds_read_b64_tr_b16 v[32:33], v6 offset:49152
    s_lshl_b32 s73, s70, 5
    v_mfma_f32_16x16x32_bf16 v[136:139], v[64:67], v[88:91], v[136:139]
    ds_read_b64_tr_b16 v[34:35], v6 offset:50176
    buffer_load_dwordx4 v240, s[32:35], s60 offen offset:0 lds
    v_mfma_f32_16x16x32_bf16 v[140:143], v[64:67], v[92:95], v[140:143]
    ds_read_b128 v[52:55], v12 offset:34816
    v_mfma_f32_16x16x32_bf16 v[192:195], v[64:67], v[20:23], v[192:195]
    ds_read_b64_tr_b16 v[36:37], v7 offset:49152
    v_mfma_f32_16x16x32_bf16 v[144:147], v[68:71], v[80:83], v[144:147]
    ds_read_b64_tr_b16 v[38:39], v7 offset:50176
    v_lshl_add_u32 v233, v24, 3, s73
    v_mfma_f32_16x16x32_bf16 v[148:151], v[68:71], v[84:87], v[148:151]
    ds_read_b128 v[56:59], v12 offset:36864
    buffer_load_dwordx4 v241, s[32:35], s60 offen offset:1024 lds
    v_mfma_f32_16x16x32_bf16 v[152:155], v[68:71], v[88:91], v[152:155]
    ds_read_b64_tr_b16 v[40:41], v8 offset:49152
    v_mfma_f32_16x16x32_bf16 v[156:159], v[68:71], v[92:95], v[156:159]
    ds_read_b64_tr_b16 v[42:43], v8 offset:50176
    v_mfma_f32_16x16x32_bf16 v[196:199], v[68:71], v[20:23], v[196:199]
    ds_read_b128 v[60:63], v12 offset:38912
    s_lshl_b32 s73, s71, 5
    v_mfma_f32_16x16x32_bf16 v[160:163], v[72:75], v[80:83], v[160:163]
    ds_read_b64_tr_b16 v[44:45], v9 offset:49152
    v_mfma_f32_16x16x32_bf16 v[164:167], v[72:75], v[84:87], v[164:167]
    ds_read_b64_tr_b16 v[46:47], v9 offset:50176
    buffer_load_dwordx4 v242, s[32:35], s60 offen offset:2048 lds
    v_mfma_f32_16x16x32_bf16 v[168:171], v[72:75], v[88:91], v[168:171]
    v_lshl_add_u32 v234, v24, 3, s73
    v_mfma_f32_16x16x32_bf16 v[172:175], v[72:75], v[92:95], v[172:175]
    v_mfma_f32_16x16x32_bf16 v[176:179], v[76:79], v[80:83], v[176:179]
    s_lshl_b32 s73, s72, 5
    v_mfma_f32_16x16x32_bf16 v[180:183], v[76:79], v[84:87], v[180:183]
    buffer_load_dwordx4 v243, s[32:35], s60 offen offset:3072 lds
    v_mfma_f32_16x16x32_bf16 v[184:187], v[76:79], v[88:91], v[184:187]
    v_lshl_add_u32 v235, v24, 3, s73
    v_mfma_f32_16x16x32_bf16 v[188:191], v[76:79], v[92:95], v[188:191]
    s_waitcnt lgkmcnt(0)
    v_mfma_f32_16x16x32_bf16 v[128:131], v[32:35], v[48:51], v[128:131]
    ds_read_b128 v[80:83], v13 offset:32768
    s_add_u32 m0, s62, 49152
    v_mfma_f32_16x16x32_bf16 v[132:135], v[32:35], v[52:55], v[132:135]
    ds_read_b64_tr_b16 v[64:65], v6 offset:57344
    s_lshr_b32 s78, s57, 1
    v_mfma_f32_16x16x32_bf16 v[136:139], v[32:35], v[56:59], v[136:139]
    ds_read_b64_tr_b16 v[66:67], v6 offset:58368
    buffer_load_dwordx4 v244, s[40:43], s61 offen offset:0 lds
    v_mfma_f32_16x16x32_bf16 v[140:143], v[32:35], v[60:63], v[140:143]
    ds_read_b128 v[84:87], v13 offset:34816
    v_mfma_f32_16x16x32_bf16 v[192:195], v[32:35], v[20:23], v[192:195]
    ds_read_b64_tr_b16 v[68:69], v7 offset:57344
    s_lshl_b32 s78, s78, 3
    s_nop 0
    v_mfma_f32_16x16x32_bf16 v[144:147], v[36:39], v[48:51], v[144:147]
    ds_read_b64_tr_b16 v[70:71], v7 offset:58368
    v_mfma_f32_16x16x32_bf16 v[148:151], v[36:39], v[52:55], v[148:151]
    ds_read_b128 v[88:91], v13 offset:36864
    buffer_load_dwordx4 v245, s[40:43], s61 offen offset:1024 lds
    v_mfma_f32_16x16x32_bf16 v[152:155], v[36:39], v[56:59], v[152:155]
    ds_read_b64_tr_b16 v[72:73], v8 offset:57344
    v_mfma_f32_16x16x32_bf16 v[156:159], v[36:39], v[60:63], v[156:159]
    ds_read_b64_tr_b16 v[74:75], v8 offset:58368
    s_and_b32 s79, s58, 7
    v_mfma_f32_16x16x32_bf16 v[196:199], v[36:39], v[20:23], v[196:199]
    ds_read_b128 v[92:95], v13 offset:38912
    v_mfma_f32_16x16x32_bf16 v[160:163], v[40:43], v[48:51], v[160:163]
    ds_read_b64_tr_b16 v[76:77], v9 offset:57344
    buffer_load_dwordx4 v246, s[40:43], s61 offen offset:2048 lds
    v_mfma_f32_16x16x32_bf16 v[164:167], v[40:43], v[52:55], v[164:167]
    ds_read_b64_tr_b16 v[78:79], v9 offset:58368
    s_add_u32 s53, s78, s79
    v_mfma_f32_16x16x32_bf16 v[168:171], v[40:43], v[56:59], v[168:171]
    v_mfma_f32_16x16x32_bf16 v[172:175], v[40:43], v[60:63], v[172:175]
    buffer_load_dwordx4 v247, s[40:43], s61 offen offset:3072 lds
    s_mul_i32 s28, s79, 7
    v_mfma_f32_16x16x32_bf16 v[176:179], v[44:47], v[48:51], v[176:179]
    s_and_b32 s78, s57, 1
    v_mfma_f32_16x16x32_bf16 v[180:183], v[44:47], v[52:55], v[180:183]
    s_bitcmp1_b32 s0, 5
    s_cselect_b32 s87, s85, 128
    s_cselect_b32 s88, s86, 221184
    v_mfma_f32_16x16x32_bf16 v[184:187], v[44:47], v[56:59], v[184:187]
    s_add_u32 s60, s60, s87
    v_mfma_f32_16x16x32_bf16 v[188:191], v[44:47], v[60:63], v[188:191]
    s_add_u32 s61, s61, s88
    s_waitcnt vmcnt(8) lgkmcnt(0)
    s_barrier
    v_mfma_f32_16x16x32_bf16 v[128:131], v[64:67], v[80:83], v[128:131]
    ds_read_b128 v[48:51], v10 offset:0
    s_add_u32 m0, s62, 65536
    v_mfma_f32_16x16x32_bf16 v[132:135], v[64:67], v[84:87], v[132:135]
    ds_read_b64_tr_b16 v[32:33], v2 offset:16384
    s_lshl_b32 s78, s78, 2
    v_mfma_f32_16x16x32_bf16 v[136:139], v[64:67], v[88:91], v[136:139]
    ds_read_b64_tr_b16 v[34:35], v2 offset:17408
    buffer_load_dwordx4 v240, s[32:35], s60 offen offset:0 lds
    v_mfma_f32_16x16x32_bf16 v[140:143], v[64:67], v[92:95], v[140:143]
    ds_read_b128 v[52:55], v10 offset:2048
    v_mfma_f32_16x16x32_bf16 v[192:195], v[64:67], v[20:23], v[192:195]
    ds_read_b64_tr_b16 v[36:37], v3 offset:16384
    s_lshr_b32 s79, s58, 3
    v_mfma_f32_16x16x32_bf16 v[144:147], v[68:71], v[80:83], v[144:147]
    ds_read_b64_tr_b16 v[38:39], v3 offset:17408
    v_mfma_f32_16x16x32_bf16 v[148:151], v[68:71], v[84:87], v[148:151]
    ds_read_b128 v[56:59], v10 offset:4096
    buffer_load_dwordx4 v241, s[32:35], s60 offen offset:1024 lds
    v_mfma_f32_16x16x32_bf16 v[152:155], v[68:71], v[88:91], v[152:155]
    ds_read_b64_tr_b16 v[40:41], v4 offset:16384
    s_add_u32 s54, s78, s79
    v_mfma_f32_16x16x32_bf16 v[156:159], v[68:71], v[92:95], v[156:159]
    ds_read_b64_tr_b16 v[42:43], v4 offset:17408
    v_mfma_f32_16x16x32_bf16 v[196:199], v[68:71], v[20:23], v[196:199]
    ds_read_b128 v[60:63], v10 offset:6144
    s_mul_i32 s79, s79, 14
    v_mfma_f32_16x16x32_bf16 v[160:163], v[72:75], v[80:83], v[160:163]
    ds_read_b64_tr_b16 v[44:45], v5 offset:16384
    v_mfma_f32_16x16x32_bf16 v[164:167], v[72:75], v[84:87], v[164:167]
    ds_read_b64_tr_b16 v[46:47], v5 offset:17408
    buffer_load_dwordx4 v242, s[32:35], s60 offen offset:2048 lds
    v_mfma_f32_16x16x32_bf16 v[168:171], v[72:75], v[88:91], v[168:171]
    ds_read_b64_tr_b16 v[216:217], v200 offset:0
    s_add_u32 s28, s28, s79
    v_mfma_f32_16x16x32_bf16 v[172:175], v[72:75], v[92:95], v[172:175]
    ds_read_b64_tr_b16 v[218:219], v200 offset:2560
    v_mfma_f32_16x16x32_bf16 v[176:179], v[76:79], v[80:83], v[176:179]
    ds_read_b64_tr_b16 v[220:221], v201 offset:0
    s_lshr_b32 s28, s28, 2
    v_mfma_f32_16x16x32_bf16 v[180:183], v[76:79], v[84:87], v[180:183]
    ds_read_b64_tr_b16 v[222:223], v201 offset:2560
    buffer_load_dwordx4 v243, s[32:35], s60 offen offset:3072 lds
    v_mfma_f32_16x16x32_bf16 v[184:187], v[76:79], v[88:91], v[184:187]
    ds_read_b64_tr_b16 v[224:225], v202 offset:0
    v_mfma_f32_16x16x32_bf16 v[188:191], v[76:79], v[92:95], v[188:191]
    ds_read_b64_tr_b16 v[226:227], v202 offset:2560
    s_waitcnt lgkmcnt(0)
    v_mfma_f32_16x16x32_bf16 v[128:131], v[32:35], v[48:51], v[128:131]
    ds_read_b128 v[80:83], v11 offset:0
    buffer_store_dwordx4 v[216:219], v14, s[36:39], s74 offen sc1
    v_mfma_f32_16x16x32_bf16 v[132:135], v[32:35], v[52:55], v[132:135]
    ds_read_b64_tr_b16 v[64:65], v2 offset:24576
    buffer_store_dwordx4 v[220:223], v14, s[36:39], s75 offen sc1
    v_mfma_f32_16x16x32_bf16 v[136:139], v[32:35], v[56:59], v[136:139]
    ds_read_b64_tr_b16 v[66:67], v2 offset:25600
    buffer_store_dwordx4 v[224:227], v14, s[36:39], s76 offen sc1
    v_mfma_f32_16x16x32_bf16 v[140:143], v[32:35], v[60:63], v[140:143]
    ds_read_b128 v[84:87], v11 offset:2048
    s_cmp_ge_u32 s28, 14
    s_cselect_b32 s79, 14, 0
    v_mfma_f32_16x16x32_bf16 v[192:195], v[32:35], v[20:23], v[192:195]
    ds_read_b64_tr_b16 v[68:69], v3 offset:24576
    v_mfma_f32_16x16x32_bf16 v[144:147], v[36:39], v[48:51], v[144:147]
    ds_read_b64_tr_b16 v[70:71], v3 offset:25600
    s_add_u32 m0, s62, 81920
    v_mfma_f32_16x16x32_bf16 v[148:151], v[36:39], v[52:55], v[148:151]
    ds_read_b128 v[88:91], v11 offset:4096
    s_sub_u32 s28, s28, s79
    v_mfma_f32_16x16x32_bf16 v[152:155], v[36:39], v[56:59], v[152:155]
    ds_read_b64_tr_b16 v[72:73], v4 offset:24576
    buffer_load_dwordx4 v244, s[40:43], s61 offen offset:0 lds
    v_mfma_f32_16x16x32_bf16 v[156:159], v[36:39], v[60:63], v[156:159]
    ds_read_b64_tr_b16 v[74:75], v4 offset:25600
    v_mfma_f32_16x16x32_bf16 v[196:199], v[36:39], v[20:23], v[196:199]
    ds_read_b128 v[92:95], v11 offset:6144
    s_mov_b32 s28, 0
    v_mfma_f32_16x16x32_bf16 v[160:163], v[40:43], v[48:51], v[160:163]
    ds_read_b64_tr_b16 v[76:77], v5 offset:24576
    buffer_load_dwordx4 v245, s[40:43], s61 offen offset:1024 lds
    v_mfma_f32_16x16x32_bf16 v[164:167], v[40:43], v[52:55], v[164:167]
    ds_read_b64_tr_b16 v[78:79], v5 offset:25600
    s_mul_i32 s55, s3, 14
    v_mfma_f32_16x16x32_bf16 v[168:171], v[40:43], v[56:59], v[168:171]
    s_sub_u32 s79, s3, 1
    v_mfma_f32_16x16x32_bf16 v[172:175], v[40:43], v[60:63], v[172:175]
    buffer_load_dwordx4 v246, s[40:43], s61 offen offset:2048 lds
    s_cmp_ge_u32 s3, 2
    s_cselect_b32 s79, s79, 0
    v_mfma_f32_16x16x32_bf16 v[176:179], v[44:47], v[48:51], v[176:179]
    v_mfma_f32_16x16x32_bf16 v[180:183], v[44:47], v[52:55], v[180:183]
    buffer_load_dwordx4 v247, s[40:43], s61 offen offset:3072 lds
    s_bitcmp1_b32 s0, 6
    s_cselect_b32 s87, s85, 128
    s_cselect_b32 s88, s86, 221184
    v_mfma_f32_16x16x32_bf16 v[184:187], v[44:47], v[56:59], v[184:187]
    s_add_u32 s60, s60, s87
    s_sub_u32 s55, s55, s79
    v_mfma_f32_16x16x32_bf16 v[188:191], v[44:47], v[60:63], v[188:191]
    s_add_u32 s61, s61, s88
    s_waitcnt vmcnt(11) lgkmcnt(0)
    s_barrier
    v_mfma_f32_16x16x32_bf16 v[128:131], v[64:67], v[80:83], v[128:131]
    ds_read_b128 v[48:51], v10 offset:32768
    s_add_u32 m0, s62, 98304
    v_mfma_f32_16x16x32_bf16 v[132:135], v[64:67], v[84:87], v[132:135]
    ds_read_b64_tr_b16 v[32:33], v2 offset:49152
    s_mul_i32 s79, s54, 54
    s_nop 0
    v_mfma_f32_16x16x32_bf16 v[136:139], v[64:67], v[88:91], v[136:139]
    ds_read_b64_tr_b16 v[34:35], v2 offset:50176
    buffer_load_dwordx4 v240, s[32:35], s60 offen offset:0 lds
    v_mfma_f32_16x16x32_bf16 v[140:143], v[64:67], v[92:95], v[140:143]
    ds_read_b128 v[52:55], v10 offset:34816
    v_mfma_f32_16x16x32_bf16 v[192:195], v[64:67], v[20:23], v[192:195]
    ds_read_b64_tr_b16 v[36:37], v3 offset:49152
    v_mfma_f32_16x16x32_bf16 v[144:147], v[68:71], v[80:83], v[144:147]
    ds_read_b64_tr_b16 v[38:39], v3 offset:50176
    s_add_u32 s79, s79, s55
    s_nop 0
    v_mfma_f32_16x16x32_bf16 v[148:151], v[68:71], v[84:87], v[148:151]
    ds_read_b128 v[56:59], v10 offset:36864
    buffer_load_dwordx4 v241, s[32:35], s60 offen offset:1024 lds
    v_mfma_f32_16x16x32_bf16 v[152:155], v[68:71], v[88:91], v[152:155]
    ds_read_b64_tr_b16 v[40:41], v4 offset:49152
    v_mfma_f32_16x16x32_bf16 v[156:159], v[68:71], v[92:95], v[156:159]
    ds_read_b64_tr_b16 v[42:43], v4 offset:50176
    v_mfma_f32_16x16x32_bf16 v[196:199], v[68:71], v[20:23], v[196:199]
    ds_read_b128 v[60:63], v10 offset:38912
    s_mul_i32 s79, s79, 5120
    v_mfma_f32_16x16x32_bf16 v[160:163], v[72:75], v[80:83], v[160:163]
    ds_read_b64_tr_b16 v[44:45], v5 offset:49152
    v_mfma_f32_16x16x32_bf16 v[164:167], v[72:75], v[84:87], v[164:167]
    ds_read_b64_tr_b16 v[46:47], v5 offset:50176
    buffer_load_dwordx4 v242, s[32:35], s60 offen offset:2048 lds
    v_mfma_f32_16x16x32_bf16 v[168:171], v[72:75], v[88:91], v[168:171]
    s_add_u32 s79, s79, 4194304
    v_mfma_f32_16x16x32_bf16 v[172:175], v[72:75], v[92:95], v[172:175]
    v_mfma_f32_16x16x32_bf16 v[176:179], v[76:79], v[80:83], v[176:179]
    s_add_u32 s16, s79, 71680
    v_mfma_f32_16x16x32_bf16 v[180:183], v[76:79], v[84:87], v[180:183]
    buffer_load_dwordx4 v243, s[32:35], s60 offen offset:3072 lds
    v_mfma_f32_16x16x32_bf16 v[184:187], v[76:79], v[88:91], v[184:187]
    s_mul_i32 s52, s28, 5120
    v_mfma_f32_16x16x32_bf16 v[188:191], v[76:79], v[92:95], v[188:191]
    s_waitcnt lgkmcnt(0)
    v_mfma_f32_16x16x32_bf16 v[128:131], v[32:35], v[48:51], v[128:131]
    ds_read_b128 v[80:83], v11 offset:32768
    s_add_u32 m0, s62, 114688
    s_add_u32 s52, s52, s79
    v_mfma_f32_16x16x32_bf16 v[132:135], v[32:35], v[52:55], v[132:135]
    ds_read_b64_tr_b16 v[64:65], v2 offset:57344
    v_lshlrev_b32_e64 v14, 4, v0
    v_mfma_f32_16x16x32_bf16 v[136:139], v[32:35], v[56:59], v[136:139]
    ds_read_b64_tr_b16 v[66:67], v2 offset:58368
    buffer_load_dwordx4 v244, s[40:43], s61 offen offset:0 lds
    v_add_u32 v15, 4096, v14
PAGE2:
    s_cbranch_execz VISIT_RET
    v_mfma_f32_16x16x32_bf16 v[140:143], v[32:35], v[60:63], v[140:143]
    ds_read_b128 v[84:87], v11 offset:34816
    s_mul_i32 s84, s57, 56
    v_mfma_f32_16x16x32_bf16 v[192:195], v[32:35], v[20:23], v[192:195]
    ds_read_b64_tr_b16 v[68:69], v3 offset:57344
    s_lshl_b32 s78, s58, 1
    v_mfma_f32_16x16x32_bf16 v[144:147], v[36:39], v[48:51], v[144:147]
    ds_read_b64_tr_b16 v[70:71], v3 offset:58368
    s_add_u32 s84, s84, s78
    v_mfma_f32_16x16x32_bf16 v[148:151], v[36:39], v[52:55], v[148:151]
    ds_read_b128 v[88:91], v11 offset:36864
    buffer_load_dwordx4 v245, s[40:43], s61 offen offset:1024 lds
    s_mul_i32 s1, s57, 28
    v_mfma_f32_16x16x32_bf16 v[152:155], v[36:39], v[56:59], v[152:155]
    ds_read_b64_tr_b16 v[72:73], v4 offset:57344
    s_add_u32 s1, s1, s58
    v_mfma_f32_16x16x32_bf16 v[156:159], v[36:39], v[60:63], v[156:159]
    ds_read_b64_tr_b16 v[74:75], v4 offset:58368
    s_lshl_b32 s1, s1, 2
    v_mfma_f32_16x16x32_bf16 v[196:199], v[36:39], v[20:23], v[196:199]
    ds_read_b128 v[92:95], v11 offset:38912
    s_add_u32 s1, s1, s3
    v_mfma_f32_16x16x32_bf16 v[160:163], v[40:43], v[48:51], v[160:163]
    ds_read_b64_tr_b16 v[76:77], v5 offset:57344
    buffer_load_dwordx4 v246, s[40:43], s61 offen offset:2048 lds
    s_lshl_b32 s1, s1, 11
    v_mfma_f32_16x16x32_bf16 v[164:167], v[40:43], v[52:55], v[164:167]
    ds_read_b64_tr_b16 v[78:79], v5 offset:58368
    s_mov_b32 s80, s12
    v_mfma_f32_16x16x32_bf16 v[168:171], v[40:43], v[56:59], v[168:171]
    s_mov_b32 s81, s13
    s_mov_b32 s82, 2621440
    v_mfma_f32_16x16x32_bf16 v[172:175], v[40:43], v[60:63], v[172:175]
    buffer_load_dwordx4 v247, s[40:43], s61 offen offset:3072 lds
    s_mov_b32 s83, 0x20000
    v_mfma_f32_16x16x32_bf16 v[176:179], v[44:47], v[48:51], v[176:179]
    v_min_u32 v127, 15, v0
    v_mfma_f32_16x16x32_bf16 v[180:183], v[44:47], v[52:55], v[180:183]
    s_bitcmp1_b32 s0, 7
    s_cselect_b32 s87, s85, 128
    s_cselect_b32 s88, s86, 221184
    v_mfma_f32_16x16x32_bf16 v[184:187], v[44:47], v[56:59], v[184:187]
    s_add_u32 s60, s60, s87
    v_lshlrev_b32 v127, 7, v127
    v_mfma_f32_16x16x32_bf16 v[188:191], v[44:47], v[60:63], v[188:191]
    s_add_u32 s61, s61, s88
    buffer_load_dword v127, v127, s[80:83], s1 offen
    s_waitcnt vmcnt(9) lgkmcnt(0)
    s_barrier
    s_mov_b32 exec_lo, 4
    s_mov_b32 exec_hi, 0
    buffer_store_dword v31, v30, s[36:39], 0 offen sc1
    s_mov_b64 exec, -1
    v_mfma_f32_16x16x32_bf16 v[128:131], v[64:67], v[80:83], v[128:131]
    ds_read_b128 v[48:51], v12 offset:0
    s_add_u32 m0, s62, 0
    v_mfma_f32_16x16x32_bf16 v[132:135], v[64:67], v[84:87], v[132:135]
    ds_read_b64_tr_b16 v[32:33], v6 offset:16384
    s_lshr_b32 s77, s84, 6
    v_mfma_f32_16x16x32_bf16 v[136:139], v[64:67], v[88:91], v[136:139]
    ds_read_b64_tr_b16 v[34:35], v6 offset:17408
    buffer_load_dwordx4 v240, s[32:35], s60 offen offset:0 lds
    v_mfma_f32_16x16x32_bf16 v[140:143], v[64:67], v[92:95], v[140:143]
    ds_read_b128 v[52:55], v12 offset:2048
    v_and_b32 v27, 31, v0
    v_mfma_f32_16x16x32_bf16 v[192:195], v[64:67], v[20:23], v[192:195]
    ds_read_b64_tr_b16 v[36:37], v7 offset:16384
    v_lshlrev_b32 v27, 6, v27
    v_mfma_f32_16x16x32_bf16 v[144:147], v[68:71], v[80:83], v[144:147]
    ds_read_b64_tr_b16 v[38:39], v7 offset:17408
    s_lshl_b32 s73, s77, 11
    v_mfma_f32_16x16x32_bf16 v[148:151], v[68:71], v[84:87], v[148:151]
    ds_read_b128 v[56:59], v12 offset:4096
    buffer_load_dwordx4 v241, s[32:35], s60 offen offset:1024 lds
    v_mfma_f32_16x16x32_bf16 v[152:155], v[68:71], v[88:91], v[152:155]
    ds_read_b64_tr_b16 v[40:41], v8 offset:16384
    v_mfma_f32_16x16x32_bf16 v[156:159], v[68:71], v[92:95], v[156:159]
    ds_read_b64_tr_b16 v[42:43], v8 offset:17408
    s_add_u32 s73, s73, 131072
    v_mfma_f32_16x16x32_bf16 v[196:199], v[68:71], v[20:23], v[196:199]
    ds_read_b128 v[60:63], v12 offset:6144
    s_lshl_b32 s78, s54, 11
    s_nop 0
    v_mfma_f32_16x16x32_bf16 v[160:163], v[72:75], v[80:83], v[160:163]
    ds_read_b64_tr_b16 v[44:45], v9 offset:16384
    v_min_u32 v26, ((C4JOIN-G1_END+511)/512)-1, v0
    v_mfma_f32_16x16x32_bf16 v[164:167], v[72:75], v[84:87], v[164:167]
    ds_read_b64_tr_b16 v[46:47], v9 offset:17408
    buffer_load_dwordx4 v242, s[32:35], s60 offen offset:2048 lds
    v_mfma_f32_16x16x32_bf16 v[168:171], v[72:75], v[88:91], v[168:171]
    s_mul_i32 s80, s3, ((C4JOIN-G1_END+511)/512)
    v_mfma_f32_16x16x32_bf16 v[172:175], v[72:75], v[92:95], v[172:175]
    v_add_u32 v26, s80, v26
    v_lshlrev_b32 v26, 7, v26
    v_mfma_f32_16x16x32_bf16 v[176:179], v[76:79], v[80:83], v[176:179]
    s_getpc_b64 s[80:81]
CT_1:
    s_nop 0
    v_add_u32 v26, G1_END-CT_1, v26
    v_mfma_f32_16x16x32_bf16 v[180:183], v[76:79], v[84:87], v[180:183]
    buffer_load_dwordx4 v243, s[32:35], s60 offen offset:3072 lds
    v_mfma_f32_16x16x32_bf16 v[184:187], v[76:79], v[88:91], v[184:187]
    s_mov_b32 s82, CODE_END-CT_1
    s_mov_b32 s83, 0x20000
    v_mfma_f32_16x16x32_bf16 v[188:191], v[76:79], v[92:95], v[188:191]
    buffer_load_dword v26, v26, s[80:83], 0 offen
    s_waitcnt lgkmcnt(0)
    s_nop 0
    v_mfma_f32_16x16x32_bf16 v[128:131], v[32:35], v[48:51], v[128:131]
    ds_read_b128 v[80:83], v13 offset:0
    s_add_u32 m0, s62, 16384
    v_mfma_f32_16x16x32_bf16 v[132:135], v[32:35], v[52:55], v[132:135]
    ds_read_b64_tr_b16 v[64:65], v6 offset:24576
    s_add_u32 s78, s78, 163840
    v_mfma_f32_16x16x32_bf16 v[136:139], v[32:35], v[56:59], v[136:139]
    ds_read_b64_tr_b16 v[66:67], v6 offset:25600
    buffer_load_dwordx4 v244, s[40:43], s61 offen offset:0 lds
    v_mfma_f32_16x16x32_bf16 v[140:143], v[32:35], v[60:63], v[140:143]
    ds_read_b128 v[84:87], v13 offset:2048
    v_mfma_f32_16x16x32_bf16 v[192:195], v[32:35], v[20:23], v[192:195]
    ds_read_b64_tr_b16 v[68:69], v7 offset:24576
    v_mov_b32_e64 v16, s73
    v_mfma_f32_16x16x32_bf16 v[144:147], v[36:39], v[48:51], v[144:147]
    ds_read_b64_tr_b16 v[70:71], v7 offset:25600
    v_mfma_f32_16x16x32_bf16 v[148:151], v[36:39], v[52:55], v[148:151]
    ds_read_b128 v[88:91], v13 offset:4096
    buffer_load_dwordx4 v245, s[40:43], s61 offen offset:1024 lds
    v_mfma_f32_16x16x32_bf16 v[152:155], v[36:39], v[56:59], v[152:155]
    ds_read_b64_tr_b16 v[72:73], v8 offset:24576
    v_mfma_f32_16x16x32_bf16 v[156:159], v[36:39], v[60:63], v[156:159]
    ds_read_b64_tr_b16 v[74:75], v8 offset:25600
    v_mov_b32_e64 v18, s78
    v_mfma_f32_16x16x32_bf16 v[196:199], v[36:39], v[20:23], v[196:199]
    ds_read_b128 v[92:95], v13 offset:6144
    v_mfma_f32_16x16x32_bf16 v[160:163], v[40:43], v[48:51], v[160:163]
    ds_read_b64_tr_b16 v[76:77], v9 offset:24576
    buffer_load_dwordx4 v246, s[40:43], s61 offen offset:2048 lds
    v_mfma_f32_16x16x32_bf16 v[164:167], v[40:43], v[52:55], v[164:167]
    ds_read_b64_tr_b16 v[78:79], v9 offset:25600
    v_and_b32 v19, 32, v0
    v_mfma_f32_16x16x32_bf16 v[168:171], v[40:43], v[56:59], v[168:171]
    v_mfma_f32_16x16x32_bf16 v[172:175], v[40:43], v[60:63], v[172:175]
    buffer_load_dwordx4 v247, s[40:43], s61 offen offset:3072 lds
    v_cmp_eq_u32 vcc, 0, v19
    v_mfma_f32_16x16x32_bf16 v[176:179], v[44:47], v[48:51], v[176:179]
    s_nop 1
    v_mfma_f32_16x16x32_bf16 v[180:183], v[44:47], v[52:55], v[180:183]
    s_bitcmp1_b32 s0, 8
    s_cselect_b32 s87, s85, 128
    s_cselect_b32 s88, s86, 221184
    v_mfma_f32_16x16x32_bf16 v[184:187], v[44:47], v[56:59], v[184:187]
    s_add_u32 s60, s60, s87
    v_mfma_f32_16x16x32_bf16 v[188:191], v[44:47], v[60:63], v[188:191]
    s_add_u32 s61, s61, s88
    s_waitcnt vmcnt(11) lgkmcnt(0)
    s_barrier
    buffer_load_dword v29, v28, s[36:39], 0 offen sc1
    v_mfma_f32_16x16x32_bf16 v[128:131], v[64:67], v[80:83], v[128:131]
    ds_read_b128 v[48:51], v12 offset:32768
    s_add_u32 m0, s62, 32768
    v_mfma_f32_16x16x32_bf16 v[132:135], v[64:67], v[84:87], v[132:135]
    ds_read_b64_tr_b16 v[32:33], v6 offset:49152
    v_cndmask_b32_e64 v16, v18, v16, vcc
    v_mfma_f32_16x16x32_bf16 v[136:139], v[64:67], v[88:91], v[136:139]
    ds_read_b64_tr_b16 v[34:35], v6 offset:50176
    buffer_load_dwordx4 v240, s[32:35], s60 offen offset:0 lds
    v_mfma_f32_16x16x32_bf16 v[140:143], v[64:67], v[92:95], v[140:143]
    ds_read_b128 v[52:55], v12 offset:34816
    v_mfma_f32_16x16x32_bf16 v[192:195], v[64:67], v[20:23], v[192:195]
    ds_read_b64_tr_b16 v[36:37], v7 offset:49152
    v_mfma_f32_16x16x32_bf16 v[144:147], v[68:71], v[80:83], v[144:147]
    ds_read_b64_tr_b16 v[38:39], v7 offset:50176
    v_add_u32_e64 v27, v16, v27
    v_mfma_f32_16x16x32_bf16 v[148:151], v[68:71], v[84:87], v[148:151]
    ds_read_b128 v[56:59], v12 offset:36864
    buffer_load_dwordx4 v241, s[32:35], s60 offen offset:1024 lds
    v_mfma_f32_16x16x32_bf16 v[152:155], v[68:71], v[88:91], v[152:155]
    ds_read_b64_tr_b16 v[40:41], v8 offset:49152
    v_mfma_f32_16x16x32_bf16 v[156:159], v[68:71], v[92:95], v[156:159]
    ds_read_b64_tr_b16 v[42:43], v8 offset:50176
    v_mfma_f32_16x16x32_bf16 v[196:199], v[68:71], v[20:23], v[196:199]
    ds_read_b128 v[60:63], v12 offset:38912
    s_lshr_b32 s78, s3, 1
    v_mfma_f32_16x16x32_bf16 v[160:163], v[72:75], v[80:83], v[160:163]
    ds_read_b64_tr_b16 v[44:45], v9 offset:49152
    v_mfma_f32_16x16x32_bf16 v[164:167], v[72:75], v[84:87], v[164:167]
    ds_read_b64_tr_b16 v[46:47], v9 offset:50176
    buffer_load_dwordx4 v242, s[32:35], s60 offen offset:2048 lds
    v_mfma_f32_16x16x32_bf16 v[168:171], v[72:75], v[88:91], v[168:171]
    s_add_u32 s84, s84, s78
    v_mfma_f32_16x16x32_bf16 v[172:175], v[72:75], v[92:95], v[172:175]
    v_mfma_f32_16x16x32_bf16 v[176:179], v[76:79], v[80:83], v[176:179]
    s_and_b32 s87, s3, 1
    v_mfma_f32_16x16x32_bf16 v[180:183], v[76:79], v[84:87], v[180:183]
    buffer_load_dwordx4 v243, s[32:35], s60 offen offset:3072 lds
    v_mfma_f32_16x16x32_bf16 v[184:187], v[76:79], v[88:91], v[184:187]
    s_mul_i32 s86, s78, 21248
    v_mfma_f32_16x16x32_bf16 v[188:191], v[76:79], v[92:95], v[188:191]
    s_waitcnt lgkmcnt(0)
    v_mfma_f32_16x16x32_bf16 v[128:131], v[32:35], v[48:51], v[128:131]
    ds_read_b128 v[80:83], v13 offset:32768
    s_add_u32 m0, s62, 49152
    v_mfma_f32_16x16x32_bf16 v[132:135], v[32:35], v[52:55], v[132:135]
    ds_read_b64_tr_b16 v[64:65], v6 offset:57344
    s_lshl_b32 s85, s84, 12
    v_mfma_f32_16x16x32_bf16 v[136:139], v[32:35], v[56:59], v[136:139]
    ds_read_b64_tr_b16 v[66:67], v6 offset:58368
    buffer_load_dwordx4 v244, s[40:43], s61 offen offset:0 lds
    v_mfma_f32_16x16x32_bf16 v[140:143], v[32:35], v[60:63], v[140:143]
    ds_read_b128 v[84:87], v13 offset:34816
    v_mfma_f32_16x16x32_bf16 v[192:195], v[32:35], v[20:23], v[192:195]
    ds_read_b64_tr_b16 v[68:69], v7 offset:57344
    s_add_u32 s44, s12, s85
    s_addc_u32 s45, s13, 0
    s_nop 0
    v_mfma_f32_16x16x32_bf16 v[144:147], v[36:39], v[48:51], v[144:147]
    ds_read_b64_tr_b16 v[70:71], v7 offset:58368
    v_mfma_f32_16x16x32_bf16 v[148:151], v[36:39], v[52:55], v[148:151]
    ds_read_b128 v[88:91], v13 offset:36864
    buffer_load_dwordx4 v245, s[40:43], s61 offen offset:1024 lds
    v_mfma_f32_16x16x32_bf16 v[152:155], v[36:39], v[56:59], v[152:155]
    ds_read_b64_tr_b16 v[72:73], v8 offset:57344
    v_mfma_f32_16x16x32_bf16 v[156:159], v[36:39], v[60:63], v[156:159]
    ds_read_b64_tr_b16 v[74:75], v8 offset:58368
    v_mfma_f32_16x16x32_bf16 v[196:199], v[36:39], v[20:23], v[196:199]
    ds_read_b128 v[92:95], v13 offset:38912
    v_mfma_f32_16x16x32_bf16 v[160:163], v[40:43], v[48:51], v[160:163]
    ds_read_b64_tr_b16 v[76:77], v9 offset:57344
    s_mov_b32 s46, 4096
    v_mfma_f32_16x16x32_bf16 v[164:167], v[40:43], v[52:55], v[164:167]
    ds_read_b64_tr_b16 v[78:79], v9 offset:58368
    buffer_load_dwordx4 v246, s[40:43], s61 offen offset:2048 lds
    v_mfma_f32_16x16x32_bf16 v[168:171], v[40:43], v[56:59], v[168:171]
    s_mov_b32 s47, 0x20000
    v_mfma_f32_16x16x32_bf16 v[172:175], v[40:43], v[60:63], v[172:175]
    s_lshl_b32 s89, s87, 11
    v_mfma_f32_16x16x32_bf16 v[176:179], v[44:47], v[48:51], v[176:179]
    v_mfma_f32_16x16x32_bf16 v[180:183], v[44:47], v[52:55], v[180:183]
    buffer_load_dwordx4 v247, s[40:43], s61 offen offset:3072 lds
    s_add_u32 s88, s85, s89
    v_mfma_f32_16x16x32_bf16 v[184:187], v[44:47], v[56:59], v[184:187]
    s_add_u32 s88, s88, 1048576
    v_mfma_f32_16x16x32_bf16 v[188:191], v[44:47], v[60:63], v[188:191]
    s_waitcnt vmcnt(9) lgkmcnt(0)
    s_barrier
    v_mfma_f32_16x16x32_bf16 v[128:131], v[64:67], v[80:83], v[128:131]
    ds_read_b128 v[48:51], v10 offset:0
    buffer_load_dwordx2 v[208:209], v232, s[48:51], 0 offen
    v_mfma_f32_16x16x32_bf16 v[132:135], v[64:67], v[84:87], v[132:135]
    ds_read_b64_tr_b16 v[32:33], v2 offset:16384
    v_mfma_f32_16x16x32_bf16 v[136:139], v[64:67], v[88:91], v[136:139]
    ds_read_b64_tr_b16 v[34:35], v2 offset:17408
    v_mfma_f32_16x16x32_bf16 v[140:143], v[64:67], v[92:95], v[140:143]
    ds_read_b128 v[52:55], v10 offset:2048
    v_mfma_f32_16x16x32_bf16 v[192:195], v[64:67], v[20:23], v[192:195]
    ds_read_b64_tr_b16 v[36:37], v3 offset:16384
    v_mfma_f32_16x16x32_bf16 v[144:147], v[68:71], v[80:83], v[144:147]
    ds_read_b64_tr_b16 v[38:39], v3 offset:17408
    v_mfma_f32_16x16x32_bf16 v[148:151], v[68:71], v[84:87], v[148:151]
    ds_read_b128 v[56:59], v10 offset:4096
    buffer_load_dwordx2 v[210:211], v233, s[48:51], 0 offen
    v_mfma_f32_16x16x32_bf16 v[152:155], v[68:71], v[88:91], v[152:155]
    ds_read_b64_tr_b16 v[40:41], v4 offset:16384
    v_mfma_f32_16x16x32_bf16 v[156:159], v[68:71], v[92:95], v[156:159]
    ds_read_b64_tr_b16 v[42:43], v4 offset:17408
    v_mfma_f32_16x16x32_bf16 v[196:199], v[68:71], v[20:23], v[196:199]
    ds_read_b128 v[60:63], v10 offset:6144
    v_mfma_f32_16x16x32_bf16 v[160:163], v[72:75], v[80:83], v[160:163]
    ds_read_b64_tr_b16 v[44:45], v5 offset:16384
    v_mfma_f32_16x16x32_bf16 v[164:167], v[72:75], v[84:87], v[164:167]
    ds_read_b64_tr_b16 v[46:47], v5 offset:17408
    v_mfma_f32_16x16x32_bf16 v[168:171], v[72:75], v[88:91], v[168:171]
    buffer_load_dwordx2 v[212:213], v234, s[48:51], 0 offen
    v_mfma_f32_16x16x32_bf16 v[172:175], v[72:75], v[92:95], v[172:175]
    v_mfma_f32_16x16x32_bf16 v[176:179], v[76:79], v[80:83], v[176:179]
    v_mfma_f32_16x16x32_bf16 v[180:183], v[76:79], v[84:87], v[180:183]
    buffer_load_dwordx2 v[214:215], v235, s[48:51], 0 offen
    v_mfma_f32_16x16x32_bf16 v[184:187], v[76:79], v[88:91], v[184:187]
    v_mfma_f32_16x16x32_bf16 v[188:191], v[76:79], v[92:95], v[188:191]
    s_waitcnt lgkmcnt(0)
    v_mfma_f32_16x16x32_bf16 v[128:131], v[32:35], v[48:51], v[128:131]
    ds_read_b128 v[80:83], v11 offset:0
    s_lshl_b32 s79, s53, 6
    v_mfma_f32_16x16x32_bf16 v[132:135], v[32:35], v[52:55], v[132:135]
    ds_read_b64_tr_b16 v[64:65], v2 offset:24576
    s_lshl_b32 s80, s3, 4
    v_mfma_f32_16x16x32_bf16 v[136:139], v[32:35], v[56:59], v[136:139]
    ds_read_b64_tr_b16 v[66:67], v2 offset:25600
    s_add_u32 s79, s79, s80
    v_mfma_f32_16x16x32_bf16 v[140:143], v[32:35], v[60:63], v[140:143]
    ds_read_b128 v[84:87], v11 offset:2048
    v_lshrrev_b32 v116, 2, v0
    v_mfma_f32_16x16x32_bf16 v[192:195], v[32:35], v[20:23], v[192:195]
    ds_read_b64_tr_b16 v[68:69], v3 offset:24576
    v_add_u32 v116, s79, v116
    v_mfma_f32_16x16x32_bf16 v[144:147], v[36:39], v[48:51], v[144:147]
    ds_read_b64_tr_b16 v[70:71], v3 offset:25600
    v_mul_u32_u24 v116, 1280, v116
    v_mfma_f32_16x16x32_bf16 v[148:151], v[36:39], v[52:55], v[148:151]
    ds_read_b128 v[88:91], v11 offset:4096
    s_mul_i32 s80, s54, 160
    v_mfma_f32_16x16x32_bf16 v[152:155], v[36:39], v[56:59], v[152:155]
    ds_read_b64_tr_b16 v[72:73], v4 offset:24576
    v_add_u32 v116, s80, v116
    v_mfma_f32_16x16x32_bf16 v[156:159], v[36:39], v[60:63], v[156:159]
    ds_read_b64_tr_b16 v[74:75], v4 offset:25600
    v_and_b32 v117, 3, v0
    v_mfma_f32_16x16x32_bf16 v[196:199], v[36:39], v[20:23], v[196:199]
    ds_read_b128 v[92:95], v11 offset:6144
    v_lshl_add_u32 v118, v117, 4, v116
    v_mfma_f32_16x16x32_bf16 v[160:163], v[40:43], v[48:51], v[160:163]
    ds_read_b64_tr_b16 v[76:77], v5 offset:24576
    v_lshl_add_u32 v119, v117, 3, v116
    v_mfma_f32_16x16x32_bf16 v[164:167], v[40:43], v[52:55], v[164:167]
    ds_read_b64_tr_b16 v[78:79], v5 offset:25600
    v_mfma_f32_16x16x32_bf16 v[168:171], v[40:43], v[56:59], v[168:171]
    s_mov_b32 s40, s24
    s_mov_b32 s41, s25
    v_mfma_f32_16x16x32_bf16 v[172:175], v[40:43], v[60:63], v[172:175]
    s_mov_b32 s42, 1280
    s_mov_b32 s43, 0x20000
    v_mfma_f32_16x16x32_bf16 v[176:179], v[44:47], v[48:51], v[176:179]
    v_lshrrev_b32 v104, 4, v0
    s_mul_i32 s60, s54, 160
    v_mfma_f32_16x16x32_bf16 v[180:183], v[44:47], v[52:55], v[180:183]
    v_lshlrev_b32 v105, 4, v104
    v_lshlrev_b32_e64 v106, 3, v104
    v_mfma_f32_16x16x32_bf16 v[184:187], v[44:47], v[56:59], v[184:187]
    buffer_load_dwordx4 a[240:243], v105, s[40:43], s60 offen
    buffer_load_dwordx4 a[244:247], v105, s[40:43], s60 offen offset:64
    v_mfma_f32_16x16x32_bf16 v[188:191], v[44:47], v[60:63], v[188:191]
    buffer_load_dwordx2 a[248:249], v106, s[40:43], s60 offen offset:128
    s_waitcnt vmcnt(7) lgkmcnt(0)
    s_waitcnt vmcnt(15)
    v_cmp_ne_u32 vcc, s56, v29
    s_mov_b64 s[82:83], vcc
    s_cmp_eq_u64 s[82:83], 0
    s_cbranch_scc0 P1_RETRY_2
P1_DONE_3:
    s_barrier
    v_mfma_f32_16x16x32_bf16 v[128:131], v[64:67], v[80:83], v[128:131]
    ds_read_b128 v[48:51], v10 offset:32768
    buffer_load_dword v24, v27, s[36:39], 0 offen sc1
    v_mfma_f32_16x16x32_bf16 v[132:135], v[64:67], v[84:87], v[132:135]
    ds_read_b64_tr_b16 v[32:33], v2 offset:49152
    v_mfma_f32_16x16x32_bf16 v[136:139], v[64:67], v[88:91], v[136:139]
    ds_read_b64_tr_b16 v[34:35], v2 offset:50176
    v_and_b32 v16, 15, v0
    v_mfma_f32_16x16x32_bf16 v[140:143], v[64:67], v[92:95], v[140:143]
    ds_read_b128 v[52:55], v10 offset:34816
    v_mfma_f32_16x16x32_bf16 v[192:195], v[64:67], v[20:23], v[192:195]
    ds_read_b64_tr_b16 v[36:37], v3 offset:49152
    v_mfma_f32_16x16x32_bf16 v[144:147], v[68:71], v[80:83], v[144:147]
    ds_read_b64_tr_b16 v[38:39], v3 offset:50176
    v_add_u32_e64 v16, s67, v16
    v_mfma_f32_16x16x32_bf16 v[148:151], v[68:71], v[84:87], v[148:151]
    ds_read_b128 v[56:59], v10 offset:36864
    v_mfma_f32_16x16x32_bf16 v[152:155], v[68:71], v[88:91], v[152:155]
    ds_read_b64_tr_b16 v[40:41], v4 offset:49152
    v_mfma_f32_16x16x32_bf16 v[156:159], v[68:71], v[92:95], v[156:159]
    ds_read_b64_tr_b16 v[42:43], v4 offset:50176
    v_lshlrev_b32_e64 v16, 3, v16
    v_mfma_f32_16x16x32_bf16 v[196:199], v[68:71], v[20:23], v[196:199]
    ds_read_b128 v[60:63], v10 offset:38912
    v_mfma_f32_16x16x32_bf16 v[160:163], v[72:75], v[80:83], v[160:163]
    ds_read_b64_tr_b16 v[44:45], v5 offset:49152
    s_mov_b32 s59, 65536
    v_mfma_f32_16x16x32_bf16 v[164:167], v[72:75], v[84:87], v[164:167]
    ds_read_b64_tr_b16 v[46:47], v5 offset:50176
    v_mfma_f32_16x16x32_bf16 v[168:171], v[72:75], v[88:91], v[168:171]
    buffer_load_dwordx2 v[200:201], v16, s[36:39], s59 offen offset:0 sc1
    v_mfma_f32_16x16x32_bf16 v[172:175], v[72:75], v[92:95], v[172:175]
    v_mfma_f32_16x16x32_bf16 v[176:179], v[76:79], v[80:83], v[176:179]
    buffer_load_dwordx2 v[202:203], v16, s[36:39], s59 offen offset:128 sc1
    v_mfma_f32_16x16x32_bf16 v[180:183], v[76:79], v[84:87], v[180:183]
    buffer_load_dwordx2 v[204:205], v16, s[36:39], s59 offen offset:256 sc1
    v_mfma_f32_16x16x32_bf16 v[184:187], v[76:79], v[88:91], v[184:187]
    buffer_load_dwordx2 v[206:207], v16, s[36:39], s59 offen offset:384 sc1
    v_mfma_f32_16x16x32_bf16 v[188:191], v[76:79], v[92:95], v[188:191]
    s_waitcnt lgkmcnt(0)
    v_mfma_f32_16x16x32_bf16 v[128:131], v[32:35], v[48:51], v[128:131]
    ds_read_b128 v[80:83], v11 offset:32768
    buffer_load_dwordx4 v[244:247], v118, s[32:35], 0 offen
    s_and_b32 s73, s69, 7
    v_mfma_f32_16x16x32_bf16 v[132:135], v[32:35], v[52:55], v[132:135]
    ds_read_b64_tr_b16 v[64:65], v2 offset:57344
    s_lshl_b32 s73, s73, 6
    v_mfma_f32_16x16x32_bf16 v[136:139], v[32:35], v[56:59], v[136:139]
    ds_read_b64_tr_b16 v[66:67], v2 offset:58368
    s_add_u32 s73, s73, 131072
    v_lshl_add_u32 v108, v17, 4, s73
    v_mfma_f32_16x16x32_bf16 v[140:143], v[32:35], v[60:63], v[140:143]
    ds_read_b128 v[84:87], v11 offset:34816
    s_and_b32 s73, s70, 7
    v_mfma_f32_16x16x32_bf16 v[192:195], v[32:35], v[20:23], v[192:195]
    ds_read_b64_tr_b16 v[68:69], v3 offset:57344
    s_lshl_b32 s73, s73, 6
    s_add_u32 s73, s73, 131072
    v_mfma_f32_16x16x32_bf16 v[144:147], v[36:39], v[48:51], v[144:147]
    ds_read_b64_tr_b16 v[70:71], v3 offset:58368
    v_lshl_add_u32 v109, v17, 4, s73
    v_mfma_f32_16x16x32_bf16 v[148:151], v[36:39], v[52:55], v[148:151]
    ds_read_b128 v[88:91], v11 offset:36864
    s_and_b32 s73, s71, 7
    v_mfma_f32_16x16x32_bf16 v[152:155], v[36:39], v[56:59], v[152:155]
    ds_read_b64_tr_b16 v[72:73], v4 offset:57344
    s_lshl_b32 s73, s73, 6
    s_add_u32 s73, s73, 131072
    v_mfma_f32_16x16x32_bf16 v[156:159], v[36:39], v[60:63], v[156:159]
    ds_read_b64_tr_b16 v[74:75], v4 offset:58368
    v_lshl_add_u32 v110, v17, 4, s73
    v_mfma_f32_16x16x32_bf16 v[196:199], v[36:39], v[20:23], v[196:199]
    ds_read_b128 v[92:95], v11 offset:38912
    s_and_b32 s73, s72, 7
    s_lshl_b32 s73, s73, 6
    s_nop 0
    v_mfma_f32_16x16x32_bf16 v[160:163], v[40:43], v[48:51], v[160:163]
    ds_read_b64_tr_b16 v[76:77], v5 offset:57344
    s_add_u32 s73, s73, 131072
    v_mfma_f32_16x16x32_bf16 v[164:167], v[40:43], v[52:55], v[164:167]
    ds_read_b64_tr_b16 v[78:79], v5 offset:58368
    v_lshl_add_u32 v111, v17, 4, s73
    v_mov_b32 v112, 0xbf8bf336
    v_mfma_f32_16x16x32_bf16 v[168:171], v[40:43], v[56:59], v[168:171]
    v_mov_b32 v113, 0xbf8bf336
    v_mov_b32 v114, 0x3eeff558
    v_mfma_f32_16x16x32_bf16 v[172:175], v[40:43], v[60:63], v[172:175]
    v_mov_b32 v115, 0x3eeff558
    v_min_u32 v19, ((G2_START-C4JOIN+511)/512)-1, v0
    v_mfma_f32_16x16x32_bf16 v[176:179], v[44:47], v[48:51], v[176:179]
    s_mul_i32 s80, s3, ((G2_START-C4JOIN+511)/512)
    v_add_u32 v19, s80, v19
    v_mfma_f32_16x16x32_bf16 v[180:183], v[44:47], v[52:55], v[180:183]
    v_lshlrev_b32 v19, 7, v19
    s_getpc_b64 s[80:81]
CT_5:
    v_mfma_f32_16x16x32_bf16 v[184:187], v[44:47], v[56:59], v[184:187]
    v_add_u32 v19, C4JOIN-CT_5, v19
    s_mov_b32 s82, CODE_END-CT_5
    v_mfma_f32_16x16x32_bf16 v[188:191], v[44:47], v[60:63], v[188:191]
    s_mov_b32 s83, 0x20000
    buffer_load_dword v19, v19, s[80:83], 0 offen
    s_waitcnt lgkmcnt(0)
    v_mfma_f32_16x16x32_bf16 v[192:195], v[64:67], v[20:23], v[192:195]
    s_waitcnt vmcnt(10)
    v_lshlrev_b32 v40, 16, v208
    v_mfma_f32_16x16x32_bf16 v[196:199], v[68:71], v[20:23], v[196:199]
    buffer_load_dwordx4 v[248:251], v118, s[32:35], 0 offen offset:64
    v_and_b32 v41, 0xffff0000, v208
    v_mfma_f32_16x16x32_bf16 v[128:131], v[64:67], v[80:83], v[128:131]
    v_lshlrev_b32 v42, 16, v209
    v_mfma_f32_16x16x32_bf16 v[132:135], v[64:67], v[84:87], v[132:135]
    v_and_b32 v43, 0xffff0000, v209
    v_lshlrev_b32 v44, 16, v210
    v_mfma_f32_16x16x32_bf16 v[136:139], v[64:67], v[88:91], v[136:139]
    v_and_b32 v45, 0xffff0000, v210
    v_lshlrev_b32 v46, 16, v211
    v_mfma_f32_16x16x32_bf16 v[140:143], v[64:67], v[92:95], v[140:143]
    v_and_b32 v47, 0xffff0000, v211
    v_mfma_f32_16x16x32_bf16 v[144:147], v[68:71], v[80:83], v[144:147]
    v_lshlrev_b32 v56, 16, v212
    v_and_b32 v57, 0xffff0000, v212
    v_mfma_f32_16x16x32_bf16 v[148:151], v[68:71], v[84:87], v[148:151]
    v_lshlrev_b32 v58, 16, v213
    v_mfma_f32_16x16x32_bf16 v[152:155], v[68:71], v[88:91], v[152:155]
    v_and_b32 v59, 0xffff0000, v213
    v_lshlrev_b32 v60, 16, v214
    v_mfma_f32_16x16x32_bf16 v[156:159], v[68:71], v[92:95], v[156:159]
    buffer_load_dwordx2 v[252:253], v119, s[32:35], 0 offen offset:128
    v_and_b32 v61, 0xffff0000, v214
    v_mfma_f32_16x16x32_bf16 v[160:163], v[72:75], v[80:83], v[160:163]
    s_mov_b32 exec_lo, 0x00010001
    s_mov_b32 exec_hi, 0x00010001
    ds_write_b128 v108, v[192:195]
    ds_write_b128 v109, v[196:199]
    s_mov_b64 exec, -1
    v_mfma_f32_16x16x32_bf16 v[164:167], v[72:75], v[84:87], v[164:167]
    v_lshlrev_b32 v62, 16, v215
    v_mfma_f32_16x16x32_bf16 v[168:171], v[72:75], v[88:91], v[168:171]
    v_and_b32 v63, 0xffff0000, v215
    s_mov_b32 s74, 0x409d30fc
    v_mfma_f32_16x16x32_bf16 v[172:175], v[72:75], v[92:95], v[172:175]
    s_mov_b32 s75, 0x409d30fc
    v_mfma_f32_16x16x32_bf16 v[176:179], v[76:79], v[80:83], v[176:179]
    s_lshr_b32 s76, s67, 4
    s_mul_i32 s76, s76, 55296
    v_mfma_f32_16x16x32_bf16 v[180:183], v[76:79], v[84:87], v[180:183]
    s_add_u32 s76, s76, 10485760
    v_mfma_f32_16x16x32_bf16 v[184:187], v[76:79], v[88:91], v[184:187]
    s_cmp_ge_u32 s68, 108
    s_cselect_b32 s76, 17563648, s76
    v_mfma_f32_16x16x32_bf16 v[188:191], v[76:79], v[92:95], v[188:191]
    v_lshlrev_b32 v18, 4, v0
G1_END:
    s_waitcnt vmcnt(8)
    v_cmp_ne_u32 vcc, s56, v24
    s_mov_b64 s[82:83], vcc
    s_cmp_eq_u64 s[82:83], 0
    s_cbranch_scc0 P2_RETRY_6
P2_DONE_7:
    s_waitcnt lgkmcnt(0)
    s_barrier
    s_nop 0
    ds_read_b128 v[216:219], v108
    ds_read_b128 v[220:223], v109
    ds_read_b128 v[224:227], v110
    ds_read_b128 v[228:231], v111
    buffer_load_dwordx4 v[96:99], v14, s[44:47], s89 offen offset:0 nt
    buffer_load_dwordx4 v[100:103], v14, s[44:47], s89 offen offset:1024 nt
    buffer_load_dwordx2 v[116:117], v14, s[44:47], s89 offen offset:2048 nt
    v_pk_mul_f32 v[40:41], v[40:41], v[114:115]
    v_pk_mul_f32 v[42:43], v[42:43], v[114:115]
    v_pk_mul_f32 v[44:45], v[44:45], v[114:115]
    v_pk_mul_f32 v[46:47], v[46:47], v[114:115]
    v_pk_mul_f32 v[56:57], v[56:57], v[114:115]
    v_pk_mul_f32 v[58:59], v[58:59], v[114:115]
    v_pk_mul_f32 v[60:61], v[60:61], v[114:115]
    v_pk_mul_f32 v[62:63], v[62:63], v[114:115]
    s_waitcnt vmcnt(7)
    v_mul_f32 v201, v114, v201
    v_mul_f32 v200, v200, v201
    v_mul_f32 v203, v114, v203
    v_mul_f32 v202, v202, v203
    v_mul_f32 v205, v114, v205
    v_mul_f32 v204, v204, v205
    v_mul_f32 v207, v114, v207
    v_mul_f32_e64 v206, v206, v207
    buffer_load_dwordx4 v[120:123], v14, s[36:39], s88 offen offset:0 sc1
    buffer_load_dwordx4 v[124:127], v14, s[36:39], s88 offen offset:1024 sc1
    s_waitcnt lgkmcnt(0)
    s_lshl_b32 s78, s84, 1
    s_and_b32 s78, s78, -4
    s_nop 0
    s_load_dword s77, s[14:15], s78
    v_pk_fma_f32 v[32:33], v[216:217], v[200:201], v[40:41] op_sel_hi:[1,0,1] neg_lo:[0,1,0] neg_hi:[0,1,0]
    v_pk_fma_f32 v[34:35], v[218:219], v[200:201], v[42:43] op_sel_hi:[1,0,1] neg_lo:[0,1,0] neg_hi:[0,1,0]
    v_pk_fma_f32 v[36:37], v[220:221], v[200:201], v[44:45] op_sel_hi:[1,0,1] neg_lo:[0,1,0] neg_hi:[0,1,0]
    buffer_load_dwordx4 a[0:3], v14, s[36:39], s52 offen offset:0 sc1
    v_pk_fma_f32 v[38:39], v[222:223], v[200:201], v[46:47] op_sel_hi:[1,0,1] neg_lo:[0,1,0] neg_hi:[0,1,0]
    v_pk_fma_f32 v[32:33], v[128:129], v[200:201], v[32:33] op_sel:[0,1,0] op_sel_hi:[1,1,1]
    v_pk_fma_f32 v[34:35], v[130:131], v[200:201], v[34:35] op_sel:[0,1,0] op_sel_hi:[1,1,1]
    v_pk_fma_f32 v[36:37], v[144:145], v[200:201], v[36:37] op_sel:[0,1,0] op_sel_hi:[1,1,1]
    v_pk_fma_f32 v[38:39], v[146:147], v[200:201], v[38:39] op_sel:[0,1,0] op_sel_hi:[1,1,1]
    v_pk_fma_f32 v[48:49], v[32:33], v[32:33], s[74:75]
    v_pk_fma_f32 v[50:51], v[34:35], v[34:35], s[74:75]
    v_pk_fma_f32 v[52:53], v[36:37], v[36:37], s[74:75]
    v_pk_fma_f32 v[54:55], v[38:39], v[38:39], s[74:75]
    v_pk_fma_f32 v[48:49], v[48:49], v[32:33], v[112:113] neg_lo:[0,1,0] neg_hi:[0,1,0]
    v_pk_fma_f32 v[50:51], v[50:51], v[34:35], v[112:113] neg_lo:[0,1,0] neg_hi:[0,1,0]
    v_pk_fma_f32 v[52:53], v[52:53], v[36:37], v[112:113] neg_lo:[0,1,0] neg_hi:[0,1,0]
    v_pk_fma_f32 v[54:55], v[54:55], v[38:39], v[112:113] neg_lo:[0,1,0] neg_hi:[0,1,0]
    v_exp_f32 v64, v48
    v_exp_f32 v65, v49
    v_exp_f32 v66, v50
    v_exp_f32 v67, v51
    v_exp_f32 v68, v52
    v_exp_f32 v69, v53
    v_exp_f32 v70, v54
    v_exp_f32 v71, v55
    v_pk_add_f32 v[64:65], v[64:65], v[114:115]
    buffer_load_dwordx4 a[4:7], v14, s[36:39], s52 offen offset:1024 sc1
    v_pk_add_f32 v[66:67], v[66:67], v[114:115]
    v_pk_add_f32 v[68:69], v[68:69], v[114:115]
    v_pk_add_f32 v[70:71], v[70:71], v[114:115]
    v_rcp_f32 v64, v64
    v_rcp_f32 v65, v65
    v_rcp_f32 v66, v66
    v_rcp_f32 v67, v67
    v_rcp_f32 v68, v68
    v_rcp_f32 v69, v69
    v_rcp_f32_e64 v70, v70
    v_rcp_f32 v71, v71
    s_nop 0
    v_pk_mul_f32 v[32:33], v[32:33], v[64:65]
    v_pk_mul_f32 v[34:35], v[34:35], v[66:67]
    v_pk_mul_f32 v[36:37], v[36:37], v[68:69]
    v_pk_mul_f32 v[38:39], v[38:39], v[70:71]
    v_cvt_pk_bf16_f32 v128, v32, v33
    v_cvt_pk_bf16_f32 v129, v34, v35
    v_cvt_pk_bf16_f32 v130, v36, v37
    v_cvt_pk_bf16_f32 v131, v38, v39
    s_lshr_b32 s73, s69, 1
    s_lshl_b32 s73, s73, 10
    s_add_u32 s73, s73, s76
    s_nop 0
    buffer_store_dwordx4 v[128:131], v18, s[36:39], s73 offen sc1
PAGE3:
    s_cbranch_execz PAGE4
    s_nop 0
    v_pk_fma_f32 v[32:33], v[224:225], v[200:201], v[56:57] op_sel_hi:[1,0,1] neg_lo:[0,1,0] neg_hi:[0,1,0]
    v_pk_fma_f32 v[34:35], v[226:227], v[200:201], v[58:59] op_sel_hi:[1,0,1] neg_lo:[0,1,0] neg_hi:[0,1,0]
    v_pk_fma_f32 v[36:37], v[228:229], v[200:201], v[60:61] op_sel_hi:[1,0,1] neg_lo:[0,1,0] neg_hi:[0,1,0]
    buffer_load_dwordx4 a[8:11], v14, s[36:39], s52 offen offset:2048 sc1
    v_pk_fma_f32 v[38:39], v[230:231], v[200:201], v[62:63] op_sel_hi:[1,0,1] neg_lo:[0,1,0] neg_hi:[0,1,0]
    v_pk_fma_f32 v[32:33], v[160:161], v[200:201], v[32:33] op_sel:[0,1,0] op_sel_hi:[1,1,1]
    v_pk_fma_f32 v[34:35], v[162:163], v[200:201], v[34:35] op_sel:[0,1,0] op_sel_hi:[1,1,1]
    v_pk_fma_f32 v[36:37], v[176:177], v[200:201], v[36:37] op_sel:[0,1,0] op_sel_hi:[1,1,1]
    v_pk_fma_f32 v[38:39], v[178:179], v[200:201], v[38:39] op_sel:[0,1,0] op_sel_hi:[1,1,1]
    v_pk_fma_f32 v[48:49], v[32:33], v[32:33], s[74:75]
    v_pk_fma_f32 v[50:51], v[34:35], v[34:35], s[74:75]
    v_pk_fma_f32 v[52:53], v[36:37], v[36:37], s[74:75]
    v_pk_fma_f32 v[54:55], v[38:39], v[38:39], s[74:75]
    v_pk_fma_f32 v[48:49], v[48:49], v[32:33], v[112:113] neg_lo:[0,1,0] neg_hi:[0,1,0]
    v_pk_fma_f32 v[50:51], v[50:51], v[34:35], v[112:113] neg_lo:[0,1,0] neg_hi:[0,1,0]
    v_pk_fma_f32 v[52:53], v[52:53], v[36:37], v[112:113] neg_lo:[0,1,0] neg_hi:[0,1,0]
    v_pk_fma_f32 v[54:55], v[54:55], v[38:39], v[112:113] neg_lo:[0,1,0] neg_hi:[0,1,0]
    v_exp_f32 v64, v48
    v_exp_f32 v65, v49
    v_exp_f32 v66, v50
    v_exp_f32 v67, v51
    v_exp_f32 v68, v52
    v_exp_f32 v69, v53
    v_exp_f32 v70, v54
    v_exp_f32 v71, v55
    v_pk_add_f32 v[64:65], v[64:65], v[114:115]
    buffer_load_dwordx4 a[12:15], v14, s[36:39], s52 offen offset:3072 sc1
    v_pk_add_f32 v[66:67], v[66:67], v[114:115]
    v_pk_add_f32 v[68:69], v[68:69], v[114:115]
    v_pk_add_f32 v[70:71], v[70:71], v[114:115]
    v_rcp_f32 v64, v64
    v_rcp_f32 v65, v65
    v_rcp_f32 v66, v66
    v_rcp_f32 v67, v67
    v_rcp_f32 v68, v68
    v_rcp_f32 v69, v69
    v_rcp_f32_e64 v70, v70
    v_rcp_f32 v71, v71
    s_nop 0
    v_pk_mul_f32 v[32:33], v[32:33], v[64:65]
    v_pk_mul_f32 v[34:35], v[34:35], v[66:67]
    v_pk_mul_f32 v[36:37], v[36:37], v[68:69]
    v_pk_mul_f32 v[38:39], v[38:39], v[70:71]
    v_cvt_pk_bf16_f32 v160, v32, v33
    v_cvt_pk_bf16_f32 v161, v34, v35
    v_cvt_pk_bf16_f32 v162, v36, v37
    v_cvt_pk_bf16_f32 v163, v38, v39
    s_lshr_b32 s73, s71, 1
    s_lshl_b32 s73, s73, 10
    s_add_u32 s73, s73, s76
    s_nop 0
    buffer_store_dwordx4 v[160:163], v18, s[36:39], s73 offen sc1
    v_pk_fma_f32 v[32:33], v[216:217], v[202:203], v[40:41] op_sel_hi:[1,0,1] neg_lo:[0,1,0] neg_hi:[0,1,0]
    v_pk_fma_f32 v[34:35], v[218:219], v[202:203], v[42:43] op_sel_hi:[1,0,1] neg_lo:[0,1,0] neg_hi:[0,1,0]
    v_pk_fma_f32 v[36:37], v[220:221], v[202:203], v[44:45] op_sel_hi:[1,0,1] neg_lo:[0,1,0] neg_hi:[0,1,0]
    buffer_load_dwordx4 a[16:19], v15, s[36:39], s52 offen offset:0 sc1
    s_add_u32 s52, s52, 5120
    v_pk_fma_f32 v[38:39], v[222:223], v[202:203], v[46:47] op_sel_hi:[1,0,1] neg_lo:[0,1,0] neg_hi:[0,1,0]
    v_pk_fma_f32 v[32:33], v[132:133], v[202:203], v[32:33] op_sel:[0,1,0] op_sel_hi:[1,1,1]
    v_pk_fma_f32 v[34:35], v[134:135], v[202:203], v[34:35] op_sel:[0,1,0] op_sel_hi:[1,1,1]
    v_pk_fma_f32 v[36:37], v[148:149], v[202:203], v[36:37] op_sel:[0,1,0] op_sel_hi:[1,1,1]
    v_pk_fma_f32 v[38:39], v[150:151], v[202:203], v[38:39] op_sel:[0,1,0] op_sel_hi:[1,1,1]
    v_pk_fma_f32 v[48:49], v[32:33], v[32:33], s[74:75]
    v_pk_fma_f32 v[50:51], v[34:35], v[34:35], s[74:75]
    v_pk_fma_f32 v[52:53], v[36:37], v[36:37], s[74:75]
    v_pk_fma_f32 v[54:55], v[38:39], v[38:39], s[74:75]
    v_pk_fma_f32 v[48:49], v[48:49], v[32:33], v[112:113] neg_lo:[0,1,0] neg_hi:[0,1,0]
    v_pk_fma_f32 v[50:51], v[50:51], v[34:35], v[112:113] neg_lo:[0,1,0] neg_hi:[0,1,0]
    v_pk_fma_f32 v[52:53], v[52:53], v[36:37], v[112:113] neg_lo:[0,1,0] neg_hi:[0,1,0]
    v_pk_fma_f32 v[54:55], v[54:55], v[38:39], v[112:113] neg_lo:[0,1,0] neg_hi:[0,1,0]
    v_exp_f32 v64, v48
    v_exp_f32 v65, v49
    v_exp_f32 v66, v50
    v_exp_f32 v67, v51
    v_exp_f32 v68, v52
    v_exp_f32 v69, v53
    v_exp_f32 v70, v54
    v_exp_f32 v71, v55
    v_pk_add_f32 v[64:65], v[64:65], v[114:115]
    buffer_load_dwordx4 a[20:23], v14, s[36:39], s52 offen offset:0 sc1
    v_pk_add_f32 v[66:67], v[66:67], v[114:115]
    v_pk_add_f32 v[68:69], v[68:69], v[114:115]
    v_pk_add_f32 v[70:71], v[70:71], v[114:115]
    v_rcp_f32 v64, v64
    v_rcp_f32 v65, v65
    v_rcp_f32 v66, v66
    v_rcp_f32 v67, v67
    v_rcp_f32 v68, v68
    v_rcp_f32 v69, v69
    v_rcp_f32_e64 v70, v70
    v_rcp_f32 v71, v71
    s_nop 0
    v_pk_mul_f32 v[32:33], v[32:33], v[64:65]
    v_pk_mul_f32 v[34:35], v[34:35], v[66:67]
    v_pk_mul_f32 v[36:37], v[36:37], v[68:69]
    v_pk_mul_f32 v[38:39], v[38:39], v[70:71]
    v_cvt_pk_bf16_f32 v132, v32, v33
    v_cvt_pk_bf16_f32 v133, v34, v35
    v_cvt_pk_bf16_f32 v134, v36, v37
    v_cvt_pk_bf16_f32 v135, v38, v39
    s_lshr_b32 s73, s69, 1
    s_lshl_b32 s73, s73, 10
    s_add_u32 s73, s73, s76
    s_nop 0
    s_add_u32 s73, s73, 55296
    buffer_store_dwordx4 v[132:135], v18, s[36:39], s73 offen sc1
    v_pk_fma_f32 v[32:33], v[224:225], v[202:203], v[56:57] op_sel_hi:[1,0,1] neg_lo:[0,1,0] neg_hi:[0,1,0]
    v_pk_fma_f32 v[34:35], v[226:227], v[202:203], v[58:59] op_sel_hi:[1,0,1] neg_lo:[0,1,0] neg_hi:[0,1,0]
    v_pk_fma_f32 v[36:37], v[228:229], v[202:203], v[60:61] op_sel_hi:[1,0,1] neg_lo:[0,1,0] neg_hi:[0,1,0]
    buffer_load_dwordx4 a[24:27], v14, s[36:39], s52 offen offset:1024 sc1
    v_pk_fma_f32 v[38:39], v[230:231], v[202:203], v[62:63] op_sel_hi:[1,0,1] neg_lo:[0,1,0] neg_hi:[0,1,0]
    v_pk_fma_f32 v[32:33], v[164:165], v[202:203], v[32:33] op_sel:[0,1,0] op_sel_hi:[1,1,1]
    v_pk_fma_f32 v[34:35], v[166:167], v[202:203], v[34:35] op_sel:[0,1,0] op_sel_hi:[1,1,1]
    v_pk_fma_f32 v[36:37], v[180:181], v[202:203], v[36:37] op_sel:[0,1,0] op_sel_hi:[1,1,1]
    v_pk_fma_f32 v[38:39], v[182:183], v[202:203], v[38:39] op_sel:[0,1,0] op_sel_hi:[1,1,1]
    v_pk_fma_f32 v[48:49], v[32:33], v[32:33], s[74:75]
    v_pk_fma_f32 v[50:51], v[34:35], v[34:35], s[74:75]
    v_pk_fma_f32 v[52:53], v[36:37], v[36:37], s[74:75]
    v_pk_fma_f32 v[54:55], v[38:39], v[38:39], s[74:75]
    v_pk_fma_f32 v[48:49], v[48:49], v[32:33], v[112:113] neg_lo:[0,1,0] neg_hi:[0,1,0]
    v_pk_fma_f32 v[50:51], v[50:51], v[34:35], v[112:113] neg_lo:[0,1,0] neg_hi:[0,1,0]
    v_pk_fma_f32 v[52:53], v[52:53], v[36:37], v[112:113] neg_lo:[0,1,0] neg_hi:[0,1,0]
    v_pk_fma_f32 v[54:55], v[54:55], v[38:39], v[112:113] neg_lo:[0,1,0] neg_hi:[0,1,0]
    v_exp_f32 v64, v48
    v_exp_f32 v65, v49
    v_exp_f32 v66, v50
    v_exp_f32 v67, v51
    v_exp_f32 v68, v52
    v_exp_f32 v69, v53
    v_exp_f32 v70, v54
    v_exp_f32 v71, v55
    v_pk_add_f32 v[64:65], v[64:65], v[114:115]
    buffer_load_dwordx4 a[28:31], v14, s[36:39], s52 offen offset:2048 sc1
    v_pk_add_f32 v[66:67], v[66:67], v[114:115]
    v_pk_add_f32 v[68:69], v[68:69], v[114:115]
    v_pk_add_f32 v[70:71], v[70:71], v[114:115]
    v_rcp_f32 v64, v64
    v_rcp_f32 v65, v65
    v_rcp_f32 v66, v66
    v_rcp_f32 v67, v67
    v_rcp_f32 v68, v68
    v_rcp_f32 v69, v69
    v_rcp_f32_e64 v70, v70
    v_rcp_f32 v71, v71
    s_nop 0
    v_pk_mul_f32 v[32:33], v[32:33], v[64:65]
    v_pk_mul_f32 v[34:35], v[34:35], v[66:67]
    v_pk_mul_f32 v[36:37], v[36:37], v[68:69]
    v_pk_mul_f32 v[38:39], v[38:39], v[70:71]
    v_cvt_pk_bf16_f32 v164, v32, v33
    v_cvt_pk_bf16_f32 v165, v34, v35
    v_cvt_pk_bf16_f32 v166, v36, v37
    v_cvt_pk_bf16_f32 v167, v38, v39
    s_lshr_b32 s73, s71, 1
    s_lshl_b32 s73, s73, 10
    s_add_u32 s73, s73, s76
    s_nop 0
    s_add_u32 s73, s73, 55296
    buffer_store_dwordx4 v[164:167], v18, s[36:39], s73 offen sc1
    v_pk_fma_f32 v[32:33], v[216:217], v[204:205], v[40:41] op_sel_hi:[1,0,1] neg_lo:[0,1,0] neg_hi:[0,1,0]
    v_pk_fma_f32 v[34:35], v[218:219], v[204:205], v[42:43] op_sel_hi:[1,0,1] neg_lo:[0,1,0] neg_hi:[0,1,0]
    v_pk_fma_f32 v[36:37], v[220:221], v[204:205], v[44:45] op_sel_hi:[1,0,1] neg_lo:[0,1,0] neg_hi:[0,1,0]
    buffer_load_dwordx4 a[32:35], v14, s[36:39], s52 offen offset:3072 sc1
    v_pk_fma_f32 v[38:39], v[222:223], v[204:205], v[46:47] op_sel_hi:[1,0,1] neg_lo:[0,1,0] neg_hi:[0,1,0]
    v_pk_fma_f32 v[32:33], v[136:137], v[204:205], v[32:33] op_sel:[0,1,0] op_sel_hi:[1,1,1]
    v_pk_fma_f32 v[34:35], v[138:139], v[204:205], v[34:35] op_sel:[0,1,0] op_sel_hi:[1,1,1]
    v_pk_fma_f32 v[36:37], v[152:153], v[204:205], v[36:37] op_sel:[0,1,0] op_sel_hi:[1,1,1]
    v_pk_fma_f32 v[38:39], v[154:155], v[204:205], v[38:39] op_sel:[0,1,0] op_sel_hi:[1,1,1]
    v_pk_fma_f32 v[48:49], v[32:33], v[32:33], s[74:75]
    v_pk_fma_f32 v[50:51], v[34:35], v[34:35], s[74:75]
    v_pk_fma_f32 v[52:53], v[36:37], v[36:37], s[74:75]
    v_pk_fma_f32 v[54:55], v[38:39], v[38:39], s[74:75]
    v_pk_fma_f32 v[48:49], v[48:49], v[32:33], v[112:113] neg_lo:[0,1,0] neg_hi:[0,1,0]
    v_pk_fma_f32 v[50:51], v[50:51], v[34:35], v[112:113] neg_lo:[0,1,0] neg_hi:[0,1,0]
    v_pk_fma_f32 v[52:53], v[52:53], v[36:37], v[112:113] neg_lo:[0,1,0] neg_hi:[0,1,0]
    v_pk_fma_f32 v[54:55], v[54:55], v[38:39], v[112:113] neg_lo:[0,1,0] neg_hi:[0,1,0]
    v_exp_f32 v64, v48
    v_exp_f32 v65, v49
    v_exp_f32 v66, v50
    v_exp_f32 v67, v51
    v_exp_f32 v68, v52
    v_exp_f32 v69, v53
    v_exp_f32 v70, v54
    v_exp_f32 v71, v55
    v_pk_add_f32 v[64:65], v[64:65], v[114:115]
    buffer_load_dwordx4 a[36:39], v15, s[36:39], s52 offen offset:0 sc1
    s_add_u32 s52, s52, 5120
    v_pk_add_f32 v[66:67], v[66:67], v[114:115]
    v_pk_add_f32 v[68:69], v[68:69], v[114:115]
    v_pk_add_f32 v[70:71], v[70:71], v[114:115]
    v_rcp_f32 v64, v64
    v_rcp_f32 v65, v65
    v_rcp_f32 v66, v66
    v_rcp_f32 v67, v67
    v_rcp_f32 v68, v68
    v_rcp_f32 v69, v69
    v_rcp_f32_e64 v70, v70
    v_rcp_f32 v71, v71
    s_nop 0
    v_pk_mul_f32 v[32:33], v[32:33], v[64:65]
    v_pk_mul_f32 v[34:35], v[34:35], v[66:67]
    v_pk_mul_f32 v[36:37], v[36:37], v[68:69]
    v_pk_mul_f32 v[38:39], v[38:39], v[70:71]
    v_cvt_pk_bf16_f32 v136, v32, v33
    v_cvt_pk_bf16_f32 v137, v34, v35
    v_cvt_pk_bf16_f32 v138, v36, v37
    v_cvt_pk_bf16_f32 v139, v38, v39
    s_lshr_b32 s73, s69, 1
    s_lshl_b32 s73, s73, 10
    s_add_u32 s73, s73, s76
    s_nop 0
    s_add_u32 s73, s73, 110592
    buffer_store_dwordx4 v[136:139], v18, s[36:39], s73 offen sc1
    v_pk_fma_f32 v[32:33], v[224:225], v[204:205], v[56:57] op_sel_hi:[1,0,1] neg_lo:[0,1,0] neg_hi:[0,1,0]
    v_pk_fma_f32 v[34:35], v[226:227], v[204:205], v[58:59] op_sel_hi:[1,0,1] neg_lo:[0,1,0] neg_hi:[0,1,0]
    v_pk_fma_f32 v[36:37], v[228:229], v[204:205], v[60:61] op_sel_hi:[1,0,1] neg_lo:[0,1,0] neg_hi:[0,1,0]
    buffer_load_dwordx4 a[40:43], v14, s[36:39], s52 offen offset:0 sc1
    v_pk_fma_f32 v[38:39], v[230:231], v[204:205], v[62:63] op_sel_hi:[1,0,1] neg_lo:[0,1,0] neg_hi:[0,1,0]
    v_pk_fma_f32 v[32:33], v[168:169], v[204:205], v[32:33] op_sel:[0,1,0] op_sel_hi:[1,1,1]
    v_pk_fma_f32 v[34:35], v[170:171], v[204:205], v[34:35] op_sel:[0,1,0] op_sel_hi:[1,1,1]
    v_pk_fma_f32 v[36:37], v[184:185], v[204:205], v[36:37] op_sel:[0,1,0] op_sel_hi:[1,1,1]
    v_pk_fma_f32 v[38:39], v[186:187], v[204:205], v[38:39] op_sel:[0,1,0] op_sel_hi:[1,1,1]
    v_pk_fma_f32 v[48:49], v[32:33], v[32:33], s[74:75]
    v_pk_fma_f32 v[50:51], v[34:35], v[34:35], s[74:75]
    v_pk_fma_f32 v[52:53], v[36:37], v[36:37], s[74:75]
    v_pk_fma_f32 v[54:55], v[38:39], v[38:39], s[74:75]
    v_pk_fma_f32 v[48:49], v[48:49], v[32:33], v[112:113] neg_lo:[0,1,0] neg_hi:[0,1,0]
    v_pk_fma_f32 v[50:51], v[50:51], v[34:35], v[112:113] neg_lo:[0,1,0] neg_hi:[0,1,0]
    v_pk_fma_f32 v[52:53], v[52:53], v[36:37], v[112:113] neg_lo:[0,1,0] neg_hi:[0,1,0]
    v_pk_fma_f32 v[54:55], v[54:55], v[38:39], v[112:113] neg_lo:[0,1,0] neg_hi:[0,1,0]
    v_exp_f32 v64, v48
    v_exp_f32 v65, v49
    v_exp_f32 v66, v50
    v_exp_f32 v67, v51
    v_exp_f32 v68, v52
    v_exp_f32 v69, v53
    v_exp_f32 v70, v54
    v_exp_f32 v71, v55
    v_pk_add_f32 v[64:65], v[64:65], v[114:115]
    buffer_load_dwordx4 a[44:47], v14, s[36:39], s52 offen offset:1024 sc1
    v_pk_add_f32 v[66:67], v[66:67], v[114:115]
    v_pk_add_f32 v[68:69], v[68:69], v[114:115]
    v_pk_add_f32 v[70:71], v[70:71], v[114:115]
    v_rcp_f32 v64, v64
    v_rcp_f32 v65, v65
    v_rcp_f32 v66, v66
    v_rcp_f32 v67, v67
    v_rcp_f32 v68, v68
    v_rcp_f32 v69, v69
    v_rcp_f32_e64 v70, v70
    v_rcp_f32 v71, v71
    s_nop 0
    v_pk_mul_f32 v[32:33], v[32:33], v[64:65]
    v_pk_mul_f32 v[34:35], v[34:35], v[66:67]
    v_pk_mul_f32 v[36:37], v[36:37], v[68:69]
    v_pk_mul_f32 v[38:39], v[38:39], v[70:71]
    v_cvt_pk_bf16_f32 v168, v32, v33
    v_cvt_pk_bf16_f32 v169, v34, v35
    v_cvt_pk_bf16_f32 v170, v36, v37
    v_cvt_pk_bf16_f32 v171, v38, v39
    s_lshr_b32 s73, s71, 1
    s_lshl_b32 s73, s73, 10
    s_add_u32 s73, s73, s76
    s_nop 0
    s_add_u32 s73, s73, 110592
    buffer_store_dwordx4 v[168:171], v18, s[36:39], s73 offen sc1
    v_pk_fma_f32 v[32:33], v[216:217], v[206:207], v[40:41] op_sel_hi:[1,0,1] neg_lo:[0,1,0] neg_hi:[0,1,0]
    v_pk_fma_f32 v[34:35], v[218:219], v[206:207], v[42:43] op_sel_hi:[1,0,1] neg_lo:[0,1,0] neg_hi:[0,1,0]
    v_pk_fma_f32 v[36:37], v[220:221], v[206:207], v[44:45] op_sel_hi:[1,0,1] neg_lo:[0,1,0] neg_hi:[0,1,0]
    buffer_load_dwordx4 a[48:51], v14, s[36:39], s52 offen offset:2048 sc1
    v_pk_fma_f32 v[38:39], v[222:223], v[206:207], v[46:47] op_sel_hi:[1,0,1] neg_lo:[0,1,0] neg_hi:[0,1,0]
    v_pk_fma_f32 v[32:33], v[140:141], v[206:207], v[32:33] op_sel:[0,1,0] op_sel_hi:[1,1,1]
    v_pk_fma_f32 v[34:35], v[142:143], v[206:207], v[34:35] op_sel:[0,1,0] op_sel_hi:[1,1,1]
    v_pk_fma_f32 v[36:37], v[156:157], v[206:207], v[36:37] op_sel:[0,1,0] op_sel_hi:[1,1,1]
    v_pk_fma_f32 v[38:39], v[158:159], v[206:207], v[38:39] op_sel:[0,1,0] op_sel_hi:[1,1,1]
    v_pk_fma_f32 v[48:49], v[32:33], v[32:33], s[74:75]
    v_pk_fma_f32 v[50:51], v[34:35], v[34:35], s[74:75]
    v_pk_fma_f32 v[52:53], v[36:37], v[36:37], s[74:75]
    v_pk_fma_f32 v[54:55], v[38:39], v[38:39], s[74:75]
    v_pk_fma_f32 v[48:49], v[48:49], v[32:33], v[112:113] neg_lo:[0,1,0] neg_hi:[0,1,0]
    v_pk_fma_f32 v[50:51], v[50:51], v[34:35], v[112:113] neg_lo:[0,1,0] neg_hi:[0,1,0]
    v_pk_fma_f32 v[52:53], v[52:53], v[36:37], v[112:113] neg_lo:[0,1,0] neg_hi:[0,1,0]
    v_pk_fma_f32 v[54:55], v[54:55], v[38:39], v[112:113] neg_lo:[0,1,0] neg_hi:[0,1,0]
    v_exp_f32 v64, v48
    v_exp_f32 v65, v49
    v_exp_f32 v66, v50
    v_exp_f32 v67, v51
    v_exp_f32 v68, v52
    v_exp_f32 v69, v53
    v_exp_f32 v70, v54
    v_exp_f32 v71, v55
    v_pk_add_f32 v[64:65], v[64:65], v[114:115]
    buffer_load_dwordx4 a[52:55], v14, s[36:39], s52 offen offset:3072 sc1
    v_pk_add_f32 v[66:67], v[66:67], v[114:115]
    v_pk_add_f32 v[68:69], v[68:69], v[114:115]
    v_pk_add_f32 v[70:71], v[70:71], v[114:115]
    v_rcp_f32 v64, v64
    v_rcp_f32 v65, v65
    v_rcp_f32 v66, v66
    v_rcp_f32 v67, v67
    v_rcp_f32 v68, v68
    v_rcp_f32 v69, v69
    v_rcp_f32_e64 v70, v70
    v_rcp_f32 v71, v71
    s_nop 0
    v_pk_mul_f32 v[32:33], v[32:33], v[64:65]
    v_pk_mul_f32 v[34:35], v[34:35], v[66:67]
    v_pk_mul_f32 v[36:37], v[36:37], v[68:69]
    v_pk_mul_f32 v[38:39], v[38:39], v[70:71]
    v_cvt_pk_bf16_f32 v140, v32, v33
    v_cvt_pk_bf16_f32 v141, v34, v35
    v_cvt_pk_bf16_f32 v142, v36, v37
    v_cvt_pk_bf16_f32 v143, v38, v39
    s_lshr_b32 s73, s69, 1
    s_lshl_b32 s73, s73, 10
    s_add_u32 s73, s73, s76
    s_nop 0
    s_add_u32 s73, s73, 165888
    buffer_store_dwordx4 v[140:143], v18, s[36:39], s73 offen sc1
    v_pk_fma_f32 v[32:33], v[224:225], v[206:207], v[56:57] op_sel_hi:[1,0,1] neg_lo:[0,1,0] neg_hi:[0,1,0]
    v_pk_fma_f32 v[34:35], v[226:227], v[206:207], v[58:59] op_sel_hi:[1,0,1] neg_lo:[0,1,0] neg_hi:[0,1,0]
    v_pk_fma_f32 v[36:37], v[228:229], v[206:207], v[60:61] op_sel_hi:[1,0,1] neg_lo:[0,1,0] neg_hi:[0,1,0]
    buffer_load_dwordx4 a[56:59], v15, s[36:39], s52 offen offset:0 sc1
    s_add_u32 s52, s52, 5120
    v_pk_fma_f32 v[38:39], v[230:231], v[206:207], v[62:63] op_sel_hi:[1,0,1] neg_lo:[0,1,0] neg_hi:[0,1,0]
    v_pk_fma_f32 v[32:33], v[172:173], v[206:207], v[32:33] op_sel:[0,1,0] op_sel_hi:[1,1,1]
    v_pk_fma_f32 v[34:35], v[174:175], v[206:207], v[34:35] op_sel:[0,1,0] op_sel_hi:[1,1,1]
    v_pk_fma_f32 v[36:37], v[188:189], v[206:207], v[36:37] op_sel:[0,1,0] op_sel_hi:[1,1,1]
    v_pk_fma_f32 v[38:39], v[190:191], v[206:207], v[38:39] op_sel:[0,1,0] op_sel_hi:[1,1,1]
    v_pk_fma_f32 v[48:49], v[32:33], v[32:33], s[74:75]
    v_pk_fma_f32 v[50:51], v[34:35], v[34:35], s[74:75]
    v_pk_fma_f32 v[52:53], v[36:37], v[36:37], s[74:75]
    v_pk_fma_f32 v[54:55], v[38:39], v[38:39], s[74:75]
    v_pk_fma_f32 v[48:49], v[48:49], v[32:33], v[112:113] neg_lo:[0,1,0] neg_hi:[0,1,0]
    v_pk_fma_f32 v[50:51], v[50:51], v[34:35], v[112:113] neg_lo:[0,1,0] neg_hi:[0,1,0]
    v_pk_fma_f32 v[52:53], v[52:53], v[36:37], v[112:113] neg_lo:[0,1,0] neg_hi:[0,1,0]
    v_pk_fma_f32 v[54:55], v[54:55], v[38:39], v[112:113] neg_lo:[0,1,0] neg_hi:[0,1,0]
    v_exp_f32 v64, v48
    v_exp_f32 v65, v49
    v_exp_f32 v66, v50
    v_exp_f32 v67, v51
    v_exp_f32 v68, v52
    v_exp_f32 v69, v53
    v_exp_f32 v70, v54
    v_exp_f32 v71, v55
    v_pk_add_f32 v[64:65], v[64:65], v[114:115]
    buffer_load_dwordx4 a[60:63], v14, s[36:39], s52 offen offset:0 sc1
    v_pk_add_f32 v[66:67], v[66:67], v[114:115]
    v_pk_add_f32 v[68:69], v[68:69], v[114:115]
    v_pk_add_f32 v[70:71], v[70:71], v[114:115]
    v_rcp_f32 v64, v64
    v_rcp_f32 v65, v65
    v_rcp_f32 v66, v66
    v_rcp_f32 v67, v67
    v_rcp_f32 v68, v68
    v_rcp_f32 v69, v69
    v_rcp_f32_e64 v70, v70
    v_rcp_f32 v71, v71
    s_nop 0
    v_pk_mul_f32 v[32:33], v[32:33], v[64:65]
    v_pk_mul_f32 v[34:35], v[34:35], v[66:67]
    v_pk_mul_f32 v[36:37], v[36:37], v[68:69]
    v_pk_mul_f32 v[38:39], v[38:39], v[70:71]
    v_cvt_pk_bf16_f32 v172, v32, v33
    v_cvt_pk_bf16_f32 v173, v34, v35
    v_cvt_pk_bf16_f32 v174, v36, v37
    v_cvt_pk_bf16_f32 v175, v38, v39
    s_lshr_b32 s73, s71, 1
    s_lshl_b32 s73, s73, 10
    s_add_u32 s73, s73, s76
    s_add_u32 s73, s73, 165888
    buffer_store_dwordx4 v[172:175], v18, s[36:39], s73 offen sc1
    s_lshl_b32 s48, s63, 4
    s_add_u32 s48, s48, s64
    s_lshl_b32 s48, s48, 6
    s_add_u32 s48, s48, 229376
    s_cmp_eq_u32 s3, 0
    s_cselect_b32 s48, s48, 17563648
    s_mov_b32 s50, 1
    s_lshr_b32 s78, s68, 1
    s_lshl_b32 s78, s78, 10
    s_add_u32 s29, s76, s78
C4JOIN:
    s_lshr_b32 s49, s53, 1
    s_lshl_b32 s49, s49, 10
    s_add_u32 s49, s49, 229376
    s_mul_i32 s79, s53, 216
    s_add_u32 s79, s79, s55
    s_lshl_b32 s79, s79, 10
    s_add_u32 s79, s79, 10485760
    s_add_u32 s61, s79, 14336
    s_cmp_ge_u32 s3, 2
    s_cselect_b32 s62, s79, 1
    s_lshl_b32 s60, s28, 10
    s_add_u32 s60, s60, s79
    s_add_u32 s78, s3, 0
    s_and_b32 s78, s78, 3
    s_mul_i32 s78, s78, 55296
    v_add_u32 v24, s78, v14
    s_add_u32 s78, s3, 1
    s_and_b32 s78, s78, 3
    s_mul_i32 s78, s78, 55296
    v_add_u32 v25, s78, v14
    s_add_u32 s78, s3, 2
    s_and_b32 s78, s78, 3
    s_mul_i32 s78, s78, 55296
    v_add_u32 v26, s78, v14
    s_add_u32 s78, s3, 3
    s_and_b32 s78, s78, 3
    s_mul_i32 s78, s78, 55296
    v_add_u32 v27, s78, v14
    s_mul_i32 s68, s54, 160
    v_min_u32 v18, 13, v0
    v_lshlrev_b32 v18, 6, v18
    s_waitcnt vmcnt(24) lgkmcnt(0)
    v_mov_b32_dpp v107, v100 wave_rol:1 row_mask:0xf bank_mask:0xf
    v_mov_b32_dpp v112, v101 wave_rol:1 row_mask:0xf bank_mask:0xf
    v_mov_b32_dpp v111, v116 wave_rol:1 row_mask:0xf bank_mask:0xf
    v_mov_b32_dpp v113, v117 wave_rol:1 row_mask:0xf bank_mask:0xf
    v_mov_b32 v104, v97
    v_mov_b32 v105, v98
    v_mov_b32 v106, v99
    v_mov_b32 v108, v101
    v_mov_b32 v109, v102
    v_mov_b32 v110, v103
    v_mov_b32_dpp v107, v96 wave_shl:1 row_mask:0xf bank_mask:0xf
    v_mov_b32_dpp v112, v97 wave_shl:1 row_mask:0xf bank_mask:0xf
    v_mov_b32_dpp v111, v100 wave_shl:1 row_mask:0xf bank_mask:0xf
    v_mov_b32_dpp v113, v101 wave_shl:1 row_mask:0xf bank_mask:0xf
    s_nop 1
    v_lshlrev_b32 v1, 4, v0
    v_add_u32 v5, s86, v1
    s_cmp_lg_u32 s87, 0
    s_cbranch_scc1 CV_NOPRE_10
    v_mov_b32 v20, 0
    v_mov_b32 v21, 0
    v_mov_b32 v22, 0
    v_mov_b32 v23, 0
    v_lshrrev_b32 v4, 1, v0
    v_mul_u32_u24 v4, 4160, v4
    v_and_b32 v6, 1, v0
    v_lshl_add_u32 v4, v6, 4, v4
    v_add_u32 v4, s86, v4
    s_mov_b32 exec_lo, 0xff
    s_mov_b32 exec_hi, 0
    ds_write_b128 v4, v[20:23]
    s_mov_b32 exec_lo, -1
    ds_write_b128 v5, v[20:23] offset:16640
    v_lshlrev_b32 v12, 16, v96
    v_alignbit_b32 v13, v104, v96, 16
    s_mov_b32 exec_lo, 1
    ds_write_b32 v5, v12 offset:4188
    ds_write_b32 v5, v96 offset:8348
    ds_write_b64 v5, v[12:13] offset:12504
    s_mov_b64 exec, -1
CV_NOPRE_10:
    s_lshl_b32 s78, s87, 11
    v_add_u32_e64 v5, s78, v5
    v_alignbit_b32 v32, v104, v96, 16
    v_alignbit_b32 v36, v105, v104, 16
    v_alignbit_b32 v33, v105, v97, 16
    v_alignbit_b32 v37, v106, v105, 16
    v_alignbit_b32 v34, v106, v98, 16
    v_alignbit_b32 v38, v107, v106, 16
    v_alignbit_b32 v35, v107, v99, 16
    v_alignbit_b32 v39, v112, v107, 16
    v_min_u32 v19, ((IDLE-G2_START+511)/512)-1, v0
    s_mul_i32 s80, s3, ((IDLE-G2_START+511)/512)
    v_add_u32 v19, s80, v19
    v_lshlrev_b32 v19, 7, v19
    s_getpc_b64 s[80:81]
CT_9:
    s_nop 0
    v_add_u32 v19, G2_START-CT_9, v19
    s_mov_b32 s82, CODE_END-CT_9
    s_mov_b32 s83, 0x20000
    buffer_load_dword v19, v19, s[80:83], 0 offen
    buffer_load_dwordx4 a[64:67], v14, s[36:39], s52 offen offset:1024 sc1
    ds_write_b128 v5, v[96:99] offset:32
    ds_write_b128 v5, v[32:35] offset:4192
    buffer_load_dwordx4 a[68:71], v14, s[36:39], s52 offen offset:2048 sc1
    buffer_load_dwordx4 a[72:75], v14, s[36:39], s52 offen offset:3072 sc1
    ds_write_b128 v5, v[104:107] offset:8352
    ds_write_b128 v5, v[36:39] offset:12512
    ds_write_b128 v5, v[120:123] offset:17152
    buffer_load_dwordx4 a[76:79], v15, s[36:39], s52 offen offset:0 sc1
    s_add_u32 s52, s52, 5120
    buffer_load_dwordx4 a[80:83], v14, s[36:39], s52 offen offset:0 sc1
    v_alignbit_b32 v40, v108, v100, 16
    v_alignbit_b32 v44, v109, v108, 16
    v_alignbit_b32 v41, v109, v101, 16
    v_alignbit_b32 v45, v110, v109, 16
    v_alignbit_b32 v42, v110, v102, 16
    v_alignbit_b32 v46, v111, v110, 16
    v_alignbit_b32 v43, v111, v103, 16
    v_alignbit_b32 v47, v113, v111, 16
    buffer_load_dwordx4 a[84:87], v14, s[36:39], s52 offen offset:1024 sc1
    ds_write_b128 v5, v[100:103] offset:1056
    ds_write_b128 v5, v[40:43] offset:5216
    buffer_load_dwordx4 a[88:91], v14, s[36:39], s52 offen offset:2048 sc1
    ds_write_b128 v5, v[108:111] offset:9376
    ds_write_b128 v5, v[44:47] offset:13536
    ds_write_b128 v5, v[124:127] offset:18176
    buffer_load_dwordx4 a[92:95], v14, s[36:39], s52 offen offset:3072 sc1
    v_and_b32 v6, 15, v0
    v_lshrrev_b32 v7, 4, v0
    v_add_u32 v8, 1, v6
    v_and_b32 v9, 3, v8
    v_and_b32_e64 v8, 28, v8
    v_mul_u32_u24 v9, 4160, v9
    v_lshl_add_u32 v9, v8, 1, v9
    v_lshl_add_u32 v9, v7, 4, v9
    v_add_u32 v2, s86, v9
    v_lshlrev_b32 v8, 1, v6
    v_sub_u32 v8, v8, v7
    v_lshlrev_b32 v8, 4, v8
    v_add_u32 v8, 16720, v8
    v_add_u32 v3, s86, v8
    s_lshl_b32 s78, s87, 8
    v_add_u32 v2, s78, v2
    v_subrev_u32 v3, s78, v3
    buffer_load_dwordx4 a[96:99], v15, s[36:39], s52 offen offset:0 sc1
    s_add_u32 s52, s52, 5120
    v_sub_u32 v8, 15, v6
    v_lshrrev_b32 v9, 3, v8
    v_cmp_eq_u32 s[80:81], v9, v7
    v_bfe_u32 v9, v8, 1, 2
    v_and_b32 v10, 1, v8
    v_lshlrev_b32 v10, 4, v10
    s_and_b32 s78, s84, 1
    s_lshl_b32 s78, s78, 4
    s_lshr_b32 s77, s77, s78
    s_and_b32 s77, s77, 0xffff
    s_cmp_eq_u32 s87, 0
    s_cselect_b32 s77, s77, 0
    buffer_load_dwordx4 a[100:103], v14, s[36:39], s52 offen offset:0 sc1
    v_mov_b32 v11, s77
    v_lshlrev_b32 v11, v10, v11
    v_cndmask_b32 v11, 0, v11, s[80:81]
    v_cmp_eq_u32 vcc, 0, v9
    s_nop 1
    v_cndmask_b32 v192, 0, v11, vcc
    v_cmp_eq_u32 vcc, 1, v9
    s_nop 1
    v_cndmask_b32 v193, 0, v11, vcc
    buffer_load_dwordx4 a[104:107], v14, s[36:39], s52 offen offset:1024 sc1
    v_cmp_eq_u32 vcc, 2, v9
    s_nop 1
    v_cndmask_b32 v194, 0, v11, vcc
    v_cmp_eq_u32 vcc, 3, v9
    s_nop 1
    v_cndmask_b32_e64 v195, 0, v11, vcc
    buffer_load_dwordx4 a[108:111], v14, s[36:39], s52 offen offset:2048 sc1
    buffer_load_dwordx4 a[112:115], v14, s[36:39], s52 offen offset:3072 sc1
    s_waitcnt vmcnt(14) lgkmcnt(0)
    s_barrier
    v_mov_b32 v16, s56
    v_lshlrev_b32 v17, 6, v0
    s_mov_b32 exec_lo, s50
    s_mov_b32 exec_hi, 0
    buffer_store_dword v16, v17, s[36:39], s48 offen sc1
    s_mov_b64 exec, -1
    s_nop 0
    ds_read_b128 v[64:67], v3 offset:448
    ds_read_b64 v[32:33], v2 offset:0
    ds_read_b64 v[34:35], v2 offset:8
    ds_read_b128 v[68:71], v3 offset:960
    ds_read_b64 v[36:37], v2 offset:512
    ds_read_b64 v[38:39], v2 offset:520
    ds_read_b128 v[72:75], v3 offset:1472
    ds_read_b64 v[40:41], v2 offset:1024
    ds_read_b64 v[42:43], v2 offset:1032
    ds_read_b128 v[76:79], v3 offset:1984
    ds_read_b64 v[44:45], v2 offset:1536
    ds_read_b64 v[46:47], v2 offset:1544
    ds_read_b128 v[80:83], v3 offset:2496
    ds_read_b64 v[48:49], v2 offset:2048
    ds_read_b64 v[50:51], v2 offset:2056
    ds_read_b128 v[84:87], v3 offset:3008
    ds_read_b64 v[52:53], v2 offset:2560
    ds_read_b64 v[54:55], v2 offset:2568
    ds_read_b128 v[88:91], v3 offset:3520
    ds_read_b64 v[56:57], v2 offset:3072
    ds_read_b64 v[58:59], v2 offset:3080
    ds_read_b128 v[92:95], v3 offset:4032
    ds_read_b64 v[60:61], v2 offset:3584
    ds_read_b64 v[62:63], v2 offset:3592
    s_waitcnt lgkmcnt(15)
    s_nop 0
    v_mfma_f32_16x16x32_bf16 v[160:163], v[192:195], v[64:67], 0
    ds_read_b128 v[128:131], v3 offset:384
    v_mfma_f32_16x16x32_bf16 v[164:167], v[192:195], v[68:71], 0
    ds_read_b64 v[96:97], v2 offset:64
    v_mfma_f32_16x16x32_bf16 v[168:171], v[192:195], v[72:75], 0
    ds_read_b64 v[98:99], v2 offset:72
    buffer_load_dwordx4 a[116:119], v15, s[36:39], s52 offen offset:0 sc1
    s_add_u32 s52, s52, 5120
    s_waitcnt lgkmcnt(15)
    v_mfma_f32_16x16x32_bf16 v[172:175], v[192:195], v[76:79], 0
    ds_read_b128 v[132:135], v3 offset:896
    s_waitcnt lgkmcnt(15)
    v_mfma_f32_16x16x32_bf16 v[176:179], v[192:195], v[80:83], 0
    ds_read_b64 v[100:101], v2 offset:576
    s_waitcnt lgkmcnt(13)
    v_mfma_f32_16x16x32_bf16 v[180:183], v[192:195], v[84:87], 0
    ds_read_b64 v[102:103], v2 offset:584
    s_waitcnt lgkmcnt(11)
    v_mfma_f32_16x16x32_bf16 v[184:187], v[192:195], v[88:91], 0
    ds_read_b128 v[136:139], v3 offset:1408
    s_waitcnt lgkmcnt(9)
    v_mfma_f32_16x16x32_bf16 v[188:191], v[192:195], v[92:95], 0
    ds_read_b64 v[104:105], v2 offset:1088
    buffer_load_dwordx4 a[120:123], v14, s[36:39], s52 offen offset:0 sc1
    s_waitcnt lgkmcnt(8)
    v_mfma_f32_16x16x32_bf16 v[160:163], v[32:35], v[64:67], v[160:163]
    ds_read_b64 v[106:107], v2 offset:1096
    v_mfma_f32_16x16x32_bf16 v[164:167], v[32:35], v[68:71], v[164:167]
    ds_read_b128 v[140:143], v3 offset:1920
    v_mfma_f32_16x16x32_bf16 v[168:171], v[32:35], v[72:75], v[168:171]
    ds_read_b64 v[108:109], v2 offset:1600
    v_mfma_f32_16x16x32_bf16 v[172:175], v[32:35], v[76:79], v[172:175]
    ds_read_b64 v[110:111], v2 offset:1608
    v_mfma_f32_16x16x32_bf16 v[176:179], v[32:35], v[80:83], v[176:179]
    ds_read_b128 v[144:147], v3 offset:2432
    buffer_load_dwordx4 a[124:127], v14, s[36:39], s52 offen offset:1024 sc1
    v_mfma_f32_16x16x32_bf16 v[180:183], v[32:35], v[84:87], v[180:183]
    ds_read_b64 v[112:113], v2 offset:2112
    v_mfma_f32_16x16x32_bf16 v[184:187], v[32:35], v[88:91], v[184:187]
    ds_read_b64 v[114:115], v2 offset:2120
    v_mfma_f32_16x16x32_bf16 v[188:191], v[32:35], v[92:95], v[188:191]
    ds_read_b128 v[148:151], v3 offset:2944
    v_mfma_f32_16x16x32_bf16 v[164:167], v[36:39], v[64:67], v[164:167]
    ds_read_b64 v[116:117], v2 offset:2624
    v_mfma_f32_16x16x32_bf16 v[168:171], v[36:39], v[68:71], v[168:171]
    ds_read_b64 v[118:119], v2 offset:2632
    buffer_load_dwordx4 a[128:131], v14, s[36:39], s52 offen offset:2048 sc1
    v_mfma_f32_16x16x32_bf16 v[172:175], v[36:39], v[72:75], v[172:175]
    ds_read_b128 v[152:155], v3 offset:3456
PAGE4:
    s_cbranch_execz VISIT_RET
    s_nop 0
    v_mfma_f32_16x16x32_bf16 v[176:179], v[36:39], v[76:79], v[176:179]
    ds_read_b64 v[120:121], v2 offset:3136
    v_mfma_f32_16x16x32_bf16 v[180:183], v[36:39], v[80:83], v[180:183]
    ds_read_b64 v[122:123], v2 offset:3144
    v_mfma_f32_16x16x32_bf16 v[184:187], v[36:39], v[84:87], v[184:187]
    ds_read_b128 v[156:159], v3 offset:3968
    v_mfma_f32_16x16x32_bf16 v[188:191], v[36:39], v[88:91], v[188:191]
    ds_read_b64 v[124:125], v2 offset:3648
    buffer_load_dwordx4 a[132:135], v14, s[36:39], s52 offen offset:3072 sc1
    v_mfma_f32_16x16x32_bf16 v[168:171], v[40:43], v[64:67], v[168:171]
    ds_read_b64 v[126:127], v2 offset:3656
    v_mfma_f32_16x16x32_bf16 v[172:175], v[40:43], v[68:71], v[172:175]
    v_mfma_f32_16x16x32_bf16 v[176:179], v[40:43], v[72:75], v[176:179]
    v_mfma_f32_16x16x32_bf16 v[180:183], v[40:43], v[76:79], v[180:183]
    buffer_load_dwordx4 a[136:139], v15, s[36:39], s52 offen offset:0 sc1
    s_add_u32 s52, s52, 5120
    v_mfma_f32_16x16x32_bf16 v[184:187], v[40:43], v[80:83], v[184:187]
    v_mfma_f32_16x16x32_bf16 v[188:191], v[40:43], v[84:87], v[188:191]
    v_mfma_f32_16x16x32_bf16 v[172:175], v[44:47], v[64:67], v[172:175]
    v_mfma_f32_16x16x32_bf16 v[176:179], v[44:47], v[68:71], v[176:179]
    v_mfma_f32_16x16x32_bf16 v[180:183], v[44:47], v[72:75], v[180:183]
    buffer_load_dwordx4 a[140:143], v14, s[36:39], s52 offen offset:0 sc1
    v_mfma_f32_16x16x32_bf16 v[184:187], v[44:47], v[76:79], v[184:187]
    v_mfma_f32_16x16x32_bf16 v[188:191], v[44:47], v[80:83], v[188:191]
    v_mfma_f32_16x16x32_bf16 v[176:179], v[48:51], v[64:67], v[176:179]
    v_mfma_f32_16x16x32_bf16 v[180:183], v[48:51], v[68:71], v[180:183]
    v_mfma_f32_16x16x32_bf16 v[184:187], v[48:51], v[72:75], v[184:187]
    buffer_load_dwordx4 a[144:147], v14, s[36:39], s52 offen offset:1024 sc1
    v_mfma_f32_16x16x32_bf16 v[188:191], v[48:51], v[76:79], v[188:191]
    v_mfma_f32_16x16x32_bf16 v[180:183], v[52:55], v[64:67], v[180:183]
    v_mfma_f32_16x16x32_bf16 v[184:187], v[52:55], v[68:71], v[184:187]
    v_mfma_f32_16x16x32_bf16 v[188:191], v[52:55], v[72:75], v[188:191]
    v_mfma_f32_16x16x32_bf16 v[184:187], v[56:59], v[64:67], v[184:187]
    buffer_load_dwordx4 a[148:151], v14, s[36:39], s52 offen offset:2048 sc1
    v_mfma_f32_16x16x32_bf16 v[188:191], v[56:59], v[68:71], v[188:191]
    v_mfma_f32_16x16x32_bf16 v[188:191], v[60:63], v[64:67], v[188:191]
    s_waitcnt lgkmcnt(0)
    v_mfma_f32_16x16x32_bf16 v[160:163], v[96:99], v[128:131], v[160:163]
    ds_read_b128 v[64:67], v3 offset:320
    v_and_b32 v20, 15, v0
    v_mfma_f32_16x16x32_bf16 v[164:167], v[96:99], v[132:135], v[164:167]
    ds_read_b64 v[32:33], v2 offset:128
    buffer_load_dwordx4 a[152:155], v14, s[36:39], s52 offen offset:3072 sc1
    v_mfma_f32_16x16x32_bf16 v[168:171], v[96:99], v[136:139], v[168:171]
    ds_read_b64 v[34:35], v2 offset:136
    v_mfma_f32_16x16x32_bf16 v[172:175], v[96:99], v[140:143], v[172:175]
    ds_read_b128 v[68:71], v3 offset:832
    v_mfma_f32_16x16x32_bf16 v[176:179], v[96:99], v[144:147], v[176:179]
    ds_read_b64 v[36:37], v2 offset:640
    v_lshrrev_b32_e64 v21, 4, v0
    v_mfma_f32_16x16x32_bf16 v[180:183], v[96:99], v[148:151], v[180:183]
    ds_read_b64 v[38:39], v2 offset:648
    buffer_load_dwordx4 a[156:159], v15, s[36:39], s52 offen offset:0 sc1
    s_add_u32 s52, s52, 5120
    v_mfma_f32_16x16x32_bf16 v[184:187], v[96:99], v[152:155], v[184:187]
    ds_read_b128 v[72:75], v3 offset:1344
    v_mfma_f32_16x16x32_bf16 v[188:191], v[96:99], v[156:159], v[188:191]
    ds_read_b64 v[40:41], v2 offset:1152
    v_mfma_f32_16x16x32_bf16 v[164:167], v[100:103], v[128:131], v[164:167]
    ds_read_b64 v[42:43], v2 offset:1160
    v_mfma_f32_16x16x32_bf16 v[168:171], v[100:103], v[132:135], v[168:171]
    ds_read_b128 v[76:79], v3 offset:1856
    buffer_load_dwordx4 a[160:163], v14, s[36:39], s52 offen offset:0 sc1
    v_mfma_f32_16x16x32_bf16 v[172:175], v[100:103], v[136:139], v[172:175]
    ds_read_b64 v[44:45], v2 offset:1664
    s_lshl_b32 s69, s53, 6
    s_nop 0
    v_mfma_f32_16x16x32_bf16 v[176:179], v[100:103], v[140:143], v[176:179]
    ds_read_b64 v[46:47], v2 offset:1672
    v_mfma_f32_16x16x32_bf16 v[180:183], v[100:103], v[144:147], v[180:183]
    ds_read_b128 v[80:83], v3 offset:2368
    buffer_load_dwordx4 a[164:167], v14, s[36:39], s52 offen offset:1024 sc1
    v_mfma_f32_16x16x32_bf16 v[184:187], v[100:103], v[148:151], v[184:187]
    ds_read_b64 v[48:49], v2 offset:2176
    v_mfma_f32_16x16x32_bf16 v[188:191], v[100:103], v[152:155], v[188:191]
    ds_read_b64 v[50:51], v2 offset:2184
    v_mfma_f32_16x16x32_bf16 v[168:171], v[104:107], v[128:131], v[168:171]
    ds_read_b128 v[84:87], v3 offset:2880
    s_lshl_b32 s70, s3, 4
    s_nop 0
    v_mfma_f32_16x16x32_bf16 v[172:175], v[104:107], v[132:135], v[172:175]
    ds_read_b64 v[52:53], v2 offset:2688
    buffer_load_dwordx4 a[168:171], v14, s[36:39], s52 offen offset:2048 sc1
    v_mfma_f32_16x16x32_bf16 v[176:179], v[104:107], v[136:139], v[176:179]
    ds_read_b64 v[54:55], v2 offset:2696
    v_mfma_f32_16x16x32_bf16 v[180:183], v[104:107], v[140:143], v[180:183]
    ds_read_b128 v[88:91], v3 offset:3392
    v_mfma_f32_16x16x32_bf16 v[184:187], v[104:107], v[144:147], v[184:187]
    ds_read_b64 v[56:57], v2 offset:3200
    buffer_load_dwordx4 a[172:175], v14, s[36:39], s52 offen offset:3072 sc1
    v_mfma_f32_16x16x32_bf16 v[188:191], v[104:107], v[148:151], v[188:191]
    ds_read_b64 v[58:59], v2 offset:3208
    v_mfma_f32_16x16x32_bf16 v[172:175], v[108:111], v[128:131], v[172:175]
    ds_read_b128 v[92:95], v3 offset:3904
    s_add_u32 s70, s70, s69
    v_mfma_f32_16x16x32_bf16 v[176:179], v[108:111], v[132:135], v[176:179]
    ds_read_b64 v[60:61], v2 offset:3712
    v_mfma_f32_16x16x32_bf16 v[180:183], v[108:111], v[136:139], v[180:183]
    ds_read_b64 v[62:63], v2 offset:3720
    buffer_load_dwordx4 a[176:179], v15, s[36:39], s52 offen offset:0 sc1
    s_add_u32 s52, s52, 5120
    v_mfma_f32_16x16x32_bf16 v[184:187], v[108:111], v[140:143], v[184:187]
    v_mfma_f32_16x16x32_bf16 v[188:191], v[108:111], v[144:147], v[188:191]
    v_add_u32 v22, s70, v20
    v_mfma_f32_16x16x32_bf16 v[176:179], v[112:115], v[128:131], v[176:179]
    v_mul_u32_u24 v28, 1280, v22
    v_mfma_f32_16x16x32_bf16 v[180:183], v[112:115], v[132:135], v[180:183]
    buffer_load_dwordx4 a[180:183], v14, s[36:39], s52 offen offset:0 sc1
    v_mfma_f32_16x16x32_bf16 v[184:187], v[112:115], v[136:139], v[184:187]
    v_mfma_f32_16x16x32_bf16 v[188:191], v[112:115], v[140:143], v[188:191]
    v_lshl_add_u32 v29, v21, 3, v28
    v_mfma_f32_16x16x32_bf16 v[180:183], v[116:119], v[128:131], v[180:183]
    buffer_load_dwordx4 a[184:187], v14, s[36:39], s52 offen offset:1024 sc1
    v_mfma_f32_16x16x32_bf16 v[184:187], v[116:119], v[132:135], v[184:187]
    v_lshl_add_u32 v28, v21, 4, v28
    v_mfma_f32_16x16x32_bf16 v[188:191], v[116:119], v[136:139], v[188:191]
    v_mfma_f32_16x16x32_bf16 v[184:187], v[120:123], v[128:131], v[184:187]
    v_lshlrev_b32 v22, 3, v22
    v_mfma_f32_16x16x32_bf16 v[188:191], v[120:123], v[132:135], v[188:191]
    buffer_load_dwordx4 a[188:191], v14, s[36:39], s52 offen offset:2048 sc1
    v_mfma_f32_16x16x32_bf16 v[188:191], v[124:127], v[128:131], v[188:191]
    s_waitcnt lgkmcnt(0)
    v_mfma_f32_16x16x32_bf16 v[160:163], v[32:35], v[64:67], v[160:163]
    ds_read_b128 v[128:131], v3 offset:256
    v_mfma_f32_16x16x32_bf16 v[164:167], v[32:35], v[68:71], v[164:167]
    ds_read_b64 v[96:97], v2 offset:192
    buffer_load_dwordx4 a[192:195], v14, s[36:39], s52 offen offset:3072 sc1
    v_mfma_f32_16x16x32_bf16 v[168:171], v[32:35], v[72:75], v[168:171]
    ds_read_b64 v[98:99], v2 offset:200
    v_mfma_f32_16x16x32_bf16 v[172:175], v[32:35], v[76:79], v[172:175]
    ds_read_b128 v[132:135], v3 offset:768
    v_mfma_f32_16x16x32_bf16 v[176:179], v[32:35], v[80:83], v[176:179]
    ds_read_b64 v[100:101], v2 offset:704
    buffer_load_dwordx4 a[196:199], v15, s[36:39], s52 offen offset:0 sc1
    s_add_u32 s52, s52, 5120
    v_mfma_f32_16x16x32_bf16 v[180:183], v[32:35], v[84:87], v[180:183]
    ds_read_b64 v[102:103], v2 offset:712
    v_mfma_f32_16x16x32_bf16 v[184:187], v[32:35], v[88:91], v[184:187]
    ds_read_b128 v[136:139], v3 offset:1280
    v_mfma_f32_16x16x32_bf16 v[188:191], v[32:35], v[92:95], v[188:191]
    ds_read_b64 v[104:105], v2 offset:1216
    v_mfma_f32_16x16x32_bf16 v[164:167], v[36:39], v[64:67], v[164:167]
    ds_read_b64 v[106:107], v2 offset:1224
    buffer_load_dwordx4 a[200:203], v14, s[36:39], s52 offen offset:0 sc1
    v_mfma_f32_16x16x32_bf16 v[168:171], v[36:39], v[68:71], v[168:171]
    ds_read_b128 v[140:143], v3 offset:1792
    v_mfma_f32_16x16x32_bf16 v[172:175], v[36:39], v[72:75], v[172:175]
    ds_read_b64 v[108:109], v2 offset:1728
    v_mfma_f32_16x16x32_bf16 v[176:179], v[36:39], v[76:79], v[176:179]
    ds_read_b64 v[110:111], v2 offset:1736
    buffer_load_dwordx4 a[204:207], v14, s[36:39], s52 offen offset:1024 sc1
    v_mfma_f32_16x16x32_bf16 v[180:183], v[36:39], v[80:83], v[180:183]
    ds_read_b128 v[144:147], v3 offset:2304
    v_mfma_f32_16x16x32_bf16 v[184:187], v[36:39], v[84:87], v[184:187]
    ds_read_b64 v[112:113], v2 offset:2240
    v_mfma_f32_16x16x32_bf16 v[188:191], v[36:39], v[88:91], v[188:191]
    ds_read_b64 v[114:115], v2 offset:2248
    buffer_load_dwordx4 a[208:211], v14, s[36:39], s52 offen offset:2048 sc1
    v_mfma_f32_16x16x32_bf16 v[168:171], v[40:43], v[64:67], v[168:171]
    ds_read_b128 v[148:151], v3 offset:2816
    v_mfma_f32_16x16x32_bf16 v[172:175], v[40:43], v[68:71], v[172:175]
    ds_read_b64 v[116:117], v2 offset:2752
    v_mfma_f32_16x16x32_bf16 v[176:179], v[40:43], v[72:75], v[176:179]
    ds_read_b64 v[118:119], v2 offset:2760
    v_mfma_f32_16x16x32_bf16 v[180:183], v[40:43], v[76:79], v[180:183]
    ds_read_b128 v[152:155], v3 offset:3328
    buffer_load_dwordx4 a[212:215], v14, s[36:39], s52 offen offset:3072 sc1
    v_mfma_f32_16x16x32_bf16 v[184:187], v[40:43], v[80:83], v[184:187]
    ds_read_b64 v[120:121], v2 offset:3264
    v_mfma_f32_16x16x32_bf16 v[188:191], v[40:43], v[84:87], v[188:191]
    ds_read_b64 v[122:123], v2 offset:3272
    v_mfma_f32_16x16x32_bf16 v[172:175], v[44:47], v[64:67], v[172:175]
    ds_read_b128 v[156:159], v3 offset:3840
    buffer_load_dwordx4 a[216:219], v15, s[36:39], s52 offen offset:0 sc1
    s_add_u32 s52, s52, 5120
    v_mfma_f32_16x16x32_bf16 v[176:179], v[44:47], v[68:71], v[176:179]
    ds_read_b64 v[124:125], v2 offset:3776
    v_mfma_f32_16x16x32_bf16 v[180:183], v[44:47], v[72:75], v[180:183]
    ds_read_b64 v[126:127], v2 offset:3784
    v_mfma_f32_16x16x32_bf16 v[184:187], v[44:47], v[76:79], v[184:187]
    buffer_load_dwordx4 a[220:223], v14, s[36:39], s52 offen offset:0 sc1
    v_mfma_f32_16x16x32_bf16 v[188:191], v[44:47], v[80:83], v[188:191]
    v_mfma_f32_16x16x32_bf16 v[176:179], v[48:51], v[64:67], v[176:179]
    v_mfma_f32_16x16x32_bf16 v[180:183], v[48:51], v[68:71], v[180:183]
    buffer_load_dwordx4 a[224:227], v14, s[36:39], s52 offen offset:1024 sc1
    v_mfma_f32_16x16x32_bf16 v[184:187], v[48:51], v[72:75], v[184:187]
    v_mfma_f32_16x16x32_bf16 v[188:191], v[48:51], v[76:79], v[188:191]
    v_mfma_f32_16x16x32_bf16 v[180:183], v[52:55], v[64:67], v[180:183]
    v_mfma_f32_16x16x32_bf16 v[184:187], v[52:55], v[68:71], v[184:187]
    buffer_load_dwordx4 a[228:231], v14, s[36:39], s52 offen offset:2048 sc1
    v_mfma_f32_16x16x32_bf16 v[188:191], v[52:55], v[72:75], v[188:191]
    v_mfma_f32_16x16x32_bf16 v[184:187], v[56:59], v[64:67], v[184:187]
    v_mfma_f32_16x16x32_bf16 v[188:191], v[56:59], v[68:71], v[188:191]
    buffer_load_dwordx4 a[232:235], v14, s[36:39], s52 offen offset:3072 sc1
    v_mfma_f32_16x16x32_bf16 v[188:191], v[60:63], v[64:67], v[188:191]
    s_waitcnt lgkmcnt(0)
    s_nop 0
    v_mfma_f32_16x16x32_bf16 v[160:163], v[96:99], v[128:131], v[160:163]
    v_mfma_f32_16x16x32_bf16 v[164:167], v[96:99], v[132:135], v[164:167]
    buffer_load_dwordx4 a[236:239], v15, s[36:39], s52 offen offset:0 sc1
    s_add_u32 s52, s52, 5120
    v_mfma_f32_16x16x32_bf16 v[168:171], v[96:99], v[136:139], v[168:171]
    v_mfma_f32_16x16x32_bf16 v[172:175], v[96:99], v[140:143], v[172:175]
    v_mfma_f32_16x16x32_bf16 v[176:179], v[96:99], v[144:147], v[176:179]
    buffer_load_dwordx4 v[196:199], v14, s[36:39], s52 offen offset:0 sc1
    v_mfma_f32_16x16x32_bf16 v[180:183], v[96:99], v[148:151], v[180:183]
    v_mfma_f32_16x16x32_bf16 v[184:187], v[96:99], v[152:155], v[184:187]
    v_mfma_f32_16x16x32_bf16 v[188:191], v[96:99], v[156:159], v[188:191]
    v_mfma_f32_16x16x32_bf16 v[164:167], v[100:103], v[128:131], v[164:167]
    buffer_load_dwordx4 v[200:203], v14, s[36:39], s52 offen offset:1024 sc1
    v_mfma_f32_16x16x32_bf16 v[168:171], v[100:103], v[132:135], v[168:171]
    v_mfma_f32_16x16x32_bf16 v[172:175], v[100:103], v[136:139], v[172:175]
    buffer_load_dword v19, v18, s[36:39], s49 offen sc1
    v_mfma_f32_16x16x32_bf16 v[176:179], v[100:103], v[140:143], v[176:179]
    buffer_load_dwordx4 v[204:207], v14, s[36:39], s52 offen offset:2048 sc1
    v_mfma_f32_16x16x32_bf16 v[180:183], v[100:103], v[144:147], v[180:183]
    v_mfma_f32_16x16x32_bf16 v[184:187], v[100:103], v[148:151], v[184:187]
    v_mfma_f32_16x16x32_bf16 v[188:191], v[100:103], v[152:155], v[188:191]
    buffer_load_dwordx4 v[208:211], v14, s[36:39], s52 offen offset:3072 sc1
    v_mfma_f32_16x16x32_bf16 v[168:171], v[104:107], v[128:131], v[168:171]
    v_mfma_f32_16x16x32_bf16 v[172:175], v[104:107], v[132:135], v[172:175]
    v_mfma_f32_16x16x32_bf16 v[176:179], v[104:107], v[136:139], v[176:179]
    v_mfma_f32_16x16x32_bf16 v[180:183], v[104:107], v[140:143], v[180:183]
    buffer_load_dwordx4 v[212:215], v15, s[36:39], s52 offen offset:0 sc1
    s_add_u32 s52, s52, 5120
    v_mfma_f32_16x16x32_bf16 v[184:187], v[104:107], v[144:147], v[184:187]
    v_mfma_f32_16x16x32_bf16 v[188:191], v[104:107], v[148:151], v[188:191]
    v_mfma_f32_16x16x32_bf16 v[172:175], v[108:111], v[128:131], v[172:175]
    buffer_load_dwordx4 v[216:219], v14, s[36:39], s52 offen offset:0 sc1
    v_mfma_f32_16x16x32_bf16 v[176:179], v[108:111], v[132:135], v[176:179]
    v_mfma_f32_16x16x32_bf16 v[180:183], v[108:111], v[136:139], v[180:183]
    v_mfma_f32_16x16x32_bf16 v[184:187], v[108:111], v[140:143], v[184:187]
    buffer_load_dwordx4 v[220:223], v14, s[36:39], s52 offen offset:1024 sc1
    v_mfma_f32_16x16x32_bf16 v[188:191], v[108:111], v[144:147], v[188:191]
    v_mfma_f32_16x16x32_bf16 v[176:179], v[112:115], v[128:131], v[176:179]
    v_mfma_f32_16x16x32_bf16 v[180:183], v[112:115], v[132:135], v[180:183]
    buffer_load_dwordx4 v[224:227], v14, s[36:39], s52 offen offset:2048 sc1
    v_mfma_f32_16x16x32_bf16 v[184:187], v[112:115], v[136:139], v[184:187]
    v_mfma_f32_16x16x32_bf16 v[188:191], v[112:115], v[140:143], v[188:191]
    v_mfma_f32_16x16x32_bf16 v[180:183], v[116:119], v[128:131], v[180:183]
    v_mfma_f32_16x16x32_bf16 v[184:187], v[116:119], v[132:135], v[184:187]
    buffer_load_dwordx4 v[228:231], v14, s[36:39], s52 offen offset:3072 sc1
    v_mfma_f32_16x16x32_bf16 v[188:191], v[116:119], v[136:139], v[188:191]
    v_mfma_f32_16x16x32_bf16 v[184:187], v[120:123], v[128:131], v[184:187]
    v_mfma_f32_16x16x32_bf16 v[188:191], v[120:123], v[132:135], v[188:191]
    buffer_load_dwordx4 v[232:235], v15, s[36:39], s52 offen offset:0 sc1
    v_mfma_f32_16x16x32_bf16 v[188:191], v[124:127], v[128:131], v[188:191]
    s_nop 3
    s_waitcnt vmcnt(8)
    v_cmp_ne_u32 vcc, s56, v19
    s_mov_b64 s[82:83], vcc
    s_cmp_eq_u64 s[82:83], 0
    s_cbranch_scc0 FH_RETRY_11
FH_DONE_12:
    s_mov_b32 s71, 65536
    buffer_load_dwordx2 v[254:255], v22, s[36:39], s71 offen sc1
    s_cmp_eq_u32 s60, s62
    s_cselect_b32 s63, 17563648, s60
    buffer_load_dwordx4 v[48:51], v24, s[36:39], s63 offen offset:0 sc1
    v_lshlrev_b32 v9, 4, v0
    buffer_load_dwordx4 v[52:55], v25, s[36:39], s63 offen offset:0 sc1
    s_lshl_b32 s78, s3, 12
    buffer_load_dwordx4 v[56:59], v26, s[36:39], s63 offen offset:0 sc1
    s_add_u32 s78, s78, 84992
    v_add_u32 v10, s78, v9
    buffer_load_dwordx4 v[60:63], v27, s[36:39], s63 offen offset:0 sc1
    s_xor_b32 s78, s3, 1
    buffer_load_dwordx4 v[64:67], v24, s[36:39], s60 offen offset:1024 sc1
    s_lshl_b32 s78, s78, 12
    s_add_u32 s78, s78, 84992
    buffer_load_dwordx4 v[68:71], v25, s[36:39], s60 offen offset:1024 sc1
    v_add_u32 v11, s78, v9
    buffer_load_dwordx4 v[72:75], v26, s[36:39], s60 offen offset:1024 sc1
    s_cmp_lg_u32 s87, 0
    s_cselect_b32 s78, -1, 0
    buffer_load_dwordx4 v[76:79], v27, s[36:39], s60 offen offset:1024 sc1
    s_mov_b32 exec_lo, s78
    s_mov_b32 exec_hi, s78
    v_swap_b32 v160, v176
    v_swap_b32 v161, v177
    v_swap_b32 v162, v178
    v_swap_b32 v163, v179
    s_mov_b64 exec, -1
    ds_write_b128 v10, v[176:179] offset:0
    buffer_load_dwordx4 v[80:83], v24, s[36:39], s60 offen offset:2048 sc1
    s_mov_b32 exec_lo, s78
    s_mov_b32 exec_hi, s78
    v_swap_b32 v164, v180
    v_swap_b32 v165, v181
    v_swap_b32 v166, v182
    v_swap_b32 v167, v183
    s_mov_b64 exec, -1
    buffer_load_dwordx4 v[84:87], v25, s[36:39], s60 offen offset:2048 sc1
    ds_write_b128 v10, v[180:183] offset:1024
    s_mov_b32 exec_lo, s78
    s_mov_b32 exec_hi, s78
    v_swap_b32 v168, v184
    v_swap_b32 v169, v185
    v_swap_b32 v170, v186
    v_swap_b32 v171, v187
    s_mov_b64 exec, -1
    buffer_load_dwordx4 v[88:91], v26, s[36:39], s60 offen offset:2048 sc1
    ds_write_b128 v10, v[184:187] offset:2048
    buffer_load_dwordx4 v[92:95], v27, s[36:39], s60 offen offset:2048 sc1
    s_mov_b32 exec_lo, s78
    s_mov_b32 exec_hi, s78
    v_swap_b32 v172, v188
    v_swap_b32 v173, v189
    v_swap_b32 v174, v190
    v_swap_b32 v175, v191
    s_mov_b64 exec, -1
    ds_write_b128 v10, v[188:191] offset:3072
    s_waitcnt lgkmcnt(0)
    s_barrier
    s_nop 0
    buffer_load_dwordx4 v[96:99], v24, s[36:39], s60 offen offset:3072 sc1
    ds_read_b128 v[32:35], v11 offset:0
    ds_read_b128 v[36:39], v11 offset:1024
    ds_read_b128 v[40:43], v11 offset:2048
    ds_read_b128 v[44:47], v11 offset:3072
    s_waitcnt lgkmcnt(0)
    s_nop 0
    v_pk_add_f32 v[160:161], v[160:161], v[32:33]
    v_pk_add_f32 v[162:163], v[162:163], v[34:35]
    v_pk_add_f32 v[164:165], v[164:165], v[36:37]
    buffer_load_dwordx4 v[100:103], v25, s[36:39], s60 offen offset:3072 sc1
    v_pk_add_f32 v[166:167], v[166:167], v[38:39]
    v_pk_add_f32 v[168:169], v[168:169], v[40:41]
    v_pk_add_f32 v[170:171], v[170:171], v[42:43]
    v_pk_add_f32 v[172:173], v[172:173], v[44:45]
    v_pk_add_f32 v[174:175], v[174:175], v[46:47]
    s_lshl_b32 s79, s87, 11
    s_add_u32 s79, s79, s85
    s_add_u32 s79, s79, 7340032
    v_bfe_u32 v8, v0, 4, 1
    buffer_load_dwordx4 v[236:239], v26, s[36:39], s60 offen offset:3072 sc1
    v_lshlrev_b32 v8, 9, v8
    v_and_b32 v9, 15, v0
    v_lshl_add_u32 v8, v9, 5, v8
    v_lshrrev_b32_e64 v9, 5, v0
    v_lshl_add_u32 v8, v9, 4, v8
    v_cvt_pk_bf16_f32 v32, v160, v161
    v_cvt_pk_bf16_f32 v33, v162, v163
    v_cvt_pk_bf16_f32 v34, v164, v165
    v_cvt_pk_bf16_f32 v35, v166, v167
    buffer_load_dwordx4 v[240:243], v27, s[36:39], s60 offen offset:3072 sc1
    s_add_u32 s60, s60, 4096
    v_cvt_pk_bf16_f32 v36, v168, v169
    v_cvt_pk_bf16_f32 v37, v170, v171
    v_cvt_pk_bf16_f32 v38, v172, v173
    v_cvt_pk_bf16_f32 v39, v174, v175
    s_nop 1
    v_permlane16_swap_b32 v32, v34
    v_permlane16_swap_b32 v33, v35
    v_permlane16_swap_b32 v36, v38
    v_permlane16_swap_b32 v37, v39
    buffer_store_dwordx4 v[32:35], v8, s[36:39], s79 offen offset:0 sc1
    buffer_store_dwordx4 v[36:39], v8, s[36:39], s79 offen offset:1024 sc1
G2_START:
    s_lshr_b32 s72, s84, 1
    s_lshl_b32 s72, s72, 6
    s_add_u32 s72, s72, 262144
    s_cmp_eq_u32 s3, 0
    s_cselect_b32 s72, s72, 17563648
    s_mul_i32 s59, s54, 2560
    s_add_u32 s59, s59, 262144
    v_min_u32 v18, 39, v0
    v_lshlrev_b32 v18, 6, v18
    v_accvgpr_read_b32 v105, a240
    v_accvgpr_read_b32 v107, a241
    v_accvgpr_read_b32 v109, a242
    v_accvgpr_read_b32 v111, a243
    v_accvgpr_read_b32 v113, a244
    v_accvgpr_read_b32 v115, a245
    v_accvgpr_read_b32 v117, a246
    v_accvgpr_read_b32 v119, a247
    v_accvgpr_read_b32 v121, a248
    v_accvgpr_read_b32 v123, a249
    v_lshlrev_b32 v104, 16, v105
    v_and_b32 v105, 0xffff0000, v105
    v_lshlrev_b32 v106, 16, v107
    v_and_b32 v107, 0xffff0000, v107
    v_lshlrev_b32 v108, 16, v109
    v_and_b32 v109, 0xffff0000, v109
    v_lshlrev_b32 v110, 16, v111
    v_and_b32 v111, 0xffff0000, v111
    v_lshlrev_b32 v112, 16, v113
    v_and_b32 v113, 0xffff0000, v113
    v_lshlrev_b32 v114, 16, v115
    v_and_b32 v115, 0xffff0000, v115
    v_lshlrev_b32 v116, 16, v117
    v_and_b32 v117, 0xffff0000, v117
    v_lshlrev_b32 v118, 16, v119
    v_and_b32 v119, 0xffff0000, v119
    v_lshlrev_b32 v120, 16, v121
    v_and_b32 v121, 0xffff0000, v121
    v_lshlrev_b32 v122, 16, v123
    v_and_b32 v123, 0xffff0000, v123
    s_waitcnt vmcnt(14)
    v_mfma_f32_16x16x32_bf16 v[104:107], a[0:3], v[48:51], v[104:107]
    v_mfma_f32_16x16x32_bf16 v[124:127], a[0:3], v[52:55], 0
    buffer_load_dwordx4 v[32:35], v24, s[36:39], s60 offen offset:0 sc1
    v_mfma_f32_16x16x32_bf16 v[144:147], a[0:3], v[56:59], 0
    v_mfma_f32_16x16x32_bf16 v[164:167], a[0:3], v[60:63], 0
    v_mfma_f32_16x16x32_bf16 v[108:111], a[4:7], v[48:51], v[108:111]
    v_mfma_f32_16x16x32_bf16 v[128:131], a[4:7], v[52:55], 0
    buffer_load_dwordx4 v[36:39], v25, s[36:39], s60 offen offset:0 sc1
    v_mfma_f32_16x16x32_bf16 v[148:151], a[4:7], v[56:59], 0
    v_mfma_f32_16x16x32_bf16 v[168:171], a[4:7], v[60:63], 0
    v_mfma_f32_16x16x32_bf16 v[112:115], a[8:11], v[48:51], v[112:115]
    v_mfma_f32_16x16x32_bf16 v[132:135], a[8:11], v[52:55], 0
    buffer_load_dwordx4 v[40:43], v26, s[36:39], s60 offen offset:0 sc1
    v_mfma_f32_16x16x32_bf16 v[152:155], a[8:11], v[56:59], 0
    v_mfma_f32_16x16x32_bf16 v[172:175], a[8:11], v[60:63], 0
    v_mfma_f32_16x16x32_bf16 v[116:119], a[12:15], v[48:51], v[116:119]
    v_mfma_f32_16x16x32_bf16 v[136:139], a[12:15], v[52:55], 0
    buffer_load_dwordx4 v[44:47], v27, s[36:39], s60 offen offset:0 sc1
    v_mfma_f32_16x16x32_bf16 v[156:159], a[12:15], v[56:59], 0
    v_mfma_f32_16x16x32_bf16 v[176:179], a[12:15], v[60:63], 0
    v_mfma_f32_16x16x32_bf16 v[120:123], a[16:19], v[48:51], v[120:123]
    v_mfma_f32_16x16x32_bf16 v[140:143], a[16:19], v[52:55], 0
    v_mfma_f32_16x16x32_bf16 v[160:163], a[16:19], v[56:59], 0
    v_mfma_f32_16x16x32_bf16 v[180:183], a[16:19], v[60:63], 0
    s_waitcnt vmcnt(14)
    v_mfma_f32_16x16x32_bf16 v[104:107], a[20:23], v[64:67], v[104:107]
    v_mfma_f32_16x16x32_bf16 v[124:127], a[20:23], v[68:71], v[124:127]
    buffer_load_dwordx4 v[48:51], v24, s[36:39], s60 offen offset:1024 sc1
    v_mfma_f32_16x16x32_bf16 v[144:147], a[20:23], v[72:75], v[144:147]
    v_mfma_f32_16x16x32_bf16 v[164:167], a[20:23], v[76:79], v[164:167]
    v_mfma_f32_16x16x32_bf16 v[108:111], a[24:27], v[64:67], v[108:111]
    v_mfma_f32_16x16x32_bf16 v[128:131], a[24:27], v[68:71], v[128:131]
    buffer_load_dwordx4 v[52:55], v25, s[36:39], s60 offen offset:1024 sc1
    v_mfma_f32_16x16x32_bf16 v[148:151], a[24:27], v[72:75], v[148:151]
    v_mfma_f32_16x16x32_bf16 v[168:171], a[24:27], v[76:79], v[168:171]
    v_mfma_f32_16x16x32_bf16 v[112:115], a[28:31], v[64:67], v[112:115]
    v_mfma_f32_16x16x32_bf16 v[132:135], a[28:31], v[68:71], v[132:135]
    buffer_load_dwordx4 v[56:59], v26, s[36:39], s60 offen offset:1024 sc1
    v_mfma_f32_16x16x32_bf16 v[152:155], a[28:31], v[72:75], v[152:155]
    v_mfma_f32_16x16x32_bf16 v[172:175], a[28:31], v[76:79], v[172:175]
    v_mfma_f32_16x16x32_bf16 v[116:119], a[32:35], v[64:67], v[116:119]
    v_mfma_f32_16x16x32_bf16 v[136:139], a[32:35], v[68:71], v[136:139]
    buffer_load_dwordx4 v[60:63], v27, s[36:39], s60 offen offset:1024 sc1
    v_mfma_f32_16x16x32_bf16 v[156:159], a[32:35], v[72:75], v[156:159]
    v_mfma_f32_16x16x32_bf16 v[176:179], a[32:35], v[76:79], v[176:179]
    v_mfma_f32_16x16x32_bf16 v[120:123], a[36:39], v[64:67], v[120:123]
    v_mfma_f32_16x16x32_bf16 v[140:143], a[36:39], v[68:71], v[140:143]
    v_mfma_f32_16x16x32_bf16 v[160:163], a[36:39], v[72:75], v[160:163]
    v_mfma_f32_16x16x32_bf16 v[180:183], a[36:39], v[76:79], v[180:183]
    s_waitcnt vmcnt(8)
    s_barrier
    v_mov_b32 v16, s56
    v_lshlrev_b32 v17, 2, v0
    s_mov_b32 exec_lo, 1
    s_mov_b32 exec_hi, 0
    buffer_store_dword v16, v17, s[36:39], s72 offen sc1
    s_mov_b64 exec, -1
    v_mfma_f32_16x16x32_bf16 v[104:107], a[40:43], v[80:83], v[104:107]
    v_mfma_f32_16x16x32_bf16 v[124:127], a[40:43], v[84:87], v[124:127]
    buffer_load_dwordx4 v[64:67], v24, s[36:39], s60 offen offset:2048 sc1
    v_mfma_f32_16x16x32_bf16 v[144:147], a[40:43], v[88:91], v[144:147]
    v_lshrrev_b32 v4, 4, v0
    v_mfma_f32_16x16x32_bf16 v[164:167], a[40:43], v[92:95], v[164:167]
    v_mfma_f32_16x16x32_bf16 v[108:111], a[44:47], v[80:83], v[108:111]
    v_mfma_f32_16x16x32_bf16 v[128:131], a[44:47], v[84:87], v[128:131]
    buffer_load_dwordx4 v[68:71], v25, s[36:39], s60 offen offset:2048 sc1
    v_mfma_f32_16x16x32_bf16 v[148:151], a[44:47], v[88:91], v[148:151]
    v_mfma_f32_16x16x32_bf16 v[168:171], a[44:47], v[92:95], v[168:171]
    v_mfma_f32_16x16x32_bf16 v[112:115], a[48:51], v[80:83], v[112:115]
    v_mfma_f32_16x16x32_bf16 v[132:135], a[48:51], v[84:87], v[132:135]
    buffer_load_dwordx4 v[72:75], v26, s[36:39], s60 offen offset:2048 sc1
    v_mfma_f32_16x16x32_bf16 v[152:155], a[48:51], v[88:91], v[152:155]
    v_mfma_f32_16x16x32_bf16 v[172:175], a[48:51], v[92:95], v[172:175]
    v_mfma_f32_16x16x32_bf16 v[116:119], a[52:55], v[80:83], v[116:119]
    v_mfma_f32_16x16x32_bf16 v[136:139], a[52:55], v[84:87], v[136:139]
    buffer_load_dwordx4 v[76:79], v27, s[36:39], s60 offen offset:2048 sc1
    v_mfma_f32_16x16x32_bf16 v[156:159], a[52:55], v[88:91], v[156:159]
    v_mfma_f32_16x16x32_bf16 v[176:179], a[52:55], v[92:95], v[176:179]
    v_mfma_f32_16x16x32_bf16 v[120:123], a[56:59], v[80:83], v[120:123]
    v_mfma_f32_16x16x32_bf16 v[140:143], a[56:59], v[84:87], v[140:143]
    v_mfma_f32_16x16x32_bf16 v[160:163], a[56:59], v[88:91], v[160:163]
    v_mfma_f32_16x16x32_bf16 v[180:183], a[56:59], v[92:95], v[180:183]
    s_waitcnt vmcnt(15)
    s_nop 0
    v_mfma_f32_16x16x32_bf16 v[104:107], a[60:63], v[96:99], v[104:107]
    v_mfma_f32_16x16x32_bf16 v[124:127], a[60:63], v[100:103], v[124:127]
    buffer_load_dwordx4 v[80:83], v24, s[36:39], s60 offen offset:3072 sc1
    v_mfma_f32_16x16x32_bf16 v[144:147], a[60:63], v[236:239], v[144:147]
    v_mfma_f32_16x16x32_bf16 v[164:167], a[60:63], v[240:243], v[164:167]
    v_mfma_f32_16x16x32_bf16 v[108:111], a[64:67], v[96:99], v[108:111]
    v_mfma_f32_16x16x32_bf16 v[128:131], a[64:67], v[100:103], v[128:131]
    buffer_load_dwordx4 v[84:87], v25, s[36:39], s60 offen offset:3072 sc1
    v_mfma_f32_16x16x32_bf16 v[148:151], a[64:67], v[236:239], v[148:151]
    v_mfma_f32_16x16x32_bf16 v[168:171], a[64:67], v[240:243], v[168:171]
    v_mfma_f32_16x16x32_bf16 v[112:115], a[68:71], v[96:99], v[112:115]
    v_mfma_f32_16x16x32_bf16 v[132:135], a[68:71], v[100:103], v[132:135]
    buffer_load_dwordx4 v[88:91], v26, s[36:39], s60 offen offset:3072 sc1
    v_mfma_f32_16x16x32_bf16 v[152:155], a[68:71], v[236:239], v[152:155]
    v_mfma_f32_16x16x32_bf16 v[172:175], a[68:71], v[240:243], v[172:175]
    v_mfma_f32_16x16x32_bf16 v[116:119], a[72:75], v[96:99], v[116:119]
    v_mfma_f32_16x16x32_bf16 v[136:139], a[72:75], v[100:103], v[136:139]
    buffer_load_dwordx4 v[92:95], v27, s[36:39], s60 offen offset:3072 sc1
    s_add_u32 s60, s60, 4096
    v_mfma_f32_16x16x32_bf16 v[156:159], a[72:75], v[236:239], v[156:159]
    v_mfma_f32_16x16x32_bf16 v[176:179], a[72:75], v[240:243], v[176:179]
    v_mfma_f32_16x16x32_bf16 v[120:123], a[76:79], v[96:99], v[120:123]
    v_mfma_f32_16x16x32_bf16 v[140:143], a[76:79], v[100:103], v[140:143]
    v_mfma_f32_16x16x32_bf16 v[160:163], a[76:79], v[236:239], v[160:163]
    v_mfma_f32_16x16x32_bf16 v[180:183], a[76:79], v[240:243], v[180:183]
    s_waitcnt vmcnt(13)
    v_mfma_f32_16x16x32_bf16 v[104:107], a[80:83], v[32:35], v[104:107]
    v_mfma_f32_16x16x32_bf16 v[124:127], a[80:83], v[36:39], v[124:127]
    buffer_load_dwordx4 v[96:99], v24, s[36:39], s60 offen offset:0 sc1
    v_mfma_f32_16x16x32_bf16 v[144:147], a[80:83], v[40:43], v[144:147]
    v_mfma_f32_16x16x32_bf16 v[164:167], a[80:83], v[44:47], v[164:167]
    v_mfma_f32_16x16x32_bf16 v[108:111], a[84:87], v[32:35], v[108:111]
    v_mfma_f32_16x16x32_bf16 v[128:131], a[84:87], v[36:39], v[128:131]
    buffer_load_dwordx4 v[100:103], v25, s[36:39], s60 offen offset:0 sc1
    v_mfma_f32_16x16x32_bf16 v[148:151], a[84:87], v[40:43], v[148:151]
    v_mfma_f32_16x16x32_bf16 v[168:171], a[84:87], v[44:47], v[168:171]
    v_mfma_f32_16x16x32_bf16 v[112:115], a[88:91], v[32:35], v[112:115]
    v_mfma_f32_16x16x32_bf16 v[132:135], a[88:91], v[36:39], v[132:135]
    buffer_load_dwordx4 v[236:239], v26, s[36:39], s60 offen offset:0 sc1
    v_mfma_f32_16x16x32_bf16 v[152:155], a[88:91], v[40:43], v[152:155]
    v_mfma_f32_16x16x32_bf16 v[172:175], a[88:91], v[44:47], v[172:175]
    v_mfma_f32_16x16x32_bf16 v[116:119], a[92:95], v[32:35], v[116:119]
    v_mfma_f32_16x16x32_bf16 v[136:139], a[92:95], v[36:39], v[136:139]
    buffer_load_dwordx4 v[240:243], v27, s[36:39], s60 offen offset:0 sc1
    v_mfma_f32_16x16x32_bf16 v[156:159], a[92:95], v[40:43], v[156:159]
    v_mfma_f32_16x16x32_bf16 v[176:179], a[92:95], v[44:47], v[176:179]
    v_mfma_f32_16x16x32_bf16 v[120:123], a[96:99], v[32:35], v[120:123]
    v_mfma_f32_16x16x32_bf16 v[140:143], a[96:99], v[36:39], v[140:143]
    v_mfma_f32_16x16x32_bf16 v[160:163], a[96:99], v[40:43], v[160:163]
    v_mfma_f32_16x16x32_bf16 v[180:183], a[96:99], v[44:47], v[180:183]
    s_waitcnt vmcnt(13)
    v_mfma_f32_16x16x32_bf16 v[104:107], a[100:103], v[48:51], v[104:107]
    s_mul_i32 s65, s54, 327680
    s_lshl_b32 s66, s53, 7
    v_mfma_f32_16x16x32_bf16 v[124:127], a[100:103], v[52:55], v[124:127]
    buffer_load_dwordx4 v[32:35], v24, s[36:39], s60 offen offset:1024 sc1
    v_mfma_f32_16x16x32_bf16 v[144:147], a[100:103], v[56:59], v[144:147]
    s_add_u32 s65, s65, s66
    s_add_u32 s65, s65, 7340032
    v_mfma_f32_16x16x32_bf16 v[164:167], a[100:103], v[60:63], v[164:167]
    s_add_u32 s66, s65, 0x20000
    v_mfma_f32_16x16x32_bf16 v[108:111], a[104:107], v[48:51], v[108:111]
    s_add_u32 s67, s65, 0x40000
    v_mfma_f32_16x16x32_bf16 v[128:131], a[104:107], v[52:55], v[128:131]
    buffer_load_dwordx4 v[36:39], v25, s[36:39], s60 offen offset:1024 sc1
    s_cmp_ge_u32 s3, 2
    s_cselect_b32 s67, 17563648, s67
    v_mfma_f32_16x16x32_bf16 v[148:151], a[104:107], v[56:59], v[148:151]
    v_mfma_f32_16x16x32_bf16 v[168:171], a[104:107], v[60:63], v[168:171]
    s_lshl_b32 s79, s3, 3
    v_mfma_f32_16x16x32_bf16 v[112:115], a[108:111], v[48:51], v[112:115]
    v_lshrrev_b32 v10, 3, v0
    v_mfma_f32_16x16x32_bf16 v[132:135], a[108:111], v[52:55], v[132:135]
    buffer_load_dwordx4 v[40:43], v26, s[36:39], s60 offen offset:1024 sc1
    v_add_u32 v10, s79, v10
    v_mfma_f32_16x16x32_bf16 v[152:155], a[108:111], v[56:59], v[152:155]
    v_and_b32 v11, 7, v0
    v_mfma_f32_16x16x32_bf16 v[172:175], a[108:111], v[60:63], v[172:175]
    v_lshlrev_b32 v13, 12, v10
    v_mfma_f32_16x16x32_bf16 v[116:119], a[112:115], v[48:51], v[116:119]
    v_lshl_add_u32 v13, v11, 4, v13
    v_and_b32 v12, 2, v10
    v_mfma_f32_16x16x32_bf16 v[136:139], a[112:115], v[52:55], v[136:139]
    buffer_load_dwordx4 v[44:47], v27, s[36:39], s60 offen offset:1024 sc1
PAGE5:
    s_cbranch_execz PAGE6
    v_mfma_f32_16x16x32_bf16 v[156:159], a[112:115], v[56:59], v[156:159]
    v_xor_b32 v11, v11, v12
    v_mfma_f32_16x16x32_bf16 v[176:179], a[112:115], v[60:63], v[176:179]
    v_lshrrev_b32 v12, 1, v10
    v_and_b32 v12, 4, v12
    v_mfma_f32_16x16x32_bf16 v[120:123], a[116:119], v[48:51], v[120:123]
    v_xor_b32 v11, v11, v12
    v_mfma_f32_16x16x32_bf16 v[140:143], a[116:119], v[52:55], v[140:143]
    v_lshlrev_b32_e64 v10, 7, v10
    v_mfma_f32_16x16x32_bf16 v[160:163], a[116:119], v[56:59], v[160:163]
    v_lshl_add_u32 v10, v11, 4, v10
    v_mfma_f32_16x16x32_bf16 v[180:183], a[116:119], v[60:63], v[180:183]
    v_add_u32 v10, 120832, v10
    s_waitcnt vmcnt(12)
    v_mfma_f32_16x16x32_bf16 v[104:107], a[120:123], v[64:67], v[104:107]
    v_mfma_f32_16x16x32_bf16 v[124:127], a[120:123], v[68:71], v[124:127]
    buffer_load_dwordx4 v[48:51], v24, s[36:39], s60 offen offset:2048 sc1
    v_mfma_f32_16x16x32_bf16 v[144:147], a[120:123], v[72:75], v[144:147]
    s_add_u32 s69, s3, 1
    v_mfma_f32_16x16x32_bf16 v[164:167], a[120:123], v[76:79], v[164:167]
    s_and_b32 s69, s69, 3
    v_mfma_f32_16x16x32_bf16 v[108:111], a[124:127], v[64:67], v[108:111]
    s_mul_i32 s69, s69, 15360
    v_mfma_f32_16x16x32_bf16 v[128:131], a[124:127], v[68:71], v[128:131]
    buffer_load_dwordx4 v[52:55], v25, s[36:39], s60 offen offset:2048 sc1
    s_add_u32 s69, s69, 0
    v_mfma_f32_16x16x32_bf16 v[148:151], a[124:127], v[72:75], v[148:151]
    v_add_u32 v7, s69, v14
    v_mfma_f32_16x16x32_bf16 v[168:171], a[124:127], v[76:79], v[168:171]
    v_mfma_f32_16x16x32_bf16 v[112:115], a[128:131], v[64:67], v[112:115]
    s_add_u32 s69, s3, 2
    v_mfma_f32_16x16x32_bf16 v[132:135], a[128:131], v[68:71], v[132:135]
    buffer_load_dwordx4 v[56:59], v26, s[36:39], s60 offen offset:2048 sc1
    s_and_b32 s69, s69, 3
    v_mfma_f32_16x16x32_bf16 v[152:155], a[128:131], v[72:75], v[152:155]
    s_mul_i32 s69, s69, 15360
    v_mfma_f32_16x16x32_bf16 v[172:175], a[128:131], v[76:79], v[172:175]
    s_add_u32 s69, s69, 5120
    v_mfma_f32_16x16x32_bf16 v[116:119], a[132:135], v[64:67], v[116:119]
    v_add_u32 v8, s69, v14
    v_mfma_f32_16x16x32_bf16 v[136:139], a[132:135], v[68:71], v[136:139]
    buffer_load_dwordx4 v[60:63], v27, s[36:39], s60 offen offset:2048 sc1
    v_mfma_f32_16x16x32_bf16 v[156:159], a[132:135], v[72:75], v[156:159]
    s_add_u32 s69, s3, 3
    v_mfma_f32_16x16x32_bf16 v[176:179], a[132:135], v[76:79], v[176:179]
    s_and_b32 s69, s69, 3
    v_mfma_f32_16x16x32_bf16 v[120:123], a[136:139], v[64:67], v[120:123]
    s_mul_i32 s69, s69, 15360
    v_mfma_f32_16x16x32_bf16 v[140:143], a[136:139], v[68:71], v[140:143]
    s_add_u32 s69, s69, 10240
    v_mfma_f32_16x16x32_bf16 v[160:163], a[136:139], v[72:75], v[160:163]
    v_add_u32 v9, s69, v14
    v_mfma_f32_16x16x32_bf16 v[180:183], a[136:139], v[76:79], v[180:183]
    s_waitcnt vmcnt(12)
    v_mfma_f32_16x16x32_bf16 v[104:107], a[140:143], v[80:83], v[104:107]
    v_and_b32 v2, 15, v0
    v_mfma_f32_16x16x32_bf16 v[124:127], a[140:143], v[84:87], v[124:127]
    buffer_load_dwordx4 v[64:67], v24, s[36:39], s60 offen offset:3072 sc1
    v_mfma_f32_16x16x32_bf16 v[144:147], a[140:143], v[88:91], v[144:147]
    v_lshrrev_b32 v3, 4, v0
    v_mfma_f32_16x16x32_bf16 v[164:167], a[140:143], v[92:95], v[164:167]
    v_lshl_add_u32 v2, v2, 2, v3
    v_mfma_f32_16x16x32_bf16 v[108:111], a[144:147], v[80:83], v[108:111]
    v_mfma_f32_16x16x32_bf16 v[128:131], a[144:147], v[84:87], v[128:131]
    buffer_load_dwordx4 v[68:71], v25, s[36:39], s60 offen offset:3072 sc1
    v_mfma_f32_16x16x32_bf16 v[148:151], a[144:147], v[88:91], v[148:151]
    v_lshlrev_b32 v2, 2, v2
    v_mfma_f32_16x16x32_bf16 v[168:171], a[144:147], v[92:95], v[168:171]
    v_and_b32 v3, 3, v0
    v_mfma_f32_16x16x32_bf16 v[112:115], a[148:151], v[80:83], v[112:115]
    v_mfma_f32_16x16x32_bf16 v[132:135], a[148:151], v[84:87], v[132:135]
    buffer_load_dwordx4 v[72:75], v26, s[36:39], s60 offen offset:3072 sc1
    v_lshlrev_b32 v3, 6, v3
    v_mfma_f32_16x16x32_bf16 v[152:155], a[148:151], v[88:91], v[152:155]
    v_mfma_f32_16x16x32_bf16 v[172:175], a[148:151], v[92:95], v[172:175]
    v_and_b32 v11, 60, v0
    v_mfma_f32_16x16x32_bf16 v[116:119], a[152:155], v[80:83], v[116:119]
    v_mfma_f32_16x16x32_bf16 v[136:139], a[152:155], v[84:87], v[136:139]
    buffer_load_dwordx4 v[76:79], v27, s[36:39], s60 offen offset:3072 sc1
    s_add_u32 s60, s60, 4096
    v_mfma_f32_16x16x32_bf16 v[156:159], a[152:155], v[88:91], v[156:159]
    v_or_b32 v3, v3, v11
    v_mfma_f32_16x16x32_bf16 v[176:179], a[152:155], v[92:95], v[176:179]
    v_mfma_f32_16x16x32_bf16 v[120:123], a[156:159], v[80:83], v[120:123]
    v_mfma_f32_16x16x32_bf16 v[140:143], a[156:159], v[84:87], v[140:143]
    v_mfma_f32_16x16x32_bf16 v[160:163], a[156:159], v[88:91], v[160:163]
    buffer_load_dword v20, v18, s[36:39], s59 offen sc1
    v_mfma_f32_16x16x32_bf16 v[180:183], a[156:159], v[92:95], v[180:183]
    s_waitcnt vmcnt(13)
    v_mfma_f32_16x16x32_bf16 v[104:107], a[160:163], v[96:99], v[104:107]
    v_mfma_f32_16x16x32_bf16 v[124:127], a[160:163], v[100:103], v[124:127]
    buffer_load_dwordx4 v[80:83], v24, s[36:39], s60 offen offset:0 sc1
    v_mfma_f32_16x16x32_bf16 v[144:147], a[160:163], v[236:239], v[144:147]
    ds_bpermute_b32 v244, v2, v244
    v_mfma_f32_16x16x32_bf16 v[164:167], a[160:163], v[240:243], v[164:167]
    ds_bpermute_b32 v245, v2, v245
    v_mfma_f32_16x16x32_bf16 v[108:111], a[164:167], v[96:99], v[108:111]
    v_mfma_f32_16x16x32_bf16 v[128:131], a[164:167], v[100:103], v[128:131]
    buffer_load_dwordx4 v[84:87], v25, s[36:39], s60 offen offset:0 sc1
    ds_bpermute_b32 v246, v2, v246
    v_mfma_f32_16x16x32_bf16 v[148:151], a[164:167], v[236:239], v[148:151]
    v_mfma_f32_16x16x32_bf16 v[168:171], a[164:167], v[240:243], v[168:171]
    ds_bpermute_b32 v247, v2, v247
    v_mfma_f32_16x16x32_bf16 v[112:115], a[168:171], v[96:99], v[112:115]
    v_mfma_f32_16x16x32_bf16 v[132:135], a[168:171], v[100:103], v[132:135]
    buffer_load_dwordx4 v[88:91], v26, s[36:39], s60 offen offset:0 sc1
    ds_bpermute_b32 v248, v2, v248
    v_mfma_f32_16x16x32_bf16 v[152:155], a[168:171], v[236:239], v[152:155]
    v_mfma_f32_16x16x32_bf16 v[172:175], a[168:171], v[240:243], v[172:175]
    ds_bpermute_b32 v249, v2, v249
    v_mfma_f32_16x16x32_bf16 v[116:119], a[172:175], v[96:99], v[116:119]
    ds_bpermute_b32 v250, v2, v250
    v_mfma_f32_16x16x32_bf16 v[136:139], a[172:175], v[100:103], v[136:139]
    buffer_load_dwordx4 v[92:95], v27, s[36:39], s60 offen offset:0 sc1
    v_mfma_f32_16x16x32_bf16 v[156:159], a[172:175], v[236:239], v[156:159]
    v_mfma_f32_16x16x32_bf16 v[176:179], a[172:175], v[240:243], v[176:179]
    ds_bpermute_b32 v251, v2, v251
    v_mfma_f32_16x16x32_bf16 v[120:123], a[176:179], v[96:99], v[120:123]
    ds_bpermute_b32 v252, v2, v252
    v_mfma_f32_16x16x32_bf16 v[140:143], a[176:179], v[100:103], v[140:143]
    v_mfma_f32_16x16x32_bf16 v[160:163], a[176:179], v[236:239], v[160:163]
    ds_bpermute_b32 v253, v2, v253
    v_mfma_f32_16x16x32_bf16 v[180:183], a[176:179], v[240:243], v[180:183]
    s_waitcnt vmcnt(13)
    v_mfma_f32_16x16x32_bf16 v[104:107], a[180:183], v[32:35], v[104:107]
    v_mfma_f32_16x16x32_bf16 v[124:127], a[180:183], v[36:39], v[124:127]
    buffer_load_dwordx4 v[100:103], v25, s[36:39], s60 offen offset:1024 sc1
    v_mfma_f32_16x16x32_bf16 v[144:147], a[180:183], v[40:43], v[144:147]
    s_mov_b32 s48, s26
    v_mfma_f32_16x16x32_bf16 v[164:167], a[180:183], v[44:47], v[164:167]
    v_mfma_f32_16x16x32_bf16 v[108:111], a[184:187], v[32:35], v[108:111]
    s_mov_b32 s49, s27
    s_nop 0
    v_mfma_f32_16x16x32_bf16 v[128:131], a[184:187], v[36:39], v[128:131]
    buffer_load_dwordx4 v[236:239], v26, s[36:39], s60 offen offset:1024 sc1
    v_mfma_f32_16x16x32_bf16 v[148:151], a[184:187], v[40:43], v[148:151]
    v_mfma_f32_16x16x32_bf16 v[168:171], a[184:187], v[44:47], v[168:171]
    s_mov_b32 s50, 2621440
    v_mfma_f32_16x16x32_bf16 v[112:115], a[188:191], v[32:35], v[112:115]
    v_mfma_f32_16x16x32_bf16 v[132:135], a[188:191], v[36:39], v[132:135]
    buffer_load_dwordx4 v[240:243], v27, s[36:39], s60 offen offset:1024 sc1
    v_mfma_f32_16x16x32_bf16 v[152:155], a[188:191], v[40:43], v[152:155]
    s_mov_b32 s51, 0x20000
    v_mfma_f32_16x16x32_bf16 v[172:175], a[188:191], v[44:47], v[172:175]
    v_mfma_f32_16x16x32_bf16 v[116:119], a[192:195], v[32:35], v[116:119]
    v_mfma_f32_16x16x32_bf16 v[136:139], a[192:195], v[36:39], v[136:139]
    buffer_load_dwordx4 v[96:99], v24, s[36:39], s60 offen offset:1024 sc1
    v_mfma_f32_16x16x32_bf16 v[156:159], a[192:195], v[40:43], v[156:159]
    v_mfma_f32_16x16x32_bf16 v[176:179], a[192:195], v[44:47], v[176:179]
    v_mfma_f32_16x16x32_bf16 v[120:123], a[196:199], v[32:35], v[120:123]
    v_mfma_f32_16x16x32_bf16 v[140:143], a[196:199], v[36:39], v[140:143]
    v_mfma_f32_16x16x32_bf16 v[160:163], a[196:199], v[40:43], v[160:163]
    v_mfma_f32_16x16x32_bf16 v[180:183], a[196:199], v[44:47], v[180:183]
    s_waitcnt vmcnt(13)
    v_mfma_f32_16x16x32_bf16 v[104:107], a[200:203], v[48:51], v[104:107]
    s_waitcnt vmcnt(8)
    v_cmp_ne_u32 vcc, s56, v20
    v_mfma_f32_16x16x32_bf16 v[124:127], a[200:203], v[52:55], v[124:127]
    s_mov_b64 s[82:83], vcc
    s_cmp_eq_u64 s[82:83], 0
    s_cbranch_scc0 FY_RETRY_14
FY_DONE_15:
    v_mfma_f32_16x16x32_bf16 v[144:147], a[200:203], v[56:59], v[144:147]
    buffer_load_dwordx4 v[184:187], v13, s[36:39], s65 offen sc1
    v_mfma_f32_16x16x32_bf16 v[164:167], a[200:203], v[60:63], v[164:167]
    buffer_load_dwordx4 v[188:191], v13, s[36:39], s66 offen sc1
    v_mfma_f32_16x16x32_bf16 v[108:111], a[204:207], v[48:51], v[108:111]
    buffer_load_dwordx4 v[192:195], v13, s[36:39], s67 offen sc1
    v_mfma_f32_16x16x32_bf16 v[128:131], a[204:207], v[52:55], v[128:131]
    s_lshl_b32 s76, s3, 12
    s_add_u32 s76, s76, 131072
    s_cmp_eq_u32 s2, 0
    s_cselect_b32 s76, s76, 17563648
    v_mfma_f32_16x16x32_bf16 v[148:151], a[204:207], v[56:59], v[148:151]
    v_lshlrev_b32_e64 v16, 6, v0
    v_mfma_f32_16x16x32_bf16 v[168:171], a[204:207], v[60:63], v[168:171]
    buffer_load_dword v24, v16, s[36:39], s76 offen sc1
    s_mul_i32 s79, s3, 15360
    v_mfma_f32_16x16x32_bf16 v[112:115], a[208:211], v[48:51], v[112:115]
    v_add_u32 v26, s79, v14
    v_bfe_u32 v17, v0, 2, 2
    v_and_b32 v18, 3, v0
    v_mfma_f32_16x16x32_bf16 v[132:135], a[208:211], v[52:55], v[132:135]
    v_lshrrev_b32 v19, 1, v18
    s_lshl_b32 s78, s3, 1
    v_mfma_f32_16x16x32_bf16 v[152:155], a[208:211], v[56:59], v[152:155]
    v_or_b32 v19, s78, v19
    v_and_b32 v18, 1, v18
    v_mfma_f32_16x16x32_bf16 v[172:175], a[208:211], v[60:63], v[172:175]
    v_lshlrev_b32 v18, 3, v18
    v_add_u32 v18, 120832, v18
    v_and_b32 v27, 2, v17
    v_mfma_f32_16x16x32_bf16 v[116:119], a[212:215], v[48:51], v[116:119]
    v_and_b32 v20, 1, v4
    v_lshl_or_b32 v27, v20, 2, v27
    v_mfma_f32_16x16x32_bf16 v[136:139], a[212:215], v[52:55], v[136:139]
    v_xor_b32 v27, v27, v19
    v_lshl_add_u32 v27, v27, 4, v18
    v_mfma_f32_16x16x32_bf16 v[156:159], a[212:215], v[56:59], v[156:159]
    v_lshl_add_u32 v20, v4, 3, v17
    v_lshl_add_u32 v27, v20, 7, v27
    v_lshl_add_u32 v20, v4, 2, v17
    v_mfma_f32_16x16x32_bf16 v[176:179], a[212:215], v[60:63], v[176:179]
    v_and_b32 v23, 2, v20
    v_lshrrev_b32 v21, 1, v20
    v_mfma_f32_16x16x32_bf16 v[120:123], a[216:219], v[48:51], v[120:123]
    v_and_b32 v21, 4, v21
    v_or_b32 v23, v23, v21
    v_mfma_f32_16x16x32_bf16 v[140:143], a[216:219], v[52:55], v[140:143]
    v_xor_b32_e64 v23, v23, v19
    v_lshl_add_u32 v23, v23, 4, v18
    v_lshl_add_u32 v23, v20, 7, v23
    v_mfma_f32_16x16x32_bf16 v[160:163], a[216:219], v[56:59], v[160:163]
    s_mov_b32 s74, 0xbfb8aa3b
    s_mov_b32 s75, 0xbfb8aa3b
    v_mfma_f32_16x16x32_bf16 v[180:183], a[216:219], v[60:63], v[180:183]
    v_mov_b32 v30, 1.0
    v_mov_b32 v31, 1.0
    s_waitcnt vmcnt(8) lgkmcnt(0)
    v_mfma_f32_16x16x32_bf16 v[124:127], a[220:223], v[68:71], v[124:127]
    v_lshlrev_b32 v32, 16, v244
    v_and_b32 v33, 0xffff0000, v244
    v_mfma_f32_16x16x32_bf16 v[128:131], a[224:227], v[68:71], v[128:131]
    v_lshlrev_b32 v34, 16, v245
    v_mfma_f32_16x16x32_bf16 v[124:127], v[196:199], v[84:87], v[124:127]
    v_and_b32 v35, 0xffff0000, v245
    v_mfma_f32_16x16x32_bf16 v[128:131], v[200:203], v[84:87], v[128:131]
    s_waitcnt vmcnt(7)
    v_lshlrev_b32 v36, 16, v246
    v_mfma_f32_16x16x32_bf16 v[124:127], v[216:219], v[100:103], v[124:127]
    v_and_b32 v37, 0xffff0000, v246
    v_mfma_f32_16x16x32_bf16 v[128:131], v[220:223], v[100:103], v[128:131]
    v_lshlrev_b32 v38, 16, v247
    v_mfma_f32_16x16x32_bf16 v[132:135], a[228:231], v[68:71], v[132:135]
    v_and_b32 v39, 0xffff0000, v247
    v_lshlrev_b32_e64 v40, 16, v248
    v_mfma_f32_16x16x32_bf16 v[136:139], a[232:235], v[68:71], v[136:139]
    v_and_b32 v41, 0xffff0000, v248
    v_mfma_f32_16x16x32_bf16 v[132:135], v[204:207], v[84:87], v[132:135]
    ds_write_b128 v7, v[124:127] offset:0
    v_mfma_f32_16x16x32_bf16 v[136:139], v[208:211], v[84:87], v[136:139]
    v_lshlrev_b32_e64 v42, 16, v249
    v_mfma_f32_16x16x32_bf16 v[132:135], v[224:227], v[100:103], v[132:135]
    v_and_b32 v43, 0xffff0000, v249
    v_mfma_f32_16x16x32_bf16 v[136:139], v[228:231], v[100:103], v[136:139]
    ds_write_b128 v7, v[128:131] offset:1024
    v_mfma_f32_16x16x32_bf16 v[140:143], a[236:239], v[68:71], v[140:143]
    v_lshlrev_b32 v44, 16, v250
    v_mfma_f32_16x16x32_bf16 v[144:147], a[220:223], v[72:75], v[144:147]
    v_and_b32 v45, 0xffff0000, v250
    v_mfma_f32_16x16x32_bf16 v[140:143], v[212:215], v[84:87], v[140:143]
    v_lshlrev_b32 v46, 16, v251
    v_and_b32 v47, 0xffff0000, v251
    v_mfma_f32_16x16x32_bf16 v[144:147], v[196:199], v[88:91], v[144:147]
    ds_write_b128 v7, v[132:135] offset:2048
    v_mfma_f32_16x16x32_bf16 v[140:143], v[232:235], v[100:103], v[140:143]
    s_waitcnt vmcnt(6)
    v_lshlrev_b32 v48, 16, v252
    v_mfma_f32_16x16x32_bf16 v[144:147], v[216:219], v[236:239], v[144:147]
    v_and_b32 v49, 0xffff0000, v252
    v_mfma_f32_16x16x32_bf16 v[148:151], a[224:227], v[72:75], v[148:151]
    ds_write_b128 v7, v[136:139] offset:3072
    v_mfma_f32_16x16x32_bf16 v[152:155], a[228:231], v[72:75], v[152:155]
    v_lshlrev_b32_e64 v50, 16, v253
    v_mfma_f32_16x16x32_bf16 v[148:151], v[200:203], v[88:91], v[148:151]
    v_and_b32 v51, 0xffff0000, v253
    v_mfma_f32_16x16x32_bf16 v[152:155], v[204:207], v[88:91], v[152:155]
    ds_write_b128 v7, v[140:143] offset:4096
    v_mfma_f32_16x16x32_bf16 v[148:151], v[220:223], v[236:239], v[148:151]
    v_mul_f32 v254, v254, v255
    v_mfma_f32_16x16x32_bf16 v[152:155], v[224:227], v[236:239], v[152:155]
    v_sub_f32 v254, 0, v254
    v_fma_f32 v52, v32, v255, v254
    v_mfma_f32_16x16x32_bf16 v[156:159], a[232:235], v[72:75], v[156:159]
    ds_write_b128 v8, v[144:147] offset:0
    v_mfma_f32_16x16x32_bf16 v[160:163], a[236:239], v[72:75], v[160:163]
    v_fma_f32 v53, v33, v255, v254
    v_mfma_f32_16x16x32_bf16 v[156:159], v[208:211], v[88:91], v[156:159]
    v_fma_f32 v54, v34, v255, v254
    v_mfma_f32_16x16x32_bf16 v[160:163], v[212:215], v[88:91], v[160:163]
    ds_write_b128 v8, v[148:151] offset:1024
    v_mfma_f32_16x16x32_bf16 v[156:159], v[228:231], v[236:239], v[156:159]
    v_fma_f32 v55, v35, v255, v254
    v_mfma_f32_16x16x32_bf16 v[160:163], v[232:235], v[236:239], v[160:163]
    v_fma_f32 v56, v36, v255, v254
    v_mfma_f32_16x16x32_bf16 v[164:167], a[220:223], v[76:79], v[164:167]
    ds_write_b128 v8, v[152:155] offset:2048
    v_mfma_f32_16x16x32_bf16 v[168:171], a[224:227], v[76:79], v[168:171]
    v_fma_f32 v57, v37, v255, v254
    v_mfma_f32_16x16x32_bf16 v[164:167], v[196:199], v[92:95], v[164:167]
    v_fma_f32 v58, v38, v255, v254
    v_fma_f32 v59, v39, v255, v254
    v_mfma_f32_16x16x32_bf16 v[168:171], v[200:203], v[92:95], v[168:171]
    ds_write_b128 v8, v[156:159] offset:3072
    s_waitcnt vmcnt(5)
    s_nop 0
    v_mfma_f32_16x16x32_bf16 v[164:167], v[216:219], v[240:243], v[164:167]
    v_fma_f32 v60, v40, v255, v254
    v_mfma_f32_16x16x32_bf16 v[168:171], v[220:223], v[240:243], v[168:171]
    v_fma_f32 v61, v41, v255, v254
    v_mfma_f32_16x16x32_bf16 v[172:175], a[228:231], v[76:79], v[172:175]
    ds_write_b128 v8, v[160:163] offset:4096
    v_mfma_f32_16x16x32_bf16 v[176:179], a[232:235], v[76:79], v[176:179]
    v_fma_f32 v62, v42, v255, v254
    v_mfma_f32_16x16x32_bf16 v[172:175], v[204:207], v[92:95], v[172:175]
    v_fma_f32 v63, v43, v255, v254
    v_mfma_f32_16x16x32_bf16 v[176:179], v[208:211], v[92:95], v[176:179]
    ds_write_b128 v9, v[164:167] offset:0
    v_mfma_f32_16x16x32_bf16 v[172:175], v[224:227], v[240:243], v[172:175]
    v_fma_f32 v244, v44, v255, v254
    v_mfma_f32_16x16x32_bf16 v[176:179], v[228:231], v[240:243], v[176:179]
    v_fma_f32 v245, v45, v255, v254
    v_fma_f32 v246, v46, v255, v254
    v_mfma_f32_16x16x32_bf16 v[180:183], a[236:239], v[76:79], v[180:183]
    ds_write_b128 v9, v[168:171] offset:1024
    v_mfma_f32_16x16x32_bf16 v[104:107], a[220:223], v[64:67], v[104:107]
    v_fma_f32 v247, v47, v255, v254
    v_mfma_f32_16x16x32_bf16 v[180:183], v[212:215], v[92:95], v[180:183]
    v_fma_f32 v248, v48, v255, v254
    v_mfma_f32_16x16x32_bf16 v[104:107], v[196:199], v[80:83], v[104:107]
    ds_write_b128 v9, v[172:175] offset:2048
    v_mfma_f32_16x16x32_bf16 v[180:183], v[232:235], v[240:243], v[180:183]
    s_waitcnt vmcnt(4)
    s_nop 0
    v_fma_f32 v249, v49, v255, v254
    v_mfma_f32_16x16x32_bf16 v[104:107], v[216:219], v[96:99], v[104:107]
    v_fma_f32 v250, v50, v255, v254
    v_mfma_f32_16x16x32_bf16 v[108:111], a[224:227], v[64:67], v[108:111]
    ds_write_b128 v9, v[176:179] offset:3072
    v_mfma_f32_16x16x32_bf16 v[112:115], a[228:231], v[64:67], v[112:115]
    v_fma_f32 v251, v51, v255, v254
    v_mfma_f32_16x16x32_bf16 v[108:111], v[200:203], v[80:83], v[108:111]
    v_mfma_f32_16x16x32_bf16 v[112:115], v[204:207], v[80:83], v[112:115]
    ds_write_b128 v9, v[180:183] offset:4096
    v_mfma_f32_16x16x32_bf16 v[108:111], v[220:223], v[96:99], v[108:111]
    v_mfma_f32_16x16x32_bf16 v[112:115], v[224:227], v[96:99], v[112:115]
    v_mfma_f32_16x16x32_bf16 v[116:119], a[232:235], v[64:67], v[116:119]
    s_waitcnt vmcnt(1)
    ds_write_b128 v10, v[184:187] offset:0
    v_mfma_f32_16x16x32_bf16 v[120:123], a[236:239], v[64:67], v[120:123]
    v_mfma_f32_16x16x32_bf16 v[116:119], v[208:211], v[80:83], v[116:119]
    ds_write_b128 v10, v[188:191] offset:4096
    v_mfma_f32_16x16x32_bf16 v[120:123], v[212:215], v[80:83], v[120:123]
    v_mfma_f32_16x16x32_bf16 v[116:119], v[228:231], v[96:99], v[116:119]
    ds_write_b128 v10, v[192:195] offset:8192
    v_mfma_f32_16x16x32_bf16 v[120:123], v[232:235], v[96:99], v[120:123]
    s_cmp_eq_u32 s2, 0
    s_cbranch_scc1 EP_CHECK
EP_BACK:
    s_or_b32 s73, s2, s3
    s_cmp_eq_u32 s73, 0
    s_waitcnt lgkmcnt(0)
    s_barrier
    s_cbranch_scc1 EP_STORE
EP_STORED:
    ds_read_b64_tr_b16 v[220:221], v27 offset:0
    ds_read_b64_tr_b16 v[222:223], v27 offset:512
    ds_read_b64_tr_b16 v[224:225], v27 offset:4096
    ds_read_b64_tr_b16 v[226:227], v27 offset:4608
    ds_read_b64_tr_b16 v[228:229], v23 offset:8192
    ds_read_b128 v[124:127], v26 offset:0
    ds_read_b128 v[144:147], v26 offset:5120
    ds_read_b128 v[164:167], v26 offset:10240
    ds_read_b128 v[128:131], v26 offset:1024
    ds_read_b128 v[148:151], v26 offset:6144
    ds_read_b128 v[168:171], v26 offset:11264
    ds_read_b128 v[132:135], v26 offset:2048
    ds_read_b128 v[152:155], v26 offset:7168
    ds_read_b128 v[172:175], v26 offset:12288
    ds_read_b128 v[136:139], v26 offset:3072
    ds_read_b128 v[156:159], v26 offset:8192
    ds_read_b128 v[176:179], v26 offset:13312
    ds_read_b128 v[140:143], v26 offset:4096
    ds_read_b128 v[160:163], v26 offset:9216
    ds_read_b128 v[180:183], v26 offset:14336
    s_waitcnt lgkmcnt(15)
    v_lshlrev_b32 v92, 16, v220
    v_and_b32 v93, 0xffff0000, v220
    v_lshlrev_b32 v94, 16, v221
    v_and_b32 v95, 0xffff0000, v221
    v_lshlrev_b32 v96, 16, v222
    v_and_b32 v97, 0xffff0000, v222
    v_lshlrev_b32_e64 v98, 16, v223
    v_and_b32 v99, 0xffff0000, v223
    v_pk_mul_f32 v[52:53], v[52:53], v[92:93]
    v_pk_mul_f32 v[54:55], v[54:55], v[94:95]
    v_pk_mul_f32 v[56:57], v[56:57], v[96:97]
    v_pk_mul_f32 v[58:59], v[58:59], v[98:99]
    s_waitcnt lgkmcnt(9)
    s_nop 0
    v_pk_add_f32 v[104:105], v[104:105], v[124:125]
    v_pk_add_f32 v[106:107], v[106:107], v[126:127]
    v_pk_add_f32 v[108:109], v[108:109], v[128:129]
    v_pk_add_f32 v[110:111], v[110:111], v[130:131]
    v_pk_add_f32 v[104:105], v[104:105], v[144:145]
    v_pk_add_f32 v[106:107], v[106:107], v[146:147]
    v_pk_add_f32 v[108:109], v[108:109], v[148:149]
    v_pk_add_f32 v[110:111], v[110:111], v[150:151]
    v_pk_add_f32 v[104:105], v[104:105], v[164:165]
    v_pk_add_f32 v[106:107], v[106:107], v[166:167]
    v_pk_add_f32 v[108:109], v[108:109], v[168:169]
    v_pk_add_f32 v[110:111], v[110:111], v[170:171]
    v_pk_mul_f32 v[72:73], v[104:105], s[74:75]
    v_pk_mul_f32 v[74:75], v[106:107], s[74:75]
    v_pk_mul_f32 v[76:77], v[108:109], s[74:75]
    v_pk_mul_f32 v[78:79], v[110:111], s[74:75]
    v_exp_f32 v72, v72
    v_exp_f32 v73, v73
    v_exp_f32 v74, v74
    v_exp_f32 v75, v75
    v_exp_f32 v76, v76
    v_exp_f32 v77, v77
    v_exp_f32 v78, v78
    v_exp_f32 v79, v79
    v_lshlrev_b32 v100, 16, v224
    v_and_b32 v101, 0xffff0000, v224
    v_lshlrev_b32 v102, 16, v225
    v_and_b32 v103, 0xffff0000, v225
    v_lshlrev_b32 v230, 16, v226
    v_and_b32 v231, 0xffff0000, v226
    v_lshlrev_b32 v232, 16, v227
    v_and_b32 v233, 0xffff0000, v227
    v_pk_add_f32 v[72:73], v[72:73], v[30:31]
    v_pk_add_f32 v[74:75], v[74:75], v[30:31]
    v_pk_add_f32 v[76:77], v[76:77], v[30:31]
    v_pk_add_f32 v[78:79], v[78:79], v[30:31]
    v_rcp_f32 v72, v72
    v_rcp_f32 v73, v73
    v_rcp_f32 v74, v74
    v_rcp_f32 v75, v75
    v_rcp_f32 v76, v76
    v_rcp_f32 v77, v77
    v_rcp_f32 v78, v78
    v_rcp_f32 v79, v79
    v_pk_mul_f32 v[60:61], v[60:61], v[100:101]
    v_pk_mul_f32 v[62:63], v[62:63], v[102:103]
    v_pk_mul_f32 v[244:245], v[244:245], v[230:231]
    v_pk_mul_f32 v[246:247], v[246:247], v[232:233]
    v_pk_mul_f32 v[72:73], v[72:73], v[104:105]
    v_pk_mul_f32 v[74:75], v[74:75], v[106:107]
    v_pk_mul_f32 v[76:77], v[76:77], v[108:109]
    v_pk_mul_f32 v[78:79], v[78:79], v[110:111]
    v_pk_fma_f32 v[72:73], v[72:73], v[52:53], v[32:33]
    v_pk_fma_f32 v[74:75], v[74:75], v[54:55], v[34:35]
    v_pk_fma_f32 v[76:77], v[76:77], v[56:57], v[36:37]
    v_pk_fma_f32 v[78:79], v[78:79], v[58:59], v[38:39]
    v_cvt_pk_bf16_f32 v184, v72, v73
    v_cvt_pk_bf16_f32 v185, v74, v75
    v_cvt_pk_bf16_f32 v186, v76, v77
    v_cvt_pk_bf16_f32 v187, v78, v79
    buffer_store_dwordx4 v[184:187], v28, s[48:51], s68 offen offset:0
    s_waitcnt lgkmcnt(3)
    s_nop 0
    v_pk_add_f32 v[112:113], v[112:113], v[132:133]
    v_pk_add_f32 v[114:115], v[114:115], v[134:135]
    v_pk_add_f32 v[116:117], v[116:117], v[136:137]
    v_pk_add_f32 v[118:119], v[118:119], v[138:139]
    v_pk_add_f32 v[112:113], v[112:113], v[152:153]
    v_pk_add_f32 v[114:115], v[114:115], v[154:155]
    v_pk_add_f32 v[116:117], v[116:117], v[156:157]
    v_pk_add_f32 v[118:119], v[118:119], v[158:159]
    v_pk_add_f32 v[112:113], v[112:113], v[172:173]
    v_pk_add_f32 v[114:115], v[114:115], v[174:175]
    v_pk_add_f32 v[116:117], v[116:117], v[176:177]
    v_pk_add_f32 v[118:119], v[118:119], v[178:179]
    v_pk_mul_f32 v[80:81], v[112:113], s[74:75]
    v_pk_mul_f32 v[82:83], v[114:115], s[74:75]
    v_pk_mul_f32 v[84:85], v[116:117], s[74:75]
    v_pk_mul_f32 v[86:87], v[118:119], s[74:75]
    v_exp_f32 v80, v80
    v_exp_f32 v81, v81
    v_exp_f32 v82, v82
    v_exp_f32 v83, v83
    v_exp_f32 v84, v84
    v_exp_f32 v85, v85
    v_exp_f32 v86, v86
    v_exp_f32 v87, v87
    v_lshlrev_b32 v234, 16, v228
    v_and_b32 v235, 0xffff0000, v228
    v_lshlrev_b32 v236, 16, v229
    v_and_b32 v237, 0xffff0000, v229
    v_pk_add_f32 v[80:81], v[80:81], v[30:31]
    v_pk_add_f32 v[82:83], v[82:83], v[30:31]
    v_pk_add_f32 v[84:85], v[84:85], v[30:31]
    v_pk_add_f32 v[86:87], v[86:87], v[30:31]
    v_rcp_f32 v80, v80
    v_rcp_f32 v81, v81
    v_rcp_f32 v82, v82
    v_rcp_f32 v83, v83
    v_rcp_f32 v84, v84
    v_rcp_f32 v85, v85
    v_rcp_f32 v86, v86
    v_rcp_f32 v87, v87
    v_pk_mul_f32 v[248:249], v[248:249], v[234:235]
    v_pk_mul_f32 v[250:251], v[250:251], v[236:237]
    v_pk_mul_f32 v[80:81], v[80:81], v[112:113]
    v_pk_mul_f32 v[82:83], v[82:83], v[114:115]
    v_pk_mul_f32 v[84:85], v[84:85], v[116:117]
    v_pk_mul_f32 v[86:87], v[86:87], v[118:119]
    v_pk_fma_f32 v[80:81], v[80:81], v[60:61], v[40:41]
    v_pk_fma_f32 v[82:83], v[82:83], v[62:63], v[42:43]
    v_pk_fma_f32 v[84:85], v[84:85], v[244:245], v[44:45]
    v_pk_fma_f32 v[86:87], v[86:87], v[246:247], v[46:47]
    v_cvt_pk_bf16_f32 v188, v80, v81
    v_cvt_pk_bf16_f32 v189, v82, v83
    v_cvt_pk_bf16_f32 v190, v84, v85
    v_cvt_pk_bf16_f32 v191, v86, v87
    buffer_store_dwordx4 v[188:191], v28, s[48:51], s68 offen offset:64
    s_waitcnt lgkmcnt(0)
    s_nop 0
    v_pk_add_f32 v[120:121], v[120:121], v[140:141]
    v_pk_add_f32 v[122:123], v[122:123], v[142:143]
    v_pk_add_f32 v[120:121], v[120:121], v[160:161]
    v_pk_add_f32 v[122:123], v[122:123], v[162:163]
    v_pk_add_f32 v[120:121], v[120:121], v[180:181]
    v_pk_add_f32 v[122:123], v[122:123], v[182:183]
    v_pk_mul_f32 v[88:89], v[120:121], s[74:75]
    v_pk_mul_f32 v[90:91], v[122:123], s[74:75]
    v_exp_f32 v88, v88
    v_exp_f32 v89, v89
    v_exp_f32_e64 v90, v90
    v_exp_f32 v91, v91
    s_nop 0
    v_pk_add_f32 v[88:89], v[88:89], v[30:31]
    v_pk_add_f32 v[90:91], v[90:91], v[30:31]
    v_rcp_f32 v88, v88
    v_rcp_f32 v89, v89
    v_rcp_f32_e64 v90, v90
    v_rcp_f32 v91, v91
    s_nop 0
    v_pk_mul_f32 v[88:89], v[88:89], v[120:121]
    v_pk_mul_f32 v[90:91], v[90:91], v[122:123]
    v_pk_fma_f32 v[88:89], v[88:89], v[248:249], v[48:49]
    v_pk_fma_f32 v[90:91], v[90:91], v[250:251], v[50:51]
    v_cvt_pk_bf16_f32 v192, v88, v89
    v_cvt_pk_bf16_f32 v193, v90, v91
    buffer_store_dwordx2 v[192:193], v29, s[48:51], s68 offen offset:128
    s_branch DONE
IDLE:
    s_movk_i32 s73, 1280
    s_sub_u32 s76, s58, 28
    s_lshl_b32 s76, s76, 3
    s_add_u32 s76, s76, s57
    v_lshrrev_b32 v15, 4, v0
    s_lshl_b32 s78, s3, 2
    v_add_u32 v15, s78, v15
    v_and_b32_e64 v18, 15, v0
    v_mul_u32_u24 v14, 5120, v15
    v_lshl_add_u32 v14, v18, 3, v14
    s_mul_i32 s78, s76, 81920
    v_add_u32_e64 v14, s78, v14
    v_add_u32 v15, 0xfffff100, v14
    v_add_u32 v16, 0xfffff600, v14
    v_add_u32 v17, 0xfffffb00, v14
    v_lshlrev_b32 v18, 5, v18
    s_waitcnt lgkmcnt(0)
    s_load_dword s56, s[30:31], 0
    s_mov_b32 s32, s4
    s_mov_b32 s33, s5
    s_mov_b32 s34, 2621440
    s_mov_b32 s35, 0x20000
    s_mov_b32 s44, s6
    s_mov_b32 s45, s7
    s_mov_b32 s46, 2621440
    s_mov_b32 s47, 0x20000
    s_mov_b32 s48, s8
    s_mov_b32 s49, s9
    s_mov_b32 s50, 2621440
    s_mov_b32 s51, 0x20000
    s_mov_b32 s52, s10
    s_mov_b32 s53, s11
    s_mov_b32 s54, 5120
    s_mov_b32 s55, 0x20000
    s_movk_i32 s79, 896
    s_movk_i32 s80, 3584
    v_add_u32 v22, s79, v14
    v_add_u32 v23, s79, v15
    v_add_u32 v24, s79, v16
    v_add_u32 v25, s79, v17
    buffer_load_dwordx2 v[96:97], v23, s[44:47], 0 offen nt
    buffer_load_dwordx2 v[98:99], v24, s[44:47], 0 offen nt
    buffer_load_dwordx2 v[100:101], v25, s[44:47], 0 offen nt
    buffer_load_dwordx2 v[102:103], v22, s[44:47], 0 offen offset:0 nt
    buffer_load_dwordx2 v[104:105], v22, s[44:47], 0 offen offset:1280 nt
    buffer_load_dwordx2 v[106:107], v22, s[44:47], 0 offen offset:2560 nt
    buffer_load_dwordx2 v[108:109], v22, s[44:47], 0 offen offset:3840 nt
    buffer_load_dwordx4 v[118:121], v18, s[52:55], s80 offen
    buffer_load_dwordx4 v[122:125], v18, s[52:55], s80 offen offset:16
    buffer_load_dwordx2 v[110:111], v22, s[48:51], 0 offen offset:0 nt
    buffer_load_dwordx2 v[112:113], v22, s[48:51], 0 offen offset:1280 nt
    buffer_load_dwordx2 v[114:115], v22, s[48:51], 0 offen offset:2560 nt
    buffer_load_dwordx2 v[116:117], v22, s[48:51], 0 offen offset:3840 nt
    s_mov_b32 s42, 1
    s_mov_b64 exec, 0
PAGE6:
    s_cbranch_execz VISIT_RET
    s_cmp_eq_u32 s3, 0
    s_cbranch_scc1 PAGE1
    s_cmp_eq_u32 s3, 1
    s_cbranch_scc1 PAGE3
    s_cmp_eq_u32 s3, 2
    s_cbranch_scc1 PAGE5
    s_branch PAGE7
VISIT_RET_I:
    s_mov_b64 exec, -1
    s_lshl_b32 s80, s76, 7
    s_add_u32 s59, s80, 2883584
    s_lshl_b32 s68, s76, 6
    s_add_u32 s68, s68, 145408
    s_and_b32 s76, s58, 7
    s_lshl_b32 s77, s57, 2
    s_lshr_b32 s78, s58, 3
    s_add_u32 s77, s77, s78
    s_mul_i32 s78, s77, 40960
    s_mul_i32 s79, s76, 160
    s_add_u32 s78, s78, s79
    s_add_u32 s79, s78, 1310720
    s_cmp_lt_u32 s77, 22
    s_cselect_b32 s79, s79, 2211840
    s_lshl_b32 s80, s3, 6
    v_add_u32_e64 v24, s80, v0
    v_cmp_gt_u32 vcc, 320, v24
    v_subrev_u32 v25, 320, v24
    v_mov_b32 v26, s79
    v_mov_b32 v27, s78
    v_cndmask_b32 v25, v25, v24, vcc
    v_cndmask_b32 v26, v26, v27, vcc
    v_mul_u32_u24 v27, 6554, v25
    v_lshrrev_b32 v27, 16, v27
    v_mul_u32_u24 v28, 10, v27
    v_sub_u32_e64 v28, v25, v28
    v_mul_u32_u24 v27, 1280, v27
    v_lshl_add_u32 v27, v28, 4, v27
    v_add_u32 v80, v27, v26
    v_add_u32 v24, s80, v0
    v_add_u32 v24, 256, v24
    v_cmp_gt_u32 vcc, 320, v24
    v_subrev_u32 v25, 320, v24
    v_mov_b32 v26, s79
    v_mov_b32 v27, s78
    v_cndmask_b32 v25, v25, v24, vcc
    v_cndmask_b32 v26, v26, v27, vcc
    v_mul_u32_u24 v27, 6554, v25
    v_lshrrev_b32 v27, 16, v27
    v_mul_u32_u24 v28, 10, v27
    v_sub_u32_e64 v28, v25, v28
    v_mul_u32_u24 v27, 1280, v27
    v_lshl_add_u32 v27, v28, 4, v27
    v_add_u32 v81, v27, v26
    v_add_u32 v24, s80, v0
    v_add_u32 v24, 512, v24
    v_cmp_gt_u32 vcc, 320, v24
    v_subrev_u32 v25, 320, v24
    v_mov_b32 v26, s79
    v_mov_b32 v27, s78
    v_cndmask_b32 v25, v25, v24, vcc
    v_cndmask_b32 v26, v26, v27, vcc
    v_mul_u32_u24 v27, 6554, v25
    v_lshrrev_b32 v27, 16, v27
    v_mul_u32_u24 v28, 10, v27
    v_sub_u32_e64 v28, v25, v28
    v_mul_u32_u24 v27, 1280, v27
    v_lshl_add_u32 v27, v28, 4, v27
    v_add_u32_e64 v82, v27, v26
    v_mov_b32 v26, 2211840
    v_cmp_gt_u32 vcc, 640, v24
    s_nop 1
    v_cndmask_b32 v82, v26, v82, vcc
    v_and_b32 v203, 15, v0
    v_lshrrev_b32 v204, 5, v0
    s_lshl_b32 s78, s3, 1
    v_add_u32 v204, s78, v204
    v_xor_b32 v204, v204, v203
    v_and_b32 v204, 7, v204
    v_lshlrev_b32_e64 v204, 4, v204
    v_lshl_add_u32 v203, v203, 9, v204
    v_bfe_u32 v204, v0, 4, 1
    v_xor_b32_e64 v204, 1, v204
    v_lshl_add_u32 v203, v204, 3, v203
    v_add_u32 v203, 131584, v203
    s_lshl_b32 s78, s3, 6
    v_add_u32 v205, s78, v0
    v_lshrrev_b32 v206, 3, v205
    v_lshrrev_b32 v204, 5, v205
    v_xor_b32 v204, v204, v205
    v_and_b32 v204, 7, v204
    v_lshlrev_b32_e64 v204, 4, v204
    v_lshl_add_u32 v204, v206, 7, v204
    v_add_u32 v204, 131584, v204
    v_and_b32 v205, 7, v205
    v_lshlrev_b32 v205, 4, v205
    v_lshl_add_u32 v205, v206, 12, v205
    v_add_u32 v206, 0x20000, v205
    s_movk_i32 s79, 1024
    s_movk_i32 s80, 4096
    v_add_u32 v22, s79, v14
    v_add_u32 v23, s79, v15
    v_add_u32 v24, s79, v16
    v_add_u32 v25, s79, v17
    buffer_load_dwordx2 v[126:127], v23, s[44:47], 0 offen nt
    buffer_load_dwordx2 v[128:129], v24, s[44:47], 0 offen nt
    buffer_load_dwordx2 v[130:131], v25, s[44:47], 0 offen nt
    buffer_load_dwordx2 v[132:133], v22, s[44:47], 0 offen offset:0 nt
    buffer_load_dwordx2 v[134:135], v22, s[44:47], 0 offen offset:1280 nt
    buffer_load_dwordx2 v[136:137], v22, s[44:47], 0 offen offset:2560 nt
    buffer_load_dwordx2 v[138:139], v22, s[44:47], 0 offen offset:3840 nt
    buffer_load_dwordx4 v[148:151], v18, s[52:55], s80 offen
    buffer_load_dwordx4 v[152:155], v18, s[52:55], s80 offen offset:16
    buffer_load_dwordx2 v[140:141], v22, s[48:51], 0 offen offset:0 nt
    buffer_load_dwordx2 v[142:143], v22, s[48:51], 0 offen offset:1280 nt
    buffer_load_dwordx2 v[144:145], v22, s[48:51], 0 offen offset:2560 nt
    buffer_load_dwordx2 v[146:147], v22, s[48:51], 0 offen offset:3840 nt
    s_waitcnt vmcnt(17)
    v_lshlrev_b32 v224, 16, v118
    v_and_b32 v228, 0xffff0000, v118
    v_lshlrev_b32 v225, 16, v122
    v_and_b32 v229, 0xffff0000, v122
    v_lshlrev_b32 v226, 16, v120
    v_and_b32 v230, 0xffff0000, v120
    v_lshlrev_b32 v227, 16, v124
    v_and_b32 v231, 0xffff0000, v124
    v_lshlrev_b32 v232, 16, v119
    v_and_b32 v236, 0xffff0000, v119
    v_lshlrev_b32 v233, 16, v123
    v_and_b32 v237, 0xffff0000, v123
    v_lshlrev_b32 v234, 16, v121
    v_and_b32 v238, 0xffff0000, v121
    v_lshlrev_b32 v235, 16, v125
    v_and_b32 v239, 0xffff0000, v125
    v_lshlrev_b32 v208, 16, v96
    v_and_b32 v96, 0xffff0000, v96
    v_lshlrev_b32 v209, 16, v97
    v_and_b32 v97, 0xffff0000, v97
    v_lshlrev_b32 v210, 16, v98
    v_and_b32 v98, 0xffff0000, v98
    v_lshlrev_b32 v211, 16, v99
    v_and_b32 v99, 0xffff0000, v99
    v_lshlrev_b32 v212, 16, v100
    v_and_b32 v100, 0xffff0000, v100
    v_lshlrev_b32 v213, 16, v101
    v_and_b32 v101, 0xffff0000, v101
    v_lshlrev_b32 v214, 16, v102
    v_and_b32 v102, 0xffff0000, v102
    v_lshlrev_b32 v215, 16, v103
    v_and_b32 v103, 0xffff0000, v103
    v_lshlrev_b32 v216, 16, v104
    v_and_b32 v104, 0xffff0000, v104
    v_lshlrev_b32 v217, 16, v105
    v_and_b32 v105, 0xffff0000, v105
    v_lshlrev_b32 v218, 16, v106
    v_and_b32 v106, 0xffff0000, v106
    v_lshlrev_b32 v219, 16, v107
    v_and_b32 v107, 0xffff0000, v107
    v_lshlrev_b32 v220, 16, v108
    v_and_b32 v108, 0xffff0000, v108
    v_lshlrev_b32_e64 v221, 16, v109
    v_and_b32 v109, 0xffff0000, v109
    v_pk_mul_f32 v[240:241], v[214:215], v[224:225]
    v_pk_mul_f32 v[242:243], v[102:103], v[226:227]
    v_pk_mul_f32 v[244:245], v[216:217], v[224:225]
    v_pk_mul_f32 v[246:247], v[104:105], v[226:227]
    v_pk_mul_f32 v[248:249], v[218:219], v[224:225]
    v_pk_mul_f32 v[250:251], v[106:107], v[226:227]
    v_pk_mul_f32 v[252:253], v[220:221], v[224:225]
    v_pk_mul_f32 v[254:255], v[108:109], v[226:227]
    v_pk_fma_f32 v[240:241], v[212:213], v[228:229], v[240:241]
    v_pk_fma_f32 v[242:243], v[100:101], v[230:231], v[242:243]
    v_pk_fma_f32 v[244:245], v[214:215], v[228:229], v[244:245]
    v_pk_fma_f32 v[246:247], v[102:103], v[230:231], v[246:247]
    v_pk_fma_f32 v[248:249], v[216:217], v[228:229], v[248:249]
    v_pk_fma_f32 v[250:251], v[104:105], v[230:231], v[250:251]
    v_pk_fma_f32 v[252:253], v[218:219], v[228:229], v[252:253]
    v_pk_fma_f32 v[254:255], v[106:107], v[230:231], v[254:255]
    v_pk_fma_f32 v[240:241], v[210:211], v[232:233], v[240:241]
    v_pk_fma_f32 v[242:243], v[98:99], v[234:235], v[242:243]
    v_pk_fma_f32 v[244:245], v[212:213], v[232:233], v[244:245]
    v_pk_fma_f32 v[246:247], v[100:101], v[234:235], v[246:247]
    v_pk_fma_f32 v[248:249], v[214:215], v[232:233], v[248:249]
    v_pk_fma_f32 v[250:251], v[102:103], v[234:235], v[250:251]
    v_pk_fma_f32 v[252:253], v[216:217], v[232:233], v[252:253]
    v_pk_fma_f32 v[254:255], v[104:105], v[234:235], v[254:255]
    v_pk_fma_f32 v[240:241], v[208:209], v[236:237], v[240:241]
    v_pk_fma_f32 v[242:243], v[96:97], v[238:239], v[242:243]
    v_pk_fma_f32 v[244:245], v[210:211], v[236:237], v[244:245]
    v_pk_fma_f32 v[246:247], v[98:99], v[238:239], v[246:247]
    v_pk_fma_f32 v[248:249], v[212:213], v[236:237], v[248:249]
    v_pk_fma_f32 v[250:251], v[100:101], v[238:239], v[250:251]
    v_pk_fma_f32 v[252:253], v[214:215], v[236:237], v[252:253]
    v_pk_fma_f32 v[254:255], v[102:103], v[238:239], v[254:255]
    s_waitcnt vmcnt(13)
    v_lshlrev_b32 v208, 16, v110
    v_and_b32 v110, 0xffff0000, v110
    v_lshlrev_b32 v209, 16, v111
    v_and_b32 v111, 0xffff0000, v111
    v_lshlrev_b32 v210, 16, v112
    v_and_b32 v112, 0xffff0000, v112
    v_lshlrev_b32 v211, 16, v113
    v_and_b32 v113, 0xffff0000, v113
    v_lshlrev_b32 v212, 16, v114
    v_and_b32 v114, 0xffff0000, v114
    v_lshlrev_b32 v213, 16, v115
    v_and_b32 v115, 0xffff0000, v115
    v_lshlrev_b32 v214, 16, v116
    v_and_b32 v116, 0xffff0000, v116
    v_lshlrev_b32_e64 v215, 16, v117
    v_and_b32 v117, 0xffff0000, v117
    v_pk_mul_f32 v[240:241], v[240:241], v[208:209]
    v_pk_mul_f32 v[242:243], v[242:243], v[110:111]
    v_pk_mul_f32 v[244:245], v[244:245], v[210:211]
    v_pk_mul_f32 v[246:247], v[246:247], v[112:113]
    v_pk_mul_f32 v[248:249], v[248:249], v[212:213]
    v_pk_mul_f32 v[250:251], v[250:251], v[114:115]
    v_pk_mul_f32 v[252:253], v[252:253], v[214:215]
    v_pk_mul_f32 v[254:255], v[254:255], v[116:117]
    v_cvt_pk_bf16_f32 v224, v252, v248
    v_cvt_pk_bf16_f32 v225, v244, v240
    v_cvt_pk_bf16_f32 v226, v254, v250
    v_cvt_pk_bf16_f32 v227, v246, v242
    v_cvt_pk_bf16_f32 v228, v253, v249
    v_cvt_pk_bf16_f32 v229, v245, v241
    v_cvt_pk_bf16_f32 v230, v255, v251
    v_cvt_pk_bf16_f32 v231, v247, v243
    ds_write_b64 v203, v[224:225] offset:0
    ds_write_b64 v203, v[226:227] offset:128
    ds_write_b64 v203, v[228:229] offset:256
    ds_write_b64 v203, v[230:231] offset:384
    s_movk_i32 s79, 1152
    s_movk_i32 s80, 4608
    v_add_u32 v22, s79, v14
    v_add_u32 v23, s79, v15
    v_add_u32 v24, s79, v16
    v_add_u32 v25, s79, v17
    buffer_load_dwordx2 v[156:157], v23, s[44:47], 0 offen nt
    buffer_load_dwordx2 v[158:159], v24, s[44:47], 0 offen nt
    buffer_load_dwordx2 v[160:161], v25, s[44:47], 0 offen nt
    buffer_load_dwordx2 v[162:163], v22, s[44:47], 0 offen offset:0 nt
    buffer_load_dwordx2 v[164:165], v22, s[44:47], 0 offen offset:1280 nt
    buffer_load_dwordx2 v[166:167], v22, s[44:47], 0 offen offset:2560 nt
    buffer_load_dwordx2 v[168:169], v22, s[44:47], 0 offen offset:3840 nt
    buffer_load_dwordx4 v[178:181], v18, s[52:55], s80 offen
    buffer_load_dwordx4 v[182:185], v18, s[52:55], s80 offen offset:16
    buffer_load_dwordx2 v[170:171], v22, s[48:51], 0 offen offset:0 nt
    buffer_load_dwordx2 v[172:173], v22, s[48:51], 0 offen offset:1280 nt
    buffer_load_dwordx2 v[174:175], v22, s[48:51], 0 offen offset:2560 nt
    buffer_load_dwordx2 v[176:177], v22, s[48:51], 0 offen offset:3840 nt
    s_mov_b32 s36, s30
    s_mov_b32 s37, s31
    s_mov_b32 s38, 17563648
    s_mov_b32 s39, 0x20000
    v_mov_b32 v30, 17563648
    s_cmp_eq_u32 s3, 0
    s_cselect_b32 s80, s68, 17563648
    v_writelane_b32 v30, s80, 1
    s_lshl_b32 s77, s57, 1
    s_lshr_b32 s78, s58, 4
    s_add_u32 s77, s77, s78
    s_lshl_b32 s77, s77, 4
    s_and_b32 s78, s58, 15
    s_add_u32 s77, s77, s78
    s_lshl_b32 s77, s77, 6
    s_add_u32 s77, s77, 196608
    s_cmp_eq_u32 s3, 0
    s_cselect_b32 s77, s77, 17563648
    v_writelane_b32 v30, s77, 0
    s_and_b32 s77, s58, 7
    s_lshl_b32 s77, s77, 5
    s_lshl_b32 s78, s57, 2
    s_lshr_b32 s79, s58, 3
    s_add_u32 s78, s78, s79
    s_add_u32 s77, s77, s78
    s_lshl_b32 s77, s77, 6
    s_add_u32 s77, s77, 163840
    s_cmp_eq_u32 s3, 0
    s_cselect_b32 s77, s77, 17563648
    v_writelane_b32 v30, s77, 2
    s_waitcnt lgkmcnt(0)
    s_add_u32 s56, s56, 2654435769
    v_mov_b32 v31, s56
    s_waitcnt vmcnt(17)
    v_lshlrev_b32 v224, 16, v148
    v_and_b32 v228, 0xffff0000, v148
    v_lshlrev_b32 v225, 16, v152
    v_and_b32 v229, 0xffff0000, v152
    v_lshlrev_b32 v226, 16, v150
    v_and_b32 v230, 0xffff0000, v150
    v_lshlrev_b32 v227, 16, v154
    v_and_b32 v231, 0xffff0000, v154
    v_lshlrev_b32 v232, 16, v149
    v_and_b32 v236, 0xffff0000, v149
    v_lshlrev_b32 v233, 16, v153
    v_and_b32 v237, 0xffff0000, v153
    v_lshlrev_b32 v234, 16, v151
    v_and_b32 v238, 0xffff0000, v151
    v_lshlrev_b32 v235, 16, v155
    v_and_b32 v239, 0xffff0000, v155
    v_lshlrev_b32 v208, 16, v126
    v_and_b32 v126, 0xffff0000, v126
    v_lshlrev_b32 v209, 16, v127
    v_and_b32 v127, 0xffff0000, v127
    v_lshlrev_b32 v210, 16, v128
    v_and_b32 v128, 0xffff0000, v128
    v_lshlrev_b32 v211, 16, v129
    v_and_b32 v129, 0xffff0000, v129
    v_lshlrev_b32 v212, 16, v130
    v_and_b32 v130, 0xffff0000, v130
    v_lshlrev_b32 v213, 16, v131
    v_and_b32 v131, 0xffff0000, v131
    v_lshlrev_b32 v214, 16, v132
    v_and_b32 v132, 0xffff0000, v132
    v_lshlrev_b32 v215, 16, v133
    v_and_b32 v133, 0xffff0000, v133
    v_lshlrev_b32 v216, 16, v134
    v_and_b32 v134, 0xffff0000, v134
    v_lshlrev_b32 v217, 16, v135
    v_and_b32 v135, 0xffff0000, v135
    v_lshlrev_b32 v218, 16, v136
    v_and_b32 v136, 0xffff0000, v136
    v_lshlrev_b32 v219, 16, v137
    v_and_b32 v137, 0xffff0000, v137
    v_lshlrev_b32 v220, 16, v138
    v_and_b32 v138, 0xffff0000, v138
    v_lshlrev_b32 v221, 16, v139
    v_and_b32 v139, 0xffff0000, v139
    v_pk_mul_f32 v[240:241], v[214:215], v[224:225]
    v_pk_mul_f32 v[242:243], v[132:133], v[226:227]
    v_pk_mul_f32 v[244:245], v[216:217], v[224:225]
    v_pk_mul_f32 v[246:247], v[134:135], v[226:227]
    v_pk_mul_f32 v[248:249], v[218:219], v[224:225]
    v_pk_mul_f32 v[250:251], v[136:137], v[226:227]
    v_pk_mul_f32 v[252:253], v[220:221], v[224:225]
    v_pk_mul_f32 v[254:255], v[138:139], v[226:227]
    v_pk_fma_f32 v[240:241], v[212:213], v[228:229], v[240:241]
    v_pk_fma_f32 v[242:243], v[130:131], v[230:231], v[242:243]
    v_pk_fma_f32 v[244:245], v[214:215], v[228:229], v[244:245]
    v_pk_fma_f32 v[246:247], v[132:133], v[230:231], v[246:247]
    v_pk_fma_f32 v[248:249], v[216:217], v[228:229], v[248:249]
    v_pk_fma_f32 v[250:251], v[134:135], v[230:231], v[250:251]
    v_pk_fma_f32 v[252:253], v[218:219], v[228:229], v[252:253]
    v_pk_fma_f32 v[254:255], v[136:137], v[230:231], v[254:255]
    v_pk_fma_f32 v[240:241], v[210:211], v[232:233], v[240:241]
    v_pk_fma_f32 v[242:243], v[128:129], v[234:235], v[242:243]
    v_pk_fma_f32 v[244:245], v[212:213], v[232:233], v[244:245]
    v_pk_fma_f32 v[246:247], v[130:131], v[234:235], v[246:247]
    v_pk_fma_f32 v[248:249], v[214:215], v[232:233], v[248:249]
    v_pk_fma_f32 v[250:251], v[132:133], v[234:235], v[250:251]
    v_pk_fma_f32 v[252:253], v[216:217], v[232:233], v[252:253]
    v_pk_fma_f32 v[254:255], v[134:135], v[234:235], v[254:255]
    v_pk_fma_f32 v[240:241], v[208:209], v[236:237], v[240:241]
    v_pk_fma_f32 v[242:243], v[126:127], v[238:239], v[242:243]
    v_pk_fma_f32 v[244:245], v[210:211], v[236:237], v[244:245]
    v_pk_fma_f32 v[246:247], v[128:129], v[238:239], v[246:247]
    v_pk_fma_f32 v[248:249], v[212:213], v[236:237], v[248:249]
    v_pk_fma_f32 v[250:251], v[130:131], v[238:239], v[250:251]
    v_pk_fma_f32 v[252:253], v[214:215], v[236:237], v[252:253]
    v_pk_fma_f32 v[254:255], v[132:133], v[238:239], v[254:255]
    s_waitcnt vmcnt(13)
    v_lshlrev_b32 v208, 16, v140
    v_and_b32 v140, 0xffff0000, v140
    v_lshlrev_b32 v209, 16, v141
    v_and_b32 v141, 0xffff0000, v141
    v_lshlrev_b32 v210, 16, v142
    v_and_b32 v142, 0xffff0000, v142
    v_lshlrev_b32 v211, 16, v143
    v_and_b32 v143, 0xffff0000, v143
    v_lshlrev_b32 v212, 16, v144
    v_and_b32 v144, 0xffff0000, v144
    v_lshlrev_b32 v213, 16, v145
    v_and_b32 v145, 0xffff0000, v145
    v_lshlrev_b32 v214, 16, v146
    v_and_b32 v146, 0xffff0000, v146
    v_lshlrev_b32_e64 v215, 16, v147
    v_and_b32 v147, 0xffff0000, v147
    v_pk_mul_f32 v[240:241], v[240:241], v[208:209]
    v_pk_mul_f32 v[242:243], v[242:243], v[140:141]
    v_pk_mul_f32 v[244:245], v[244:245], v[210:211]
    v_pk_mul_f32 v[246:247], v[246:247], v[142:143]
    v_pk_mul_f32 v[248:249], v[248:249], v[212:213]
    v_pk_mul_f32 v[250:251], v[250:251], v[144:145]
    v_pk_mul_f32 v[252:253], v[252:253], v[214:215]
    v_pk_mul_f32 v[254:255], v[254:255], v[146:147]
    v_cvt_pk_bf16_f32 v224, v252, v248
    v_cvt_pk_bf16_f32 v225, v244, v240
    v_cvt_pk_bf16_f32 v226, v254, v250
    v_cvt_pk_bf16_f32 v227, v246, v242
    v_cvt_pk_bf16_f32 v228, v253, v249
    v_cvt_pk_bf16_f32 v229, v245, v241
    v_cvt_pk_bf16_f32 v230, v255, v251
    v_cvt_pk_bf16_f32 v231, v247, v243
    ds_write_b64 v203, v[224:225] offset:8192
    ds_write_b64 v203, v[226:227] offset:8320
    ds_write_b64 v203, v[228:229] offset:8448
    ds_write_b64 v203, v[230:231] offset:8576
    s_mul_i32 s84, s57, 24
    s_sub_u32 s78, s58, 28
    s_mul_i32 s78, s78, 6
    s_add_u32 s84, s84, s78
    s_add_u32 s84, s84, 448
    s_add_u32 s84, s84, s3
    s_mul_i32 s86, s3, 21248
    s_lshl_b32 s85, s84, 12
    s_add_u32 s44, s12, s85
    s_addc_u32 s45, s13, 0
    s_mov_b32 s46, 4096
    s_mov_b32 s47, 0x20000
    s_add_u32 s88, s85, 1048576
    v_lshlrev_b32_e64 v1, 4, v0
    buffer_load_dwordx4 v[32:35], v1, s[44:47], 0 offen offset:0 nt
    buffer_load_dwordx4 v[36:39], v1, s[44:47], 0 offen offset:1024 nt
    buffer_load_dwordx4 v[40:43], v1, s[44:47], 0 offen offset:2048 nt
    buffer_load_dwordx4 v[44:47], v1, s[44:47], 0 offen offset:3072 nt
    s_lshl_b32 s78, s57, 8
    s_lshl_b32 s79, s58, 3
    s_add_u32 s78, s78, s79
    s_lshl_b32 s79, s3, 1
    s_add_u32 s78, s78, s79
    v_lshrrev_b32 v196, 5, v0
    v_add_u32 v196, s78, v196
    v_and_b32 v197, 31, v0
    v_lshlrev_b32 v197, 3, v197
    v_mad_u32_u24 v197, v196, s73, v197
    v_lshlrev_b32 v196, 3, v196
    buffer_load_dwordx2 v[186:187], v197, s[32:35], 0 offen offset:0
    buffer_load_dwordx2 v[188:189], v197, s[32:35], 0 offen offset:256
    buffer_load_dwordx2 v[190:191], v197, s[32:35], 0 offen offset:512
    buffer_load_dwordx2 v[192:193], v197, s[32:35], 0 offen offset:768
    buffer_load_dwordx2 v[194:195], v197, s[32:35], 0 offen offset:1024
    s_mov_b32 s52, s22
    s_mov_b32 s53, s23
    s_mov_b32 s54, 2211840
    s_mov_b32 s55, 0x20000
    v_min_u32 v29, ((DONE-I_LATE+511)/512)-1, v0
    s_mul_i32 s80, s3, ((DONE-I_LATE+511)/512)
    v_add_u32 v29, s80, v29
    v_lshlrev_b32 v29, 7, v29
    s_getpc_b64 s[80:81]
CT_20:
    v_add_u32 v29, I_LATE-CT_20, v29
    s_mov_b32 s82, CODE_END-CT_20
    s_mov_b32 s83, 0x20000
    buffer_load_dword v29, v29, s[80:83], 0 offen
    s_and_b32 s77, s58, 7
    s_lshl_b32 s78, s57, 2
    s_lshr_b32 s79, s58, 3
    s_add_u32 s78, s78, s79
    s_mul_i32 s77, s77, 54
    s_add_u32 s77, s77, s78
    s_mul_i32 s77, s77, 5120
    s_add_u32 s77, s77, 4194304
    v_lshrrev_b32 v24, 4, v0
    v_bfe_u32 v25, v0, 2, 2
    v_lshl_add_u32 v24, v24, 2, v25
    v_mul_u32_u24 v24, 160, v24
    v_and_b32 v25, 3, v0
    s_add_u32 s79, s3, 0
    s_cmp_ge_u32 s79, 5
    s_cselect_b32 s80, 1, 0
    s_mul_i32 s81, s80, 5
    s_sub_u32 s79, s79, s81
    s_mul_i32 s81, s80, 163840
    s_add_u32 s81, s81, s77
    s_lshl_b32 s82, s79, 10
    s_add_u32 s81, s81, s82
    s_cmp_ge_u32 s78, 22
    s_cselect_b32 s82, s80, 0
    s_cmp_ge_u32 s79, 5
    s_cselect_b32 s82, 1, s82
    s_cmp_lg_u32 s82, 0
    s_cselect_b32 s74, 17563648, s81
    s_min_u32 s79, s79, 4
    s_and_b32 s82, s79, 1
    s_lshl_b32 s82, s82, 3
    s_lshr_b32 s83, s79, 1
    s_lshl_b32 s83, s83, 6
    s_add_u32 s82, s82, s83
    s_mul_i32 s83, s80, 5120
    s_add_u32 s82, s82, s83
    s_add_u32 s82, s82, 114688
    s_cmp_eq_u32 s79, 4
    s_cselect_b32 s83, 3, 4
    v_lshlrev_b32 v200, s83, v25
    v_add3_u32 v200, v200, v24, s82
    s_add_u32 s79, s3, 4
    s_cmp_ge_u32 s79, 5
    s_cselect_b32 s80, 1, 0
    s_mul_i32 s81, s80, 5
    s_sub_u32 s79, s79, s81
    s_mul_i32 s81, s80, 163840
    s_add_u32 s81, s81, s77
    s_lshl_b32 s82, s79, 10
    s_add_u32 s81, s81, s82
    s_cmp_ge_u32 s78, 22
    s_cselect_b32 s82, s80, 0
    s_cmp_ge_u32 s79, 5
    s_cselect_b32 s82, 1, s82
    s_cmp_lg_u32 s82, 0
    s_cselect_b32 s75, 17563648, s81
    s_min_u32 s79, s79, 4
    s_and_b32 s82, s79, 1
    s_lshl_b32 s82, s82, 3
    s_lshr_b32 s83, s79, 1
    s_lshl_b32 s83, s83, 6
    s_add_u32 s82, s82, s83
    s_mul_i32 s83, s80, 5120
    s_add_u32 s82, s82, s83
    s_add_u32 s82, s82, 114688
    s_cmp_eq_u32 s79, 4
    s_cselect_b32 s83, 3, 4
    v_lshlrev_b32 v201, s83, v25
    v_add3_u32 v201, v201, v24, s82
    s_add_u32 s79, s3, 8
    s_cmp_ge_u32 s79, 5
    s_cselect_b32 s80, 1, 0
    s_mul_i32 s81, s80, 5
    s_sub_u32 s79, s79, s81
    s_mul_i32 s81, s80, 163840
    s_add_u32 s81, s81, s77
    s_lshl_b32 s82, s79, 10
    s_add_u32 s81, s81, s82
    s_cmp_ge_u32 s78, 22
    s_cselect_b32 s82, s80, 0
    s_cmp_ge_u32 s79, 5
    s_cselect_b32 s82, 1, s82
    s_cmp_lg_u32 s82, 0
    s_cselect_b32 s76, 17563648, s81
    s_min_u32 s79, s79, 4
    s_and_b32 s82, s79, 1
    s_lshl_b32 s82, s82, 3
    s_lshr_b32 s83, s79, 1
    s_lshl_b32 s83, s83, 6
    s_add_u32 s82, s82, s83
    s_mul_i32 s83, s80, 5120
    s_add_u32 s82, s82, s83
    s_add_u32 s82, s82, 114688
    s_cmp_eq_u32 s79, 4
    s_cselect_b32 s83, 3, 4
    v_lshlrev_b32 v202, s83, v25
    v_add3_u32 v202, v202, v24, s82
    s_waitcnt vmcnt(14)
    v_lshlrev_b32 v224, 16, v178
    v_and_b32 v228, 0xffff0000, v178
    v_lshlrev_b32 v225, 16, v182
    v_and_b32 v229, 0xffff0000, v182
    v_lshlrev_b32 v226, 16, v180
    v_and_b32 v230, 0xffff0000, v180
    v_lshlrev_b32 v227, 16, v184
    v_and_b32 v231, 0xffff0000, v184
    v_lshlrev_b32 v232, 16, v179
    v_and_b32 v236, 0xffff0000, v179
    v_lshlrev_b32 v233, 16, v183
    v_and_b32 v237, 0xffff0000, v183
    v_lshlrev_b32 v234, 16, v181
    v_and_b32 v238, 0xffff0000, v181
    v_lshlrev_b32 v235, 16, v185
    v_and_b32 v239, 0xffff0000, v185
    v_lshlrev_b32 v208, 16, v156
    v_and_b32 v156, 0xffff0000, v156
    v_lshlrev_b32 v209, 16, v157
    v_and_b32 v157, 0xffff0000, v157
    v_lshlrev_b32 v210, 16, v158
    v_and_b32 v158, 0xffff0000, v158
    v_lshlrev_b32 v211, 16, v159
    v_and_b32 v159, 0xffff0000, v159
    v_lshlrev_b32 v212, 16, v160
    v_and_b32 v160, 0xffff0000, v160
    v_lshlrev_b32 v213, 16, v161
    v_and_b32 v161, 0xffff0000, v161
    v_lshlrev_b32 v214, 16, v162
    v_and_b32 v162, 0xffff0000, v162
    v_lshlrev_b32 v215, 16, v163
    v_and_b32 v163, 0xffff0000, v163
    v_lshlrev_b32 v216, 16, v164
    v_and_b32 v164, 0xffff0000, v164
    v_lshlrev_b32 v217, 16, v165
    v_and_b32 v165, 0xffff0000, v165
    v_lshlrev_b32 v218, 16, v166
    v_and_b32 v166, 0xffff0000, v166
    v_lshlrev_b32 v219, 16, v167
    v_and_b32 v167, 0xffff0000, v167
    v_lshlrev_b32 v220, 16, v168
    v_and_b32 v168, 0xffff0000, v168
    v_lshlrev_b32_e64 v221, 16, v169
    v_and_b32 v169, 0xffff0000, v169
    v_pk_mul_f32 v[240:241], v[214:215], v[224:225]
    v_pk_mul_f32 v[242:243], v[162:163], v[226:227]
    v_pk_mul_f32 v[244:245], v[216:217], v[224:225]
    v_pk_mul_f32 v[246:247], v[164:165], v[226:227]
    v_pk_mul_f32 v[248:249], v[218:219], v[224:225]
    v_pk_mul_f32 v[250:251], v[166:167], v[226:227]
    v_pk_mul_f32 v[252:253], v[220:221], v[224:225]
    v_pk_mul_f32 v[254:255], v[168:169], v[226:227]
    v_pk_fma_f32 v[240:241], v[212:213], v[228:229], v[240:241]
    v_pk_fma_f32 v[242:243], v[160:161], v[230:231], v[242:243]
    v_pk_fma_f32 v[244:245], v[214:215], v[228:229], v[244:245]
    v_pk_fma_f32 v[246:247], v[162:163], v[230:231], v[246:247]
    v_pk_fma_f32 v[248:249], v[216:217], v[228:229], v[248:249]
    v_pk_fma_f32 v[250:251], v[164:165], v[230:231], v[250:251]
    v_pk_fma_f32 v[252:253], v[218:219], v[228:229], v[252:253]
    v_pk_fma_f32 v[254:255], v[166:167], v[230:231], v[254:255]
    v_pk_fma_f32 v[240:241], v[210:211], v[232:233], v[240:241]
    v_pk_fma_f32 v[242:243], v[158:159], v[234:235], v[242:243]
    v_pk_fma_f32 v[244:245], v[212:213], v[232:233], v[244:245]
    v_pk_fma_f32 v[246:247], v[160:161], v[234:235], v[246:247]
    v_pk_fma_f32 v[248:249], v[214:215], v[232:233], v[248:249]
    v_pk_fma_f32 v[250:251], v[162:163], v[234:235], v[250:251]
    v_pk_fma_f32 v[252:253], v[216:217], v[232:233], v[252:253]
    v_pk_fma_f32 v[254:255], v[164:165], v[234:235], v[254:255]
    v_pk_fma_f32 v[240:241], v[208:209], v[236:237], v[240:241]
    v_pk_fma_f32 v[242:243], v[156:157], v[238:239], v[242:243]
    v_pk_fma_f32 v[244:245], v[210:211], v[236:237], v[244:245]
    v_pk_fma_f32 v[246:247], v[158:159], v[238:239], v[246:247]
    v_pk_fma_f32 v[248:249], v[212:213], v[236:237], v[248:249]
    v_pk_fma_f32 v[250:251], v[160:161], v[238:239], v[250:251]
    v_pk_fma_f32 v[252:253], v[214:215], v[236:237], v[252:253]
    v_pk_fma_f32 v[254:255], v[162:163], v[238:239], v[254:255]
    s_waitcnt vmcnt(10)
    v_lshlrev_b32 v208, 16, v170
    v_and_b32 v170, 0xffff0000, v170
    v_lshlrev_b32 v209, 16, v171
    v_and_b32 v171, 0xffff0000, v171
    v_lshlrev_b32 v210, 16, v172
    v_and_b32 v172, 0xffff0000, v172
    v_lshlrev_b32 v211, 16, v173
    v_and_b32 v173, 0xffff0000, v173
    v_lshlrev_b32 v212, 16, v174
    v_and_b32 v174, 0xffff0000, v174
    v_lshlrev_b32 v213, 16, v175
    v_and_b32 v175, 0xffff0000, v175
    v_lshlrev_b32 v214, 16, v176
    v_and_b32 v176, 0xffff0000, v176
    v_lshlrev_b32_e64 v215, 16, v177
    v_and_b32 v177, 0xffff0000, v177
    v_pk_mul_f32 v[240:241], v[240:241], v[208:209]
    v_pk_mul_f32 v[242:243], v[242:243], v[170:171]
    v_pk_mul_f32 v[244:245], v[244:245], v[210:211]
    v_pk_mul_f32 v[246:247], v[246:247], v[172:173]
    v_pk_mul_f32 v[248:249], v[248:249], v[212:213]
    v_pk_mul_f32 v[250:251], v[250:251], v[174:175]
    v_pk_mul_f32 v[252:253], v[252:253], v[214:215]
    v_pk_mul_f32 v[254:255], v[254:255], v[176:177]
    v_cvt_pk_bf16_f32 v224, v252, v248
    v_cvt_pk_bf16_f32 v225, v244, v240
    v_cvt_pk_bf16_f32 v226, v254, v250
    v_cvt_pk_bf16_f32 v227, v246, v242
    v_cvt_pk_bf16_f32 v228, v253, v249
    v_cvt_pk_bf16_f32 v229, v245, v241
    v_cvt_pk_bf16_f32 v230, v255, v251
    v_cvt_pk_bf16_f32 v231, v247, v243
    ds_write_b64 v203, v[224:225] offset:16384
    ds_write_b64 v203, v[226:227] offset:16512
PAGE7:
    s_cbranch_execz PAGE8
    ds_write_b64 v203, v[228:229] offset:16640
    ds_write_b64 v203, v[230:231] offset:16768
    s_waitcnt lgkmcnt(0)
    s_barrier
    s_nop 0
    ds_read_b128 v[208:211], v204 offset:0
    ds_read_b128 v[212:215], v204 offset:4096
    ds_read_b128 v[216:219], v204 offset:8192
    ds_read_b128 v[220:223], v204 offset:12288
    ds_read_b128 v[224:227], v204 offset:16384
    ds_read_b128 v[228:231], v204 offset:20480
    s_waitcnt lgkmcnt(4)
    buffer_store_dwordx4 v[208:211], v205, s[36:39], s59 offen sc1
    buffer_store_dwordx4 v[212:215], v206, s[36:39], s59 offen sc1
    s_add_u32 s59, s59, 262144
    s_waitcnt lgkmcnt(2)
    buffer_store_dwordx4 v[216:219], v205, s[36:39], s59 offen sc1
    buffer_store_dwordx4 v[220:223], v206, s[36:39], s59 offen sc1
    s_add_u32 s59, s59, 262144
    s_waitcnt lgkmcnt(0)
    buffer_store_dwordx4 v[224:227], v205, s[36:39], s59 offen sc1
    buffer_store_dwordx4 v[228:231], v206, s[36:39], s59 offen sc1
    s_add_u32 s59, s59, 262144
    s_lshl_b32 s81, s3, 10
    s_add_u32 m0, s81, 114688
    s_nop 0
    buffer_load_dwordx4 v80, s[52:55], 0 offen nt lds
    s_add_u32 m0, s81, 118784
    s_nop 0
    buffer_load_dwordx4 v81, s[52:55], 0 offen nt lds
    s_add_u32 m0, s81, 122880
    s_nop 0
    buffer_load_dwordx4 v82, s[52:55], 0 offen nt lds
    s_waitcnt vmcnt(10)
    s_mov_b32 s78, 0x3f803f80
    v_mov_b32_e64 v232, 0
    v_mov_b32 v233, 0
    v_dot2c_f32_bf16 v232, s78, v186
    v_dot2c_f32_bf16 v233, v186, v186
    v_dot2c_f32_bf16 v232, s78, v187
    v_dot2c_f32_bf16 v233, v187, v187
    v_dot2c_f32_bf16 v232, s78, v188
    v_dot2c_f32_bf16 v233, v188, v188
    v_dot2c_f32_bf16 v232, s78, v189
    v_dot2c_f32_bf16 v233, v189, v189
    v_dot2c_f32_bf16 v232, s78, v190
    v_dot2c_f32_bf16 v233, v190, v190
    v_dot2c_f32_bf16 v232, s78, v191
    v_dot2c_f32_bf16 v233, v191, v191
    v_dot2c_f32_bf16 v232, s78, v192
    v_dot2c_f32_bf16 v233, v192, v192
    v_dot2c_f32_bf16 v232, s78, v193
    v_dot2c_f32_bf16 v233, v193, v193
    v_dot2c_f32_bf16 v232, s78, v194
    v_dot2c_f32_bf16 v233, v194, v194
    v_dot2c_f32_bf16 v232, s78, v195
    v_dot2c_f32_bf16 v233, v195, v195
    s_nop 1
    v_add_f32_dpp v232, v232, v232 row_ror:8 row_mask:0xf bank_mask:0xf
    v_add_f32_dpp v233, v233, v233 row_ror:8 row_mask:0xf bank_mask:0xf
    s_nop 1
    v_add_f32_dpp v232, v232, v232 row_ror:4 row_mask:0xf bank_mask:0xf
    v_add_f32_dpp v233, v233, v233 row_ror:4 row_mask:0xf bank_mask:0xf
    s_nop 1
    v_add_f32_dpp v232, v232, v232 row_ror:2 row_mask:0xf bank_mask:0xf
    v_add_f32_dpp v233, v233, v233 row_ror:2 row_mask:0xf bank_mask:0xf
    s_nop 1
    v_add_f32_dpp v232, v232, v232 row_ror:1 row_mask:0xf bank_mask:0xf
    v_add_f32_dpp v233, v233, v233 row_ror:1 row_mask:0xf bank_mask:0xf
    s_nop 1
    v_add_f32_dpp v232, v232, v232 row_bcast:15 row_mask:0xa bank_mask:0xf
    v_add_f32_dpp v233, v233, v233 row_bcast:15 row_mask:0xa bank_mask:0xf
    s_nop 0
    v_mul_f32 v234, 0x3acccccd, v232
    v_mul_f32 v233, 0x3acccccd, v233
    v_fma_f32 v233, -v234, v234, v233
    v_max_f32 v233, 0, v233
    v_add_f32 v233, 0x3727c5ac, v233
    v_rsq_f32_e64 v235, v233
    s_mov_b32 s78, 65536
    s_mov_b32 exec_lo, 0x10000
    s_mov_b32 exec_hi, 0x10000
    buffer_store_dwordx2 v[234:235], v196, s[36:39], s78 offen sc1
    s_mov_b64 exec, -1
    s_waitcnt vmcnt(4)
    s_barrier
    s_mov_b32 exec_lo, 2
    s_mov_b32 exec_hi, 0
    buffer_store_dword v31, v30, s[36:39], 0 offen sc1
    s_mov_b64 exec, -1
    s_waitcnt vmcnt(17)
I_LATE:
    s_nop 0
    v_mov_b32_dpp v51, v36 wave_rol:1 row_mask:0xf bank_mask:0xf
    v_mov_b32_dpp v64, v37 wave_rol:1 row_mask:0xf bank_mask:0xf
    v_mov_b32_dpp v55, v40 wave_rol:1 row_mask:0xf bank_mask:0xf
    v_mov_b32_dpp v65, v41 wave_rol:1 row_mask:0xf bank_mask:0xf
    v_mov_b32_dpp v59, v44 wave_rol:1 row_mask:0xf bank_mask:0xf
    v_mov_b32_dpp v66, v45 wave_rol:1 row_mask:0xf bank_mask:0xf
    v_mov_b32 v48, v33
    v_mov_b32 v49, v34
    v_mov_b32 v50, v35
    v_mov_b32 v52, v37
    v_mov_b32 v53, v38
    v_mov_b32 v54, v39
    v_mov_b32 v56, v41
    v_mov_b32 v57, v42
    v_mov_b32 v58, v43
    v_mov_b32 v60, v45
    v_mov_b32 v61, v46
    v_mov_b32 v62, v47
    v_mov_b32_dpp v51, v32 wave_shl:1 row_mask:0xf bank_mask:0xf
    v_mov_b32_dpp v64, v33 wave_shl:1 row_mask:0xf bank_mask:0xf
    v_mov_b32_dpp v55, v36 wave_shl:1 row_mask:0xf bank_mask:0xf
    v_mov_b32_dpp v65, v37 wave_shl:1 row_mask:0xf bank_mask:0xf
    v_mov_b32_dpp v59, v40 wave_shl:1 row_mask:0xf bank_mask:0xf
    v_mov_b32_dpp v66, v41 wave_shl:1 row_mask:0xf bank_mask:0xf
    v_mov_b32_dpp v63, v44 wave_shl:1 row_mask:0xf bank_mask:0xf bound_ctrl:0
    v_mov_b32_dpp v67, v45 wave_shl:1 row_mask:0xf bank_mask:0xf bound_ctrl:0
    s_nop 1
    v_lshlrev_b32 v1, 4, v0
    v_add_u32 v5, s86, v1
    v_mov_b32 v20, 0
    v_mov_b32 v21, 0
    v_mov_b32 v22, 0
    v_mov_b32 v23, 0
    v_lshrrev_b32 v4, 1, v0
    v_mul_u32_u24 v4, 4160, v4
    v_and_b32 v6, 1, v0
    v_lshl_add_u32 v4, v6, 4, v4
    v_add_u32 v4, s86, v4
    s_mov_b32 exec_lo, 0xff
    s_mov_b32 exec_hi, 0
    ds_write_b128 v4, v[20:23]
    s_mov_b32 exec_lo, -1
    ds_write_b128 v5, v[20:23] offset:16640
    v_lshlrev_b32 v12, 16, v32
    v_alignbit_b32 v13, v48, v32, 16
    s_mov_b32 exec_lo, 1
    ds_write_b32 v5, v12 offset:4188
    ds_write_b32 v5, v32 offset:8348
    ds_write_b64 v5, v[12:13] offset:12504
    s_mov_b64 exec, -1
    s_nop 0
    v_alignbit_b32 v96, v48, v32, 16
    v_alignbit_b32 v100, v49, v48, 16
    v_alignbit_b32 v97, v49, v33, 16
    v_alignbit_b32 v101, v50, v49, 16
    v_alignbit_b32 v98, v50, v34, 16
    v_alignbit_b32 v102, v51, v50, 16
    v_alignbit_b32 v99, v51, v35, 16
    v_alignbit_b32 v103, v64, v51, 16
    ds_write_b128 v5, v[32:35] offset:32
    ds_write_b128 v5, v[96:99] offset:4192
    ds_write_b128 v5, v[48:51] offset:8352
    ds_write_b128 v5, v[100:103] offset:12512
    v_alignbit_b32 v104, v52, v36, 16
    v_alignbit_b32 v108, v53, v52, 16
    v_alignbit_b32 v105, v53, v37, 16
    v_alignbit_b32 v109, v54, v53, 16
    v_alignbit_b32 v106, v54, v38, 16
    v_alignbit_b32 v110, v55, v54, 16
    v_alignbit_b32 v107, v55, v39, 16
    v_alignbit_b32 v111, v65, v55, 16
    ds_write_b128 v5, v[36:39] offset:1056
    ds_write_b128 v5, v[104:107] offset:5216
    ds_write_b128 v5, v[52:55] offset:9376
    ds_write_b128 v5, v[108:111] offset:13536
    v_alignbit_b32 v112, v56, v40, 16
    v_alignbit_b32 v116, v57, v56, 16
    v_alignbit_b32 v113, v57, v41, 16
    v_alignbit_b32 v117, v58, v57, 16
    v_alignbit_b32 v114, v58, v42, 16
    v_alignbit_b32 v118, v59, v58, 16
    v_alignbit_b32 v115, v59, v43, 16
    v_alignbit_b32 v119, v66, v59, 16
    ds_write_b128 v5, v[40:43] offset:2080
    ds_write_b128 v5, v[112:115] offset:6240
    ds_write_b128 v5, v[56:59] offset:10400
    ds_write_b128 v5, v[116:119] offset:14560
    v_and_b32 v28, 31, v0
    v_lshlrev_b32 v28, 6, v28
    v_add_u32 v28, 145408, v28
    buffer_load_dword v25, v28, s[36:39], 0 offen sc1
    v_alignbit_b32 v120, v60, v44, 16
    v_alignbit_b32 v124, v61, v60, 16
    v_alignbit_b32 v121, v61, v45, 16
    v_alignbit_b32 v125, v62, v61, 16
    v_alignbit_b32 v122, v62, v46, 16
    v_alignbit_b32 v126, v63, v62, 16
    v_alignbit_b32 v123, v63, v47, 16
    v_alignbit_b32 v127, v67, v63, 16
    ds_write_b128 v5, v[44:47] offset:3104
    ds_write_b128 v5, v[120:123] offset:7264
    ds_write_b128 v5, v[60:63] offset:11424
    ds_write_b128 v5, v[124:127] offset:15584
    s_lshl_b32 s78, s84, 1
    s_and_b32 s78, s78, -4
    s_load_dword s77, s[14:15], s78
    s_waitcnt vmcnt(2)
    s_barrier
    s_mov_b32 exec_lo, 1
    s_mov_b32 exec_hi, 0
    buffer_store_dword v31, v30, s[36:39], 0 offen sc1
    s_mov_b64 exec, -1
    s_nop 0
    ds_read_b64_tr_b16 v[236:237], v200 offset:0
    ds_read_b64_tr_b16 v[238:239], v200 offset:2560
    ds_read_b64_tr_b16 v[240:241], v201 offset:0
    ds_read_b64_tr_b16 v[242:243], v201 offset:2560
    ds_read_b64_tr_b16 v[244:245], v202 offset:0
    ds_read_b64_tr_b16 v[246:247], v202 offset:2560
    v_lshlrev_b32 v26, 4, v0
    s_waitcnt lgkmcnt(0)
    buffer_store_dwordx4 v[236:239], v26, s[36:39], s74 offen sc1
    buffer_store_dwordx4 v[240:243], v26, s[36:39], s75 offen sc1
    buffer_store_dwordx4 v[244:247], v26, s[36:39], s76 offen sc1
    s_waitcnt vmcnt(4)
    v_cmp_ne_u32 vcc, s56, v25
    s_mov_b64 s[82:83], vcc
    s_cmp_eq_u64 s[82:83], 0
    s_cbranch_scc0 FAI_RETRY_21
FAI_DONE_22:
    v_lshlrev_b32 v1, 4, v0
    buffer_load_dwordx4 v[80:83], v1, s[36:39], s88 offen offset:0 sc1
    buffer_load_dwordx4 v[84:87], v1, s[36:39], s88 offen offset:1024 sc1
    buffer_load_dwordx4 v[88:91], v1, s[36:39], s88 offen offset:2048 sc1
    buffer_load_dwordx4 v[92:95], v1, s[36:39], s88 offen offset:3072 sc1
    s_lshr_b32 s78, s57, 1
    s_lshl_b32 s78, s78, 3
    s_and_b32 s79, s58, 7
    s_add_u32 s53, s78, s79
    s_mul_i32 s28, s79, 7
    s_and_b32 s78, s57, 1
    s_lshl_b32 s78, s78, 2
    s_lshr_b32 s79, s58, 3
    s_add_u32 s54, s78, s79
    s_mul_i32 s79, s79, 14
    s_add_u32 s28, s28, s79
    s_lshr_b32 s28, s28, 2
    s_cmp_ge_u32 s28, 14
    s_cselect_b32 s79, 14, 0
    s_sub_u32 s28, s28, s79
    s_mov_b32 s28, 0
    s_mul_i32 s55, s3, 14
    s_sub_u32 s79, s3, 1
    s_cmp_ge_u32 s3, 2
    s_cselect_b32 s79, s79, 0
    s_sub_u32 s55, s55, s79
    s_mul_i32 s79, s54, 54
    s_add_u32 s79, s79, s55
    s_mul_i32 s79, s79, 5120
    s_add_u32 s79, s79, 4194304
    s_add_u32 s16, s79, 71680
    s_mul_i32 s52, s28, 5120
    s_add_u32 s52, s52, s79
    v_lshlrev_b32 v14, 4, v0
    v_add_u32 v15, 4096, v14
    s_mov_b32 s40, s24
    s_mov_b32 s41, s25
    s_mov_b32 s42, 1280
    s_mov_b32 s43, 0x20000
    v_lshrrev_b32 v16, 4, v0
    s_mul_i32 s78, s54, 160
    v_lshlrev_b32 v17, 4, v16
    v_lshlrev_b32 v18, 3, v16
    buffer_load_dwordx4 a[240:243], v17, s[40:43], s78 offen
    buffer_load_dwordx4 a[244:247], v17, s[40:43], s78 offen offset:64
    buffer_load_dwordx2 a[248:249], v18, s[40:43], s78 offen offset:128
    s_mov_b32 s68, 7
    v_and_b32 v27, 31, v0
    v_lshlrev_b32 v27, 6, v27
    s_lshl_b32 s73, s68, 11
    s_add_u32 s73, s73, 131072
    s_lshl_b32 s78, s54, 11
    s_add_u32 s78, s78, 163840
    v_mov_b32 v16, s73
    v_mov_b32 v18, s78
    v_and_b32 v19, 32, v0
    v_cmp_eq_u32 vcc, 0, v19
    s_nop 1
    v_cndmask_b32 v16, v18, v16, vcc
    v_add_u32 v27, v16, v27
    s_waitcnt lgkmcnt(0)
    v_and_b32 v6, 15, v0
    v_lshrrev_b32 v7, 4, v0
    v_add_u32 v8, 1, v6
    v_and_b32 v9, 3, v8
    v_and_b32 v8, 28, v8
    v_mul_u32_u24 v9, 4160, v9
    v_lshl_add_u32 v9, v8, 1, v9
    v_lshl_add_u32 v9, v7, 4, v9
    v_add_u32 v2, s86, v9
    v_lshlrev_b32 v8, 1, v6
    v_sub_u32 v8, v8, v7
    v_lshlrev_b32 v8, 4, v8
    v_add_u32 v8, 16720, v8
    v_add_u32 v3, s86, v8
    v_sub_u32 v8, 15, v6
    v_lshrrev_b32_e64 v9, 3, v8
    v_cmp_eq_u32 s[80:81], v9, v7
    v_bfe_u32 v9, v8, 1, 2
    v_and_b32 v10, 1, v8
    v_lshlrev_b32 v10, 4, v10
    s_and_b32 s78, s84, 1
    s_lshl_b32 s78, s78, 4
    s_lshr_b32 s77, s77, s78
    s_and_b32 s77, s77, 0xffff
    v_mov_b32 v11, s77
    v_lshlrev_b32 v11, v10, v11
    v_cndmask_b32 v11, 0, v11, s[80:81]
    v_cmp_eq_u32 vcc, 0, v9
    s_nop 1
    v_cndmask_b32 v192, 0, v11, vcc
    v_cmp_eq_u32 vcc, 1, v9
    s_nop 1
    v_cndmask_b32 v193, 0, v11, vcc
    v_cmp_eq_u32 vcc, 2, v9
    s_nop 1
    v_cndmask_b32 v194, 0, v11, vcc
    v_cmp_eq_u32 vcc, 3, v9
    s_nop 1
    v_cndmask_b32 v195, 0, v11, vcc
    s_waitcnt vmcnt(7)
    s_barrier
    s_mov_b32 exec_lo, 4
    s_mov_b32 exec_hi, 0
    buffer_store_dword v31, v30, s[36:39], 0 offen sc1
    s_mov_b64 exec, -1
    s_waitcnt vmcnt(4)
    v_lshlrev_b32 v1, 4, v0
    v_add_u32_e64 v5, s86, v1
    ds_write_b128 v5, v[80:83] offset:17152
    ds_write_b128 v5, v[84:87] offset:18176
    ds_write_b128 v5, v[88:91] offset:19200
    ds_write_b128 v5, v[92:95] offset:20224
    s_add_u32 s18, s85, 7340032
    s_sub_u32 s84, s84, s3
    s_lshl_b32 s48, s84, 5
    s_add_u32 s48, s48, 262144
    s_cmp_eq_u32 s3, 0
    s_cselect_b32 s48, s48, 17563648
    s_mov_b32 s50, 3
    s_add_u32 s84, s84, 4
    s_lshr_b32 s78, s3, 1
    s_add_u32 s84, s84, s78
    s_and_b32 s87, s3, 1
    s_mul_i32 s86, s78, 21248
    s_lshl_b32 s85, s84, 12
    s_add_u32 s44, s12, s85
    s_addc_u32 s45, s13, 0
    s_mov_b32 s46, 4096
    s_mov_b32 s47, 0x20000
    s_lshl_b32 s89, s87, 11
    s_add_u32 s88, s85, s89
    s_add_u32 s88, s88, 1048576
    s_lshl_b32 s78, s84, 1
    s_and_b32 s78, s78, -4
    s_load_dword s77, s[14:15], s78
    s_waitcnt lgkmcnt(0)
    ds_read_b128 v[64:67], v3 offset:448
    ds_read_b64 v[32:33], v2 offset:0
    ds_read_b64 v[34:35], v2 offset:8
    ds_read_b128 v[68:71], v3 offset:960
    ds_read_b64 v[36:37], v2 offset:512
    ds_read_b64 v[38:39], v2 offset:520
    ds_read_b128 v[72:75], v3 offset:1472
    ds_read_b64 v[40:41], v2 offset:1024
    ds_read_b64 v[42:43], v2 offset:1032
    ds_read_b128 v[76:79], v3 offset:1984
    ds_read_b64 v[44:45], v2 offset:1536
    ds_read_b64 v[46:47], v2 offset:1544
    ds_read_b128 v[80:83], v3 offset:2496
    ds_read_b64 v[48:49], v2 offset:2048
    ds_read_b64 v[50:51], v2 offset:2056
    ds_read_b128 v[84:87], v3 offset:3008
    ds_read_b64 v[52:53], v2 offset:2560
    ds_read_b64 v[54:55], v2 offset:2568
    ds_read_b128 v[88:91], v3 offset:3520
    ds_read_b64 v[56:57], v2 offset:3072
    ds_read_b64 v[58:59], v2 offset:3080
    ds_read_b128 v[92:95], v3 offset:4032
    ds_read_b64 v[60:61], v2 offset:3584
    ds_read_b64 v[62:63], v2 offset:3592
    s_waitcnt lgkmcnt(15)
    v_mfma_f32_16x16x32_bf16 v[160:163], v[192:195], v[64:67], 0
    ds_read_b128 v[128:131], v3 offset:384
    v_mfma_f32_16x16x32_bf16 v[164:167], v[192:195], v[68:71], 0
    ds_read_b64 v[96:97], v2 offset:64
    v_mfma_f32_16x16x32_bf16 v[168:171], v[192:195], v[72:75], 0
    ds_read_b64 v[98:99], v2 offset:72
    s_waitcnt lgkmcnt(15)
    v_mfma_f32_16x16x32_bf16 v[172:175], v[192:195], v[76:79], 0
    ds_read_b128 v[132:135], v3 offset:896
    s_waitcnt lgkmcnt(15)
    v_mfma_f32_16x16x32_bf16 v[176:179], v[192:195], v[80:83], 0
    ds_read_b64 v[100:101], v2 offset:576
    buffer_load_dwordx4 v[200:203], v14, s[44:47], s89 offen offset:0 nt
    s_waitcnt lgkmcnt(13)
    v_mfma_f32_16x16x32_bf16 v[180:183], v[192:195], v[84:87], 0
    ds_read_b64 v[102:103], v2 offset:584
    s_waitcnt lgkmcnt(11)
    v_mfma_f32_16x16x32_bf16 v[184:187], v[192:195], v[88:91], 0
    ds_read_b128 v[136:139], v3 offset:1408
    s_waitcnt lgkmcnt(9)
    v_mfma_f32_16x16x32_bf16 v[188:191], v[192:195], v[92:95], 0
    ds_read_b64 v[104:105], v2 offset:1088
    s_waitcnt lgkmcnt(8)
    s_nop 0
    v_mfma_f32_16x16x32_bf16 v[160:163], v[32:35], v[64:67], v[160:163]
    ds_read_b64 v[106:107], v2 offset:1096
    v_mfma_f32_16x16x32_bf16 v[164:167], v[32:35], v[68:71], v[164:167]
    ds_read_b128 v[140:143], v3 offset:1920
    v_mfma_f32_16x16x32_bf16 v[168:171], v[32:35], v[72:75], v[168:171]
    ds_read_b64 v[108:109], v2 offset:1600
    v_mfma_f32_16x16x32_bf16 v[172:175], v[32:35], v[76:79], v[172:175]
    ds_read_b64 v[110:111], v2 offset:1608
    v_mfma_f32_16x16x32_bf16 v[176:179], v[32:35], v[80:83], v[176:179]
    ds_read_b128 v[144:147], v3 offset:2432
    v_mfma_f32_16x16x32_bf16 v[180:183], v[32:35], v[84:87], v[180:183]
    ds_read_b64 v[112:113], v2 offset:2112
    buffer_load_dwordx4 v[204:207], v14, s[44:47], s89 offen offset:1024 nt
    v_mfma_f32_16x16x32_bf16 v[184:187], v[32:35], v[88:91], v[184:187]
    ds_read_b64 v[114:115], v2 offset:2120
    v_mfma_f32_16x16x32_bf16 v[188:191], v[32:35], v[92:95], v[188:191]
    ds_read_b128 v[148:151], v3 offset:2944
    v_mfma_f32_16x16x32_bf16 v[164:167], v[36:39], v[64:67], v[164:167]
    ds_read_b64 v[116:117], v2 offset:2624
    v_mfma_f32_16x16x32_bf16 v[168:171], v[36:39], v[68:71], v[168:171]
    ds_read_b64 v[118:119], v2 offset:2632
    v_mfma_f32_16x16x32_bf16 v[172:175], v[36:39], v[72:75], v[172:175]
    ds_read_b128 v[152:155], v3 offset:3456
    v_mfma_f32_16x16x32_bf16 v[176:179], v[36:39], v[76:79], v[176:179]
    ds_read_b64 v[120:121], v2 offset:3136
    v_mfma_f32_16x16x32_bf16 v[180:183], v[36:39], v[80:83], v[180:183]
    ds_read_b64 v[122:123], v2 offset:3144
    v_mfma_f32_16x16x32_bf16 v[184:187], v[36:39], v[84:87], v[184:187]
    ds_read_b128 v[156:159], v3 offset:3968
    v_mfma_f32_16x16x32_bf16 v[188:191], v[36:39], v[88:91], v[188:191]
    ds_read_b64 v[124:125], v2 offset:3648
    buffer_load_dwordx2 v[220:221], v14, s[44:47], s89 offen offset:2048 nt
    v_mfma_f32_16x16x32_bf16 v[168:171], v[40:43], v[64:67], v[168:171]
    ds_read_b64 v[126:127], v2 offset:3656
    v_mfma_f32_16x16x32_bf16 v[172:175], v[40:43], v[68:71], v[172:175]
    v_mfma_f32_16x16x32_bf16 v[176:179], v[40:43], v[72:75], v[176:179]
    v_mfma_f32_16x16x32_bf16 v[180:183], v[40:43], v[76:79], v[180:183]
    v_mfma_f32_16x16x32_bf16 v[184:187], v[40:43], v[80:83], v[184:187]
    v_mfma_f32_16x16x32_bf16 v[188:191], v[40:43], v[84:87], v[188:191]
    v_mfma_f32_16x16x32_bf16 v[172:175], v[44:47], v[64:67], v[172:175]
    v_mfma_f32_16x16x32_bf16 v[176:179], v[44:47], v[68:71], v[176:179]
    buffer_load_dwordx4 v[224:227], v14, s[36:39], s88 offen offset:0 sc1
    v_mfma_f32_16x16x32_bf16 v[180:183], v[44:47], v[72:75], v[180:183]
    v_mfma_f32_16x16x32_bf16 v[184:187], v[44:47], v[76:79], v[184:187]
    v_mfma_f32_16x16x32_bf16 v[188:191], v[44:47], v[80:83], v[188:191]
    v_mfma_f32_16x16x32_bf16 v[176:179], v[48:51], v[64:67], v[176:179]
    v_mfma_f32_16x16x32_bf16 v[180:183], v[48:51], v[68:71], v[180:183]
    v_mfma_f32_16x16x32_bf16 v[184:187], v[48:51], v[72:75], v[184:187]
    v_mfma_f32_16x16x32_bf16 v[188:191], v[48:51], v[76:79], v[188:191]
    v_mfma_f32_16x16x32_bf16 v[180:183], v[52:55], v[64:67], v[180:183]
    v_mfma_f32_16x16x32_bf16 v[184:187], v[52:55], v[68:71], v[184:187]
    buffer_load_dwordx4 v[228:231], v14, s[36:39], s88 offen offset:1024 sc1
    v_mfma_f32_16x16x32_bf16 v[188:191], v[52:55], v[72:75], v[188:191]
    v_mfma_f32_16x16x32_bf16 v[184:187], v[56:59], v[64:67], v[184:187]
    v_mfma_f32_16x16x32_bf16 v[188:191], v[56:59], v[68:71], v[188:191]
    v_mfma_f32_16x16x32_bf16 v[188:191], v[60:63], v[64:67], v[188:191]
    s_waitcnt lgkmcnt(0)
    s_nop 0
    v_mfma_f32_16x16x32_bf16 v[160:163], v[96:99], v[128:131], v[160:163]
    ds_read_b128 v[64:67], v3 offset:320
    v_mfma_f32_16x16x32_bf16 v[164:167], v[96:99], v[132:135], v[164:167]
    ds_read_b64 v[32:33], v2 offset:128
    v_mfma_f32_16x16x32_bf16 v[168:171], v[96:99], v[136:139], v[168:171]
    ds_read_b64 v[34:35], v2 offset:136
    v_mfma_f32_16x16x32_bf16 v[172:175], v[96:99], v[140:143], v[172:175]
    ds_read_b128 v[68:71], v3 offset:832
    v_mfma_f32_16x16x32_bf16 v[176:179], v[96:99], v[144:147], v[176:179]
    ds_read_b64 v[36:37], v2 offset:640
    v_mfma_f32_16x16x32_bf16 v[180:183], v[96:99], v[148:151], v[180:183]
    ds_read_b64 v[38:39], v2 offset:648
    v_mfma_f32_16x16x32_bf16 v[184:187], v[96:99], v[152:155], v[184:187]
    ds_read_b128 v[72:75], v3 offset:1344
    v_mfma_f32_16x16x32_bf16 v[188:191], v[96:99], v[156:159], v[188:191]
    ds_read_b64 v[40:41], v2 offset:1152
    v_mfma_f32_16x16x32_bf16 v[164:167], v[100:103], v[128:131], v[164:167]
    ds_read_b64 v[42:43], v2 offset:1160
    v_mfma_f32_16x16x32_bf16 v[168:171], v[100:103], v[132:135], v[168:171]
    ds_read_b128 v[76:79], v3 offset:1856
    v_mfma_f32_16x16x32_bf16 v[172:175], v[100:103], v[136:139], v[172:175]
    ds_read_b64 v[44:45], v2 offset:1664
    v_mfma_f32_16x16x32_bf16 v[176:179], v[100:103], v[140:143], v[176:179]
    ds_read_b64 v[46:47], v2 offset:1672
    v_mfma_f32_16x16x32_bf16 v[180:183], v[100:103], v[144:147], v[180:183]
    ds_read_b128 v[80:83], v3 offset:2368
    v_mfma_f32_16x16x32_bf16 v[184:187], v[100:103], v[148:151], v[184:187]
    ds_read_b64 v[48:49], v2 offset:2176
    v_mfma_f32_16x16x32_bf16 v[188:191], v[100:103], v[152:155], v[188:191]
    ds_read_b64 v[50:51], v2 offset:2184
    v_mfma_f32_16x16x32_bf16 v[168:171], v[104:107], v[128:131], v[168:171]
    ds_read_b128 v[84:87], v3 offset:2880
    v_mfma_f32_16x16x32_bf16 v[172:175], v[104:107], v[132:135], v[172:175]
    ds_read_b64 v[52:53], v2 offset:2688
    v_mfma_f32_16x16x32_bf16 v[176:179], v[104:107], v[136:139], v[176:179]
    ds_read_b64 v[54:55], v2 offset:2696
    v_mfma_f32_16x16x32_bf16 v[180:183], v[104:107], v[140:143], v[180:183]
    ds_read_b128 v[88:91], v3 offset:3392
    v_mfma_f32_16x16x32_bf16 v[184:187], v[104:107], v[144:147], v[184:187]
    ds_read_b64 v[56:57], v2 offset:3200
    v_mfma_f32_16x16x32_bf16 v[188:191], v[104:107], v[148:151], v[188:191]
    ds_read_b64 v[58:59], v2 offset:3208
    v_mfma_f32_16x16x32_bf16 v[172:175], v[108:111], v[128:131], v[172:175]
    ds_read_b128 v[92:95], v3 offset:3904
    v_mfma_f32_16x16x32_bf16 v[176:179], v[108:111], v[132:135], v[176:179]
    ds_read_b64 v[60:61], v2 offset:3712
    v_mfma_f32_16x16x32_bf16 v[180:183], v[108:111], v[136:139], v[180:183]
    ds_read_b64 v[62:63], v2 offset:3720
    v_mfma_f32_16x16x32_bf16 v[184:187], v[108:111], v[140:143], v[184:187]
    v_mfma_f32_16x16x32_bf16 v[188:191], v[108:111], v[144:147], v[188:191]
    v_mfma_f32_16x16x32_bf16 v[176:179], v[112:115], v[128:131], v[176:179]
    v_mfma_f32_16x16x32_bf16 v[180:183], v[112:115], v[132:135], v[180:183]
    v_mfma_f32_16x16x32_bf16 v[184:187], v[112:115], v[136:139], v[184:187]
    v_mfma_f32_16x16x32_bf16 v[188:191], v[112:115], v[140:143], v[188:191]
    v_mfma_f32_16x16x32_bf16 v[180:183], v[116:119], v[128:131], v[180:183]
    v_mfma_f32_16x16x32_bf16 v[184:187], v[116:119], v[132:135], v[184:187]
    v_mfma_f32_16x16x32_bf16 v[188:191], v[116:119], v[136:139], v[188:191]
    v_mfma_f32_16x16x32_bf16 v[184:187], v[120:123], v[128:131], v[184:187]
    v_mfma_f32_16x16x32_bf16 v[188:191], v[120:123], v[132:135], v[188:191]
    v_mfma_f32_16x16x32_bf16 v[188:191], v[124:127], v[128:131], v[188:191]
    s_waitcnt lgkmcnt(0)
    s_nop 0
    v_mfma_f32_16x16x32_bf16 v[160:163], v[32:35], v[64:67], v[160:163]
    ds_read_b128 v[128:131], v3 offset:256
    v_mfma_f32_16x16x32_bf16 v[164:167], v[32:35], v[68:71], v[164:167]
    ds_read_b64 v[96:97], v2 offset:192
    v_mfma_f32_16x16x32_bf16 v[168:171], v[32:35], v[72:75], v[168:171]
    ds_read_b64 v[98:99], v2 offset:200
    v_mfma_f32_16x16x32_bf16 v[172:175], v[32:35], v[76:79], v[172:175]
    ds_read_b128 v[132:135], v3 offset:768
    v_mfma_f32_16x16x32_bf16 v[176:179], v[32:35], v[80:83], v[176:179]
    ds_read_b64 v[100:101], v2 offset:704
    v_mfma_f32_16x16x32_bf16 v[180:183], v[32:35], v[84:87], v[180:183]
    ds_read_b64 v[102:103], v2 offset:712
    v_mfma_f32_16x16x32_bf16 v[184:187], v[32:35], v[88:91], v[184:187]
    ds_read_b128 v[136:139], v3 offset:1280
    v_mfma_f32_16x16x32_bf16 v[188:191], v[32:35], v[92:95], v[188:191]
    ds_read_b64 v[104:105], v2 offset:1216
    v_mfma_f32_16x16x32_bf16 v[164:167], v[36:39], v[64:67], v[164:167]
    ds_read_b64 v[106:107], v2 offset:1224
    v_mfma_f32_16x16x32_bf16 v[168:171], v[36:39], v[68:71], v[168:171]
    ds_read_b128 v[140:143], v3 offset:1792
    v_mfma_f32_16x16x32_bf16 v[172:175], v[36:39], v[72:75], v[172:175]
    ds_read_b64 v[108:109], v2 offset:1728
    v_mfma_f32_16x16x32_bf16 v[176:179], v[36:39], v[76:79], v[176:179]
    ds_read_b64 v[110:111], v2 offset:1736
    v_mfma_f32_16x16x32_bf16 v[180:183], v[36:39], v[80:83], v[180:183]
    ds_read_b128 v[144:147], v3 offset:2304
    v_mfma_f32_16x16x32_bf16 v[184:187], v[36:39], v[84:87], v[184:187]
    ds_read_b64 v[112:113], v2 offset:2240
    v_mfma_f32_16x16x32_bf16 v[188:191], v[36:39], v[88:91], v[188:191]
    ds_read_b64 v[114:115], v2 offset:2248
    v_mfma_f32_16x16x32_bf16 v[168:171], v[40:43], v[64:67], v[168:171]
    ds_read_b128 v[148:151], v3 offset:2816
    v_mfma_f32_16x16x32_bf16 v[172:175], v[40:43], v[68:71], v[172:175]
    ds_read_b64 v[116:117], v2 offset:2752
    v_mfma_f32_16x16x32_bf16 v[176:179], v[40:43], v[72:75], v[176:179]
    ds_read_b64 v[118:119], v2 offset:2760
    v_mfma_f32_16x16x32_bf16 v[180:183], v[40:43], v[76:79], v[180:183]
    ds_read_b128 v[152:155], v3 offset:3328
    v_mfma_f32_16x16x32_bf16 v[184:187], v[40:43], v[80:83], v[184:187]
    ds_read_b64 v[120:121], v2 offset:3264
    v_mfma_f32_16x16x32_bf16 v[188:191], v[40:43], v[84:87], v[188:191]
    ds_read_b64 v[122:123], v2 offset:3272
    v_mfma_f32_16x16x32_bf16 v[172:175], v[44:47], v[64:67], v[172:175]
    ds_read_b128 v[156:159], v3 offset:3840
    v_mfma_f32_16x16x32_bf16 v[176:179], v[44:47], v[68:71], v[176:179]
    ds_read_b64 v[124:125], v2 offset:3776
    v_mfma_f32_16x16x32_bf16 v[180:183], v[44:47], v[72:75], v[180:183]
    ds_read_b64 v[126:127], v2 offset:3784
    v_mfma_f32_16x16x32_bf16 v[184:187], v[44:47], v[76:79], v[184:187]
    v_mfma_f32_16x16x32_bf16 v[188:191], v[44:47], v[80:83], v[188:191]
    v_mfma_f32_16x16x32_bf16 v[176:179], v[48:51], v[64:67], v[176:179]
    v_mfma_f32_16x16x32_bf16 v[180:183], v[48:51], v[68:71], v[180:183]
    v_mfma_f32_16x16x32_bf16 v[184:187], v[48:51], v[72:75], v[184:187]
    v_mfma_f32_16x16x32_bf16 v[188:191], v[48:51], v[76:79], v[188:191]
    v_mfma_f32_16x16x32_bf16 v[180:183], v[52:55], v[64:67], v[180:183]
    v_mfma_f32_16x16x32_bf16 v[184:187], v[52:55], v[68:71], v[184:187]
    v_mfma_f32_16x16x32_bf16 v[188:191], v[52:55], v[72:75], v[188:191]
    v_mfma_f32_16x16x32_bf16 v[184:187], v[56:59], v[64:67], v[184:187]
    v_mfma_f32_16x16x32_bf16 v[188:191], v[56:59], v[68:71], v[188:191]
    v_mfma_f32_16x16x32_bf16 v[188:191], v[60:63], v[64:67], v[188:191]
    s_waitcnt lgkmcnt(0)
    s_nop 0
    v_mfma_f32_16x16x32_bf16 v[160:163], v[96:99], v[128:131], v[160:163]
    ds_read_b128 v[64:67], v3 offset:192
    v_mfma_f32_16x16x32_bf16 v[164:167], v[96:99], v[132:135], v[164:167]
    ds_read_b64 v[32:33], v2 offset:256
    v_mfma_f32_16x16x32_bf16 v[168:171], v[96:99], v[136:139], v[168:171]
    ds_read_b64 v[34:35], v2 offset:264
    v_mfma_f32_16x16x32_bf16 v[172:175], v[96:99], v[140:143], v[172:175]
    ds_read_b128 v[68:71], v3 offset:704
    v_mfma_f32_16x16x32_bf16 v[176:179], v[96:99], v[144:147], v[176:179]
    ds_read_b64 v[36:37], v2 offset:768
    v_mfma_f32_16x16x32_bf16 v[180:183], v[96:99], v[148:151], v[180:183]
    ds_read_b64 v[38:39], v2 offset:776
    v_mfma_f32_16x16x32_bf16 v[184:187], v[96:99], v[152:155], v[184:187]
    ds_read_b128 v[72:75], v3 offset:1216
    v_mfma_f32_16x16x32_bf16 v[188:191], v[96:99], v[156:159], v[188:191]
    ds_read_b64 v[40:41], v2 offset:1280
    v_mfma_f32_16x16x32_bf16 v[164:167], v[100:103], v[128:131], v[164:167]
    ds_read_b64 v[42:43], v2 offset:1288
    v_mfma_f32_16x16x32_bf16 v[168:171], v[100:103], v[132:135], v[168:171]
    ds_read_b128 v[76:79], v3 offset:1728
    v_mfma_f32_16x16x32_bf16 v[172:175], v[100:103], v[136:139], v[172:175]
    ds_read_b64 v[44:45], v2 offset:1792
    v_mfma_f32_16x16x32_bf16 v[176:179], v[100:103], v[140:143], v[176:179]
    ds_read_b64 v[46:47], v2 offset:1800
PAGE8:
    s_cbranch_execz VISIT_RET
    s_nop 0
    v_mfma_f32_16x16x32_bf16 v[180:183], v[100:103], v[144:147], v[180:183]
    ds_read_b128 v[80:83], v3 offset:2240
    v_mfma_f32_16x16x32_bf16 v[184:187], v[100:103], v[148:151], v[184:187]
    ds_read_b64 v[48:49], v2 offset:2304
    v_mfma_f32_16x16x32_bf16 v[188:191], v[100:103], v[152:155], v[188:191]
    ds_read_b64 v[50:51], v2 offset:2312
    v_mfma_f32_16x16x32_bf16 v[168:171], v[104:107], v[128:131], v[168:171]
    ds_read_b128 v[84:87], v3 offset:2752
    v_mfma_f32_16x16x32_bf16 v[172:175], v[104:107], v[132:135], v[172:175]
    ds_read_b64 v[52:53], v2 offset:2816
    v_mfma_f32_16x16x32_bf16 v[176:179], v[104:107], v[136:139], v[176:179]
    ds_read_b64 v[54:55], v2 offset:2824
    v_mfma_f32_16x16x32_bf16 v[180:183], v[104:107], v[140:143], v[180:183]
    ds_read_b128 v[88:91], v3 offset:3264
    v_mfma_f32_16x16x32_bf16 v[184:187], v[104:107], v[144:147], v[184:187]
    ds_read_b64 v[56:57], v2 offset:3328
    v_mfma_f32_16x16x32_bf16 v[188:191], v[104:107], v[148:151], v[188:191]
    ds_read_b64 v[58:59], v2 offset:3336
    v_mfma_f32_16x16x32_bf16 v[172:175], v[108:111], v[128:131], v[172:175]
    ds_read_b128 v[92:95], v3 offset:3776
    v_mfma_f32_16x16x32_bf16 v[176:179], v[108:111], v[132:135], v[176:179]
    ds_read_b64 v[60:61], v2 offset:3840
    v_mfma_f32_16x16x32_bf16 v[180:183], v[108:111], v[136:139], v[180:183]
    ds_read_b64 v[62:63], v2 offset:3848
    v_mfma_f32_16x16x32_bf16 v[184:187], v[108:111], v[140:143], v[184:187]
    v_mfma_f32_16x16x32_bf16 v[188:191], v[108:111], v[144:147], v[188:191]
    v_mfma_f32_16x16x32_bf16 v[176:179], v[112:115], v[128:131], v[176:179]
    v_mfma_f32_16x16x32_bf16 v[180:183], v[112:115], v[132:135], v[180:183]
    v_mfma_f32_16x16x32_bf16 v[184:187], v[112:115], v[136:139], v[184:187]
    v_mfma_f32_16x16x32_bf16 v[188:191], v[112:115], v[140:143], v[188:191]
    v_mfma_f32_16x16x32_bf16 v[180:183], v[116:119], v[128:131], v[180:183]
    v_mfma_f32_16x16x32_bf16 v[184:187], v[116:119], v[132:135], v[184:187]
    v_mfma_f32_16x16x32_bf16 v[188:191], v[116:119], v[136:139], v[188:191]
    v_mfma_f32_16x16x32_bf16 v[184:187], v[120:123], v[128:131], v[184:187]
    v_mfma_f32_16x16x32_bf16 v[188:191], v[120:123], v[132:135], v[188:191]
    v_mfma_f32_16x16x32_bf16 v[188:191], v[124:127], v[128:131], v[188:191]
    s_waitcnt lgkmcnt(0)
    s_nop 0
    v_mfma_f32_16x16x32_bf16 v[160:163], v[32:35], v[64:67], v[160:163]
    ds_read_b128 v[128:131], v3 offset:128
    v_mfma_f32_16x16x32_bf16 v[164:167], v[32:35], v[68:71], v[164:167]
    ds_read_b64 v[96:97], v2 offset:320
    v_mfma_f32_16x16x32_bf16 v[168:171], v[32:35], v[72:75], v[168:171]
    ds_read_b64 v[98:99], v2 offset:328
    v_mfma_f32_16x16x32_bf16 v[172:175], v[32:35], v[76:79], v[172:175]
    ds_read_b128 v[132:135], v3 offset:640
    v_mfma_f32_16x16x32_bf16 v[176:179], v[32:35], v[80:83], v[176:179]
    ds_read_b64 v[100:101], v2 offset:832
    v_mfma_f32_16x16x32_bf16 v[180:183], v[32:35], v[84:87], v[180:183]
    ds_read_b64 v[102:103], v2 offset:840
    v_mfma_f32_16x16x32_bf16 v[184:187], v[32:35], v[88:91], v[184:187]
    ds_read_b128 v[136:139], v3 offset:1152
    v_mfma_f32_16x16x32_bf16 v[188:191], v[32:35], v[92:95], v[188:191]
    ds_read_b64 v[104:105], v2 offset:1344
    v_mfma_f32_16x16x32_bf16 v[164:167], v[36:39], v[64:67], v[164:167]
    ds_read_b64 v[106:107], v2 offset:1352
    v_mfma_f32_16x16x32_bf16 v[168:171], v[36:39], v[68:71], v[168:171]
    ds_read_b128 v[140:143], v3 offset:1664
    v_mfma_f32_16x16x32_bf16 v[172:175], v[36:39], v[72:75], v[172:175]
    ds_read_b64 v[108:109], v2 offset:1856
    v_mfma_f32_16x16x32_bf16 v[176:179], v[36:39], v[76:79], v[176:179]
    ds_read_b64 v[110:111], v2 offset:1864
    v_mfma_f32_16x16x32_bf16 v[180:183], v[36:39], v[80:83], v[180:183]
    ds_read_b128 v[144:147], v3 offset:2176
    v_mfma_f32_16x16x32_bf16 v[184:187], v[36:39], v[84:87], v[184:187]
    ds_read_b64 v[112:113], v2 offset:2368
    v_mfma_f32_16x16x32_bf16 v[188:191], v[36:39], v[88:91], v[188:191]
    ds_read_b64 v[114:115], v2 offset:2376
    v_mfma_f32_16x16x32_bf16 v[168:171], v[40:43], v[64:67], v[168:171]
    ds_read_b128 v[148:151], v3 offset:2688
    v_mfma_f32_16x16x32_bf16 v[172:175], v[40:43], v[68:71], v[172:175]
    ds_read_b64 v[116:117], v2 offset:2880
    v_mfma_f32_16x16x32_bf16 v[176:179], v[40:43], v[72:75], v[176:179]
    ds_read_b64 v[118:119], v2 offset:2888
    v_mfma_f32_16x16x32_bf16 v[180:183], v[40:43], v[76:79], v[180:183]
    ds_read_b128 v[152:155], v3 offset:3200
    buffer_load_dword v24, v27, s[36:39], 0 offen sc1
    v_mfma_f32_16x16x32_bf16 v[184:187], v[40:43], v[80:83], v[184:187]
    ds_read_b64 v[120:121], v2 offset:3392
    v_mfma_f32_16x16x32_bf16 v[188:191], v[40:43], v[84:87], v[188:191]
    ds_read_b64 v[122:123], v2 offset:3400
    v_mfma_f32_16x16x32_bf16 v[172:175], v[44:47], v[64:67], v[172:175]
    ds_read_b128 v[156:159], v3 offset:3712
    v_mfma_f32_16x16x32_bf16 v[176:179], v[44:47], v[68:71], v[176:179]
    ds_read_b64 v[124:125], v2 offset:3904
    v_mfma_f32_16x16x32_bf16 v[180:183], v[44:47], v[72:75], v[180:183]
    ds_read_b64 v[126:127], v2 offset:3912
    v_mfma_f32_16x16x32_bf16 v[184:187], v[44:47], v[76:79], v[184:187]
    v_mfma_f32_16x16x32_bf16 v[188:191], v[44:47], v[80:83], v[188:191]
    v_mfma_f32_16x16x32_bf16 v[176:179], v[48:51], v[64:67], v[176:179]
    v_mfma_f32_16x16x32_bf16 v[180:183], v[48:51], v[68:71], v[180:183]
    v_mfma_f32_16x16x32_bf16 v[184:187], v[48:51], v[72:75], v[184:187]
    v_mfma_f32_16x16x32_bf16 v[188:191], v[48:51], v[76:79], v[188:191]
    v_mfma_f32_16x16x32_bf16 v[180:183], v[52:55], v[64:67], v[180:183]
    v_mfma_f32_16x16x32_bf16 v[184:187], v[52:55], v[68:71], v[184:187]
    v_mfma_f32_16x16x32_bf16 v[188:191], v[52:55], v[72:75], v[188:191]
    v_mfma_f32_16x16x32_bf16 v[184:187], v[56:59], v[64:67], v[184:187]
    v_mfma_f32_16x16x32_bf16 v[188:191], v[56:59], v[68:71], v[188:191]
    v_mfma_f32_16x16x32_bf16 v[188:191], v[60:63], v[64:67], v[188:191]
    s_waitcnt lgkmcnt(0)
    v_mfma_f32_16x16x32_bf16 v[160:163], v[96:99], v[128:131], v[160:163]
    ds_read_b128 v[64:67], v3 offset:64
    v_mfma_f32_16x16x32_bf16 v[164:167], v[96:99], v[132:135], v[164:167]
    ds_read_b64 v[32:33], v2 offset:384
    s_lshl_b32 s79, s53, 6
    s_lshl_b32 s80, s3, 4
    s_add_u32 s79, s79, s80
    v_lshrrev_b32 v236, 2, v0
    v_add_u32 v236, s79, v236
    v_mfma_f32_16x16x32_bf16 v[168:171], v[96:99], v[136:139], v[168:171]
    ds_read_b64 v[34:35], v2 offset:392
    v_mul_u32_u24 v236, 1280, v236
    s_mul_i32 s80, s54, 160
    v_add_u32 v236, s80, v236
    v_mfma_f32_16x16x32_bf16 v[172:175], v[96:99], v[140:143], v[172:175]
    ds_read_b128 v[68:71], v3 offset:576
    v_and_b32 v237, 3, v0
    v_mfma_f32_16x16x32_bf16 v[176:179], v[96:99], v[144:147], v[176:179]
    ds_read_b64 v[36:37], v2 offset:896
    v_lshl_add_u32 v238, v237, 4, v236
    v_mfma_f32_16x16x32_bf16 v[180:183], v[96:99], v[148:151], v[180:183]
    ds_read_b64 v[38:39], v2 offset:904
    v_lshl_add_u32 v239, v237, 3, v236
    v_mfma_f32_16x16x32_bf16 v[184:187], v[96:99], v[152:155], v[184:187]
    ds_read_b128 v[72:75], v3 offset:1088
    buffer_load_dwordx4 v[244:247], v238, s[32:35], 0 offen
    v_mfma_f32_16x16x32_bf16 v[188:191], v[96:99], v[156:159], v[188:191]
    ds_read_b64 v[40:41], v2 offset:1408
    v_mfma_f32_16x16x32_bf16 v[164:167], v[100:103], v[128:131], v[164:167]
    ds_read_b64 v[42:43], v2 offset:1416
    v_mfma_f32_16x16x32_bf16 v[168:171], v[100:103], v[132:135], v[168:171]
    ds_read_b128 v[76:79], v3 offset:1600
    v_mfma_f32_16x16x32_bf16 v[172:175], v[100:103], v[136:139], v[172:175]
    ds_read_b64 v[44:45], v2 offset:1920
    v_mfma_f32_16x16x32_bf16 v[176:179], v[100:103], v[140:143], v[176:179]
    ds_read_b64 v[46:47], v2 offset:1928
    v_mfma_f32_16x16x32_bf16 v[180:183], v[100:103], v[144:147], v[180:183]
    ds_read_b128 v[80:83], v3 offset:2112
    v_mfma_f32_16x16x32_bf16 v[184:187], v[100:103], v[148:151], v[184:187]
    ds_read_b64 v[48:49], v2 offset:2432
    v_mfma_f32_16x16x32_bf16 v[188:191], v[100:103], v[152:155], v[188:191]
    ds_read_b64 v[50:51], v2 offset:2440
    v_mfma_f32_16x16x32_bf16 v[168:171], v[104:107], v[128:131], v[168:171]
    ds_read_b128 v[84:87], v3 offset:2624
    v_mfma_f32_16x16x32_bf16 v[172:175], v[104:107], v[132:135], v[172:175]
    ds_read_b64 v[52:53], v2 offset:2944
    v_mfma_f32_16x16x32_bf16 v[176:179], v[104:107], v[136:139], v[176:179]
    ds_read_b64 v[54:55], v2 offset:2952
    v_mfma_f32_16x16x32_bf16 v[180:183], v[104:107], v[140:143], v[180:183]
    ds_read_b128 v[88:91], v3 offset:3136
    buffer_load_dwordx4 v[248:251], v238, s[32:35], 0 offen offset:64
    v_mfma_f32_16x16x32_bf16 v[184:187], v[104:107], v[144:147], v[184:187]
    ds_read_b64 v[56:57], v2 offset:3456
    v_mfma_f32_16x16x32_bf16 v[188:191], v[104:107], v[148:151], v[188:191]
    ds_read_b64 v[58:59], v2 offset:3464
    v_mfma_f32_16x16x32_bf16 v[172:175], v[108:111], v[128:131], v[172:175]
    ds_read_b128 v[92:95], v3 offset:3648
    v_mfma_f32_16x16x32_bf16 v[176:179], v[108:111], v[132:135], v[176:179]
    ds_read_b64 v[60:61], v2 offset:3968
    v_mfma_f32_16x16x32_bf16 v[180:183], v[108:111], v[136:139], v[180:183]
    ds_read_b64 v[62:63], v2 offset:3976
    v_mfma_f32_16x16x32_bf16 v[184:187], v[108:111], v[140:143], v[184:187]
    v_mfma_f32_16x16x32_bf16 v[188:191], v[108:111], v[144:147], v[188:191]
    v_mfma_f32_16x16x32_bf16 v[176:179], v[112:115], v[128:131], v[176:179]
    v_mfma_f32_16x16x32_bf16 v[180:183], v[112:115], v[132:135], v[180:183]
    v_mfma_f32_16x16x32_bf16 v[184:187], v[112:115], v[136:139], v[184:187]
    v_mfma_f32_16x16x32_bf16 v[188:191], v[112:115], v[140:143], v[188:191]
    v_mfma_f32_16x16x32_bf16 v[180:183], v[116:119], v[128:131], v[180:183]
    buffer_load_dwordx2 v[252:253], v239, s[32:35], 0 offen offset:128
    v_mfma_f32_16x16x32_bf16 v[184:187], v[116:119], v[132:135], v[184:187]
    v_mfma_f32_16x16x32_bf16 v[188:191], v[116:119], v[136:139], v[188:191]
    v_mfma_f32_16x16x32_bf16 v[184:187], v[120:123], v[128:131], v[184:187]
    v_mfma_f32_16x16x32_bf16 v[188:191], v[120:123], v[132:135], v[188:191]
    v_mfma_f32_16x16x32_bf16 v[188:191], v[124:127], v[128:131], v[188:191]
    s_waitcnt lgkmcnt(0)
    s_waitcnt vmcnt(3)
    v_cmp_ne_u32 vcc, s56, v24
    s_mov_b64 s[82:83], vcc
    s_cmp_eq_u64 s[82:83], 0
    s_cbranch_scc0 P2I_RETRY_24
P2I_DONE_25:
    v_mfma_f32_16x16x32_bf16 v[160:163], v[32:35], v[64:67], v[160:163]
    ds_read_b128 v[128:131], v3 offset:0
    v_mfma_f32_16x16x32_bf16 v[164:167], v[32:35], v[68:71], v[164:167]
    ds_read_b64 v[96:97], v2 offset:448
    v_mfma_f32_16x16x32_bf16 v[168:171], v[32:35], v[72:75], v[168:171]
    ds_read_b64 v[98:99], v2 offset:456
    buffer_load_dwordx4 a[0:3], v14, s[36:39], s52 offen offset:0 sc1
    v_mfma_f32_16x16x32_bf16 v[172:175], v[32:35], v[76:79], v[172:175]
    ds_read_b128 v[132:135], v3 offset:512
    v_mfma_f32_16x16x32_bf16 v[176:179], v[32:35], v[80:83], v[176:179]
    ds_read_b64 v[100:101], v2 offset:960
    v_mfma_f32_16x16x32_bf16 v[180:183], v[32:35], v[84:87], v[180:183]
    ds_read_b64 v[102:103], v2 offset:968
    v_mfma_f32_16x16x32_bf16 v[184:187], v[32:35], v[88:91], v[184:187]
    ds_read_b128 v[136:139], v3 offset:1024
    buffer_load_dwordx4 a[4:7], v14, s[36:39], s52 offen offset:1024 sc1
    v_mfma_f32_16x16x32_bf16 v[188:191], v[32:35], v[92:95], v[188:191]
    ds_read_b64 v[104:105], v2 offset:1472
    v_mfma_f32_16x16x32_bf16 v[164:167], v[36:39], v[64:67], v[164:167]
    ds_read_b64 v[106:107], v2 offset:1480
    v_mfma_f32_16x16x32_bf16 v[168:171], v[36:39], v[68:71], v[168:171]
    ds_read_b128 v[140:143], v3 offset:1536
    v_mfma_f32_16x16x32_bf16 v[172:175], v[36:39], v[72:75], v[172:175]
    ds_read_b64 v[108:109], v2 offset:1984
    v_mfma_f32_16x16x32_bf16 v[176:179], v[36:39], v[76:79], v[176:179]
    ds_read_b64 v[110:111], v2 offset:1992
    buffer_load_dwordx4 a[8:11], v14, s[36:39], s52 offen offset:2048 sc1
    v_mfma_f32_16x16x32_bf16 v[180:183], v[36:39], v[80:83], v[180:183]
    ds_read_b128 v[144:147], v3 offset:2048
    v_mfma_f32_16x16x32_bf16 v[184:187], v[36:39], v[84:87], v[184:187]
    ds_read_b64 v[112:113], v2 offset:2496
    v_mfma_f32_16x16x32_bf16 v[188:191], v[36:39], v[88:91], v[188:191]
    ds_read_b64 v[114:115], v2 offset:2504
    v_mfma_f32_16x16x32_bf16 v[168:171], v[40:43], v[64:67], v[168:171]
    ds_read_b128 v[148:151], v3 offset:2560
    buffer_load_dwordx4 a[12:15], v14, s[36:39], s52 offen offset:3072 sc1
    v_mfma_f32_16x16x32_bf16 v[172:175], v[40:43], v[68:71], v[172:175]
    ds_read_b64 v[116:117], v2 offset:3008
    v_mfma_f32_16x16x32_bf16 v[176:179], v[40:43], v[72:75], v[176:179]
    ds_read_b64 v[118:119], v2 offset:3016
    v_mfma_f32_16x16x32_bf16 v[180:183], v[40:43], v[76:79], v[180:183]
    ds_read_b128 v[152:155], v3 offset:3072
    v_mfma_f32_16x16x32_bf16 v[184:187], v[40:43], v[80:83], v[184:187]
    ds_read_b64 v[120:121], v2 offset:3520
    v_mfma_f32_16x16x32_bf16 v[188:191], v[40:43], v[84:87], v[188:191]
    ds_read_b64 v[122:123], v2 offset:3528
    buffer_load_dwordx4 a[16:19], v15, s[36:39], s52 offen offset:0 sc1
    s_add_u32 s52, s52, 5120
    v_mfma_f32_16x16x32_bf16 v[172:175], v[44:47], v[64:67], v[172:175]
    ds_read_b128 v[156:159], v3 offset:3584
    v_mfma_f32_16x16x32_bf16 v[176:179], v[44:47], v[68:71], v[176:179]
    ds_read_b64 v[124:125], v2 offset:4032
    v_mfma_f32_16x16x32_bf16 v[180:183], v[44:47], v[72:75], v[180:183]
    ds_read_b64 v[126:127], v2 offset:4040
    v_mfma_f32_16x16x32_bf16 v[184:187], v[44:47], v[76:79], v[184:187]
    buffer_load_dwordx4 a[20:23], v14, s[36:39], s52 offen offset:0 sc1
    v_mfma_f32_16x16x32_bf16 v[188:191], v[44:47], v[80:83], v[188:191]
    v_mfma_f32_16x16x32_bf16 v[176:179], v[48:51], v[64:67], v[176:179]
    v_mfma_f32_16x16x32_bf16 v[180:183], v[48:51], v[68:71], v[180:183]
    v_mfma_f32_16x16x32_bf16 v[184:187], v[48:51], v[72:75], v[184:187]
    v_mfma_f32_16x16x32_bf16 v[188:191], v[48:51], v[76:79], v[188:191]
    buffer_load_dwordx4 a[24:27], v14, s[36:39], s52 offen offset:1024 sc1
    v_mfma_f32_16x16x32_bf16 v[180:183], v[52:55], v[64:67], v[180:183]
    v_mfma_f32_16x16x32_bf16 v[184:187], v[52:55], v[68:71], v[184:187]
    v_mfma_f32_16x16x32_bf16 v[188:191], v[52:55], v[72:75], v[188:191]
    v_mfma_f32_16x16x32_bf16 v[184:187], v[56:59], v[64:67], v[184:187]
    buffer_load_dwordx4 a[28:31], v14, s[36:39], s52 offen offset:2048 sc1
    v_mfma_f32_16x16x32_bf16 v[188:191], v[56:59], v[68:71], v[188:191]
    v_mfma_f32_16x16x32_bf16 v[188:191], v[60:63], v[64:67], v[188:191]
    s_waitcnt lgkmcnt(0)
    s_nop 0
    v_mfma_f32_16x16x32_bf16 v[160:163], v[96:99], v[128:131], v[160:163]
    v_mfma_f32_16x16x32_bf16 v[164:167], v[96:99], v[132:135], v[164:167]
    v_mfma_f32_16x16x32_bf16 v[168:171], v[96:99], v[136:139], v[168:171]
    buffer_load_dwordx4 a[32:35], v14, s[36:39], s52 offen offset:3072 sc1
    v_mfma_f32_16x16x32_bf16 v[172:175], v[96:99], v[140:143], v[172:175]
    v_mfma_f32_16x16x32_bf16 v[176:179], v[96:99], v[144:147], v[176:179]
    v_mfma_f32_16x16x32_bf16 v[180:183], v[96:99], v[148:151], v[180:183]
    v_mfma_f32_16x16x32_bf16 v[184:187], v[96:99], v[152:155], v[184:187]
    buffer_load_dwordx4 a[36:39], v15, s[36:39], s52 offen offset:0 sc1
    s_add_u32 s52, s52, 5120
    v_mfma_f32_16x16x32_bf16 v[188:191], v[96:99], v[156:159], v[188:191]
    v_mfma_f32_16x16x32_bf16 v[164:167], v[100:103], v[128:131], v[164:167]
    v_mfma_f32_16x16x32_bf16 v[168:171], v[100:103], v[132:135], v[168:171]
    v_mfma_f32_16x16x32_bf16 v[172:175], v[100:103], v[136:139], v[172:175]
    v_mfma_f32_16x16x32_bf16 v[176:179], v[100:103], v[140:143], v[176:179]
    buffer_load_dwordx4 a[40:43], v14, s[36:39], s52 offen offset:0 sc1
    v_mfma_f32_16x16x32_bf16 v[180:183], v[100:103], v[144:147], v[180:183]
    v_mfma_f32_16x16x32_bf16 v[184:187], v[100:103], v[148:151], v[184:187]
    v_mfma_f32_16x16x32_bf16 v[188:191], v[100:103], v[152:155], v[188:191]
    v_mfma_f32_16x16x32_bf16 v[168:171], v[104:107], v[128:131], v[168:171]
    buffer_load_dwordx4 a[44:47], v14, s[36:39], s52 offen offset:1024 sc1
    v_mfma_f32_16x16x32_bf16 v[172:175], v[104:107], v[132:135], v[172:175]
    v_mfma_f32_16x16x32_bf16 v[176:179], v[104:107], v[136:139], v[176:179]
    v_mfma_f32_16x16x32_bf16 v[180:183], v[104:107], v[140:143], v[180:183]
    v_mfma_f32_16x16x32_bf16 v[184:187], v[104:107], v[144:147], v[184:187]
    v_mfma_f32_16x16x32_bf16 v[188:191], v[104:107], v[148:151], v[188:191]
    buffer_load_dwordx4 a[48:51], v14, s[36:39], s52 offen offset:2048 sc1
    v_mfma_f32_16x16x32_bf16 v[172:175], v[108:111], v[128:131], v[172:175]
    v_mfma_f32_16x16x32_bf16 v[176:179], v[108:111], v[132:135], v[176:179]
    v_mfma_f32_16x16x32_bf16 v[180:183], v[108:111], v[136:139], v[180:183]
    v_mfma_f32_16x16x32_bf16 v[184:187], v[108:111], v[140:143], v[184:187]
    buffer_load_dwordx4 a[52:55], v14, s[36:39], s52 offen offset:3072 sc1
    v_mfma_f32_16x16x32_bf16 v[188:191], v[108:111], v[144:147], v[188:191]
    v_mfma_f32_16x16x32_bf16 v[176:179], v[112:115], v[128:131], v[176:179]
    v_mfma_f32_16x16x32_bf16 v[180:183], v[112:115], v[132:135], v[180:183]
    v_mfma_f32_16x16x32_bf16 v[184:187], v[112:115], v[136:139], v[184:187]
    v_mfma_f32_16x16x32_bf16 v[188:191], v[112:115], v[140:143], v[188:191]
    buffer_load_dwordx4 a[56:59], v15, s[36:39], s52 offen offset:0 sc1
    s_add_u32 s52, s52, 5120
    v_mfma_f32_16x16x32_bf16 v[180:183], v[116:119], v[128:131], v[180:183]
    v_mfma_f32_16x16x32_bf16 v[184:187], v[116:119], v[132:135], v[184:187]
    v_mfma_f32_16x16x32_bf16 v[188:191], v[116:119], v[136:139], v[188:191]
    v_mfma_f32_16x16x32_bf16 v[184:187], v[120:123], v[128:131], v[184:187]
    buffer_load_dwordx4 a[60:63], v14, s[36:39], s52 offen offset:0 sc1
    v_mfma_f32_16x16x32_bf16 v[188:191], v[120:123], v[132:135], v[188:191]
    v_mfma_f32_16x16x32_bf16 v[188:191], v[124:127], v[128:131], v[188:191]
    s_nop 7
    v_bfe_u32 v8, v0, 4, 1
    v_lshlrev_b32 v8, 9, v8
    v_and_b32 v9, 15, v0
    v_lshl_add_u32 v8, v9, 5, v8
    v_lshrrev_b32 v9, 5, v0
    v_lshl_add_u32 v8, v9, 4, v8
    v_cvt_pk_bf16_f32 v32, v160, v161
    v_cvt_pk_bf16_f32 v33, v162, v163
    v_cvt_pk_bf16_f32 v34, v164, v165
    v_cvt_pk_bf16_f32 v35, v166, v167
    v_cvt_pk_bf16_f32 v36, v168, v169
    v_cvt_pk_bf16_f32 v37, v170, v171
    v_cvt_pk_bf16_f32 v38, v172, v173
    v_cvt_pk_bf16_f32 v39, v174, v175
    v_cvt_pk_bf16_f32 v40, v176, v177
    v_cvt_pk_bf16_f32 v41, v178, v179
    v_cvt_pk_bf16_f32 v42, v180, v181
    v_cvt_pk_bf16_f32 v43, v182, v183
    v_cvt_pk_bf16_f32 v44, v184, v185
    v_cvt_pk_bf16_f32 v45, v186, v187
    v_cvt_pk_bf16_f32 v46, v188, v189
    v_cvt_pk_bf16_f32 v47, v190, v191
    s_nop 1
    v_permlane16_swap_b32 v32, v34
    v_permlane16_swap_b32 v33, v35
    v_permlane16_swap_b32 v36, v38
    v_permlane16_swap_b32 v37, v39
    v_permlane16_swap_b32 v40, v42
    v_permlane16_swap_b32 v41, v43
    v_permlane16_swap_b32 v44, v46
    v_permlane16_swap_b32 v45, v47
    buffer_store_dwordx4 v[32:35], v8, s[36:39], s18 offen offset:0 sc1
    buffer_store_dwordx4 v[36:39], v8, s[36:39], s18 offen offset:1024 sc1
    buffer_store_dwordx4 v[40:43], v8, s[36:39], s18 offen offset:2048 sc1
    buffer_store_dwordx4 v[44:47], v8, s[36:39], s18 offen offset:3072 sc1
    s_waitcnt vmcnt(24)
    v_mov_b32 v96, v200
    v_mov_b32 v97, v201
    v_mov_b32 v98, v202
    v_mov_b32 v99, v203
    v_mov_b32 v100, v204
    v_mov_b32 v101, v205
    v_mov_b32 v102, v206
    v_mov_b32 v103, v207
    v_mov_b32 v104, v208
    v_mov_b32 v105, v209
    v_mov_b32 v106, v210
    v_mov_b32 v107, v211
    v_mov_b32 v108, v212
    v_mov_b32 v109, v213
    v_mov_b32 v110, v214
    v_mov_b32 v111, v215
    v_mov_b32 v112, v216
    v_mov_b32 v113, v217
    v_mov_b32 v114, v218
    v_mov_b32 v115, v219
    v_mov_b32 v116, v220
    v_mov_b32 v117, v221
    v_mov_b32 v118, v222
    v_mov_b32 v119, v223
    v_mov_b32 v120, v224
    v_mov_b32 v121, v225
    v_mov_b32 v122, v226
    v_mov_b32 v123, v227
    v_mov_b32 v124, v228
    v_mov_b32 v125, v229
    v_mov_b32 v126, v230
    v_mov_b32 v127, v231
    s_mov_b32 s29, 17563648
    s_barrier
    s_branch C4JOIN
DONE:
EXIT:
    s_endpgm
P1_RETRY_2:
    s_mov_b32 s81, 0x40000
P1_LOOP_4:
    buffer_load_dword v29, v28, s[36:39], 0 offen sc1
    s_waitcnt vmcnt(0)
    v_cmp_ne_u32 vcc, s56, v29
    s_mov_b64 s[82:83], vcc
    s_cmp_eq_u64 s[82:83], 0
    s_cbranch_scc1 P1_DONE_3
    s_sub_u32 s81, s81, 1
    s_cmp_lg_u32 s81, 0
    s_cbranch_scc1 P1_LOOP_4
    s_branch P1_DONE_3
P2_RETRY_6:
    s_mov_b32 s81, 0x40000
P2_LOOP_8:
    buffer_load_dword v24, v27, s[36:39], 0 offen sc1
    s_waitcnt vmcnt(0)
    v_cmp_ne_u32 vcc, s56, v24
    s_mov_b64 s[82:83], vcc
    s_cmp_eq_u64 s[82:83], 0
    s_cbranch_scc1 P2_DONE_7
    s_sub_u32 s81, s81, 1
    s_cmp_lg_u32 s81, 0
    s_cbranch_scc1 P2_LOOP_8
    s_branch P2_DONE_7
FH_RETRY_11:
    s_mov_b32 s81, 0x40000
FH_LOOP_13:
    buffer_load_dword v19, v18, s[36:39], s49 offen sc1
    s_waitcnt vmcnt(0)
    v_cmp_ne_u32 vcc, s56, v19
    s_mov_b64 s[82:83], vcc
    s_cmp_eq_u64 s[82:83], 0
    s_cbranch_scc1 FH_DONE_12
    s_sub_u32 s81, s81, 1
    s_cmp_lg_u32 s81, 0
    s_cbranch_scc1 FH_LOOP_13
    s_branch FH_DONE_12
FY_RETRY_14:
    s_mov_b32 s81, 0x40000
FY_LOOP_16:
    buffer_load_dword v20, v18, s[36:39], s59 offen sc1
    s_waitcnt vmcnt(0)
    v_cmp_ne_u32 vcc, s56, v20
    s_mov_b64 s[82:83], vcc
    s_cmp_eq_u64 s[82:83], 0
    s_cbranch_scc1 FY_DONE_15
    s_sub_u32 s81, s81, 1
    s_cmp_lg_u32 s81, 0
    s_cbranch_scc1 FY_LOOP_16
    s_branch FY_DONE_15
EP_RETRY_17:
    s_mov_b32 s81, 0x40000
EP_LOOP_19:
    buffer_load_dword v24, v16, s[36:39], s76 offen sc1
    s_waitcnt vmcnt(0)
    v_cmp_ne_u32 vcc, s56, v24
    s_mov_b64 s[82:83], vcc
    s_cmp_eq_u64 s[82:83], 0
    s_cbranch_scc1 EP_DONE_18
    s_sub_u32 s81, s81, 1
    s_cmp_lg_u32 s81, 0
    s_cbranch_scc1 EP_LOOP_19
    s_branch EP_DONE_18
EP_CHECK:
    s_waitcnt vmcnt(0)
    v_cmp_ne_u32 vcc, s56, v24
    s_mov_b64 s[82:83], vcc
    s_cmp_eq_u64 s[82:83], 0
    s_cbranch_scc0 EP_RETRY_17
EP_DONE_18:
    s_branch EP_BACK
EP_STORE:
    s_sub_u32 s73, s56, 2654435768
    v_mov_b32 v16, s73
    v_mov_b32 v17, 0
    s_mov_b32 exec_lo, 1
    s_mov_b32 exec_hi, 0
    buffer_store_dword v16, v17, s[36:39], 0 offen sc1
    s_mov_b64 exec, -1
    s_branch EP_STORED
FAI_RETRY_21:
    s_mov_b32 s81, 0x40000
FAI_LOOP_23:
    buffer_load_dword v25, v28, s[36:39], 0 offen sc1
    s_waitcnt vmcnt(0)
    v_cmp_ne_u32 vcc, s56, v25
    s_mov_b64 s[82:83], vcc
    s_cmp_eq_u64 s[82:83], 0
    s_cbranch_scc1 FAI_DONE_22
    s_sub_u32 s81, s81, 1
    s_cmp_lg_u32 s81, 0
    s_cbranch_scc1 FAI_LOOP_23
    s_branch FAI_DONE_22
P2I_RETRY_24:
    s_mov_b32 s81, 0x40000
P2I_LOOP_26:
    buffer_load_dword v24, v27, s[36:39], 0 offen sc1
    s_waitcnt vmcnt(0)
    v_cmp_ne_u32 vcc, s56, v24
    s_mov_b64 s[82:83], vcc
    s_cmp_eq_u64 s[82:83], 0
    s_cbranch_scc1 P2I_DONE_25
    s_sub_u32 s81, s81, 1
    s_cmp_lg_u32 s81, 0
    s_cbranch_scc1 P2I_LOOP_26
    s_branch P2I_DONE_25
CODE_END:
.section .rodata,"a"
.p2align 6
.amdhsa_kernel recurrent_scan__ssm_conv_h3__dense_activation_gelu__prompt_kernel
  .amdhsa_next_free_vgpr 512
  .amdhsa_next_free_sgpr 102
  .amdhsa_accum_offset 256
  .amdhsa_group_segment_fixed_size 0
  .amdhsa_kernarg_size 112
  .amdhsa_user_sgpr_count 2
  .amdhsa_user_sgpr_kernarg_segment_ptr 1
  .amdhsa_system_sgpr_workgroup_id_x 1
.end_amdhsa_kernel
```

```asm
; @launch grid=(256,1,1) block=(256,1,1) lds=156160
.amdgcn_target "amdgcn-amd-amdhsa--gfx950"
.text
.globl recurrent_scan__ssm_conv_h3__dense_activation_gelu__prompt_kernel
.p2align 12
.type recurrent_scan__ssm_conv_h3__dense_activation_gelu__prompt_kernel,@function
recurrent_scan__ssm_conv_h3__dense_activation_gelu__prompt_kernel:
    s_cmp_ge_u32 s2, 256
    s_cbranch_scc1 EXIT
    s_load_dwordx16 s[4:19], s[0:1], 0
    s_load_dwordx8 s[20:27], s[0:1], 64
    s_load_dwordx4 s[28:31], s[0:1], 96
    v_lshrrev_b32 v1, 6, v0
    s_and_b32 s57, s2, 7
    s_lshr_b32 s58, s2, 3
    s_getpc_b64 s[44:45]
PF_BASE:
    s_mov_b32 s46, CODE_END-PF_BASE
    s_mov_b32 s47, 0x20000
    s_mul_i32 s78, s58, 9
    v_add_u32 v2, s78, v0
    v_lshlrev_b32 v2, 7, v2
    v_cmp_gt_u32 vcc, 9, v0
    v_cndmask_b32 v2, -1, v2, vcc
    buffer_load_dword v47, v2, s[44:47], 0 offen
    v_and_b32 v0, 63, v0
    v_readfirstlane_b32 s3, v1
    s_cmp_ge_u32 s58, 28
    s_cbranch_scc1 IDLE
    s_lshr_b32 s75, s58, 2
    s_and_b32 s76, s58, 3
    s_lshl_b32 s76, s76, 3
    s_add_u32 s76, s76, s57
    v_lshrrev_b32 v15, 4, v0
    s_lshl_b32 s78, s3, 2
    v_add_u32 v15, s78, v15
    v_and_b32 v18, 15, v0
    v_mul_u32_u24 v14, 5120, v15
    v_lshl_add_u32 v14, v18, 3, v14
    s_mul_i32 s78, s76, 81920
    v_add_u32_e64 v14, s78, v14
    v_add_u32 v15, 0xfffff100, v14
    v_add_u32 v16, 0xfffff600, v14
    v_add_u32 v17, 0xfffffb00, v14
    v_lshlrev_b32 v18, 5, v18
    s_lshl_b32 s79, s75, 7
    v_add_u32 v248, s79, v14
    v_add_u32 v249, s79, v15
    v_add_u32 v250, s79, v16
    v_add_u32 v251, s79, v17
    v_lshl_add_u32 v252, s75, 9, v18
    s_lshl_b32 s79, s75, 18
    s_lshl_b32 s80, s76, 7
    s_add_u32 s59, s79, s80
    s_add_u32 s59, s59, 1048576
    s_lshl_b32 s84, s75, 5
    s_add_u32 s84, s84, s76
    s_lshl_b32 s84, s84, 6
    s_add_u32 s84, s84, 131072
    s_waitcnt lgkmcnt(0)
    s_load_dword s56, s[30:31], 0
    s_mov_b32 s32, s4
    s_mov_b32 s33, s5
    s_mov_b32 s34, 2621440
    s_mov_b32 s35, 0x20000
    s_mov_b32 s44, s6
    s_mov_b32 s45, s7
    s_mov_b32 s46, 2621440
    s_mov_b32 s47, 0x20000
    s_mov_b32 s48, s8
    s_mov_b32 s49, s9
    s_mov_b32 s50, 2621440
    s_mov_b32 s51, 0x20000
    s_mov_b32 s52, s10
    s_mov_b32 s53, s11
    s_mov_b32 s54, 5120
    s_mov_b32 s55, 0x20000
    buffer_load_dwordx2 v[96:97], v249, s[44:47], 0 offen nt
    s_lshr_b32 s73, s57, 1
    s_lshl_b32 s73, s73, 2
    s_and_b32 s74, s58, 3
    s_add_u32 s63, s73, s74
    buffer_load_dwordx2 v[98:99], v250, s[44:47], 0 offen nt
    s_and_b32 s73, s57, 1
    s_mul_i32 s73, s73, 7
    s_lshr_b32 s74, s58, 2
    s_add_u32 s64, s73, s74
    buffer_load_dwordx2 v[100:101], v251, s[44:47], 0 offen nt
    s_and_b32 s65, s3, 1
    s_lshr_b32 s66, s3, 1
    s_mul_i32 s73, s63, 163840
    s_mul_i32 s74, s3, 40960
    s_add_u32 s60, s73, s74
    buffer_load_dwordx2 v[102:103], v248, s[44:47], 0 offen offset:0 nt
    s_lshl_b32 s73, s64, 8
    s_mul_i32 s74, s3, 55296
    s_add_u32 s61, s73, s74
    s_lshl_b32 s62, s3, 12
    buffer_load_dwordx2 v[104:105], v248, s[44:47], 0 offen offset:1280 nt
    s_mov_b32 s85, -1152
    s_mov_b32 s86, -1990656
    s_lshr_b32 s73, s58, 2
    s_mul_i32 s73, s73, 10
    s_add_u32 s73, s73, 3
    buffer_load_dwordx2 v[106:107], v248, s[44:47], 0 offen offset:2560 nt
    s_mul_i32 s73, s73, 9363
    s_lshr_b32 s73, s73, 16
    s_and_b32 s74, s58, 3
    s_mul_i32 s74, s74, 5
    buffer_load_dwordx2 v[108:109], v248, s[44:47], 0 offen offset:3840 nt
    s_lshr_b32 s74, s74, 1
    s_add_u32 s73, s73, s74
    s_cmp_ge_u32 s73, 10
    s_cselect_b32 s74, 10, 0
    s_sub_u32 s73, s73, s74
    s_sub_u32 s74, 9, s73
    buffer_load_dwordx4 v[118:121], v252, s[52:55], 0 offen
    s_lshl_b32 s0, 1, s74
    s_lshl_b32 s74, s73, 7
    s_add_u32 s60, s60, s74
    s_mul_i32 s74, s73, 221184
    buffer_load_dwordx4 v[122:125], v252, s[52:55], 0 offen offset:16
    s_add_u32 s61, s61, s74
    v_lshrrev_b32 v1, 3, v0
    v_and_b32 v2, 7, v0
    v_xor_b32 v2, v2, v1
    v_lshlrev_b32_e64 v2, 4, v2
    buffer_load_dwordx2 v[110:111], v248, s[48:51], 0 offen offset:0 nt
    v_mul_u32_u24 v240, 1280, v1
    v_add_u32_e64 v240, v240, v2
    v_add_u32 v241, 9216, v240
    v_add_u32 v242, 18432, v240
    buffer_load_dwordx2 v[112:113], v248, s[48:51], 0 offen offset:1280 nt
    v_add_u32 v243, 27648, v240
    v_lshrrev_b32 v1, 4, v0
    v_and_b32 v2, 15, v0
    v_lshlrev_b32 v3, 1, v1
    v_xor_b32 v2, v2, v3
    buffer_load_dwordx2 v[114:115], v248, s[48:51], 0 offen offset:2560 nt
    v_lshlrev_b32 v2, 4, v2
    v_mul_u32_u24 v3, 3456, v1
    v_add_u32 v244, v3, v2
    v_add_u32 v245, 12800, v244
    buffer_load_dwordx2 v[116:117], v248, s[48:51], 0 offen offset:3840 nt
    v_xor_b32 v2, 128, v2
    v_add_u32_e64 v3, v3, v2
    v_add_u32 v246, 25600, v3
    v_add_u32 v247, 38400, v3
    s_movk_i32 s73, 1280
    s_mov_b32 s42, 0
    s_mov_b64 exec, 0
    s_cmp_eq_u32 s3, 0
    s_cbranch_scc1 PAGE1
    s_cmp_eq_u32 s3, 1
    s_cbranch_scc1 PAGE3
    s_cmp_eq_u32 s3, 2
    s_cbranch_scc1 PAGE5
    s_branch PAGE7
VISIT_RET:
    s_cmp_eq_u32 s42, 1
    s_cbranch_scc1 VISIT_RET_I
    s_mov_b64 exec, -1
    s_lshl_b32 s78, s57, 8
    s_lshl_b32 s79, s58, 3
    s_add_u32 s78, s78, s79
    s_lshl_b32 s79, s3, 1
    s_add_u32 s78, s78, s79
    v_lshrrev_b32 v226, 5, v0
    v_add_u32 v226, s78, v226
    v_and_b32 v227, 31, v0
    v_lshlrev_b32 v227, 3, v227
    v_mad_u32_u24 v227, v226, s73, v227
    v_lshlrev_b32_e64 v226, 3, v226
    buffer_load_dwordx2 v[216:217], v227, s[32:35], 0 offen offset:0
    buffer_load_dwordx2 v[218:219], v227, s[32:35], 0 offen offset:256
    buffer_load_dwordx2 v[220:221], v227, s[32:35], 0 offen offset:512
    buffer_load_dwordx2 v[222:223], v227, s[32:35], 0 offen offset:768
    buffer_load_dwordx2 v[224:225], v227, s[32:35], 0 offen offset:1024
    s_mov_b32 s44, s22
    s_mov_b32 s45, s23
    s_mov_b32 s46, 2211840
    s_mov_b32 s47, 0x20000
    s_mov_b32 s40, s18
    s_mov_b32 s41, s19
    s_mov_b32 s42, 2211840
    s_mov_b32 s43, 0x20000
    s_add_u32 m0, s62, 0
    s_nop 0
    buffer_load_dwordx4 v240, s[32:35], s60 offen offset:0 lds
    s_lshl_b32 s68, s64, 3
    s_lshl_b32 s73, s65, 2
    s_add_u32 s68, s68, s73
    s_lshl_b32 s73, s66, 1
    s_add_u32 s74, s73, 0
    s_and_b32 s74, s74, 3
    s_add_u32 s69, s74, s68
    s_add_u32 s74, s73, 1
    s_and_b32 s74, s74, 3
    s_add_u32 s70, s74, s68
    s_add_u32 s74, s73, 2
    s_and_b32 s74, s74, 3
    s_add_u32 s71, s74, s68
    s_add_u32 s74, s73, 3
    s_and_b32 s74, s74, 3
    s_add_u32 s72, s74, s68
    s_mov_b32 s36, s30
    s_mov_b32 s37, s31
    s_mov_b32 s38, 17563648
    s_mov_b32 s39, 0x20000
    v_and_b32 v203, 15, v0
    v_lshrrev_b32 v204, 5, v0
    s_lshl_b32 s78, s3, 1
    v_add_u32 v204, s78, v204
    v_xor_b32 v204, v204, v203
    v_and_b32 v204, 7, v204
    v_lshlrev_b32_e64 v204, 4, v204
    v_lshl_add_u32 v203, v203, 9, v204
    buffer_load_dwordx4 v241, s[32:35], s60 offen offset:1024 lds
    v_bfe_u32 v204, v0, 4, 1
    v_xor_b32_e64 v204, 1, v204
    v_lshl_add_u32 v203, v204, 3, v203
    v_add_u32 v203, 131584, v203
    s_lshl_b32 s78, s3, 6
    v_add_u32 v205, s78, v0
    v_lshrrev_b32 v206, 3, v205
    v_lshrrev_b32 v204, 5, v205
    v_xor_b32 v204, v204, v205
    v_and_b32 v204, 7, v204
    v_lshlrev_b32_e64 v204, 4, v204
    v_lshl_add_u32 v204, v206, 7, v204
    v_add_u32 v204, 131584, v204
    v_and_b32 v205, 7, v205
    v_lshlrev_b32 v205, 4, v205
    v_lshl_add_u32 v205, v206, 12, v205
    v_add_u32 v206, 0x20000, v205
    s_and_b32 s76, s58, 7
    s_lshl_b32 s77, s57, 2
    s_lshr_b32 s78, s58, 3
    s_add_u32 s77, s77, s78
    s_mul_i32 s78, s77, 40960
    s_mul_i32 s79, s76, 160
    s_add_u32 s78, s78, s79
    s_add_u32 s79, s78, 1310720
    s_cmp_lt_u32 s77, 22
    s_cselect_b32 s79, s79, 2211840
    s_lshl_b32 s80, s3, 6
    v_add_u32 v24, s80, v0
    buffer_load_dwordx4 v242, s[32:35], s60 offen offset:2048 lds
    v_cmp_gt_u32 vcc, 320, v24
    v_subrev_u32 v25, 320, v24
    v_mov_b32 v26, s79
    v_mov_b32 v27, s78
    v_cndmask_b32 v25, v25, v24, vcc
    v_cndmask_b32 v26, v26, v27, vcc
    v_mul_u32_u24 v27, 6554, v25
    v_lshrrev_b32 v27, 16, v27
    v_mul_u32_u24 v28, 10, v27
    v_sub_u32_e64 v28, v25, v28
    v_mul_u32_u24 v27, 1280, v27
    v_lshl_add_u32 v27, v28, 4, v27
    v_add_u32 v253, v27, v26
    v_add_u32 v24, s80, v0
    v_add_u32 v24, 256, v24
    v_cmp_gt_u32 vcc, 320, v24
    v_subrev_u32 v25, 320, v24
    v_mov_b32 v26, s79
    v_mov_b32 v27, s78
    v_cndmask_b32 v25, v25, v24, vcc
    v_cndmask_b32 v26, v26, v27, vcc
    v_mul_u32_u24 v27, 6554, v25
    v_lshrrev_b32 v27, 16, v27
    v_mul_u32_u24 v28, 10, v27
    v_sub_u32_e64 v28, v25, v28
    v_mul_u32_u24 v27, 1280, v27
    v_lshl_add_u32 v27, v28, 4, v27
    v_add_u32 v254, v27, v26
    v_add_u32 v24, s80, v0
    buffer_load_dwordx4 v243, s[32:35], s60 offen offset:3072 lds
    v_add_u32 v24, 512, v24
    v_cmp_gt_u32 vcc, 320, v24
    v_subrev_u32 v25, 320, v24
    v_mov_b32 v26, s79
    v_mov_b32 v27, s78
    v_cndmask_b32 v25, v25, v24, vcc
    v_cndmask_b32 v26, v26, v27, vcc
    v_mul_u32_u24 v27, 6554, v25
    v_lshrrev_b32 v27, 16, v27
    v_mul_u32_u24 v28, 10, v27
    v_sub_u32_e64 v28, v25, v28
    v_mul_u32_u24 v27, 1280, v27
    v_lshl_add_u32 v27, v28, 4, v27
    v_add_u32_e64 v255, v27, v26
    v_mov_b32 v26, 2211840
    v_cmp_gt_u32 vcc, 640, v24
    s_nop 1
    v_cndmask_b32 v255, v26, v255, vcc
    s_and_b32 s77, s58, 7
    s_lshl_b32 s78, s57, 2
    s_lshr_b32 s79, s58, 3
    s_add_u32 s78, s78, s79
    s_mul_i32 s77, s77, 54
    s_add_u32 s77, s77, s78
    s_mul_i32 s77, s77, 5120
    s_add_u32 s77, s77, 4194304
    v_lshrrev_b32_e64 v24, 4, v0
    v_bfe_u32 v25, v0, 2, 2
    s_add_u32 m0, s62, 16384
    s_nop 0
    buffer_load_dwordx4 v244, s[40:43], s61 offen offset:0 lds
    v_lshl_add_u32 v24, v24, 2, v25
    v_mul_u32_u24 v24, 160, v24
    v_and_b32 v25, 3, v0
    s_add_u32 s79, s3, 0
    s_cmp_ge_u32 s79, 5
    s_cselect_b32 s80, 1, 0
    s_mul_i32 s81, s80, 5
    s_sub_u32 s79, s79, s81
    s_mul_i32 s81, s80, 163840
    s_add_u32 s81, s81, s77
    s_lshl_b32 s82, s79, 10
    s_add_u32 s81, s81, s82
    s_cmp_ge_u32 s78, 22
    s_cselect_b32 s82, s80, 0
    s_cmp_ge_u32 s79, 5
    s_cselect_b32 s82, 1, s82
    s_cmp_lg_u32 s82, 0
    s_cselect_b32 s74, 17563648, s81
    s_min_u32 s79, s79, 4
    s_and_b32 s82, s79, 1
    s_lshl_b32 s82, s82, 3
    s_lshr_b32 s83, s79, 1
    s_lshl_b32 s83, s83, 6
    s_add_u32 s82, s82, s83
    s_mul_i32 s83, s80, 5120
    s_add_u32 s82, s82, s83
    s_add_u32 s82, s82, 139776
    s_cmp_eq_u32 s79, 4
    s_cselect_b32 s83, 3, 4
    v_lshlrev_b32 v200, s83, v25
    v_add3_u32 v200, v200, v24, s82
    s_add_u32 s79, s3, 4
    s_cmp_ge_u32 s79, 5
    s_cselect_b32 s80, 1, 0
    buffer_load_dwordx4 v245, s[40:43], s61 offen offset:1024 lds
    s_mul_i32 s81, s80, 5
    s_sub_u32 s79, s79, s81
    s_mul_i32 s81, s80, 163840
    s_add_u32 s81, s81, s77
    s_lshl_b32 s82, s79, 10
    s_add_u32 s81, s81, s82
    s_cmp_ge_u32 s78, 22
    s_cselect_b32 s82, s80, 0
    s_cmp_ge_u32 s79, 5
    s_cselect_b32 s82, 1, s82
    s_cmp_lg_u32 s82, 0
    s_cselect_b32 s75, 17563648, s81
    s_min_u32 s79, s79, 4
    s_and_b32 s82, s79, 1
    s_lshl_b32 s82, s82, 3
    s_lshr_b32 s83, s79, 1
    s_lshl_b32 s83, s83, 6
    s_add_u32 s82, s82, s83
    s_mul_i32 s83, s80, 5120
    s_add_u32 s82, s82, s83
    s_add_u32 s82, s82, 139776
    s_cmp_eq_u32 s79, 4
    s_cselect_b32 s83, 3, 4
    v_lshlrev_b32 v201, s83, v25
    v_add3_u32 v201, v201, v24, s82
    s_add_u32 s79, s3, 8
    s_cmp_ge_u32 s79, 5
    s_cselect_b32 s80, 1, 0
    s_mul_i32 s81, s80, 5
    s_sub_u32 s79, s79, s81
    s_mul_i32 s81, s80, 163840
    s_add_u32 s81, s81, s77
    s_lshl_b32 s82, s79, 10
    s_add_u32 s81, s81, s82
    buffer_load_dwordx4 v246, s[40:43], s61 offen offset:2048 lds
    s_cmp_ge_u32 s78, 22
    s_cselect_b32 s82, s80, 0
    s_cmp_ge_u32 s79, 5
    s_cselect_b32 s82, 1, s82
    s_cmp_lg_u32 s82, 0
    s_cselect_b32 s76, 17563648, s81
    s_min_u32 s79, s79, 4
    s_and_b32 s82, s79, 1
    s_lshl_b32 s82, s82, 3
    s_lshr_b32 s83, s79, 1
    s_lshl_b32 s83, s83, 6
    s_add_u32 s82, s82, s83
    s_mul_i32 s83, s80, 5120
    s_add_u32 s82, s82, s83
    s_add_u32 s82, s82, 139776
    s_cmp_eq_u32 s79, 4
    s_cselect_b32 s83, 3, 4
    v_lshlrev_b32 v202, s83, v25
    v_add3_u32 v202, v202, v24, s82
    v_lshlrev_b32 v14, 4, v0
    v_and_b32 v1, 15, v0
    v_lshrrev_b32 v17, 4, v0
    v_bfe_u32 v18, v0, 2, 2
    v_and_b32 v19, 3, v0
    v_and_b32 v24, 1, v17
    v_lshl_or_b32 v24, v24, 2, v18
    v_lshl_add_u32 v25, v17, 3, v18
    v_lshlrev_b32 v25, 8, v25
    v_lshl_add_u32 v25, v19, 3, v25
    s_and_b32 s73, s69, 7
    v_xor_b32_e64 v26, s73, v24
    v_lshl_add_u32 v2, v26, 5, v25
    buffer_load_dwordx4 v247, s[40:43], s61 offen offset:3072 lds
    v_add_u32 v6, 0x10000, v2
    s_and_b32 s73, s70, 7
    v_xor_b32 v26, s73, v24
    v_lshl_add_u32 v3, v26, 5, v25
    v_add_u32 v7, 0x10000, v3
    s_and_b32 s73, s71, 7
    v_xor_b32 v26, s73, v24
    v_lshl_add_u32 v4, v26, 5, v25
    v_add_u32 v8, 0x10000, v4
    s_and_b32 s73, s72, 7
    v_xor_b32 v26, s73, v24
    v_lshl_add_u32 v5, v26, 5, v25
    v_add_u32 v9, 0x10000, v5
    s_lshl_b32 s73, s66, 13
    v_and_b32 v24, 7, v1
    v_xor_b32 v24, v24, v17
    v_lshlrev_b32 v24, 4, v24
    v_lshl_add_u32 v24, v1, 7, v24
    v_add_u32 v10, s73, v24
    v_xor_b32 v11, 64, v10
    v_add_u32 v12, 0x10000, v10
    v_add_u32 v13, 0x10000, v11
    v_mov_b32 v20, 0x3f803f80
    v_mov_b32 v21, 0x3f803f80
    v_mov_b32 v22, 0x3f803f80
    v_mov_b32 v23, 0x3f803f80
    s_lshl_b32 s67, s63, 7
    s_lshl_b32 s73, s66, 6
    s_add_u32 s67, s67, s73
    s_bitcmp1_b32 s0, 0
    s_cselect_b32 s87, s85, 128
    s_cselect_b32 s88, s86, 221184
    s_add_u32 s60, s60, s87
    s_add_u32 s61, s61, s88
    s_add_u32 m0, s62, 32768
    s_nop 0
    buffer_load_dwordx4 v240, s[32:35], s60 offen offset:0 lds
    s_waitcnt vmcnt(18)
    v_lshlrev_b32 v144, 16, v118
    v_and_b32 v148, 0xffff0000, v118
    v_lshlrev_b32 v145, 16, v122
    v_and_b32 v149, 0xffff0000, v122
    v_lshlrev_b32 v146, 16, v120
    v_and_b32 v150, 0xffff0000, v120
    v_lshlrev_b32 v147, 16, v124
    v_and_b32 v151, 0xffff0000, v124
    v_lshlrev_b32 v152, 16, v119
    v_and_b32 v156, 0xffff0000, v119
    v_lshlrev_b32 v153, 16, v123
    v_and_b32 v157, 0xffff0000, v123
    v_lshlrev_b32 v154, 16, v121
    v_and_b32 v158, 0xffff0000, v121
    v_lshlrev_b32 v155, 16, v125
    buffer_load_dwordx4 v241, s[32:35], s60 offen offset:1024 lds
    v_and_b32 v159, 0xffff0000, v125
    v_lshlrev_b32 v128, 16, v96
    v_and_b32 v96, 0xffff0000, v96
    v_lshlrev_b32 v129, 16, v97
    v_and_b32 v97, 0xffff0000, v97
    v_lshlrev_b32 v130, 16, v98
    v_and_b32 v98, 0xffff0000, v98
    v_lshlrev_b32 v131, 16, v99
    v_and_b32 v99, 0xffff0000, v99
    v_lshlrev_b32 v132, 16, v100
    v_and_b32 v100, 0xffff0000, v100
    v_lshlrev_b32 v133, 16, v101
    v_and_b32 v101, 0xffff0000, v101
    v_lshlrev_b32 v134, 16, v102
    v_and_b32 v102, 0xffff0000, v102
    v_lshlrev_b32 v135, 16, v103
    buffer_load_dwordx4 v242, s[32:35], s60 offen offset:2048 lds
    v_and_b32 v103, 0xffff0000, v103
    v_lshlrev_b32 v136, 16, v104
    v_and_b32 v104, 0xffff0000, v104
    v_lshlrev_b32 v137, 16, v105
    v_and_b32 v105, 0xffff0000, v105
    v_lshlrev_b32 v138, 16, v106
    v_and_b32 v106, 0xffff0000, v106
    v_lshlrev_b32 v139, 16, v107
    v_and_b32 v107, 0xffff0000, v107
    v_lshlrev_b32 v140, 16, v108
    v_and_b32 v108, 0xffff0000, v108
    v_lshlrev_b32 v141, 16, v109
    v_and_b32 v109, 0xffff0000, v109
    v_pk_mul_f32 v[160:161], v[134:135], v[144:145]
    v_pk_mul_f32 v[162:163], v[102:103], v[146:147]
    v_pk_mul_f32 v[164:165], v[136:137], v[144:145]
    buffer_load_dwordx4 v243, s[32:35], s60 offen offset:3072 lds
    v_pk_mul_f32 v[166:167], v[104:105], v[146:147]
    v_pk_mul_f32 v[168:169], v[138:139], v[144:145]
    v_pk_mul_f32 v[170:171], v[106:107], v[146:147]
    v_pk_mul_f32 v[172:173], v[140:141], v[144:145]
    v_pk_mul_f32 v[174:175], v[108:109], v[146:147]
    v_pk_fma_f32 v[160:161], v[132:133], v[148:149], v[160:161]
    v_pk_fma_f32 v[162:163], v[100:101], v[150:151], v[162:163]
    v_pk_fma_f32 v[164:165], v[134:135], v[148:149], v[164:165]
    v_pk_fma_f32 v[166:167], v[102:103], v[150:151], v[166:167]
    v_pk_fma_f32 v[168:169], v[136:137], v[148:149], v[168:169]
    v_pk_fma_f32 v[170:171], v[104:105], v[150:151], v[170:171]
    v_pk_fma_f32 v[172:173], v[138:139], v[148:149], v[172:173]
    v_pk_fma_f32 v[174:175], v[106:107], v[150:151], v[174:175]
    v_pk_fma_f32 v[160:161], v[130:131], v[152:153], v[160:161]
    v_pk_fma_f32 v[162:163], v[98:99], v[154:155], v[162:163]
    v_pk_fma_f32 v[164:165], v[132:133], v[152:153], v[164:165]
    s_add_u32 m0, s62, 49152
    s_nop 0
    s_nop 0
    buffer_load_dwordx4 v244, s[40:43], s61 offen offset:0 lds
    v_pk_fma_f32 v[166:167], v[100:101], v[154:155], v[166:167]
    v_pk_fma_f32 v[168:169], v[134:135], v[152:153], v[168:169]
    v_pk_fma_f32 v[170:171], v[102:103], v[154:155], v[170:171]
    v_pk_fma_f32 v[172:173], v[136:137], v[152:153], v[172:173]
    v_pk_fma_f32 v[174:175], v[104:105], v[154:155], v[174:175]
    v_pk_fma_f32 v[160:161], v[128:129], v[156:157], v[160:161]
    v_pk_fma_f32 v[162:163], v[96:97], v[158:159], v[162:163]
    v_pk_fma_f32 v[164:165], v[130:131], v[156:157], v[164:165]
    v_pk_fma_f32 v[166:167], v[98:99], v[158:159], v[166:167]
    v_pk_fma_f32 v[168:169], v[132:133], v[156:157], v[168:169]
    v_pk_fma_f32 v[170:171], v[100:101], v[158:159], v[170:171]
    v_pk_fma_f32 v[172:173], v[134:135], v[156:157], v[172:173]
    v_pk_fma_f32 v[174:175], v[102:103], v[158:159], v[174:175]
    s_waitcnt vmcnt(18)
    v_lshlrev_b32 v128, 16, v110
    v_and_b32 v110, 0xffff0000, v110
    buffer_load_dwordx4 v245, s[40:43], s61 offen offset:1024 lds
    v_lshlrev_b32 v129, 16, v111
    v_and_b32 v111, 0xffff0000, v111
    v_lshlrev_b32 v130, 16, v112
    v_and_b32 v112, 0xffff0000, v112
    v_lshlrev_b32 v131, 16, v113
    v_and_b32 v113, 0xffff0000, v113
    v_lshlrev_b32 v132, 16, v114
    v_and_b32 v114, 0xffff0000, v114
    v_lshlrev_b32 v133, 16, v115
    v_and_b32 v115, 0xffff0000, v115
    v_lshlrev_b32 v134, 16, v116
    v_and_b32 v116, 0xffff0000, v116
    v_lshlrev_b32_e64 v135, 16, v117
    v_and_b32 v117, 0xffff0000, v117
    v_pk_mul_f32 v[160:161], v[160:161], v[128:129]
    v_pk_mul_f32 v[162:163], v[162:163], v[110:111]
    buffer_load_dwordx4 v246, s[40:43], s61 offen offset:2048 lds
    v_pk_mul_f32 v[164:165], v[164:165], v[130:131]
    v_pk_mul_f32 v[166:167], v[166:167], v[112:113]
    v_pk_mul_f32 v[168:169], v[168:169], v[132:133]
    v_pk_mul_f32 v[170:171], v[170:171], v[114:115]
    v_pk_mul_f32 v[172:173], v[172:173], v[134:135]
    v_pk_mul_f32 v[174:175], v[174:175], v[116:117]
    v_cvt_pk_bf16_f32 v144, v172, v168
    v_cvt_pk_bf16_f32 v145, v164, v160
    v_cvt_pk_bf16_f32 v146, v174, v170
    v_cvt_pk_bf16_f32 v147, v166, v162
    v_cvt_pk_bf16_f32 v148, v173, v169
    v_cvt_pk_bf16_f32 v149, v165, v161
    v_cvt_pk_bf16_f32 v150, v175, v171
    v_cvt_pk_bf16_f32 v151, v167, v163
    ds_write_b64 v203, v[144:145] offset:0
    ds_write_b64 v203, v[146:147] offset:128
    buffer_load_dwordx4 v247, s[40:43], s61 offen offset:3072 lds
    ds_write_b64 v203, v[148:149] offset:256
    ds_write_b64 v203, v[150:151] offset:384
    s_waitcnt vmcnt(16)
    s_mov_b32 s78, 0x3f803f80
    v_mov_b32 v228, 0
    v_mov_b32 v229, 0
    v_dot2c_f32_bf16 v228, s78, v216
    v_dot2c_f32_bf16 v229, v216, v216
    v_dot2c_f32_bf16 v228, s78, v217
    v_dot2c_f32_bf16 v229, v217, v217
    v_dot2c_f32_bf16 v228, s78, v218
    v_dot2c_f32_bf16 v229, v218, v218
    v_dot2c_f32_bf16 v228, s78, v219
    v_dot2c_f32_bf16 v229, v219, v219
    v_dot2c_f32_bf16 v228, s78, v220
PAGE1:
    s_cbranch_execz PAGE2
    v_dot2c_f32_bf16 v229, v220, v220
    v_dot2c_f32_bf16 v228, s78, v221
    s_bitcmp1_b32 s0, 1
    s_cselect_b32 s87, s85, 128
    s_cselect_b32 s88, s86, 221184
    s_add_u32 s60, s60, s87
    s_add_u32 s61, s61, s88
    v_dot2c_f32_bf16 v229, v221, v221
    v_dot2c_f32_bf16 v228, s78, v222
    v_dot2c_f32_bf16 v229, v222, v222
    v_dot2c_f32_bf16 v228, s78, v223
    v_dot2c_f32_bf16 v229, v223, v223
    v_dot2c_f32_bf16 v228, s78, v224
    v_dot2c_f32_bf16 v229, v224, v224
    v_dot2c_f32_bf16 v228, s78, v225
    v_dot2c_f32_bf16 v229, v225, v225
    s_nop 1
    v_add_f32_dpp v228, v228, v228 row_ror:8 row_mask:0xf bank_mask:0xf
    v_add_f32_dpp v229, v229, v229 row_ror:8 row_mask:0xf bank_mask:0xf
    s_nop 1
    v_add_f32_dpp v228, v228, v228 row_ror:4 row_mask:0xf bank_mask:0xf
    v_add_f32_dpp v229, v229, v229 row_ror:4 row_mask:0xf bank_mask:0xf
    s_nop 1
    v_add_f32_dpp v228, v228, v228 row_ror:2 row_mask:0xf bank_mask:0xf
    v_add_f32_dpp v229, v229, v229 row_ror:2 row_mask:0xf bank_mask:0xf
    s_nop 1
    v_add_f32_dpp v228, v228, v228 row_ror:1 row_mask:0xf bank_mask:0xf
    v_add_f32_dpp v229, v229, v229 row_ror:1 row_mask:0xf bank_mask:0xf
    s_nop 1
    v_add_f32_dpp v228, v228, v228 row_bcast:15 row_mask:0xa bank_mask:0xf
    v_add_f32_dpp v229, v229, v229 row_bcast:15 row_mask:0xa bank_mask:0xf
    s_nop 0
    v_mul_f32 v230, 0x3acccccd, v228
    v_mul_f32 v229, 0x3acccccd, v229
    v_fma_f32 v229, -v230, v230, v229
    v_max_f32 v229, 0, v229
    v_add_f32 v229, 0x3727c5ac, v229
    v_rsq_f32_e64 v231, v229
    s_mov_b32 s78, 65536
    s_mov_b32 exec_lo, 0x10000
    s_mov_b32 exec_hi, 0x10000
    buffer_store_dwordx2 v[230:231], v226, s[36:39], s78 offen sc1
    s_mov_b64 exec, -1
    s_waitcnt vmcnt(9) lgkmcnt(0)
    s_barrier
    s_add_u32 s56, s56, 2654435769
    v_mov_b32 v31, s56
    ds_read_b128 v[48:51], v10 offset:0
    ds_read_b64_tr_b16 v[32:33], v2 offset:16384
    ds_read_b64_tr_b16 v[34:35], v2 offset:17408
    ds_read_b128 v[52:55], v10 offset:2048
    ds_read_b64_tr_b16 v[36:37], v3 offset:16384
    ds_read_b64_tr_b16 v[38:39], v3 offset:17408
    ds_read_b128 v[56:59], v10 offset:4096
    ds_read_b64_tr_b16 v[40:41], v4 offset:16384
    ds_read_b64_tr_b16 v[42:43], v4 offset:17408
    ds_read_b128 v[60:63], v10 offset:6144
    ds_read_b64_tr_b16 v[44:45], v5 offset:16384
    ds_read_b64_tr_b16 v[46:47], v5 offset:17408
    ds_read_b128 v[96:99], v204 offset:0
    ds_read_b128 v[100:103], v204 offset:4096
    s_add_u32 m0, s62, 65536
    s_nop 0
    buffer_load_dwordx4 v240, s[32:35], s60 offen offset:0 lds
    buffer_load_dwordx4 v241, s[32:35], s60 offen offset:1024 lds
    buffer_load_dwordx4 v242, s[32:35], s60 offen offset:2048 lds
    buffer_load_dwordx4 v243, s[32:35], s60 offen offset:3072 lds
    s_waitcnt lgkmcnt(0)
    v_mfma_f32_16x16x32_bf16 v[128:131], v[32:35], v[48:51], 0
    ds_read_b128 v[80:83], v11 offset:0
    buffer_store_dwordx4 v[96:99], v205, s[36:39], s59 offen sc1
    v_mfma_f32_16x16x32_bf16 v[132:135], v[32:35], v[52:55], 0
    ds_read_b64_tr_b16 v[64:65], v2 offset:24576
    buffer_store_dwordx4 v[100:103], v206, s[36:39], s59 offen sc1
    v_mfma_f32_16x16x32_bf16 v[136:139], v[32:35], v[56:59], 0
    ds_read_b64_tr_b16 v[66:67], v2 offset:25600
    v_mfma_f32_16x16x32_bf16 v[140:143], v[32:35], v[60:63], 0
    ds_read_b128 v[84:87], v11 offset:2048
    v_mfma_f32_16x16x32_bf16 v[192:195], v[32:35], v[20:23], 0
    ds_read_b64_tr_b16 v[68:69], v3 offset:24576
    v_mfma_f32_16x16x32_bf16 v[144:147], v[36:39], v[48:51], 0
    ds_read_b64_tr_b16 v[70:71], v3 offset:25600
    s_add_u32 m0, s62, 81920
    v_mfma_f32_16x16x32_bf16 v[148:151], v[36:39], v[52:55], 0
    ds_read_b128 v[88:91], v11 offset:4096
    v_mfma_f32_16x16x32_bf16 v[152:155], v[36:39], v[56:59], 0
    ds_read_b64_tr_b16 v[72:73], v4 offset:24576
    buffer_load_dwordx4 v244, s[40:43], s61 offen offset:0 lds
    v_mfma_f32_16x16x32_bf16 v[156:159], v[36:39], v[60:63], 0
    ds_read_b64_tr_b16 v[74:75], v4 offset:25600
    v_mfma_f32_16x16x32_bf16 v[196:199], v[36:39], v[20:23], 0
    ds_read_b128 v[92:95], v11 offset:6144
    v_mfma_f32_16x16x32_bf16 v[160:163], v[40:43], v[48:51], 0
    ds_read_b64_tr_b16 v[76:77], v5 offset:24576
    buffer_load_dwordx4 v245, s[40:43], s61 offen offset:1024 lds
    v_mfma_f32_16x16x32_bf16 v[164:167], v[40:43], v[52:55], 0
    ds_read_b64_tr_b16 v[78:79], v5 offset:25600
    v_mfma_f32_16x16x32_bf16 v[168:171], v[40:43], v[56:59], 0
    v_mfma_f32_16x16x32_bf16 v[172:175], v[40:43], v[60:63], 0
    buffer_load_dwordx4 v246, s[40:43], s61 offen offset:2048 lds
    v_mfma_f32_16x16x32_bf16 v[176:179], v[44:47], v[48:51], 0
    v_mfma_f32_16x16x32_bf16 v[180:183], v[44:47], v[52:55], 0
    buffer_load_dwordx4 v247, s[40:43], s61 offen offset:3072 lds
    s_bitcmp1_b32 s0, 2
    s_cselect_b32 s87, s85, 128
    s_cselect_b32 s88, s86, 221184
    v_mfma_f32_16x16x32_bf16 v[184:187], v[44:47], v[56:59], 0
    s_add_u32 s60, s60, s87
    v_mfma_f32_16x16x32_bf16 v[188:191], v[44:47], v[60:63], 0
    s_add_u32 s61, s61, s88
    s_waitcnt vmcnt(11) lgkmcnt(0)
    s_barrier
    s_nop 0
    v_mfma_f32_16x16x32_bf16 v[128:131], v[64:67], v[80:83], v[128:131]
    ds_read_b128 v[48:51], v10 offset:32768
    s_add_u32 m0, s62, 98304
    v_mfma_f32_16x16x32_bf16 v[132:135], v[64:67], v[84:87], v[132:135]
    ds_read_b64_tr_b16 v[32:33], v2 offset:49152
    v_mov_b32 v30, 17563648
    v_mfma_f32_16x16x32_bf16 v[136:139], v[64:67], v[88:91], v[136:139]
    ds_read_b64_tr_b16 v[34:35], v2 offset:50176
    buffer_load_dwordx4 v240, s[32:35], s60 offen offset:0 lds
    v_mfma_f32_16x16x32_bf16 v[140:143], v[64:67], v[92:95], v[140:143]
    ds_read_b128 v[52:55], v10 offset:34816
    s_cmp_eq_u32 s3, 0
    s_nop 0
    s_cselect_b32 s80, s84, 17563648
    v_mfma_f32_16x16x32_bf16 v[192:195], v[64:67], v[20:23], v[192:195]
    ds_read_b64_tr_b16 v[36:37], v3 offset:49152
    v_mfma_f32_16x16x32_bf16 v[144:147], v[68:71], v[80:83], v[144:147]
    ds_read_b64_tr_b16 v[38:39], v3 offset:50176
    v_mfma_f32_16x16x32_bf16 v[148:151], v[68:71], v[84:87], v[148:151]
    ds_read_b128 v[56:59], v10 offset:36864
    buffer_load_dwordx4 v241, s[32:35], s60 offen offset:1024 lds
    v_mfma_f32_16x16x32_bf16 v[152:155], v[68:71], v[88:91], v[152:155]
    ds_read_b64_tr_b16 v[40:41], v4 offset:49152
    v_writelane_b32 v30, s80, 1
    v_mfma_f32_16x16x32_bf16 v[156:159], v[68:71], v[92:95], v[156:159]
    ds_read_b64_tr_b16 v[42:43], v4 offset:50176
    v_mfma_f32_16x16x32_bf16 v[196:199], v[68:71], v[20:23], v[196:199]
    ds_read_b128 v[60:63], v10 offset:38912
    s_lshl_b32 s77, s57, 1
    v_mfma_f32_16x16x32_bf16 v[160:163], v[72:75], v[80:83], v[160:163]
    ds_read_b64_tr_b16 v[44:45], v5 offset:49152
    s_lshr_b32 s78, s58, 4
    v_mfma_f32_16x16x32_bf16 v[164:167], v[72:75], v[84:87], v[164:167]
    ds_read_b64_tr_b16 v[46:47], v5 offset:50176
    buffer_load_dwordx4 v242, s[32:35], s60 offen offset:2048 lds
    v_mfma_f32_16x16x32_bf16 v[168:171], v[72:75], v[88:91], v[168:171]
    s_add_u32 s77, s77, s78
    v_mfma_f32_16x16x32_bf16 v[172:175], v[72:75], v[92:95], v[172:175]
    s_lshl_b32 s77, s77, 4
    v_mfma_f32_16x16x32_bf16 v[176:179], v[76:79], v[80:83], v[176:179]
    s_and_b32 s78, s58, 15
    v_mfma_f32_16x16x32_bf16 v[180:183], v[76:79], v[84:87], v[180:183]
    buffer_load_dwordx4 v243, s[32:35], s60 offen offset:3072 lds
    s_add_u32 s77, s77, s78
    v_mfma_f32_16x16x32_bf16 v[184:187], v[76:79], v[88:91], v[184:187]
    s_lshl_b32 s77, s77, 6
    v_mfma_f32_16x16x32_bf16 v[188:191], v[76:79], v[92:95], v[188:191]
    s_add_u32 s77, s77, 196608
    s_waitcnt lgkmcnt(0)
    v_mfma_f32_16x16x32_bf16 v[128:131], v[32:35], v[48:51], v[128:131]
    ds_read_b128 v[80:83], v11 offset:32768
    s_add_u32 m0, s62, 114688
    v_mfma_f32_16x16x32_bf16 v[132:135], v[32:35], v[52:55], v[132:135]
    ds_read_b64_tr_b16 v[64:65], v2 offset:57344
    s_cmp_eq_u32 s3, 0
    s_nop 0
    s_cselect_b32 s77, s77, 17563648
    v_mfma_f32_16x16x32_bf16 v[136:139], v[32:35], v[56:59], v[136:139]
    ds_read_b64_tr_b16 v[66:67], v2 offset:58368
    buffer_load_dwordx4 v244, s[40:43], s61 offen offset:0 lds
    v_mfma_f32_16x16x32_bf16 v[140:143], v[32:35], v[60:63], v[140:143]
    ds_read_b128 v[84:87], v11 offset:34816
    v_mfma_f32_16x16x32_bf16 v[192:195], v[32:35], v[20:23], v[192:195]
    ds_read_b64_tr_b16 v[68:69], v3 offset:57344
    v_writelane_b32 v30, s77, 0
    v_mfma_f32_16x16x32_bf16 v[144:147], v[36:39], v[48:51], v[144:147]
    ds_read_b64_tr_b16 v[70:71], v3 offset:58368
    s_and_b32 s77, s58, 7
    v_mfma_f32_16x16x32_bf16 v[148:151], v[36:39], v[52:55], v[148:151]
    ds_read_b128 v[88:91], v11 offset:36864
    buffer_load_dwordx4 v245, s[40:43], s61 offen offset:1024 lds
    v_mfma_f32_16x16x32_bf16 v[152:155], v[36:39], v[56:59], v[152:155]
    ds_read_b64_tr_b16 v[72:73], v4 offset:57344
    s_lshl_b32 s77, s77, 5
    v_mfma_f32_16x16x32_bf16 v[156:159], v[36:39], v[60:63], v[156:159]
    ds_read_b64_tr_b16 v[74:75], v4 offset:58368
    s_lshl_b32 s78, s57, 2
    v_mfma_f32_16x16x32_bf16 v[196:199], v[36:39], v[20:23], v[196:199]
    ds_read_b128 v[92:95], v11 offset:38912
    s_lshr_b32 s79, s58, 3
    v_mfma_f32_16x16x32_bf16 v[160:163], v[40:43], v[48:51], v[160:163]
    ds_read_b64_tr_b16 v[76:77], v5 offset:57344
    buffer_load_dwordx4 v246, s[40:43], s61 offen offset:2048 lds
    v_mfma_f32_16x16x32_bf16 v[164:167], v[40:43], v[52:55], v[164:167]
    ds_read_b64_tr_b16 v[78:79], v5 offset:58368
    s_add_u32 s78, s78, s79
    v_mfma_f32_16x16x32_bf16 v[168:171], v[40:43], v[56:59], v[168:171]
    s_add_u32 s77, s77, s78
    s_lshl_b32 s77, s77, 6
    v_mfma_f32_16x16x32_bf16 v[172:175], v[40:43], v[60:63], v[172:175]
    buffer_load_dwordx4 v247, s[40:43], s61 offen offset:3072 lds
    s_add_u32 s77, s77, 163840
    v_mfma_f32_16x16x32_bf16 v[176:179], v[44:47], v[48:51], v[176:179]
    s_cmp_eq_u32 s3, 0
    s_cselect_b32 s77, s77, 17563648
    v_mfma_f32_16x16x32_bf16 v[180:183], v[44:47], v[52:55], v[180:183]
    s_bitcmp1_b32 s0, 3
    s_cselect_b32 s87, s85, 128
    s_cselect_b32 s88, s86, 221184
    v_mfma_f32_16x16x32_bf16 v[184:187], v[44:47], v[56:59], v[184:187]
    s_add_u32 s60, s60, s87
    v_writelane_b32 v30, s77, 2
    v_mfma_f32_16x16x32_bf16 v[188:191], v[44:47], v[60:63], v[188:191]
    s_add_u32 s61, s61, s88
    s_waitcnt vmcnt(8) lgkmcnt(0)
    s_barrier
    s_mov_b32 exec_lo, 3
    s_mov_b32 exec_hi, 0
    buffer_store_dword v31, v30, s[36:39], 0 offen sc1
    s_mov_b64 exec, -1
    v_mfma_f32_16x16x32_bf16 v[128:131], v[64:67], v[80:83], v[128:131]
    ds_read_b128 v[48:51], v12 offset:0
    s_lshl_b32 m0, s3, 10
    s_add_u32 m0, m0, 139776
    s_nop 0
    buffer_load_dwordx4 v253, s[44:47], 0 offen nt lds
    v_mfma_f32_16x16x32_bf16 v[132:135], v[64:67], v[84:87], v[132:135]
    ds_read_b64_tr_b16 v[32:33], v6 offset:16384
    s_lshl_b32 m0, s3, 10
    s_add_u32 m0, m0, 143872
    s_nop 0
    buffer_load_dwordx4 v254, s[44:47], 0 offen nt lds
    v_mfma_f32_16x16x32_bf16 v[136:139], v[64:67], v[88:91], v[136:139]
    ds_read_b64_tr_b16 v[34:35], v6 offset:17408
    s_lshl_b32 m0, s3, 10
    s_add_u32 m0, m0, 147968
    s_nop 0
    buffer_load_dwordx4 v255, s[44:47], 0 offen nt lds
    v_mfma_f32_16x16x32_bf16 v[140:143], v[64:67], v[92:95], v[140:143]
    ds_read_b128 v[52:55], v12 offset:2048
    v_min_u32_e64 v28, 15, v0
    v_mfma_f32_16x16x32_bf16 v[192:195], v[64:67], v[20:23], v[192:195]
    ds_read_b64_tr_b16 v[36:37], v7 offset:16384
    v_mfma_f32_16x16x32_bf16 v[144:147], v[68:71], v[80:83], v[144:147]
    ds_read_b64_tr_b16 v[38:39], v7 offset:17408
    s_add_u32 m0, s62, 0
    v_mfma_f32_16x16x32_bf16 v[148:151], v[68:71], v[84:87], v[148:151]
    ds_read_b128 v[56:59], v12 offset:4096
    v_lshlrev_b32 v28, 6, v28
    v_mfma_f32_16x16x32_bf16 v[152:155], v[68:71], v[88:91], v[152:155]
    ds_read_b64_tr_b16 v[40:41], v8 offset:16384
    buffer_load_dwordx4 v240, s[32:35], s60 offen offset:0 lds
    v_mfma_f32_16x16x32_bf16 v[156:159], v[68:71], v[92:95], v[156:159]
    ds_read_b64_tr_b16 v[42:43], v8 offset:17408
    v_mfma_f32_16x16x32_bf16 v[196:199], v[68:71], v[20:23], v[196:199]
    ds_read_b128 v[60:63], v12 offset:6144
    v_mfma_f32_16x16x32_bf16 v[160:163], v[72:75], v[80:83], v[160:163]
    ds_read_b64_tr_b16 v[44:45], v9 offset:16384
    buffer_load_dwordx4 v241, s[32:35], s60 offen offset:1024 lds
    v_mfma_f32_16x16x32_bf16 v[164:167], v[72:75], v[84:87], v[164:167]
    ds_read_b64_tr_b16 v[46:47], v9 offset:17408
    s_lshl_b32 s73, s63, 10
    v_mfma_f32_16x16x32_bf16 v[168:171], v[72:75], v[88:91], v[168:171]
    v_mfma_f32_16x16x32_bf16 v[172:175], v[72:75], v[92:95], v[172:175]
    buffer_load_dwordx4 v242, s[32:35], s60 offen offset:2048 lds
    s_add_u32 s73, s73, 196608
    v_mfma_f32_16x16x32_bf16 v[176:179], v[76:79], v[80:83], v[176:179]
    v_add_u32 v28, s73, v28
    v_mfma_f32_16x16x32_bf16 v[180:183], v[76:79], v[84:87], v[180:183]
    buffer_load_dwordx4 v243, s[32:35], s60 offen offset:3072 lds
    v_mfma_f32_16x16x32_bf16 v[184:187], v[76:79], v[88:91], v[184:187]
    s_mov_b32 s48, s20
    v_mfma_f32_16x16x32_bf16 v[188:191], v[76:79], v[92:95], v[188:191]
    s_waitcnt lgkmcnt(0)
    v_mfma_f32_16x16x32_bf16 v[128:131], v[32:35], v[48:51], v[128:131]
    ds_read_b128 v[80:83], v13 offset:0
    s_add_u32 m0, s62, 16384
    v_mfma_f32_16x16x32_bf16 v[132:135], v[32:35], v[52:55], v[132:135]
    ds_read_b64_tr_b16 v[64:65], v6 offset:24576
    s_mov_b32 s49, s21
    s_nop 0
    v_mfma_f32_16x16x32_bf16 v[136:139], v[32:35], v[56:59], v[136:139]
    ds_read_b64_tr_b16 v[66:67], v6 offset:25600
    buffer_load_dwordx4 v244, s[40:43], s61 offen offset:0 lds
    v_mfma_f32_16x16x32_bf16 v[140:143], v[32:35], v[60:63], v[140:143]
    ds_read_b128 v[84:87], v13 offset:2048
    v_mfma_f32_16x16x32_bf16 v[192:195], v[32:35], v[20:23], v[192:195]
    ds_read_b64_tr_b16 v[68:69], v7 offset:24576
    s_mov_b32 s50, 3456
    v_mfma_f32_16x16x32_bf16 v[144:147], v[36:39], v[48:51], v[144:147]
    ds_read_b64_tr_b16 v[70:71], v7 offset:25600
    v_mfma_f32_16x16x32_bf16 v[148:151], v[36:39], v[52:55], v[148:151]
    ds_read_b128 v[88:91], v13 offset:4096
    buffer_load_dwordx4 v245, s[40:43], s61 offen offset:1024 lds
    v_mfma_f32_16x16x32_bf16 v[152:155], v[36:39], v[56:59], v[152:155]
    ds_read_b64_tr_b16 v[72:73], v8 offset:24576
    v_mfma_f32_16x16x32_bf16 v[156:159], v[36:39], v[60:63], v[156:159]
    ds_read_b64_tr_b16 v[74:75], v8 offset:25600
    s_mov_b32 s51, 0x20000
    v_mfma_f32_16x16x32_bf16 v[196:199], v[36:39], v[20:23], v[196:199]
    ds_read_b128 v[92:95], v13 offset:6144
    v_mfma_f32_16x16x32_bf16 v[160:163], v[40:43], v[48:51], v[160:163]
    ds_read_b64_tr_b16 v[76:77], v9 offset:24576
    buffer_load_dwordx4 v246, s[40:43], s61 offen offset:2048 lds
    v_mfma_f32_16x16x32_bf16 v[164:167], v[40:43], v[52:55], v[164:167]
    ds_read_b64_tr_b16 v[78:79], v9 offset:25600
    v_lshrrev_b32 v24, 4, v0
    v_mfma_f32_16x16x32_bf16 v[168:171], v[40:43], v[56:59], v[168:171]
    v_mfma_f32_16x16x32_bf16 v[172:175], v[40:43], v[60:63], v[172:175]
    buffer_load_dwordx4 v247, s[40:43], s61 offen offset:3072 lds
    s_lshl_b32 s73, s69, 5
    v_mfma_f32_16x16x32_bf16 v[176:179], v[44:47], v[48:51], v[176:179]
    v_lshl_add_u32 v232, v24, 3, s73
    v_mfma_f32_16x16x32_bf16 v[180:183], v[44:47], v[52:55], v[180:183]
    s_bitcmp1_b32 s0, 4
    s_cselect_b32 s87, s85, 128
    s_cselect_b32 s88, s86, 221184
    v_mfma_f32_16x16x32_bf16 v[184:187], v[44:47], v[56:59], v[184:187]
    s_add_u32 s60, s60, s87
    v_mfma_f32_16x16x32_bf16 v[188:191], v[44:47], v[60:63], v[188:191]
    s_add_u32 s61, s61, s88
    s_waitcnt vmcnt(12) lgkmcnt(0)
    s_barrier
    v_mfma_f32_16x16x32_bf16 v[128:131], v[64:67], v[80:83], v[128:131]
    ds_read_b128 v[48:51], v12 offset:32768
    s_add_u32 m0, s62, 32768
    v_mfma_f32_16x16x32_bf16 v[132:135], v[64:67], v[84:87], v[132:135]
    ds_read_b64_tr_b16 v[32:33], v6 offset:49152
    s_lshl_b32 s73, s70, 5
    v_mfma_f32_16x16x32_bf16 v[136:139], v[64:67], v[88:91], v[136:139]
    ds_read_b64_tr_b16 v[34:35], v6 offset:50176
    buffer_load_dwordx4 v240, s[32:35], s60 offen offset:0 lds
    v_mfma_f32_16x16x32_bf16 v[140:143], v[64:67], v[92:95], v[140:143]
    ds_read_b128 v[52:55], v12 offset:34816
    v_mfma_f32_16x16x32_bf16 v[192:195], v[64:67], v[20:23], v[192:195]
    ds_read_b64_tr_b16 v[36:37], v7 offset:49152
    v_mfma_f32_16x16x32_bf16 v[144:147], v[68:71], v[80:83], v[144:147]
    ds_read_b64_tr_b16 v[38:39], v7 offset:50176
    v_lshl_add_u32 v233, v24, 3, s73
    v_mfma_f32_16x16x32_bf16 v[148:151], v[68:71], v[84:87], v[148:151]
    ds_read_b128 v[56:59], v12 offset:36864
    buffer_load_dwordx4 v241, s[32:35], s60 offen offset:1024 lds
    v_mfma_f32_16x16x32_bf16 v[152:155], v[68:71], v[88:91], v[152:155]
    ds_read_b64_tr_b16 v[40:41], v8 offset:49152
    v_mfma_f32_16x16x32_bf16 v[156:159], v[68:71], v[92:95], v[156:159]
    ds_read_b64_tr_b16 v[42:43], v8 offset:50176
    v_mfma_f32_16x16x32_bf16 v[196:199], v[68:71], v[20:23], v[196:199]
    ds_read_b128 v[60:63], v12 offset:38912
    s_lshl_b32 s73, s71, 5
    v_mfma_f32_16x16x32_bf16 v[160:163], v[72:75], v[80:83], v[160:163]
    ds_read_b64_tr_b16 v[44:45], v9 offset:49152
    v_mfma_f32_16x16x32_bf16 v[164:167], v[72:75], v[84:87], v[164:167]
    ds_read_b64_tr_b16 v[46:47], v9 offset:50176
    buffer_load_dwordx4 v242, s[32:35], s60 offen offset:2048 lds
    v_mfma_f32_16x16x32_bf16 v[168:171], v[72:75], v[88:91], v[168:171]
    v_lshl_add_u32 v234, v24, 3, s73
    v_mfma_f32_16x16x32_bf16 v[172:175], v[72:75], v[92:95], v[172:175]
    v_mfma_f32_16x16x32_bf16 v[176:179], v[76:79], v[80:83], v[176:179]
    s_lshl_b32 s73, s72, 5
    v_mfma_f32_16x16x32_bf16 v[180:183], v[76:79], v[84:87], v[180:183]
    buffer_load_dwordx4 v243, s[32:35], s60 offen offset:3072 lds
    v_mfma_f32_16x16x32_bf16 v[184:187], v[76:79], v[88:91], v[184:187]
    v_lshl_add_u32 v235, v24, 3, s73
    v_mfma_f32_16x16x32_bf16 v[188:191], v[76:79], v[92:95], v[188:191]
    s_waitcnt lgkmcnt(0)
    v_mfma_f32_16x16x32_bf16 v[128:131], v[32:35], v[48:51], v[128:131]
    ds_read_b128 v[80:83], v13 offset:32768
    s_add_u32 m0, s62, 49152
    v_mfma_f32_16x16x32_bf16 v[132:135], v[32:35], v[52:55], v[132:135]
    ds_read_b64_tr_b16 v[64:65], v6 offset:57344
    s_lshr_b32 s78, s57, 1
    v_mfma_f32_16x16x32_bf16 v[136:139], v[32:35], v[56:59], v[136:139]
    ds_read_b64_tr_b16 v[66:67], v6 offset:58368
    buffer_load_dwordx4 v244, s[40:43], s61 offen offset:0 lds
    v_mfma_f32_16x16x32_bf16 v[140:143], v[32:35], v[60:63], v[140:143]
    ds_read_b128 v[84:87], v13 offset:34816
    v_mfma_f32_16x16x32_bf16 v[192:195], v[32:35], v[20:23], v[192:195]
    ds_read_b64_tr_b16 v[68:69], v7 offset:57344
    s_lshl_b32 s78, s78, 3
    s_nop 0
    v_mfma_f32_16x16x32_bf16 v[144:147], v[36:39], v[48:51], v[144:147]
    ds_read_b64_tr_b16 v[70:71], v7 offset:58368
    v_mfma_f32_16x16x32_bf16 v[148:151], v[36:39], v[52:55], v[148:151]
    ds_read_b128 v[88:91], v13 offset:36864
    buffer_load_dwordx4 v245, s[40:43], s61 offen offset:1024 lds
    v_mfma_f32_16x16x32_bf16 v[152:155], v[36:39], v[56:59], v[152:155]
    ds_read_b64_tr_b16 v[72:73], v8 offset:57344
    v_mfma_f32_16x16x32_bf16 v[156:159], v[36:39], v[60:63], v[156:159]
    ds_read_b64_tr_b16 v[74:75], v8 offset:58368
    s_and_b32 s79, s58, 7
    v_mfma_f32_16x16x32_bf16 v[196:199], v[36:39], v[20:23], v[196:199]
    ds_read_b128 v[92:95], v13 offset:38912
    v_mfma_f32_16x16x32_bf16 v[160:163], v[40:43], v[48:51], v[160:163]
    ds_read_b64_tr_b16 v[76:77], v9 offset:57344
    buffer_load_dwordx4 v246, s[40:43], s61 offen offset:2048 lds
    v_mfma_f32_16x16x32_bf16 v[164:167], v[40:43], v[52:55], v[164:167]
    ds_read_b64_tr_b16 v[78:79], v9 offset:58368
    s_add_u32 s53, s78, s79
    v_mfma_f32_16x16x32_bf16 v[168:171], v[40:43], v[56:59], v[168:171]
    v_mfma_f32_16x16x32_bf16 v[172:175], v[40:43], v[60:63], v[172:175]
    buffer_load_dwordx4 v247, s[40:43], s61 offen offset:3072 lds
    s_mul_i32 s28, s79, 7
    v_mfma_f32_16x16x32_bf16 v[176:179], v[44:47], v[48:51], v[176:179]
    s_and_b32 s78, s57, 1
    v_mfma_f32_16x16x32_bf16 v[180:183], v[44:47], v[52:55], v[180:183]
    s_bitcmp1_b32 s0, 5
    s_cselect_b32 s87, s85, 128
    s_cselect_b32 s88, s86, 221184
    v_mfma_f32_16x16x32_bf16 v[184:187], v[44:47], v[56:59], v[184:187]
    s_add_u32 s60, s60, s87
    v_mfma_f32_16x16x32_bf16 v[188:191], v[44:47], v[60:63], v[188:191]
    s_add_u32 s61, s61, s88
    s_waitcnt vmcnt(8) lgkmcnt(0)
    s_barrier
    v_mfma_f32_16x16x32_bf16 v[128:131], v[64:67], v[80:83], v[128:131]
    ds_read_b128 v[48:51], v10 offset:0
    s_add_u32 m0, s62, 65536
    v_mfma_f32_16x16x32_bf16 v[132:135], v[64:67], v[84:87], v[132:135]
    ds_read_b64_tr_b16 v[32:33], v2 offset:16384
    s_lshl_b32 s78, s78, 2
    v_mfma_f32_16x16x32_bf16 v[136:139], v[64:67], v[88:91], v[136:139]
    ds_read_b64_tr_b16 v[34:35], v2 offset:17408
    buffer_load_dwordx4 v240, s[32:35], s60 offen offset:0 lds
    v_mfma_f32_16x16x32_bf16 v[140:143], v[64:67], v[92:95], v[140:143]
    ds_read_b128 v[52:55], v10 offset:2048
    v_mfma_f32_16x16x32_bf16 v[192:195], v[64:67], v[20:23], v[192:195]
    ds_read_b64_tr_b16 v[36:37], v3 offset:16384
    s_lshr_b32 s79, s58, 3
    v_mfma_f32_16x16x32_bf16 v[144:147], v[68:71], v[80:83], v[144:147]
    ds_read_b64_tr_b16 v[38:39], v3 offset:17408
    v_mfma_f32_16x16x32_bf16 v[148:151], v[68:71], v[84:87], v[148:151]
    ds_read_b128 v[56:59], v10 offset:4096
    buffer_load_dwordx4 v241, s[32:35], s60 offen offset:1024 lds
    v_mfma_f32_16x16x32_bf16 v[152:155], v[68:71], v[88:91], v[152:155]
    ds_read_b64_tr_b16 v[40:41], v4 offset:16384
    s_add_u32 s54, s78, s79
    v_mfma_f32_16x16x32_bf16 v[156:159], v[68:71], v[92:95], v[156:159]
    ds_read_b64_tr_b16 v[42:43], v4 offset:17408
    v_mfma_f32_16x16x32_bf16 v[196:199], v[68:71], v[20:23], v[196:199]
    ds_read_b128 v[60:63], v10 offset:6144
    s_mul_i32 s79, s79, 14
    v_mfma_f32_16x16x32_bf16 v[160:163], v[72:75], v[80:83], v[160:163]
    ds_read_b64_tr_b16 v[44:45], v5 offset:16384
    v_mfma_f32_16x16x32_bf16 v[164:167], v[72:75], v[84:87], v[164:167]
    ds_read_b64_tr_b16 v[46:47], v5 offset:17408
    buffer_load_dwordx4 v242, s[32:35], s60 offen offset:2048 lds
    v_mfma_f32_16x16x32_bf16 v[168:171], v[72:75], v[88:91], v[168:171]
    ds_read_b64_tr_b16 v[216:217], v200 offset:0
    s_add_u32 s28, s28, s79
    v_mfma_f32_16x16x32_bf16 v[172:175], v[72:75], v[92:95], v[172:175]
    ds_read_b64_tr_b16 v[218:219], v200 offset:2560
    v_mfma_f32_16x16x32_bf16 v[176:179], v[76:79], v[80:83], v[176:179]
    ds_read_b64_tr_b16 v[220:221], v201 offset:0
    s_lshr_b32 s28, s28, 2
    v_mfma_f32_16x16x32_bf16 v[180:183], v[76:79], v[84:87], v[180:183]
    ds_read_b64_tr_b16 v[222:223], v201 offset:2560
    buffer_load_dwordx4 v243, s[32:35], s60 offen offset:3072 lds
    v_mfma_f32_16x16x32_bf16 v[184:187], v[76:79], v[88:91], v[184:187]
    ds_read_b64_tr_b16 v[224:225], v202 offset:0
    v_mfma_f32_16x16x32_bf16 v[188:191], v[76:79], v[92:95], v[188:191]
    ds_read_b64_tr_b16 v[226:227], v202 offset:2560
    s_waitcnt lgkmcnt(0)
    v_mfma_f32_16x16x32_bf16 v[128:131], v[32:35], v[48:51], v[128:131]
    ds_read_b128 v[80:83], v11 offset:0
    buffer_store_dwordx4 v[216:219], v14, s[36:39], s74 offen sc1
    v_mfma_f32_16x16x32_bf16 v[132:135], v[32:35], v[52:55], v[132:135]
    ds_read_b64_tr_b16 v[64:65], v2 offset:24576
    buffer_store_dwordx4 v[220:223], v14, s[36:39], s75 offen sc1
    v_mfma_f32_16x16x32_bf16 v[136:139], v[32:35], v[56:59], v[136:139]
    ds_read_b64_tr_b16 v[66:67], v2 offset:25600
    buffer_store_dwordx4 v[224:227], v14, s[36:39], s76 offen sc1
    v_mfma_f32_16x16x32_bf16 v[140:143], v[32:35], v[60:63], v[140:143]
    ds_read_b128 v[84:87], v11 offset:2048
    s_cmp_ge_u32 s28, 14
    s_cselect_b32 s79, 14, 0
    v_mfma_f32_16x16x32_bf16 v[192:195], v[32:35], v[20:23], v[192:195]
    ds_read_b64_tr_b16 v[68:69], v3 offset:24576
    v_mfma_f32_16x16x32_bf16 v[144:147], v[36:39], v[48:51], v[144:147]
    ds_read_b64_tr_b16 v[70:71], v3 offset:25600
    s_add_u32 m0, s62, 81920
    v_mfma_f32_16x16x32_bf16 v[148:151], v[36:39], v[52:55], v[148:151]
    ds_read_b128 v[88:91], v11 offset:4096
    s_sub_u32 s28, s28, s79
    v_mfma_f32_16x16x32_bf16 v[152:155], v[36:39], v[56:59], v[152:155]
    ds_read_b64_tr_b16 v[72:73], v4 offset:24576
    buffer_load_dwordx4 v244, s[40:43], s61 offen offset:0 lds
    v_mfma_f32_16x16x32_bf16 v[156:159], v[36:39], v[60:63], v[156:159]
    ds_read_b64_tr_b16 v[74:75], v4 offset:25600
    v_mfma_f32_16x16x32_bf16 v[196:199], v[36:39], v[20:23], v[196:199]
    ds_read_b128 v[92:95], v11 offset:6144
    s_mov_b32 s28, 0
    v_mfma_f32_16x16x32_bf16 v[160:163], v[40:43], v[48:51], v[160:163]
    ds_read_b64_tr_b16 v[76:77], v5 offset:24576
    buffer_load_dwordx4 v245, s[40:43], s61 offen offset:1024 lds
    v_mfma_f32_16x16x32_bf16 v[164:167], v[40:43], v[52:55], v[164:167]
    ds_read_b64_tr_b16 v[78:79], v5 offset:25600
    s_mul_i32 s55, s3, 14
    v_mfma_f32_16x16x32_bf16 v[168:171], v[40:43], v[56:59], v[168:171]
    s_sub_u32 s79, s3, 1
    v_mfma_f32_16x16x32_bf16 v[172:175], v[40:43], v[60:63], v[172:175]
    buffer_load_dwordx4 v246, s[40:43], s61 offen offset:2048 lds
    s_cmp_ge_u32 s3, 2
    s_cselect_b32 s79, s79, 0
    v_mfma_f32_16x16x32_bf16 v[176:179], v[44:47], v[48:51], v[176:179]
    v_mfma_f32_16x16x32_bf16 v[180:183], v[44:47], v[52:55], v[180:183]
    buffer_load_dwordx4 v247, s[40:43], s61 offen offset:3072 lds
    s_bitcmp1_b32 s0, 6
    s_cselect_b32 s87, s85, 128
    s_cselect_b32 s88, s86, 221184
    v_mfma_f32_16x16x32_bf16 v[184:187], v[44:47], v[56:59], v[184:187]
    s_add_u32 s60, s60, s87
    s_sub_u32 s55, s55, s79
    v_mfma_f32_16x16x32_bf16 v[188:191], v[44:47], v[60:63], v[188:191]
    s_add_u32 s61, s61, s88
    s_waitcnt vmcnt(11) lgkmcnt(0)
    s_barrier
    v_mfma_f32_16x16x32_bf16 v[128:131], v[64:67], v[80:83], v[128:131]
    ds_read_b128 v[48:51], v10 offset:32768
    s_add_u32 m0, s62, 98304
    v_mfma_f32_16x16x32_bf16 v[132:135], v[64:67], v[84:87], v[132:135]
    ds_read_b64_tr_b16 v[32:33], v2 offset:49152
    s_mul_i32 s79, s54, 54
    s_nop 0
    v_mfma_f32_16x16x32_bf16 v[136:139], v[64:67], v[88:91], v[136:139]
    ds_read_b64_tr_b16 v[34:35], v2 offset:50176
    buffer_load_dwordx4 v240, s[32:35], s60 offen offset:0 lds
    v_mfma_f32_16x16x32_bf16 v[140:143], v[64:67], v[92:95], v[140:143]
    ds_read_b128 v[52:55], v10 offset:34816
    v_mfma_f32_16x16x32_bf16 v[192:195], v[64:67], v[20:23], v[192:195]
    ds_read_b64_tr_b16 v[36:37], v3 offset:49152
    v_mfma_f32_16x16x32_bf16 v[144:147], v[68:71], v[80:83], v[144:147]
    ds_read_b64_tr_b16 v[38:39], v3 offset:50176
    s_add_u32 s79, s79, s55
    s_nop 0
    v_mfma_f32_16x16x32_bf16 v[148:151], v[68:71], v[84:87], v[148:151]
    ds_read_b128 v[56:59], v10 offset:36864
    buffer_load_dwordx4 v241, s[32:35], s60 offen offset:1024 lds
    v_mfma_f32_16x16x32_bf16 v[152:155], v[68:71], v[88:91], v[152:155]
    ds_read_b64_tr_b16 v[40:41], v4 offset:49152
    v_mfma_f32_16x16x32_bf16 v[156:159], v[68:71], v[92:95], v[156:159]
    ds_read_b64_tr_b16 v[42:43], v4 offset:50176
    v_mfma_f32_16x16x32_bf16 v[196:199], v[68:71], v[20:23], v[196:199]
    ds_read_b128 v[60:63], v10 offset:38912
    s_mul_i32 s79, s79, 5120
    v_mfma_f32_16x16x32_bf16 v[160:163], v[72:75], v[80:83], v[160:163]
    ds_read_b64_tr_b16 v[44:45], v5 offset:49152
    v_mfma_f32_16x16x32_bf16 v[164:167], v[72:75], v[84:87], v[164:167]
    ds_read_b64_tr_b16 v[46:47], v5 offset:50176
    buffer_load_dwordx4 v242, s[32:35], s60 offen offset:2048 lds
    v_mfma_f32_16x16x32_bf16 v[168:171], v[72:75], v[88:91], v[168:171]
    s_add_u32 s79, s79, 4194304
    v_mfma_f32_16x16x32_bf16 v[172:175], v[72:75], v[92:95], v[172:175]
    v_mfma_f32_16x16x32_bf16 v[176:179], v[76:79], v[80:83], v[176:179]
    s_add_u32 s16, s79, 71680
    v_mfma_f32_16x16x32_bf16 v[180:183], v[76:79], v[84:87], v[180:183]
    buffer_load_dwordx4 v243, s[32:35], s60 offen offset:3072 lds
    v_mfma_f32_16x16x32_bf16 v[184:187], v[76:79], v[88:91], v[184:187]
    s_mul_i32 s52, s28, 5120
    v_mfma_f32_16x16x32_bf16 v[188:191], v[76:79], v[92:95], v[188:191]
    s_waitcnt lgkmcnt(0)
    v_mfma_f32_16x16x32_bf16 v[128:131], v[32:35], v[48:51], v[128:131]
    ds_read_b128 v[80:83], v11 offset:32768
    s_add_u32 m0, s62, 114688
    s_add_u32 s52, s52, s79
    v_mfma_f32_16x16x32_bf16 v[132:135], v[32:35], v[52:55], v[132:135]
    ds_read_b64_tr_b16 v[64:65], v2 offset:57344
    v_lshlrev_b32_e64 v14, 4, v0
    v_mfma_f32_16x16x32_bf16 v[136:139], v[32:35], v[56:59], v[136:139]
    ds_read_b64_tr_b16 v[66:67], v2 offset:58368
    buffer_load_dwordx4 v244, s[40:43], s61 offen offset:0 lds
    v_add_u32 v15, 4096, v14
PAGE2:
    s_cbranch_execz VISIT_RET
    v_mfma_f32_16x16x32_bf16 v[140:143], v[32:35], v[60:63], v[140:143]
    ds_read_b128 v[84:87], v11 offset:34816
    s_mul_i32 s84, s57, 56
    v_mfma_f32_16x16x32_bf16 v[192:195], v[32:35], v[20:23], v[192:195]
    ds_read_b64_tr_b16 v[68:69], v3 offset:57344
    s_lshl_b32 s78, s58, 1
    v_mfma_f32_16x16x32_bf16 v[144:147], v[36:39], v[48:51], v[144:147]
    ds_read_b64_tr_b16 v[70:71], v3 offset:58368
    s_add_u32 s84, s84, s78
    v_mfma_f32_16x16x32_bf16 v[148:151], v[36:39], v[52:55], v[148:151]
    ds_read_b128 v[88:91], v11 offset:36864
    buffer_load_dwordx4 v245, s[40:43], s61 offen offset:1024 lds
    s_mul_i32 s1, s57, 28
    v_mfma_f32_16x16x32_bf16 v[152:155], v[36:39], v[56:59], v[152:155]
    ds_read_b64_tr_b16 v[72:73], v4 offset:57344
    s_add_u32 s1, s1, s58
    v_mfma_f32_16x16x32_bf16 v[156:159], v[36:39], v[60:63], v[156:159]
    ds_read_b64_tr_b16 v[74:75], v4 offset:58368
    s_lshl_b32 s1, s1, 2
    v_mfma_f32_16x16x32_bf16 v[196:199], v[36:39], v[20:23], v[196:199]
    ds_read_b128 v[92:95], v11 offset:38912
    s_add_u32 s1, s1, s3
    v_mfma_f32_16x16x32_bf16 v[160:163], v[40:43], v[48:51], v[160:163]
    ds_read_b64_tr_b16 v[76:77], v5 offset:57344
    buffer_load_dwordx4 v246, s[40:43], s61 offen offset:2048 lds
    s_lshl_b32 s1, s1, 11
    v_mfma_f32_16x16x32_bf16 v[164:167], v[40:43], v[52:55], v[164:167]
    ds_read_b64_tr_b16 v[78:79], v5 offset:58368
    s_mov_b32 s80, s12
    v_mfma_f32_16x16x32_bf16 v[168:171], v[40:43], v[56:59], v[168:171]
    s_mov_b32 s81, s13
    s_mov_b32 s82, 2621440
    v_mfma_f32_16x16x32_bf16 v[172:175], v[40:43], v[60:63], v[172:175]
    buffer_load_dwordx4 v247, s[40:43], s61 offen offset:3072 lds
    s_mov_b32 s83, 0x20000
    v_mfma_f32_16x16x32_bf16 v[176:179], v[44:47], v[48:51], v[176:179]
    v_min_u32 v127, 15, v0
    v_mfma_f32_16x16x32_bf16 v[180:183], v[44:47], v[52:55], v[180:183]
    s_bitcmp1_b32 s0, 7
    s_cselect_b32 s87, s85, 128
    s_cselect_b32 s88, s86, 221184
    v_mfma_f32_16x16x32_bf16 v[184:187], v[44:47], v[56:59], v[184:187]
    s_add_u32 s60, s60, s87
    v_lshlrev_b32 v127, 7, v127
    v_mfma_f32_16x16x32_bf16 v[188:191], v[44:47], v[60:63], v[188:191]
    s_add_u32 s61, s61, s88
    buffer_load_dword v127, v127, s[80:83], s1 offen
    s_waitcnt vmcnt(9) lgkmcnt(0)
    s_barrier
    s_mov_b32 exec_lo, 4
    s_mov_b32 exec_hi, 0
    buffer_store_dword v31, v30, s[36:39], 0 offen sc1
    s_mov_b64 exec, -1
    v_mfma_f32_16x16x32_bf16 v[128:131], v[64:67], v[80:83], v[128:131]
    ds_read_b128 v[48:51], v12 offset:0
    s_add_u32 m0, s62, 0
    v_mfma_f32_16x16x32_bf16 v[132:135], v[64:67], v[84:87], v[132:135]
    ds_read_b64_tr_b16 v[32:33], v6 offset:16384
    s_lshr_b32 s77, s84, 6
    s_nop 0
    v_mfma_f32_16x16x32_bf16 v[136:139], v[64:67], v[88:91], v[136:139]
    ds_read_b64_tr_b16 v[34:35], v6 offset:17408
    buffer_load_dwordx4 v240, s[32:35], s60 offen offset:0 lds
    v_mfma_f32_16x16x32_bf16 v[140:143], v[64:67], v[92:95], v[140:143]
    ds_read_b128 v[52:55], v12 offset:2048
    v_mfma_f32_16x16x32_bf16 v[192:195], v[64:67], v[20:23], v[192:195]
    ds_read_b64_tr_b16 v[36:37], v7 offset:16384
    v_mfma_f32_16x16x32_bf16 v[144:147], v[68:71], v[80:83], v[144:147]
    ds_read_b64_tr_b16 v[38:39], v7 offset:17408
    v_and_b32_e64 v27, 31, v0
    v_mfma_f32_16x16x32_bf16 v[148:151], v[68:71], v[84:87], v[148:151]
    ds_read_b128 v[56:59], v12 offset:4096
    buffer_load_dwordx4 v241, s[32:35], s60 offen offset:1024 lds
    v_mfma_f32_16x16x32_bf16 v[152:155], v[68:71], v[88:91], v[152:155]
    ds_read_b64_tr_b16 v[40:41], v8 offset:16384
    v_mfma_f32_16x16x32_bf16 v[156:159], v[68:71], v[92:95], v[156:159]
    ds_read_b64_tr_b16 v[42:43], v8 offset:17408
    v_mfma_f32_16x16x32_bf16 v[196:199], v[68:71], v[20:23], v[196:199]
    ds_read_b128 v[60:63], v12 offset:6144
    v_lshlrev_b32_e64 v27, 6, v27
    v_mfma_f32_16x16x32_bf16 v[160:163], v[72:75], v[80:83], v[160:163]
    ds_read_b64_tr_b16 v[44:45], v9 offset:16384
    v_mfma_f32_16x16x32_bf16 v[164:167], v[72:75], v[84:87], v[164:167]
    ds_read_b64_tr_b16 v[46:47], v9 offset:17408
    buffer_load_dwordx4 v242, s[32:35], s60 offen offset:2048 lds
    v_mfma_f32_16x16x32_bf16 v[168:171], v[72:75], v[88:91], v[168:171]
    s_lshl_b32 s73, s77, 11
    v_mfma_f32_16x16x32_bf16 v[172:175], v[72:75], v[92:95], v[172:175]
    v_mfma_f32_16x16x32_bf16 v[176:179], v[76:79], v[80:83], v[176:179]
    s_add_u32 s73, s73, 131072
    v_mfma_f32_16x16x32_bf16 v[180:183], v[76:79], v[84:87], v[180:183]
    buffer_load_dwordx4 v243, s[32:35], s60 offen offset:3072 lds
    v_mfma_f32_16x16x32_bf16 v[184:187], v[76:79], v[88:91], v[184:187]
    s_lshl_b32 s78, s54, 11
    v_mfma_f32_16x16x32_bf16 v[188:191], v[76:79], v[92:95], v[188:191]
    s_waitcnt lgkmcnt(0)
    s_nop 0
    v_mfma_f32_16x16x32_bf16 v[128:131], v[32:35], v[48:51], v[128:131]
    ds_read_b128 v[80:83], v13 offset:0
    s_add_u32 m0, s62, 16384
    v_mfma_f32_16x16x32_bf16 v[132:135], v[32:35], v[52:55], v[132:135]
    ds_read_b64_tr_b16 v[64:65], v6 offset:24576
    s_add_u32 s78, s78, 163840
    v_mfma_f32_16x16x32_bf16 v[136:139], v[32:35], v[56:59], v[136:139]
    ds_read_b64_tr_b16 v[66:67], v6 offset:25600
    buffer_load_dwordx4 v244, s[40:43], s61 offen offset:0 lds
    v_mfma_f32_16x16x32_bf16 v[140:143], v[32:35], v[60:63], v[140:143]
    ds_read_b128 v[84:87], v13 offset:2048
    v_mfma_f32_16x16x32_bf16 v[192:195], v[32:35], v[20:23], v[192:195]
    ds_read_b64_tr_b16 v[68:69], v7 offset:24576
    v_mov_b32_e64 v16, s73
    v_mfma_f32_16x16x32_bf16 v[144:147], v[36:39], v[48:51], v[144:147]
    ds_read_b64_tr_b16 v[70:71], v7 offset:25600
    v_mfma_f32_16x16x32_bf16 v[148:151], v[36:39], v[52:55], v[148:151]
    ds_read_b128 v[88:91], v13 offset:4096
    buffer_load_dwordx4 v245, s[40:43], s61 offen offset:1024 lds
    v_mfma_f32_16x16x32_bf16 v[152:155], v[36:39], v[56:59], v[152:155]
    ds_read_b64_tr_b16 v[72:73], v8 offset:24576
    v_mfma_f32_16x16x32_bf16 v[156:159], v[36:39], v[60:63], v[156:159]
    ds_read_b64_tr_b16 v[74:75], v8 offset:25600
    v_mov_b32_e64 v18, s78
    v_mfma_f32_16x16x32_bf16 v[196:199], v[36:39], v[20:23], v[196:199]
    ds_read_b128 v[92:95], v13 offset:6144
    v_mfma_f32_16x16x32_bf16 v[160:163], v[40:43], v[48:51], v[160:163]
    ds_read_b64_tr_b16 v[76:77], v9 offset:24576
    buffer_load_dwordx4 v246, s[40:43], s61 offen offset:2048 lds
    v_mfma_f32_16x16x32_bf16 v[164:167], v[40:43], v[52:55], v[164:167]
    ds_read_b64_tr_b16 v[78:79], v9 offset:25600
    v_and_b32 v19, 32, v0
    v_mfma_f32_16x16x32_bf16 v[168:171], v[40:43], v[56:59], v[168:171]
    v_mfma_f32_16x16x32_bf16 v[172:175], v[40:43], v[60:63], v[172:175]
    buffer_load_dwordx4 v247, s[40:43], s61 offen offset:3072 lds
    v_cmp_eq_u32 vcc, 0, v19
    v_mfma_f32_16x16x32_bf16 v[176:179], v[44:47], v[48:51], v[176:179]
    s_nop 1
    v_mfma_f32_16x16x32_bf16 v[180:183], v[44:47], v[52:55], v[180:183]
    s_bitcmp1_b32 s0, 8
    s_cselect_b32 s87, s85, 128
    s_cselect_b32 s88, s86, 221184
    v_mfma_f32_16x16x32_bf16 v[184:187], v[44:47], v[56:59], v[184:187]
    s_add_u32 s60, s60, s87
    v_mfma_f32_16x16x32_bf16 v[188:191], v[44:47], v[60:63], v[188:191]
    s_add_u32 s61, s61, s88
    s_waitcnt vmcnt(10) lgkmcnt(0)
    s_barrier
    buffer_load_dword v29, v28, s[36:39], 0 offen sc1
    v_mfma_f32_16x16x32_bf16 v[128:131], v[64:67], v[80:83], v[128:131]
    ds_read_b128 v[48:51], v12 offset:32768
    s_add_u32 m0, s62, 32768
    v_mfma_f32_16x16x32_bf16 v[132:135], v[64:67], v[84:87], v[132:135]
    ds_read_b64_tr_b16 v[32:33], v6 offset:49152
    v_cndmask_b32_e64 v16, v18, v16, vcc
    v_mfma_f32_16x16x32_bf16 v[136:139], v[64:67], v[88:91], v[136:139]
    ds_read_b64_tr_b16 v[34:35], v6 offset:50176
    buffer_load_dwordx4 v240, s[32:35], s60 offen offset:0 lds
    v_mfma_f32_16x16x32_bf16 v[140:143], v[64:67], v[92:95], v[140:143]
    ds_read_b128 v[52:55], v12 offset:34816
    v_mfma_f32_16x16x32_bf16 v[192:195], v[64:67], v[20:23], v[192:195]
    ds_read_b64_tr_b16 v[36:37], v7 offset:49152
    v_mfma_f32_16x16x32_bf16 v[144:147], v[68:71], v[80:83], v[144:147]
    ds_read_b64_tr_b16 v[38:39], v7 offset:50176
    v_add_u32_e64 v27, v16, v27
    v_mfma_f32_16x16x32_bf16 v[148:151], v[68:71], v[84:87], v[148:151]
    ds_read_b128 v[56:59], v12 offset:36864
    buffer_load_dwordx4 v241, s[32:35], s60 offen offset:1024 lds
    v_mfma_f32_16x16x32_bf16 v[152:155], v[68:71], v[88:91], v[152:155]
    ds_read_b64_tr_b16 v[40:41], v8 offset:49152
    v_mfma_f32_16x16x32_bf16 v[156:159], v[68:71], v[92:95], v[156:159]
    ds_read_b64_tr_b16 v[42:43], v8 offset:50176
    v_mfma_f32_16x16x32_bf16 v[196:199], v[68:71], v[20:23], v[196:199]
    ds_read_b128 v[60:63], v12 offset:38912
    s_lshr_b32 s78, s3, 1
    v_mfma_f32_16x16x32_bf16 v[160:163], v[72:75], v[80:83], v[160:163]
    ds_read_b64_tr_b16 v[44:45], v9 offset:49152
    v_mfma_f32_16x16x32_bf16 v[164:167], v[72:75], v[84:87], v[164:167]
    ds_read_b64_tr_b16 v[46:47], v9 offset:50176
    buffer_load_dwordx4 v242, s[32:35], s60 offen offset:2048 lds
    v_mfma_f32_16x16x32_bf16 v[168:171], v[72:75], v[88:91], v[168:171]
    s_add_u32 s84, s84, s78
    v_mfma_f32_16x16x32_bf16 v[172:175], v[72:75], v[92:95], v[172:175]
    v_mfma_f32_16x16x32_bf16 v[176:179], v[76:79], v[80:83], v[176:179]
    s_and_b32 s87, s3, 1
    v_mfma_f32_16x16x32_bf16 v[180:183], v[76:79], v[84:87], v[180:183]
    buffer_load_dwordx4 v243, s[32:35], s60 offen offset:3072 lds
    v_mfma_f32_16x16x32_bf16 v[184:187], v[76:79], v[88:91], v[184:187]
    s_mul_i32 s86, s78, 21248
    v_mfma_f32_16x16x32_bf16 v[188:191], v[76:79], v[92:95], v[188:191]
    s_waitcnt lgkmcnt(0)
    v_mfma_f32_16x16x32_bf16 v[128:131], v[32:35], v[48:51], v[128:131]
    ds_read_b128 v[80:83], v13 offset:32768
    s_add_u32 m0, s62, 49152
    v_mfma_f32_16x16x32_bf16 v[132:135], v[32:35], v[52:55], v[132:135]
    ds_read_b64_tr_b16 v[64:65], v6 offset:57344
    s_lshl_b32 s85, s84, 12
    v_mfma_f32_16x16x32_bf16 v[136:139], v[32:35], v[56:59], v[136:139]
    ds_read_b64_tr_b16 v[66:67], v6 offset:58368
    buffer_load_dwordx4 v244, s[40:43], s61 offen offset:0 lds
    v_mfma_f32_16x16x32_bf16 v[140:143], v[32:35], v[60:63], v[140:143]
    ds_read_b128 v[84:87], v13 offset:34816
    v_mfma_f32_16x16x32_bf16 v[192:195], v[32:35], v[20:23], v[192:195]
    ds_read_b64_tr_b16 v[68:69], v7 offset:57344
    s_add_u32 s44, s12, s85
    s_addc_u32 s45, s13, 0
    s_nop 0
    v_mfma_f32_16x16x32_bf16 v[144:147], v[36:39], v[48:51], v[144:147]
    ds_read_b64_tr_b16 v[70:71], v7 offset:58368
    v_mfma_f32_16x16x32_bf16 v[148:151], v[36:39], v[52:55], v[148:151]
    ds_read_b128 v[88:91], v13 offset:36864
    buffer_load_dwordx4 v245, s[40:43], s61 offen offset:1024 lds
    v_mfma_f32_16x16x32_bf16 v[152:155], v[36:39], v[56:59], v[152:155]
    ds_read_b64_tr_b16 v[72:73], v8 offset:57344
    v_mfma_f32_16x16x32_bf16 v[156:159], v[36:39], v[60:63], v[156:159]
    ds_read_b64_tr_b16 v[74:75], v8 offset:58368
    v_mfma_f32_16x16x32_bf16 v[196:199], v[36:39], v[20:23], v[196:199]
    ds_read_b128 v[92:95], v13 offset:38912
    v_mfma_f32_16x16x32_bf16 v[160:163], v[40:43], v[48:51], v[160:163]
    ds_read_b64_tr_b16 v[76:77], v9 offset:57344
    s_mov_b32 s46, 4096
    v_mfma_f32_16x16x32_bf16 v[164:167], v[40:43], v[52:55], v[164:167]
    ds_read_b64_tr_b16 v[78:79], v9 offset:58368
    buffer_load_dwordx4 v246, s[40:43], s61 offen offset:2048 lds
    v_mfma_f32_16x16x32_bf16 v[168:171], v[40:43], v[56:59], v[168:171]
    s_mov_b32 s47, 0x20000
    v_mfma_f32_16x16x32_bf16 v[172:175], v[40:43], v[60:63], v[172:175]
    s_lshl_b32 s89, s87, 11
    v_mfma_f32_16x16x32_bf16 v[176:179], v[44:47], v[48:51], v[176:179]
    v_mfma_f32_16x16x32_bf16 v[180:183], v[44:47], v[52:55], v[180:183]
    buffer_load_dwordx4 v247, s[40:43], s61 offen offset:3072 lds
    s_add_u32 s88, s85, s89
    v_mfma_f32_16x16x32_bf16 v[184:187], v[44:47], v[56:59], v[184:187]
    s_add_u32 s88, s88, 1048576
    v_mfma_f32_16x16x32_bf16 v[188:191], v[44:47], v[60:63], v[188:191]
    s_waitcnt vmcnt(9) lgkmcnt(0)
    s_barrier
    v_mfma_f32_16x16x32_bf16 v[128:131], v[64:67], v[80:83], v[128:131]
    ds_read_b128 v[48:51], v10 offset:0
    buffer_load_dwordx2 v[208:209], v232, s[48:51], 0 offen
    v_mfma_f32_16x16x32_bf16 v[132:135], v[64:67], v[84:87], v[132:135]
    ds_read_b64_tr_b16 v[32:33], v2 offset:16384
    v_mfma_f32_16x16x32_bf16 v[136:139], v[64:67], v[88:91], v[136:139]
    ds_read_b64_tr_b16 v[34:35], v2 offset:17408
    v_mfma_f32_16x16x32_bf16 v[140:143], v[64:67], v[92:95], v[140:143]
    ds_read_b128 v[52:55], v10 offset:2048
    v_mfma_f32_16x16x32_bf16 v[192:195], v[64:67], v[20:23], v[192:195]
    ds_read_b64_tr_b16 v[36:37], v3 offset:16384
    v_mfma_f32_16x16x32_bf16 v[144:147], v[68:71], v[80:83], v[144:147]
    ds_read_b64_tr_b16 v[38:39], v3 offset:17408
    v_mfma_f32_16x16x32_bf16 v[148:151], v[68:71], v[84:87], v[148:151]
    ds_read_b128 v[56:59], v10 offset:4096
    buffer_load_dwordx2 v[210:211], v233, s[48:51], 0 offen
    v_mfma_f32_16x16x32_bf16 v[152:155], v[68:71], v[88:91], v[152:155]
    ds_read_b64_tr_b16 v[40:41], v4 offset:16384
    v_mfma_f32_16x16x32_bf16 v[156:159], v[68:71], v[92:95], v[156:159]
    ds_read_b64_tr_b16 v[42:43], v4 offset:17408
    v_mfma_f32_16x16x32_bf16 v[196:199], v[68:71], v[20:23], v[196:199]
    ds_read_b128 v[60:63], v10 offset:6144
    v_mfma_f32_16x16x32_bf16 v[160:163], v[72:75], v[80:83], v[160:163]
    ds_read_b64_tr_b16 v[44:45], v5 offset:16384
    v_mfma_f32_16x16x32_bf16 v[164:167], v[72:75], v[84:87], v[164:167]
    ds_read_b64_tr_b16 v[46:47], v5 offset:17408
    v_mfma_f32_16x16x32_bf16 v[168:171], v[72:75], v[88:91], v[168:171]
    buffer_load_dwordx2 v[212:213], v234, s[48:51], 0 offen
    v_mfma_f32_16x16x32_bf16 v[172:175], v[72:75], v[92:95], v[172:175]
    v_mfma_f32_16x16x32_bf16 v[176:179], v[76:79], v[80:83], v[176:179]
    v_mfma_f32_16x16x32_bf16 v[180:183], v[76:79], v[84:87], v[180:183]
    buffer_load_dwordx2 v[214:215], v235, s[48:51], 0 offen
    v_mfma_f32_16x16x32_bf16 v[184:187], v[76:79], v[88:91], v[184:187]
    v_mfma_f32_16x16x32_bf16 v[188:191], v[76:79], v[92:95], v[188:191]
    s_waitcnt lgkmcnt(0)
    v_mfma_f32_16x16x32_bf16 v[128:131], v[32:35], v[48:51], v[128:131]
    ds_read_b128 v[80:83], v11 offset:0
    s_lshl_b32 s79, s53, 6
    v_mfma_f32_16x16x32_bf16 v[132:135], v[32:35], v[52:55], v[132:135]
    ds_read_b64_tr_b16 v[64:65], v2 offset:24576
    s_lshl_b32 s80, s3, 4
    v_mfma_f32_16x16x32_bf16 v[136:139], v[32:35], v[56:59], v[136:139]
    ds_read_b64_tr_b16 v[66:67], v2 offset:25600
    s_add_u32 s79, s79, s80
    v_mfma_f32_16x16x32_bf16 v[140:143], v[32:35], v[60:63], v[140:143]
    ds_read_b128 v[84:87], v11 offset:2048
    v_lshrrev_b32 v116, 2, v0
    v_mfma_f32_16x16x32_bf16 v[192:195], v[32:35], v[20:23], v[192:195]
    ds_read_b64_tr_b16 v[68:69], v3 offset:24576
    v_add_u32 v116, s79, v116
    v_mfma_f32_16x16x32_bf16 v[144:147], v[36:39], v[48:51], v[144:147]
    ds_read_b64_tr_b16 v[70:71], v3 offset:25600
    v_mul_u32_u24 v116, 1280, v116
    v_mfma_f32_16x16x32_bf16 v[148:151], v[36:39], v[52:55], v[148:151]
    ds_read_b128 v[88:91], v11 offset:4096
    s_mul_i32 s80, s54, 160
    v_mfma_f32_16x16x32_bf16 v[152:155], v[36:39], v[56:59], v[152:155]
    ds_read_b64_tr_b16 v[72:73], v4 offset:24576
    v_add_u32 v116, s80, v116
    v_mfma_f32_16x16x32_bf16 v[156:159], v[36:39], v[60:63], v[156:159]
    ds_read_b64_tr_b16 v[74:75], v4 offset:25600
    v_and_b32 v117, 3, v0
    v_mfma_f32_16x16x32_bf16 v[196:199], v[36:39], v[20:23], v[196:199]
    ds_read_b128 v[92:95], v11 offset:6144
    v_lshl_add_u32 v118, v117, 4, v116
    v_mfma_f32_16x16x32_bf16 v[160:163], v[40:43], v[48:51], v[160:163]
    ds_read_b64_tr_b16 v[76:77], v5 offset:24576
    v_lshl_add_u32 v119, v117, 3, v116
    v_mfma_f32_16x16x32_bf16 v[164:167], v[40:43], v[52:55], v[164:167]
    ds_read_b64_tr_b16 v[78:79], v5 offset:25600
    v_mfma_f32_16x16x32_bf16 v[168:171], v[40:43], v[56:59], v[168:171]
    s_mov_b32 s40, s24
    s_mov_b32 s41, s25
    v_mfma_f32_16x16x32_bf16 v[172:175], v[40:43], v[60:63], v[172:175]
    s_mov_b32 s42, 1280
    s_mov_b32 s43, 0x20000
    v_mfma_f32_16x16x32_bf16 v[176:179], v[44:47], v[48:51], v[176:179]
    v_lshrrev_b32 v104, 4, v0
    s_mul_i32 s60, s54, 160
    v_mfma_f32_16x16x32_bf16 v[180:183], v[44:47], v[52:55], v[180:183]
    v_lshlrev_b32 v105, 4, v104
    v_lshlrev_b32_e64 v106, 3, v104
    v_mfma_f32_16x16x32_bf16 v[184:187], v[44:47], v[56:59], v[184:187]
    buffer_load_dwordx4 a[240:243], v105, s[40:43], s60 offen
    buffer_load_dwordx4 a[244:247], v105, s[40:43], s60 offen offset:64
    v_mfma_f32_16x16x32_bf16 v[188:191], v[44:47], v[60:63], v[188:191]
    buffer_load_dwordx2 a[248:249], v106, s[40:43], s60 offen offset:128
    s_waitcnt vmcnt(7) lgkmcnt(0)
    s_waitcnt vmcnt(15)
    v_cmp_ne_u32 vcc, s56, v29
    s_mov_b64 s[82:83], vcc
    s_cmp_eq_u64 s[82:83], 0
    s_cbranch_scc0 P1_RETRY_1
P1_DONE_2:
    s_barrier
    v_mfma_f32_16x16x32_bf16 v[128:131], v[64:67], v[80:83], v[128:131]
    ds_read_b128 v[48:51], v10 offset:32768
    buffer_load_dword v24, v27, s[36:39], 0 offen sc1
    v_mfma_f32_16x16x32_bf16 v[132:135], v[64:67], v[84:87], v[132:135]
    ds_read_b64_tr_b16 v[32:33], v2 offset:49152
    v_mfma_f32_16x16x32_bf16 v[136:139], v[64:67], v[88:91], v[136:139]
    ds_read_b64_tr_b16 v[34:35], v2 offset:50176
    v_and_b32 v16, 15, v0
    v_mfma_f32_16x16x32_bf16 v[140:143], v[64:67], v[92:95], v[140:143]
    ds_read_b128 v[52:55], v10 offset:34816
    v_mfma_f32_16x16x32_bf16 v[192:195], v[64:67], v[20:23], v[192:195]
    ds_read_b64_tr_b16 v[36:37], v3 offset:49152
    v_mfma_f32_16x16x32_bf16 v[144:147], v[68:71], v[80:83], v[144:147]
    ds_read_b64_tr_b16 v[38:39], v3 offset:50176
    v_add_u32_e64 v16, s67, v16
    v_mfma_f32_16x16x32_bf16 v[148:151], v[68:71], v[84:87], v[148:151]
    ds_read_b128 v[56:59], v10 offset:36864
    v_mfma_f32_16x16x32_bf16 v[152:155], v[68:71], v[88:91], v[152:155]
    ds_read_b64_tr_b16 v[40:41], v4 offset:49152
    v_mfma_f32_16x16x32_bf16 v[156:159], v[68:71], v[92:95], v[156:159]
    ds_read_b64_tr_b16 v[42:43], v4 offset:50176
    v_lshlrev_b32_e64 v16, 3, v16
    v_mfma_f32_16x16x32_bf16 v[196:199], v[68:71], v[20:23], v[196:199]
    ds_read_b128 v[60:63], v10 offset:38912
    v_mfma_f32_16x16x32_bf16 v[160:163], v[72:75], v[80:83], v[160:163]
    ds_read_b64_tr_b16 v[44:45], v5 offset:49152
    s_mov_b32 s59, 65536
    v_mfma_f32_16x16x32_bf16 v[164:167], v[72:75], v[84:87], v[164:167]
    ds_read_b64_tr_b16 v[46:47], v5 offset:50176
    v_mfma_f32_16x16x32_bf16 v[168:171], v[72:75], v[88:91], v[168:171]
    buffer_load_dwordx2 v[200:201], v16, s[36:39], s59 offen offset:0 sc1
    v_mfma_f32_16x16x32_bf16 v[172:175], v[72:75], v[92:95], v[172:175]
    v_mfma_f32_16x16x32_bf16 v[176:179], v[76:79], v[80:83], v[176:179]
    buffer_load_dwordx2 v[202:203], v16, s[36:39], s59 offen offset:128 sc1
    v_mfma_f32_16x16x32_bf16 v[180:183], v[76:79], v[84:87], v[180:183]
    buffer_load_dwordx2 v[204:205], v16, s[36:39], s59 offen offset:256 sc1
    v_mfma_f32_16x16x32_bf16 v[184:187], v[76:79], v[88:91], v[184:187]
    buffer_load_dwordx2 v[206:207], v16, s[36:39], s59 offen offset:384 sc1
    v_mfma_f32_16x16x32_bf16 v[188:191], v[76:79], v[92:95], v[188:191]
    s_waitcnt lgkmcnt(0)
    v_mfma_f32_16x16x32_bf16 v[128:131], v[32:35], v[48:51], v[128:131]
    ds_read_b128 v[80:83], v11 offset:32768
    buffer_load_dwordx4 v[244:247], v118, s[32:35], 0 offen
    v_mfma_f32_16x16x32_bf16 v[132:135], v[32:35], v[52:55], v[132:135]
    ds_read_b64_tr_b16 v[64:65], v2 offset:57344
    s_and_b32 s73, s69, 7
    v_mfma_f32_16x16x32_bf16 v[136:139], v[32:35], v[56:59], v[136:139]
    ds_read_b64_tr_b16 v[66:67], v2 offset:58368
    s_lshl_b32 s73, s73, 6
    s_nop 0
    v_mfma_f32_16x16x32_bf16 v[140:143], v[32:35], v[60:63], v[140:143]
    ds_read_b128 v[84:87], v11 offset:34816
    s_add_u32 s73, s73, 131072
    v_mfma_f32_16x16x32_bf16 v[192:195], v[32:35], v[20:23], v[192:195]
    ds_read_b64_tr_b16 v[68:69], v3 offset:57344
    v_lshl_add_u32 v108, v17, 4, s73
    v_mfma_f32_16x16x32_bf16 v[144:147], v[36:39], v[48:51], v[144:147]
    ds_read_b64_tr_b16 v[70:71], v3 offset:58368
    s_and_b32 s73, s70, 7
    v_mfma_f32_16x16x32_bf16 v[148:151], v[36:39], v[52:55], v[148:151]
    ds_read_b128 v[88:91], v11 offset:36864
    s_lshl_b32 s73, s73, 6
    v_mfma_f32_16x16x32_bf16 v[152:155], v[36:39], v[56:59], v[152:155]
    ds_read_b64_tr_b16 v[72:73], v4 offset:57344
    v_mfma_f32_16x16x32_bf16 v[156:159], v[36:39], v[60:63], v[156:159]
    ds_read_b64_tr_b16 v[74:75], v4 offset:58368
    s_add_u32 s73, s73, 131072
    v_mfma_f32_16x16x32_bf16 v[196:199], v[36:39], v[20:23], v[196:199]
    ds_read_b128 v[92:95], v11 offset:38912
    v_lshl_add_u32 v109, v17, 4, s73
    v_mfma_f32_16x16x32_bf16 v[160:163], v[40:43], v[48:51], v[160:163]
    ds_read_b64_tr_b16 v[76:77], v5 offset:57344
    s_and_b32 s73, s71, 7
    v_mfma_f32_16x16x32_bf16 v[164:167], v[40:43], v[52:55], v[164:167]
    ds_read_b64_tr_b16 v[78:79], v5 offset:58368
    s_lshl_b32 s73, s73, 6
    v_mfma_f32_16x16x32_bf16 v[168:171], v[40:43], v[56:59], v[168:171]
    s_add_u32 s73, s73, 131072
    v_lshl_add_u32 v110, v17, 4, s73
    v_mfma_f32_16x16x32_bf16 v[172:175], v[40:43], v[60:63], v[172:175]
    s_and_b32 s73, s72, 7
    v_mfma_f32_16x16x32_bf16 v[176:179], v[44:47], v[48:51], v[176:179]
    s_lshl_b32 s73, s73, 6
    s_add_u32 s73, s73, 131072
    v_mfma_f32_16x16x32_bf16 v[180:183], v[44:47], v[52:55], v[180:183]
    v_lshl_add_u32 v111, v17, 4, s73
    v_mov_b32 v112, 0xbf8bf336
    v_mfma_f32_16x16x32_bf16 v[184:187], v[44:47], v[56:59], v[184:187]
    v_mov_b32 v113, 0xbf8bf336
    v_mov_b32 v114, 0x3eeff558
    v_mfma_f32_16x16x32_bf16 v[188:191], v[44:47], v[60:63], v[188:191]
    v_mov_b32 v115, 0x3eeff558
    s_waitcnt lgkmcnt(0)
    v_mfma_f32_16x16x32_bf16 v[192:195], v[64:67], v[20:23], v[192:195]
    s_waitcnt vmcnt(9)
    v_lshlrev_b32_e64 v40, 16, v208
    v_mfma_f32_16x16x32_bf16 v[196:199], v[68:71], v[20:23], v[196:199]
    buffer_load_dwordx4 v[248:251], v118, s[32:35], 0 offen offset:64
    v_and_b32 v41, 0xffff0000, v208
    v_mfma_f32_16x16x32_bf16 v[128:131], v[64:67], v[80:83], v[128:131]
    v_lshlrev_b32 v42, 16, v209
    v_mfma_f32_16x16x32_bf16 v[132:135], v[64:67], v[84:87], v[132:135]
    v_and_b32 v43, 0xffff0000, v209
    v_lshlrev_b32 v44, 16, v210
    v_mfma_f32_16x16x32_bf16 v[136:139], v[64:67], v[88:91], v[136:139]
    v_and_b32 v45, 0xffff0000, v210
    v_lshlrev_b32 v46, 16, v211
    v_mfma_f32_16x16x32_bf16 v[140:143], v[64:67], v[92:95], v[140:143]
    v_and_b32 v47, 0xffff0000, v211
    v_mfma_f32_16x16x32_bf16 v[144:147], v[68:71], v[80:83], v[144:147]
    v_lshlrev_b32 v56, 16, v212
    v_and_b32 v57, 0xffff0000, v212
    v_mfma_f32_16x16x32_bf16 v[148:151], v[68:71], v[84:87], v[148:151]
    v_lshlrev_b32 v58, 16, v213
    v_mfma_f32_16x16x32_bf16 v[152:155], v[68:71], v[88:91], v[152:155]
    v_and_b32 v59, 0xffff0000, v213
    v_lshlrev_b32 v60, 16, v214
    v_mfma_f32_16x16x32_bf16 v[156:159], v[68:71], v[92:95], v[156:159]
    buffer_load_dwordx2 v[252:253], v119, s[32:35], 0 offen offset:128
    v_and_b32 v61, 0xffff0000, v214
    v_mfma_f32_16x16x32_bf16 v[160:163], v[72:75], v[80:83], v[160:163]
    s_mov_b32 exec_lo, 0x00010001
    s_mov_b32 exec_hi, 0x00010001
    ds_write_b128 v108, v[192:195]
    ds_write_b128 v109, v[196:199]
    s_mov_b64 exec, -1
    v_mfma_f32_16x16x32_bf16 v[164:167], v[72:75], v[84:87], v[164:167]
    v_lshlrev_b32 v62, 16, v215
    v_mfma_f32_16x16x32_bf16 v[168:171], v[72:75], v[88:91], v[168:171]
    v_and_b32 v63, 0xffff0000, v215
    s_mov_b32 s74, 0x409d30fc
    v_mfma_f32_16x16x32_bf16 v[172:175], v[72:75], v[92:95], v[172:175]
    s_mov_b32 s75, 0x409d30fc
    v_mfma_f32_16x16x32_bf16 v[176:179], v[76:79], v[80:83], v[176:179]
    s_lshr_b32 s76, s67, 4
    s_mul_i32 s76, s76, 55296
    v_mfma_f32_16x16x32_bf16 v[180:183], v[76:79], v[84:87], v[180:183]
    s_add_u32 s76, s76, 10485760
    v_mfma_f32_16x16x32_bf16 v[184:187], v[76:79], v[88:91], v[184:187]
    s_cmp_ge_u32 s68, 108
    s_cselect_b32 s76, 17563648, s76
    v_mfma_f32_16x16x32_bf16 v[188:191], v[76:79], v[92:95], v[188:191]
    v_lshlrev_b32 v18, 4, v0
G1_END:
    s_waitcnt vmcnt(7)
    v_cmp_ne_u32 vcc, s56, v24
    s_mov_b64 s[82:83], vcc
    s_cmp_eq_u64 s[82:83], 0
    s_cbranch_scc0 P2_RETRY_4
P2_DONE_5:
    s_waitcnt lgkmcnt(0)
    s_barrier
    s_nop 0
    ds_read_b128 v[216:219], v108
    ds_read_b128 v[220:223], v109
    ds_read_b128 v[224:227], v110
    ds_read_b128 v[228:231], v111
    buffer_load_dwordx4 v[96:99], v14, s[44:47], s89 offen offset:0 nt
    buffer_load_dwordx4 v[100:103], v14, s[44:47], s89 offen offset:1024 nt
    buffer_load_dwordx2 v[116:117], v14, s[44:47], s89 offen offset:2048 nt
    v_pk_mul_f32 v[40:41], v[40:41], v[114:115]
    v_pk_mul_f32 v[42:43], v[42:43], v[114:115]
    v_pk_mul_f32 v[44:45], v[44:45], v[114:115]
    v_pk_mul_f32 v[46:47], v[46:47], v[114:115]
    v_pk_mul_f32 v[56:57], v[56:57], v[114:115]
    v_pk_mul_f32 v[58:59], v[58:59], v[114:115]
    v_pk_mul_f32 v[60:61], v[60:61], v[114:115]
    v_pk_mul_f32 v[62:63], v[62:63], v[114:115]
    s_waitcnt vmcnt(6)
    v_mul_f32 v201, v114, v201
    v_mul_f32 v200, v200, v201
    v_mul_f32 v203, v114, v203
    v_mul_f32 v202, v202, v203
    v_mul_f32 v205, v114, v205
    v_mul_f32 v204, v204, v205
    v_mul_f32 v207, v114, v207
    v_mul_f32_e64 v206, v206, v207
    buffer_load_dwordx4 v[120:123], v14, s[36:39], s88 offen offset:0 sc1
    buffer_load_dwordx4 v[124:127], v14, s[36:39], s88 offen offset:1024 sc1
    s_waitcnt lgkmcnt(0)
    s_lshl_b32 s78, s84, 1
    s_and_b32 s78, s78, -4
    s_nop 0
    s_load_dword s77, s[14:15], s78
    v_pk_fma_f32 v[32:33], v[216:217], v[200:201], v[40:41] op_sel_hi:[1,0,1] neg_lo:[0,1,0] neg_hi:[0,1,0]
    v_pk_fma_f32 v[34:35], v[218:219], v[200:201], v[42:43] op_sel_hi:[1,0,1] neg_lo:[0,1,0] neg_hi:[0,1,0]
    v_pk_fma_f32 v[36:37], v[220:221], v[200:201], v[44:45] op_sel_hi:[1,0,1] neg_lo:[0,1,0] neg_hi:[0,1,0]
    buffer_load_dwordx4 a[0:3], v14, s[36:39], s52 offen offset:0 sc1
    v_pk_fma_f32 v[38:39], v[222:223], v[200:201], v[46:47] op_sel_hi:[1,0,1] neg_lo:[0,1,0] neg_hi:[0,1,0]
    v_pk_fma_f32 v[32:33], v[128:129], v[200:201], v[32:33] op_sel:[0,1,0] op_sel_hi:[1,1,1]
    v_pk_fma_f32 v[34:35], v[130:131], v[200:201], v[34:35] op_sel:[0,1,0] op_sel_hi:[1,1,1]
    v_pk_fma_f32 v[36:37], v[144:145], v[200:201], v[36:37] op_sel:[0,1,0] op_sel_hi:[1,1,1]
    v_pk_fma_f32 v[38:39], v[146:147], v[200:201], v[38:39] op_sel:[0,1,0] op_sel_hi:[1,1,1]
    v_pk_fma_f32 v[48:49], v[32:33], v[32:33], s[74:75]
    v_pk_fma_f32 v[50:51], v[34:35], v[34:35], s[74:75]
    v_pk_fma_f32 v[52:53], v[36:37], v[36:37], s[74:75]
    v_pk_fma_f32 v[54:55], v[38:39], v[38:39], s[74:75]
    v_pk_fma_f32 v[48:49], v[48:49], v[32:33], v[112:113] neg_lo:[0,1,0] neg_hi:[0,1,0]
    v_pk_fma_f32 v[50:51], v[50:51], v[34:35], v[112:113] neg_lo:[0,1,0] neg_hi:[0,1,0]
    v_pk_fma_f32 v[52:53], v[52:53], v[36:37], v[112:113] neg_lo:[0,1,0] neg_hi:[0,1,0]
    v_pk_fma_f32 v[54:55], v[54:55], v[38:39], v[112:113] neg_lo:[0,1,0] neg_hi:[0,1,0]
    v_exp_f32 v64, v48
    v_exp_f32 v65, v49
    v_exp_f32 v66, v50
    v_exp_f32 v67, v51
    v_exp_f32 v68, v52
    v_exp_f32 v69, v53
    v_exp_f32 v70, v54
    v_exp_f32 v71, v55
    v_pk_add_f32 v[64:65], v[64:65], v[114:115]
    buffer_load_dwordx4 a[4:7], v14, s[36:39], s52 offen offset:1024 sc1
    v_pk_add_f32 v[66:67], v[66:67], v[114:115]
    v_pk_add_f32 v[68:69], v[68:69], v[114:115]
    v_pk_add_f32 v[70:71], v[70:71], v[114:115]
    v_rcp_f32 v64, v64
    v_rcp_f32 v65, v65
    v_rcp_f32 v66, v66
    v_rcp_f32 v67, v67
    v_rcp_f32 v68, v68
    v_rcp_f32 v69, v69
    v_rcp_f32_e64 v70, v70
    v_rcp_f32 v71, v71
    s_nop 0
    v_pk_mul_f32 v[32:33], v[32:33], v[64:65]
    v_pk_mul_f32 v[34:35], v[34:35], v[66:67]
    v_pk_mul_f32 v[36:37], v[36:37], v[68:69]
    v_pk_mul_f32 v[38:39], v[38:39], v[70:71]
    v_cvt_pk_bf16_f32 v128, v32, v33
    v_cvt_pk_bf16_f32 v129, v34, v35
    v_cvt_pk_bf16_f32 v130, v36, v37
    v_cvt_pk_bf16_f32 v131, v38, v39
    s_lshr_b32 s73, s69, 1
    s_lshl_b32 s73, s73, 10
    s_add_u32 s73, s73, s76
    s_nop 0
    buffer_store_dwordx4 v[128:131], v18, s[36:39], s73 offen sc1
    v_pk_fma_f32 v[32:33], v[224:225], v[200:201], v[56:57] op_sel_hi:[1,0,1] neg_lo:[0,1,0] neg_hi:[0,1,0]
    v_pk_fma_f32 v[34:35], v[226:227], v[200:201], v[58:59] op_sel_hi:[1,0,1] neg_lo:[0,1,0] neg_hi:[0,1,0]
    v_pk_fma_f32 v[36:37], v[228:229], v[200:201], v[60:61] op_sel_hi:[1,0,1] neg_lo:[0,1,0] neg_hi:[0,1,0]
    buffer_load_dwordx4 a[8:11], v14, s[36:39], s52 offen offset:2048 sc1
    v_pk_fma_f32 v[38:39], v[230:231], v[200:201], v[62:63] op_sel_hi:[1,0,1] neg_lo:[0,1,0] neg_hi:[0,1,0]
    v_pk_fma_f32 v[32:33], v[160:161], v[200:201], v[32:33] op_sel:[0,1,0] op_sel_hi:[1,1,1]
    v_pk_fma_f32 v[34:35], v[162:163], v[200:201], v[34:35] op_sel:[0,1,0] op_sel_hi:[1,1,1]
    v_pk_fma_f32 v[36:37], v[176:177], v[200:201], v[36:37] op_sel:[0,1,0] op_sel_hi:[1,1,1]
    v_pk_fma_f32 v[38:39], v[178:179], v[200:201], v[38:39] op_sel:[0,1,0] op_sel_hi:[1,1,1]
    v_pk_fma_f32 v[48:49], v[32:33], v[32:33], s[74:75]
    v_pk_fma_f32 v[50:51], v[34:35], v[34:35], s[74:75]
    v_pk_fma_f32 v[52:53], v[36:37], v[36:37], s[74:75]
    v_pk_fma_f32 v[54:55], v[38:39], v[38:39], s[74:75]
    v_pk_fma_f32 v[48:49], v[48:49], v[32:33], v[112:113] neg_lo:[0,1,0] neg_hi:[0,1,0]
PAGE3:
    s_cbranch_execz PAGE4
    v_pk_fma_f32 v[50:51], v[50:51], v[34:35], v[112:113] neg_lo:[0,1,0] neg_hi:[0,1,0]
    v_pk_fma_f32 v[52:53], v[52:53], v[36:37], v[112:113] neg_lo:[0,1,0] neg_hi:[0,1,0]
    v_pk_fma_f32 v[54:55], v[54:55], v[38:39], v[112:113] neg_lo:[0,1,0] neg_hi:[0,1,0]
    v_exp_f32 v64, v48
    v_exp_f32 v65, v49
    v_exp_f32 v66, v50
    v_exp_f32 v67, v51
    v_exp_f32 v68, v52
    v_exp_f32 v69, v53
    v_exp_f32 v70, v54
    v_exp_f32_e64 v71, v55
    v_pk_add_f32 v[64:65], v[64:65], v[114:115]
    buffer_load_dwordx4 a[12:15], v14, s[36:39], s52 offen offset:3072 sc1
    v_pk_add_f32 v[66:67], v[66:67], v[114:115]
    v_pk_add_f32 v[68:69], v[68:69], v[114:115]
    v_pk_add_f32 v[70:71], v[70:71], v[114:115]
    v_rcp_f32 v64, v64
    v_rcp_f32 v65, v65
    v_rcp_f32 v66, v66
    v_rcp_f32 v67, v67
    v_rcp_f32 v68, v68
    v_rcp_f32 v69, v69
    v_rcp_f32_e64 v70, v70
    v_rcp_f32 v71, v71
    s_nop 0
    v_pk_mul_f32 v[32:33], v[32:33], v[64:65]
    v_pk_mul_f32 v[34:35], v[34:35], v[66:67]
    v_pk_mul_f32 v[36:37], v[36:37], v[68:69]
    v_pk_mul_f32 v[38:39], v[38:39], v[70:71]
    v_cvt_pk_bf16_f32 v160, v32, v33
    v_cvt_pk_bf16_f32 v161, v34, v35
    v_cvt_pk_bf16_f32 v162, v36, v37
    v_cvt_pk_bf16_f32 v163, v38, v39
    s_lshr_b32 s73, s71, 1
    s_lshl_b32 s73, s73, 10
    s_add_u32 s73, s73, s76
    s_nop 0
    buffer_store_dwordx4 v[160:163], v18, s[36:39], s73 offen sc1
    v_pk_fma_f32 v[32:33], v[216:217], v[202:203], v[40:41] op_sel_hi:[1,0,1] neg_lo:[0,1,0] neg_hi:[0,1,0]
    v_pk_fma_f32 v[34:35], v[218:219], v[202:203], v[42:43] op_sel_hi:[1,0,1] neg_lo:[0,1,0] neg_hi:[0,1,0]
    v_pk_fma_f32 v[36:37], v[220:221], v[202:203], v[44:45] op_sel_hi:[1,0,1] neg_lo:[0,1,0] neg_hi:[0,1,0]
    buffer_load_dwordx4 a[16:19], v15, s[36:39], s52 offen offset:0 sc1
    s_add_u32 s52, s52, 5120
    v_pk_fma_f32 v[38:39], v[222:223], v[202:203], v[46:47] op_sel_hi:[1,0,1] neg_lo:[0,1,0] neg_hi:[0,1,0]
    v_pk_fma_f32 v[32:33], v[132:133], v[202:203], v[32:33] op_sel:[0,1,0] op_sel_hi:[1,1,1]
    v_pk_fma_f32 v[34:35], v[134:135], v[202:203], v[34:35] op_sel:[0,1,0] op_sel_hi:[1,1,1]
    v_pk_fma_f32 v[36:37], v[148:149], v[202:203], v[36:37] op_sel:[0,1,0] op_sel_hi:[1,1,1]
    v_pk_fma_f32 v[38:39], v[150:151], v[202:203], v[38:39] op_sel:[0,1,0] op_sel_hi:[1,1,1]
    v_pk_fma_f32 v[48:49], v[32:33], v[32:33], s[74:75]
    v_pk_fma_f32 v[50:51], v[34:35], v[34:35], s[74:75]
    v_pk_fma_f32 v[52:53], v[36:37], v[36:37], s[74:75]
    v_pk_fma_f32 v[54:55], v[38:39], v[38:39], s[74:75]
    v_pk_fma_f32 v[48:49], v[48:49], v[32:33], v[112:113] neg_lo:[0,1,0] neg_hi:[0,1,0]
    v_pk_fma_f32 v[50:51], v[50:51], v[34:35], v[112:113] neg_lo:[0,1,0] neg_hi:[0,1,0]
    v_pk_fma_f32 v[52:53], v[52:53], v[36:37], v[112:113] neg_lo:[0,1,0] neg_hi:[0,1,0]
    v_pk_fma_f32 v[54:55], v[54:55], v[38:39], v[112:113] neg_lo:[0,1,0] neg_hi:[0,1,0]
    v_exp_f32 v64, v48
    v_exp_f32 v65, v49
    v_exp_f32 v66, v50
    v_exp_f32 v67, v51
    v_exp_f32 v68, v52
    v_exp_f32 v69, v53
    v_exp_f32 v70, v54
    v_exp_f32 v71, v55
    v_pk_add_f32 v[64:65], v[64:65], v[114:115]
    buffer_load_dwordx4 a[20:23], v14, s[36:39], s52 offen offset:0 sc1
    v_pk_add_f32 v[66:67], v[66:67], v[114:115]
    v_pk_add_f32 v[68:69], v[68:69], v[114:115]
    v_pk_add_f32 v[70:71], v[70:71], v[114:115]
    v_rcp_f32 v64, v64
    v_rcp_f32 v65, v65
    v_rcp_f32 v66, v66
    v_rcp_f32 v67, v67
    v_rcp_f32 v68, v68
    v_rcp_f32 v69, v69
    v_rcp_f32_e64 v70, v70
    v_rcp_f32 v71, v71
    s_nop 0
    v_pk_mul_f32 v[32:33], v[32:33], v[64:65]
    v_pk_mul_f32 v[34:35], v[34:35], v[66:67]
    v_pk_mul_f32 v[36:37], v[36:37], v[68:69]
    v_pk_mul_f32 v[38:39], v[38:39], v[70:71]
    v_cvt_pk_bf16_f32 v132, v32, v33
    v_cvt_pk_bf16_f32 v133, v34, v35
    v_cvt_pk_bf16_f32 v134, v36, v37
    v_cvt_pk_bf16_f32 v135, v38, v39
    s_lshr_b32 s73, s69, 1
    s_lshl_b32 s73, s73, 10
    s_add_u32 s73, s73, s76
    s_nop 0
    s_add_u32 s73, s73, 55296
    buffer_store_dwordx4 v[132:135], v18, s[36:39], s73 offen sc1
    v_pk_fma_f32 v[32:33], v[224:225], v[202:203], v[56:57] op_sel_hi:[1,0,1] neg_lo:[0,1,0] neg_hi:[0,1,0]
    v_pk_fma_f32 v[34:35], v[226:227], v[202:203], v[58:59] op_sel_hi:[1,0,1] neg_lo:[0,1,0] neg_hi:[0,1,0]
    v_pk_fma_f32 v[36:37], v[228:229], v[202:203], v[60:61] op_sel_hi:[1,0,1] neg_lo:[0,1,0] neg_hi:[0,1,0]
    buffer_load_dwordx4 a[24:27], v14, s[36:39], s52 offen offset:1024 sc1
    v_pk_fma_f32 v[38:39], v[230:231], v[202:203], v[62:63] op_sel_hi:[1,0,1] neg_lo:[0,1,0] neg_hi:[0,1,0]
    v_pk_fma_f32 v[32:33], v[164:165], v[202:203], v[32:33] op_sel:[0,1,0] op_sel_hi:[1,1,1]
    v_pk_fma_f32 v[34:35], v[166:167], v[202:203], v[34:35] op_sel:[0,1,0] op_sel_hi:[1,1,1]
    v_pk_fma_f32 v[36:37], v[180:181], v[202:203], v[36:37] op_sel:[0,1,0] op_sel_hi:[1,1,1]
    v_pk_fma_f32 v[38:39], v[182:183], v[202:203], v[38:39] op_sel:[0,1,0] op_sel_hi:[1,1,1]
    v_pk_fma_f32 v[48:49], v[32:33], v[32:33], s[74:75]
    v_pk_fma_f32 v[50:51], v[34:35], v[34:35], s[74:75]
    v_pk_fma_f32 v[52:53], v[36:37], v[36:37], s[74:75]
    v_pk_fma_f32 v[54:55], v[38:39], v[38:39], s[74:75]
    v_pk_fma_f32 v[48:49], v[48:49], v[32:33], v[112:113] neg_lo:[0,1,0] neg_hi:[0,1,0]
    v_pk_fma_f32 v[50:51], v[50:51], v[34:35], v[112:113] neg_lo:[0,1,0] neg_hi:[0,1,0]
    v_pk_fma_f32 v[52:53], v[52:53], v[36:37], v[112:113] neg_lo:[0,1,0] neg_hi:[0,1,0]
    v_pk_fma_f32 v[54:55], v[54:55], v[38:39], v[112:113] neg_lo:[0,1,0] neg_hi:[0,1,0]
    v_exp_f32 v64, v48
    v_exp_f32 v65, v49
    v_exp_f32 v66, v50
    v_exp_f32 v67, v51
    v_exp_f32 v68, v52
    v_exp_f32 v69, v53
    v_exp_f32 v70, v54
    v_exp_f32 v71, v55
    v_pk_add_f32 v[64:65], v[64:65], v[114:115]
    buffer_load_dwordx4 a[28:31], v14, s[36:39], s52 offen offset:2048 sc1
    v_pk_add_f32 v[66:67], v[66:67], v[114:115]
    v_pk_add_f32 v[68:69], v[68:69], v[114:115]
    v_pk_add_f32 v[70:71], v[70:71], v[114:115]
    v_rcp_f32 v64, v64
    v_rcp_f32 v65, v65
    v_rcp_f32 v66, v66
    v_rcp_f32 v67, v67
    v_rcp_f32 v68, v68
    v_rcp_f32 v69, v69
    v_rcp_f32_e64 v70, v70
    v_rcp_f32 v71, v71
    s_nop 0
    v_pk_mul_f32 v[32:33], v[32:33], v[64:65]
    v_pk_mul_f32 v[34:35], v[34:35], v[66:67]
    v_pk_mul_f32 v[36:37], v[36:37], v[68:69]
    v_pk_mul_f32 v[38:39], v[38:39], v[70:71]
    v_cvt_pk_bf16_f32 v164, v32, v33
    v_cvt_pk_bf16_f32 v165, v34, v35
    v_cvt_pk_bf16_f32 v166, v36, v37
    v_cvt_pk_bf16_f32 v167, v38, v39
    s_lshr_b32 s73, s71, 1
    s_lshl_b32 s73, s73, 10
    s_add_u32 s73, s73, s76
    s_nop 0
    s_add_u32 s73, s73, 55296
    buffer_store_dwordx4 v[164:167], v18, s[36:39], s73 offen sc1
    v_pk_fma_f32 v[32:33], v[216:217], v[204:205], v[40:41] op_sel_hi:[1,0,1] neg_lo:[0,1,0] neg_hi:[0,1,0]
    v_pk_fma_f32 v[34:35], v[218:219], v[204:205], v[42:43] op_sel_hi:[1,0,1] neg_lo:[0,1,0] neg_hi:[0,1,0]
    v_pk_fma_f32 v[36:37], v[220:221], v[204:205], v[44:45] op_sel_hi:[1,0,1] neg_lo:[0,1,0] neg_hi:[0,1,0]
    buffer_load_dwordx4 a[32:35], v14, s[36:39], s52 offen offset:3072 sc1
    v_pk_fma_f32 v[38:39], v[222:223], v[204:205], v[46:47] op_sel_hi:[1,0,1] neg_lo:[0,1,0] neg_hi:[0,1,0]
    v_pk_fma_f32 v[32:33], v[136:137], v[204:205], v[32:33] op_sel:[0,1,0] op_sel_hi:[1,1,1]
    v_pk_fma_f32 v[34:35], v[138:139], v[204:205], v[34:35] op_sel:[0,1,0] op_sel_hi:[1,1,1]
    v_pk_fma_f32 v[36:37], v[152:153], v[204:205], v[36:37] op_sel:[0,1,0] op_sel_hi:[1,1,1]
    v_pk_fma_f32 v[38:39], v[154:155], v[204:205], v[38:39] op_sel:[0,1,0] op_sel_hi:[1,1,1]
    v_pk_fma_f32 v[48:49], v[32:33], v[32:33], s[74:75]
    v_pk_fma_f32 v[50:51], v[34:35], v[34:35], s[74:75]
    v_pk_fma_f32 v[52:53], v[36:37], v[36:37], s[74:75]
    v_pk_fma_f32 v[54:55], v[38:39], v[38:39], s[74:75]
    v_pk_fma_f32 v[48:49], v[48:49], v[32:33], v[112:113] neg_lo:[0,1,0] neg_hi:[0,1,0]
    v_pk_fma_f32 v[50:51], v[50:51], v[34:35], v[112:113] neg_lo:[0,1,0] neg_hi:[0,1,0]
    v_pk_fma_f32 v[52:53], v[52:53], v[36:37], v[112:113] neg_lo:[0,1,0] neg_hi:[0,1,0]
    v_pk_fma_f32 v[54:55], v[54:55], v[38:39], v[112:113] neg_lo:[0,1,0] neg_hi:[0,1,0]
    v_exp_f32 v64, v48
    v_exp_f32 v65, v49
    v_exp_f32 v66, v50
    v_exp_f32 v67, v51
    v_exp_f32 v68, v52
    v_exp_f32 v69, v53
    v_exp_f32 v70, v54
    v_exp_f32 v71, v55
    v_pk_add_f32 v[64:65], v[64:65], v[114:115]
    buffer_load_dwordx4 a[36:39], v15, s[36:39], s52 offen offset:0 sc1
    s_add_u32 s52, s52, 5120
    v_pk_add_f32 v[66:67], v[66:67], v[114:115]
    v_pk_add_f32 v[68:69], v[68:69], v[114:115]
    v_pk_add_f32 v[70:71], v[70:71], v[114:115]
    v_rcp_f32 v64, v64
    v_rcp_f32 v65, v65
    v_rcp_f32 v66, v66
    v_rcp_f32 v67, v67
    v_rcp_f32 v68, v68
    v_rcp_f32 v69, v69
    v_rcp_f32_e64 v70, v70
    v_rcp_f32 v71, v71
    s_nop 0
    v_pk_mul_f32 v[32:33], v[32:33], v[64:65]
    v_pk_mul_f32 v[34:35], v[34:35], v[66:67]
    v_pk_mul_f32 v[36:37], v[36:37], v[68:69]
    v_pk_mul_f32 v[38:39], v[38:39], v[70:71]
    v_cvt_pk_bf16_f32 v136, v32, v33
    v_cvt_pk_bf16_f32 v137, v34, v35
    v_cvt_pk_bf16_f32 v138, v36, v37
    v_cvt_pk_bf16_f32 v139, v38, v39
    s_lshr_b32 s73, s69, 1
    s_lshl_b32 s73, s73, 10
    s_add_u32 s73, s73, s76
    s_nop 0
    s_add_u32 s73, s73, 110592
    buffer_store_dwordx4 v[136:139], v18, s[36:39], s73 offen sc1
    v_pk_fma_f32 v[32:33], v[224:225], v[204:205], v[56:57] op_sel_hi:[1,0,1] neg_lo:[0,1,0] neg_hi:[0,1,0]
    v_pk_fma_f32 v[34:35], v[226:227], v[204:205], v[58:59] op_sel_hi:[1,0,1] neg_lo:[0,1,0] neg_hi:[0,1,0]
    v_pk_fma_f32 v[36:37], v[228:229], v[204:205], v[60:61] op_sel_hi:[1,0,1] neg_lo:[0,1,0] neg_hi:[0,1,0]
    buffer_load_dwordx4 a[40:43], v14, s[36:39], s52 offen offset:0 sc1
    v_pk_fma_f32 v[38:39], v[230:231], v[204:205], v[62:63] op_sel_hi:[1,0,1] neg_lo:[0,1,0] neg_hi:[0,1,0]
    v_pk_fma_f32 v[32:33], v[168:169], v[204:205], v[32:33] op_sel:[0,1,0] op_sel_hi:[1,1,1]
    v_pk_fma_f32 v[34:35], v[170:171], v[204:205], v[34:35] op_sel:[0,1,0] op_sel_hi:[1,1,1]
    v_pk_fma_f32 v[36:37], v[184:185], v[204:205], v[36:37] op_sel:[0,1,0] op_sel_hi:[1,1,1]
    v_pk_fma_f32 v[38:39], v[186:187], v[204:205], v[38:39] op_sel:[0,1,0] op_sel_hi:[1,1,1]
    v_pk_fma_f32 v[48:49], v[32:33], v[32:33], s[74:75]
    v_pk_fma_f32 v[50:51], v[34:35], v[34:35], s[74:75]
    v_pk_fma_f32 v[52:53], v[36:37], v[36:37], s[74:75]
    v_pk_fma_f32 v[54:55], v[38:39], v[38:39], s[74:75]
    v_pk_fma_f32 v[48:49], v[48:49], v[32:33], v[112:113] neg_lo:[0,1,0] neg_hi:[0,1,0]
    v_pk_fma_f32 v[50:51], v[50:51], v[34:35], v[112:113] neg_lo:[0,1,0] neg_hi:[0,1,0]
    v_pk_fma_f32 v[52:53], v[52:53], v[36:37], v[112:113] neg_lo:[0,1,0] neg_hi:[0,1,0]
    v_pk_fma_f32 v[54:55], v[54:55], v[38:39], v[112:113] neg_lo:[0,1,0] neg_hi:[0,1,0]
    v_exp_f32 v64, v48
    v_exp_f32 v65, v49
    v_exp_f32 v66, v50
    v_exp_f32 v67, v51
    v_exp_f32 v68, v52
    v_exp_f32 v69, v53
    v_exp_f32 v70, v54
    v_exp_f32 v71, v55
    v_pk_add_f32 v[64:65], v[64:65], v[114:115]
    buffer_load_dwordx4 a[44:47], v14, s[36:39], s52 offen offset:1024 sc1
    v_pk_add_f32 v[66:67], v[66:67], v[114:115]
    v_pk_add_f32 v[68:69], v[68:69], v[114:115]
    v_pk_add_f32 v[70:71], v[70:71], v[114:115]
    v_rcp_f32 v64, v64
    v_rcp_f32 v65, v65
    v_rcp_f32 v66, v66
    v_rcp_f32 v67, v67
    v_rcp_f32 v68, v68
    v_rcp_f32 v69, v69
    v_rcp_f32_e64 v70, v70
    v_rcp_f32 v71, v71
    s_nop 0
    v_pk_mul_f32 v[32:33], v[32:33], v[64:65]
    v_pk_mul_f32 v[34:35], v[34:35], v[66:67]
    v_pk_mul_f32 v[36:37], v[36:37], v[68:69]
    v_pk_mul_f32 v[38:39], v[38:39], v[70:71]
    v_cvt_pk_bf16_f32 v168, v32, v33
    v_cvt_pk_bf16_f32 v169, v34, v35
    v_cvt_pk_bf16_f32 v170, v36, v37
    v_cvt_pk_bf16_f32 v171, v38, v39
    s_lshr_b32 s73, s71, 1
    s_lshl_b32 s73, s73, 10
    s_add_u32 s73, s73, s76
    s_nop 0
    s_add_u32 s73, s73, 110592
    buffer_store_dwordx4 v[168:171], v18, s[36:39], s73 offen sc1
    v_pk_fma_f32 v[32:33], v[216:217], v[206:207], v[40:41] op_sel_hi:[1,0,1] neg_lo:[0,1,0] neg_hi:[0,1,0]
    v_pk_fma_f32 v[34:35], v[218:219], v[206:207], v[42:43] op_sel_hi:[1,0,1] neg_lo:[0,1,0] neg_hi:[0,1,0]
    v_pk_fma_f32 v[36:37], v[220:221], v[206:207], v[44:45] op_sel_hi:[1,0,1] neg_lo:[0,1,0] neg_hi:[0,1,0]
    buffer_load_dwordx4 a[48:51], v14, s[36:39], s52 offen offset:2048 sc1
    v_pk_fma_f32 v[38:39], v[222:223], v[206:207], v[46:47] op_sel_hi:[1,0,1] neg_lo:[0,1,0] neg_hi:[0,1,0]
    v_pk_fma_f32 v[32:33], v[140:141], v[206:207], v[32:33] op_sel:[0,1,0] op_sel_hi:[1,1,1]
    v_pk_fma_f32 v[34:35], v[142:143], v[206:207], v[34:35] op_sel:[0,1,0] op_sel_hi:[1,1,1]
    v_pk_fma_f32 v[36:37], v[156:157], v[206:207], v[36:37] op_sel:[0,1,0] op_sel_hi:[1,1,1]
    v_pk_fma_f32 v[38:39], v[158:159], v[206:207], v[38:39] op_sel:[0,1,0] op_sel_hi:[1,1,1]
    v_pk_fma_f32 v[48:49], v[32:33], v[32:33], s[74:75]
    v_pk_fma_f32 v[50:51], v[34:35], v[34:35], s[74:75]
    v_pk_fma_f32 v[52:53], v[36:37], v[36:37], s[74:75]
    v_pk_fma_f32 v[54:55], v[38:39], v[38:39], s[74:75]
    v_pk_fma_f32 v[48:49], v[48:49], v[32:33], v[112:113] neg_lo:[0,1,0] neg_hi:[0,1,0]
    v_pk_fma_f32 v[50:51], v[50:51], v[34:35], v[112:113] neg_lo:[0,1,0] neg_hi:[0,1,0]
    v_pk_fma_f32 v[52:53], v[52:53], v[36:37], v[112:113] neg_lo:[0,1,0] neg_hi:[0,1,0]
    v_pk_fma_f32 v[54:55], v[54:55], v[38:39], v[112:113] neg_lo:[0,1,0] neg_hi:[0,1,0]
    v_exp_f32 v64, v48
    v_exp_f32 v65, v49
    v_exp_f32 v66, v50
    v_exp_f32 v67, v51
    v_exp_f32 v68, v52
    v_exp_f32 v69, v53
    v_exp_f32 v70, v54
    v_exp_f32 v71, v55
    v_pk_add_f32 v[64:65], v[64:65], v[114:115]
    buffer_load_dwordx4 a[52:55], v14, s[36:39], s52 offen offset:3072 sc1
    v_pk_add_f32 v[66:67], v[66:67], v[114:115]
    v_pk_add_f32 v[68:69], v[68:69], v[114:115]
    v_pk_add_f32 v[70:71], v[70:71], v[114:115]
    v_rcp_f32 v64, v64
    v_rcp_f32 v65, v65
    v_rcp_f32 v66, v66
    v_rcp_f32 v67, v67
    v_rcp_f32 v68, v68
    v_rcp_f32 v69, v69
    v_rcp_f32_e64 v70, v70
    v_rcp_f32 v71, v71
    s_nop 0
    v_pk_mul_f32 v[32:33], v[32:33], v[64:65]
    v_pk_mul_f32 v[34:35], v[34:35], v[66:67]
    v_pk_mul_f32 v[36:37], v[36:37], v[68:69]
    v_pk_mul_f32 v[38:39], v[38:39], v[70:71]
    v_cvt_pk_bf16_f32 v140, v32, v33
    v_cvt_pk_bf16_f32 v141, v34, v35
    v_cvt_pk_bf16_f32 v142, v36, v37
    v_cvt_pk_bf16_f32 v143, v38, v39
    s_lshr_b32 s73, s69, 1
    s_lshl_b32 s73, s73, 10
    s_add_u32 s73, s73, s76
    s_nop 0
    s_add_u32 s73, s73, 165888
    buffer_store_dwordx4 v[140:143], v18, s[36:39], s73 offen sc1
    v_pk_fma_f32 v[32:33], v[224:225], v[206:207], v[56:57] op_sel_hi:[1,0,1] neg_lo:[0,1,0] neg_hi:[0,1,0]
    v_pk_fma_f32 v[34:35], v[226:227], v[206:207], v[58:59] op_sel_hi:[1,0,1] neg_lo:[0,1,0] neg_hi:[0,1,0]
    v_pk_fma_f32 v[36:37], v[228:229], v[206:207], v[60:61] op_sel_hi:[1,0,1] neg_lo:[0,1,0] neg_hi:[0,1,0]
    buffer_load_dwordx4 a[56:59], v15, s[36:39], s52 offen offset:0 sc1
    s_add_u32 s52, s52, 5120
    v_pk_fma_f32 v[38:39], v[230:231], v[206:207], v[62:63] op_sel_hi:[1,0,1] neg_lo:[0,1,0] neg_hi:[0,1,0]
    v_pk_fma_f32 v[32:33], v[172:173], v[206:207], v[32:33] op_sel:[0,1,0] op_sel_hi:[1,1,1]
    v_pk_fma_f32 v[34:35], v[174:175], v[206:207], v[34:35] op_sel:[0,1,0] op_sel_hi:[1,1,1]
    v_pk_fma_f32 v[36:37], v[188:189], v[206:207], v[36:37] op_sel:[0,1,0] op_sel_hi:[1,1,1]
    v_pk_fma_f32 v[38:39], v[190:191], v[206:207], v[38:39] op_sel:[0,1,0] op_sel_hi:[1,1,1]
    v_pk_fma_f32 v[48:49], v[32:33], v[32:33], s[74:75]
    v_pk_fma_f32 v[50:51], v[34:35], v[34:35], s[74:75]
    v_pk_fma_f32 v[52:53], v[36:37], v[36:37], s[74:75]
    v_pk_fma_f32 v[54:55], v[38:39], v[38:39], s[74:75]
    v_pk_fma_f32 v[48:49], v[48:49], v[32:33], v[112:113] neg_lo:[0,1,0] neg_hi:[0,1,0]
    v_pk_fma_f32 v[50:51], v[50:51], v[34:35], v[112:113] neg_lo:[0,1,0] neg_hi:[0,1,0]
    v_pk_fma_f32 v[52:53], v[52:53], v[36:37], v[112:113] neg_lo:[0,1,0] neg_hi:[0,1,0]
    v_pk_fma_f32 v[54:55], v[54:55], v[38:39], v[112:113] neg_lo:[0,1,0] neg_hi:[0,1,0]
    v_exp_f32 v64, v48
    v_exp_f32 v65, v49
    v_exp_f32 v66, v50
    v_exp_f32 v67, v51
    v_exp_f32 v68, v52
    v_exp_f32 v69, v53
    v_exp_f32 v70, v54
    v_exp_f32 v71, v55
    v_pk_add_f32 v[64:65], v[64:65], v[114:115]
    buffer_load_dwordx4 a[60:63], v14, s[36:39], s52 offen offset:0 sc1
    v_pk_add_f32 v[66:67], v[66:67], v[114:115]
    v_pk_add_f32 v[68:69], v[68:69], v[114:115]
    v_pk_add_f32 v[70:71], v[70:71], v[114:115]
    v_rcp_f32 v64, v64
    v_rcp_f32 v65, v65
    v_rcp_f32 v66, v66
    v_rcp_f32 v67, v67
    v_rcp_f32 v68, v68
    v_rcp_f32 v69, v69
    v_rcp_f32_e64 v70, v70
    v_rcp_f32 v71, v71
    s_nop 0
    v_pk_mul_f32 v[32:33], v[32:33], v[64:65]
    v_pk_mul_f32 v[34:35], v[34:35], v[66:67]
    v_pk_mul_f32 v[36:37], v[36:37], v[68:69]
    v_pk_mul_f32 v[38:39], v[38:39], v[70:71]
    v_cvt_pk_bf16_f32 v172, v32, v33
    v_cvt_pk_bf16_f32 v173, v34, v35
    v_cvt_pk_bf16_f32 v174, v36, v37
    v_cvt_pk_bf16_f32 v175, v38, v39
    s_lshr_b32 s73, s71, 1
    s_lshl_b32 s73, s73, 10
    s_add_u32 s73, s73, s76
    s_add_u32 s73, s73, 165888
    buffer_store_dwordx4 v[172:175], v18, s[36:39], s73 offen sc1
    s_lshl_b32 s48, s63, 4
    s_add_u32 s48, s48, s64
    s_lshl_b32 s48, s48, 6
    s_add_u32 s48, s48, 229376
    s_cmp_eq_u32 s3, 0
    s_cselect_b32 s48, s48, 17563648
    s_mov_b32 s50, 1
    s_lshr_b32 s78, s68, 1
    s_lshl_b32 s78, s78, 10
    s_add_u32 s29, s76, s78
C4JOIN:
    s_lshr_b32 s49, s53, 1
    s_lshl_b32 s49, s49, 10
    s_add_u32 s49, s49, 229376
    s_mul_i32 s79, s53, 216
    s_add_u32 s79, s79, s55
    s_lshl_b32 s79, s79, 10
    s_add_u32 s79, s79, 10485760
    s_add_u32 s61, s79, 14336
    s_cmp_ge_u32 s3, 2
    s_cselect_b32 s62, s79, 1
    s_lshl_b32 s60, s28, 10
    s_add_u32 s60, s60, s79
    s_add_u32 s78, s3, 0
    s_and_b32 s78, s78, 3
    s_mul_i32 s78, s78, 55296
    v_add_u32 v24, s78, v14
    s_add_u32 s78, s3, 1
    s_and_b32 s78, s78, 3
    s_mul_i32 s78, s78, 55296
    v_add_u32 v25, s78, v14
    s_add_u32 s78, s3, 2
    s_and_b32 s78, s78, 3
    s_mul_i32 s78, s78, 55296
    v_add_u32 v26, s78, v14
    s_add_u32 s78, s3, 3
    s_and_b32 s78, s78, 3
    s_mul_i32 s78, s78, 55296
    v_add_u32 v27, s78, v14
    s_mul_i32 s68, s54, 160
    v_min_u32 v18, 13, v0
    v_lshlrev_b32 v18, 6, v18
    s_waitcnt vmcnt(24) lgkmcnt(0)
    v_mov_b32_dpp v107, v100 wave_rol:1 row_mask:0xf bank_mask:0xf
    v_mov_b32_dpp v112, v101 wave_rol:1 row_mask:0xf bank_mask:0xf
    v_mov_b32_dpp v111, v116 wave_rol:1 row_mask:0xf bank_mask:0xf
    v_mov_b32_dpp v113, v117 wave_rol:1 row_mask:0xf bank_mask:0xf
    v_mov_b32 v104, v97
    v_mov_b32 v105, v98
    v_mov_b32 v106, v99
    v_mov_b32 v108, v101
    v_mov_b32 v109, v102
    v_mov_b32 v110, v103
    v_mov_b32_dpp v107, v96 wave_shl:1 row_mask:0xf bank_mask:0xf
    v_mov_b32_dpp v112, v97 wave_shl:1 row_mask:0xf bank_mask:0xf
    v_mov_b32_dpp v111, v100 wave_shl:1 row_mask:0xf bank_mask:0xf
    v_mov_b32_dpp v113, v101 wave_shl:1 row_mask:0xf bank_mask:0xf
    s_nop 1
    v_lshlrev_b32 v1, 4, v0
    v_add_u32 v5, s86, v1
    s_cmp_lg_u32 s87, 0
    s_cbranch_scc1 CV_NOPRE_7
    v_mov_b32 v20, 0
    v_mov_b32 v21, 0
    v_mov_b32 v22, 0
    v_mov_b32 v23, 0
    v_lshrrev_b32 v4, 1, v0
    v_mul_u32_u24 v4, 4160, v4
    v_and_b32 v6, 1, v0
    v_lshl_add_u32 v4, v6, 4, v4
    v_add_u32 v4, s86, v4
    s_mov_b32 exec_lo, 0xff
    s_mov_b32 exec_hi, 0
    ds_write_b128 v4, v[20:23]
    s_mov_b32 exec_lo, -1
    ds_write_b128 v5, v[20:23] offset:16640
    v_lshlrev_b32 v12, 16, v96
    v_alignbit_b32 v13, v104, v96, 16
    s_mov_b32 exec_lo, 1
    ds_write_b32 v5, v12 offset:4188
    ds_write_b32 v5, v96 offset:8348
    ds_write_b64 v5, v[12:13] offset:12504
    s_mov_b64 exec, -1
CV_NOPRE_7:
    s_lshl_b32 s78, s87, 11
    v_add_u32_e64 v5, s78, v5
    v_alignbit_b32 v32, v104, v96, 16
    v_alignbit_b32 v36, v105, v104, 16
    v_alignbit_b32 v33, v105, v97, 16
    v_alignbit_b32 v37, v106, v105, 16
    v_alignbit_b32 v34, v106, v98, 16
    v_alignbit_b32 v38, v107, v106, 16
    v_alignbit_b32 v35, v107, v99, 16
    v_alignbit_b32 v39, v112, v107, 16
    buffer_load_dwordx4 a[64:67], v14, s[36:39], s52 offen offset:1024 sc1
    buffer_load_dwordx4 a[68:71], v14, s[36:39], s52 offen offset:2048 sc1
    ds_write_b128 v5, v[96:99] offset:32
    ds_write_b128 v5, v[32:35] offset:4192
    buffer_load_dwordx4 a[72:75], v14, s[36:39], s52 offen offset:3072 sc1
    buffer_load_dwordx4 a[76:79], v15, s[36:39], s52 offen offset:0 sc1
    s_add_u32 s52, s52, 5120
    ds_write_b128 v5, v[104:107] offset:8352
    ds_write_b128 v5, v[36:39] offset:12512
    ds_write_b128 v5, v[120:123] offset:17152
    buffer_load_dwordx4 a[80:83], v14, s[36:39], s52 offen offset:0 sc1
    v_alignbit_b32 v40, v108, v100, 16
    v_alignbit_b32 v44, v109, v108, 16
    v_alignbit_b32 v41, v109, v101, 16
    v_alignbit_b32 v45, v110, v109, 16
    v_alignbit_b32 v42, v110, v102, 16
    v_alignbit_b32 v46, v111, v110, 16
    v_alignbit_b32 v43, v111, v103, 16
    v_alignbit_b32 v47, v113, v111, 16
    buffer_load_dwordx4 a[84:87], v14, s[36:39], s52 offen offset:1024 sc1
    ds_write_b128 v5, v[100:103] offset:1056
    ds_write_b128 v5, v[40:43] offset:5216
    buffer_load_dwordx4 a[88:91], v14, s[36:39], s52 offen offset:2048 sc1
    ds_write_b128 v5, v[108:111] offset:9376
    ds_write_b128 v5, v[44:47] offset:13536
    ds_write_b128 v5, v[124:127] offset:18176
    buffer_load_dwordx4 a[92:95], v14, s[36:39], s52 offen offset:3072 sc1
    v_and_b32 v6, 15, v0
    v_lshrrev_b32 v7, 4, v0
    v_add_u32 v8, 1, v6
    v_and_b32 v9, 3, v8
    v_and_b32_e64 v8, 28, v8
    v_mul_u32_u24 v9, 4160, v9
    v_lshl_add_u32 v9, v8, 1, v9
    v_lshl_add_u32 v9, v7, 4, v9
    v_add_u32 v2, s86, v9
    v_lshlrev_b32 v8, 1, v6
    v_sub_u32 v8, v8, v7
    v_lshlrev_b32 v8, 4, v8
    v_add_u32 v8, 16720, v8
    v_add_u32 v3, s86, v8
    s_lshl_b32 s78, s87, 8
    v_add_u32 v2, s78, v2
    v_subrev_u32 v3, s78, v3
    buffer_load_dwordx4 a[96:99], v15, s[36:39], s52 offen offset:0 sc1
    s_add_u32 s52, s52, 5120
    v_sub_u32 v8, 15, v6
    v_lshrrev_b32 v9, 3, v8
    v_cmp_eq_u32 s[80:81], v9, v7
    v_bfe_u32 v9, v8, 1, 2
    v_and_b32 v10, 1, v8
    v_lshlrev_b32 v10, 4, v10
    s_and_b32 s78, s84, 1
    s_lshl_b32 s78, s78, 4
    s_lshr_b32 s77, s77, s78
    s_and_b32 s77, s77, 0xffff
    s_cmp_eq_u32 s87, 0
    s_cselect_b32 s77, s77, 0
    buffer_load_dwordx4 a[100:103], v14, s[36:39], s52 offen offset:0 sc1
    v_mov_b32 v11, s77
    v_lshlrev_b32 v11, v10, v11
    v_cndmask_b32 v11, 0, v11, s[80:81]
    v_cmp_eq_u32 vcc, 0, v9
    s_nop 1
    v_cndmask_b32 v192, 0, v11, vcc
    v_cmp_eq_u32 vcc, 1, v9
    s_nop 1
    v_cndmask_b32 v193, 0, v11, vcc
    buffer_load_dwordx4 a[104:107], v14, s[36:39], s52 offen offset:1024 sc1
    v_cmp_eq_u32 vcc, 2, v9
    s_nop 1
    v_cndmask_b32 v194, 0, v11, vcc
    v_cmp_eq_u32 vcc, 3, v9
    s_nop 1
    v_cndmask_b32_e64 v195, 0, v11, vcc
    buffer_load_dwordx4 a[108:111], v14, s[36:39], s52 offen offset:2048 sc1
    buffer_load_dwordx4 a[112:115], v14, s[36:39], s52 offen offset:3072 sc1
    s_waitcnt vmcnt(13) lgkmcnt(0)
    s_barrier
    v_mov_b32 v16, s56
    v_lshlrev_b32 v17, 6, v0
    s_mov_b32 exec_lo, s50
    s_mov_b32 exec_hi, 0
    buffer_store_dword v16, v17, s[36:39], s48 offen sc1
    s_mov_b64 exec, -1
    s_nop 0
    ds_read_b128 v[64:67], v3 offset:448
    ds_read_b64 v[32:33], v2 offset:0
    ds_read_b64 v[34:35], v2 offset:8
    ds_read_b128 v[68:71], v3 offset:960
    ds_read_b64 v[36:37], v2 offset:512
    ds_read_b64 v[38:39], v2 offset:520
    ds_read_b128 v[72:75], v3 offset:1472
    ds_read_b64 v[40:41], v2 offset:1024
    ds_read_b64 v[42:43], v2 offset:1032
    ds_read_b128 v[76:79], v3 offset:1984
    ds_read_b64 v[44:45], v2 offset:1536
    ds_read_b64 v[46:47], v2 offset:1544
    ds_read_b128 v[80:83], v3 offset:2496
    ds_read_b64 v[48:49], v2 offset:2048
    ds_read_b64 v[50:51], v2 offset:2056
    ds_read_b128 v[84:87], v3 offset:3008
    ds_read_b64 v[52:53], v2 offset:2560
    ds_read_b64 v[54:55], v2 offset:2568
    ds_read_b128 v[88:91], v3 offset:3520
    ds_read_b64 v[56:57], v2 offset:3072
    ds_read_b64 v[58:59], v2 offset:3080
    ds_read_b128 v[92:95], v3 offset:4032
    ds_read_b64 v[60:61], v2 offset:3584
    ds_read_b64 v[62:63], v2 offset:3592
    s_waitcnt lgkmcnt(15)
    s_nop 0
    v_mfma_f32_16x16x32_bf16 v[160:163], v[192:195], v[64:67], 0
    ds_read_b128 v[128:131], v3 offset:384
    v_mfma_f32_16x16x32_bf16 v[164:167], v[192:195], v[68:71], 0
    ds_read_b64 v[96:97], v2 offset:64
    v_mfma_f32_16x16x32_bf16 v[168:171], v[192:195], v[72:75], 0
    ds_read_b64 v[98:99], v2 offset:72
    buffer_load_dwordx4 a[116:119], v15, s[36:39], s52 offen offset:0 sc1
    s_add_u32 s52, s52, 5120
    s_waitcnt lgkmcnt(15)
    v_mfma_f32_16x16x32_bf16 v[172:175], v[192:195], v[76:79], 0
    ds_read_b128 v[132:135], v3 offset:896
    s_waitcnt lgkmcnt(15)
    v_mfma_f32_16x16x32_bf16 v[176:179], v[192:195], v[80:83], 0
    ds_read_b64 v[100:101], v2 offset:576
    s_waitcnt lgkmcnt(13)
    v_mfma_f32_16x16x32_bf16 v[180:183], v[192:195], v[84:87], 0
    ds_read_b64 v[102:103], v2 offset:584
    s_waitcnt lgkmcnt(11)
    v_mfma_f32_16x16x32_bf16 v[184:187], v[192:195], v[88:91], 0
    ds_read_b128 v[136:139], v3 offset:1408
    s_waitcnt lgkmcnt(9)
    v_mfma_f32_16x16x32_bf16 v[188:191], v[192:195], v[92:95], 0
    ds_read_b64 v[104:105], v2 offset:1088
    buffer_load_dwordx4 a[120:123], v14, s[36:39], s52 offen offset:0 sc1
    s_waitcnt lgkmcnt(8)
    v_mfma_f32_16x16x32_bf16 v[160:163], v[32:35], v[64:67], v[160:163]
    ds_read_b64 v[106:107], v2 offset:1096
    v_mfma_f32_16x16x32_bf16 v[164:167], v[32:35], v[68:71], v[164:167]
    ds_read_b128 v[140:143], v3 offset:1920
    v_mfma_f32_16x16x32_bf16 v[168:171], v[32:35], v[72:75], v[168:171]
    ds_read_b64 v[108:109], v2 offset:1600
    v_mfma_f32_16x16x32_bf16 v[172:175], v[32:35], v[76:79], v[172:175]
    ds_read_b64 v[110:111], v2 offset:1608
    v_mfma_f32_16x16x32_bf16 v[176:179], v[32:35], v[80:83], v[176:179]
    ds_read_b128 v[144:147], v3 offset:2432
    buffer_load_dwordx4 a[124:127], v14, s[36:39], s52 offen offset:1024 sc1
    v_mfma_f32_16x16x32_bf16 v[180:183], v[32:35], v[84:87], v[180:183]
    ds_read_b64 v[112:113], v2 offset:2112
    v_mfma_f32_16x16x32_bf16 v[184:187], v[32:35], v[88:91], v[184:187]
    ds_read_b64 v[114:115], v2 offset:2120
    v_mfma_f32_16x16x32_bf16 v[188:191], v[32:35], v[92:95], v[188:191]
    ds_read_b128 v[148:151], v3 offset:2944
    v_mfma_f32_16x16x32_bf16 v[164:167], v[36:39], v[64:67], v[164:167]
    ds_read_b64 v[116:117], v2 offset:2624
    v_mfma_f32_16x16x32_bf16 v[168:171], v[36:39], v[68:71], v[168:171]
    ds_read_b64 v[118:119], v2 offset:2632
    buffer_load_dwordx4 a[128:131], v14, s[36:39], s52 offen offset:2048 sc1
    v_mfma_f32_16x16x32_bf16 v[172:175], v[36:39], v[72:75], v[172:175]
    ds_read_b128 v[152:155], v3 offset:3456
    v_mfma_f32_16x16x32_bf16 v[176:179], v[36:39], v[76:79], v[176:179]
    ds_read_b64 v[120:121], v2 offset:3136
    v_mfma_f32_16x16x32_bf16 v[180:183], v[36:39], v[80:83], v[180:183]
    ds_read_b64 v[122:123], v2 offset:3144
    v_mfma_f32_16x16x32_bf16 v[184:187], v[36:39], v[84:87], v[184:187]
    ds_read_b128 v[156:159], v3 offset:3968
    v_mfma_f32_16x16x32_bf16 v[188:191], v[36:39], v[88:91], v[188:191]
    ds_read_b64 v[124:125], v2 offset:3648
    buffer_load_dwordx4 a[132:135], v14, s[36:39], s52 offen offset:3072 sc1
    v_mfma_f32_16x16x32_bf16 v[168:171], v[40:43], v[64:67], v[168:171]
    ds_read_b64 v[126:127], v2 offset:3656
    v_mfma_f32_16x16x32_bf16 v[172:175], v[40:43], v[68:71], v[172:175]
    v_mfma_f32_16x16x32_bf16 v[176:179], v[40:43], v[72:75], v[176:179]
    v_mfma_f32_16x16x32_bf16 v[180:183], v[40:43], v[76:79], v[180:183]
    buffer_load_dwordx4 a[136:139], v15, s[36:39], s52 offen offset:0 sc1
    s_add_u32 s52, s52, 5120
    v_mfma_f32_16x16x32_bf16 v[184:187], v[40:43], v[80:83], v[184:187]
    v_mfma_f32_16x16x32_bf16 v[188:191], v[40:43], v[84:87], v[188:191]
    v_mfma_f32_16x16x32_bf16 v[172:175], v[44:47], v[64:67], v[172:175]
    v_mfma_f32_16x16x32_bf16 v[176:179], v[44:47], v[68:71], v[176:179]
    v_mfma_f32_16x16x32_bf16 v[180:183], v[44:47], v[72:75], v[180:183]
    buffer_load_dwordx4 a[140:143], v14, s[36:39], s52 offen offset:0 sc1
PAGE4:
    s_cbranch_execz VISIT_RET
    v_mfma_f32_16x16x32_bf16 v[184:187], v[44:47], v[76:79], v[184:187]
    v_mfma_f32_16x16x32_bf16 v[188:191], v[44:47], v[80:83], v[188:191]
    v_mfma_f32_16x16x32_bf16 v[176:179], v[48:51], v[64:67], v[176:179]
    v_mfma_f32_16x16x32_bf16 v[180:183], v[48:51], v[68:71], v[180:183]
    v_mfma_f32_16x16x32_bf16 v[184:187], v[48:51], v[72:75], v[184:187]
    buffer_load_dwordx4 a[144:147], v14, s[36:39], s52 offen offset:1024 sc1
    v_mfma_f32_16x16x32_bf16 v[188:191], v[48:51], v[76:79], v[188:191]
    v_mfma_f32_16x16x32_bf16 v[180:183], v[52:55], v[64:67], v[180:183]
    v_mfma_f32_16x16x32_bf16 v[184:187], v[52:55], v[68:71], v[184:187]
    v_mfma_f32_16x16x32_bf16 v[188:191], v[52:55], v[72:75], v[188:191]
    v_mfma_f32_16x16x32_bf16 v[184:187], v[56:59], v[64:67], v[184:187]
    buffer_load_dwordx4 a[148:151], v14, s[36:39], s52 offen offset:2048 sc1
    v_mfma_f32_16x16x32_bf16 v[188:191], v[56:59], v[68:71], v[188:191]
    v_mfma_f32_16x16x32_bf16 v[188:191], v[60:63], v[64:67], v[188:191]
    s_waitcnt lgkmcnt(0)
    v_mfma_f32_16x16x32_bf16 v[160:163], v[96:99], v[128:131], v[160:163]
    ds_read_b128 v[64:67], v3 offset:320
    v_and_b32_e64 v20, 15, v0
    v_mfma_f32_16x16x32_bf16 v[164:167], v[96:99], v[132:135], v[164:167]
    ds_read_b64 v[32:33], v2 offset:128
    buffer_load_dwordx4 a[152:155], v14, s[36:39], s52 offen offset:3072 sc1
    v_mfma_f32_16x16x32_bf16 v[168:171], v[96:99], v[136:139], v[168:171]
    ds_read_b64 v[34:35], v2 offset:136
    v_mfma_f32_16x16x32_bf16 v[172:175], v[96:99], v[140:143], v[172:175]
    ds_read_b128 v[68:71], v3 offset:832
    v_mfma_f32_16x16x32_bf16 v[176:179], v[96:99], v[144:147], v[176:179]
    ds_read_b64 v[36:37], v2 offset:640
    v_lshrrev_b32_e64 v21, 4, v0
    v_mfma_f32_16x16x32_bf16 v[180:183], v[96:99], v[148:151], v[180:183]
    ds_read_b64 v[38:39], v2 offset:648
    buffer_load_dwordx4 a[156:159], v15, s[36:39], s52 offen offset:0 sc1
    s_add_u32 s52, s52, 5120
    v_mfma_f32_16x16x32_bf16 v[184:187], v[96:99], v[152:155], v[184:187]
    ds_read_b128 v[72:75], v3 offset:1344
    v_mfma_f32_16x16x32_bf16 v[188:191], v[96:99], v[156:159], v[188:191]
    ds_read_b64 v[40:41], v2 offset:1152
    v_mfma_f32_16x16x32_bf16 v[164:167], v[100:103], v[128:131], v[164:167]
    ds_read_b64 v[42:43], v2 offset:1160
    v_mfma_f32_16x16x32_bf16 v[168:171], v[100:103], v[132:135], v[168:171]
    ds_read_b128 v[76:79], v3 offset:1856
    buffer_load_dwordx4 a[160:163], v14, s[36:39], s52 offen offset:0 sc1
    v_mfma_f32_16x16x32_bf16 v[172:175], v[100:103], v[136:139], v[172:175]
    ds_read_b64 v[44:45], v2 offset:1664
    s_lshl_b32 s69, s53, 6
    s_nop 0
    v_mfma_f32_16x16x32_bf16 v[176:179], v[100:103], v[140:143], v[176:179]
    ds_read_b64 v[46:47], v2 offset:1672
    v_mfma_f32_16x16x32_bf16 v[180:183], v[100:103], v[144:147], v[180:183]
    ds_read_b128 v[80:83], v3 offset:2368
    buffer_load_dwordx4 a[164:167], v14, s[36:39], s52 offen offset:1024 sc1
    v_mfma_f32_16x16x32_bf16 v[184:187], v[100:103], v[148:151], v[184:187]
    ds_read_b64 v[48:49], v2 offset:2176
    v_mfma_f32_16x16x32_bf16 v[188:191], v[100:103], v[152:155], v[188:191]
    ds_read_b64 v[50:51], v2 offset:2184
    v_mfma_f32_16x16x32_bf16 v[168:171], v[104:107], v[128:131], v[168:171]
    ds_read_b128 v[84:87], v3 offset:2880
    s_lshl_b32 s70, s3, 4
    s_nop 0
    v_mfma_f32_16x16x32_bf16 v[172:175], v[104:107], v[132:135], v[172:175]
    ds_read_b64 v[52:53], v2 offset:2688
    buffer_load_dwordx4 a[168:171], v14, s[36:39], s52 offen offset:2048 sc1
    v_mfma_f32_16x16x32_bf16 v[176:179], v[104:107], v[136:139], v[176:179]
    ds_read_b64 v[54:55], v2 offset:2696
    v_mfma_f32_16x16x32_bf16 v[180:183], v[104:107], v[140:143], v[180:183]
    ds_read_b128 v[88:91], v3 offset:3392
    v_mfma_f32_16x16x32_bf16 v[184:187], v[104:107], v[144:147], v[184:187]
    ds_read_b64 v[56:57], v2 offset:3200
    buffer_load_dwordx4 a[172:175], v14, s[36:39], s52 offen offset:3072 sc1
    v_mfma_f32_16x16x32_bf16 v[188:191], v[104:107], v[148:151], v[188:191]
    ds_read_b64 v[58:59], v2 offset:3208
    v_mfma_f32_16x16x32_bf16 v[172:175], v[108:111], v[128:131], v[172:175]
    ds_read_b128 v[92:95], v3 offset:3904
    s_add_u32 s70, s70, s69
    v_mfma_f32_16x16x32_bf16 v[176:179], v[108:111], v[132:135], v[176:179]
    ds_read_b64 v[60:61], v2 offset:3712
    v_mfma_f32_16x16x32_bf16 v[180:183], v[108:111], v[136:139], v[180:183]
    ds_read_b64 v[62:63], v2 offset:3720
    buffer_load_dwordx4 a[176:179], v15, s[36:39], s52 offen offset:0 sc1
    s_add_u32 s52, s52, 5120
    v_mfma_f32_16x16x32_bf16 v[184:187], v[108:111], v[140:143], v[184:187]
    v_mfma_f32_16x16x32_bf16 v[188:191], v[108:111], v[144:147], v[188:191]
    v_add_u32 v22, s70, v20
    v_mfma_f32_16x16x32_bf16 v[176:179], v[112:115], v[128:131], v[176:179]
    v_mul_u32_u24 v28, 1280, v22
    v_mfma_f32_16x16x32_bf16 v[180:183], v[112:115], v[132:135], v[180:183]
    buffer_load_dwordx4 a[180:183], v14, s[36:39], s52 offen offset:0 sc1
    v_mfma_f32_16x16x32_bf16 v[184:187], v[112:115], v[136:139], v[184:187]
    v_mfma_f32_16x16x32_bf16 v[188:191], v[112:115], v[140:143], v[188:191]
    v_lshl_add_u32 v29, v21, 3, v28
    v_mfma_f32_16x16x32_bf16 v[180:183], v[116:119], v[128:131], v[180:183]
    buffer_load_dwordx4 a[184:187], v14, s[36:39], s52 offen offset:1024 sc1
    v_mfma_f32_16x16x32_bf16 v[184:187], v[116:119], v[132:135], v[184:187]
    v_lshl_add_u32 v28, v21, 4, v28
    v_mfma_f32_16x16x32_bf16 v[188:191], v[116:119], v[136:139], v[188:191]
    v_mfma_f32_16x16x32_bf16 v[184:187], v[120:123], v[128:131], v[184:187]
    v_lshlrev_b32 v22, 3, v22
    v_mfma_f32_16x16x32_bf16 v[188:191], v[120:123], v[132:135], v[188:191]
    buffer_load_dwordx4 a[188:191], v14, s[36:39], s52 offen offset:2048 sc1
    v_mfma_f32_16x16x32_bf16 v[188:191], v[124:127], v[128:131], v[188:191]
    s_waitcnt lgkmcnt(0)
    v_mfma_f32_16x16x32_bf16 v[160:163], v[32:35], v[64:67], v[160:163]
    ds_read_b128 v[128:131], v3 offset:256
    v_mfma_f32_16x16x32_bf16 v[164:167], v[32:35], v[68:71], v[164:167]
    ds_read_b64 v[96:97], v2 offset:192
    buffer_load_dwordx4 a[192:195], v14, s[36:39], s52 offen offset:3072 sc1
    v_mfma_f32_16x16x32_bf16 v[168:171], v[32:35], v[72:75], v[168:171]
    ds_read_b64 v[98:99], v2 offset:200
    v_mfma_f32_16x16x32_bf16 v[172:175], v[32:35], v[76:79], v[172:175]
    ds_read_b128 v[132:135], v3 offset:768
    v_mfma_f32_16x16x32_bf16 v[176:179], v[32:35], v[80:83], v[176:179]
    ds_read_b64 v[100:101], v2 offset:704
    buffer_load_dwordx4 a[196:199], v15, s[36:39], s52 offen offset:0 sc1
    s_add_u32 s52, s52, 5120
    v_mfma_f32_16x16x32_bf16 v[180:183], v[32:35], v[84:87], v[180:183]
    ds_read_b64 v[102:103], v2 offset:712
    v_mfma_f32_16x16x32_bf16 v[184:187], v[32:35], v[88:91], v[184:187]
    ds_read_b128 v[136:139], v3 offset:1280
    v_mfma_f32_16x16x32_bf16 v[188:191], v[32:35], v[92:95], v[188:191]
    ds_read_b64 v[104:105], v2 offset:1216
    v_mfma_f32_16x16x32_bf16 v[164:167], v[36:39], v[64:67], v[164:167]
    ds_read_b64 v[106:107], v2 offset:1224
    buffer_load_dwordx4 a[200:203], v14, s[36:39], s52 offen offset:0 sc1
    v_mfma_f32_16x16x32_bf16 v[168:171], v[36:39], v[68:71], v[168:171]
    ds_read_b128 v[140:143], v3 offset:1792
    v_mfma_f32_16x16x32_bf16 v[172:175], v[36:39], v[72:75], v[172:175]
    ds_read_b64 v[108:109], v2 offset:1728
    v_mfma_f32_16x16x32_bf16 v[176:179], v[36:39], v[76:79], v[176:179]
    ds_read_b64 v[110:111], v2 offset:1736
    buffer_load_dwordx4 a[204:207], v14, s[36:39], s52 offen offset:1024 sc1
    v_mfma_f32_16x16x32_bf16 v[180:183], v[36:39], v[80:83], v[180:183]
    ds_read_b128 v[144:147], v3 offset:2304
    v_mfma_f32_16x16x32_bf16 v[184:187], v[36:39], v[84:87], v[184:187]
    ds_read_b64 v[112:113], v2 offset:2240
    v_mfma_f32_16x16x32_bf16 v[188:191], v[36:39], v[88:91], v[188:191]
    ds_read_b64 v[114:115], v2 offset:2248
    buffer_load_dwordx4 a[208:211], v14, s[36:39], s52 offen offset:2048 sc1
    v_mfma_f32_16x16x32_bf16 v[168:171], v[40:43], v[64:67], v[168:171]
    ds_read_b128 v[148:151], v3 offset:2816
    v_mfma_f32_16x16x32_bf16 v[172:175], v[40:43], v[68:71], v[172:175]
    ds_read_b64 v[116:117], v2 offset:2752
    v_mfma_f32_16x16x32_bf16 v[176:179], v[40:43], v[72:75], v[176:179]
    ds_read_b64 v[118:119], v2 offset:2760
    v_mfma_f32_16x16x32_bf16 v[180:183], v[40:43], v[76:79], v[180:183]
    ds_read_b128 v[152:155], v3 offset:3328
    buffer_load_dwordx4 a[212:215], v14, s[36:39], s52 offen offset:3072 sc1
    v_mfma_f32_16x16x32_bf16 v[184:187], v[40:43], v[80:83], v[184:187]
    ds_read_b64 v[120:121], v2 offset:3264
    v_mfma_f32_16x16x32_bf16 v[188:191], v[40:43], v[84:87], v[188:191]
    ds_read_b64 v[122:123], v2 offset:3272
    v_mfma_f32_16x16x32_bf16 v[172:175], v[44:47], v[64:67], v[172:175]
    ds_read_b128 v[156:159], v3 offset:3840
    buffer_load_dwordx4 a[216:219], v15, s[36:39], s52 offen offset:0 sc1
    s_add_u32 s52, s52, 5120
    v_mfma_f32_16x16x32_bf16 v[176:179], v[44:47], v[68:71], v[176:179]
    ds_read_b64 v[124:125], v2 offset:3776
    v_mfma_f32_16x16x32_bf16 v[180:183], v[44:47], v[72:75], v[180:183]
    ds_read_b64 v[126:127], v2 offset:3784
    v_mfma_f32_16x16x32_bf16 v[184:187], v[44:47], v[76:79], v[184:187]
    buffer_load_dwordx4 a[220:223], v14, s[36:39], s52 offen offset:0 sc1
    v_mfma_f32_16x16x32_bf16 v[188:191], v[44:47], v[80:83], v[188:191]
    v_mfma_f32_16x16x32_bf16 v[176:179], v[48:51], v[64:67], v[176:179]
    v_mfma_f32_16x16x32_bf16 v[180:183], v[48:51], v[68:71], v[180:183]
    buffer_load_dwordx4 a[224:227], v14, s[36:39], s52 offen offset:1024 sc1
    v_mfma_f32_16x16x32_bf16 v[184:187], v[48:51], v[72:75], v[184:187]
    v_mfma_f32_16x16x32_bf16 v[188:191], v[48:51], v[76:79], v[188:191]
    v_mfma_f32_16x16x32_bf16 v[180:183], v[52:55], v[64:67], v[180:183]
    v_mfma_f32_16x16x32_bf16 v[184:187], v[52:55], v[68:71], v[184:187]
    buffer_load_dwordx4 a[228:231], v14, s[36:39], s52 offen offset:2048 sc1
    v_mfma_f32_16x16x32_bf16 v[188:191], v[52:55], v[72:75], v[188:191]
    v_mfma_f32_16x16x32_bf16 v[184:187], v[56:59], v[64:67], v[184:187]
    v_mfma_f32_16x16x32_bf16 v[188:191], v[56:59], v[68:71], v[188:191]
    buffer_load_dwordx4 a[232:235], v14, s[36:39], s52 offen offset:3072 sc1
    v_mfma_f32_16x16x32_bf16 v[188:191], v[60:63], v[64:67], v[188:191]
    s_waitcnt lgkmcnt(0)
    s_nop 0
    v_mfma_f32_16x16x32_bf16 v[160:163], v[96:99], v[128:131], v[160:163]
    v_mfma_f32_16x16x32_bf16 v[164:167], v[96:99], v[132:135], v[164:167]
    buffer_load_dwordx4 a[236:239], v15, s[36:39], s52 offen offset:0 sc1
    s_add_u32 s52, s52, 5120
    v_mfma_f32_16x16x32_bf16 v[168:171], v[96:99], v[136:139], v[168:171]
    v_mfma_f32_16x16x32_bf16 v[172:175], v[96:99], v[140:143], v[172:175]
    v_mfma_f32_16x16x32_bf16 v[176:179], v[96:99], v[144:147], v[176:179]
    buffer_load_dwordx4 v[196:199], v14, s[36:39], s52 offen offset:0 sc1
    v_mfma_f32_16x16x32_bf16 v[180:183], v[96:99], v[148:151], v[180:183]
    v_mfma_f32_16x16x32_bf16 v[184:187], v[96:99], v[152:155], v[184:187]
    v_mfma_f32_16x16x32_bf16 v[188:191], v[96:99], v[156:159], v[188:191]
    v_mfma_f32_16x16x32_bf16 v[164:167], v[100:103], v[128:131], v[164:167]
    buffer_load_dwordx4 v[200:203], v14, s[36:39], s52 offen offset:1024 sc1
    v_mfma_f32_16x16x32_bf16 v[168:171], v[100:103], v[132:135], v[168:171]
    v_mfma_f32_16x16x32_bf16 v[172:175], v[100:103], v[136:139], v[172:175]
    buffer_load_dword v19, v18, s[36:39], s49 offen sc1
    v_mfma_f32_16x16x32_bf16 v[176:179], v[100:103], v[140:143], v[176:179]
    buffer_load_dwordx4 v[204:207], v14, s[36:39], s52 offen offset:2048 sc1
    v_mfma_f32_16x16x32_bf16 v[180:183], v[100:103], v[144:147], v[180:183]
    v_mfma_f32_16x16x32_bf16 v[184:187], v[100:103], v[148:151], v[184:187]
    v_mfma_f32_16x16x32_bf16 v[188:191], v[100:103], v[152:155], v[188:191]
    buffer_load_dwordx4 v[208:211], v14, s[36:39], s52 offen offset:3072 sc1
    v_mfma_f32_16x16x32_bf16 v[168:171], v[104:107], v[128:131], v[168:171]
    v_mfma_f32_16x16x32_bf16 v[172:175], v[104:107], v[132:135], v[172:175]
    v_mfma_f32_16x16x32_bf16 v[176:179], v[104:107], v[136:139], v[176:179]
    v_mfma_f32_16x16x32_bf16 v[180:183], v[104:107], v[140:143], v[180:183]
    buffer_load_dwordx4 v[212:215], v15, s[36:39], s52 offen offset:0 sc1
    s_add_u32 s52, s52, 5120
    v_mfma_f32_16x16x32_bf16 v[184:187], v[104:107], v[144:147], v[184:187]
    v_mfma_f32_16x16x32_bf16 v[188:191], v[104:107], v[148:151], v[188:191]
    v_mfma_f32_16x16x32_bf16 v[172:175], v[108:111], v[128:131], v[172:175]
    buffer_load_dwordx4 v[216:219], v14, s[36:39], s52 offen offset:0 sc1
    v_mfma_f32_16x16x32_bf16 v[176:179], v[108:111], v[132:135], v[176:179]
    v_mfma_f32_16x16x32_bf16 v[180:183], v[108:111], v[136:139], v[180:183]
    v_mfma_f32_16x16x32_bf16 v[184:187], v[108:111], v[140:143], v[184:187]
    buffer_load_dwordx4 v[220:223], v14, s[36:39], s52 offen offset:1024 sc1
    v_mfma_f32_16x16x32_bf16 v[188:191], v[108:111], v[144:147], v[188:191]
    v_mfma_f32_16x16x32_bf16 v[176:179], v[112:115], v[128:131], v[176:179]
    v_mfma_f32_16x16x32_bf16 v[180:183], v[112:115], v[132:135], v[180:183]
    buffer_load_dwordx4 v[224:227], v14, s[36:39], s52 offen offset:2048 sc1
    v_mfma_f32_16x16x32_bf16 v[184:187], v[112:115], v[136:139], v[184:187]
    v_mfma_f32_16x16x32_bf16 v[188:191], v[112:115], v[140:143], v[188:191]
    v_mfma_f32_16x16x32_bf16 v[180:183], v[116:119], v[128:131], v[180:183]
    v_mfma_f32_16x16x32_bf16 v[184:187], v[116:119], v[132:135], v[184:187]
    buffer_load_dwordx4 v[228:231], v14, s[36:39], s52 offen offset:3072 sc1
    v_mfma_f32_16x16x32_bf16 v[188:191], v[116:119], v[136:139], v[188:191]
    v_mfma_f32_16x16x32_bf16 v[184:187], v[120:123], v[128:131], v[184:187]
    v_mfma_f32_16x16x32_bf16 v[188:191], v[120:123], v[132:135], v[188:191]
    buffer_load_dwordx4 v[232:235], v15, s[36:39], s52 offen offset:0 sc1
    v_mfma_f32_16x16x32_bf16 v[188:191], v[124:127], v[128:131], v[188:191]
    s_nop 3
    s_waitcnt vmcnt(8)
    v_cmp_ne_u32 vcc, s56, v19
    s_mov_b64 s[82:83], vcc
    s_cmp_eq_u64 s[82:83], 0
    s_cbranch_scc0 FH_RETRY_8
FH_DONE_9:
    s_mov_b32 s71, 65536
    buffer_load_dwordx2 v[254:255], v22, s[36:39], s71 offen sc1
    s_cmp_eq_u32 s60, s62
    s_cselect_b32 s63, 17563648, s60
    buffer_load_dwordx4 v[48:51], v24, s[36:39], s63 offen offset:0 sc1
    v_lshlrev_b32 v9, 4, v0
    buffer_load_dwordx4 v[52:55], v25, s[36:39], s63 offen offset:0 sc1
    s_lshl_b32 s78, s3, 12
    buffer_load_dwordx4 v[56:59], v26, s[36:39], s63 offen offset:0 sc1
    s_add_u32 s78, s78, 84992
    v_add_u32 v10, s78, v9
    buffer_load_dwordx4 v[60:63], v27, s[36:39], s63 offen offset:0 sc1
    s_xor_b32 s78, s3, 1
    buffer_load_dwordx4 v[64:67], v24, s[36:39], s60 offen offset:1024 sc1
    s_lshl_b32 s78, s78, 12
    s_add_u32 s78, s78, 84992
    buffer_load_dwordx4 v[68:71], v25, s[36:39], s60 offen offset:1024 sc1
    v_add_u32 v11, s78, v9
    buffer_load_dwordx4 v[72:75], v26, s[36:39], s60 offen offset:1024 sc1
    s_cmp_lg_u32 s87, 0
    s_cselect_b32 s78, -1, 0
    buffer_load_dwordx4 v[76:79], v27, s[36:39], s60 offen offset:1024 sc1
    s_mov_b32 exec_lo, s78
    s_mov_b32 exec_hi, s78
    v_swap_b32 v160, v176
    v_swap_b32 v161, v177
    v_swap_b32 v162, v178
    v_swap_b32 v163, v179
    s_mov_b64 exec, -1
    ds_write_b128 v10, v[176:179] offset:0
    buffer_load_dwordx4 v[80:83], v24, s[36:39], s60 offen offset:2048 sc1
    s_mov_b32 exec_lo, s78
    s_mov_b32 exec_hi, s78
    v_swap_b32 v164, v180
    v_swap_b32 v165, v181
    v_swap_b32 v166, v182
    v_swap_b32 v167, v183
    s_mov_b64 exec, -1
    buffer_load_dwordx4 v[84:87], v25, s[36:39], s60 offen offset:2048 sc1
    ds_write_b128 v10, v[180:183] offset:1024
    s_mov_b32 exec_lo, s78
    s_mov_b32 exec_hi, s78
    v_swap_b32 v168, v184
    v_swap_b32 v169, v185
    v_swap_b32 v170, v186
    v_swap_b32 v171, v187
    s_mov_b64 exec, -1
    buffer_load_dwordx4 v[88:91], v26, s[36:39], s60 offen offset:2048 sc1
    ds_write_b128 v10, v[184:187] offset:2048
    buffer_load_dwordx4 v[92:95], v27, s[36:39], s60 offen offset:2048 sc1
    s_mov_b32 exec_lo, s78
    s_mov_b32 exec_hi, s78
    v_swap_b32 v172, v188
    v_swap_b32 v173, v189
    v_swap_b32 v174, v190
    v_swap_b32 v175, v191
    s_mov_b64 exec, -1
    ds_write_b128 v10, v[188:191] offset:3072
    s_waitcnt lgkmcnt(0)
    s_barrier
    s_nop 0
    buffer_load_dwordx4 v[96:99], v24, s[36:39], s60 offen offset:3072 sc1
    ds_read_b128 v[32:35], v11 offset:0
    ds_read_b128 v[36:39], v11 offset:1024
    ds_read_b128 v[40:43], v11 offset:2048
    ds_read_b128 v[44:47], v11 offset:3072
    s_waitcnt lgkmcnt(0)
    s_nop 0
    v_pk_add_f32 v[160:161], v[160:161], v[32:33]
    v_pk_add_f32 v[162:163], v[162:163], v[34:35]
    v_pk_add_f32 v[164:165], v[164:165], v[36:37]
    buffer_load_dwordx4 v[100:103], v25, s[36:39], s60 offen offset:3072 sc1
    v_pk_add_f32 v[166:167], v[166:167], v[38:39]
    v_pk_add_f32 v[168:169], v[168:169], v[40:41]
    v_pk_add_f32 v[170:171], v[170:171], v[42:43]
    v_pk_add_f32 v[172:173], v[172:173], v[44:45]
    v_pk_add_f32 v[174:175], v[174:175], v[46:47]
    s_lshl_b32 s79, s87, 11
    s_add_u32 s79, s79, s85
    s_add_u32 s79, s79, 7340032
    v_bfe_u32 v8, v0, 4, 1
    buffer_load_dwordx4 v[236:239], v26, s[36:39], s60 offen offset:3072 sc1
    v_lshlrev_b32 v8, 9, v8
    v_and_b32 v9, 15, v0
    v_lshl_add_u32 v8, v9, 5, v8
    v_lshrrev_b32_e64 v9, 5, v0
    v_lshl_add_u32 v8, v9, 4, v8
    v_cvt_pk_bf16_f32 v32, v160, v161
    v_cvt_pk_bf16_f32 v33, v162, v163
    v_cvt_pk_bf16_f32 v34, v164, v165
    v_cvt_pk_bf16_f32 v35, v166, v167
    buffer_load_dwordx4 v[240:243], v27, s[36:39], s60 offen offset:3072 sc1
    s_add_u32 s60, s60, 4096
    v_cvt_pk_bf16_f32 v36, v168, v169
    v_cvt_pk_bf16_f32 v37, v170, v171
    v_cvt_pk_bf16_f32 v38, v172, v173
    v_cvt_pk_bf16_f32 v39, v174, v175
    s_nop 1
    v_permlane16_swap_b32 v32, v34
    v_permlane16_swap_b32 v33, v35
    v_permlane16_swap_b32 v36, v38
    v_permlane16_swap_b32 v37, v39
    buffer_store_dwordx4 v[32:35], v8, s[36:39], s79 offen offset:0 sc1
    buffer_store_dwordx4 v[36:39], v8, s[36:39], s79 offen offset:1024 sc1
G2_START:
    s_lshr_b32 s72, s84, 1
    s_lshl_b32 s72, s72, 6
    s_add_u32 s72, s72, 262144
    s_cmp_eq_u32 s3, 0
    s_cselect_b32 s72, s72, 17563648
    s_mul_i32 s59, s54, 2560
    s_add_u32 s59, s59, 262144
    v_min_u32 v18, 39, v0
    v_lshlrev_b32 v18, 6, v18
    v_accvgpr_read_b32 v105, a240
    v_accvgpr_read_b32 v107, a241
    v_accvgpr_read_b32 v109, a242
    v_accvgpr_read_b32 v111, a243
    v_accvgpr_read_b32 v113, a244
    v_accvgpr_read_b32 v115, a245
    v_accvgpr_read_b32 v117, a246
    v_accvgpr_read_b32 v119, a247
    v_accvgpr_read_b32 v121, a248
    v_accvgpr_read_b32 v123, a249
    v_lshlrev_b32 v104, 16, v105
    v_and_b32 v105, 0xffff0000, v105
    v_lshlrev_b32 v106, 16, v107
    v_and_b32 v107, 0xffff0000, v107
    v_lshlrev_b32 v108, 16, v109
    v_and_b32 v109, 0xffff0000, v109
    v_lshlrev_b32 v110, 16, v111
    v_and_b32 v111, 0xffff0000, v111
    v_lshlrev_b32 v112, 16, v113
    v_and_b32 v113, 0xffff0000, v113
    v_lshlrev_b32 v114, 16, v115
    v_and_b32 v115, 0xffff0000, v115
    v_lshlrev_b32 v116, 16, v117
    v_and_b32 v117, 0xffff0000, v117
    v_lshlrev_b32 v118, 16, v119
    v_and_b32 v119, 0xffff0000, v119
    v_lshlrev_b32 v120, 16, v121
    v_and_b32 v121, 0xffff0000, v121
    v_lshlrev_b32 v122, 16, v123
    v_and_b32 v123, 0xffff0000, v123
    s_waitcnt vmcnt(14)
    v_mfma_f32_16x16x32_bf16 v[104:107], a[0:3], v[48:51], v[104:107]
    v_mfma_f32_16x16x32_bf16 v[124:127], a[0:3], v[52:55], 0
    buffer_load_dwordx4 v[32:35], v24, s[36:39], s60 offen offset:0 sc1
    v_mfma_f32_16x16x32_bf16 v[144:147], a[0:3], v[56:59], 0
    v_mfma_f32_16x16x32_bf16 v[164:167], a[0:3], v[60:63], 0
    v_mfma_f32_16x16x32_bf16 v[108:111], a[4:7], v[48:51], v[108:111]
    v_mfma_f32_16x16x32_bf16 v[128:131], a[4:7], v[52:55], 0
    buffer_load_dwordx4 v[36:39], v25, s[36:39], s60 offen offset:0 sc1
    v_mfma_f32_16x16x32_bf16 v[148:151], a[4:7], v[56:59], 0
    v_mfma_f32_16x16x32_bf16 v[168:171], a[4:7], v[60:63], 0
    v_mfma_f32_16x16x32_bf16 v[112:115], a[8:11], v[48:51], v[112:115]
    v_mfma_f32_16x16x32_bf16 v[132:135], a[8:11], v[52:55], 0
    buffer_load_dwordx4 v[40:43], v26, s[36:39], s60 offen offset:0 sc1
    v_mfma_f32_16x16x32_bf16 v[152:155], a[8:11], v[56:59], 0
    v_mfma_f32_16x16x32_bf16 v[172:175], a[8:11], v[60:63], 0
    v_mfma_f32_16x16x32_bf16 v[116:119], a[12:15], v[48:51], v[116:119]
    v_mfma_f32_16x16x32_bf16 v[136:139], a[12:15], v[52:55], 0
    buffer_load_dwordx4 v[44:47], v27, s[36:39], s60 offen offset:0 sc1
    v_mfma_f32_16x16x32_bf16 v[156:159], a[12:15], v[56:59], 0
    v_mfma_f32_16x16x32_bf16 v[176:179], a[12:15], v[60:63], 0
    v_mfma_f32_16x16x32_bf16 v[120:123], a[16:19], v[48:51], v[120:123]
    v_mfma_f32_16x16x32_bf16 v[140:143], a[16:19], v[52:55], 0
    v_mfma_f32_16x16x32_bf16 v[160:163], a[16:19], v[56:59], 0
    v_mfma_f32_16x16x32_bf16 v[180:183], a[16:19], v[60:63], 0
    s_waitcnt vmcnt(14)
    v_mfma_f32_16x16x32_bf16 v[104:107], a[20:23], v[64:67], v[104:107]
    v_mfma_f32_16x16x32_bf16 v[124:127], a[20:23], v[68:71], v[124:127]
    buffer_load_dwordx4 v[48:51], v24, s[36:39], s60 offen offset:1024 sc1
    v_mfma_f32_16x16x32_bf16 v[144:147], a[20:23], v[72:75], v[144:147]
    v_mfma_f32_16x16x32_bf16 v[164:167], a[20:23], v[76:79], v[164:167]
    v_mfma_f32_16x16x32_bf16 v[108:111], a[24:27], v[64:67], v[108:111]
    v_mfma_f32_16x16x32_bf16 v[128:131], a[24:27], v[68:71], v[128:131]
    buffer_load_dwordx4 v[52:55], v25, s[36:39], s60 offen offset:1024 sc1
    v_mfma_f32_16x16x32_bf16 v[148:151], a[24:27], v[72:75], v[148:151]
    v_mfma_f32_16x16x32_bf16 v[168:171], a[24:27], v[76:79], v[168:171]
    v_mfma_f32_16x16x32_bf16 v[112:115], a[28:31], v[64:67], v[112:115]
    v_mfma_f32_16x16x32_bf16 v[132:135], a[28:31], v[68:71], v[132:135]
    buffer_load_dwordx4 v[56:59], v26, s[36:39], s60 offen offset:1024 sc1
    v_mfma_f32_16x16x32_bf16 v[152:155], a[28:31], v[72:75], v[152:155]
    v_mfma_f32_16x16x32_bf16 v[172:175], a[28:31], v[76:79], v[172:175]
    v_mfma_f32_16x16x32_bf16 v[116:119], a[32:35], v[64:67], v[116:119]
    v_mfma_f32_16x16x32_bf16 v[136:139], a[32:35], v[68:71], v[136:139]
    buffer_load_dwordx4 v[60:63], v27, s[36:39], s60 offen offset:1024 sc1
    v_mfma_f32_16x16x32_bf16 v[156:159], a[32:35], v[72:75], v[156:159]
    v_mfma_f32_16x16x32_bf16 v[176:179], a[32:35], v[76:79], v[176:179]
    v_mfma_f32_16x16x32_bf16 v[120:123], a[36:39], v[64:67], v[120:123]
    v_mfma_f32_16x16x32_bf16 v[140:143], a[36:39], v[68:71], v[140:143]
    v_mfma_f32_16x16x32_bf16 v[160:163], a[36:39], v[72:75], v[160:163]
    v_mfma_f32_16x16x32_bf16 v[180:183], a[36:39], v[76:79], v[180:183]
    s_waitcnt vmcnt(14)
    v_mfma_f32_16x16x32_bf16 v[104:107], a[40:43], v[80:83], v[104:107]
    v_mfma_f32_16x16x32_bf16 v[124:127], a[40:43], v[84:87], v[124:127]
    buffer_load_dwordx4 v[64:67], v24, s[36:39], s60 offen offset:2048 sc1
    v_mfma_f32_16x16x32_bf16 v[144:147], a[40:43], v[88:91], v[144:147]
    v_lshrrev_b32 v4, 4, v0
    v_mfma_f32_16x16x32_bf16 v[164:167], a[40:43], v[92:95], v[164:167]
    v_mfma_f32_16x16x32_bf16 v[108:111], a[44:47], v[80:83], v[108:111]
    v_mfma_f32_16x16x32_bf16 v[128:131], a[44:47], v[84:87], v[128:131]
    buffer_load_dwordx4 v[68:71], v25, s[36:39], s60 offen offset:2048 sc1
    v_mfma_f32_16x16x32_bf16 v[148:151], a[44:47], v[88:91], v[148:151]
    v_mfma_f32_16x16x32_bf16 v[168:171], a[44:47], v[92:95], v[168:171]
    v_mfma_f32_16x16x32_bf16 v[112:115], a[48:51], v[80:83], v[112:115]
    v_mfma_f32_16x16x32_bf16 v[132:135], a[48:51], v[84:87], v[132:135]
    buffer_load_dwordx4 v[72:75], v26, s[36:39], s60 offen offset:2048 sc1
    v_mfma_f32_16x16x32_bf16 v[152:155], a[48:51], v[88:91], v[152:155]
    v_mfma_f32_16x16x32_bf16 v[172:175], a[48:51], v[92:95], v[172:175]
    v_mfma_f32_16x16x32_bf16 v[116:119], a[52:55], v[80:83], v[116:119]
    v_mfma_f32_16x16x32_bf16 v[136:139], a[52:55], v[84:87], v[136:139]
    buffer_load_dwordx4 v[76:79], v27, s[36:39], s60 offen offset:2048 sc1
    v_mfma_f32_16x16x32_bf16 v[156:159], a[52:55], v[88:91], v[156:159]
    v_mfma_f32_16x16x32_bf16 v[176:179], a[52:55], v[92:95], v[176:179]
    v_mfma_f32_16x16x32_bf16 v[120:123], a[56:59], v[80:83], v[120:123]
    v_mfma_f32_16x16x32_bf16 v[140:143], a[56:59], v[84:87], v[140:143]
    v_mfma_f32_16x16x32_bf16 v[160:163], a[56:59], v[88:91], v[160:163]
    v_mfma_f32_16x16x32_bf16 v[180:183], a[56:59], v[92:95], v[180:183]
    s_waitcnt vmcnt(12)
    s_barrier
    v_mov_b32 v16, s56
    v_lshlrev_b32 v17, 2, v0
    s_mov_b32 exec_lo, 1
    s_mov_b32 exec_hi, 0
    buffer_store_dword v16, v17, s[36:39], s72 offen sc1
    s_mov_b64 exec, -1
    s_nop 0
    v_mfma_f32_16x16x32_bf16 v[104:107], a[60:63], v[96:99], v[104:107]
    v_mfma_f32_16x16x32_bf16 v[124:127], a[60:63], v[100:103], v[124:127]
    buffer_load_dwordx4 v[80:83], v24, s[36:39], s60 offen offset:3072 sc1
    v_mfma_f32_16x16x32_bf16 v[144:147], a[60:63], v[236:239], v[144:147]
    v_mfma_f32_16x16x32_bf16 v[164:167], a[60:63], v[240:243], v[164:167]
    v_mfma_f32_16x16x32_bf16 v[108:111], a[64:67], v[96:99], v[108:111]
    v_mfma_f32_16x16x32_bf16 v[128:131], a[64:67], v[100:103], v[128:131]
    buffer_load_dwordx4 v[84:87], v25, s[36:39], s60 offen offset:3072 sc1
    v_mfma_f32_16x16x32_bf16 v[148:151], a[64:67], v[236:239], v[148:151]
    v_mfma_f32_16x16x32_bf16 v[168:171], a[64:67], v[240:243], v[168:171]
    v_mfma_f32_16x16x32_bf16 v[112:115], a[68:71], v[96:99], v[112:115]
    v_mfma_f32_16x16x32_bf16 v[132:135], a[68:71], v[100:103], v[132:135]
    buffer_load_dwordx4 v[88:91], v26, s[36:39], s60 offen offset:3072 sc1
    v_mfma_f32_16x16x32_bf16 v[152:155], a[68:71], v[236:239], v[152:155]
    v_mfma_f32_16x16x32_bf16 v[172:175], a[68:71], v[240:243], v[172:175]
    v_mfma_f32_16x16x32_bf16 v[116:119], a[72:75], v[96:99], v[116:119]
    v_mfma_f32_16x16x32_bf16 v[136:139], a[72:75], v[100:103], v[136:139]
    buffer_load_dwordx4 v[92:95], v27, s[36:39], s60 offen offset:3072 sc1
    s_add_u32 s60, s60, 4096
    v_mfma_f32_16x16x32_bf16 v[156:159], a[72:75], v[236:239], v[156:159]
    v_mfma_f32_16x16x32_bf16 v[176:179], a[72:75], v[240:243], v[176:179]
    v_mfma_f32_16x16x32_bf16 v[120:123], a[76:79], v[96:99], v[120:123]
    v_mfma_f32_16x16x32_bf16 v[140:143], a[76:79], v[100:103], v[140:143]
    v_mfma_f32_16x16x32_bf16 v[160:163], a[76:79], v[236:239], v[160:163]
    v_mfma_f32_16x16x32_bf16 v[180:183], a[76:79], v[240:243], v[180:183]
    s_waitcnt vmcnt(13)
    v_mfma_f32_16x16x32_bf16 v[104:107], a[80:83], v[32:35], v[104:107]
    v_mfma_f32_16x16x32_bf16 v[124:127], a[80:83], v[36:39], v[124:127]
    buffer_load_dwordx4 v[96:99], v24, s[36:39], s60 offen offset:0 sc1
    v_mfma_f32_16x16x32_bf16 v[144:147], a[80:83], v[40:43], v[144:147]
    v_mfma_f32_16x16x32_bf16 v[164:167], a[80:83], v[44:47], v[164:167]
    v_mfma_f32_16x16x32_bf16 v[108:111], a[84:87], v[32:35], v[108:111]
    v_mfma_f32_16x16x32_bf16 v[128:131], a[84:87], v[36:39], v[128:131]
    buffer_load_dwordx4 v[100:103], v25, s[36:39], s60 offen offset:0 sc1
    v_mfma_f32_16x16x32_bf16 v[148:151], a[84:87], v[40:43], v[148:151]
    v_mfma_f32_16x16x32_bf16 v[168:171], a[84:87], v[44:47], v[168:171]
    v_mfma_f32_16x16x32_bf16 v[112:115], a[88:91], v[32:35], v[112:115]
    v_mfma_f32_16x16x32_bf16 v[132:135], a[88:91], v[36:39], v[132:135]
    buffer_load_dwordx4 v[236:239], v26, s[36:39], s60 offen offset:0 sc1
    v_mfma_f32_16x16x32_bf16 v[152:155], a[88:91], v[40:43], v[152:155]
    v_mfma_f32_16x16x32_bf16 v[172:175], a[88:91], v[44:47], v[172:175]
    v_mfma_f32_16x16x32_bf16 v[116:119], a[92:95], v[32:35], v[116:119]
    v_mfma_f32_16x16x32_bf16 v[136:139], a[92:95], v[36:39], v[136:139]
    buffer_load_dwordx4 v[240:243], v27, s[36:39], s60 offen offset:0 sc1
    v_mfma_f32_16x16x32_bf16 v[156:159], a[92:95], v[40:43], v[156:159]
    v_mfma_f32_16x16x32_bf16 v[176:179], a[92:95], v[44:47], v[176:179]
    v_mfma_f32_16x16x32_bf16 v[120:123], a[96:99], v[32:35], v[120:123]
    v_mfma_f32_16x16x32_bf16 v[140:143], a[96:99], v[36:39], v[140:143]
    v_mfma_f32_16x16x32_bf16 v[160:163], a[96:99], v[40:43], v[160:163]
    v_mfma_f32_16x16x32_bf16 v[180:183], a[96:99], v[44:47], v[180:183]
    s_waitcnt vmcnt(13)
    v_mfma_f32_16x16x32_bf16 v[104:107], a[100:103], v[48:51], v[104:107]
    s_mul_i32 s65, s54, 327680
    s_lshl_b32 s66, s53, 7
    v_mfma_f32_16x16x32_bf16 v[124:127], a[100:103], v[52:55], v[124:127]
    buffer_load_dwordx4 v[32:35], v24, s[36:39], s60 offen offset:1024 sc1
    v_mfma_f32_16x16x32_bf16 v[144:147], a[100:103], v[56:59], v[144:147]
    s_add_u32 s65, s65, s66
    s_add_u32 s65, s65, 7340032
    v_mfma_f32_16x16x32_bf16 v[164:167], a[100:103], v[60:63], v[164:167]
    s_add_u32 s66, s65, 0x20000
    v_mfma_f32_16x16x32_bf16 v[108:111], a[104:107], v[48:51], v[108:111]
    s_add_u32 s67, s65, 0x40000
    v_mfma_f32_16x16x32_bf16 v[128:131], a[104:107], v[52:55], v[128:131]
    buffer_load_dwordx4 v[36:39], v25, s[36:39], s60 offen offset:1024 sc1
    s_cmp_ge_u32 s3, 2
    s_cselect_b32 s67, 17563648, s67
    v_mfma_f32_16x16x32_bf16 v[148:151], a[104:107], v[56:59], v[148:151]
    v_mfma_f32_16x16x32_bf16 v[168:171], a[104:107], v[60:63], v[168:171]
    s_lshl_b32 s79, s3, 3
    v_mfma_f32_16x16x32_bf16 v[112:115], a[108:111], v[48:51], v[112:115]
    v_lshrrev_b32 v10, 3, v0
    v_mfma_f32_16x16x32_bf16 v[132:135], a[108:111], v[52:55], v[132:135]
    buffer_load_dwordx4 v[40:43], v26, s[36:39], s60 offen offset:1024 sc1
    v_add_u32 v10, s79, v10
    v_mfma_f32_16x16x32_bf16 v[152:155], a[108:111], v[56:59], v[152:155]
    v_and_b32 v11, 7, v0
    v_mfma_f32_16x16x32_bf16 v[172:175], a[108:111], v[60:63], v[172:175]
    v_lshlrev_b32 v13, 12, v10
    v_mfma_f32_16x16x32_bf16 v[116:119], a[112:115], v[48:51], v[116:119]
    v_lshl_add_u32 v13, v11, 4, v13
    v_and_b32 v12, 2, v10
    v_mfma_f32_16x16x32_bf16 v[136:139], a[112:115], v[52:55], v[136:139]
    buffer_load_dwordx4 v[44:47], v27, s[36:39], s60 offen offset:1024 sc1
    v_mfma_f32_16x16x32_bf16 v[156:159], a[112:115], v[56:59], v[156:159]
    v_xor_b32 v11, v11, v12
    v_mfma_f32_16x16x32_bf16 v[176:179], a[112:115], v[60:63], v[176:179]
    v_lshrrev_b32 v12, 1, v10
    v_and_b32 v12, 4, v12
    v_mfma_f32_16x16x32_bf16 v[120:123], a[116:119], v[48:51], v[120:123]
    v_xor_b32 v11, v11, v12
    v_mfma_f32_16x16x32_bf16 v[140:143], a[116:119], v[52:55], v[140:143]
    v_lshlrev_b32 v10, 7, v10
    v_mfma_f32_16x16x32_bf16 v[160:163], a[116:119], v[56:59], v[160:163]
    v_lshl_add_u32 v10, v11, 4, v10
    v_mfma_f32_16x16x32_bf16 v[180:183], a[116:119], v[60:63], v[180:183]
    v_add_u32 v10, 120832, v10
    s_waitcnt vmcnt(13)
    v_mfma_f32_16x16x32_bf16 v[104:107], a[120:123], v[64:67], v[104:107]
    v_mfma_f32_16x16x32_bf16 v[124:127], a[120:123], v[68:71], v[124:127]
    buffer_load_dwordx4 v[48:51], v24, s[36:39], s60 offen offset:2048 sc1
    v_mfma_f32_16x16x32_bf16 v[144:147], a[120:123], v[72:75], v[144:147]
    s_add_u32 s69, s3, 1
    v_mfma_f32_16x16x32_bf16 v[164:167], a[120:123], v[76:79], v[164:167]
    s_and_b32 s69, s69, 3
    v_mfma_f32_16x16x32_bf16 v[108:111], a[124:127], v[64:67], v[108:111]
    s_mul_i32 s69, s69, 15360
    v_mfma_f32_16x16x32_bf16 v[128:131], a[124:127], v[68:71], v[128:131]
    buffer_load_dwordx4 v[52:55], v25, s[36:39], s60 offen offset:2048 sc1
    s_add_u32 s69, s69, 0
PAGE5:
    s_cbranch_execz PAGE6
    v_mfma_f32_16x16x32_bf16 v[148:151], a[124:127], v[72:75], v[148:151]
    v_add_u32 v7, s69, v14
    v_mfma_f32_16x16x32_bf16 v[168:171], a[124:127], v[76:79], v[168:171]
    v_mfma_f32_16x16x32_bf16 v[112:115], a[128:131], v[64:67], v[112:115]
    s_add_u32 s69, s3, 2
    v_mfma_f32_16x16x32_bf16 v[132:135], a[128:131], v[68:71], v[132:135]
    buffer_load_dwordx4 v[56:59], v26, s[36:39], s60 offen offset:2048 sc1
    s_and_b32 s69, s69, 3
    v_mfma_f32_16x16x32_bf16 v[152:155], a[128:131], v[72:75], v[152:155]
    s_mul_i32 s69, s69, 15360
    v_mfma_f32_16x16x32_bf16 v[172:175], a[128:131], v[76:79], v[172:175]
    s_add_u32 s69, s69, 5120
    v_mfma_f32_16x16x32_bf16 v[116:119], a[132:135], v[64:67], v[116:119]
    v_add_u32 v8, s69, v14
    v_mfma_f32_16x16x32_bf16 v[136:139], a[132:135], v[68:71], v[136:139]
    buffer_load_dwordx4 v[60:63], v27, s[36:39], s60 offen offset:2048 sc1
    v_mfma_f32_16x16x32_bf16 v[156:159], a[132:135], v[72:75], v[156:159]
    s_add_u32 s69, s3, 3
    v_mfma_f32_16x16x32_bf16 v[176:179], a[132:135], v[76:79], v[176:179]
    s_and_b32 s69, s69, 3
    v_mfma_f32_16x16x32_bf16 v[120:123], a[136:139], v[64:67], v[120:123]
    s_mul_i32 s69, s69, 15360
    v_mfma_f32_16x16x32_bf16 v[140:143], a[136:139], v[68:71], v[140:143]
    s_add_u32 s69, s69, 10240
    v_mfma_f32_16x16x32_bf16 v[160:163], a[136:139], v[72:75], v[160:163]
    v_add_u32 v9, s69, v14
    v_mfma_f32_16x16x32_bf16 v[180:183], a[136:139], v[76:79], v[180:183]
    s_waitcnt vmcnt(12)
    v_mfma_f32_16x16x32_bf16 v[104:107], a[140:143], v[80:83], v[104:107]
    v_and_b32 v2, 15, v0
    v_mfma_f32_16x16x32_bf16 v[124:127], a[140:143], v[84:87], v[124:127]
    buffer_load_dwordx4 v[64:67], v24, s[36:39], s60 offen offset:3072 sc1
    v_mfma_f32_16x16x32_bf16 v[144:147], a[140:143], v[88:91], v[144:147]
    v_lshrrev_b32_e64 v3, 4, v0
    v_mfma_f32_16x16x32_bf16 v[164:167], a[140:143], v[92:95], v[164:167]
    v_lshl_add_u32 v2, v2, 2, v3
    v_mfma_f32_16x16x32_bf16 v[108:111], a[144:147], v[80:83], v[108:111]
    v_mfma_f32_16x16x32_bf16 v[128:131], a[144:147], v[84:87], v[128:131]
    buffer_load_dwordx4 v[68:71], v25, s[36:39], s60 offen offset:3072 sc1
    v_mfma_f32_16x16x32_bf16 v[148:151], a[144:147], v[88:91], v[148:151]
    v_lshlrev_b32 v2, 2, v2
    v_mfma_f32_16x16x32_bf16 v[168:171], a[144:147], v[92:95], v[168:171]
    v_and_b32 v3, 3, v0
    v_mfma_f32_16x16x32_bf16 v[112:115], a[148:151], v[80:83], v[112:115]
    v_mfma_f32_16x16x32_bf16 v[132:135], a[148:151], v[84:87], v[132:135]
    buffer_load_dwordx4 v[72:75], v26, s[36:39], s60 offen offset:3072 sc1
    v_lshlrev_b32 v3, 6, v3
    v_mfma_f32_16x16x32_bf16 v[152:155], a[148:151], v[88:91], v[152:155]
    v_mfma_f32_16x16x32_bf16 v[172:175], a[148:151], v[92:95], v[172:175]
    v_and_b32 v11, 60, v0
    v_mfma_f32_16x16x32_bf16 v[116:119], a[152:155], v[80:83], v[116:119]
    v_mfma_f32_16x16x32_bf16 v[136:139], a[152:155], v[84:87], v[136:139]
    buffer_load_dwordx4 v[76:79], v27, s[36:39], s60 offen offset:3072 sc1
    s_add_u32 s60, s60, 4096
    v_mfma_f32_16x16x32_bf16 v[156:159], a[152:155], v[88:91], v[156:159]
    v_or_b32 v3, v3, v11
    v_mfma_f32_16x16x32_bf16 v[176:179], a[152:155], v[92:95], v[176:179]
    v_mfma_f32_16x16x32_bf16 v[120:123], a[156:159], v[80:83], v[120:123]
    v_mfma_f32_16x16x32_bf16 v[140:143], a[156:159], v[84:87], v[140:143]
    v_mfma_f32_16x16x32_bf16 v[160:163], a[156:159], v[88:91], v[160:163]
    buffer_load_dword v20, v18, s[36:39], s59 offen sc1
    v_mfma_f32_16x16x32_bf16 v[180:183], a[156:159], v[92:95], v[180:183]
    s_waitcnt vmcnt(13)
    v_mfma_f32_16x16x32_bf16 v[104:107], a[160:163], v[96:99], v[104:107]
    v_mfma_f32_16x16x32_bf16 v[124:127], a[160:163], v[100:103], v[124:127]
    buffer_load_dwordx4 v[80:83], v24, s[36:39], s60 offen offset:0 sc1
    v_mfma_f32_16x16x32_bf16 v[144:147], a[160:163], v[236:239], v[144:147]
    ds_bpermute_b32 v244, v2, v244
    v_mfma_f32_16x16x32_bf16 v[164:167], a[160:163], v[240:243], v[164:167]
    ds_bpermute_b32 v245, v2, v245
    v_mfma_f32_16x16x32_bf16 v[108:111], a[164:167], v[96:99], v[108:111]
    v_mfma_f32_16x16x32_bf16 v[128:131], a[164:167], v[100:103], v[128:131]
    buffer_load_dwordx4 v[84:87], v25, s[36:39], s60 offen offset:0 sc1
    ds_bpermute_b32 v246, v2, v246
    v_mfma_f32_16x16x32_bf16 v[148:151], a[164:167], v[236:239], v[148:151]
    v_mfma_f32_16x16x32_bf16 v[168:171], a[164:167], v[240:243], v[168:171]
    ds_bpermute_b32 v247, v2, v247
    v_mfma_f32_16x16x32_bf16 v[112:115], a[168:171], v[96:99], v[112:115]
    v_mfma_f32_16x16x32_bf16 v[132:135], a[168:171], v[100:103], v[132:135]
    buffer_load_dwordx4 v[88:91], v26, s[36:39], s60 offen offset:0 sc1
    ds_bpermute_b32 v248, v2, v248
    v_mfma_f32_16x16x32_bf16 v[152:155], a[168:171], v[236:239], v[152:155]
    v_mfma_f32_16x16x32_bf16 v[172:175], a[168:171], v[240:243], v[172:175]
    ds_bpermute_b32 v249, v2, v249
    v_mfma_f32_16x16x32_bf16 v[116:119], a[172:175], v[96:99], v[116:119]
    ds_bpermute_b32 v250, v2, v250
    v_mfma_f32_16x16x32_bf16 v[136:139], a[172:175], v[100:103], v[136:139]
    buffer_load_dwordx4 v[92:95], v27, s[36:39], s60 offen offset:0 sc1
    v_mfma_f32_16x16x32_bf16 v[156:159], a[172:175], v[236:239], v[156:159]
    v_mfma_f32_16x16x32_bf16 v[176:179], a[172:175], v[240:243], v[176:179]
    ds_bpermute_b32 v251, v2, v251
    v_mfma_f32_16x16x32_bf16 v[120:123], a[176:179], v[96:99], v[120:123]
    ds_bpermute_b32 v252, v2, v252
    v_mfma_f32_16x16x32_bf16 v[140:143], a[176:179], v[100:103], v[140:143]
    v_mfma_f32_16x16x32_bf16 v[160:163], a[176:179], v[236:239], v[160:163]
    ds_bpermute_b32 v253, v2, v253
    v_mfma_f32_16x16x32_bf16 v[180:183], a[176:179], v[240:243], v[180:183]
    s_waitcnt vmcnt(13)
    v_mfma_f32_16x16x32_bf16 v[104:107], a[180:183], v[32:35], v[104:107]
    v_mfma_f32_16x16x32_bf16 v[124:127], a[180:183], v[36:39], v[124:127]
    buffer_load_dwordx4 v[100:103], v25, s[36:39], s60 offen offset:1024 sc1
    v_mfma_f32_16x16x32_bf16 v[144:147], a[180:183], v[40:43], v[144:147]
    s_mov_b32 s48, s26
    v_mfma_f32_16x16x32_bf16 v[164:167], a[180:183], v[44:47], v[164:167]
    v_mfma_f32_16x16x32_bf16 v[108:111], a[184:187], v[32:35], v[108:111]
    s_mov_b32 s49, s27
    s_nop 0
    v_mfma_f32_16x16x32_bf16 v[128:131], a[184:187], v[36:39], v[128:131]
    buffer_load_dwordx4 v[236:239], v26, s[36:39], s60 offen offset:1024 sc1
    v_mfma_f32_16x16x32_bf16 v[148:151], a[184:187], v[40:43], v[148:151]
    v_mfma_f32_16x16x32_bf16 v[168:171], a[184:187], v[44:47], v[168:171]
    s_mov_b32 s50, 2621440
    v_mfma_f32_16x16x32_bf16 v[112:115], a[188:191], v[32:35], v[112:115]
    v_mfma_f32_16x16x32_bf16 v[132:135], a[188:191], v[36:39], v[132:135]
    buffer_load_dwordx4 v[240:243], v27, s[36:39], s60 offen offset:1024 sc1
    v_mfma_f32_16x16x32_bf16 v[152:155], a[188:191], v[40:43], v[152:155]
    s_mov_b32 s51, 0x20000
    v_mfma_f32_16x16x32_bf16 v[172:175], a[188:191], v[44:47], v[172:175]
    v_mfma_f32_16x16x32_bf16 v[116:119], a[192:195], v[32:35], v[116:119]
    v_mfma_f32_16x16x32_bf16 v[136:139], a[192:195], v[36:39], v[136:139]
    buffer_load_dwordx4 v[96:99], v24, s[36:39], s60 offen offset:1024 sc1
    v_mfma_f32_16x16x32_bf16 v[156:159], a[192:195], v[40:43], v[156:159]
    v_mfma_f32_16x16x32_bf16 v[176:179], a[192:195], v[44:47], v[176:179]
    v_mfma_f32_16x16x32_bf16 v[120:123], a[196:199], v[32:35], v[120:123]
    v_mfma_f32_16x16x32_bf16 v[140:143], a[196:199], v[36:39], v[140:143]
    v_mfma_f32_16x16x32_bf16 v[160:163], a[196:199], v[40:43], v[160:163]
    v_mfma_f32_16x16x32_bf16 v[180:183], a[196:199], v[44:47], v[180:183]
    s_waitcnt vmcnt(13)
    v_mfma_f32_16x16x32_bf16 v[104:107], a[200:203], v[48:51], v[104:107]
    s_waitcnt vmcnt(8)
    v_cmp_ne_u32 vcc, s56, v20
    v_mfma_f32_16x16x32_bf16 v[124:127], a[200:203], v[52:55], v[124:127]
    s_mov_b64 s[82:83], vcc
    s_cmp_eq_u64 s[82:83], 0
    s_cbranch_scc0 FY_RETRY_11
FY_DONE_12:
    v_mfma_f32_16x16x32_bf16 v[144:147], a[200:203], v[56:59], v[144:147]
    buffer_load_dwordx4 v[184:187], v13, s[36:39], s65 offen sc1
    v_mfma_f32_16x16x32_bf16 v[164:167], a[200:203], v[60:63], v[164:167]
    buffer_load_dwordx4 v[188:191], v13, s[36:39], s66 offen sc1
    v_mfma_f32_16x16x32_bf16 v[108:111], a[204:207], v[48:51], v[108:111]
    buffer_load_dwordx4 v[192:195], v13, s[36:39], s67 offen sc1
    v_mfma_f32_16x16x32_bf16 v[128:131], a[204:207], v[52:55], v[128:131]
    s_lshl_b32 s76, s3, 12
    s_add_u32 s76, s76, 131072
    s_cmp_eq_u32 s2, 0
    s_cselect_b32 s76, s76, 17563648
    v_mfma_f32_16x16x32_bf16 v[148:151], a[204:207], v[56:59], v[148:151]
    v_lshlrev_b32_e64 v16, 6, v0
    v_mfma_f32_16x16x32_bf16 v[168:171], a[204:207], v[60:63], v[168:171]
    buffer_load_dword v24, v16, s[36:39], s76 offen sc1
    s_mul_i32 s79, s3, 15360
    v_mfma_f32_16x16x32_bf16 v[112:115], a[208:211], v[48:51], v[112:115]
    v_add_u32 v26, s79, v14
    v_bfe_u32 v17, v0, 2, 2
    v_and_b32 v18, 3, v0
    v_mfma_f32_16x16x32_bf16 v[132:135], a[208:211], v[52:55], v[132:135]
    v_lshrrev_b32 v19, 1, v18
    s_lshl_b32 s78, s3, 1
    v_mfma_f32_16x16x32_bf16 v[152:155], a[208:211], v[56:59], v[152:155]
    v_or_b32 v19, s78, v19
    v_and_b32 v18, 1, v18
    v_mfma_f32_16x16x32_bf16 v[172:175], a[208:211], v[60:63], v[172:175]
    v_lshlrev_b32 v18, 3, v18
    v_add_u32 v18, 120832, v18
    v_and_b32 v27, 2, v17
    v_mfma_f32_16x16x32_bf16 v[116:119], a[212:215], v[48:51], v[116:119]
    v_and_b32 v20, 1, v4
    v_lshl_or_b32 v27, v20, 2, v27
    v_mfma_f32_16x16x32_bf16 v[136:139], a[212:215], v[52:55], v[136:139]
    v_xor_b32 v27, v27, v19
    v_lshl_add_u32 v27, v27, 4, v18
    v_mfma_f32_16x16x32_bf16 v[156:159], a[212:215], v[56:59], v[156:159]
    v_lshl_add_u32 v20, v4, 3, v17
    v_lshl_add_u32 v27, v20, 7, v27
    v_lshl_add_u32 v20, v4, 2, v17
    v_mfma_f32_16x16x32_bf16 v[176:179], a[212:215], v[60:63], v[176:179]
    v_and_b32 v23, 2, v20
    v_lshrrev_b32 v21, 1, v20
    v_mfma_f32_16x16x32_bf16 v[120:123], a[216:219], v[48:51], v[120:123]
    v_and_b32 v21, 4, v21
    v_or_b32 v23, v23, v21
    v_mfma_f32_16x16x32_bf16 v[140:143], a[216:219], v[52:55], v[140:143]
    v_xor_b32_e64 v23, v23, v19
    v_lshl_add_u32 v23, v23, 4, v18
    v_lshl_add_u32 v23, v20, 7, v23
    v_mfma_f32_16x16x32_bf16 v[160:163], a[216:219], v[56:59], v[160:163]
    s_mov_b32 s74, 0xbfb8aa3b
    s_mov_b32 s75, 0xbfb8aa3b
    v_mfma_f32_16x16x32_bf16 v[180:183], a[216:219], v[60:63], v[180:183]
    v_mov_b32 v30, 1.0
    v_mov_b32 v31, 1.0
    s_waitcnt vmcnt(8) lgkmcnt(0)
    v_mfma_f32_16x16x32_bf16 v[124:127], a[220:223], v[68:71], v[124:127]
    v_lshlrev_b32 v32, 16, v244
    v_and_b32 v33, 0xffff0000, v244
    v_mfma_f32_16x16x32_bf16 v[128:131], a[224:227], v[68:71], v[128:131]
    v_lshlrev_b32 v34, 16, v245
    v_mfma_f32_16x16x32_bf16 v[124:127], v[196:199], v[84:87], v[124:127]
    v_and_b32 v35, 0xffff0000, v245
    v_mfma_f32_16x16x32_bf16 v[128:131], v[200:203], v[84:87], v[128:131]
    s_waitcnt vmcnt(7)
    v_lshlrev_b32 v36, 16, v246
    v_mfma_f32_16x16x32_bf16 v[124:127], v[216:219], v[100:103], v[124:127]
    v_and_b32 v37, 0xffff0000, v246
    v_mfma_f32_16x16x32_bf16 v[128:131], v[220:223], v[100:103], v[128:131]
    v_lshlrev_b32 v38, 16, v247
    v_mfma_f32_16x16x32_bf16 v[132:135], a[228:231], v[68:71], v[132:135]
    v_and_b32 v39, 0xffff0000, v247
    v_lshlrev_b32_e64 v40, 16, v248
    v_mfma_f32_16x16x32_bf16 v[136:139], a[232:235], v[68:71], v[136:139]
    v_and_b32 v41, 0xffff0000, v248
    v_mfma_f32_16x16x32_bf16 v[132:135], v[204:207], v[84:87], v[132:135]
    ds_write_b128 v7, v[124:127] offset:0
    v_mfma_f32_16x16x32_bf16 v[136:139], v[208:211], v[84:87], v[136:139]
    v_lshlrev_b32_e64 v42, 16, v249
    v_mfma_f32_16x16x32_bf16 v[132:135], v[224:227], v[100:103], v[132:135]
    v_and_b32 v43, 0xffff0000, v249
    v_mfma_f32_16x16x32_bf16 v[136:139], v[228:231], v[100:103], v[136:139]
    ds_write_b128 v7, v[128:131] offset:1024
    v_mfma_f32_16x16x32_bf16 v[140:143], a[236:239], v[68:71], v[140:143]
    v_lshlrev_b32 v44, 16, v250
    v_mfma_f32_16x16x32_bf16 v[144:147], a[220:223], v[72:75], v[144:147]
    v_and_b32 v45, 0xffff0000, v250
    v_mfma_f32_16x16x32_bf16 v[140:143], v[212:215], v[84:87], v[140:143]
    v_lshlrev_b32 v46, 16, v251
    v_and_b32 v47, 0xffff0000, v251
    v_mfma_f32_16x16x32_bf16 v[144:147], v[196:199], v[88:91], v[144:147]
    ds_write_b128 v7, v[132:135] offset:2048
    v_mfma_f32_16x16x32_bf16 v[140:143], v[232:235], v[100:103], v[140:143]
    s_waitcnt vmcnt(6)
    v_lshlrev_b32 v48, 16, v252
    v_mfma_f32_16x16x32_bf16 v[144:147], v[216:219], v[236:239], v[144:147]
    v_and_b32 v49, 0xffff0000, v252
    v_mfma_f32_16x16x32_bf16 v[148:151], a[224:227], v[72:75], v[148:151]
    ds_write_b128 v7, v[136:139] offset:3072
    v_mfma_f32_16x16x32_bf16 v[152:155], a[228:231], v[72:75], v[152:155]
    v_lshlrev_b32_e64 v50, 16, v253
    v_mfma_f32_16x16x32_bf16 v[148:151], v[200:203], v[88:91], v[148:151]
    v_and_b32 v51, 0xffff0000, v253
    v_mfma_f32_16x16x32_bf16 v[152:155], v[204:207], v[88:91], v[152:155]
    ds_write_b128 v7, v[140:143] offset:4096
    v_mfma_f32_16x16x32_bf16 v[148:151], v[220:223], v[236:239], v[148:151]
    v_mul_f32 v254, v254, v255
    v_mfma_f32_16x16x32_bf16 v[152:155], v[224:227], v[236:239], v[152:155]
    v_sub_f32 v254, 0, v254
    v_fma_f32 v52, v32, v255, v254
    v_mfma_f32_16x16x32_bf16 v[156:159], a[232:235], v[72:75], v[156:159]
    ds_write_b128 v8, v[144:147] offset:0
    v_mfma_f32_16x16x32_bf16 v[160:163], a[236:239], v[72:75], v[160:163]
    v_fma_f32 v53, v33, v255, v254
    v_mfma_f32_16x16x32_bf16 v[156:159], v[208:211], v[88:91], v[156:159]
    v_fma_f32 v54, v34, v255, v254
    v_mfma_f32_16x16x32_bf16 v[160:163], v[212:215], v[88:91], v[160:163]
    ds_write_b128 v8, v[148:151] offset:1024
    v_mfma_f32_16x16x32_bf16 v[156:159], v[228:231], v[236:239], v[156:159]
    v_fma_f32 v55, v35, v255, v254
    v_mfma_f32_16x16x32_bf16 v[160:163], v[232:235], v[236:239], v[160:163]
    v_fma_f32 v56, v36, v255, v254
    v_mfma_f32_16x16x32_bf16 v[164:167], a[220:223], v[76:79], v[164:167]
    ds_write_b128 v8, v[152:155] offset:2048
    v_mfma_f32_16x16x32_bf16 v[168:171], a[224:227], v[76:79], v[168:171]
    v_fma_f32 v57, v37, v255, v254
    v_mfma_f32_16x16x32_bf16 v[164:167], v[196:199], v[92:95], v[164:167]
    v_fma_f32 v58, v38, v255, v254
    v_fma_f32 v59, v39, v255, v254
    v_mfma_f32_16x16x32_bf16 v[168:171], v[200:203], v[92:95], v[168:171]
    ds_write_b128 v8, v[156:159] offset:3072
    s_waitcnt vmcnt(5)
    s_nop 0
    v_mfma_f32_16x16x32_bf16 v[164:167], v[216:219], v[240:243], v[164:167]
    v_fma_f32 v60, v40, v255, v254
    v_mfma_f32_16x16x32_bf16 v[168:171], v[220:223], v[240:243], v[168:171]
    v_fma_f32 v61, v41, v255, v254
    v_mfma_f32_16x16x32_bf16 v[172:175], a[228:231], v[76:79], v[172:175]
    ds_write_b128 v8, v[160:163] offset:4096
    v_mfma_f32_16x16x32_bf16 v[176:179], a[232:235], v[76:79], v[176:179]
    v_fma_f32 v62, v42, v255, v254
    v_mfma_f32_16x16x32_bf16 v[172:175], v[204:207], v[92:95], v[172:175]
    v_fma_f32 v63, v43, v255, v254
    v_mfma_f32_16x16x32_bf16 v[176:179], v[208:211], v[92:95], v[176:179]
    ds_write_b128 v9, v[164:167] offset:0
    v_mfma_f32_16x16x32_bf16 v[172:175], v[224:227], v[240:243], v[172:175]
    v_fma_f32 v244, v44, v255, v254
    v_mfma_f32_16x16x32_bf16 v[176:179], v[228:231], v[240:243], v[176:179]
    v_fma_f32 v245, v45, v255, v254
    v_fma_f32 v246, v46, v255, v254
    v_mfma_f32_16x16x32_bf16 v[180:183], a[236:239], v[76:79], v[180:183]
    ds_write_b128 v9, v[168:171] offset:1024
    v_mfma_f32_16x16x32_bf16 v[104:107], a[220:223], v[64:67], v[104:107]
    v_fma_f32 v247, v47, v255, v254
    v_mfma_f32_16x16x32_bf16 v[180:183], v[212:215], v[92:95], v[180:183]
    v_fma_f32 v248, v48, v255, v254
    v_mfma_f32_16x16x32_bf16 v[104:107], v[196:199], v[80:83], v[104:107]
    ds_write_b128 v9, v[172:175] offset:2048
    v_mfma_f32_16x16x32_bf16 v[180:183], v[232:235], v[240:243], v[180:183]
    s_waitcnt vmcnt(4)
    s_nop 0
    v_fma_f32 v249, v49, v255, v254
    v_mfma_f32_16x16x32_bf16 v[104:107], v[216:219], v[96:99], v[104:107]
    v_fma_f32 v250, v50, v255, v254
    v_mfma_f32_16x16x32_bf16 v[108:111], a[224:227], v[64:67], v[108:111]
    ds_write_b128 v9, v[176:179] offset:3072
    v_mfma_f32_16x16x32_bf16 v[112:115], a[228:231], v[64:67], v[112:115]
    v_fma_f32 v251, v51, v255, v254
    v_mfma_f32_16x16x32_bf16 v[108:111], v[200:203], v[80:83], v[108:111]
    v_mfma_f32_16x16x32_bf16 v[112:115], v[204:207], v[80:83], v[112:115]
    ds_write_b128 v9, v[180:183] offset:4096
    v_mfma_f32_16x16x32_bf16 v[108:111], v[220:223], v[96:99], v[108:111]
    v_mfma_f32_16x16x32_bf16 v[112:115], v[224:227], v[96:99], v[112:115]
    v_mfma_f32_16x16x32_bf16 v[116:119], a[232:235], v[64:67], v[116:119]
    s_waitcnt vmcnt(1)
    ds_write_b128 v10, v[184:187] offset:0
    v_mfma_f32_16x16x32_bf16 v[120:123], a[236:239], v[64:67], v[120:123]
    v_mfma_f32_16x16x32_bf16 v[116:119], v[208:211], v[80:83], v[116:119]
    ds_write_b128 v10, v[188:191] offset:4096
    v_mfma_f32_16x16x32_bf16 v[120:123], v[212:215], v[80:83], v[120:123]
    v_mfma_f32_16x16x32_bf16 v[116:119], v[228:231], v[96:99], v[116:119]
    ds_write_b128 v10, v[192:195] offset:8192
    v_mfma_f32_16x16x32_bf16 v[120:123], v[232:235], v[96:99], v[120:123]
    s_cmp_eq_u32 s2, 0
    s_cbranch_scc1 EP_CHECK
EP_BACK:
    s_or_b32 s73, s2, s3
    s_cmp_eq_u32 s73, 0
    s_waitcnt lgkmcnt(0)
    s_barrier
    s_cbranch_scc1 EP_STORE
EP_STORED:
    ds_read_b64_tr_b16 v[220:221], v27 offset:0
    ds_read_b64_tr_b16 v[222:223], v27 offset:512
    ds_read_b64_tr_b16 v[224:225], v27 offset:4096
    ds_read_b64_tr_b16 v[226:227], v27 offset:4608
    ds_read_b64_tr_b16 v[228:229], v23 offset:8192
    ds_read_b128 v[124:127], v26 offset:0
    ds_read_b128 v[144:147], v26 offset:5120
    ds_read_b128 v[164:167], v26 offset:10240
    ds_read_b128 v[128:131], v26 offset:1024
    ds_read_b128 v[148:151], v26 offset:6144
    ds_read_b128 v[168:171], v26 offset:11264
    ds_read_b128 v[132:135], v26 offset:2048
    ds_read_b128 v[152:155], v26 offset:7168
    ds_read_b128 v[172:175], v26 offset:12288
    ds_read_b128 v[136:139], v26 offset:3072
    ds_read_b128 v[156:159], v26 offset:8192
    ds_read_b128 v[176:179], v26 offset:13312
    ds_read_b128 v[140:143], v26 offset:4096
    ds_read_b128 v[160:163], v26 offset:9216
    ds_read_b128 v[180:183], v26 offset:14336
    s_waitcnt lgkmcnt(15)
    v_lshlrev_b32 v92, 16, v220
    v_and_b32 v93, 0xffff0000, v220
    v_lshlrev_b32 v94, 16, v221
    v_and_b32 v95, 0xffff0000, v221
    v_lshlrev_b32 v96, 16, v222
    v_and_b32 v97, 0xffff0000, v222
    v_lshlrev_b32_e64 v98, 16, v223
    v_and_b32 v99, 0xffff0000, v223
    v_pk_mul_f32 v[52:53], v[52:53], v[92:93]
    v_pk_mul_f32 v[54:55], v[54:55], v[94:95]
    v_pk_mul_f32 v[56:57], v[56:57], v[96:97]
    v_pk_mul_f32 v[58:59], v[58:59], v[98:99]
    s_waitcnt lgkmcnt(9)
    s_nop 0
    v_pk_add_f32 v[104:105], v[104:105], v[124:125]
    v_pk_add_f32 v[106:107], v[106:107], v[126:127]
    v_pk_add_f32 v[108:109], v[108:109], v[128:129]
    v_pk_add_f32 v[110:111], v[110:111], v[130:131]
    v_pk_add_f32 v[104:105], v[104:105], v[144:145]
    v_pk_add_f32 v[106:107], v[106:107], v[146:147]
    v_pk_add_f32 v[108:109], v[108:109], v[148:149]
    v_pk_add_f32 v[110:111], v[110:111], v[150:151]
    v_pk_add_f32 v[104:105], v[104:105], v[164:165]
    v_pk_add_f32 v[106:107], v[106:107], v[166:167]
    v_pk_add_f32 v[108:109], v[108:109], v[168:169]
    v_pk_add_f32 v[110:111], v[110:111], v[170:171]
    v_pk_mul_f32 v[72:73], v[104:105], s[74:75]
    v_pk_mul_f32 v[74:75], v[106:107], s[74:75]
    v_pk_mul_f32 v[76:77], v[108:109], s[74:75]
    v_pk_mul_f32 v[78:79], v[110:111], s[74:75]
    v_exp_f32 v72, v72
    v_exp_f32 v73, v73
    v_exp_f32 v74, v74
    v_exp_f32 v75, v75
    v_exp_f32 v76, v76
    v_exp_f32 v77, v77
    v_exp_f32 v78, v78
    v_exp_f32 v79, v79
    v_lshlrev_b32 v100, 16, v224
    v_and_b32 v101, 0xffff0000, v224
    v_lshlrev_b32 v102, 16, v225
    v_and_b32 v103, 0xffff0000, v225
    v_lshlrev_b32 v230, 16, v226
    v_and_b32 v231, 0xffff0000, v226
    v_lshlrev_b32 v232, 16, v227
    v_and_b32 v233, 0xffff0000, v227
    v_pk_add_f32 v[72:73], v[72:73], v[30:31]
    v_pk_add_f32 v[74:75], v[74:75], v[30:31]
    v_pk_add_f32 v[76:77], v[76:77], v[30:31]
    v_pk_add_f32 v[78:79], v[78:79], v[30:31]
    v_rcp_f32 v72, v72
    v_rcp_f32 v73, v73
    v_rcp_f32 v74, v74
    v_rcp_f32 v75, v75
    v_rcp_f32 v76, v76
    v_rcp_f32 v77, v77
    v_rcp_f32 v78, v78
    v_rcp_f32 v79, v79
    v_pk_mul_f32 v[60:61], v[60:61], v[100:101]
    v_pk_mul_f32 v[62:63], v[62:63], v[102:103]
    v_pk_mul_f32 v[244:245], v[244:245], v[230:231]
    v_pk_mul_f32 v[246:247], v[246:247], v[232:233]
    v_pk_mul_f32 v[72:73], v[72:73], v[104:105]
    v_pk_mul_f32 v[74:75], v[74:75], v[106:107]
    v_pk_mul_f32 v[76:77], v[76:77], v[108:109]
    v_pk_mul_f32 v[78:79], v[78:79], v[110:111]
    v_pk_fma_f32 v[72:73], v[72:73], v[52:53], v[32:33]
    v_pk_fma_f32 v[74:75], v[74:75], v[54:55], v[34:35]
    v_pk_fma_f32 v[76:77], v[76:77], v[56:57], v[36:37]
    v_pk_fma_f32 v[78:79], v[78:79], v[58:59], v[38:39]
    v_cvt_pk_bf16_f32 v184, v72, v73
    v_cvt_pk_bf16_f32 v185, v74, v75
    v_cvt_pk_bf16_f32 v186, v76, v77
    v_cvt_pk_bf16_f32 v187, v78, v79
    buffer_store_dwordx4 v[184:187], v28, s[48:51], s68 offen offset:0
    s_waitcnt lgkmcnt(3)
    s_nop 0
    v_pk_add_f32 v[112:113], v[112:113], v[132:133]
    v_pk_add_f32 v[114:115], v[114:115], v[134:135]
    v_pk_add_f32 v[116:117], v[116:117], v[136:137]
    v_pk_add_f32 v[118:119], v[118:119], v[138:139]
    v_pk_add_f32 v[112:113], v[112:113], v[152:153]
    v_pk_add_f32 v[114:115], v[114:115], v[154:155]
    v_pk_add_f32 v[116:117], v[116:117], v[156:157]
    v_pk_add_f32 v[118:119], v[118:119], v[158:159]
    v_pk_add_f32 v[112:113], v[112:113], v[172:173]
    v_pk_add_f32 v[114:115], v[114:115], v[174:175]
    v_pk_add_f32 v[116:117], v[116:117], v[176:177]
    v_pk_add_f32 v[118:119], v[118:119], v[178:179]
    v_pk_mul_f32 v[80:81], v[112:113], s[74:75]
    v_pk_mul_f32 v[82:83], v[114:115], s[74:75]
    v_pk_mul_f32 v[84:85], v[116:117], s[74:75]
    v_pk_mul_f32 v[86:87], v[118:119], s[74:75]
    v_exp_f32 v80, v80
    v_exp_f32 v81, v81
    v_exp_f32 v82, v82
    v_exp_f32 v83, v83
    v_exp_f32 v84, v84
    v_exp_f32 v85, v85
    v_exp_f32 v86, v86
    v_exp_f32 v87, v87
    v_lshlrev_b32 v234, 16, v228
    v_and_b32 v235, 0xffff0000, v228
    v_lshlrev_b32 v236, 16, v229
    v_and_b32 v237, 0xffff0000, v229
    v_pk_add_f32 v[80:81], v[80:81], v[30:31]
    v_pk_add_f32 v[82:83], v[82:83], v[30:31]
    v_pk_add_f32 v[84:85], v[84:85], v[30:31]
    v_pk_add_f32 v[86:87], v[86:87], v[30:31]
    v_rcp_f32 v80, v80
    v_rcp_f32 v81, v81
    v_rcp_f32 v82, v82
    v_rcp_f32 v83, v83
    v_rcp_f32 v84, v84
    v_rcp_f32 v85, v85
    v_rcp_f32 v86, v86
    v_rcp_f32 v87, v87
    v_pk_mul_f32 v[248:249], v[248:249], v[234:235]
    v_pk_mul_f32 v[250:251], v[250:251], v[236:237]
    v_pk_mul_f32 v[80:81], v[80:81], v[112:113]
    v_pk_mul_f32 v[82:83], v[82:83], v[114:115]
    v_pk_mul_f32 v[84:85], v[84:85], v[116:117]
    v_pk_mul_f32 v[86:87], v[86:87], v[118:119]
    v_pk_fma_f32 v[80:81], v[80:81], v[60:61], v[40:41]
    v_pk_fma_f32 v[82:83], v[82:83], v[62:63], v[42:43]
    v_pk_fma_f32 v[84:85], v[84:85], v[244:245], v[44:45]
    v_pk_fma_f32 v[86:87], v[86:87], v[246:247], v[46:47]
    v_cvt_pk_bf16_f32 v188, v80, v81
    v_cvt_pk_bf16_f32 v189, v82, v83
    v_cvt_pk_bf16_f32 v190, v84, v85
    v_cvt_pk_bf16_f32 v191, v86, v87
    buffer_store_dwordx4 v[188:191], v28, s[48:51], s68 offen offset:64
    s_waitcnt lgkmcnt(0)
    s_nop 0
    v_pk_add_f32 v[120:121], v[120:121], v[140:141]
    v_pk_add_f32 v[122:123], v[122:123], v[142:143]
    v_pk_add_f32 v[120:121], v[120:121], v[160:161]
    v_pk_add_f32 v[122:123], v[122:123], v[162:163]
    v_pk_add_f32 v[120:121], v[120:121], v[180:181]
    v_pk_add_f32 v[122:123], v[122:123], v[182:183]
    v_pk_mul_f32 v[88:89], v[120:121], s[74:75]
    v_pk_mul_f32 v[90:91], v[122:123], s[74:75]
    v_exp_f32 v88, v88
    v_exp_f32 v89, v89
    v_exp_f32_e64 v90, v90
    v_exp_f32 v91, v91
    s_nop 0
    v_pk_add_f32 v[88:89], v[88:89], v[30:31]
    v_pk_add_f32 v[90:91], v[90:91], v[30:31]
    v_rcp_f32 v88, v88
    v_rcp_f32 v89, v89
    v_rcp_f32_e64 v90, v90
    v_rcp_f32 v91, v91
    s_nop 0
    v_pk_mul_f32 v[88:89], v[88:89], v[120:121]
    v_pk_mul_f32 v[90:91], v[90:91], v[122:123]
    v_pk_fma_f32 v[88:89], v[88:89], v[248:249], v[48:49]
    v_pk_fma_f32 v[90:91], v[90:91], v[250:251], v[50:51]
    v_cvt_pk_bf16_f32 v192, v88, v89
    v_cvt_pk_bf16_f32 v193, v90, v91
    buffer_store_dwordx2 v[192:193], v29, s[48:51], s68 offen offset:128
    s_branch DONE
IDLE:
    s_movk_i32 s73, 1280
    s_sub_u32 s76, s58, 28
    s_lshl_b32 s76, s76, 3
    s_add_u32 s76, s76, s57
    v_lshrrev_b32 v15, 4, v0
    s_lshl_b32 s78, s3, 2
    v_add_u32 v15, s78, v15
    v_and_b32_e64 v18, 15, v0
    v_mul_u32_u24 v14, 5120, v15
    v_lshl_add_u32 v14, v18, 3, v14
    s_mul_i32 s78, s76, 81920
    v_add_u32_e64 v14, s78, v14
    v_add_u32 v15, 0xfffff100, v14
    v_add_u32 v16, 0xfffff600, v14
    v_add_u32 v17, 0xfffffb00, v14
    v_lshlrev_b32 v18, 5, v18
    s_waitcnt lgkmcnt(0)
    s_load_dword s56, s[30:31], 0
    s_mov_b32 s32, s4
    s_mov_b32 s33, s5
    s_mov_b32 s34, 2621440
    s_mov_b32 s35, 0x20000
    s_mov_b32 s44, s6
    s_mov_b32 s45, s7
    s_mov_b32 s46, 2621440
    s_mov_b32 s47, 0x20000
    s_mov_b32 s48, s8
    s_mov_b32 s49, s9
    s_mov_b32 s50, 2621440
    s_mov_b32 s51, 0x20000
    s_mov_b32 s52, s10
    s_mov_b32 s53, s11
    s_mov_b32 s54, 5120
    s_mov_b32 s55, 0x20000
    s_movk_i32 s79, 896
    s_movk_i32 s80, 3584
    v_add_u32 v22, s79, v14
    v_add_u32 v23, s79, v15
    v_add_u32 v24, s79, v16
    v_add_u32 v25, s79, v17
    buffer_load_dwordx2 v[96:97], v23, s[44:47], 0 offen nt
    buffer_load_dwordx2 v[98:99], v24, s[44:47], 0 offen nt
    buffer_load_dwordx2 v[100:101], v25, s[44:47], 0 offen nt
    buffer_load_dwordx2 v[102:103], v22, s[44:47], 0 offen offset:0 nt
    buffer_load_dwordx2 v[104:105], v22, s[44:47], 0 offen offset:1280 nt
    buffer_load_dwordx2 v[106:107], v22, s[44:47], 0 offen offset:2560 nt
    buffer_load_dwordx2 v[108:109], v22, s[44:47], 0 offen offset:3840 nt
    buffer_load_dwordx4 v[118:121], v18, s[52:55], s80 offen
    buffer_load_dwordx4 v[122:125], v18, s[52:55], s80 offen offset:16
    buffer_load_dwordx2 v[110:111], v22, s[48:51], 0 offen offset:0 nt
    buffer_load_dwordx2 v[112:113], v22, s[48:51], 0 offen offset:1280 nt
    buffer_load_dwordx2 v[114:115], v22, s[48:51], 0 offen offset:2560 nt
    buffer_load_dwordx2 v[116:117], v22, s[48:51], 0 offen offset:3840 nt
    s_mov_b32 s42, 1
    s_mov_b64 exec, 0
    s_cmp_eq_u32 s3, 0
    s_cbranch_scc1 PAGE1
    s_cmp_eq_u32 s3, 1
    s_cbranch_scc1 PAGE3
    s_cmp_eq_u32 s3, 2
    s_cbranch_scc1 PAGE5
    s_branch PAGE7
VISIT_RET_I:
    s_mov_b64 exec, -1
    s_lshl_b32 s80, s76, 7
    s_add_u32 s59, s80, 2883584
    s_lshl_b32 s68, s76, 6
    s_add_u32 s68, s68, 145408
    s_and_b32 s76, s58, 7
    s_lshl_b32 s77, s57, 2
    s_lshr_b32 s78, s58, 3
    s_add_u32 s77, s77, s78
    s_mul_i32 s78, s77, 40960
    s_mul_i32 s79, s76, 160
    s_add_u32 s78, s78, s79
    s_add_u32 s79, s78, 1310720
    s_cmp_lt_u32 s77, 22
    s_cselect_b32 s79, s79, 2211840
    s_lshl_b32 s80, s3, 6
    v_add_u32 v24, s80, v0
    v_cmp_gt_u32 vcc, 320, v24
    v_subrev_u32 v25, 320, v24
    v_mov_b32 v26, s79
    v_mov_b32 v27, s78
    v_cndmask_b32 v25, v25, v24, vcc
    v_cndmask_b32 v26, v26, v27, vcc
    v_mul_u32_u24 v27, 6554, v25
    v_lshrrev_b32 v27, 16, v27
    v_mul_u32_u24 v28, 10, v27
    v_sub_u32_e64 v28, v25, v28
    v_mul_u32_u24 v27, 1280, v27
PAGE6:
    s_cbranch_execz VISIT_RET
    v_lshl_add_u32 v27, v28, 4, v27
    v_add_u32 v80, v27, v26
    v_add_u32_e64 v24, s80, v0
    v_add_u32 v24, 256, v24
    v_cmp_gt_u32 vcc, 320, v24
    v_subrev_u32 v25, 320, v24
    v_mov_b32 v26, s79
    v_mov_b32 v27, s78
    v_cndmask_b32 v25, v25, v24, vcc
    v_cndmask_b32 v26, v26, v27, vcc
    v_mul_u32_u24 v27, 6554, v25
    v_lshrrev_b32 v27, 16, v27
    v_mul_u32_u24 v28, 10, v27
    v_sub_u32_e64 v28, v25, v28
    v_mul_u32_u24 v27, 1280, v27
    v_lshl_add_u32 v27, v28, 4, v27
    v_add_u32 v81, v27, v26
    v_add_u32 v24, s80, v0
    v_add_u32 v24, 512, v24
    v_cmp_gt_u32 vcc, 320, v24
    v_subrev_u32 v25, 320, v24
    v_mov_b32 v26, s79
    v_mov_b32 v27, s78
    v_cndmask_b32 v25, v25, v24, vcc
    v_cndmask_b32 v26, v26, v27, vcc
    v_mul_u32_u24 v27, 6554, v25
    v_lshrrev_b32 v27, 16, v27
    v_mul_u32_u24 v28, 10, v27
    v_sub_u32_e64 v28, v25, v28
    v_mul_u32_u24 v27, 1280, v27
    v_lshl_add_u32 v27, v28, 4, v27
    v_add_u32_e64 v82, v27, v26
    v_mov_b32 v26, 2211840
    v_cmp_gt_u32 vcc, 640, v24
    s_nop 1
    v_cndmask_b32 v82, v26, v82, vcc
    v_and_b32 v203, 15, v0
    v_lshrrev_b32 v204, 5, v0
    s_lshl_b32 s78, s3, 1
    v_add_u32 v204, s78, v204
    v_xor_b32 v204, v204, v203
    v_and_b32 v204, 7, v204
    v_lshlrev_b32_e64 v204, 4, v204
    v_lshl_add_u32 v203, v203, 9, v204
    v_bfe_u32 v204, v0, 4, 1
    v_xor_b32_e64 v204, 1, v204
    v_lshl_add_u32 v203, v204, 3, v203
    v_add_u32 v203, 131584, v203
    s_lshl_b32 s78, s3, 6
    v_add_u32 v205, s78, v0
    v_lshrrev_b32 v206, 3, v205
    v_lshrrev_b32 v204, 5, v205
    v_xor_b32 v204, v204, v205
    v_and_b32 v204, 7, v204
    v_lshlrev_b32_e64 v204, 4, v204
    v_lshl_add_u32 v204, v206, 7, v204
    v_add_u32 v204, 131584, v204
    v_and_b32 v205, 7, v205
    v_lshlrev_b32 v205, 4, v205
    v_lshl_add_u32 v205, v206, 12, v205
    v_add_u32 v206, 0x20000, v205
    s_movk_i32 s79, 1024
    s_movk_i32 s80, 4096
    v_add_u32 v22, s79, v14
    v_add_u32 v23, s79, v15
    v_add_u32 v24, s79, v16
    v_add_u32 v25, s79, v17
    buffer_load_dwordx2 v[126:127], v23, s[44:47], 0 offen nt
    buffer_load_dwordx2 v[128:129], v24, s[44:47], 0 offen nt
    buffer_load_dwordx2 v[130:131], v25, s[44:47], 0 offen nt
    buffer_load_dwordx2 v[132:133], v22, s[44:47], 0 offen offset:0 nt
    buffer_load_dwordx2 v[134:135], v22, s[44:47], 0 offen offset:1280 nt
    buffer_load_dwordx2 v[136:137], v22, s[44:47], 0 offen offset:2560 nt
    buffer_load_dwordx2 v[138:139], v22, s[44:47], 0 offen offset:3840 nt
    buffer_load_dwordx4 v[148:151], v18, s[52:55], s80 offen
    buffer_load_dwordx4 v[152:155], v18, s[52:55], s80 offen offset:16
    buffer_load_dwordx2 v[140:141], v22, s[48:51], 0 offen offset:0 nt
    buffer_load_dwordx2 v[142:143], v22, s[48:51], 0 offen offset:1280 nt
    buffer_load_dwordx2 v[144:145], v22, s[48:51], 0 offen offset:2560 nt
    buffer_load_dwordx2 v[146:147], v22, s[48:51], 0 offen offset:3840 nt
    s_waitcnt vmcnt(17)
    v_lshlrev_b32 v224, 16, v118
    v_and_b32 v228, 0xffff0000, v118
    v_lshlrev_b32 v225, 16, v122
    v_and_b32 v229, 0xffff0000, v122
    v_lshlrev_b32 v226, 16, v120
    v_and_b32 v230, 0xffff0000, v120
    v_lshlrev_b32 v227, 16, v124
    v_and_b32 v231, 0xffff0000, v124
    v_lshlrev_b32 v232, 16, v119
    v_and_b32 v236, 0xffff0000, v119
    v_lshlrev_b32 v233, 16, v123
    v_and_b32 v237, 0xffff0000, v123
    v_lshlrev_b32 v234, 16, v121
    v_and_b32 v238, 0xffff0000, v121
    v_lshlrev_b32 v235, 16, v125
    v_and_b32 v239, 0xffff0000, v125
    v_lshlrev_b32 v208, 16, v96
    v_and_b32 v96, 0xffff0000, v96
    v_lshlrev_b32 v209, 16, v97
    v_and_b32 v97, 0xffff0000, v97
    v_lshlrev_b32 v210, 16, v98
    v_and_b32 v98, 0xffff0000, v98
    v_lshlrev_b32 v211, 16, v99
    v_and_b32 v99, 0xffff0000, v99
    v_lshlrev_b32 v212, 16, v100
    v_and_b32 v100, 0xffff0000, v100
    v_lshlrev_b32 v213, 16, v101
    v_and_b32 v101, 0xffff0000, v101
    v_lshlrev_b32 v214, 16, v102
    v_and_b32 v102, 0xffff0000, v102
    v_lshlrev_b32 v215, 16, v103
    v_and_b32 v103, 0xffff0000, v103
    v_lshlrev_b32 v216, 16, v104
    v_and_b32 v104, 0xffff0000, v104
    v_lshlrev_b32 v217, 16, v105
    v_and_b32 v105, 0xffff0000, v105
    v_lshlrev_b32 v218, 16, v106
    v_and_b32 v106, 0xffff0000, v106
    v_lshlrev_b32 v219, 16, v107
    v_and_b32 v107, 0xffff0000, v107
    v_lshlrev_b32 v220, 16, v108
    v_and_b32 v108, 0xffff0000, v108
    v_lshlrev_b32_e64 v221, 16, v109
    v_and_b32 v109, 0xffff0000, v109
    v_pk_mul_f32 v[240:241], v[214:215], v[224:225]
    v_pk_mul_f32 v[242:243], v[102:103], v[226:227]
    v_pk_mul_f32 v[244:245], v[216:217], v[224:225]
    v_pk_mul_f32 v[246:247], v[104:105], v[226:227]
    v_pk_mul_f32 v[248:249], v[218:219], v[224:225]
    v_pk_mul_f32 v[250:251], v[106:107], v[226:227]
    v_pk_mul_f32 v[252:253], v[220:221], v[224:225]
    v_pk_mul_f32 v[254:255], v[108:109], v[226:227]
    v_pk_fma_f32 v[240:241], v[212:213], v[228:229], v[240:241]
    v_pk_fma_f32 v[242:243], v[100:101], v[230:231], v[242:243]
    v_pk_fma_f32 v[244:245], v[214:215], v[228:229], v[244:245]
    v_pk_fma_f32 v[246:247], v[102:103], v[230:231], v[246:247]
    v_pk_fma_f32 v[248:249], v[216:217], v[228:229], v[248:249]
    v_pk_fma_f32 v[250:251], v[104:105], v[230:231], v[250:251]
    v_pk_fma_f32 v[252:253], v[218:219], v[228:229], v[252:253]
    v_pk_fma_f32 v[254:255], v[106:107], v[230:231], v[254:255]
    v_pk_fma_f32 v[240:241], v[210:211], v[232:233], v[240:241]
    v_pk_fma_f32 v[242:243], v[98:99], v[234:235], v[242:243]
    v_pk_fma_f32 v[244:245], v[212:213], v[232:233], v[244:245]
    v_pk_fma_f32 v[246:247], v[100:101], v[234:235], v[246:247]
    v_pk_fma_f32 v[248:249], v[214:215], v[232:233], v[248:249]
    v_pk_fma_f32 v[250:251], v[102:103], v[234:235], v[250:251]
    v_pk_fma_f32 v[252:253], v[216:217], v[232:233], v[252:253]
    v_pk_fma_f32 v[254:255], v[104:105], v[234:235], v[254:255]
    v_pk_fma_f32 v[240:241], v[208:209], v[236:237], v[240:241]
    v_pk_fma_f32 v[242:243], v[96:97], v[238:239], v[242:243]
    v_pk_fma_f32 v[244:245], v[210:211], v[236:237], v[244:245]
    v_pk_fma_f32 v[246:247], v[98:99], v[238:239], v[246:247]
    v_pk_fma_f32 v[248:249], v[212:213], v[236:237], v[248:249]
    v_pk_fma_f32 v[250:251], v[100:101], v[238:239], v[250:251]
    v_pk_fma_f32 v[252:253], v[214:215], v[236:237], v[252:253]
    v_pk_fma_f32 v[254:255], v[102:103], v[238:239], v[254:255]
    s_waitcnt vmcnt(13)
    v_lshlrev_b32 v208, 16, v110
    v_and_b32 v110, 0xffff0000, v110
    v_lshlrev_b32 v209, 16, v111
    v_and_b32 v111, 0xffff0000, v111
    v_lshlrev_b32 v210, 16, v112
    v_and_b32 v112, 0xffff0000, v112
    v_lshlrev_b32 v211, 16, v113
    v_and_b32 v113, 0xffff0000, v113
    v_lshlrev_b32 v212, 16, v114
    v_and_b32 v114, 0xffff0000, v114
    v_lshlrev_b32 v213, 16, v115
    v_and_b32 v115, 0xffff0000, v115
    v_lshlrev_b32 v214, 16, v116
    v_and_b32 v116, 0xffff0000, v116
    v_lshlrev_b32_e64 v215, 16, v117
    v_and_b32 v117, 0xffff0000, v117
    v_pk_mul_f32 v[240:241], v[240:241], v[208:209]
    v_pk_mul_f32 v[242:243], v[242:243], v[110:111]
    v_pk_mul_f32 v[244:245], v[244:245], v[210:211]
    v_pk_mul_f32 v[246:247], v[246:247], v[112:113]
    v_pk_mul_f32 v[248:249], v[248:249], v[212:213]
    v_pk_mul_f32 v[250:251], v[250:251], v[114:115]
    v_pk_mul_f32 v[252:253], v[252:253], v[214:215]
    v_pk_mul_f32 v[254:255], v[254:255], v[116:117]
    v_cvt_pk_bf16_f32 v224, v252, v248
    v_cvt_pk_bf16_f32 v225, v244, v240
    v_cvt_pk_bf16_f32 v226, v254, v250
    v_cvt_pk_bf16_f32 v227, v246, v242
    v_cvt_pk_bf16_f32 v228, v253, v249
    v_cvt_pk_bf16_f32 v229, v245, v241
    v_cvt_pk_bf16_f32 v230, v255, v251
    v_cvt_pk_bf16_f32 v231, v247, v243
    ds_write_b64 v203, v[224:225] offset:0
    ds_write_b64 v203, v[226:227] offset:128
    ds_write_b64 v203, v[228:229] offset:256
    ds_write_b64 v203, v[230:231] offset:384
    s_movk_i32 s79, 1152
    s_movk_i32 s80, 4608
    v_add_u32 v22, s79, v14
    v_add_u32 v23, s79, v15
    v_add_u32 v24, s79, v16
    v_add_u32 v25, s79, v17
    buffer_load_dwordx2 v[156:157], v23, s[44:47], 0 offen nt
    buffer_load_dwordx2 v[158:159], v24, s[44:47], 0 offen nt
    buffer_load_dwordx2 v[160:161], v25, s[44:47], 0 offen nt
    buffer_load_dwordx2 v[162:163], v22, s[44:47], 0 offen offset:0 nt
    buffer_load_dwordx2 v[164:165], v22, s[44:47], 0 offen offset:1280 nt
    buffer_load_dwordx2 v[166:167], v22, s[44:47], 0 offen offset:2560 nt
    buffer_load_dwordx2 v[168:169], v22, s[44:47], 0 offen offset:3840 nt
    buffer_load_dwordx4 v[178:181], v18, s[52:55], s80 offen
    buffer_load_dwordx4 v[182:185], v18, s[52:55], s80 offen offset:16
    buffer_load_dwordx2 v[170:171], v22, s[48:51], 0 offen offset:0 nt
    buffer_load_dwordx2 v[172:173], v22, s[48:51], 0 offen offset:1280 nt
    buffer_load_dwordx2 v[174:175], v22, s[48:51], 0 offen offset:2560 nt
    buffer_load_dwordx2 v[176:177], v22, s[48:51], 0 offen offset:3840 nt
    s_mov_b32 s36, s30
    s_mov_b32 s37, s31
    s_mov_b32 s38, 17563648
    s_mov_b32 s39, 0x20000
    v_mov_b32 v30, 17563648
    s_cmp_eq_u32 s3, 0
    s_cselect_b32 s80, s68, 17563648
    v_writelane_b32 v30, s80, 1
    s_lshl_b32 s77, s57, 1
    s_lshr_b32 s78, s58, 4
    s_add_u32 s77, s77, s78
    s_lshl_b32 s77, s77, 4
    s_and_b32 s78, s58, 15
    s_add_u32 s77, s77, s78
    s_lshl_b32 s77, s77, 6
    s_add_u32 s77, s77, 196608
    s_cmp_eq_u32 s3, 0
    s_cselect_b32 s77, s77, 17563648
    v_writelane_b32 v30, s77, 0
    s_and_b32 s77, s58, 7
    s_lshl_b32 s77, s77, 5
    s_lshl_b32 s78, s57, 2
    s_lshr_b32 s79, s58, 3
    s_add_u32 s78, s78, s79
    s_add_u32 s77, s77, s78
    s_lshl_b32 s77, s77, 6
    s_add_u32 s77, s77, 163840
    s_cmp_eq_u32 s3, 0
    s_cselect_b32 s77, s77, 17563648
    v_writelane_b32 v30, s77, 2
    s_waitcnt lgkmcnt(0)
    s_add_u32 s56, s56, 2654435769
    v_mov_b32 v31, s56
    s_waitcnt vmcnt(17)
    v_lshlrev_b32 v224, 16, v148
    v_and_b32 v228, 0xffff0000, v148
    v_lshlrev_b32 v225, 16, v152
    v_and_b32 v229, 0xffff0000, v152
    v_lshlrev_b32 v226, 16, v150
    v_and_b32 v230, 0xffff0000, v150
    v_lshlrev_b32 v227, 16, v154
    v_and_b32 v231, 0xffff0000, v154
    v_lshlrev_b32 v232, 16, v149
    v_and_b32 v236, 0xffff0000, v149
    v_lshlrev_b32 v233, 16, v153
    v_and_b32 v237, 0xffff0000, v153
    v_lshlrev_b32 v234, 16, v151
    v_and_b32 v238, 0xffff0000, v151
    v_lshlrev_b32 v235, 16, v155
    v_and_b32 v239, 0xffff0000, v155
    v_lshlrev_b32 v208, 16, v126
    v_and_b32 v126, 0xffff0000, v126
    v_lshlrev_b32 v209, 16, v127
    v_and_b32 v127, 0xffff0000, v127
    v_lshlrev_b32 v210, 16, v128
    v_and_b32 v128, 0xffff0000, v128
    v_lshlrev_b32 v211, 16, v129
    v_and_b32 v129, 0xffff0000, v129
    v_lshlrev_b32 v212, 16, v130
    v_and_b32 v130, 0xffff0000, v130
    v_lshlrev_b32 v213, 16, v131
    v_and_b32 v131, 0xffff0000, v131
    v_lshlrev_b32 v214, 16, v132
    v_and_b32 v132, 0xffff0000, v132
    v_lshlrev_b32 v215, 16, v133
    v_and_b32 v133, 0xffff0000, v133
    v_lshlrev_b32 v216, 16, v134
    v_and_b32 v134, 0xffff0000, v134
    v_lshlrev_b32 v217, 16, v135
    v_and_b32 v135, 0xffff0000, v135
    v_lshlrev_b32 v218, 16, v136
    v_and_b32 v136, 0xffff0000, v136
    v_lshlrev_b32 v219, 16, v137
    v_and_b32 v137, 0xffff0000, v137
    v_lshlrev_b32 v220, 16, v138
    v_and_b32 v138, 0xffff0000, v138
    v_lshlrev_b32 v221, 16, v139
    v_and_b32 v139, 0xffff0000, v139
    v_pk_mul_f32 v[240:241], v[214:215], v[224:225]
    v_pk_mul_f32 v[242:243], v[132:133], v[226:227]
    v_pk_mul_f32 v[244:245], v[216:217], v[224:225]
    v_pk_mul_f32 v[246:247], v[134:135], v[226:227]
    v_pk_mul_f32 v[248:249], v[218:219], v[224:225]
    v_pk_mul_f32 v[250:251], v[136:137], v[226:227]
    v_pk_mul_f32 v[252:253], v[220:221], v[224:225]
    v_pk_mul_f32 v[254:255], v[138:139], v[226:227]
    v_pk_fma_f32 v[240:241], v[212:213], v[228:229], v[240:241]
    v_pk_fma_f32 v[242:243], v[130:131], v[230:231], v[242:243]
    v_pk_fma_f32 v[244:245], v[214:215], v[228:229], v[244:245]
    v_pk_fma_f32 v[246:247], v[132:133], v[230:231], v[246:247]
    v_pk_fma_f32 v[248:249], v[216:217], v[228:229], v[248:249]
    v_pk_fma_f32 v[250:251], v[134:135], v[230:231], v[250:251]
    v_pk_fma_f32 v[252:253], v[218:219], v[228:229], v[252:253]
    v_pk_fma_f32 v[254:255], v[136:137], v[230:231], v[254:255]
    v_pk_fma_f32 v[240:241], v[210:211], v[232:233], v[240:241]
    v_pk_fma_f32 v[242:243], v[128:129], v[234:235], v[242:243]
    v_pk_fma_f32 v[244:245], v[212:213], v[232:233], v[244:245]
    v_pk_fma_f32 v[246:247], v[130:131], v[234:235], v[246:247]
    v_pk_fma_f32 v[248:249], v[214:215], v[232:233], v[248:249]
    v_pk_fma_f32 v[250:251], v[132:133], v[234:235], v[250:251]
    v_pk_fma_f32 v[252:253], v[216:217], v[232:233], v[252:253]
    v_pk_fma_f32 v[254:255], v[134:135], v[234:235], v[254:255]
    v_pk_fma_f32 v[240:241], v[208:209], v[236:237], v[240:241]
    v_pk_fma_f32 v[242:243], v[126:127], v[238:239], v[242:243]
    v_pk_fma_f32 v[244:245], v[210:211], v[236:237], v[244:245]
    v_pk_fma_f32 v[246:247], v[128:129], v[238:239], v[246:247]
    v_pk_fma_f32 v[248:249], v[212:213], v[236:237], v[248:249]
    v_pk_fma_f32 v[250:251], v[130:131], v[238:239], v[250:251]
    v_pk_fma_f32 v[252:253], v[214:215], v[236:237], v[252:253]
    v_pk_fma_f32 v[254:255], v[132:133], v[238:239], v[254:255]
    s_waitcnt vmcnt(13)
    v_lshlrev_b32 v208, 16, v140
    v_and_b32 v140, 0xffff0000, v140
    v_lshlrev_b32 v209, 16, v141
    v_and_b32 v141, 0xffff0000, v141
    v_lshlrev_b32 v210, 16, v142
    v_and_b32 v142, 0xffff0000, v142
    v_lshlrev_b32 v211, 16, v143
    v_and_b32 v143, 0xffff0000, v143
    v_lshlrev_b32 v212, 16, v144
    v_and_b32 v144, 0xffff0000, v144
    v_lshlrev_b32 v213, 16, v145
    v_and_b32 v145, 0xffff0000, v145
    v_lshlrev_b32 v214, 16, v146
    v_and_b32 v146, 0xffff0000, v146
    v_lshlrev_b32_e64 v215, 16, v147
    v_and_b32 v147, 0xffff0000, v147
    v_pk_mul_f32 v[240:241], v[240:241], v[208:209]
    v_pk_mul_f32 v[242:243], v[242:243], v[140:141]
    v_pk_mul_f32 v[244:245], v[244:245], v[210:211]
    v_pk_mul_f32 v[246:247], v[246:247], v[142:143]
    v_pk_mul_f32 v[248:249], v[248:249], v[212:213]
    v_pk_mul_f32 v[250:251], v[250:251], v[144:145]
    v_pk_mul_f32 v[252:253], v[252:253], v[214:215]
    v_pk_mul_f32 v[254:255], v[254:255], v[146:147]
    v_cvt_pk_bf16_f32 v224, v252, v248
    v_cvt_pk_bf16_f32 v225, v244, v240
    v_cvt_pk_bf16_f32 v226, v254, v250
    v_cvt_pk_bf16_f32 v227, v246, v242
    v_cvt_pk_bf16_f32 v228, v253, v249
    v_cvt_pk_bf16_f32 v229, v245, v241
    v_cvt_pk_bf16_f32 v230, v255, v251
    v_cvt_pk_bf16_f32 v231, v247, v243
    ds_write_b64 v203, v[224:225] offset:8192
    ds_write_b64 v203, v[226:227] offset:8320
    ds_write_b64 v203, v[228:229] offset:8448
    ds_write_b64 v203, v[230:231] offset:8576
    s_mul_i32 s84, s57, 24
    s_sub_u32 s78, s58, 28
    s_mul_i32 s78, s78, 6
    s_add_u32 s84, s84, s78
    s_add_u32 s84, s84, 448
    s_add_u32 s84, s84, s3
    s_mul_i32 s86, s3, 21248
    s_lshl_b32 s85, s84, 12
    s_add_u32 s44, s12, s85
    s_addc_u32 s45, s13, 0
    s_mov_b32 s46, 4096
    s_mov_b32 s47, 0x20000
    s_add_u32 s88, s85, 1048576
    v_lshlrev_b32_e64 v1, 4, v0
    buffer_load_dwordx4 v[32:35], v1, s[44:47], 0 offen offset:0 nt
    buffer_load_dwordx4 v[36:39], v1, s[44:47], 0 offen offset:1024 nt
    buffer_load_dwordx4 v[40:43], v1, s[44:47], 0 offen offset:2048 nt
    buffer_load_dwordx4 v[44:47], v1, s[44:47], 0 offen offset:3072 nt
    s_lshl_b32 s78, s57, 8
    s_lshl_b32 s79, s58, 3
    s_add_u32 s78, s78, s79
    s_lshl_b32 s79, s3, 1
    s_add_u32 s78, s78, s79
    v_lshrrev_b32 v196, 5, v0
    v_add_u32 v196, s78, v196
    v_and_b32 v197, 31, v0
    v_lshlrev_b32 v197, 3, v197
    v_mad_u32_u24 v197, v196, s73, v197
    v_lshlrev_b32 v196, 3, v196
    buffer_load_dwordx2 v[186:187], v197, s[32:35], 0 offen offset:0
    buffer_load_dwordx2 v[188:189], v197, s[32:35], 0 offen offset:256
    buffer_load_dwordx2 v[190:191], v197, s[32:35], 0 offen offset:512
    buffer_load_dwordx2 v[192:193], v197, s[32:35], 0 offen offset:768
    buffer_load_dwordx2 v[194:195], v197, s[32:35], 0 offen offset:1024
    s_mov_b32 s52, s22
    s_mov_b32 s53, s23
    s_mov_b32 s54, 2211840
    s_mov_b32 s55, 0x20000
    s_and_b32 s77, s58, 7
    s_lshl_b32 s78, s57, 2
    s_lshr_b32 s79, s58, 3
    s_add_u32 s78, s78, s79
    s_mul_i32 s77, s77, 54
    s_add_u32 s77, s77, s78
    s_mul_i32 s77, s77, 5120
    s_add_u32 s77, s77, 4194304
    v_lshrrev_b32_e64 v24, 4, v0
    v_bfe_u32 v25, v0, 2, 2
    v_lshl_add_u32 v24, v24, 2, v25
    v_mul_u32_u24 v24, 160, v24
    v_and_b32 v25, 3, v0
    s_add_u32 s79, s3, 0
    s_cmp_ge_u32 s79, 5
    s_cselect_b32 s80, 1, 0
    s_mul_i32 s81, s80, 5
    s_sub_u32 s79, s79, s81
    s_mul_i32 s81, s80, 163840
    s_add_u32 s81, s81, s77
    s_lshl_b32 s82, s79, 10
    s_add_u32 s81, s81, s82
    s_cmp_ge_u32 s78, 22
    s_cselect_b32 s82, s80, 0
    s_cmp_ge_u32 s79, 5
    s_cselect_b32 s82, 1, s82
    s_cmp_lg_u32 s82, 0
    s_cselect_b32 s74, 17563648, s81
    s_min_u32 s79, s79, 4
    s_and_b32 s82, s79, 1
    s_lshl_b32 s82, s82, 3
    s_lshr_b32 s83, s79, 1
    s_lshl_b32 s83, s83, 6
    s_add_u32 s82, s82, s83
    s_mul_i32 s83, s80, 5120
    s_add_u32 s82, s82, s83
    s_add_u32 s82, s82, 114688
    s_cmp_eq_u32 s79, 4
    s_cselect_b32 s83, 3, 4
    v_lshlrev_b32 v200, s83, v25
    v_add3_u32 v200, v200, v24, s82
    s_add_u32 s79, s3, 4
    s_cmp_ge_u32 s79, 5
    s_cselect_b32 s80, 1, 0
    s_mul_i32 s81, s80, 5
    s_sub_u32 s79, s79, s81
    s_mul_i32 s81, s80, 163840
    s_add_u32 s81, s81, s77
    s_lshl_b32 s82, s79, 10
    s_add_u32 s81, s81, s82
    s_cmp_ge_u32 s78, 22
    s_cselect_b32 s82, s80, 0
    s_cmp_ge_u32 s79, 5
    s_cselect_b32 s82, 1, s82
    s_cmp_lg_u32 s82, 0
    s_cselect_b32 s75, 17563648, s81
    s_min_u32 s79, s79, 4
    s_and_b32 s82, s79, 1
    s_lshl_b32 s82, s82, 3
    s_lshr_b32 s83, s79, 1
    s_lshl_b32 s83, s83, 6
    s_add_u32 s82, s82, s83
    s_mul_i32 s83, s80, 5120
    s_add_u32 s82, s82, s83
    s_add_u32 s82, s82, 114688
    s_cmp_eq_u32 s79, 4
    s_cselect_b32 s83, 3, 4
    v_lshlrev_b32 v201, s83, v25
    v_add3_u32 v201, v201, v24, s82
    s_add_u32 s79, s3, 8
    s_cmp_ge_u32 s79, 5
    s_cselect_b32 s80, 1, 0
    s_mul_i32 s81, s80, 5
    s_sub_u32 s79, s79, s81
    s_mul_i32 s81, s80, 163840
    s_add_u32 s81, s81, s77
    s_lshl_b32 s82, s79, 10
    s_add_u32 s81, s81, s82
    s_cmp_ge_u32 s78, 22
    s_cselect_b32 s82, s80, 0
    s_cmp_ge_u32 s79, 5
    s_cselect_b32 s82, 1, s82
    s_cmp_lg_u32 s82, 0
    s_cselect_b32 s76, 17563648, s81
    s_min_u32 s79, s79, 4
    s_and_b32 s82, s79, 1
    s_lshl_b32 s82, s82, 3
    s_lshr_b32 s83, s79, 1
    s_lshl_b32 s83, s83, 6
    s_add_u32 s82, s82, s83
    s_mul_i32 s83, s80, 5120
    s_add_u32 s82, s82, s83
    s_add_u32 s82, s82, 114688
    s_cmp_eq_u32 s79, 4
    s_cselect_b32 s83, 3, 4
    v_lshlrev_b32 v202, s83, v25
    v_add3_u32 v202, v202, v24, s82
    s_waitcnt vmcnt(13)
    v_lshlrev_b32 v224, 16, v178
    v_and_b32 v228, 0xffff0000, v178
    v_lshlrev_b32 v225, 16, v182
    v_and_b32 v229, 0xffff0000, v182
    v_lshlrev_b32 v226, 16, v180
    v_and_b32 v230, 0xffff0000, v180
    v_lshlrev_b32 v227, 16, v184
    v_and_b32 v231, 0xffff0000, v184
    v_lshlrev_b32 v232, 16, v179
    v_and_b32 v236, 0xffff0000, v179
    v_lshlrev_b32 v233, 16, v183
    v_and_b32 v237, 0xffff0000, v183
    v_lshlrev_b32 v234, 16, v181
    v_and_b32 v238, 0xffff0000, v181
    v_lshlrev_b32 v235, 16, v185
    v_and_b32 v239, 0xffff0000, v185
    v_lshlrev_b32 v208, 16, v156
    v_and_b32 v156, 0xffff0000, v156
    v_lshlrev_b32 v209, 16, v157
    v_and_b32 v157, 0xffff0000, v157
    v_lshlrev_b32 v210, 16, v158
    v_and_b32 v158, 0xffff0000, v158
    v_lshlrev_b32 v211, 16, v159
    v_and_b32 v159, 0xffff0000, v159
    v_lshlrev_b32 v212, 16, v160
    v_and_b32 v160, 0xffff0000, v160
    v_lshlrev_b32 v213, 16, v161
    v_and_b32 v161, 0xffff0000, v161
    v_lshlrev_b32 v214, 16, v162
    v_and_b32 v162, 0xffff0000, v162
    v_lshlrev_b32 v215, 16, v163
    v_and_b32 v163, 0xffff0000, v163
    v_lshlrev_b32 v216, 16, v164
    v_and_b32 v164, 0xffff0000, v164
    v_lshlrev_b32 v217, 16, v165
    v_and_b32 v165, 0xffff0000, v165
    v_lshlrev_b32 v218, 16, v166
    v_and_b32 v166, 0xffff0000, v166
    v_lshlrev_b32 v219, 16, v167
    v_and_b32 v167, 0xffff0000, v167
    v_lshlrev_b32 v220, 16, v168
    v_and_b32 v168, 0xffff0000, v168
    v_lshlrev_b32_e64 v221, 16, v169
    v_and_b32 v169, 0xffff0000, v169
    v_pk_mul_f32 v[240:241], v[214:215], v[224:225]
    v_pk_mul_f32 v[242:243], v[162:163], v[226:227]
    v_pk_mul_f32 v[244:245], v[216:217], v[224:225]
    v_pk_mul_f32 v[246:247], v[164:165], v[226:227]
    v_pk_mul_f32 v[248:249], v[218:219], v[224:225]
    v_pk_mul_f32 v[250:251], v[166:167], v[226:227]
    v_pk_mul_f32 v[252:253], v[220:221], v[224:225]
    v_pk_mul_f32 v[254:255], v[168:169], v[226:227]
    v_pk_fma_f32 v[240:241], v[212:213], v[228:229], v[240:241]
    v_pk_fma_f32 v[242:243], v[160:161], v[230:231], v[242:243]
    v_pk_fma_f32 v[244:245], v[214:215], v[228:229], v[244:245]
    v_pk_fma_f32 v[246:247], v[162:163], v[230:231], v[246:247]
    v_pk_fma_f32 v[248:249], v[216:217], v[228:229], v[248:249]
    v_pk_fma_f32 v[250:251], v[164:165], v[230:231], v[250:251]
    v_pk_fma_f32 v[252:253], v[218:219], v[228:229], v[252:253]
    v_pk_fma_f32 v[254:255], v[166:167], v[230:231], v[254:255]
    v_pk_fma_f32 v[240:241], v[210:211], v[232:233], v[240:241]
    v_pk_fma_f32 v[242:243], v[158:159], v[234:235], v[242:243]
    v_pk_fma_f32 v[244:245], v[212:213], v[232:233], v[244:245]
    v_pk_fma_f32 v[246:247], v[160:161], v[234:235], v[246:247]
    v_pk_fma_f32 v[248:249], v[214:215], v[232:233], v[248:249]
    v_pk_fma_f32 v[250:251], v[162:163], v[234:235], v[250:251]
    v_pk_fma_f32 v[252:253], v[216:217], v[232:233], v[252:253]
    v_pk_fma_f32 v[254:255], v[164:165], v[234:235], v[254:255]
    v_pk_fma_f32 v[240:241], v[208:209], v[236:237], v[240:241]
    v_pk_fma_f32 v[242:243], v[156:157], v[238:239], v[242:243]
    v_pk_fma_f32 v[244:245], v[210:211], v[236:237], v[244:245]
    v_pk_fma_f32 v[246:247], v[158:159], v[238:239], v[246:247]
    v_pk_fma_f32 v[248:249], v[212:213], v[236:237], v[248:249]
    v_pk_fma_f32 v[250:251], v[160:161], v[238:239], v[250:251]
    v_pk_fma_f32 v[252:253], v[214:215], v[236:237], v[252:253]
    v_pk_fma_f32 v[254:255], v[162:163], v[238:239], v[254:255]
    s_waitcnt vmcnt(9)
    v_lshlrev_b32 v208, 16, v170
    v_and_b32 v170, 0xffff0000, v170
    v_lshlrev_b32 v209, 16, v171
    v_and_b32 v171, 0xffff0000, v171
    v_lshlrev_b32 v210, 16, v172
    v_and_b32 v172, 0xffff0000, v172
    v_lshlrev_b32 v211, 16, v173
    v_and_b32 v173, 0xffff0000, v173
    v_lshlrev_b32 v212, 16, v174
    v_and_b32 v174, 0xffff0000, v174
    v_lshlrev_b32 v213, 16, v175
    v_and_b32 v175, 0xffff0000, v175
    v_lshlrev_b32 v214, 16, v176
    v_and_b32 v176, 0xffff0000, v176
    v_lshlrev_b32_e64 v215, 16, v177
    v_and_b32 v177, 0xffff0000, v177
    v_pk_mul_f32 v[240:241], v[240:241], v[208:209]
    v_pk_mul_f32 v[242:243], v[242:243], v[170:171]
    v_pk_mul_f32 v[244:245], v[244:245], v[210:211]
    v_pk_mul_f32 v[246:247], v[246:247], v[172:173]
    v_pk_mul_f32 v[248:249], v[248:249], v[212:213]
    v_pk_mul_f32 v[250:251], v[250:251], v[174:175]
    v_pk_mul_f32 v[252:253], v[252:253], v[214:215]
    v_pk_mul_f32 v[254:255], v[254:255], v[176:177]
    v_cvt_pk_bf16_f32 v224, v252, v248
    v_cvt_pk_bf16_f32 v225, v244, v240
    v_cvt_pk_bf16_f32 v226, v254, v250
    v_cvt_pk_bf16_f32 v227, v246, v242
    v_cvt_pk_bf16_f32 v228, v253, v249
    v_cvt_pk_bf16_f32 v229, v245, v241
    v_cvt_pk_bf16_f32 v230, v255, v251
    v_cvt_pk_bf16_f32 v231, v247, v243
    ds_write_b64 v203, v[224:225] offset:16384
    ds_write_b64 v203, v[226:227] offset:16512
    ds_write_b64 v203, v[228:229] offset:16640
    ds_write_b64 v203, v[230:231] offset:16768
    s_waitcnt lgkmcnt(0)
    s_barrier
    ds_read_b128 v[208:211], v204 offset:0
    ds_read_b128 v[212:215], v204 offset:4096
    ds_read_b128 v[216:219], v204 offset:8192
    ds_read_b128 v[220:223], v204 offset:12288
    ds_read_b128 v[224:227], v204 offset:16384
    ds_read_b128 v[228:231], v204 offset:20480
    s_waitcnt lgkmcnt(4)
    buffer_store_dwordx4 v[208:211], v205, s[36:39], s59 offen sc1
    buffer_store_dwordx4 v[212:215], v206, s[36:39], s59 offen sc1
    s_add_u32 s59, s59, 262144
    s_waitcnt lgkmcnt(2)
    buffer_store_dwordx4 v[216:219], v205, s[36:39], s59 offen sc1
    buffer_store_dwordx4 v[220:223], v206, s[36:39], s59 offen sc1
    s_add_u32 s59, s59, 262144
    s_waitcnt lgkmcnt(0)
    buffer_store_dwordx4 v[224:227], v205, s[36:39], s59 offen sc1
    buffer_store_dwordx4 v[228:231], v206, s[36:39], s59 offen sc1
    s_add_u32 s59, s59, 262144
    s_lshl_b32 s81, s3, 10
    s_add_u32 m0, s81, 114688
    s_nop 0
    buffer_load_dwordx4 v80, s[52:55], 0 offen nt lds
    s_add_u32 m0, s81, 118784
    s_nop 0
    buffer_load_dwordx4 v81, s[52:55], 0 offen nt lds
    s_add_u32 m0, s81, 122880
    s_nop 0
    buffer_load_dwordx4 v82, s[52:55], 0 offen nt lds
    s_waitcnt vmcnt(9)
    s_mov_b32 s78, 0x3f803f80
PAGE7:
    s_cbranch_execz PAGE8
    v_mov_b32 v232, 0
    v_mov_b32 v233, 0
    v_dot2c_f32_bf16 v232, s78, v186
    v_dot2c_f32_bf16 v233, v186, v186
    v_dot2c_f32_bf16 v232, s78, v187
    v_dot2c_f32_bf16 v233, v187, v187
    v_dot2c_f32_bf16 v232, s78, v188
    v_dot2c_f32_bf16 v233, v188, v188
    v_dot2c_f32_bf16 v232, s78, v189
    v_dot2c_f32_bf16 v233, v189, v189
    v_dot2c_f32_bf16 v232, s78, v190
    v_dot2c_f32_bf16 v233, v190, v190
    v_dot2c_f32_bf16 v232, s78, v191
    v_dot2c_f32_bf16 v233, v191, v191
    v_dot2c_f32_bf16 v232, s78, v192
    v_dot2c_f32_bf16 v233, v192, v192
    v_dot2c_f32_bf16 v232, s78, v193
    v_dot2c_f32_bf16 v233, v193, v193
    v_dot2c_f32_bf16 v232, s78, v194
    v_dot2c_f32_bf16 v233, v194, v194
    v_dot2c_f32_bf16 v232, s78, v195
    v_dot2c_f32_bf16 v233, v195, v195
    s_nop 1
    v_add_f32_dpp v232, v232, v232 row_ror:8 row_mask:0xf bank_mask:0xf
    v_add_f32_dpp v233, v233, v233 row_ror:8 row_mask:0xf bank_mask:0xf
    s_nop 1
    v_add_f32_dpp v232, v232, v232 row_ror:4 row_mask:0xf bank_mask:0xf
    v_add_f32_dpp v233, v233, v233 row_ror:4 row_mask:0xf bank_mask:0xf
    s_nop 1
    v_add_f32_dpp v232, v232, v232 row_ror:2 row_mask:0xf bank_mask:0xf
    v_add_f32_dpp v233, v233, v233 row_ror:2 row_mask:0xf bank_mask:0xf
    s_nop 1
    v_add_f32_dpp v232, v232, v232 row_ror:1 row_mask:0xf bank_mask:0xf
    v_add_f32_dpp v233, v233, v233 row_ror:1 row_mask:0xf bank_mask:0xf
    s_nop 1
    v_add_f32_dpp v232, v232, v232 row_bcast:15 row_mask:0xa bank_mask:0xf
    v_add_f32_dpp v233, v233, v233 row_bcast:15 row_mask:0xa bank_mask:0xf
    s_nop 0
    v_mul_f32 v234, 0x3acccccd, v232
    v_mul_f32 v233, 0x3acccccd, v233
    v_fma_f32 v233, -v234, v234, v233
    v_max_f32 v233, 0, v233
    v_add_f32 v233, 0x3727c5ac, v233
    v_rsq_f32_e64 v235, v233
    s_mov_b32 s78, 65536
    s_mov_b32 exec_lo, 0x10000
    s_mov_b32 exec_hi, 0x10000
    buffer_store_dwordx2 v[234:235], v196, s[36:39], s78 offen sc1
    s_mov_b64 exec, -1
    s_waitcnt vmcnt(4)
    s_barrier
    s_mov_b32 exec_lo, 2
    s_mov_b32 exec_hi, 0
    buffer_store_dword v31, v30, s[36:39], 0 offen sc1
    s_mov_b64 exec, -1
    s_waitcnt vmcnt(16)
I_LATE:
    s_nop 0
    v_mov_b32_dpp v51, v36 wave_rol:1 row_mask:0xf bank_mask:0xf
    v_mov_b32_dpp v64, v37 wave_rol:1 row_mask:0xf bank_mask:0xf
    v_mov_b32_dpp v55, v40 wave_rol:1 row_mask:0xf bank_mask:0xf
    v_mov_b32_dpp v65, v41 wave_rol:1 row_mask:0xf bank_mask:0xf
    v_mov_b32_dpp v59, v44 wave_rol:1 row_mask:0xf bank_mask:0xf
    v_mov_b32_dpp v66, v45 wave_rol:1 row_mask:0xf bank_mask:0xf
    v_mov_b32 v48, v33
    v_mov_b32 v49, v34
    v_mov_b32 v50, v35
    v_mov_b32 v52, v37
    v_mov_b32 v53, v38
    v_mov_b32 v54, v39
    v_mov_b32 v56, v41
    v_mov_b32 v57, v42
    v_mov_b32 v58, v43
    v_mov_b32 v60, v45
    v_mov_b32 v61, v46
    v_mov_b32 v62, v47
    v_mov_b32_dpp v51, v32 wave_shl:1 row_mask:0xf bank_mask:0xf
    v_mov_b32_dpp v64, v33 wave_shl:1 row_mask:0xf bank_mask:0xf
    v_mov_b32_dpp v55, v36 wave_shl:1 row_mask:0xf bank_mask:0xf
    v_mov_b32_dpp v65, v37 wave_shl:1 row_mask:0xf bank_mask:0xf
    v_mov_b32_dpp v59, v40 wave_shl:1 row_mask:0xf bank_mask:0xf
    v_mov_b32_dpp v66, v41 wave_shl:1 row_mask:0xf bank_mask:0xf
    v_mov_b32_dpp v63, v44 wave_shl:1 row_mask:0xf bank_mask:0xf bound_ctrl:0
    v_mov_b32_dpp v67, v45 wave_shl:1 row_mask:0xf bank_mask:0xf bound_ctrl:0
    s_nop 1
    v_lshlrev_b32 v1, 4, v0
    v_add_u32 v5, s86, v1
    v_mov_b32 v20, 0
    v_mov_b32 v21, 0
    v_mov_b32 v22, 0
    v_mov_b32 v23, 0
    v_lshrrev_b32 v4, 1, v0
    v_mul_u32_u24 v4, 4160, v4
    v_and_b32 v6, 1, v0
    v_lshl_add_u32 v4, v6, 4, v4
    v_add_u32 v4, s86, v4
    s_mov_b32 exec_lo, 0xff
    s_mov_b32 exec_hi, 0
    ds_write_b128 v4, v[20:23]
    s_mov_b32 exec_lo, -1
    ds_write_b128 v5, v[20:23] offset:16640
    v_lshlrev_b32 v12, 16, v32
    v_alignbit_b32 v13, v48, v32, 16
    s_mov_b32 exec_lo, 1
    ds_write_b32 v5, v12 offset:4188
    ds_write_b32 v5, v32 offset:8348
    ds_write_b64 v5, v[12:13] offset:12504
    s_mov_b64 exec, -1
    s_nop 0
    v_alignbit_b32 v96, v48, v32, 16
    v_alignbit_b32 v100, v49, v48, 16
    v_alignbit_b32 v97, v49, v33, 16
    v_alignbit_b32 v101, v50, v49, 16
    v_alignbit_b32 v98, v50, v34, 16
    v_alignbit_b32 v102, v51, v50, 16
    v_alignbit_b32 v99, v51, v35, 16
    v_alignbit_b32 v103, v64, v51, 16
    ds_write_b128 v5, v[32:35] offset:32
    ds_write_b128 v5, v[96:99] offset:4192
    ds_write_b128 v5, v[48:51] offset:8352
    ds_write_b128 v5, v[100:103] offset:12512
    v_alignbit_b32 v104, v52, v36, 16
    v_alignbit_b32 v108, v53, v52, 16
    v_alignbit_b32 v105, v53, v37, 16
    v_alignbit_b32 v109, v54, v53, 16
    v_alignbit_b32 v106, v54, v38, 16
    v_alignbit_b32 v110, v55, v54, 16
    v_alignbit_b32 v107, v55, v39, 16
    v_alignbit_b32 v111, v65, v55, 16
    ds_write_b128 v5, v[36:39] offset:1056
    ds_write_b128 v5, v[104:107] offset:5216
    ds_write_b128 v5, v[52:55] offset:9376
    ds_write_b128 v5, v[108:111] offset:13536
    v_alignbit_b32 v112, v56, v40, 16
    v_alignbit_b32 v116, v57, v56, 16
    v_alignbit_b32 v113, v57, v41, 16
    v_alignbit_b32 v117, v58, v57, 16
    v_alignbit_b32 v114, v58, v42, 16
    v_alignbit_b32 v118, v59, v58, 16
    v_alignbit_b32 v115, v59, v43, 16
    v_alignbit_b32 v119, v66, v59, 16
    ds_write_b128 v5, v[40:43] offset:2080
    ds_write_b128 v5, v[112:115] offset:6240
    ds_write_b128 v5, v[56:59] offset:10400
    ds_write_b128 v5, v[116:119] offset:14560
    v_and_b32 v28, 31, v0
    v_lshlrev_b32 v28, 6, v28
    v_add_u32 v28, 145408, v28
    buffer_load_dword v25, v28, s[36:39], 0 offen sc1
    v_alignbit_b32 v120, v60, v44, 16
    v_alignbit_b32 v124, v61, v60, 16
    v_alignbit_b32 v121, v61, v45, 16
    v_alignbit_b32 v125, v62, v61, 16
    v_alignbit_b32 v122, v62, v46, 16
    v_alignbit_b32 v126, v63, v62, 16
    v_alignbit_b32 v123, v63, v47, 16
    v_alignbit_b32 v127, v67, v63, 16
    ds_write_b128 v5, v[44:47] offset:3104
    ds_write_b128 v5, v[120:123] offset:7264
    ds_write_b128 v5, v[60:63] offset:11424
    ds_write_b128 v5, v[124:127] offset:15584
    s_lshl_b32 s78, s84, 1
    s_and_b32 s78, s78, -4
    s_load_dword s77, s[14:15], s78
    s_waitcnt vmcnt(2)
    s_barrier
    s_mov_b32 exec_lo, 1
    s_mov_b32 exec_hi, 0
    buffer_store_dword v31, v30, s[36:39], 0 offen sc1
    s_mov_b64 exec, -1
    s_nop 0
    ds_read_b64_tr_b16 v[236:237], v200 offset:0
    ds_read_b64_tr_b16 v[238:239], v200 offset:2560
    ds_read_b64_tr_b16 v[240:241], v201 offset:0
    ds_read_b64_tr_b16 v[242:243], v201 offset:2560
    ds_read_b64_tr_b16 v[244:245], v202 offset:0
    ds_read_b64_tr_b16 v[246:247], v202 offset:2560
    v_lshlrev_b32 v26, 4, v0
    s_waitcnt lgkmcnt(0)
    buffer_store_dwordx4 v[236:239], v26, s[36:39], s74 offen sc1
    buffer_store_dwordx4 v[240:243], v26, s[36:39], s75 offen sc1
    buffer_store_dwordx4 v[244:247], v26, s[36:39], s76 offen sc1
    s_waitcnt vmcnt(4)
    v_cmp_ne_u32 vcc, s56, v25
    s_mov_b64 s[82:83], vcc
    s_cmp_eq_u64 s[82:83], 0
    s_cbranch_scc0 FAI_RETRY_17
FAI_DONE_18:
    v_lshlrev_b32 v1, 4, v0
    buffer_load_dwordx4 v[80:83], v1, s[36:39], s88 offen offset:0 sc1
    buffer_load_dwordx4 v[84:87], v1, s[36:39], s88 offen offset:1024 sc1
    buffer_load_dwordx4 v[88:91], v1, s[36:39], s88 offen offset:2048 sc1
    buffer_load_dwordx4 v[92:95], v1, s[36:39], s88 offen offset:3072 sc1
    s_lshr_b32 s78, s57, 1
    s_lshl_b32 s78, s78, 3
    s_and_b32 s79, s58, 7
    s_add_u32 s53, s78, s79
    s_mul_i32 s28, s79, 7
    s_and_b32 s78, s57, 1
    s_lshl_b32 s78, s78, 2
    s_lshr_b32 s79, s58, 3
    s_add_u32 s54, s78, s79
    s_mul_i32 s79, s79, 14
    s_add_u32 s28, s28, s79
    s_lshr_b32 s28, s28, 2
    s_cmp_ge_u32 s28, 14
    s_cselect_b32 s79, 14, 0
    s_sub_u32 s28, s28, s79
    s_mov_b32 s28, 0
    s_mul_i32 s55, s3, 14
    s_sub_u32 s79, s3, 1
    s_cmp_ge_u32 s3, 2
    s_cselect_b32 s79, s79, 0
    s_sub_u32 s55, s55, s79
    s_mul_i32 s79, s54, 54
    s_add_u32 s79, s79, s55
    s_mul_i32 s79, s79, 5120
    s_add_u32 s79, s79, 4194304
    s_add_u32 s16, s79, 71680
    s_mul_i32 s52, s28, 5120
    s_add_u32 s52, s52, s79
    v_lshlrev_b32 v14, 4, v0
    v_add_u32 v15, 4096, v14
    s_mov_b32 s40, s24
    s_mov_b32 s41, s25
    s_mov_b32 s42, 1280
    s_mov_b32 s43, 0x20000
    v_lshrrev_b32 v16, 4, v0
    s_mul_i32 s78, s54, 160
    v_lshlrev_b32 v17, 4, v16
    v_lshlrev_b32 v18, 3, v16
    buffer_load_dwordx4 a[240:243], v17, s[40:43], s78 offen
    buffer_load_dwordx4 a[244:247], v17, s[40:43], s78 offen offset:64
    buffer_load_dwordx2 a[248:249], v18, s[40:43], s78 offen offset:128
    s_mov_b32 s68, 7
    v_and_b32 v27, 31, v0
    v_lshlrev_b32 v27, 6, v27
    s_lshl_b32 s73, s68, 11
    s_add_u32 s73, s73, 131072
    s_lshl_b32 s78, s54, 11
    s_add_u32 s78, s78, 163840
    v_mov_b32 v16, s73
    v_mov_b32 v18, s78
    v_and_b32 v19, 32, v0
    v_cmp_eq_u32 vcc, 0, v19
    s_nop 1
    v_cndmask_b32 v16, v18, v16, vcc
    v_add_u32 v27, v16, v27
    s_waitcnt lgkmcnt(0)
    v_and_b32 v6, 15, v0
    v_lshrrev_b32 v7, 4, v0
    v_add_u32 v8, 1, v6
    v_and_b32 v9, 3, v8
    v_and_b32 v8, 28, v8
    v_mul_u32_u24 v9, 4160, v9
    v_lshl_add_u32 v9, v8, 1, v9
    v_lshl_add_u32 v9, v7, 4, v9
    v_add_u32 v2, s86, v9
    v_lshlrev_b32 v8, 1, v6
    v_sub_u32 v8, v8, v7
    v_lshlrev_b32 v8, 4, v8
    v_add_u32 v8, 16720, v8
    v_add_u32 v3, s86, v8
    v_sub_u32 v8, 15, v6
    v_lshrrev_b32_e64 v9, 3, v8
    v_cmp_eq_u32 s[80:81], v9, v7
    v_bfe_u32 v9, v8, 1, 2
    v_and_b32 v10, 1, v8
    v_lshlrev_b32 v10, 4, v10
    s_and_b32 s78, s84, 1
    s_lshl_b32 s78, s78, 4
    s_lshr_b32 s77, s77, s78
    s_and_b32 s77, s77, 0xffff
    v_mov_b32 v11, s77
    v_lshlrev_b32 v11, v10, v11
    v_cndmask_b32 v11, 0, v11, s[80:81]
    v_cmp_eq_u32 vcc, 0, v9
    s_nop 1
    v_cndmask_b32 v192, 0, v11, vcc
    v_cmp_eq_u32 vcc, 1, v9
    s_nop 1
    v_cndmask_b32 v193, 0, v11, vcc
    v_cmp_eq_u32 vcc, 2, v9
    s_nop 1
    v_cndmask_b32 v194, 0, v11, vcc
    v_cmp_eq_u32 vcc, 3, v9
    s_nop 1
    v_cndmask_b32 v195, 0, v11, vcc
    s_waitcnt vmcnt(7)
    s_barrier
    s_mov_b32 exec_lo, 4
    s_mov_b32 exec_hi, 0
    buffer_store_dword v31, v30, s[36:39], 0 offen sc1
    s_mov_b64 exec, -1
    s_waitcnt vmcnt(4)
    v_lshlrev_b32 v1, 4, v0
    v_add_u32_e64 v5, s86, v1
    ds_write_b128 v5, v[80:83] offset:17152
    ds_write_b128 v5, v[84:87] offset:18176
    ds_write_b128 v5, v[88:91] offset:19200
    ds_write_b128 v5, v[92:95] offset:20224
    s_add_u32 s18, s85, 7340032
    s_sub_u32 s84, s84, s3
    s_lshl_b32 s48, s84, 5
    s_add_u32 s48, s48, 262144
    s_cmp_eq_u32 s3, 0
    s_cselect_b32 s48, s48, 17563648
    s_mov_b32 s50, 3
    s_add_u32 s84, s84, 4
    s_lshr_b32 s78, s3, 1
    s_add_u32 s84, s84, s78
    s_and_b32 s87, s3, 1
    s_mul_i32 s86, s78, 21248
    s_lshl_b32 s85, s84, 12
    s_add_u32 s44, s12, s85
    s_addc_u32 s45, s13, 0
    s_mov_b32 s46, 4096
    s_mov_b32 s47, 0x20000
    s_lshl_b32 s89, s87, 11
    s_add_u32 s88, s85, s89
    s_add_u32 s88, s88, 1048576
    s_lshl_b32 s78, s84, 1
    s_and_b32 s78, s78, -4
    s_load_dword s77, s[14:15], s78
    s_waitcnt lgkmcnt(0)
    ds_read_b128 v[64:67], v3 offset:448
    ds_read_b64 v[32:33], v2 offset:0
    ds_read_b64 v[34:35], v2 offset:8
    ds_read_b128 v[68:71], v3 offset:960
    ds_read_b64 v[36:37], v2 offset:512
    ds_read_b64 v[38:39], v2 offset:520
    ds_read_b128 v[72:75], v3 offset:1472
    ds_read_b64 v[40:41], v2 offset:1024
    ds_read_b64 v[42:43], v2 offset:1032
    ds_read_b128 v[76:79], v3 offset:1984
    ds_read_b64 v[44:45], v2 offset:1536
    ds_read_b64 v[46:47], v2 offset:1544
    ds_read_b128 v[80:83], v3 offset:2496
    ds_read_b64 v[48:49], v2 offset:2048
    ds_read_b64 v[50:51], v2 offset:2056
    ds_read_b128 v[84:87], v3 offset:3008
    ds_read_b64 v[52:53], v2 offset:2560
    ds_read_b64 v[54:55], v2 offset:2568
    ds_read_b128 v[88:91], v3 offset:3520
    ds_read_b64 v[56:57], v2 offset:3072
    ds_read_b64 v[58:59], v2 offset:3080
    ds_read_b128 v[92:95], v3 offset:4032
    ds_read_b64 v[60:61], v2 offset:3584
    ds_read_b64 v[62:63], v2 offset:3592
    s_waitcnt lgkmcnt(15)
    v_mfma_f32_16x16x32_bf16 v[160:163], v[192:195], v[64:67], 0
    ds_read_b128 v[128:131], v3 offset:384
    v_mfma_f32_16x16x32_bf16 v[164:167], v[192:195], v[68:71], 0
    ds_read_b64 v[96:97], v2 offset:64
    v_mfma_f32_16x16x32_bf16 v[168:171], v[192:195], v[72:75], 0
    ds_read_b64 v[98:99], v2 offset:72
    s_waitcnt lgkmcnt(15)
    v_mfma_f32_16x16x32_bf16 v[172:175], v[192:195], v[76:79], 0
    ds_read_b128 v[132:135], v3 offset:896
    s_waitcnt lgkmcnt(15)
    v_mfma_f32_16x16x32_bf16 v[176:179], v[192:195], v[80:83], 0
    ds_read_b64 v[100:101], v2 offset:576
    buffer_load_dwordx4 v[200:203], v14, s[44:47], s89 offen offset:0 nt
    s_waitcnt lgkmcnt(13)
    v_mfma_f32_16x16x32_bf16 v[180:183], v[192:195], v[84:87], 0
    ds_read_b64 v[102:103], v2 offset:584
    s_waitcnt lgkmcnt(11)
    v_mfma_f32_16x16x32_bf16 v[184:187], v[192:195], v[88:91], 0
    ds_read_b128 v[136:139], v3 offset:1408
    s_waitcnt lgkmcnt(9)
    v_mfma_f32_16x16x32_bf16 v[188:191], v[192:195], v[92:95], 0
    ds_read_b64 v[104:105], v2 offset:1088
    s_waitcnt lgkmcnt(8)
    s_nop 0
    v_mfma_f32_16x16x32_bf16 v[160:163], v[32:35], v[64:67], v[160:163]
    ds_read_b64 v[106:107], v2 offset:1096
    v_mfma_f32_16x16x32_bf16 v[164:167], v[32:35], v[68:71], v[164:167]
    ds_read_b128 v[140:143], v3 offset:1920
    v_mfma_f32_16x16x32_bf16 v[168:171], v[32:35], v[72:75], v[168:171]
    ds_read_b64 v[108:109], v2 offset:1600
    v_mfma_f32_16x16x32_bf16 v[172:175], v[32:35], v[76:79], v[172:175]
    ds_read_b64 v[110:111], v2 offset:1608
    v_mfma_f32_16x16x32_bf16 v[176:179], v[32:35], v[80:83], v[176:179]
    ds_read_b128 v[144:147], v3 offset:2432
    v_mfma_f32_16x16x32_bf16 v[180:183], v[32:35], v[84:87], v[180:183]
    ds_read_b64 v[112:113], v2 offset:2112
    buffer_load_dwordx4 v[204:207], v14, s[44:47], s89 offen offset:1024 nt
    v_mfma_f32_16x16x32_bf16 v[184:187], v[32:35], v[88:91], v[184:187]
    ds_read_b64 v[114:115], v2 offset:2120
    v_mfma_f32_16x16x32_bf16 v[188:191], v[32:35], v[92:95], v[188:191]
    ds_read_b128 v[148:151], v3 offset:2944
    v_mfma_f32_16x16x32_bf16 v[164:167], v[36:39], v[64:67], v[164:167]
    ds_read_b64 v[116:117], v2 offset:2624
    v_mfma_f32_16x16x32_bf16 v[168:171], v[36:39], v[68:71], v[168:171]
    ds_read_b64 v[118:119], v2 offset:2632
    v_mfma_f32_16x16x32_bf16 v[172:175], v[36:39], v[72:75], v[172:175]
    ds_read_b128 v[152:155], v3 offset:3456
    v_mfma_f32_16x16x32_bf16 v[176:179], v[36:39], v[76:79], v[176:179]
    ds_read_b64 v[120:121], v2 offset:3136
    v_mfma_f32_16x16x32_bf16 v[180:183], v[36:39], v[80:83], v[180:183]
    ds_read_b64 v[122:123], v2 offset:3144
    v_mfma_f32_16x16x32_bf16 v[184:187], v[36:39], v[84:87], v[184:187]
    ds_read_b128 v[156:159], v3 offset:3968
    v_mfma_f32_16x16x32_bf16 v[188:191], v[36:39], v[88:91], v[188:191]
    ds_read_b64 v[124:125], v2 offset:3648
    buffer_load_dwordx2 v[220:221], v14, s[44:47], s89 offen offset:2048 nt
    v_mfma_f32_16x16x32_bf16 v[168:171], v[40:43], v[64:67], v[168:171]
    ds_read_b64 v[126:127], v2 offset:3656
    v_mfma_f32_16x16x32_bf16 v[172:175], v[40:43], v[68:71], v[172:175]
    v_mfma_f32_16x16x32_bf16 v[176:179], v[40:43], v[72:75], v[176:179]
    v_mfma_f32_16x16x32_bf16 v[180:183], v[40:43], v[76:79], v[180:183]
    v_mfma_f32_16x16x32_bf16 v[184:187], v[40:43], v[80:83], v[184:187]
    v_mfma_f32_16x16x32_bf16 v[188:191], v[40:43], v[84:87], v[188:191]
    v_mfma_f32_16x16x32_bf16 v[172:175], v[44:47], v[64:67], v[172:175]
    v_mfma_f32_16x16x32_bf16 v[176:179], v[44:47], v[68:71], v[176:179]
    buffer_load_dwordx4 v[224:227], v14, s[36:39], s88 offen offset:0 sc1
    v_mfma_f32_16x16x32_bf16 v[180:183], v[44:47], v[72:75], v[180:183]
    v_mfma_f32_16x16x32_bf16 v[184:187], v[44:47], v[76:79], v[184:187]
    v_mfma_f32_16x16x32_bf16 v[188:191], v[44:47], v[80:83], v[188:191]
    v_mfma_f32_16x16x32_bf16 v[176:179], v[48:51], v[64:67], v[176:179]
    v_mfma_f32_16x16x32_bf16 v[180:183], v[48:51], v[68:71], v[180:183]
    v_mfma_f32_16x16x32_bf16 v[184:187], v[48:51], v[72:75], v[184:187]
    v_mfma_f32_16x16x32_bf16 v[188:191], v[48:51], v[76:79], v[188:191]
    v_mfma_f32_16x16x32_bf16 v[180:183], v[52:55], v[64:67], v[180:183]
    v_mfma_f32_16x16x32_bf16 v[184:187], v[52:55], v[68:71], v[184:187]
    buffer_load_dwordx4 v[228:231], v14, s[36:39], s88 offen offset:1024 sc1
    v_mfma_f32_16x16x32_bf16 v[188:191], v[52:55], v[72:75], v[188:191]
    v_mfma_f32_16x16x32_bf16 v[184:187], v[56:59], v[64:67], v[184:187]
    v_mfma_f32_16x16x32_bf16 v[188:191], v[56:59], v[68:71], v[188:191]
    v_mfma_f32_16x16x32_bf16 v[188:191], v[60:63], v[64:67], v[188:191]
    s_waitcnt lgkmcnt(0)
    s_nop 0
    v_mfma_f32_16x16x32_bf16 v[160:163], v[96:99], v[128:131], v[160:163]
    ds_read_b128 v[64:67], v3 offset:320
    v_mfma_f32_16x16x32_bf16 v[164:167], v[96:99], v[132:135], v[164:167]
    ds_read_b64 v[32:33], v2 offset:128
    v_mfma_f32_16x16x32_bf16 v[168:171], v[96:99], v[136:139], v[168:171]
    ds_read_b64 v[34:35], v2 offset:136
    v_mfma_f32_16x16x32_bf16 v[172:175], v[96:99], v[140:143], v[172:175]
    ds_read_b128 v[68:71], v3 offset:832
    v_mfma_f32_16x16x32_bf16 v[176:179], v[96:99], v[144:147], v[176:179]
    ds_read_b64 v[36:37], v2 offset:640
    v_mfma_f32_16x16x32_bf16 v[180:183], v[96:99], v[148:151], v[180:183]
    ds_read_b64 v[38:39], v2 offset:648
    v_mfma_f32_16x16x32_bf16 v[184:187], v[96:99], v[152:155], v[184:187]
    ds_read_b128 v[72:75], v3 offset:1344
    v_mfma_f32_16x16x32_bf16 v[188:191], v[96:99], v[156:159], v[188:191]
    ds_read_b64 v[40:41], v2 offset:1152
    v_mfma_f32_16x16x32_bf16 v[164:167], v[100:103], v[128:131], v[164:167]
    ds_read_b64 v[42:43], v2 offset:1160
    v_mfma_f32_16x16x32_bf16 v[168:171], v[100:103], v[132:135], v[168:171]
    ds_read_b128 v[76:79], v3 offset:1856
    v_mfma_f32_16x16x32_bf16 v[172:175], v[100:103], v[136:139], v[172:175]
    ds_read_b64 v[44:45], v2 offset:1664
    v_mfma_f32_16x16x32_bf16 v[176:179], v[100:103], v[140:143], v[176:179]
    ds_read_b64 v[46:47], v2 offset:1672
    v_mfma_f32_16x16x32_bf16 v[180:183], v[100:103], v[144:147], v[180:183]
    ds_read_b128 v[80:83], v3 offset:2368
    v_mfma_f32_16x16x32_bf16 v[184:187], v[100:103], v[148:151], v[184:187]
    ds_read_b64 v[48:49], v2 offset:2176
    v_mfma_f32_16x16x32_bf16 v[188:191], v[100:103], v[152:155], v[188:191]
    ds_read_b64 v[50:51], v2 offset:2184
    v_mfma_f32_16x16x32_bf16 v[168:171], v[104:107], v[128:131], v[168:171]
    ds_read_b128 v[84:87], v3 offset:2880
    v_mfma_f32_16x16x32_bf16 v[172:175], v[104:107], v[132:135], v[172:175]
    ds_read_b64 v[52:53], v2 offset:2688
    v_mfma_f32_16x16x32_bf16 v[176:179], v[104:107], v[136:139], v[176:179]
    ds_read_b64 v[54:55], v2 offset:2696
    v_mfma_f32_16x16x32_bf16 v[180:183], v[104:107], v[140:143], v[180:183]
    ds_read_b128 v[88:91], v3 offset:3392
    v_mfma_f32_16x16x32_bf16 v[184:187], v[104:107], v[144:147], v[184:187]
    ds_read_b64 v[56:57], v2 offset:3200
    v_mfma_f32_16x16x32_bf16 v[188:191], v[104:107], v[148:151], v[188:191]
    ds_read_b64 v[58:59], v2 offset:3208
    v_mfma_f32_16x16x32_bf16 v[172:175], v[108:111], v[128:131], v[172:175]
    ds_read_b128 v[92:95], v3 offset:3904
    v_mfma_f32_16x16x32_bf16 v[176:179], v[108:111], v[132:135], v[176:179]
    ds_read_b64 v[60:61], v2 offset:3712
    v_mfma_f32_16x16x32_bf16 v[180:183], v[108:111], v[136:139], v[180:183]
    ds_read_b64 v[62:63], v2 offset:3720
    v_mfma_f32_16x16x32_bf16 v[184:187], v[108:111], v[140:143], v[184:187]
    v_mfma_f32_16x16x32_bf16 v[188:191], v[108:111], v[144:147], v[188:191]
    v_mfma_f32_16x16x32_bf16 v[176:179], v[112:115], v[128:131], v[176:179]
    v_mfma_f32_16x16x32_bf16 v[180:183], v[112:115], v[132:135], v[180:183]
    v_mfma_f32_16x16x32_bf16 v[184:187], v[112:115], v[136:139], v[184:187]
    v_mfma_f32_16x16x32_bf16 v[188:191], v[112:115], v[140:143], v[188:191]
    v_mfma_f32_16x16x32_bf16 v[180:183], v[116:119], v[128:131], v[180:183]
    v_mfma_f32_16x16x32_bf16 v[184:187], v[116:119], v[132:135], v[184:187]
    v_mfma_f32_16x16x32_bf16 v[188:191], v[116:119], v[136:139], v[188:191]
    v_mfma_f32_16x16x32_bf16 v[184:187], v[120:123], v[128:131], v[184:187]
    v_mfma_f32_16x16x32_bf16 v[188:191], v[120:123], v[132:135], v[188:191]
    v_mfma_f32_16x16x32_bf16 v[188:191], v[124:127], v[128:131], v[188:191]
    s_waitcnt lgkmcnt(0)
    s_nop 0
    v_mfma_f32_16x16x32_bf16 v[160:163], v[32:35], v[64:67], v[160:163]
    ds_read_b128 v[128:131], v3 offset:256
    v_mfma_f32_16x16x32_bf16 v[164:167], v[32:35], v[68:71], v[164:167]
    ds_read_b64 v[96:97], v2 offset:192
    v_mfma_f32_16x16x32_bf16 v[168:171], v[32:35], v[72:75], v[168:171]
    ds_read_b64 v[98:99], v2 offset:200
    v_mfma_f32_16x16x32_bf16 v[172:175], v[32:35], v[76:79], v[172:175]
    ds_read_b128 v[132:135], v3 offset:768
    v_mfma_f32_16x16x32_bf16 v[176:179], v[32:35], v[80:83], v[176:179]
    ds_read_b64 v[100:101], v2 offset:704
    v_mfma_f32_16x16x32_bf16 v[180:183], v[32:35], v[84:87], v[180:183]
    ds_read_b64 v[102:103], v2 offset:712
    v_mfma_f32_16x16x32_bf16 v[184:187], v[32:35], v[88:91], v[184:187]
    ds_read_b128 v[136:139], v3 offset:1280
    v_mfma_f32_16x16x32_bf16 v[188:191], v[32:35], v[92:95], v[188:191]
    ds_read_b64 v[104:105], v2 offset:1216
    v_mfma_f32_16x16x32_bf16 v[164:167], v[36:39], v[64:67], v[164:167]
    ds_read_b64 v[106:107], v2 offset:1224
    v_mfma_f32_16x16x32_bf16 v[168:171], v[36:39], v[68:71], v[168:171]
    ds_read_b128 v[140:143], v3 offset:1792
    v_mfma_f32_16x16x32_bf16 v[172:175], v[36:39], v[72:75], v[172:175]
    ds_read_b64 v[108:109], v2 offset:1728
    v_mfma_f32_16x16x32_bf16 v[176:179], v[36:39], v[76:79], v[176:179]
    ds_read_b64 v[110:111], v2 offset:1736
    v_mfma_f32_16x16x32_bf16 v[180:183], v[36:39], v[80:83], v[180:183]
    ds_read_b128 v[144:147], v3 offset:2304
    v_mfma_f32_16x16x32_bf16 v[184:187], v[36:39], v[84:87], v[184:187]
    ds_read_b64 v[112:113], v2 offset:2240
    v_mfma_f32_16x16x32_bf16 v[188:191], v[36:39], v[88:91], v[188:191]
    ds_read_b64 v[114:115], v2 offset:2248
    v_mfma_f32_16x16x32_bf16 v[168:171], v[40:43], v[64:67], v[168:171]
    ds_read_b128 v[148:151], v3 offset:2816
    v_mfma_f32_16x16x32_bf16 v[172:175], v[40:43], v[68:71], v[172:175]
    ds_read_b64 v[116:117], v2 offset:2752
    v_mfma_f32_16x16x32_bf16 v[176:179], v[40:43], v[72:75], v[176:179]
    ds_read_b64 v[118:119], v2 offset:2760
    v_mfma_f32_16x16x32_bf16 v[180:183], v[40:43], v[76:79], v[180:183]
    ds_read_b128 v[152:155], v3 offset:3328
    v_mfma_f32_16x16x32_bf16 v[184:187], v[40:43], v[80:83], v[184:187]
    ds_read_b64 v[120:121], v2 offset:3264
    v_mfma_f32_16x16x32_bf16 v[188:191], v[40:43], v[84:87], v[188:191]
    ds_read_b64 v[122:123], v2 offset:3272
    v_mfma_f32_16x16x32_bf16 v[172:175], v[44:47], v[64:67], v[172:175]
    ds_read_b128 v[156:159], v3 offset:3840
    v_mfma_f32_16x16x32_bf16 v[176:179], v[44:47], v[68:71], v[176:179]
    ds_read_b64 v[124:125], v2 offset:3776
    v_mfma_f32_16x16x32_bf16 v[180:183], v[44:47], v[72:75], v[180:183]
    ds_read_b64 v[126:127], v2 offset:3784
    v_mfma_f32_16x16x32_bf16 v[184:187], v[44:47], v[76:79], v[184:187]
    v_mfma_f32_16x16x32_bf16 v[188:191], v[44:47], v[80:83], v[188:191]
    v_mfma_f32_16x16x32_bf16 v[176:179], v[48:51], v[64:67], v[176:179]
    v_mfma_f32_16x16x32_bf16 v[180:183], v[48:51], v[68:71], v[180:183]
    v_mfma_f32_16x16x32_bf16 v[184:187], v[48:51], v[72:75], v[184:187]
    v_mfma_f32_16x16x32_bf16 v[188:191], v[48:51], v[76:79], v[188:191]
    v_mfma_f32_16x16x32_bf16 v[180:183], v[52:55], v[64:67], v[180:183]
    v_mfma_f32_16x16x32_bf16 v[184:187], v[52:55], v[68:71], v[184:187]
    v_mfma_f32_16x16x32_bf16 v[188:191], v[52:55], v[72:75], v[188:191]
    v_mfma_f32_16x16x32_bf16 v[184:187], v[56:59], v[64:67], v[184:187]
    v_mfma_f32_16x16x32_bf16 v[188:191], v[56:59], v[68:71], v[188:191]
    v_mfma_f32_16x16x32_bf16 v[188:191], v[60:63], v[64:67], v[188:191]
    s_waitcnt lgkmcnt(0)
    s_nop 0
    v_mfma_f32_16x16x32_bf16 v[160:163], v[96:99], v[128:131], v[160:163]
    ds_read_b128 v[64:67], v3 offset:192
    v_mfma_f32_16x16x32_bf16 v[164:167], v[96:99], v[132:135], v[164:167]
    ds_read_b64 v[32:33], v2 offset:256
    v_mfma_f32_16x16x32_bf16 v[168:171], v[96:99], v[136:139], v[168:171]
    ds_read_b64 v[34:35], v2 offset:264
    v_mfma_f32_16x16x32_bf16 v[172:175], v[96:99], v[140:143], v[172:175]
    ds_read_b128 v[68:71], v3 offset:704
    v_mfma_f32_16x16x32_bf16 v[176:179], v[96:99], v[144:147], v[176:179]
    ds_read_b64 v[36:37], v2 offset:768
    v_mfma_f32_16x16x32_bf16 v[180:183], v[96:99], v[148:151], v[180:183]
    ds_read_b64 v[38:39], v2 offset:776
    v_mfma_f32_16x16x32_bf16 v[184:187], v[96:99], v[152:155], v[184:187]
    ds_read_b128 v[72:75], v3 offset:1216
    v_mfma_f32_16x16x32_bf16 v[188:191], v[96:99], v[156:159], v[188:191]
    ds_read_b64 v[40:41], v2 offset:1280
    v_mfma_f32_16x16x32_bf16 v[164:167], v[100:103], v[128:131], v[164:167]
    ds_read_b64 v[42:43], v2 offset:1288
    v_mfma_f32_16x16x32_bf16 v[168:171], v[100:103], v[132:135], v[168:171]
    ds_read_b128 v[76:79], v3 offset:1728
    v_mfma_f32_16x16x32_bf16 v[172:175], v[100:103], v[136:139], v[172:175]
    ds_read_b64 v[44:45], v2 offset:1792
    v_mfma_f32_16x16x32_bf16 v[176:179], v[100:103], v[140:143], v[176:179]
    ds_read_b64 v[46:47], v2 offset:1800
    v_mfma_f32_16x16x32_bf16 v[180:183], v[100:103], v[144:147], v[180:183]
    ds_read_b128 v[80:83], v3 offset:2240
    v_mfma_f32_16x16x32_bf16 v[184:187], v[100:103], v[148:151], v[184:187]
    ds_read_b64 v[48:49], v2 offset:2304
    v_mfma_f32_16x16x32_bf16 v[188:191], v[100:103], v[152:155], v[188:191]
    ds_read_b64 v[50:51], v2 offset:2312
    v_mfma_f32_16x16x32_bf16 v[168:171], v[104:107], v[128:131], v[168:171]
    ds_read_b128 v[84:87], v3 offset:2752
    v_mfma_f32_16x16x32_bf16 v[172:175], v[104:107], v[132:135], v[172:175]
    ds_read_b64 v[52:53], v2 offset:2816
    v_mfma_f32_16x16x32_bf16 v[176:179], v[104:107], v[136:139], v[176:179]
    ds_read_b64 v[54:55], v2 offset:2824
    v_mfma_f32_16x16x32_bf16 v[180:183], v[104:107], v[140:143], v[180:183]
    ds_read_b128 v[88:91], v3 offset:3264
    v_mfma_f32_16x16x32_bf16 v[184:187], v[104:107], v[144:147], v[184:187]
    ds_read_b64 v[56:57], v2 offset:3328
    v_mfma_f32_16x16x32_bf16 v[188:191], v[104:107], v[148:151], v[188:191]
    ds_read_b64 v[58:59], v2 offset:3336
    v_mfma_f32_16x16x32_bf16 v[172:175], v[108:111], v[128:131], v[172:175]
    ds_read_b128 v[92:95], v3 offset:3776
    v_mfma_f32_16x16x32_bf16 v[176:179], v[108:111], v[132:135], v[176:179]
    ds_read_b64 v[60:61], v2 offset:3840
    v_mfma_f32_16x16x32_bf16 v[180:183], v[108:111], v[136:139], v[180:183]
    ds_read_b64 v[62:63], v2 offset:3848
    v_mfma_f32_16x16x32_bf16 v[184:187], v[108:111], v[140:143], v[184:187]
    v_mfma_f32_16x16x32_bf16 v[188:191], v[108:111], v[144:147], v[188:191]
    v_mfma_f32_16x16x32_bf16 v[176:179], v[112:115], v[128:131], v[176:179]
    v_mfma_f32_16x16x32_bf16 v[180:183], v[112:115], v[132:135], v[180:183]
    v_mfma_f32_16x16x32_bf16 v[184:187], v[112:115], v[136:139], v[184:187]
    v_mfma_f32_16x16x32_bf16 v[188:191], v[112:115], v[140:143], v[188:191]
PAGE8:
    s_cbranch_execz VISIT_RET
    v_mfma_f32_16x16x32_bf16 v[180:183], v[116:119], v[128:131], v[180:183]
    v_mfma_f32_16x16x32_bf16 v[184:187], v[116:119], v[132:135], v[184:187]
    v_mfma_f32_16x16x32_bf16 v[188:191], v[116:119], v[136:139], v[188:191]
    v_mfma_f32_16x16x32_bf16 v[184:187], v[120:123], v[128:131], v[184:187]
    v_mfma_f32_16x16x32_bf16 v[188:191], v[120:123], v[132:135], v[188:191]
    v_mfma_f32_16x16x32_bf16 v[188:191], v[124:127], v[128:131], v[188:191]
    s_waitcnt lgkmcnt(0)
    v_mfma_f32_16x16x32_bf16 v[160:163], v[32:35], v[64:67], v[160:163]
    ds_read_b128 v[128:131], v3 offset:128
    v_mfma_f32_16x16x32_bf16 v[164:167], v[32:35], v[68:71], v[164:167]
    ds_read_b64 v[96:97], v2 offset:320
    v_mfma_f32_16x16x32_bf16 v[168:171], v[32:35], v[72:75], v[168:171]
    ds_read_b64 v[98:99], v2 offset:328
    v_mfma_f32_16x16x32_bf16 v[172:175], v[32:35], v[76:79], v[172:175]
    ds_read_b128 v[132:135], v3 offset:640
    v_mfma_f32_16x16x32_bf16 v[176:179], v[32:35], v[80:83], v[176:179]
    ds_read_b64 v[100:101], v2 offset:832
    v_mfma_f32_16x16x32_bf16 v[180:183], v[32:35], v[84:87], v[180:183]
    ds_read_b64 v[102:103], v2 offset:840
    v_mfma_f32_16x16x32_bf16 v[184:187], v[32:35], v[88:91], v[184:187]
    ds_read_b128 v[136:139], v3 offset:1152
    v_mfma_f32_16x16x32_bf16 v[188:191], v[32:35], v[92:95], v[188:191]
    ds_read_b64 v[104:105], v2 offset:1344
    v_mfma_f32_16x16x32_bf16 v[164:167], v[36:39], v[64:67], v[164:167]
    ds_read_b64 v[106:107], v2 offset:1352
    v_mfma_f32_16x16x32_bf16 v[168:171], v[36:39], v[68:71], v[168:171]
    ds_read_b128 v[140:143], v3 offset:1664
    v_mfma_f32_16x16x32_bf16 v[172:175], v[36:39], v[72:75], v[172:175]
    ds_read_b64 v[108:109], v2 offset:1856
    v_mfma_f32_16x16x32_bf16 v[176:179], v[36:39], v[76:79], v[176:179]
    ds_read_b64 v[110:111], v2 offset:1864
    v_mfma_f32_16x16x32_bf16 v[180:183], v[36:39], v[80:83], v[180:183]
    ds_read_b128 v[144:147], v3 offset:2176
    v_mfma_f32_16x16x32_bf16 v[184:187], v[36:39], v[84:87], v[184:187]
    ds_read_b64 v[112:113], v2 offset:2368
    v_mfma_f32_16x16x32_bf16 v[188:191], v[36:39], v[88:91], v[188:191]
    ds_read_b64 v[114:115], v2 offset:2376
    v_mfma_f32_16x16x32_bf16 v[168:171], v[40:43], v[64:67], v[168:171]
    ds_read_b128 v[148:151], v3 offset:2688
    v_mfma_f32_16x16x32_bf16 v[172:175], v[40:43], v[68:71], v[172:175]
    ds_read_b64 v[116:117], v2 offset:2880
    v_mfma_f32_16x16x32_bf16 v[176:179], v[40:43], v[72:75], v[176:179]
    ds_read_b64 v[118:119], v2 offset:2888
    v_mfma_f32_16x16x32_bf16 v[180:183], v[40:43], v[76:79], v[180:183]
    ds_read_b128 v[152:155], v3 offset:3200
    buffer_load_dword v24, v27, s[36:39], 0 offen sc1
    v_mfma_f32_16x16x32_bf16 v[184:187], v[40:43], v[80:83], v[184:187]
    ds_read_b64 v[120:121], v2 offset:3392
    v_mfma_f32_16x16x32_bf16 v[188:191], v[40:43], v[84:87], v[188:191]
    ds_read_b64 v[122:123], v2 offset:3400
    v_mfma_f32_16x16x32_bf16 v[172:175], v[44:47], v[64:67], v[172:175]
    ds_read_b128 v[156:159], v3 offset:3712
    v_mfma_f32_16x16x32_bf16 v[176:179], v[44:47], v[68:71], v[176:179]
    ds_read_b64 v[124:125], v2 offset:3904
    v_mfma_f32_16x16x32_bf16 v[180:183], v[44:47], v[72:75], v[180:183]
    ds_read_b64 v[126:127], v2 offset:3912
    v_mfma_f32_16x16x32_bf16 v[184:187], v[44:47], v[76:79], v[184:187]
    v_mfma_f32_16x16x32_bf16 v[188:191], v[44:47], v[80:83], v[188:191]
    v_mfma_f32_16x16x32_bf16 v[176:179], v[48:51], v[64:67], v[176:179]
    v_mfma_f32_16x16x32_bf16 v[180:183], v[48:51], v[68:71], v[180:183]
    v_mfma_f32_16x16x32_bf16 v[184:187], v[48:51], v[72:75], v[184:187]
    v_mfma_f32_16x16x32_bf16 v[188:191], v[48:51], v[76:79], v[188:191]
    v_mfma_f32_16x16x32_bf16 v[180:183], v[52:55], v[64:67], v[180:183]
    v_mfma_f32_16x16x32_bf16 v[184:187], v[52:55], v[68:71], v[184:187]
    v_mfma_f32_16x16x32_bf16 v[188:191], v[52:55], v[72:75], v[188:191]
    v_mfma_f32_16x16x32_bf16 v[184:187], v[56:59], v[64:67], v[184:187]
    v_mfma_f32_16x16x32_bf16 v[188:191], v[56:59], v[68:71], v[188:191]
    v_mfma_f32_16x16x32_bf16 v[188:191], v[60:63], v[64:67], v[188:191]
    s_waitcnt lgkmcnt(0)
    v_mfma_f32_16x16x32_bf16 v[160:163], v[96:99], v[128:131], v[160:163]
    ds_read_b128 v[64:67], v3 offset:64
    v_mfma_f32_16x16x32_bf16 v[164:167], v[96:99], v[132:135], v[164:167]
    ds_read_b64 v[32:33], v2 offset:384
    s_lshl_b32 s79, s53, 6
    s_lshl_b32 s80, s3, 4
    s_add_u32 s79, s79, s80
    v_lshrrev_b32 v236, 2, v0
    v_add_u32 v236, s79, v236
    v_mfma_f32_16x16x32_bf16 v[168:171], v[96:99], v[136:139], v[168:171]
    ds_read_b64 v[34:35], v2 offset:392
    v_mul_u32_u24 v236, 1280, v236
    s_mul_i32 s80, s54, 160
    v_add_u32 v236, s80, v236
    v_mfma_f32_16x16x32_bf16 v[172:175], v[96:99], v[140:143], v[172:175]
    ds_read_b128 v[68:71], v3 offset:576
    v_and_b32 v237, 3, v0
    v_mfma_f32_16x16x32_bf16 v[176:179], v[96:99], v[144:147], v[176:179]
    ds_read_b64 v[36:37], v2 offset:896
    v_lshl_add_u32 v238, v237, 4, v236
    v_mfma_f32_16x16x32_bf16 v[180:183], v[96:99], v[148:151], v[180:183]
    ds_read_b64 v[38:39], v2 offset:904
    v_lshl_add_u32 v239, v237, 3, v236
    v_mfma_f32_16x16x32_bf16 v[184:187], v[96:99], v[152:155], v[184:187]
    ds_read_b128 v[72:75], v3 offset:1088
    buffer_load_dwordx4 v[244:247], v238, s[32:35], 0 offen
    v_mfma_f32_16x16x32_bf16 v[188:191], v[96:99], v[156:159], v[188:191]
    ds_read_b64 v[40:41], v2 offset:1408
    v_mfma_f32_16x16x32_bf16 v[164:167], v[100:103], v[128:131], v[164:167]
    ds_read_b64 v[42:43], v2 offset:1416
    v_mfma_f32_16x16x32_bf16 v[168:171], v[100:103], v[132:135], v[168:171]
    ds_read_b128 v[76:79], v3 offset:1600
    v_mfma_f32_16x16x32_bf16 v[172:175], v[100:103], v[136:139], v[172:175]
    ds_read_b64 v[44:45], v2 offset:1920
    v_mfma_f32_16x16x32_bf16 v[176:179], v[100:103], v[140:143], v[176:179]
    ds_read_b64 v[46:47], v2 offset:1928
    v_mfma_f32_16x16x32_bf16 v[180:183], v[100:103], v[144:147], v[180:183]
    ds_read_b128 v[80:83], v3 offset:2112
    v_mfma_f32_16x16x32_bf16 v[184:187], v[100:103], v[148:151], v[184:187]
    ds_read_b64 v[48:49], v2 offset:2432
    v_mfma_f32_16x16x32_bf16 v[188:191], v[100:103], v[152:155], v[188:191]
    ds_read_b64 v[50:51], v2 offset:2440
    v_mfma_f32_16x16x32_bf16 v[168:171], v[104:107], v[128:131], v[168:171]
    ds_read_b128 v[84:87], v3 offset:2624
    v_mfma_f32_16x16x32_bf16 v[172:175], v[104:107], v[132:135], v[172:175]
    ds_read_b64 v[52:53], v2 offset:2944
    v_mfma_f32_16x16x32_bf16 v[176:179], v[104:107], v[136:139], v[176:179]
    ds_read_b64 v[54:55], v2 offset:2952
    v_mfma_f32_16x16x32_bf16 v[180:183], v[104:107], v[140:143], v[180:183]
    ds_read_b128 v[88:91], v3 offset:3136
    buffer_load_dwordx4 v[248:251], v238, s[32:35], 0 offen offset:64
    v_mfma_f32_16x16x32_bf16 v[184:187], v[104:107], v[144:147], v[184:187]
    ds_read_b64 v[56:57], v2 offset:3456
    v_mfma_f32_16x16x32_bf16 v[188:191], v[104:107], v[148:151], v[188:191]
    ds_read_b64 v[58:59], v2 offset:3464
    v_mfma_f32_16x16x32_bf16 v[172:175], v[108:111], v[128:131], v[172:175]
    ds_read_b128 v[92:95], v3 offset:3648
    v_mfma_f32_16x16x32_bf16 v[176:179], v[108:111], v[132:135], v[176:179]
    ds_read_b64 v[60:61], v2 offset:3968
    v_mfma_f32_16x16x32_bf16 v[180:183], v[108:111], v[136:139], v[180:183]
    ds_read_b64 v[62:63], v2 offset:3976
    v_mfma_f32_16x16x32_bf16 v[184:187], v[108:111], v[140:143], v[184:187]
    v_mfma_f32_16x16x32_bf16 v[188:191], v[108:111], v[144:147], v[188:191]
    v_mfma_f32_16x16x32_bf16 v[176:179], v[112:115], v[128:131], v[176:179]
    v_mfma_f32_16x16x32_bf16 v[180:183], v[112:115], v[132:135], v[180:183]
    v_mfma_f32_16x16x32_bf16 v[184:187], v[112:115], v[136:139], v[184:187]
    v_mfma_f32_16x16x32_bf16 v[188:191], v[112:115], v[140:143], v[188:191]
    v_mfma_f32_16x16x32_bf16 v[180:183], v[116:119], v[128:131], v[180:183]
    buffer_load_dwordx2 v[252:253], v239, s[32:35], 0 offen offset:128
    v_mfma_f32_16x16x32_bf16 v[184:187], v[116:119], v[132:135], v[184:187]
    v_mfma_f32_16x16x32_bf16 v[188:191], v[116:119], v[136:139], v[188:191]
    v_mfma_f32_16x16x32_bf16 v[184:187], v[120:123], v[128:131], v[184:187]
    v_mfma_f32_16x16x32_bf16 v[188:191], v[120:123], v[132:135], v[188:191]
    v_mfma_f32_16x16x32_bf16 v[188:191], v[124:127], v[128:131], v[188:191]
    s_waitcnt lgkmcnt(0)
    s_waitcnt vmcnt(3)
    v_cmp_ne_u32 vcc, s56, v24
    s_mov_b64 s[82:83], vcc
    s_cmp_eq_u64 s[82:83], 0
    s_cbranch_scc0 P2I_RETRY_20
P2I_DONE_21:
    v_mfma_f32_16x16x32_bf16 v[160:163], v[32:35], v[64:67], v[160:163]
    ds_read_b128 v[128:131], v3 offset:0
    v_mfma_f32_16x16x32_bf16 v[164:167], v[32:35], v[68:71], v[164:167]
    ds_read_b64 v[96:97], v2 offset:448
    v_mfma_f32_16x16x32_bf16 v[168:171], v[32:35], v[72:75], v[168:171]
    ds_read_b64 v[98:99], v2 offset:456
    buffer_load_dwordx4 a[0:3], v14, s[36:39], s52 offen offset:0 sc1
    v_mfma_f32_16x16x32_bf16 v[172:175], v[32:35], v[76:79], v[172:175]
    ds_read_b128 v[132:135], v3 offset:512
    v_mfma_f32_16x16x32_bf16 v[176:179], v[32:35], v[80:83], v[176:179]
    ds_read_b64 v[100:101], v2 offset:960
    v_mfma_f32_16x16x32_bf16 v[180:183], v[32:35], v[84:87], v[180:183]
    ds_read_b64 v[102:103], v2 offset:968
    v_mfma_f32_16x16x32_bf16 v[184:187], v[32:35], v[88:91], v[184:187]
    ds_read_b128 v[136:139], v3 offset:1024
    buffer_load_dwordx4 a[4:7], v14, s[36:39], s52 offen offset:1024 sc1
    v_mfma_f32_16x16x32_bf16 v[188:191], v[32:35], v[92:95], v[188:191]
    ds_read_b64 v[104:105], v2 offset:1472
    v_mfma_f32_16x16x32_bf16 v[164:167], v[36:39], v[64:67], v[164:167]
    ds_read_b64 v[106:107], v2 offset:1480
    v_mfma_f32_16x16x32_bf16 v[168:171], v[36:39], v[68:71], v[168:171]
    ds_read_b128 v[140:143], v3 offset:1536
    v_mfma_f32_16x16x32_bf16 v[172:175], v[36:39], v[72:75], v[172:175]
    ds_read_b64 v[108:109], v2 offset:1984
    v_mfma_f32_16x16x32_bf16 v[176:179], v[36:39], v[76:79], v[176:179]
    ds_read_b64 v[110:111], v2 offset:1992
    buffer_load_dwordx4 a[8:11], v14, s[36:39], s52 offen offset:2048 sc1
    v_mfma_f32_16x16x32_bf16 v[180:183], v[36:39], v[80:83], v[180:183]
    ds_read_b128 v[144:147], v3 offset:2048
    v_mfma_f32_16x16x32_bf16 v[184:187], v[36:39], v[84:87], v[184:187]
    ds_read_b64 v[112:113], v2 offset:2496
    v_mfma_f32_16x16x32_bf16 v[188:191], v[36:39], v[88:91], v[188:191]
    ds_read_b64 v[114:115], v2 offset:2504
    v_mfma_f32_16x16x32_bf16 v[168:171], v[40:43], v[64:67], v[168:171]
    ds_read_b128 v[148:151], v3 offset:2560
    buffer_load_dwordx4 a[12:15], v14, s[36:39], s52 offen offset:3072 sc1
    v_mfma_f32_16x16x32_bf16 v[172:175], v[40:43], v[68:71], v[172:175]
    ds_read_b64 v[116:117], v2 offset:3008
    v_mfma_f32_16x16x32_bf16 v[176:179], v[40:43], v[72:75], v[176:179]
    ds_read_b64 v[118:119], v2 offset:3016
    v_mfma_f32_16x16x32_bf16 v[180:183], v[40:43], v[76:79], v[180:183]
    ds_read_b128 v[152:155], v3 offset:3072
    v_mfma_f32_16x16x32_bf16 v[184:187], v[40:43], v[80:83], v[184:187]
    ds_read_b64 v[120:121], v2 offset:3520
    v_mfma_f32_16x16x32_bf16 v[188:191], v[40:43], v[84:87], v[188:191]
    ds_read_b64 v[122:123], v2 offset:3528
    buffer_load_dwordx4 a[16:19], v15, s[36:39], s52 offen offset:0 sc1
    s_add_u32 s52, s52, 5120
    v_mfma_f32_16x16x32_bf16 v[172:175], v[44:47], v[64:67], v[172:175]
    ds_read_b128 v[156:159], v3 offset:3584
    v_mfma_f32_16x16x32_bf16 v[176:179], v[44:47], v[68:71], v[176:179]
    ds_read_b64 v[124:125], v2 offset:4032
    v_mfma_f32_16x16x32_bf16 v[180:183], v[44:47], v[72:75], v[180:183]
    ds_read_b64 v[126:127], v2 offset:4040
    v_mfma_f32_16x16x32_bf16 v[184:187], v[44:47], v[76:79], v[184:187]
    buffer_load_dwordx4 a[20:23], v14, s[36:39], s52 offen offset:0 sc1
    v_mfma_f32_16x16x32_bf16 v[188:191], v[44:47], v[80:83], v[188:191]
    v_mfma_f32_16x16x32_bf16 v[176:179], v[48:51], v[64:67], v[176:179]
    v_mfma_f32_16x16x32_bf16 v[180:183], v[48:51], v[68:71], v[180:183]
    v_mfma_f32_16x16x32_bf16 v[184:187], v[48:51], v[72:75], v[184:187]
    v_mfma_f32_16x16x32_bf16 v[188:191], v[48:51], v[76:79], v[188:191]
    buffer_load_dwordx4 a[24:27], v14, s[36:39], s52 offen offset:1024 sc1
    v_mfma_f32_16x16x32_bf16 v[180:183], v[52:55], v[64:67], v[180:183]
    v_mfma_f32_16x16x32_bf16 v[184:187], v[52:55], v[68:71], v[184:187]
    v_mfma_f32_16x16x32_bf16 v[188:191], v[52:55], v[72:75], v[188:191]
    v_mfma_f32_16x16x32_bf16 v[184:187], v[56:59], v[64:67], v[184:187]
    buffer_load_dwordx4 a[28:31], v14, s[36:39], s52 offen offset:2048 sc1
    v_mfma_f32_16x16x32_bf16 v[188:191], v[56:59], v[68:71], v[188:191]
    v_mfma_f32_16x16x32_bf16 v[188:191], v[60:63], v[64:67], v[188:191]
    s_waitcnt lgkmcnt(0)
    s_nop 0
    v_mfma_f32_16x16x32_bf16 v[160:163], v[96:99], v[128:131], v[160:163]
    v_mfma_f32_16x16x32_bf16 v[164:167], v[96:99], v[132:135], v[164:167]
    v_mfma_f32_16x16x32_bf16 v[168:171], v[96:99], v[136:139], v[168:171]
    buffer_load_dwordx4 a[32:35], v14, s[36:39], s52 offen offset:3072 sc1
    v_mfma_f32_16x16x32_bf16 v[172:175], v[96:99], v[140:143], v[172:175]
    v_mfma_f32_16x16x32_bf16 v[176:179], v[96:99], v[144:147], v[176:179]
    v_mfma_f32_16x16x32_bf16 v[180:183], v[96:99], v[148:151], v[180:183]
    v_mfma_f32_16x16x32_bf16 v[184:187], v[96:99], v[152:155], v[184:187]
    buffer_load_dwordx4 a[36:39], v15, s[36:39], s52 offen offset:0 sc1
    s_add_u32 s52, s52, 5120
    v_mfma_f32_16x16x32_bf16 v[188:191], v[96:99], v[156:159], v[188:191]
    v_mfma_f32_16x16x32_bf16 v[164:167], v[100:103], v[128:131], v[164:167]
    v_mfma_f32_16x16x32_bf16 v[168:171], v[100:103], v[132:135], v[168:171]
    v_mfma_f32_16x16x32_bf16 v[172:175], v[100:103], v[136:139], v[172:175]
    v_mfma_f32_16x16x32_bf16 v[176:179], v[100:103], v[140:143], v[176:179]
    buffer_load_dwordx4 a[40:43], v14, s[36:39], s52 offen offset:0 sc1
    v_mfma_f32_16x16x32_bf16 v[180:183], v[100:103], v[144:147], v[180:183]
    v_mfma_f32_16x16x32_bf16 v[184:187], v[100:103], v[148:151], v[184:187]
    v_mfma_f32_16x16x32_bf16 v[188:191], v[100:103], v[152:155], v[188:191]
    v_mfma_f32_16x16x32_bf16 v[168:171], v[104:107], v[128:131], v[168:171]
    buffer_load_dwordx4 a[44:47], v14, s[36:39], s52 offen offset:1024 sc1
    v_mfma_f32_16x16x32_bf16 v[172:175], v[104:107], v[132:135], v[172:175]
    v_mfma_f32_16x16x32_bf16 v[176:179], v[104:107], v[136:139], v[176:179]
    v_mfma_f32_16x16x32_bf16 v[180:183], v[104:107], v[140:143], v[180:183]
    v_mfma_f32_16x16x32_bf16 v[184:187], v[104:107], v[144:147], v[184:187]
    v_mfma_f32_16x16x32_bf16 v[188:191], v[104:107], v[148:151], v[188:191]
    buffer_load_dwordx4 a[48:51], v14, s[36:39], s52 offen offset:2048 sc1
    v_mfma_f32_16x16x32_bf16 v[172:175], v[108:111], v[128:131], v[172:175]
    v_mfma_f32_16x16x32_bf16 v[176:179], v[108:111], v[132:135], v[176:179]
    v_mfma_f32_16x16x32_bf16 v[180:183], v[108:111], v[136:139], v[180:183]
    v_mfma_f32_16x16x32_bf16 v[184:187], v[108:111], v[140:143], v[184:187]
    buffer_load_dwordx4 a[52:55], v14, s[36:39], s52 offen offset:3072 sc1
    v_mfma_f32_16x16x32_bf16 v[188:191], v[108:111], v[144:147], v[188:191]
    v_mfma_f32_16x16x32_bf16 v[176:179], v[112:115], v[128:131], v[176:179]
    v_mfma_f32_16x16x32_bf16 v[180:183], v[112:115], v[132:135], v[180:183]
    v_mfma_f32_16x16x32_bf16 v[184:187], v[112:115], v[136:139], v[184:187]
    v_mfma_f32_16x16x32_bf16 v[188:191], v[112:115], v[140:143], v[188:191]
    buffer_load_dwordx4 a[56:59], v15, s[36:39], s52 offen offset:0 sc1
    s_add_u32 s52, s52, 5120
    v_mfma_f32_16x16x32_bf16 v[180:183], v[116:119], v[128:131], v[180:183]
    v_mfma_f32_16x16x32_bf16 v[184:187], v[116:119], v[132:135], v[184:187]
    v_mfma_f32_16x16x32_bf16 v[188:191], v[116:119], v[136:139], v[188:191]
    v_mfma_f32_16x16x32_bf16 v[184:187], v[120:123], v[128:131], v[184:187]
    buffer_load_dwordx4 a[60:63], v14, s[36:39], s52 offen offset:0 sc1
    v_mfma_f32_16x16x32_bf16 v[188:191], v[120:123], v[132:135], v[188:191]
    v_mfma_f32_16x16x32_bf16 v[188:191], v[124:127], v[128:131], v[188:191]
    s_nop 7
    v_bfe_u32 v8, v0, 4, 1
    v_lshlrev_b32 v8, 9, v8
    v_and_b32 v9, 15, v0
    v_lshl_add_u32 v8, v9, 5, v8
    v_lshrrev_b32 v9, 5, v0
    v_lshl_add_u32 v8, v9, 4, v8
    v_cvt_pk_bf16_f32 v32, v160, v161
    v_cvt_pk_bf16_f32 v33, v162, v163
    v_cvt_pk_bf16_f32 v34, v164, v165
    v_cvt_pk_bf16_f32 v35, v166, v167
    v_cvt_pk_bf16_f32 v36, v168, v169
    v_cvt_pk_bf16_f32 v37, v170, v171
    v_cvt_pk_bf16_f32 v38, v172, v173
    v_cvt_pk_bf16_f32 v39, v174, v175
    v_cvt_pk_bf16_f32 v40, v176, v177
    v_cvt_pk_bf16_f32 v41, v178, v179
    v_cvt_pk_bf16_f32 v42, v180, v181
    v_cvt_pk_bf16_f32 v43, v182, v183
    v_cvt_pk_bf16_f32 v44, v184, v185
    v_cvt_pk_bf16_f32 v45, v186, v187
    v_cvt_pk_bf16_f32 v46, v188, v189
    v_cvt_pk_bf16_f32 v47, v190, v191
    s_nop 1
    v_permlane16_swap_b32 v32, v34
    v_permlane16_swap_b32 v33, v35
    v_permlane16_swap_b32 v36, v38
    v_permlane16_swap_b32 v37, v39
    v_permlane16_swap_b32 v40, v42
    v_permlane16_swap_b32 v41, v43
    v_permlane16_swap_b32 v44, v46
    v_permlane16_swap_b32 v45, v47
    buffer_store_dwordx4 v[32:35], v8, s[36:39], s18 offen offset:0 sc1
    buffer_store_dwordx4 v[36:39], v8, s[36:39], s18 offen offset:1024 sc1
    buffer_store_dwordx4 v[40:43], v8, s[36:39], s18 offen offset:2048 sc1
    buffer_store_dwordx4 v[44:47], v8, s[36:39], s18 offen offset:3072 sc1
    s_waitcnt vmcnt(24)
    v_mov_b32 v96, v200
    v_mov_b32 v97, v201
    v_mov_b32 v98, v202
    v_mov_b32 v99, v203
    v_mov_b32 v100, v204
    v_mov_b32 v101, v205
    v_mov_b32 v102, v206
    v_mov_b32 v103, v207
    v_mov_b32 v104, v208
    v_mov_b32 v105, v209
    v_mov_b32 v106, v210
    v_mov_b32 v107, v211
    v_mov_b32 v108, v212
    v_mov_b32 v109, v213
    v_mov_b32 v110, v214
    v_mov_b32 v111, v215
    v_mov_b32 v112, v216
    v_mov_b32 v113, v217
    v_mov_b32 v114, v218
    v_mov_b32 v115, v219
    v_mov_b32 v116, v220
    v_mov_b32 v117, v221
    v_mov_b32 v118, v222
    v_mov_b32 v119, v223
    v_mov_b32 v120, v224
    v_mov_b32 v121, v225
    v_mov_b32 v122, v226
    v_mov_b32 v123, v227
    v_mov_b32 v124, v228
    v_mov_b32 v125, v229
    v_mov_b32 v126, v230
    v_mov_b32 v127, v231
    s_mov_b32 s29, 17563648
    s_barrier
    s_branch C4JOIN
DONE:
EXIT:
    s_endpgm
P1_RETRY_1:
    s_mov_b32 s81, 0x40000
P1_LOOP_3:
    buffer_load_dword v29, v28, s[36:39], 0 offen sc1
    s_waitcnt vmcnt(0)
    v_cmp_ne_u32 vcc, s56, v29
    s_mov_b64 s[82:83], vcc
    s_cmp_eq_u64 s[82:83], 0
    s_cbranch_scc1 P1_DONE_2
    s_sub_u32 s81, s81, 1
    s_cmp_lg_u32 s81, 0
    s_cbranch_scc1 P1_LOOP_3
    s_branch P1_DONE_2
P2_RETRY_4:
    s_mov_b32 s81, 0x40000
P2_LOOP_6:
    buffer_load_dword v24, v27, s[36:39], 0 offen sc1
    s_waitcnt vmcnt(0)
    v_cmp_ne_u32 vcc, s56, v24
    s_mov_b64 s[82:83], vcc
    s_cmp_eq_u64 s[82:83], 0
    s_cbranch_scc1 P2_DONE_5
    s_sub_u32 s81, s81, 1
    s_cmp_lg_u32 s81, 0
    s_cbranch_scc1 P2_LOOP_6
    s_branch P2_DONE_5
FH_RETRY_8:
    s_mov_b32 s81, 0x40000
FH_LOOP_10:
    buffer_load_dword v19, v18, s[36:39], s49 offen sc1
    s_waitcnt vmcnt(0)
    v_cmp_ne_u32 vcc, s56, v19
    s_mov_b64 s[82:83], vcc
    s_cmp_eq_u64 s[82:83], 0
    s_cbranch_scc1 FH_DONE_9
    s_sub_u32 s81, s81, 1
    s_cmp_lg_u32 s81, 0
    s_cbranch_scc1 FH_LOOP_10
    s_branch FH_DONE_9
FY_RETRY_11:
    s_mov_b32 s81, 0x40000
FY_LOOP_13:
    buffer_load_dword v20, v18, s[36:39], s59 offen sc1
    s_waitcnt vmcnt(0)
    v_cmp_ne_u32 vcc, s56, v20
    s_mov_b64 s[82:83], vcc
    s_cmp_eq_u64 s[82:83], 0
    s_cbranch_scc1 FY_DONE_12
    s_sub_u32 s81, s81, 1
    s_cmp_lg_u32 s81, 0
    s_cbranch_scc1 FY_LOOP_13
    s_branch FY_DONE_12
EP_RETRY_14:
    s_mov_b32 s81, 0x40000
EP_LOOP_16:
    buffer_load_dword v24, v16, s[36:39], s76 offen sc1
    s_waitcnt vmcnt(0)
    v_cmp_ne_u32 vcc, s56, v24
    s_mov_b64 s[82:83], vcc
    s_cmp_eq_u64 s[82:83], 0
    s_cbranch_scc1 EP_DONE_15
    s_sub_u32 s81, s81, 1
    s_cmp_lg_u32 s81, 0
    s_cbranch_scc1 EP_LOOP_16
    s_branch EP_DONE_15
EP_CHECK:
    s_waitcnt vmcnt(0)
    v_cmp_ne_u32 vcc, s56, v24
    s_mov_b64 s[82:83], vcc
    s_cmp_eq_u64 s[82:83], 0
    s_cbranch_scc0 EP_RETRY_14
EP_DONE_15:
    s_branch EP_BACK
EP_STORE:
    s_sub_u32 s73, s56, 2654435768
    v_mov_b32 v16, s73
    v_mov_b32 v17, 0
    s_mov_b32 exec_lo, 1
    s_mov_b32 exec_hi, 0
    buffer_store_dword v16, v17, s[36:39], 0 offen sc1
    s_mov_b64 exec, -1
    s_branch EP_STORED
FAI_RETRY_17:
    s_mov_b32 s81, 0x40000
FAI_LOOP_19:
    buffer_load_dword v25, v28, s[36:39], 0 offen sc1
    s_waitcnt vmcnt(0)
    v_cmp_ne_u32 vcc, s56, v25
    s_mov_b64 s[82:83], vcc
    s_cmp_eq_u64 s[82:83], 0
    s_cbranch_scc1 FAI_DONE_18
    s_sub_u32 s81, s81, 1
    s_cmp_lg_u32 s81, 0
    s_cbranch_scc1 FAI_LOOP_19
    s_branch FAI_DONE_18
P2I_RETRY_20:
    s_mov_b32 s81, 0x40000
P2I_LOOP_22:
    buffer_load_dword v24, v27, s[36:39], 0 offen sc1
    s_waitcnt vmcnt(0)
    v_cmp_ne_u32 vcc, s56, v24
    s_mov_b64 s[82:83], vcc
    s_cmp_eq_u64 s[82:83], 0
    s_cbranch_scc1 P2I_DONE_21
    s_sub_u32 s81, s81, 1
    s_cmp_lg_u32 s81, 0
    s_cbranch_scc1 P2I_LOOP_22
    s_branch P2I_DONE_21
CODE_END:
.section .rodata,"a"
.p2align 6
.amdhsa_kernel recurrent_scan__ssm_conv_h3__dense_activation_gelu__prompt_kernel
  .amdhsa_next_free_vgpr 512
  .amdhsa_next_free_sgpr 102
  .amdhsa_accum_offset 256
  .amdhsa_group_segment_fixed_size 0
  .amdhsa_kernarg_size 112
  .amdhsa_user_sgpr_count 2
  .amdhsa_user_sgpr_kernarg_segment_ptr 1
  .amdhsa_system_sgpr_workgroup_id_x 1
.end_amdhsa_kernel
```

```asm
; @launch grid=(256,1,1) block=(256,1,1) lds=156160
.amdgcn_target "amdgcn-amd-amdhsa--gfx950"
.text
.globl recurrent_scan__ssm_conv_h3__dense_activation_gelu__prompt_kernel
.p2align 12
.type recurrent_scan__ssm_conv_h3__dense_activation_gelu__prompt_kernel,@function
recurrent_scan__ssm_conv_h3__dense_activation_gelu__prompt_kernel:
KERNEL_START:
    s_lshr_b32 s58, s2, 3
    s_cmp_ge_u32 s58, 32
    s_cbranch_scc1 EXIT
    s_load_dwordx16 s[4:19], s[0:1], 0
    s_load_dwordx8 s[20:27], s[0:1], 64
    s_load_dwordx4 s[28:31], s[0:1], 96
    s_getpc_b64 s[44:45]
PF_BASE:
    s_mul_i32 s78, s58, 9
    v_add_u32 v47, s78, v0
    v_lshlrev_b32 v47, 7, v47
    v_cmp_gt_u32 vcc, 9, v0
    s_mov_b32 s46, CODE_END-PF_BASE
    s_lshl_b32 s47, 1, 17
    v_cndmask_b32 v47, -1, v47, vcc
    v_lshrrev_b32 v1, 6, v0
    buffer_load_dword v47, v47, s[44:47], 0 offen
    v_and_b32 v0, 63, v0
    v_readfirstlane_b32 s3, v1
    s_and_b32 s57, s2, 7
    s_lshr_b32 s75, s58, 2
    s_and_b32 s76, s58, 3
    s_lshl_b32 s76, s76, 3
    s_add_u32 s76, s76, s57
    v_lshrrev_b32 v15, 4, v0
    v_and_b32 v18, 15, v0
    s_lshl_b32 s79, s75, 7
    s_mul_i32 s80, s76, 81920
    s_lshl_b32 s78, s3, 2
    v_add_u32_e64 v15, s78, v15
    v_mul_u32_u24 v14, 5120, v15
    v_lshl_add_u32 v14, v18, 3, v14
    v_add_u32 v14, s80, v14
    v_add_u32 v248, s79, v14
    v_add_u32 v249, 0xfffff100, v248
    v_add_u32 v250, 0xfffff600, v248
    v_add_u32 v251, 0xfffffb00, v248
    v_lshlrev_b32 v18, 5, v18
    v_lshl_add_u32 v252, s75, 9, v18
    s_lshl_b32 s46, 5, 19
    s_mov_b64 s[50:51], s[46:47]
    s_mov_b64 s[34:35], s[46:47]
    s_movk_i32 s54, 5120
    s_mov_b32 s55, s47
    s_waitcnt lgkmcnt(0)
    s_mov_b64 s[44:45], s[6:7]
    s_mov_b64 s[52:53], s[10:11]
    s_mov_b64 s[48:49], s[8:9]
    buffer_load_dwordx2 v[96:97], v249, s[44:47], 0 offen nt
    buffer_load_dwordx2 v[98:99], v250, s[44:47], 0 offen nt
    buffer_load_dwordx2 v[100:101], v251, s[44:47], 0 offen nt
    buffer_load_dwordx2 v[102:103], v248, s[44:47], 0 offen offset:0 nt
    buffer_load_dwordx2 v[104:105], v248, s[44:47], 0 offen offset:1280 nt
    buffer_load_dwordx2 v[106:107], v248, s[44:47], 0 offen offset:2560 nt
    buffer_load_dwordx2 v[108:109], v248, s[44:47], 0 offen offset:3840 nt
    buffer_load_dwordx4 v[118:121], v252, s[52:55], 0 offen
    buffer_load_dwordx4 v[122:125], v252, s[52:55], 0 offen offset:16
    buffer_load_dwordx2 v[110:111], v248, s[48:51], 0 offen offset:0 nt
    buffer_load_dwordx2 v[112:113], v248, s[48:51], 0 offen offset:1280 nt
    buffer_load_dwordx2 v[114:115], v248, s[48:51], 0 offen offset:2560 nt
    buffer_load_dwordx2 v[116:117], v248, s[48:51], 0 offen offset:3840 nt
    s_load_dword s56, s[30:31], 0
    s_mov_b64 s[32:33], s[4:5]
    s_movk_i32 s73, 1280
    s_cmp_ge_u32 s58, 28
    s_cbranch_scc1 IDLE
    s_lshl_b32 s78, s57, 8
    s_lshl_b32 s79, s58, 3
    s_add_u32 s78, s78, s79
    s_lshl_b32 s79, s3, 1
    s_add_u32 s78, s78, s79
    v_lshrrev_b32 v226, 5, v0
    v_add_u32 v226, s78, v226
    v_and_b32 v227, 31, v0
    v_lshlrev_b32 v227, 3, v227
    v_mad_u32_u24 v227, v226, s73, v227
    v_lshlrev_b32 v226, 3, v226
    buffer_load_dwordx2 v[216:217], v227, s[32:35], 0 offen offset:0
    buffer_load_dwordx2 v[218:219], v227, s[32:35], 0 offen offset:256
    buffer_load_dwordx2 v[220:221], v227, s[32:35], 0 offen offset:512
    buffer_load_dwordx2 v[222:223], v227, s[32:35], 0 offen offset:768
    buffer_load_dwordx2 v[224:225], v227, s[32:35], 0 offen offset:1024
    s_lshl_b32 s79, s75, 18
    s_lshl_b32 s80, s76, 7
    s_add_u32 s59, s79, s80
    s_add_u32 s59, s59, 1048576
    s_lshl_b32 s84, s75, 5
    s_add_u32 s84, s84, s76
    s_lshl_b32 s84, s84, 6
    s_add_u32 s84, s84, 131072
    s_lshr_b32 s73, s57, 1
    s_lshl_b32 s73, s73, 2
    s_and_b32 s74, s58, 3
    s_add_u32 s63, s73, s74
    s_and_b32 s73, s57, 1
    s_mul_i32 s73, s73, 7
    s_lshr_b32 s74, s58, 2
    s_add_u32 s64, s73, s74
    s_and_b32 s65, s3, 1
    s_lshr_b32 s66, s3, 1
    s_mul_i32 s73, s63, 163840
    s_mul_i32 s74, s3, 40960
    s_add_u32 s60, s73, s74
    s_lshl_b32 s73, s64, 8
    s_mul_i32 s74, s3, 55296
    s_add_u32 s61, s73, s74
    s_lshl_b32 s62, s3, 12
    s_mov_b32 s85, -1152
    s_mov_b32 s86, -1990656
    s_lshr_b32 s73, s58, 2
    s_mul_i32 s73, s73, 10
    s_add_u32 s73, s73, 3
    s_mul_i32 s73, s73, 9363
    s_lshr_b32 s73, s73, 16
    s_and_b32 s74, s58, 3
    s_mul_i32 s74, s74, 5
    s_lshr_b32 s74, s74, 1
    s_add_u32 s73, s73, s74
    s_cmp_ge_u32 s73, 10
    s_cselect_b32 s74, 10, 0
    s_sub_u32 s73, s73, s74
    s_sub_u32 s74, 9, s73
    s_lshl_b32 s0, 1, s74
    s_lshl_b32 s74, s73, 7
    s_add_u32 s60, s60, s74
    s_mul_i32 s74, s73, 221184
    s_add_u32 s61, s61, s74
    v_lshrrev_b32 v1, 3, v0
    v_and_b32 v2, 7, v0
    v_xor_b32 v2, v2, v1
    v_lshlrev_b32 v2, 4, v2
    v_mul_u32_u24 v240, 1280, v1
    v_add_u32_e64 v240, v240, v2
    v_add_u32 v241, 9216, v240
    v_add_u32 v242, 18432, v240
    v_add_u32 v243, 27648, v240
    v_lshrrev_b32 v1, 4, v0
    v_and_b32 v2, 15, v0
    v_lshlrev_b32 v3, 1, v1
    v_xor_b32 v2, v2, v3
    v_lshlrev_b32 v2, 4, v2
    v_mul_u32_u24 v3, 3456, v1
    v_add_u32 v244, v3, v2
    v_add_u32 v245, 12800, v244
    v_xor_b32 v2, 128, v2
    v_add_u32_e64 v3, v3, v2
    v_add_u32 v246, 25600, v3
    v_add_u32 v247, 38400, v3
    s_mov_b32 s42, 0
    s_mov_b64 exec, 0
    s_cmp_eq_u32 s3, 0
    s_cbranch_scc1 PAGE1
    s_cmp_eq_u32 s3, 1
    s_cbranch_scc1 PAGE3
    s_cmp_eq_u32 s3, 2
    s_cbranch_scc1 PAGE5
    s_branch PAGE7
VISIT_RET:
    s_cmp_eq_u32 s42, 1
    s_cbranch_scc1 VISIT_RET_I
    s_mov_b64 exec, -1
    s_mov_b32 s44, s22
    s_mov_b32 s45, s23
    s_mov_b32 s46, 2211840
    s_mov_b32 s47, 0x20000
    s_mov_b32 s40, s18
    s_mov_b32 s41, s19
    s_mov_b32 s42, 2211840
    s_mov_b32 s43, 0x20000
    s_add_u32 m0, s62, 0
    s_nop 0
    buffer_load_dwordx4 v240, s[32:35], s60 offen offset:0 lds
    s_lshl_b32 s68, s64, 3
    s_lshl_b32 s73, s65, 2
    s_add_u32 s68, s68, s73
    s_lshl_b32 s73, s66, 1
    s_add_u32 s74, s73, 0
    s_and_b32 s74, s74, 3
    s_add_u32 s69, s74, s68
    s_add_u32 s74, s73, 1
    s_and_b32 s74, s74, 3
    s_add_u32 s70, s74, s68
    s_add_u32 s74, s73, 2
    s_and_b32 s74, s74, 3
    s_add_u32 s71, s74, s68
    s_add_u32 s74, s73, 3
    s_and_b32 s74, s74, 3
    s_add_u32 s72, s74, s68
    s_mov_b32 s36, s30
    s_mov_b32 s37, s31
    s_mov_b32 s38, 17563648
    s_mov_b32 s39, 0x20000
    v_and_b32 v203, 15, v0
    v_lshrrev_b32 v204, 5, v0
    s_lshl_b32 s78, s3, 1
    v_add_u32 v204, s78, v204
    v_xor_b32 v204, v204, v203
    v_and_b32 v204, 7, v204
    v_lshlrev_b32_e64 v204, 4, v204
    v_lshl_add_u32 v203, v203, 9, v204
    buffer_load_dwordx4 v241, s[32:35], s60 offen offset:1024 lds
    v_bfe_u32 v204, v0, 4, 1
    v_xor_b32_e64 v204, 1, v204
    v_lshl_add_u32 v203, v204, 3, v203
    v_add_u32 v203, 131584, v203
    s_lshl_b32 s78, s3, 6
    v_add_u32 v205, s78, v0
    v_lshrrev_b32 v206, 3, v205
    v_lshrrev_b32 v204, 5, v205
    v_xor_b32 v204, v204, v205
    v_and_b32 v204, 7, v204
    v_lshlrev_b32_e64 v204, 4, v204
    v_lshl_add_u32 v204, v206, 7, v204
    v_add_u32 v204, 131584, v204
    v_and_b32 v205, 7, v205
    v_lshlrev_b32 v205, 4, v205
    v_lshl_add_u32 v205, v206, 12, v205
    v_add_u32 v206, 0x20000, v205
    s_and_b32 s76, s58, 7
    s_lshl_b32 s77, s57, 2
    s_lshr_b32 s78, s58, 3
    s_add_u32 s77, s77, s78
    s_mul_i32 s78, s77, 40960
    s_mul_i32 s79, s76, 160
    s_add_u32 s78, s78, s79
    s_add_u32 s79, s78, 1310720
    s_cmp_lt_u32 s77, 22
    s_cselect_b32 s79, s79, 2211840
    s_lshl_b32 s80, s3, 6
    v_add_u32 v24, s80, v0
    buffer_load_dwordx4 v242, s[32:35], s60 offen offset:2048 lds
    v_cmp_gt_u32 vcc, 320, v24
    v_subrev_u32 v25, 320, v24
    v_mov_b32 v26, s79
    v_mov_b32 v27, s78
    v_cndmask_b32 v25, v25, v24, vcc
    v_cndmask_b32 v26, v26, v27, vcc
    v_mul_u32_u24 v27, 6554, v25
    v_lshrrev_b32 v27, 16, v27
    v_mul_u32_u24 v28, 10, v27
    v_sub_u32_e64 v28, v25, v28
    v_mul_u32_u24 v27, 1280, v27
    v_lshl_add_u32 v27, v28, 4, v27
    v_add_u32 v253, v27, v26
    v_add_u32 v24, s80, v0
    v_add_u32 v24, 256, v24
    v_cmp_gt_u32 vcc, 320, v24
    v_subrev_u32 v25, 320, v24
    v_mov_b32 v26, s79
    v_mov_b32 v27, s78
    v_cndmask_b32 v25, v25, v24, vcc
    v_cndmask_b32 v26, v26, v27, vcc
    v_mul_u32_u24 v27, 6554, v25
    v_lshrrev_b32 v27, 16, v27
    v_mul_u32_u24 v28, 10, v27
    v_sub_u32_e64 v28, v25, v28
    v_mul_u32_u24 v27, 1280, v27
    v_lshl_add_u32 v27, v28, 4, v27
    v_add_u32 v254, v27, v26
    v_add_u32 v24, s80, v0
    buffer_load_dwordx4 v243, s[32:35], s60 offen offset:3072 lds
    v_add_u32 v24, 512, v24
    v_cmp_gt_u32 vcc, 320, v24
    v_subrev_u32 v25, 320, v24
    v_mov_b32 v26, s79
    v_mov_b32 v27, s78
    v_cndmask_b32 v25, v25, v24, vcc
    v_cndmask_b32 v26, v26, v27, vcc
    v_mul_u32_u24 v27, 6554, v25
    v_lshrrev_b32 v27, 16, v27
    v_mul_u32_u24 v28, 10, v27
    v_sub_u32_e64 v28, v25, v28
    v_mul_u32_u24 v27, 1280, v27
    v_lshl_add_u32 v27, v28, 4, v27
    v_add_u32_e64 v255, v27, v26
    v_mov_b32 v26, 2211840
    v_cmp_gt_u32 vcc, 640, v24
    s_nop 1
    v_cndmask_b32 v255, v26, v255, vcc
    s_and_b32 s77, s58, 7
    s_lshl_b32 s78, s57, 2
    s_lshr_b32 s79, s58, 3
    s_add_u32 s78, s78, s79
    s_mul_i32 s77, s77, 54
    s_add_u32 s77, s77, s78
    s_mul_i32 s77, s77, 5120
    s_add_u32 s77, s77, 4194304
    v_lshrrev_b32_e64 v24, 4, v0
    v_bfe_u32 v25, v0, 2, 2
    s_add_u32 m0, s62, 16384
    s_nop 0
    buffer_load_dwordx4 v244, s[40:43], s61 offen offset:0 lds
    v_lshl_add_u32 v24, v24, 2, v25
    v_mul_u32_u24 v24, 160, v24
    v_and_b32 v25, 3, v0
    s_add_u32 s79, s3, 0
    s_cmp_ge_u32 s79, 5
    s_cselect_b32 s80, 1, 0
    s_mul_i32 s81, s80, 5
    s_sub_u32 s79, s79, s81
    s_mul_i32 s81, s80, 163840
    s_add_u32 s81, s81, s77
    s_lshl_b32 s82, s79, 10
    s_add_u32 s81, s81, s82
    s_cmp_ge_u32 s78, 22
    s_cselect_b32 s82, s80, 0
    s_cmp_ge_u32 s79, 5
    s_cselect_b32 s82, 1, s82
    s_cmp_lg_u32 s82, 0
    s_cselect_b32 s74, 17563648, s81
    s_min_u32 s79, s79, 4
    s_and_b32 s82, s79, 1
    s_lshl_b32 s82, s82, 3
    s_lshr_b32 s83, s79, 1
    s_lshl_b32 s83, s83, 6
    s_add_u32 s82, s82, s83
    s_mul_i32 s83, s80, 5120
    s_add_u32 s82, s82, s83
    s_add_u32 s82, s82, 139776
    s_cmp_eq_u32 s79, 4
    s_cselect_b32 s83, 3, 4
    v_lshlrev_b32 v200, s83, v25
    v_add3_u32 v200, v200, v24, s82
    s_add_u32 s79, s3, 4
    s_cmp_ge_u32 s79, 5
    s_cselect_b32 s80, 1, 0
    buffer_load_dwordx4 v245, s[40:43], s61 offen offset:1024 lds
    s_mul_i32 s81, s80, 5
    s_sub_u32 s79, s79, s81
    s_mul_i32 s81, s80, 163840
    s_add_u32 s81, s81, s77
    s_lshl_b32 s82, s79, 10
    s_add_u32 s81, s81, s82
    s_cmp_ge_u32 s78, 22
    s_cselect_b32 s82, s80, 0
    s_cmp_ge_u32 s79, 5
    s_cselect_b32 s82, 1, s82
    s_cmp_lg_u32 s82, 0
    s_cselect_b32 s75, 17563648, s81
    s_min_u32 s79, s79, 4
    s_and_b32 s82, s79, 1
    s_lshl_b32 s82, s82, 3
    s_lshr_b32 s83, s79, 1
    s_lshl_b32 s83, s83, 6
    s_add_u32 s82, s82, s83
    s_mul_i32 s83, s80, 5120
    s_add_u32 s82, s82, s83
    s_add_u32 s82, s82, 139776
    s_cmp_eq_u32 s79, 4
    s_cselect_b32 s83, 3, 4
    v_lshlrev_b32 v201, s83, v25
    v_add3_u32 v201, v201, v24, s82
    s_add_u32 s79, s3, 8
    s_cmp_ge_u32 s79, 5
    s_cselect_b32 s80, 1, 0
    s_mul_i32 s81, s80, 5
    s_sub_u32 s79, s79, s81
    s_mul_i32 s81, s80, 163840
    s_add_u32 s81, s81, s77
    s_lshl_b32 s82, s79, 10
    s_add_u32 s81, s81, s82
    buffer_load_dwordx4 v246, s[40:43], s61 offen offset:2048 lds
    s_cmp_ge_u32 s78, 22
    s_cselect_b32 s82, s80, 0
    s_cmp_ge_u32 s79, 5
    s_cselect_b32 s82, 1, s82
    s_cmp_lg_u32 s82, 0
    s_cselect_b32 s76, 17563648, s81
    s_min_u32 s79, s79, 4
    s_and_b32 s82, s79, 1
    s_lshl_b32 s82, s82, 3
    s_lshr_b32 s83, s79, 1
    s_lshl_b32 s83, s83, 6
    s_add_u32 s82, s82, s83
    s_mul_i32 s83, s80, 5120
    s_add_u32 s82, s82, s83
    s_add_u32 s82, s82, 139776
    s_cmp_eq_u32 s79, 4
    s_cselect_b32 s83, 3, 4
    v_lshlrev_b32 v202, s83, v25
    v_add3_u32 v202, v202, v24, s82
    v_lshlrev_b32 v14, 4, v0
    v_and_b32 v1, 15, v0
    v_lshrrev_b32 v17, 4, v0
    v_bfe_u32 v18, v0, 2, 2
    v_and_b32 v19, 3, v0
    v_and_b32 v24, 1, v17
    v_lshl_or_b32 v24, v24, 2, v18
    v_lshl_add_u32 v25, v17, 3, v18
    v_lshlrev_b32 v25, 8, v25
    v_lshl_add_u32 v25, v19, 3, v25
    s_and_b32 s73, s69, 7
    v_xor_b32_e64 v26, s73, v24
    v_lshl_add_u32 v2, v26, 5, v25
    buffer_load_dwordx4 v247, s[40:43], s61 offen offset:3072 lds
    v_add_u32 v6, 0x10000, v2
    s_and_b32 s73, s70, 7
    v_xor_b32 v26, s73, v24
    v_lshl_add_u32 v3, v26, 5, v25
    v_add_u32 v7, 0x10000, v3
    s_and_b32 s73, s71, 7
    v_xor_b32 v26, s73, v24
    v_lshl_add_u32 v4, v26, 5, v25
    v_add_u32 v8, 0x10000, v4
    s_and_b32 s73, s72, 7
    v_xor_b32 v26, s73, v24
    v_lshl_add_u32 v5, v26, 5, v25
    v_add_u32 v9, 0x10000, v5
    s_lshl_b32 s73, s66, 13
    v_and_b32 v24, 7, v1
    v_xor_b32 v24, v24, v17
    v_lshlrev_b32 v24, 4, v24
    v_lshl_add_u32 v24, v1, 7, v24
    v_add_u32 v10, s73, v24
    v_xor_b32 v11, 64, v10
    v_add_u32 v12, 0x10000, v10
    v_add_u32 v13, 0x10000, v11
    v_mov_b32 v20, 0x3f803f80
    v_mov_b32 v21, 0x3f803f80
    v_mov_b32 v22, 0x3f803f80
    v_mov_b32 v23, 0x3f803f80
    s_lshl_b32 s67, s63, 7
    s_lshl_b32 s73, s66, 6
    s_add_u32 s67, s67, s73
    s_bitcmp1_b32 s0, 0
    s_cselect_b32 s87, s85, 128
    s_cselect_b32 s88, s86, 221184
    s_add_u32 s60, s60, s87
    s_add_u32 s61, s61, s88
    s_add_u32 m0, s62, 32768
    s_nop 0
    buffer_load_dwordx4 v240, s[32:35], s60 offen offset:0 lds
    s_waitcnt vmcnt(18)
    v_lshlrev_b32 v144, 16, v118
    v_and_b32 v148, 0xffff0000, v118
    v_lshlrev_b32 v145, 16, v122
    v_and_b32 v149, 0xffff0000, v122
    v_lshlrev_b32 v146, 16, v120
    v_and_b32 v150, 0xffff0000, v120
    v_lshlrev_b32 v147, 16, v124
    v_and_b32 v151, 0xffff0000, v124
    v_lshlrev_b32 v152, 16, v119
    v_and_b32 v156, 0xffff0000, v119
    v_lshlrev_b32 v153, 16, v123
    v_and_b32 v157, 0xffff0000, v123
    v_lshlrev_b32 v154, 16, v121
    v_and_b32 v158, 0xffff0000, v121
    v_lshlrev_b32 v155, 16, v125
    buffer_load_dwordx4 v241, s[32:35], s60 offen offset:1024 lds
    v_and_b32 v159, 0xffff0000, v125
    v_lshlrev_b32 v128, 16, v96
    v_and_b32 v96, 0xffff0000, v96
    v_lshlrev_b32 v129, 16, v97
    v_and_b32 v97, 0xffff0000, v97
    v_lshlrev_b32 v130, 16, v98
    v_and_b32 v98, 0xffff0000, v98
    v_lshlrev_b32 v131, 16, v99
    v_and_b32 v99, 0xffff0000, v99
    v_lshlrev_b32 v132, 16, v100
    v_and_b32 v100, 0xffff0000, v100
    v_lshlrev_b32 v133, 16, v101
    v_and_b32 v101, 0xffff0000, v101
    v_lshlrev_b32 v134, 16, v102
    v_and_b32 v102, 0xffff0000, v102
    v_lshlrev_b32 v135, 16, v103
    buffer_load_dwordx4 v242, s[32:35], s60 offen offset:2048 lds
    v_and_b32 v103, 0xffff0000, v103
    v_lshlrev_b32 v136, 16, v104
    v_and_b32 v104, 0xffff0000, v104
    v_lshlrev_b32 v137, 16, v105
    v_and_b32 v105, 0xffff0000, v105
    v_lshlrev_b32 v138, 16, v106
    v_and_b32 v106, 0xffff0000, v106
    v_lshlrev_b32 v139, 16, v107
    v_and_b32 v107, 0xffff0000, v107
    v_lshlrev_b32 v140, 16, v108
    v_and_b32 v108, 0xffff0000, v108
    v_lshlrev_b32 v141, 16, v109
    v_and_b32 v109, 0xffff0000, v109
    v_pk_mul_f32 v[160:161], v[134:135], v[144:145]
    v_pk_mul_f32 v[162:163], v[102:103], v[146:147]
    v_pk_mul_f32 v[164:165], v[136:137], v[144:145]
    buffer_load_dwordx4 v243, s[32:35], s60 offen offset:3072 lds
    v_pk_mul_f32 v[166:167], v[104:105], v[146:147]
    v_pk_mul_f32 v[168:169], v[138:139], v[144:145]
    v_pk_mul_f32 v[170:171], v[106:107], v[146:147]
    v_pk_mul_f32 v[172:173], v[140:141], v[144:145]
    v_pk_mul_f32 v[174:175], v[108:109], v[146:147]
    v_pk_fma_f32 v[160:161], v[132:133], v[148:149], v[160:161]
    v_pk_fma_f32 v[162:163], v[100:101], v[150:151], v[162:163]
    v_pk_fma_f32 v[164:165], v[134:135], v[148:149], v[164:165]
    v_pk_fma_f32 v[166:167], v[102:103], v[150:151], v[166:167]
    v_pk_fma_f32 v[168:169], v[136:137], v[148:149], v[168:169]
    v_pk_fma_f32 v[170:171], v[104:105], v[150:151], v[170:171]
    v_pk_fma_f32 v[172:173], v[138:139], v[148:149], v[172:173]
    v_pk_fma_f32 v[174:175], v[106:107], v[150:151], v[174:175]
    v_pk_fma_f32 v[160:161], v[130:131], v[152:153], v[160:161]
    v_pk_fma_f32 v[162:163], v[98:99], v[154:155], v[162:163]
    v_pk_fma_f32 v[164:165], v[132:133], v[152:153], v[164:165]
    s_add_u32 m0, s62, 49152
    s_nop 0
    s_nop 0
    buffer_load_dwordx4 v244, s[40:43], s61 offen offset:0 lds
    v_pk_fma_f32 v[166:167], v[100:101], v[154:155], v[166:167]
    v_pk_fma_f32 v[168:169], v[134:135], v[152:153], v[168:169]
    v_pk_fma_f32 v[170:171], v[102:103], v[154:155], v[170:171]
    v_pk_fma_f32 v[172:173], v[136:137], v[152:153], v[172:173]
    v_pk_fma_f32 v[174:175], v[104:105], v[154:155], v[174:175]
    v_pk_fma_f32 v[160:161], v[128:129], v[156:157], v[160:161]
    v_pk_fma_f32 v[162:163], v[96:97], v[158:159], v[162:163]
    v_pk_fma_f32 v[164:165], v[130:131], v[156:157], v[164:165]
    v_pk_fma_f32 v[166:167], v[98:99], v[158:159], v[166:167]
    v_pk_fma_f32 v[168:169], v[132:133], v[156:157], v[168:169]
    v_pk_fma_f32 v[170:171], v[100:101], v[158:159], v[170:171]
    v_pk_fma_f32 v[172:173], v[134:135], v[156:157], v[172:173]
    v_pk_fma_f32 v[174:175], v[102:103], v[158:159], v[174:175]
    s_waitcnt vmcnt(18)
    v_lshlrev_b32 v128, 16, v110
    v_and_b32 v110, 0xffff0000, v110
    buffer_load_dwordx4 v245, s[40:43], s61 offen offset:1024 lds
    v_lshlrev_b32 v129, 16, v111
    v_and_b32 v111, 0xffff0000, v111
    v_lshlrev_b32 v130, 16, v112
    v_and_b32 v112, 0xffff0000, v112
    v_lshlrev_b32 v131, 16, v113
    v_and_b32 v113, 0xffff0000, v113
    v_lshlrev_b32 v132, 16, v114
    v_and_b32 v114, 0xffff0000, v114
    v_lshlrev_b32 v133, 16, v115
    v_and_b32 v115, 0xffff0000, v115
    v_lshlrev_b32 v134, 16, v116
    v_and_b32 v116, 0xffff0000, v116
    v_lshlrev_b32_e64 v135, 16, v117
    v_and_b32 v117, 0xffff0000, v117
    v_pk_mul_f32 v[160:161], v[160:161], v[128:129]
    v_pk_mul_f32 v[162:163], v[162:163], v[110:111]
    buffer_load_dwordx4 v246, s[40:43], s61 offen offset:2048 lds
    v_pk_mul_f32 v[164:165], v[164:165], v[130:131]
    v_pk_mul_f32 v[166:167], v[166:167], v[112:113]
    v_pk_mul_f32 v[168:169], v[168:169], v[132:133]
    v_pk_mul_f32 v[170:171], v[170:171], v[114:115]
    v_pk_mul_f32 v[172:173], v[172:173], v[134:135]
    v_pk_mul_f32 v[174:175], v[174:175], v[116:117]
    v_cvt_pk_bf16_f32 v144, v172, v168
    v_cvt_pk_bf16_f32 v145, v164, v160
    v_cvt_pk_bf16_f32 v146, v174, v170
    v_cvt_pk_bf16_f32 v147, v166, v162
    v_cvt_pk_bf16_f32 v148, v173, v169
    v_cvt_pk_bf16_f32 v149, v165, v161
    v_cvt_pk_bf16_f32 v150, v175, v171
    v_cvt_pk_bf16_f32 v151, v167, v163
    ds_write_b64 v203, v[144:145] offset:0
    ds_write_b64 v203, v[146:147] offset:128
    buffer_load_dwordx4 v247, s[40:43], s61 offen offset:3072 lds
    ds_write_b64 v203, v[148:149] offset:256
    ds_write_b64 v203, v[150:151] offset:384
    s_waitcnt vmcnt(16)
    s_mov_b32 s78, 0x3f803f80
    v_mov_b32 v228, 0
    v_mov_b32_e64 v229, 0
    v_dot2c_f32_bf16 v228, s78, v216
    v_dot2c_f32_bf16 v229, v216, v216
    v_dot2c_f32_bf16 v228, s78, v217
    v_dot2c_f32_bf16 v229, v217, v217
    v_dot2c_f32_bf16 v228, s78, v218
    v_dot2c_f32_bf16 v229, v218, v218
    v_dot2c_f32_bf16 v228, s78, v219
    v_dot2c_f32_bf16 v229, v219, v219
    v_dot2c_f32_bf16 v228, s78, v220
    v_dot2c_f32_bf16 v229, v220, v220
    v_dot2c_f32_bf16 v228, s78, v221
    s_bitcmp1_b32 s0, 1
    s_cselect_b32 s87, s85, 128
    s_cselect_b32 s88, s86, 221184
    s_add_u32 s60, s60, s87
    s_add_u32 s61, s61, s88
    v_dot2c_f32_bf16 v229, v221, v221
    v_dot2c_f32_bf16 v228, s78, v222
    v_dot2c_f32_bf16 v229, v222, v222
    v_dot2c_f32_bf16 v228, s78, v223
    v_dot2c_f32_bf16 v229, v223, v223
    v_dot2c_f32_bf16 v228, s78, v224
    v_dot2c_f32_bf16 v229, v224, v224
    v_dot2c_f32_bf16 v228, s78, v225
    v_dot2c_f32_bf16 v229, v225, v225
    s_nop 1
    v_add_f32_dpp v228, v228, v228 row_ror:8 row_mask:0xf bank_mask:0xf
PAGE1:
    s_cbranch_execz PAGE2
    v_add_f32_dpp v229, v229, v229 row_ror:8 row_mask:0xf bank_mask:0xf
    s_nop 1
    v_add_f32_dpp v228, v228, v228 row_ror:4 row_mask:0xf bank_mask:0xf
    v_add_f32_dpp v229, v229, v229 row_ror:4 row_mask:0xf bank_mask:0xf
    s_nop 1
    v_add_f32_dpp v228, v228, v228 row_ror:2 row_mask:0xf bank_mask:0xf
    v_add_f32_dpp v229, v229, v229 row_ror:2 row_mask:0xf bank_mask:0xf
    s_nop 1
    v_add_f32_dpp v228, v228, v228 row_ror:1 row_mask:0xf bank_mask:0xf
    v_add_f32_dpp v229, v229, v229 row_ror:1 row_mask:0xf bank_mask:0xf
    s_nop 1
    v_add_f32_dpp v228, v228, v228 row_bcast:15 row_mask:0xa bank_mask:0xf
    v_add_f32_dpp v229, v229, v229 row_bcast:15 row_mask:0xa bank_mask:0xf
    s_nop 0
    v_mul_f32 v230, 0x3acccccd, v228
    v_mul_f32 v229, 0x3acccccd, v229
    v_fma_f32 v229, -v230, v230, v229
    v_max_f32 v229, 0, v229
    v_add_f32 v229, 0x3727c5ac, v229
    v_rsq_f32 v231, v229
    s_mov_b32 s78, 65536
    s_mov_b32 exec_lo, 0x10000
    s_mov_b32 exec_hi, 0x10000
    buffer_store_dwordx2 v[230:231], v226, s[36:39], s78 offen sc1
    s_mov_b64 exec, -1
    s_waitcnt vmcnt(9) lgkmcnt(0)
    s_barrier
    s_add_u32 s56, s56, 2654435769
    v_mov_b32 v31, s56
    ds_read_b128 v[48:51], v10 offset:0
    ds_read_b64_tr_b16 v[32:33], v2 offset:16384
    ds_read_b64_tr_b16 v[34:35], v2 offset:17408
    ds_read_b128 v[52:55], v10 offset:2048
    ds_read_b64_tr_b16 v[36:37], v3 offset:16384
    ds_read_b64_tr_b16 v[38:39], v3 offset:17408
    ds_read_b128 v[56:59], v10 offset:4096
    ds_read_b64_tr_b16 v[40:41], v4 offset:16384
    ds_read_b64_tr_b16 v[42:43], v4 offset:17408
    ds_read_b128 v[60:63], v10 offset:6144
    ds_read_b64_tr_b16 v[44:45], v5 offset:16384
    ds_read_b64_tr_b16 v[46:47], v5 offset:17408
    ds_read_b128 v[96:99], v204 offset:0
    ds_read_b128 v[100:103], v204 offset:4096
    s_add_u32 m0, s62, 65536
    s_nop 0
    buffer_load_dwordx4 v240, s[32:35], s60 offen offset:0 lds
    buffer_load_dwordx4 v241, s[32:35], s60 offen offset:1024 lds
    buffer_load_dwordx4 v242, s[32:35], s60 offen offset:2048 lds
    buffer_load_dwordx4 v243, s[32:35], s60 offen offset:3072 lds
    s_waitcnt lgkmcnt(0)
    v_mfma_f32_16x16x32_bf16 v[128:131], v[32:35], v[48:51], 0
    ds_read_b128 v[80:83], v11 offset:0
    buffer_store_dwordx4 v[96:99], v205, s[36:39], s59 offen sc1
    v_mfma_f32_16x16x32_bf16 v[132:135], v[32:35], v[52:55], 0
    ds_read_b64_tr_b16 v[64:65], v2 offset:24576
    buffer_store_dwordx4 v[100:103], v206, s[36:39], s59 offen sc1
    v_mfma_f32_16x16x32_bf16 v[136:139], v[32:35], v[56:59], 0
    ds_read_b64_tr_b16 v[66:67], v2 offset:25600
    v_mfma_f32_16x16x32_bf16 v[140:143], v[32:35], v[60:63], 0
    ds_read_b128 v[84:87], v11 offset:2048
    v_mfma_f32_16x16x32_bf16 v[192:195], v[32:35], v[20:23], 0
    ds_read_b64_tr_b16 v[68:69], v3 offset:24576
    v_mfma_f32_16x16x32_bf16 v[144:147], v[36:39], v[48:51], 0
    ds_read_b64_tr_b16 v[70:71], v3 offset:25600
    s_add_u32 m0, s62, 81920
    v_mfma_f32_16x16x32_bf16 v[148:151], v[36:39], v[52:55], 0
    ds_read_b128 v[88:91], v11 offset:4096
    v_mfma_f32_16x16x32_bf16 v[152:155], v[36:39], v[56:59], 0
    ds_read_b64_tr_b16 v[72:73], v4 offset:24576
    buffer_load_dwordx4 v244, s[40:43], s61 offen offset:0 lds
    v_mfma_f32_16x16x32_bf16 v[156:159], v[36:39], v[60:63], 0
    ds_read_b64_tr_b16 v[74:75], v4 offset:25600
    v_mfma_f32_16x16x32_bf16 v[196:199], v[36:39], v[20:23], 0
    ds_read_b128 v[92:95], v11 offset:6144
    v_mfma_f32_16x16x32_bf16 v[160:163], v[40:43], v[48:51], 0
    ds_read_b64_tr_b16 v[76:77], v5 offset:24576
    buffer_load_dwordx4 v245, s[40:43], s61 offen offset:1024 lds
    v_mfma_f32_16x16x32_bf16 v[164:167], v[40:43], v[52:55], 0
    ds_read_b64_tr_b16 v[78:79], v5 offset:25600
    v_mfma_f32_16x16x32_bf16 v[168:171], v[40:43], v[56:59], 0
    v_mfma_f32_16x16x32_bf16 v[172:175], v[40:43], v[60:63], 0
    buffer_load_dwordx4 v246, s[40:43], s61 offen offset:2048 lds
    v_mfma_f32_16x16x32_bf16 v[176:179], v[44:47], v[48:51], 0
    v_mfma_f32_16x16x32_bf16 v[180:183], v[44:47], v[52:55], 0
    buffer_load_dwordx4 v247, s[40:43], s61 offen offset:3072 lds
    s_bitcmp1_b32 s0, 2
    s_cselect_b32 s87, s85, 128
    s_cselect_b32 s88, s86, 221184
    v_mfma_f32_16x16x32_bf16 v[184:187], v[44:47], v[56:59], 0
    s_add_u32 s60, s60, s87
    v_mfma_f32_16x16x32_bf16 v[188:191], v[44:47], v[60:63], 0
    s_add_u32 s61, s61, s88
    s_waitcnt vmcnt(11) lgkmcnt(0)
    s_barrier
    s_nop 0
    v_mfma_f32_16x16x32_bf16 v[128:131], v[64:67], v[80:83], v[128:131]
    ds_read_b128 v[48:51], v10 offset:32768
    s_add_u32 m0, s62, 98304
    v_mfma_f32_16x16x32_bf16 v[132:135], v[64:67], v[84:87], v[132:135]
    ds_read_b64_tr_b16 v[32:33], v2 offset:49152
    v_mov_b32 v30, 17563648
    v_mfma_f32_16x16x32_bf16 v[136:139], v[64:67], v[88:91], v[136:139]
    ds_read_b64_tr_b16 v[34:35], v2 offset:50176
    buffer_load_dwordx4 v240, s[32:35], s60 offen offset:0 lds
    v_mfma_f32_16x16x32_bf16 v[140:143], v[64:67], v[92:95], v[140:143]
    ds_read_b128 v[52:55], v10 offset:34816
    s_cmp_eq_u32 s3, 0
    s_nop 0
    s_cselect_b32 s80, s84, 17563648
    v_mfma_f32_16x16x32_bf16 v[192:195], v[64:67], v[20:23], v[192:195]
    ds_read_b64_tr_b16 v[36:37], v3 offset:49152
    v_mfma_f32_16x16x32_bf16 v[144:147], v[68:71], v[80:83], v[144:147]
    ds_read_b64_tr_b16 v[38:39], v3 offset:50176
    v_mfma_f32_16x16x32_bf16 v[148:151], v[68:71], v[84:87], v[148:151]
    ds_read_b128 v[56:59], v10 offset:36864
    buffer_load_dwordx4 v241, s[32:35], s60 offen offset:1024 lds
    v_mfma_f32_16x16x32_bf16 v[152:155], v[68:71], v[88:91], v[152:155]
    ds_read_b64_tr_b16 v[40:41], v4 offset:49152
    v_writelane_b32 v30, s80, 1
    v_mfma_f32_16x16x32_bf16 v[156:159], v[68:71], v[92:95], v[156:159]
    ds_read_b64_tr_b16 v[42:43], v4 offset:50176
    v_mfma_f32_16x16x32_bf16 v[196:199], v[68:71], v[20:23], v[196:199]
    ds_read_b128 v[60:63], v10 offset:38912
    s_lshl_b32 s77, s57, 1
    v_mfma_f32_16x16x32_bf16 v[160:163], v[72:75], v[80:83], v[160:163]
    ds_read_b64_tr_b16 v[44:45], v5 offset:49152
    s_lshr_b32 s78, s58, 4
    v_mfma_f32_16x16x32_bf16 v[164:167], v[72:75], v[84:87], v[164:167]
    ds_read_b64_tr_b16 v[46:47], v5 offset:50176
    buffer_load_dwordx4 v242, s[32:35], s60 offen offset:2048 lds
    v_mfma_f32_16x16x32_bf16 v[168:171], v[72:75], v[88:91], v[168:171]
    s_add_u32 s77, s77, s78
    v_mfma_f32_16x16x32_bf16 v[172:175], v[72:75], v[92:95], v[172:175]
    s_lshl_b32 s77, s77, 4
    v_mfma_f32_16x16x32_bf16 v[176:179], v[76:79], v[80:83], v[176:179]
    s_and_b32 s78, s58, 15
    v_mfma_f32_16x16x32_bf16 v[180:183], v[76:79], v[84:87], v[180:183]
    buffer_load_dwordx4 v243, s[32:35], s60 offen offset:3072 lds
    s_add_u32 s77, s77, s78
    v_mfma_f32_16x16x32_bf16 v[184:187], v[76:79], v[88:91], v[184:187]
    s_lshl_b32 s77, s77, 6
    v_mfma_f32_16x16x32_bf16 v[188:191], v[76:79], v[92:95], v[188:191]
    s_add_u32 s77, s77, 196608
    s_waitcnt lgkmcnt(0)
    v_mfma_f32_16x16x32_bf16 v[128:131], v[32:35], v[48:51], v[128:131]
    ds_read_b128 v[80:83], v11 offset:32768
    s_add_u32 m0, s62, 114688
    v_mfma_f32_16x16x32_bf16 v[132:135], v[32:35], v[52:55], v[132:135]
    ds_read_b64_tr_b16 v[64:65], v2 offset:57344
    s_cmp_eq_u32 s3, 0
    s_nop 0
    s_cselect_b32 s77, s77, 17563648
    v_mfma_f32_16x16x32_bf16 v[136:139], v[32:35], v[56:59], v[136:139]
    ds_read_b64_tr_b16 v[66:67], v2 offset:58368
    buffer_load_dwordx4 v244, s[40:43], s61 offen offset:0 lds
    v_mfma_f32_16x16x32_bf16 v[140:143], v[32:35], v[60:63], v[140:143]
    ds_read_b128 v[84:87], v11 offset:34816
    v_mfma_f32_16x16x32_bf16 v[192:195], v[32:35], v[20:23], v[192:195]
    ds_read_b64_tr_b16 v[68:69], v3 offset:57344
    v_writelane_b32 v30, s77, 0
    v_mfma_f32_16x16x32_bf16 v[144:147], v[36:39], v[48:51], v[144:147]
    ds_read_b64_tr_b16 v[70:71], v3 offset:58368
    s_and_b32 s77, s58, 7
    v_mfma_f32_16x16x32_bf16 v[148:151], v[36:39], v[52:55], v[148:151]
    ds_read_b128 v[88:91], v11 offset:36864
    buffer_load_dwordx4 v245, s[40:43], s61 offen offset:1024 lds
    v_mfma_f32_16x16x32_bf16 v[152:155], v[36:39], v[56:59], v[152:155]
    ds_read_b64_tr_b16 v[72:73], v4 offset:57344
    s_lshl_b32 s77, s77, 5
    v_mfma_f32_16x16x32_bf16 v[156:159], v[36:39], v[60:63], v[156:159]
    ds_read_b64_tr_b16 v[74:75], v4 offset:58368
    s_lshl_b32 s78, s57, 2
    v_mfma_f32_16x16x32_bf16 v[196:199], v[36:39], v[20:23], v[196:199]
    ds_read_b128 v[92:95], v11 offset:38912
    s_lshr_b32 s79, s58, 3
    v_mfma_f32_16x16x32_bf16 v[160:163], v[40:43], v[48:51], v[160:163]
    ds_read_b64_tr_b16 v[76:77], v5 offset:57344
    buffer_load_dwordx4 v246, s[40:43], s61 offen offset:2048 lds
    v_mfma_f32_16x16x32_bf16 v[164:167], v[40:43], v[52:55], v[164:167]
    ds_read_b64_tr_b16 v[78:79], v5 offset:58368
    s_add_u32 s78, s78, s79
    v_mfma_f32_16x16x32_bf16 v[168:171], v[40:43], v[56:59], v[168:171]
    s_add_u32 s77, s77, s78
    s_lshl_b32 s77, s77, 6
    v_mfma_f32_16x16x32_bf16 v[172:175], v[40:43], v[60:63], v[172:175]
    buffer_load_dwordx4 v247, s[40:43], s61 offen offset:3072 lds
    s_add_u32 s77, s77, 163840
    v_mfma_f32_16x16x32_bf16 v[176:179], v[44:47], v[48:51], v[176:179]
    s_cmp_eq_u32 s3, 0
    s_cselect_b32 s77, s77, 17563648
    v_mfma_f32_16x16x32_bf16 v[180:183], v[44:47], v[52:55], v[180:183]
    s_bitcmp1_b32 s0, 3
    s_cselect_b32 s87, s85, 128
    s_cselect_b32 s88, s86, 221184
    v_mfma_f32_16x16x32_bf16 v[184:187], v[44:47], v[56:59], v[184:187]
    s_add_u32 s60, s60, s87
    v_writelane_b32 v30, s77, 2
    v_mfma_f32_16x16x32_bf16 v[188:191], v[44:47], v[60:63], v[188:191]
    s_add_u32 s61, s61, s88
    s_waitcnt vmcnt(8) lgkmcnt(0)
    s_barrier
    s_mov_b32 exec_lo, 3
    s_mov_b32 exec_hi, 0
    buffer_store_dword v31, v30, s[36:39], 0 offen sc1
    s_mov_b64 exec, -1
    v_mfma_f32_16x16x32_bf16 v[128:131], v[64:67], v[80:83], v[128:131]
    ds_read_b128 v[48:51], v12 offset:0
    s_lshl_b32 m0, s3, 10
    s_add_u32 m0, m0, 139776
    s_nop 0
    buffer_load_dwordx4 v253, s[44:47], 0 offen nt lds
    v_mfma_f32_16x16x32_bf16 v[132:135], v[64:67], v[84:87], v[132:135]
    ds_read_b64_tr_b16 v[32:33], v6 offset:16384
    s_lshl_b32 m0, s3, 10
    s_add_u32 m0, m0, 143872
    s_nop 0
    buffer_load_dwordx4 v254, s[44:47], 0 offen nt lds
    v_mfma_f32_16x16x32_bf16 v[136:139], v[64:67], v[88:91], v[136:139]
    ds_read_b64_tr_b16 v[34:35], v6 offset:17408
    s_lshl_b32 m0, s3, 10
    s_add_u32 m0, m0, 147968
    s_nop 0
    buffer_load_dwordx4 v255, s[44:47], 0 offen nt lds
    v_mfma_f32_16x16x32_bf16 v[140:143], v[64:67], v[92:95], v[140:143]
    ds_read_b128 v[52:55], v12 offset:2048
    v_min_u32_e64 v28, 15, v0
    v_mfma_f32_16x16x32_bf16 v[192:195], v[64:67], v[20:23], v[192:195]
    ds_read_b64_tr_b16 v[36:37], v7 offset:16384
    v_mfma_f32_16x16x32_bf16 v[144:147], v[68:71], v[80:83], v[144:147]
    ds_read_b64_tr_b16 v[38:39], v7 offset:17408
    s_add_u32 m0, s62, 0
    v_mfma_f32_16x16x32_bf16 v[148:151], v[68:71], v[84:87], v[148:151]
    ds_read_b128 v[56:59], v12 offset:4096
    v_lshlrev_b32 v28, 6, v28
    v_mfma_f32_16x16x32_bf16 v[152:155], v[68:71], v[88:91], v[152:155]
    ds_read_b64_tr_b16 v[40:41], v8 offset:16384
    buffer_load_dwordx4 v240, s[32:35], s60 offen offset:0 lds
    v_mfma_f32_16x16x32_bf16 v[156:159], v[68:71], v[92:95], v[156:159]
    ds_read_b64_tr_b16 v[42:43], v8 offset:17408
    v_mfma_f32_16x16x32_bf16 v[196:199], v[68:71], v[20:23], v[196:199]
    ds_read_b128 v[60:63], v12 offset:6144
    v_mfma_f32_16x16x32_bf16 v[160:163], v[72:75], v[80:83], v[160:163]
    ds_read_b64_tr_b16 v[44:45], v9 offset:16384
    buffer_load_dwordx4 v241, s[32:35], s60 offen offset:1024 lds
    v_mfma_f32_16x16x32_bf16 v[164:167], v[72:75], v[84:87], v[164:167]
    ds_read_b64_tr_b16 v[46:47], v9 offset:17408
    s_lshl_b32 s73, s63, 10
    v_mfma_f32_16x16x32_bf16 v[168:171], v[72:75], v[88:91], v[168:171]
    v_mfma_f32_16x16x32_bf16 v[172:175], v[72:75], v[92:95], v[172:175]
    buffer_load_dwordx4 v242, s[32:35], s60 offen offset:2048 lds
    s_add_u32 s73, s73, 196608
    v_mfma_f32_16x16x32_bf16 v[176:179], v[76:79], v[80:83], v[176:179]
    v_add_u32 v28, s73, v28
    v_mfma_f32_16x16x32_bf16 v[180:183], v[76:79], v[84:87], v[180:183]
    buffer_load_dwordx4 v243, s[32:35], s60 offen offset:3072 lds
    v_mfma_f32_16x16x32_bf16 v[184:187], v[76:79], v[88:91], v[184:187]
    s_mov_b32 s48, s20
    v_mfma_f32_16x16x32_bf16 v[188:191], v[76:79], v[92:95], v[188:191]
    s_waitcnt lgkmcnt(0)
    v_mfma_f32_16x16x32_bf16 v[128:131], v[32:35], v[48:51], v[128:131]
    ds_read_b128 v[80:83], v13 offset:0
    s_add_u32 m0, s62, 16384
    v_mfma_f32_16x16x32_bf16 v[132:135], v[32:35], v[52:55], v[132:135]
    ds_read_b64_tr_b16 v[64:65], v6 offset:24576
    s_mov_b32 s49, s21
    s_nop 0
    v_mfma_f32_16x16x32_bf16 v[136:139], v[32:35], v[56:59], v[136:139]
    ds_read_b64_tr_b16 v[66:67], v6 offset:25600
    buffer_load_dwordx4 v244, s[40:43], s61 offen offset:0 lds
    v_mfma_f32_16x16x32_bf16 v[140:143], v[32:35], v[60:63], v[140:143]
    ds_read_b128 v[84:87], v13 offset:2048
    v_mfma_f32_16x16x32_bf16 v[192:195], v[32:35], v[20:23], v[192:195]
    ds_read_b64_tr_b16 v[68:69], v7 offset:24576
    s_mov_b32 s50, 3456
    v_mfma_f32_16x16x32_bf16 v[144:147], v[36:39], v[48:51], v[144:147]
    ds_read_b64_tr_b16 v[70:71], v7 offset:25600
    v_mfma_f32_16x16x32_bf16 v[148:151], v[36:39], v[52:55], v[148:151]
    ds_read_b128 v[88:91], v13 offset:4096
    buffer_load_dwordx4 v245, s[40:43], s61 offen offset:1024 lds
    v_mfma_f32_16x16x32_bf16 v[152:155], v[36:39], v[56:59], v[152:155]
    ds_read_b64_tr_b16 v[72:73], v8 offset:24576
    v_mfma_f32_16x16x32_bf16 v[156:159], v[36:39], v[60:63], v[156:159]
    ds_read_b64_tr_b16 v[74:75], v8 offset:25600
    s_mov_b32 s51, 0x20000
    v_mfma_f32_16x16x32_bf16 v[196:199], v[36:39], v[20:23], v[196:199]
    ds_read_b128 v[92:95], v13 offset:6144
    v_mfma_f32_16x16x32_bf16 v[160:163], v[40:43], v[48:51], v[160:163]
    ds_read_b64_tr_b16 v[76:77], v9 offset:24576
    buffer_load_dwordx4 v246, s[40:43], s61 offen offset:2048 lds
    v_mfma_f32_16x16x32_bf16 v[164:167], v[40:43], v[52:55], v[164:167]
    ds_read_b64_tr_b16 v[78:79], v9 offset:25600
    v_lshrrev_b32 v24, 4, v0
    v_mfma_f32_16x16x32_bf16 v[168:171], v[40:43], v[56:59], v[168:171]
    v_mfma_f32_16x16x32_bf16 v[172:175], v[40:43], v[60:63], v[172:175]
    buffer_load_dwordx4 v247, s[40:43], s61 offen offset:3072 lds
    s_lshl_b32 s73, s69, 5
    v_mfma_f32_16x16x32_bf16 v[176:179], v[44:47], v[48:51], v[176:179]
    v_lshl_add_u32 v232, v24, 3, s73
    v_mfma_f32_16x16x32_bf16 v[180:183], v[44:47], v[52:55], v[180:183]
    s_bitcmp1_b32 s0, 4
    s_cselect_b32 s87, s85, 128
    s_cselect_b32 s88, s86, 221184
    v_mfma_f32_16x16x32_bf16 v[184:187], v[44:47], v[56:59], v[184:187]
    s_add_u32 s60, s60, s87
    v_mfma_f32_16x16x32_bf16 v[188:191], v[44:47], v[60:63], v[188:191]
    s_add_u32 s61, s61, s88
    s_waitcnt vmcnt(12) lgkmcnt(0)
    s_barrier
    v_mfma_f32_16x16x32_bf16 v[128:131], v[64:67], v[80:83], v[128:131]
    ds_read_b128 v[48:51], v12 offset:32768
    s_add_u32 m0, s62, 32768
    v_mfma_f32_16x16x32_bf16 v[132:135], v[64:67], v[84:87], v[132:135]
    ds_read_b64_tr_b16 v[32:33], v6 offset:49152
    s_lshl_b32 s73, s70, 5
    v_mfma_f32_16x16x32_bf16 v[136:139], v[64:67], v[88:91], v[136:139]
    ds_read_b64_tr_b16 v[34:35], v6 offset:50176
    buffer_load_dwordx4 v240, s[32:35], s60 offen offset:0 lds
    v_mfma_f32_16x16x32_bf16 v[140:143], v[64:67], v[92:95], v[140:143]
    ds_read_b128 v[52:55], v12 offset:34816
    v_mfma_f32_16x16x32_bf16 v[192:195], v[64:67], v[20:23], v[192:195]
    ds_read_b64_tr_b16 v[36:37], v7 offset:49152
    v_mfma_f32_16x16x32_bf16 v[144:147], v[68:71], v[80:83], v[144:147]
    ds_read_b64_tr_b16 v[38:39], v7 offset:50176
    v_lshl_add_u32 v233, v24, 3, s73
    v_mfma_f32_16x16x32_bf16 v[148:151], v[68:71], v[84:87], v[148:151]
    ds_read_b128 v[56:59], v12 offset:36864
    buffer_load_dwordx4 v241, s[32:35], s60 offen offset:1024 lds
    v_mfma_f32_16x16x32_bf16 v[152:155], v[68:71], v[88:91], v[152:155]
    ds_read_b64_tr_b16 v[40:41], v8 offset:49152
    v_mfma_f32_16x16x32_bf16 v[156:159], v[68:71], v[92:95], v[156:159]
    ds_read_b64_tr_b16 v[42:43], v8 offset:50176
    v_mfma_f32_16x16x32_bf16 v[196:199], v[68:71], v[20:23], v[196:199]
    ds_read_b128 v[60:63], v12 offset:38912
    s_lshl_b32 s73, s71, 5
    v_mfma_f32_16x16x32_bf16 v[160:163], v[72:75], v[80:83], v[160:163]
    ds_read_b64_tr_b16 v[44:45], v9 offset:49152
    v_mfma_f32_16x16x32_bf16 v[164:167], v[72:75], v[84:87], v[164:167]
    ds_read_b64_tr_b16 v[46:47], v9 offset:50176
    buffer_load_dwordx4 v242, s[32:35], s60 offen offset:2048 lds
    v_mfma_f32_16x16x32_bf16 v[168:171], v[72:75], v[88:91], v[168:171]
    v_lshl_add_u32 v234, v24, 3, s73
    v_mfma_f32_16x16x32_bf16 v[172:175], v[72:75], v[92:95], v[172:175]
    v_mfma_f32_16x16x32_bf16 v[176:179], v[76:79], v[80:83], v[176:179]
    s_lshl_b32 s73, s72, 5
    v_mfma_f32_16x16x32_bf16 v[180:183], v[76:79], v[84:87], v[180:183]
    buffer_load_dwordx4 v243, s[32:35], s60 offen offset:3072 lds
    v_mfma_f32_16x16x32_bf16 v[184:187], v[76:79], v[88:91], v[184:187]
    v_lshl_add_u32 v235, v24, 3, s73
    v_mfma_f32_16x16x32_bf16 v[188:191], v[76:79], v[92:95], v[188:191]
    s_waitcnt lgkmcnt(0)
    v_mfma_f32_16x16x32_bf16 v[128:131], v[32:35], v[48:51], v[128:131]
    ds_read_b128 v[80:83], v13 offset:32768
    s_add_u32 m0, s62, 49152
    v_mfma_f32_16x16x32_bf16 v[132:135], v[32:35], v[52:55], v[132:135]
    ds_read_b64_tr_b16 v[64:65], v6 offset:57344
    s_lshr_b32 s78, s57, 1
    v_mfma_f32_16x16x32_bf16 v[136:139], v[32:35], v[56:59], v[136:139]
    ds_read_b64_tr_b16 v[66:67], v6 offset:58368
    buffer_load_dwordx4 v244, s[40:43], s61 offen offset:0 lds
    v_mfma_f32_16x16x32_bf16 v[140:143], v[32:35], v[60:63], v[140:143]
    ds_read_b128 v[84:87], v13 offset:34816
    v_mfma_f32_16x16x32_bf16 v[192:195], v[32:35], v[20:23], v[192:195]
    ds_read_b64_tr_b16 v[68:69], v7 offset:57344
    s_lshl_b32 s78, s78, 3
    s_nop 0
    v_mfma_f32_16x16x32_bf16 v[144:147], v[36:39], v[48:51], v[144:147]
    ds_read_b64_tr_b16 v[70:71], v7 offset:58368
    v_mfma_f32_16x16x32_bf16 v[148:151], v[36:39], v[52:55], v[148:151]
    ds_read_b128 v[88:91], v13 offset:36864
    buffer_load_dwordx4 v245, s[40:43], s61 offen offset:1024 lds
    v_mfma_f32_16x16x32_bf16 v[152:155], v[36:39], v[56:59], v[152:155]
    ds_read_b64_tr_b16 v[72:73], v8 offset:57344
    v_mfma_f32_16x16x32_bf16 v[156:159], v[36:39], v[60:63], v[156:159]
    ds_read_b64_tr_b16 v[74:75], v8 offset:58368
    s_and_b32 s79, s58, 7
    v_mfma_f32_16x16x32_bf16 v[196:199], v[36:39], v[20:23], v[196:199]
    ds_read_b128 v[92:95], v13 offset:38912
    v_mfma_f32_16x16x32_bf16 v[160:163], v[40:43], v[48:51], v[160:163]
    ds_read_b64_tr_b16 v[76:77], v9 offset:57344
    buffer_load_dwordx4 v246, s[40:43], s61 offen offset:2048 lds
    v_mfma_f32_16x16x32_bf16 v[164:167], v[40:43], v[52:55], v[164:167]
    ds_read_b64_tr_b16 v[78:79], v9 offset:58368
    s_add_u32 s53, s78, s79
    v_mfma_f32_16x16x32_bf16 v[168:171], v[40:43], v[56:59], v[168:171]
    v_mfma_f32_16x16x32_bf16 v[172:175], v[40:43], v[60:63], v[172:175]
    buffer_load_dwordx4 v247, s[40:43], s61 offen offset:3072 lds
    s_mul_i32 s28, s79, 7
    v_mfma_f32_16x16x32_bf16 v[176:179], v[44:47], v[48:51], v[176:179]
    s_and_b32 s78, s57, 1
    v_mfma_f32_16x16x32_bf16 v[180:183], v[44:47], v[52:55], v[180:183]
    s_bitcmp1_b32 s0, 5
    s_cselect_b32 s87, s85, 128
    s_cselect_b32 s88, s86, 221184
    v_mfma_f32_16x16x32_bf16 v[184:187], v[44:47], v[56:59], v[184:187]
    s_add_u32 s60, s60, s87
    v_mfma_f32_16x16x32_bf16 v[188:191], v[44:47], v[60:63], v[188:191]
    s_add_u32 s61, s61, s88
    s_waitcnt vmcnt(8) lgkmcnt(0)
    s_barrier
    v_mfma_f32_16x16x32_bf16 v[128:131], v[64:67], v[80:83], v[128:131]
    ds_read_b128 v[48:51], v10 offset:0
    s_add_u32 m0, s62, 65536
    v_mfma_f32_16x16x32_bf16 v[132:135], v[64:67], v[84:87], v[132:135]
    ds_read_b64_tr_b16 v[32:33], v2 offset:16384
    s_lshl_b32 s78, s78, 2
    v_mfma_f32_16x16x32_bf16 v[136:139], v[64:67], v[88:91], v[136:139]
    ds_read_b64_tr_b16 v[34:35], v2 offset:17408
    buffer_load_dwordx4 v240, s[32:35], s60 offen offset:0 lds
    v_mfma_f32_16x16x32_bf16 v[140:143], v[64:67], v[92:95], v[140:143]
    ds_read_b128 v[52:55], v10 offset:2048
    v_mfma_f32_16x16x32_bf16 v[192:195], v[64:67], v[20:23], v[192:195]
    ds_read_b64_tr_b16 v[36:37], v3 offset:16384
    s_lshr_b32 s79, s58, 3
    v_mfma_f32_16x16x32_bf16 v[144:147], v[68:71], v[80:83], v[144:147]
    ds_read_b64_tr_b16 v[38:39], v3 offset:17408
    v_mfma_f32_16x16x32_bf16 v[148:151], v[68:71], v[84:87], v[148:151]
    ds_read_b128 v[56:59], v10 offset:4096
    buffer_load_dwordx4 v241, s[32:35], s60 offen offset:1024 lds
    v_mfma_f32_16x16x32_bf16 v[152:155], v[68:71], v[88:91], v[152:155]
    ds_read_b64_tr_b16 v[40:41], v4 offset:16384
    s_add_u32 s54, s78, s79
    v_mfma_f32_16x16x32_bf16 v[156:159], v[68:71], v[92:95], v[156:159]
    ds_read_b64_tr_b16 v[42:43], v4 offset:17408
    v_mfma_f32_16x16x32_bf16 v[196:199], v[68:71], v[20:23], v[196:199]
    ds_read_b128 v[60:63], v10 offset:6144
    s_mul_i32 s79, s79, 14
    v_mfma_f32_16x16x32_bf16 v[160:163], v[72:75], v[80:83], v[160:163]
    ds_read_b64_tr_b16 v[44:45], v5 offset:16384
    v_mfma_f32_16x16x32_bf16 v[164:167], v[72:75], v[84:87], v[164:167]
    ds_read_b64_tr_b16 v[46:47], v5 offset:17408
    buffer_load_dwordx4 v242, s[32:35], s60 offen offset:2048 lds
    v_mfma_f32_16x16x32_bf16 v[168:171], v[72:75], v[88:91], v[168:171]
    ds_read_b64_tr_b16 v[216:217], v200 offset:0
    s_add_u32 s28, s28, s79
    v_mfma_f32_16x16x32_bf16 v[172:175], v[72:75], v[92:95], v[172:175]
    ds_read_b64_tr_b16 v[218:219], v200 offset:2560
    v_mfma_f32_16x16x32_bf16 v[176:179], v[76:79], v[80:83], v[176:179]
    ds_read_b64_tr_b16 v[220:221], v201 offset:0
    s_lshr_b32 s28, s28, 2
    v_mfma_f32_16x16x32_bf16 v[180:183], v[76:79], v[84:87], v[180:183]
    ds_read_b64_tr_b16 v[222:223], v201 offset:2560
    buffer_load_dwordx4 v243, s[32:35], s60 offen offset:3072 lds
    v_mfma_f32_16x16x32_bf16 v[184:187], v[76:79], v[88:91], v[184:187]
    ds_read_b64_tr_b16 v[224:225], v202 offset:0
    v_mfma_f32_16x16x32_bf16 v[188:191], v[76:79], v[92:95], v[188:191]
    ds_read_b64_tr_b16 v[226:227], v202 offset:2560
    s_waitcnt lgkmcnt(0)
    v_mfma_f32_16x16x32_bf16 v[128:131], v[32:35], v[48:51], v[128:131]
    ds_read_b128 v[80:83], v11 offset:0
    buffer_store_dwordx4 v[216:219], v14, s[36:39], s74 offen sc1
    v_mfma_f32_16x16x32_bf16 v[132:135], v[32:35], v[52:55], v[132:135]
    ds_read_b64_tr_b16 v[64:65], v2 offset:24576
    buffer_store_dwordx4 v[220:223], v14, s[36:39], s75 offen sc1
    v_mfma_f32_16x16x32_bf16 v[136:139], v[32:35], v[56:59], v[136:139]
    ds_read_b64_tr_b16 v[66:67], v2 offset:25600
    buffer_store_dwordx4 v[224:227], v14, s[36:39], s76 offen sc1
    v_mfma_f32_16x16x32_bf16 v[140:143], v[32:35], v[60:63], v[140:143]
    ds_read_b128 v[84:87], v11 offset:2048
    s_cmp_ge_u32 s28, 14
    s_cselect_b32 s79, 14, 0
    v_mfma_f32_16x16x32_bf16 v[192:195], v[32:35], v[20:23], v[192:195]
    ds_read_b64_tr_b16 v[68:69], v3 offset:24576
    v_mfma_f32_16x16x32_bf16 v[144:147], v[36:39], v[48:51], v[144:147]
    ds_read_b64_tr_b16 v[70:71], v3 offset:25600
    s_add_u32 m0, s62, 81920
    v_mfma_f32_16x16x32_bf16 v[148:151], v[36:39], v[52:55], v[148:151]
    ds_read_b128 v[88:91], v11 offset:4096
    s_sub_u32 s28, s28, s79
    v_mfma_f32_16x16x32_bf16 v[152:155], v[36:39], v[56:59], v[152:155]
    ds_read_b64_tr_b16 v[72:73], v4 offset:24576
    buffer_load_dwordx4 v244, s[40:43], s61 offen offset:0 lds
    v_mfma_f32_16x16x32_bf16 v[156:159], v[36:39], v[60:63], v[156:159]
    ds_read_b64_tr_b16 v[74:75], v4 offset:25600
    v_mfma_f32_16x16x32_bf16 v[196:199], v[36:39], v[20:23], v[196:199]
    ds_read_b128 v[92:95], v11 offset:6144
    s_mov_b32 s28, 0
    v_mfma_f32_16x16x32_bf16 v[160:163], v[40:43], v[48:51], v[160:163]
    ds_read_b64_tr_b16 v[76:77], v5 offset:24576
    buffer_load_dwordx4 v245, s[40:43], s61 offen offset:1024 lds
    v_mfma_f32_16x16x32_bf16 v[164:167], v[40:43], v[52:55], v[164:167]
    ds_read_b64_tr_b16 v[78:79], v5 offset:25600
    s_mul_i32 s55, s3, 14
    v_mfma_f32_16x16x32_bf16 v[168:171], v[40:43], v[56:59], v[168:171]
    s_sub_u32 s79, s3, 1
    v_mfma_f32_16x16x32_bf16 v[172:175], v[40:43], v[60:63], v[172:175]
    buffer_load_dwordx4 v246, s[40:43], s61 offen offset:2048 lds
    s_cmp_ge_u32 s3, 2
    s_cselect_b32 s79, s79, 0
    v_mfma_f32_16x16x32_bf16 v[176:179], v[44:47], v[48:51], v[176:179]
    v_mfma_f32_16x16x32_bf16 v[180:183], v[44:47], v[52:55], v[180:183]
    buffer_load_dwordx4 v247, s[40:43], s61 offen offset:3072 lds
    s_bitcmp1_b32 s0, 6
    s_cselect_b32 s87, s85, 128
    s_cselect_b32 s88, s86, 221184
    v_mfma_f32_16x16x32_bf16 v[184:187], v[44:47], v[56:59], v[184:187]
    s_add_u32 s60, s60, s87
    s_sub_u32 s55, s55, s79
    v_mfma_f32_16x16x32_bf16 v[188:191], v[44:47], v[60:63], v[188:191]
    s_add_u32 s61, s61, s88
    s_waitcnt vmcnt(11) lgkmcnt(0)
    s_barrier
    v_mfma_f32_16x16x32_bf16 v[128:131], v[64:67], v[80:83], v[128:131]
    ds_read_b128 v[48:51], v10 offset:32768
    s_add_u32 m0, s62, 98304
    v_mfma_f32_16x16x32_bf16 v[132:135], v[64:67], v[84:87], v[132:135]
    ds_read_b64_tr_b16 v[32:33], v2 offset:49152
    s_mul_i32 s79, s54, 54
    s_nop 0
    v_mfma_f32_16x16x32_bf16 v[136:139], v[64:67], v[88:91], v[136:139]
    ds_read_b64_tr_b16 v[34:35], v2 offset:50176
    buffer_load_dwordx4 v240, s[32:35], s60 offen offset:0 lds
    v_mfma_f32_16x16x32_bf16 v[140:143], v[64:67], v[92:95], v[140:143]
    ds_read_b128 v[52:55], v10 offset:34816
    v_mfma_f32_16x16x32_bf16 v[192:195], v[64:67], v[20:23], v[192:195]
    ds_read_b64_tr_b16 v[36:37], v3 offset:49152
    v_mfma_f32_16x16x32_bf16 v[144:147], v[68:71], v[80:83], v[144:147]
    ds_read_b64_tr_b16 v[38:39], v3 offset:50176
    s_add_u32 s79, s79, s55
    s_nop 0
    v_mfma_f32_16x16x32_bf16 v[148:151], v[68:71], v[84:87], v[148:151]
    ds_read_b128 v[56:59], v10 offset:36864
    buffer_load_dwordx4 v241, s[32:35], s60 offen offset:1024 lds
    v_mfma_f32_16x16x32_bf16 v[152:155], v[68:71], v[88:91], v[152:155]
    ds_read_b64_tr_b16 v[40:41], v4 offset:49152
    v_mfma_f32_16x16x32_bf16 v[156:159], v[68:71], v[92:95], v[156:159]
    ds_read_b64_tr_b16 v[42:43], v4 offset:50176
    v_mfma_f32_16x16x32_bf16 v[196:199], v[68:71], v[20:23], v[196:199]
    ds_read_b128 v[60:63], v10 offset:38912
    s_mul_i32 s79, s79, 5120
    v_mfma_f32_16x16x32_bf16 v[160:163], v[72:75], v[80:83], v[160:163]
    ds_read_b64_tr_b16 v[44:45], v5 offset:49152
    v_mfma_f32_16x16x32_bf16 v[164:167], v[72:75], v[84:87], v[164:167]
    ds_read_b64_tr_b16 v[46:47], v5 offset:50176
    buffer_load_dwordx4 v242, s[32:35], s60 offen offset:2048 lds
    v_mfma_f32_16x16x32_bf16 v[168:171], v[72:75], v[88:91], v[168:171]
    s_add_u32 s79, s79, 4194304
    v_mfma_f32_16x16x32_bf16 v[172:175], v[72:75], v[92:95], v[172:175]
    v_mfma_f32_16x16x32_bf16 v[176:179], v[76:79], v[80:83], v[176:179]
    s_add_u32 s16, s79, 71680
    v_mfma_f32_16x16x32_bf16 v[180:183], v[76:79], v[84:87], v[180:183]
    buffer_load_dwordx4 v243, s[32:35], s60 offen offset:3072 lds
    v_mfma_f32_16x16x32_bf16 v[184:187], v[76:79], v[88:91], v[184:187]
    s_mul_i32 s52, s28, 5120
    v_mfma_f32_16x16x32_bf16 v[188:191], v[76:79], v[92:95], v[188:191]
    s_waitcnt lgkmcnt(0)
    v_mfma_f32_16x16x32_bf16 v[128:131], v[32:35], v[48:51], v[128:131]
    ds_read_b128 v[80:83], v11 offset:32768
    s_add_u32 m0, s62, 114688
    s_add_u32 s52, s52, s79
    v_mfma_f32_16x16x32_bf16 v[132:135], v[32:35], v[52:55], v[132:135]
    ds_read_b64_tr_b16 v[64:65], v2 offset:57344
    v_lshlrev_b32_e64 v14, 4, v0
    v_mfma_f32_16x16x32_bf16 v[136:139], v[32:35], v[56:59], v[136:139]
    ds_read_b64_tr_b16 v[66:67], v2 offset:58368
    buffer_load_dwordx4 v244, s[40:43], s61 offen offset:0 lds
    v_add_u32 v15, 4096, v14
    v_mfma_f32_16x16x32_bf16 v[140:143], v[32:35], v[60:63], v[140:143]
    ds_read_b128 v[84:87], v11 offset:34816
    s_mul_i32 s84, s57, 56
    v_mfma_f32_16x16x32_bf16 v[192:195], v[32:35], v[20:23], v[192:195]
    ds_read_b64_tr_b16 v[68:69], v3 offset:57344
    s_lshl_b32 s78, s58, 1
    v_mfma_f32_16x16x32_bf16 v[144:147], v[36:39], v[48:51], v[144:147]
    ds_read_b64_tr_b16 v[70:71], v3 offset:58368
    s_add_u32 s84, s84, s78
    v_mfma_f32_16x16x32_bf16 v[148:151], v[36:39], v[52:55], v[148:151]
    ds_read_b128 v[88:91], v11 offset:36864
    buffer_load_dwordx4 v245, s[40:43], s61 offen offset:1024 lds
    s_mul_i32 s1, s57, 28
PAGE2:
    s_cbranch_execz VISIT_RET
    v_mfma_f32_16x16x32_bf16 v[152:155], v[36:39], v[56:59], v[152:155]
    ds_read_b64_tr_b16 v[72:73], v4 offset:57344
    s_add_u32 s1, s1, s58
    v_mfma_f32_16x16x32_bf16 v[156:159], v[36:39], v[60:63], v[156:159]
    ds_read_b64_tr_b16 v[74:75], v4 offset:58368
    s_lshl_b32 s1, s1, 2
    v_mfma_f32_16x16x32_bf16 v[196:199], v[36:39], v[20:23], v[196:199]
    ds_read_b128 v[92:95], v11 offset:38912
    s_add_u32 s1, s1, s3
    v_mfma_f32_16x16x32_bf16 v[160:163], v[40:43], v[48:51], v[160:163]
    ds_read_b64_tr_b16 v[76:77], v5 offset:57344
    buffer_load_dwordx4 v246, s[40:43], s61 offen offset:2048 lds
    s_lshl_b32 s1, s1, 11
    v_mfma_f32_16x16x32_bf16 v[164:167], v[40:43], v[52:55], v[164:167]
    ds_read_b64_tr_b16 v[78:79], v5 offset:58368
    s_mov_b32 s80, s12
    v_mfma_f32_16x16x32_bf16 v[168:171], v[40:43], v[56:59], v[168:171]
    s_mov_b32 s81, s13
    s_mov_b32 s82, 2621440
    v_mfma_f32_16x16x32_bf16 v[172:175], v[40:43], v[60:63], v[172:175]
    buffer_load_dwordx4 v247, s[40:43], s61 offen offset:3072 lds
    s_mov_b32 s83, 0x20000
    v_mfma_f32_16x16x32_bf16 v[176:179], v[44:47], v[48:51], v[176:179]
    v_min_u32 v127, 15, v0
    v_mfma_f32_16x16x32_bf16 v[180:183], v[44:47], v[52:55], v[180:183]
    s_bitcmp1_b32 s0, 7
    s_cselect_b32 s87, s85, 128
    s_cselect_b32 s88, s86, 221184
    v_mfma_f32_16x16x32_bf16 v[184:187], v[44:47], v[56:59], v[184:187]
    s_add_u32 s60, s60, s87
    v_lshlrev_b32 v127, 7, v127
    v_mfma_f32_16x16x32_bf16 v[188:191], v[44:47], v[60:63], v[188:191]
    s_add_u32 s61, s61, s88
    buffer_load_dword v127, v127, s[80:83], s1 offen
    s_waitcnt vmcnt(9) lgkmcnt(0)
    s_barrier
    s_mov_b32 exec_lo, 4
    s_mov_b32 exec_hi, 0
    buffer_store_dword v31, v30, s[36:39], 0 offen sc1
    s_mov_b64 exec, -1
    v_mfma_f32_16x16x32_bf16 v[128:131], v[64:67], v[80:83], v[128:131]
    ds_read_b128 v[48:51], v12 offset:0
    s_add_u32 m0, s62, 0
    v_mfma_f32_16x16x32_bf16 v[132:135], v[64:67], v[84:87], v[132:135]
    ds_read_b64_tr_b16 v[32:33], v6 offset:16384
    s_lshr_b32 s77, s84, 6
    s_nop 0
    v_mfma_f32_16x16x32_bf16 v[136:139], v[64:67], v[88:91], v[136:139]
    ds_read_b64_tr_b16 v[34:35], v6 offset:17408
    buffer_load_dwordx4 v240, s[32:35], s60 offen offset:0 lds
    v_mfma_f32_16x16x32_bf16 v[140:143], v[64:67], v[92:95], v[140:143]
    ds_read_b128 v[52:55], v12 offset:2048
    v_mfma_f32_16x16x32_bf16 v[192:195], v[64:67], v[20:23], v[192:195]
    ds_read_b64_tr_b16 v[36:37], v7 offset:16384
    v_mfma_f32_16x16x32_bf16 v[144:147], v[68:71], v[80:83], v[144:147]
    ds_read_b64_tr_b16 v[38:39], v7 offset:17408
    v_and_b32_e64 v27, 31, v0
    v_mfma_f32_16x16x32_bf16 v[148:151], v[68:71], v[84:87], v[148:151]
    ds_read_b128 v[56:59], v12 offset:4096
    buffer_load_dwordx4 v241, s[32:35], s60 offen offset:1024 lds
    v_mfma_f32_16x16x32_bf16 v[152:155], v[68:71], v[88:91], v[152:155]
    ds_read_b64_tr_b16 v[40:41], v8 offset:16384
    v_mfma_f32_16x16x32_bf16 v[156:159], v[68:71], v[92:95], v[156:159]
    ds_read_b64_tr_b16 v[42:43], v8 offset:17408
    v_mfma_f32_16x16x32_bf16 v[196:199], v[68:71], v[20:23], v[196:199]
    ds_read_b128 v[60:63], v12 offset:6144
    v_lshlrev_b32_e64 v27, 6, v27
    v_mfma_f32_16x16x32_bf16 v[160:163], v[72:75], v[80:83], v[160:163]
    ds_read_b64_tr_b16 v[44:45], v9 offset:16384
    v_mfma_f32_16x16x32_bf16 v[164:167], v[72:75], v[84:87], v[164:167]
    ds_read_b64_tr_b16 v[46:47], v9 offset:17408
    buffer_load_dwordx4 v242, s[32:35], s60 offen offset:2048 lds
    v_mfma_f32_16x16x32_bf16 v[168:171], v[72:75], v[88:91], v[168:171]
    s_lshl_b32 s73, s77, 11
    v_mfma_f32_16x16x32_bf16 v[172:175], v[72:75], v[92:95], v[172:175]
    v_mfma_f32_16x16x32_bf16 v[176:179], v[76:79], v[80:83], v[176:179]
    s_add_u32 s73, s73, 131072
    v_mfma_f32_16x16x32_bf16 v[180:183], v[76:79], v[84:87], v[180:183]
    buffer_load_dwordx4 v243, s[32:35], s60 offen offset:3072 lds
    v_mfma_f32_16x16x32_bf16 v[184:187], v[76:79], v[88:91], v[184:187]
    s_lshl_b32 s78, s54, 11
    v_mfma_f32_16x16x32_bf16 v[188:191], v[76:79], v[92:95], v[188:191]
    s_waitcnt lgkmcnt(0)
    s_nop 0
    v_mfma_f32_16x16x32_bf16 v[128:131], v[32:35], v[48:51], v[128:131]
    ds_read_b128 v[80:83], v13 offset:0
    s_add_u32 m0, s62, 16384
    v_mfma_f32_16x16x32_bf16 v[132:135], v[32:35], v[52:55], v[132:135]
    ds_read_b64_tr_b16 v[64:65], v6 offset:24576
    s_add_u32 s78, s78, 163840
    v_mfma_f32_16x16x32_bf16 v[136:139], v[32:35], v[56:59], v[136:139]
    ds_read_b64_tr_b16 v[66:67], v6 offset:25600
    buffer_load_dwordx4 v244, s[40:43], s61 offen offset:0 lds
    v_mfma_f32_16x16x32_bf16 v[140:143], v[32:35], v[60:63], v[140:143]
    ds_read_b128 v[84:87], v13 offset:2048
    v_mfma_f32_16x16x32_bf16 v[192:195], v[32:35], v[20:23], v[192:195]
    ds_read_b64_tr_b16 v[68:69], v7 offset:24576
    v_mov_b32_e64 v16, s73
    v_mfma_f32_16x16x32_bf16 v[144:147], v[36:39], v[48:51], v[144:147]
    ds_read_b64_tr_b16 v[70:71], v7 offset:25600
    v_mfma_f32_16x16x32_bf16 v[148:151], v[36:39], v[52:55], v[148:151]
    ds_read_b128 v[88:91], v13 offset:4096
    buffer_load_dwordx4 v245, s[40:43], s61 offen offset:1024 lds
    v_mfma_f32_16x16x32_bf16 v[152:155], v[36:39], v[56:59], v[152:155]
    ds_read_b64_tr_b16 v[72:73], v8 offset:24576
    v_mfma_f32_16x16x32_bf16 v[156:159], v[36:39], v[60:63], v[156:159]
    ds_read_b64_tr_b16 v[74:75], v8 offset:25600
    v_mov_b32_e64 v18, s78
    v_mfma_f32_16x16x32_bf16 v[196:199], v[36:39], v[20:23], v[196:199]
    ds_read_b128 v[92:95], v13 offset:6144
    v_mfma_f32_16x16x32_bf16 v[160:163], v[40:43], v[48:51], v[160:163]
    ds_read_b64_tr_b16 v[76:77], v9 offset:24576
    buffer_load_dwordx4 v246, s[40:43], s61 offen offset:2048 lds
    v_mfma_f32_16x16x32_bf16 v[164:167], v[40:43], v[52:55], v[164:167]
    ds_read_b64_tr_b16 v[78:79], v9 offset:25600
    v_and_b32 v19, 32, v0
    v_mfma_f32_16x16x32_bf16 v[168:171], v[40:43], v[56:59], v[168:171]
    v_mfma_f32_16x16x32_bf16 v[172:175], v[40:43], v[60:63], v[172:175]
    buffer_load_dwordx4 v247, s[40:43], s61 offen offset:3072 lds
    v_cmp_eq_u32 vcc, 0, v19
    v_mfma_f32_16x16x32_bf16 v[176:179], v[44:47], v[48:51], v[176:179]
    s_nop 1
    v_mfma_f32_16x16x32_bf16 v[180:183], v[44:47], v[52:55], v[180:183]
    s_bitcmp1_b32 s0, 8
    s_cselect_b32 s87, s85, 128
    s_cselect_b32 s88, s86, 221184
    v_mfma_f32_16x16x32_bf16 v[184:187], v[44:47], v[56:59], v[184:187]
    s_add_u32 s60, s60, s87
    v_mfma_f32_16x16x32_bf16 v[188:191], v[44:47], v[60:63], v[188:191]
    s_add_u32 s61, s61, s88
    s_waitcnt vmcnt(10) lgkmcnt(0)
    s_barrier
    buffer_load_dword v29, v28, s[36:39], 0 offen sc1
    v_mfma_f32_16x16x32_bf16 v[128:131], v[64:67], v[80:83], v[128:131]
    ds_read_b128 v[48:51], v12 offset:32768
    s_add_u32 m0, s62, 32768
    v_mfma_f32_16x16x32_bf16 v[132:135], v[64:67], v[84:87], v[132:135]
    ds_read_b64_tr_b16 v[32:33], v6 offset:49152
    v_cndmask_b32_e64 v16, v18, v16, vcc
    v_mfma_f32_16x16x32_bf16 v[136:139], v[64:67], v[88:91], v[136:139]
    ds_read_b64_tr_b16 v[34:35], v6 offset:50176
    buffer_load_dwordx4 v240, s[32:35], s60 offen offset:0 lds
    v_mfma_f32_16x16x32_bf16 v[140:143], v[64:67], v[92:95], v[140:143]
    ds_read_b128 v[52:55], v12 offset:34816
    v_mfma_f32_16x16x32_bf16 v[192:195], v[64:67], v[20:23], v[192:195]
    ds_read_b64_tr_b16 v[36:37], v7 offset:49152
    v_mfma_f32_16x16x32_bf16 v[144:147], v[68:71], v[80:83], v[144:147]
    ds_read_b64_tr_b16 v[38:39], v7 offset:50176
    v_add_u32_e64 v27, v16, v27
    v_mfma_f32_16x16x32_bf16 v[148:151], v[68:71], v[84:87], v[148:151]
    ds_read_b128 v[56:59], v12 offset:36864
    buffer_load_dwordx4 v241, s[32:35], s60 offen offset:1024 lds
    v_mfma_f32_16x16x32_bf16 v[152:155], v[68:71], v[88:91], v[152:155]
    ds_read_b64_tr_b16 v[40:41], v8 offset:49152
    v_mfma_f32_16x16x32_bf16 v[156:159], v[68:71], v[92:95], v[156:159]
    ds_read_b64_tr_b16 v[42:43], v8 offset:50176
    v_mfma_f32_16x16x32_bf16 v[196:199], v[68:71], v[20:23], v[196:199]
    ds_read_b128 v[60:63], v12 offset:38912
    s_lshr_b32 s78, s3, 1
    v_mfma_f32_16x16x32_bf16 v[160:163], v[72:75], v[80:83], v[160:163]
    ds_read_b64_tr_b16 v[44:45], v9 offset:49152
    v_mfma_f32_16x16x32_bf16 v[164:167], v[72:75], v[84:87], v[164:167]
    ds_read_b64_tr_b16 v[46:47], v9 offset:50176
    buffer_load_dwordx4 v242, s[32:35], s60 offen offset:2048 lds
    v_mfma_f32_16x16x32_bf16 v[168:171], v[72:75], v[88:91], v[168:171]
    s_add_u32 s84, s84, s78
    v_mfma_f32_16x16x32_bf16 v[172:175], v[72:75], v[92:95], v[172:175]
    v_mfma_f32_16x16x32_bf16 v[176:179], v[76:79], v[80:83], v[176:179]
    s_and_b32 s87, s3, 1
    v_mfma_f32_16x16x32_bf16 v[180:183], v[76:79], v[84:87], v[180:183]
    buffer_load_dwordx4 v243, s[32:35], s60 offen offset:3072 lds
    v_mfma_f32_16x16x32_bf16 v[184:187], v[76:79], v[88:91], v[184:187]
    s_mul_i32 s86, s78, 21248
    v_mfma_f32_16x16x32_bf16 v[188:191], v[76:79], v[92:95], v[188:191]
    s_waitcnt lgkmcnt(0)
    v_mfma_f32_16x16x32_bf16 v[128:131], v[32:35], v[48:51], v[128:131]
    ds_read_b128 v[80:83], v13 offset:32768
    s_add_u32 m0, s62, 49152
    v_mfma_f32_16x16x32_bf16 v[132:135], v[32:35], v[52:55], v[132:135]
    ds_read_b64_tr_b16 v[64:65], v6 offset:57344
    s_lshl_b32 s85, s84, 12
    v_mfma_f32_16x16x32_bf16 v[136:139], v[32:35], v[56:59], v[136:139]
    ds_read_b64_tr_b16 v[66:67], v6 offset:58368
    buffer_load_dwordx4 v244, s[40:43], s61 offen offset:0 lds
    v_mfma_f32_16x16x32_bf16 v[140:143], v[32:35], v[60:63], v[140:143]
    ds_read_b128 v[84:87], v13 offset:34816
    v_mfma_f32_16x16x32_bf16 v[192:195], v[32:35], v[20:23], v[192:195]
    ds_read_b64_tr_b16 v[68:69], v7 offset:57344
    s_add_u32 s44, s12, s85
    s_addc_u32 s45, s13, 0
    s_nop 0
    v_mfma_f32_16x16x32_bf16 v[144:147], v[36:39], v[48:51], v[144:147]
    ds_read_b64_tr_b16 v[70:71], v7 offset:58368
    v_mfma_f32_16x16x32_bf16 v[148:151], v[36:39], v[52:55], v[148:151]
    ds_read_b128 v[88:91], v13 offset:36864
    buffer_load_dwordx4 v245, s[40:43], s61 offen offset:1024 lds
    v_mfma_f32_16x16x32_bf16 v[152:155], v[36:39], v[56:59], v[152:155]
    ds_read_b64_tr_b16 v[72:73], v8 offset:57344
    v_mfma_f32_16x16x32_bf16 v[156:159], v[36:39], v[60:63], v[156:159]
    ds_read_b64_tr_b16 v[74:75], v8 offset:58368
    v_mfma_f32_16x16x32_bf16 v[196:199], v[36:39], v[20:23], v[196:199]
    ds_read_b128 v[92:95], v13 offset:38912
    v_mfma_f32_16x16x32_bf16 v[160:163], v[40:43], v[48:51], v[160:163]
    ds_read_b64_tr_b16 v[76:77], v9 offset:57344
    s_mov_b32 s46, 4096
    v_mfma_f32_16x16x32_bf16 v[164:167], v[40:43], v[52:55], v[164:167]
    ds_read_b64_tr_b16 v[78:79], v9 offset:58368
    buffer_load_dwordx4 v246, s[40:43], s61 offen offset:2048 lds
    v_mfma_f32_16x16x32_bf16 v[168:171], v[40:43], v[56:59], v[168:171]
    s_mov_b32 s47, 0x20000
    v_mfma_f32_16x16x32_bf16 v[172:175], v[40:43], v[60:63], v[172:175]
    s_lshl_b32 s89, s87, 11
    v_mfma_f32_16x16x32_bf16 v[176:179], v[44:47], v[48:51], v[176:179]
    v_mfma_f32_16x16x32_bf16 v[180:183], v[44:47], v[52:55], v[180:183]
    buffer_load_dwordx4 v247, s[40:43], s61 offen offset:3072 lds
    s_add_u32 s88, s85, s89
    v_mfma_f32_16x16x32_bf16 v[184:187], v[44:47], v[56:59], v[184:187]
    s_add_u32 s88, s88, 1048576
    v_mfma_f32_16x16x32_bf16 v[188:191], v[44:47], v[60:63], v[188:191]
    s_waitcnt vmcnt(9) lgkmcnt(0)
    s_barrier
    v_mfma_f32_16x16x32_bf16 v[128:131], v[64:67], v[80:83], v[128:131]
    ds_read_b128 v[48:51], v10 offset:0
    buffer_load_dwordx2 v[208:209], v232, s[48:51], 0 offen
    v_mfma_f32_16x16x32_bf16 v[132:135], v[64:67], v[84:87], v[132:135]
    ds_read_b64_tr_b16 v[32:33], v2 offset:16384
    v_mfma_f32_16x16x32_bf16 v[136:139], v[64:67], v[88:91], v[136:139]
    ds_read_b64_tr_b16 v[34:35], v2 offset:17408
    v_mfma_f32_16x16x32_bf16 v[140:143], v[64:67], v[92:95], v[140:143]
    ds_read_b128 v[52:55], v10 offset:2048
    v_mfma_f32_16x16x32_bf16 v[192:195], v[64:67], v[20:23], v[192:195]
    ds_read_b64_tr_b16 v[36:37], v3 offset:16384
    v_mfma_f32_16x16x32_bf16 v[144:147], v[68:71], v[80:83], v[144:147]
    ds_read_b64_tr_b16 v[38:39], v3 offset:17408
    v_mfma_f32_16x16x32_bf16 v[148:151], v[68:71], v[84:87], v[148:151]
    ds_read_b128 v[56:59], v10 offset:4096
    buffer_load_dwordx2 v[210:211], v233, s[48:51], 0 offen
    v_mfma_f32_16x16x32_bf16 v[152:155], v[68:71], v[88:91], v[152:155]
    ds_read_b64_tr_b16 v[40:41], v4 offset:16384
    v_mfma_f32_16x16x32_bf16 v[156:159], v[68:71], v[92:95], v[156:159]
    ds_read_b64_tr_b16 v[42:43], v4 offset:17408
    v_mfma_f32_16x16x32_bf16 v[196:199], v[68:71], v[20:23], v[196:199]
    ds_read_b128 v[60:63], v10 offset:6144
    v_mfma_f32_16x16x32_bf16 v[160:163], v[72:75], v[80:83], v[160:163]
    ds_read_b64_tr_b16 v[44:45], v5 offset:16384
    v_mfma_f32_16x16x32_bf16 v[164:167], v[72:75], v[84:87], v[164:167]
    ds_read_b64_tr_b16 v[46:47], v5 offset:17408
    v_mfma_f32_16x16x32_bf16 v[168:171], v[72:75], v[88:91], v[168:171]
    buffer_load_dwordx2 v[212:213], v234, s[48:51], 0 offen
    v_mfma_f32_16x16x32_bf16 v[172:175], v[72:75], v[92:95], v[172:175]
    v_mfma_f32_16x16x32_bf16 v[176:179], v[76:79], v[80:83], v[176:179]
    v_mfma_f32_16x16x32_bf16 v[180:183], v[76:79], v[84:87], v[180:183]
    buffer_load_dwordx2 v[214:215], v235, s[48:51], 0 offen
    v_mfma_f32_16x16x32_bf16 v[184:187], v[76:79], v[88:91], v[184:187]
    v_mfma_f32_16x16x32_bf16 v[188:191], v[76:79], v[92:95], v[188:191]
    s_waitcnt lgkmcnt(0)
    v_mfma_f32_16x16x32_bf16 v[128:131], v[32:35], v[48:51], v[128:131]
    ds_read_b128 v[80:83], v11 offset:0
    s_lshl_b32 s79, s53, 6
    v_mfma_f32_16x16x32_bf16 v[132:135], v[32:35], v[52:55], v[132:135]
    ds_read_b64_tr_b16 v[64:65], v2 offset:24576
    s_lshl_b32 s80, s3, 4
    v_mfma_f32_16x16x32_bf16 v[136:139], v[32:35], v[56:59], v[136:139]
    ds_read_b64_tr_b16 v[66:67], v2 offset:25600
    s_add_u32 s79, s79, s80
    v_mfma_f32_16x16x32_bf16 v[140:143], v[32:35], v[60:63], v[140:143]
    ds_read_b128 v[84:87], v11 offset:2048
    v_lshrrev_b32 v116, 2, v0
    v_mfma_f32_16x16x32_bf16 v[192:195], v[32:35], v[20:23], v[192:195]
    ds_read_b64_tr_b16 v[68:69], v3 offset:24576
    v_add_u32 v116, s79, v116
    v_mfma_f32_16x16x32_bf16 v[144:147], v[36:39], v[48:51], v[144:147]
    ds_read_b64_tr_b16 v[70:71], v3 offset:25600
    v_mul_u32_u24 v116, 1280, v116
    v_mfma_f32_16x16x32_bf16 v[148:151], v[36:39], v[52:55], v[148:151]
    ds_read_b128 v[88:91], v11 offset:4096
    s_mul_i32 s80, s54, 160
    v_mfma_f32_16x16x32_bf16 v[152:155], v[36:39], v[56:59], v[152:155]
    ds_read_b64_tr_b16 v[72:73], v4 offset:24576
    v_add_u32 v116, s80, v116
    v_mfma_f32_16x16x32_bf16 v[156:159], v[36:39], v[60:63], v[156:159]
    ds_read_b64_tr_b16 v[74:75], v4 offset:25600
    v_and_b32 v117, 3, v0
    v_mfma_f32_16x16x32_bf16 v[196:199], v[36:39], v[20:23], v[196:199]
    ds_read_b128 v[92:95], v11 offset:6144
    v_lshl_add_u32 v118, v117, 4, v116
    v_mfma_f32_16x16x32_bf16 v[160:163], v[40:43], v[48:51], v[160:163]
    ds_read_b64_tr_b16 v[76:77], v5 offset:24576
    v_lshl_add_u32 v119, v117, 3, v116
    v_mfma_f32_16x16x32_bf16 v[164:167], v[40:43], v[52:55], v[164:167]
    ds_read_b64_tr_b16 v[78:79], v5 offset:25600
    v_mfma_f32_16x16x32_bf16 v[168:171], v[40:43], v[56:59], v[168:171]
    s_mov_b32 s40, s24
    s_mov_b32 s41, s25
    v_mfma_f32_16x16x32_bf16 v[172:175], v[40:43], v[60:63], v[172:175]
    s_mov_b32 s42, 1280
    s_mov_b32 s43, 0x20000
    v_mfma_f32_16x16x32_bf16 v[176:179], v[44:47], v[48:51], v[176:179]
    v_lshrrev_b32 v104, 4, v0
    s_mul_i32 s60, s54, 160
    v_mfma_f32_16x16x32_bf16 v[180:183], v[44:47], v[52:55], v[180:183]
    v_lshlrev_b32 v105, 4, v104
    v_lshlrev_b32_e64 v106, 3, v104
    v_mfma_f32_16x16x32_bf16 v[184:187], v[44:47], v[56:59], v[184:187]
    buffer_load_dwordx4 a[240:243], v105, s[40:43], s60 offen
    buffer_load_dwordx4 a[244:247], v105, s[40:43], s60 offen offset:64
    v_mfma_f32_16x16x32_bf16 v[188:191], v[44:47], v[60:63], v[188:191]
    buffer_load_dwordx2 a[248:249], v106, s[40:43], s60 offen offset:128
    s_waitcnt vmcnt(7) lgkmcnt(0)
    s_waitcnt vmcnt(15)
    v_cmp_ne_u32 vcc, s56, v29
    s_mov_b64 s[82:83], vcc
    s_cmp_eq_u64 s[82:83], 0
    s_cbranch_scc0 P1_RETRY_1
P1_DONE_2:
    s_barrier
    v_mfma_f32_16x16x32_bf16 v[128:131], v[64:67], v[80:83], v[128:131]
    ds_read_b128 v[48:51], v10 offset:32768
    buffer_load_dword v24, v27, s[36:39], 0 offen sc1
    v_mfma_f32_16x16x32_bf16 v[132:135], v[64:67], v[84:87], v[132:135]
    ds_read_b64_tr_b16 v[32:33], v2 offset:49152
    v_mfma_f32_16x16x32_bf16 v[136:139], v[64:67], v[88:91], v[136:139]
    ds_read_b64_tr_b16 v[34:35], v2 offset:50176
    v_and_b32 v16, 15, v0
    v_mfma_f32_16x16x32_bf16 v[140:143], v[64:67], v[92:95], v[140:143]
    ds_read_b128 v[52:55], v10 offset:34816
    v_mfma_f32_16x16x32_bf16 v[192:195], v[64:67], v[20:23], v[192:195]
    ds_read_b64_tr_b16 v[36:37], v3 offset:49152
    v_mfma_f32_16x16x32_bf16 v[144:147], v[68:71], v[80:83], v[144:147]
    ds_read_b64_tr_b16 v[38:39], v3 offset:50176
    v_add_u32_e64 v16, s67, v16
    v_mfma_f32_16x16x32_bf16 v[148:151], v[68:71], v[84:87], v[148:151]
    ds_read_b128 v[56:59], v10 offset:36864
    v_mfma_f32_16x16x32_bf16 v[152:155], v[68:71], v[88:91], v[152:155]
    ds_read_b64_tr_b16 v[40:41], v4 offset:49152
    v_mfma_f32_16x16x32_bf16 v[156:159], v[68:71], v[92:95], v[156:159]
    ds_read_b64_tr_b16 v[42:43], v4 offset:50176
    v_lshlrev_b32_e64 v16, 3, v16
    v_mfma_f32_16x16x32_bf16 v[196:199], v[68:71], v[20:23], v[196:199]
    ds_read_b128 v[60:63], v10 offset:38912
    v_mfma_f32_16x16x32_bf16 v[160:163], v[72:75], v[80:83], v[160:163]
    ds_read_b64_tr_b16 v[44:45], v5 offset:49152
    s_mov_b32 s59, 65536
    v_mfma_f32_16x16x32_bf16 v[164:167], v[72:75], v[84:87], v[164:167]
    ds_read_b64_tr_b16 v[46:47], v5 offset:50176
    v_mfma_f32_16x16x32_bf16 v[168:171], v[72:75], v[88:91], v[168:171]
    buffer_load_dwordx2 v[200:201], v16, s[36:39], s59 offen offset:0 sc1
    v_mfma_f32_16x16x32_bf16 v[172:175], v[72:75], v[92:95], v[172:175]
    v_mfma_f32_16x16x32_bf16 v[176:179], v[76:79], v[80:83], v[176:179]
    buffer_load_dwordx2 v[202:203], v16, s[36:39], s59 offen offset:128 sc1
    v_mfma_f32_16x16x32_bf16 v[180:183], v[76:79], v[84:87], v[180:183]
    buffer_load_dwordx2 v[204:205], v16, s[36:39], s59 offen offset:256 sc1
    v_mfma_f32_16x16x32_bf16 v[184:187], v[76:79], v[88:91], v[184:187]
    buffer_load_dwordx2 v[206:207], v16, s[36:39], s59 offen offset:384 sc1
    v_mfma_f32_16x16x32_bf16 v[188:191], v[76:79], v[92:95], v[188:191]
    s_waitcnt lgkmcnt(0)
    v_mfma_f32_16x16x32_bf16 v[128:131], v[32:35], v[48:51], v[128:131]
    ds_read_b128 v[80:83], v11 offset:32768
    buffer_load_dwordx4 v[244:247], v118, s[32:35], 0 offen
    v_mfma_f32_16x16x32_bf16 v[132:135], v[32:35], v[52:55], v[132:135]
    ds_read_b64_tr_b16 v[64:65], v2 offset:57344
    s_and_b32 s73, s69, 7
    v_mfma_f32_16x16x32_bf16 v[136:139], v[32:35], v[56:59], v[136:139]
    ds_read_b64_tr_b16 v[66:67], v2 offset:58368
    s_lshl_b32 s73, s73, 6
    s_nop 0
    v_mfma_f32_16x16x32_bf16 v[140:143], v[32:35], v[60:63], v[140:143]
    ds_read_b128 v[84:87], v11 offset:34816
    s_add_u32 s73, s73, 131072
    v_mfma_f32_16x16x32_bf16 v[192:195], v[32:35], v[20:23], v[192:195]
    ds_read_b64_tr_b16 v[68:69], v3 offset:57344
    v_lshl_add_u32 v108, v17, 4, s73
    v_mfma_f32_16x16x32_bf16 v[144:147], v[36:39], v[48:51], v[144:147]
    ds_read_b64_tr_b16 v[70:71], v3 offset:58368
    s_and_b32 s73, s70, 7
    v_mfma_f32_16x16x32_bf16 v[148:151], v[36:39], v[52:55], v[148:151]
    ds_read_b128 v[88:91], v11 offset:36864
    s_lshl_b32 s73, s73, 6
    v_mfma_f32_16x16x32_bf16 v[152:155], v[36:39], v[56:59], v[152:155]
    ds_read_b64_tr_b16 v[72:73], v4 offset:57344
    v_mfma_f32_16x16x32_bf16 v[156:159], v[36:39], v[60:63], v[156:159]
    ds_read_b64_tr_b16 v[74:75], v4 offset:58368
    s_add_u32 s73, s73, 131072
    v_mfma_f32_16x16x32_bf16 v[196:199], v[36:39], v[20:23], v[196:199]
    ds_read_b128 v[92:95], v11 offset:38912
    v_lshl_add_u32 v109, v17, 4, s73
    v_mfma_f32_16x16x32_bf16 v[160:163], v[40:43], v[48:51], v[160:163]
    ds_read_b64_tr_b16 v[76:77], v5 offset:57344
    s_and_b32 s73, s71, 7
    v_mfma_f32_16x16x32_bf16 v[164:167], v[40:43], v[52:55], v[164:167]
    ds_read_b64_tr_b16 v[78:79], v5 offset:58368
    s_lshl_b32 s73, s73, 6
    v_mfma_f32_16x16x32_bf16 v[168:171], v[40:43], v[56:59], v[168:171]
    s_add_u32 s73, s73, 131072
    v_lshl_add_u32 v110, v17, 4, s73
    v_mfma_f32_16x16x32_bf16 v[172:175], v[40:43], v[60:63], v[172:175]
    s_and_b32 s73, s72, 7
    v_mfma_f32_16x16x32_bf16 v[176:179], v[44:47], v[48:51], v[176:179]
    s_lshl_b32 s73, s73, 6
    s_add_u32 s73, s73, 131072
    v_mfma_f32_16x16x32_bf16 v[180:183], v[44:47], v[52:55], v[180:183]
    v_lshl_add_u32 v111, v17, 4, s73
    v_mov_b32 v112, 0xbf8bf336
    v_mfma_f32_16x16x32_bf16 v[184:187], v[44:47], v[56:59], v[184:187]
    v_mov_b32 v113, 0xbf8bf336
    v_mov_b32 v114, 0x3eeff558
    v_mfma_f32_16x16x32_bf16 v[188:191], v[44:47], v[60:63], v[188:191]
    v_mov_b32 v115, 0x3eeff558
    s_waitcnt lgkmcnt(0)
    v_mfma_f32_16x16x32_bf16 v[192:195], v[64:67], v[20:23], v[192:195]
    s_waitcnt vmcnt(9)
    v_lshlrev_b32_e64 v40, 16, v208
    v_mfma_f32_16x16x32_bf16 v[196:199], v[68:71], v[20:23], v[196:199]
    buffer_load_dwordx4 v[248:251], v118, s[32:35], 0 offen offset:64
    v_and_b32 v41, 0xffff0000, v208
    v_mfma_f32_16x16x32_bf16 v[128:131], v[64:67], v[80:83], v[128:131]
    v_lshlrev_b32 v42, 16, v209
    v_mfma_f32_16x16x32_bf16 v[132:135], v[64:67], v[84:87], v[132:135]
    v_and_b32 v43, 0xffff0000, v209
    v_lshlrev_b32 v44, 16, v210
    v_mfma_f32_16x16x32_bf16 v[136:139], v[64:67], v[88:91], v[136:139]
    v_and_b32 v45, 0xffff0000, v210
    v_lshlrev_b32 v46, 16, v211
    v_mfma_f32_16x16x32_bf16 v[140:143], v[64:67], v[92:95], v[140:143]
    v_and_b32 v47, 0xffff0000, v211
    v_mfma_f32_16x16x32_bf16 v[144:147], v[68:71], v[80:83], v[144:147]
    v_lshlrev_b32 v56, 16, v212
    v_and_b32 v57, 0xffff0000, v212
    v_mfma_f32_16x16x32_bf16 v[148:151], v[68:71], v[84:87], v[148:151]
    v_lshlrev_b32 v58, 16, v213
    v_mfma_f32_16x16x32_bf16 v[152:155], v[68:71], v[88:91], v[152:155]
    v_and_b32 v59, 0xffff0000, v213
    v_lshlrev_b32 v60, 16, v214
    v_mfma_f32_16x16x32_bf16 v[156:159], v[68:71], v[92:95], v[156:159]
    buffer_load_dwordx2 v[252:253], v119, s[32:35], 0 offen offset:128
    v_and_b32 v61, 0xffff0000, v214
    v_mfma_f32_16x16x32_bf16 v[160:163], v[72:75], v[80:83], v[160:163]
    s_mov_b32 exec_lo, 0x00010001
    s_mov_b32 exec_hi, 0x00010001
    ds_write_b128 v108, v[192:195]
    ds_write_b128 v109, v[196:199]
    s_mov_b64 exec, -1
    v_mfma_f32_16x16x32_bf16 v[164:167], v[72:75], v[84:87], v[164:167]
    v_lshlrev_b32 v62, 16, v215
    v_mfma_f32_16x16x32_bf16 v[168:171], v[72:75], v[88:91], v[168:171]
    v_and_b32 v63, 0xffff0000, v215
    s_mov_b32 s74, 0x409d30fc
    v_mfma_f32_16x16x32_bf16 v[172:175], v[72:75], v[92:95], v[172:175]
    s_mov_b32 s75, 0x409d30fc
    v_mfma_f32_16x16x32_bf16 v[176:179], v[76:79], v[80:83], v[176:179]
    s_lshr_b32 s76, s67, 4
    s_mul_i32 s76, s76, 55296
    v_mfma_f32_16x16x32_bf16 v[180:183], v[76:79], v[84:87], v[180:183]
    s_add_u32 s76, s76, 10485760
    v_mfma_f32_16x16x32_bf16 v[184:187], v[76:79], v[88:91], v[184:187]
    s_cmp_ge_u32 s68, 108
    s_cselect_b32 s76, 17563648, s76
    v_mfma_f32_16x16x32_bf16 v[188:191], v[76:79], v[92:95], v[188:191]
    v_lshlrev_b32 v18, 4, v0
G1_END:
    s_waitcnt vmcnt(7)
    v_cmp_ne_u32 vcc, s56, v24
    s_mov_b64 s[82:83], vcc
    s_cmp_eq_u64 s[82:83], 0
    s_cbranch_scc0 P2_RETRY_4
P2_DONE_5:
    s_waitcnt lgkmcnt(0)
    s_barrier
    s_nop 0
    ds_read_b128 v[216:219], v108
    ds_read_b128 v[220:223], v109
    ds_read_b128 v[224:227], v110
    ds_read_b128 v[228:231], v111
    buffer_load_dwordx4 v[96:99], v14, s[44:47], s89 offen offset:0 nt
    buffer_load_dwordx4 v[100:103], v14, s[44:47], s89 offen offset:1024 nt
    buffer_load_dwordx2 v[116:117], v14, s[44:47], s89 offen offset:2048 nt
    v_pk_mul_f32 v[40:41], v[40:41], v[114:115]
    v_pk_mul_f32 v[42:43], v[42:43], v[114:115]
    v_pk_mul_f32 v[44:45], v[44:45], v[114:115]
    v_pk_mul_f32 v[46:47], v[46:47], v[114:115]
    v_pk_mul_f32 v[56:57], v[56:57], v[114:115]
    v_pk_mul_f32 v[58:59], v[58:59], v[114:115]
    v_pk_mul_f32 v[60:61], v[60:61], v[114:115]
    v_pk_mul_f32 v[62:63], v[62:63], v[114:115]
    s_waitcnt vmcnt(6)
    v_mul_f32 v201, v114, v201
    v_mul_f32 v200, v200, v201
    v_mul_f32 v203, v114, v203
    v_mul_f32 v202, v202, v203
    v_mul_f32 v205, v114, v205
    v_mul_f32 v204, v204, v205
    v_mul_f32 v207, v114, v207
    v_mul_f32_e64 v206, v206, v207
    buffer_load_dwordx4 v[120:123], v14, s[36:39], s88 offen offset:0 sc1
    buffer_load_dwordx4 v[124:127], v14, s[36:39], s88 offen offset:1024 sc1
    s_waitcnt lgkmcnt(0)
    s_lshl_b32 s78, s84, 1
    s_and_b32 s78, s78, -4
    s_nop 0
    s_load_dword s77, s[14:15], s78
    v_pk_fma_f32 v[32:33], v[216:217], v[200:201], v[40:41] op_sel_hi:[1,0,1] neg_lo:[0,1,0] neg_hi:[0,1,0]
    v_pk_fma_f32 v[34:35], v[218:219], v[200:201], v[42:43] op_sel_hi:[1,0,1] neg_lo:[0,1,0] neg_hi:[0,1,0]
    v_pk_fma_f32 v[36:37], v[220:221], v[200:201], v[44:45] op_sel_hi:[1,0,1] neg_lo:[0,1,0] neg_hi:[0,1,0]
    buffer_load_dwordx4 a[0:3], v14, s[36:39], s52 offen offset:0 sc1
    v_pk_fma_f32 v[38:39], v[222:223], v[200:201], v[46:47] op_sel_hi:[1,0,1] neg_lo:[0,1,0] neg_hi:[0,1,0]
    v_pk_fma_f32 v[32:33], v[128:129], v[200:201], v[32:33] op_sel:[0,1,0] op_sel_hi:[1,1,1]
    v_pk_fma_f32 v[34:35], v[130:131], v[200:201], v[34:35] op_sel:[0,1,0] op_sel_hi:[1,1,1]
    v_pk_fma_f32 v[36:37], v[144:145], v[200:201], v[36:37] op_sel:[0,1,0] op_sel_hi:[1,1,1]
    v_pk_fma_f32 v[38:39], v[146:147], v[200:201], v[38:39] op_sel:[0,1,0] op_sel_hi:[1,1,1]
    v_pk_fma_f32 v[48:49], v[32:33], v[32:33], s[74:75]
    v_pk_fma_f32 v[50:51], v[34:35], v[34:35], s[74:75]
    v_pk_fma_f32 v[52:53], v[36:37], v[36:37], s[74:75]
    v_pk_fma_f32 v[54:55], v[38:39], v[38:39], s[74:75]
    v_pk_fma_f32 v[48:49], v[48:49], v[32:33], v[112:113] neg_lo:[0,1,0] neg_hi:[0,1,0]
    v_pk_fma_f32 v[50:51], v[50:51], v[34:35], v[112:113] neg_lo:[0,1,0] neg_hi:[0,1,0]
    v_pk_fma_f32 v[52:53], v[52:53], v[36:37], v[112:113] neg_lo:[0,1,0] neg_hi:[0,1,0]
    v_pk_fma_f32 v[54:55], v[54:55], v[38:39], v[112:113] neg_lo:[0,1,0] neg_hi:[0,1,0]
    v_exp_f32 v64, v48
    v_exp_f32 v65, v49
    v_exp_f32 v66, v50
    v_exp_f32 v67, v51
    v_exp_f32 v68, v52
    v_exp_f32 v69, v53
    v_exp_f32 v70, v54
    v_exp_f32 v71, v55
    v_pk_add_f32 v[64:65], v[64:65], v[114:115]
    buffer_load_dwordx4 a[4:7], v14, s[36:39], s52 offen offset:1024 sc1
    v_pk_add_f32 v[66:67], v[66:67], v[114:115]
    v_pk_add_f32 v[68:69], v[68:69], v[114:115]
    v_pk_add_f32 v[70:71], v[70:71], v[114:115]
    v_rcp_f32 v64, v64
    v_rcp_f32 v65, v65
    v_rcp_f32 v66, v66
    v_rcp_f32 v67, v67
    v_rcp_f32 v68, v68
    v_rcp_f32 v69, v69
    v_rcp_f32_e64 v70, v70
    v_rcp_f32 v71, v71
    s_nop 0
    v_pk_mul_f32 v[32:33], v[32:33], v[64:65]
    v_pk_mul_f32 v[34:35], v[34:35], v[66:67]
    v_pk_mul_f32 v[36:37], v[36:37], v[68:69]
    v_pk_mul_f32 v[38:39], v[38:39], v[70:71]
    v_cvt_pk_bf16_f32 v128, v32, v33
    v_cvt_pk_bf16_f32 v129, v34, v35
    v_cvt_pk_bf16_f32 v130, v36, v37
    v_cvt_pk_bf16_f32 v131, v38, v39
    s_lshr_b32 s73, s69, 1
    s_lshl_b32 s73, s73, 10
    s_add_u32 s73, s73, s76
    s_nop 0
    buffer_store_dwordx4 v[128:131], v18, s[36:39], s73 offen sc1
    v_pk_fma_f32 v[32:33], v[224:225], v[200:201], v[56:57] op_sel_hi:[1,0,1] neg_lo:[0,1,0] neg_hi:[0,1,0]
    v_pk_fma_f32 v[34:35], v[226:227], v[200:201], v[58:59] op_sel_hi:[1,0,1] neg_lo:[0,1,0] neg_hi:[0,1,0]
    v_pk_fma_f32 v[36:37], v[228:229], v[200:201], v[60:61] op_sel_hi:[1,0,1] neg_lo:[0,1,0] neg_hi:[0,1,0]
    buffer_load_dwordx4 a[8:11], v14, s[36:39], s52 offen offset:2048 sc1
    v_pk_fma_f32 v[38:39], v[230:231], v[200:201], v[62:63] op_sel_hi:[1,0,1] neg_lo:[0,1,0] neg_hi:[0,1,0]
    v_pk_fma_f32 v[32:33], v[160:161], v[200:201], v[32:33] op_sel:[0,1,0] op_sel_hi:[1,1,1]
    v_pk_fma_f32 v[34:35], v[162:163], v[200:201], v[34:35] op_sel:[0,1,0] op_sel_hi:[1,1,1]
    v_pk_fma_f32 v[36:37], v[176:177], v[200:201], v[36:37] op_sel:[0,1,0] op_sel_hi:[1,1,1]
    v_pk_fma_f32 v[38:39], v[178:179], v[200:201], v[38:39] op_sel:[0,1,0] op_sel_hi:[1,1,1]
    v_pk_fma_f32 v[48:49], v[32:33], v[32:33], s[74:75]
    v_pk_fma_f32 v[50:51], v[34:35], v[34:35], s[74:75]
    v_pk_fma_f32 v[52:53], v[36:37], v[36:37], s[74:75]
    v_pk_fma_f32 v[54:55], v[38:39], v[38:39], s[74:75]
    v_pk_fma_f32 v[48:49], v[48:49], v[32:33], v[112:113] neg_lo:[0,1,0] neg_hi:[0,1,0]
    v_pk_fma_f32 v[50:51], v[50:51], v[34:35], v[112:113] neg_lo:[0,1,0] neg_hi:[0,1,0]
    v_pk_fma_f32 v[52:53], v[52:53], v[36:37], v[112:113] neg_lo:[0,1,0] neg_hi:[0,1,0]
    v_pk_fma_f32 v[54:55], v[54:55], v[38:39], v[112:113] neg_lo:[0,1,0] neg_hi:[0,1,0]
    v_exp_f32 v64, v48
    v_exp_f32 v65, v49
    v_exp_f32 v66, v50
    v_exp_f32 v67, v51
    v_exp_f32 v68, v52
    v_exp_f32 v69, v53
    v_exp_f32 v70, v54
    v_exp_f32 v71, v55
    v_pk_add_f32 v[64:65], v[64:65], v[114:115]
    buffer_load_dwordx4 a[12:15], v14, s[36:39], s52 offen offset:3072 sc1
    v_pk_add_f32 v[66:67], v[66:67], v[114:115]
    v_pk_add_f32 v[68:69], v[68:69], v[114:115]
PAGE3:
    s_cbranch_execz PAGE4
    v_pk_add_f32 v[70:71], v[70:71], v[114:115]
    v_rcp_f32 v64, v64
    v_rcp_f32 v65, v65
    v_rcp_f32 v66, v66
    v_rcp_f32 v67, v67
    v_rcp_f32 v68, v68
    v_rcp_f32 v69, v69
    v_rcp_f32 v70, v70
    v_rcp_f32 v71, v71
    s_nop 0
    v_pk_mul_f32 v[32:33], v[32:33], v[64:65]
    v_pk_mul_f32 v[34:35], v[34:35], v[66:67]
    v_pk_mul_f32 v[36:37], v[36:37], v[68:69]
    v_pk_mul_f32 v[38:39], v[38:39], v[70:71]
    v_cvt_pk_bf16_f32 v160, v32, v33
    v_cvt_pk_bf16_f32 v161, v34, v35
    v_cvt_pk_bf16_f32 v162, v36, v37
    v_cvt_pk_bf16_f32 v163, v38, v39
    s_lshr_b32 s73, s71, 1
    s_lshl_b32 s73, s73, 10
    s_add_u32 s73, s73, s76
    s_nop 0
    buffer_store_dwordx4 v[160:163], v18, s[36:39], s73 offen sc1
    v_pk_fma_f32 v[32:33], v[216:217], v[202:203], v[40:41] op_sel_hi:[1,0,1] neg_lo:[0,1,0] neg_hi:[0,1,0]
    v_pk_fma_f32 v[34:35], v[218:219], v[202:203], v[42:43] op_sel_hi:[1,0,1] neg_lo:[0,1,0] neg_hi:[0,1,0]
    v_pk_fma_f32 v[36:37], v[220:221], v[202:203], v[44:45] op_sel_hi:[1,0,1] neg_lo:[0,1,0] neg_hi:[0,1,0]
    buffer_load_dwordx4 a[16:19], v15, s[36:39], s52 offen offset:0 sc1
    s_add_u32 s52, s52, 5120
    v_pk_fma_f32 v[38:39], v[222:223], v[202:203], v[46:47] op_sel_hi:[1,0,1] neg_lo:[0,1,0] neg_hi:[0,1,0]
    v_pk_fma_f32 v[32:33], v[132:133], v[202:203], v[32:33] op_sel:[0,1,0] op_sel_hi:[1,1,1]
    v_pk_fma_f32 v[34:35], v[134:135], v[202:203], v[34:35] op_sel:[0,1,0] op_sel_hi:[1,1,1]
    v_pk_fma_f32 v[36:37], v[148:149], v[202:203], v[36:37] op_sel:[0,1,0] op_sel_hi:[1,1,1]
    v_pk_fma_f32 v[38:39], v[150:151], v[202:203], v[38:39] op_sel:[0,1,0] op_sel_hi:[1,1,1]
    v_pk_fma_f32 v[48:49], v[32:33], v[32:33], s[74:75]
    v_pk_fma_f32 v[50:51], v[34:35], v[34:35], s[74:75]
    v_pk_fma_f32 v[52:53], v[36:37], v[36:37], s[74:75]
    v_pk_fma_f32 v[54:55], v[38:39], v[38:39], s[74:75]
    v_pk_fma_f32 v[48:49], v[48:49], v[32:33], v[112:113] neg_lo:[0,1,0] neg_hi:[0,1,0]
    v_pk_fma_f32 v[50:51], v[50:51], v[34:35], v[112:113] neg_lo:[0,1,0] neg_hi:[0,1,0]
    v_pk_fma_f32 v[52:53], v[52:53], v[36:37], v[112:113] neg_lo:[0,1,0] neg_hi:[0,1,0]
    v_pk_fma_f32 v[54:55], v[54:55], v[38:39], v[112:113] neg_lo:[0,1,0] neg_hi:[0,1,0]
    v_exp_f32 v64, v48
    v_exp_f32 v65, v49
    v_exp_f32 v66, v50
    v_exp_f32 v67, v51
    v_exp_f32 v68, v52
    v_exp_f32 v69, v53
    v_exp_f32 v70, v54
    v_exp_f32 v71, v55
    v_pk_add_f32 v[64:65], v[64:65], v[114:115]
    buffer_load_dwordx4 a[20:23], v14, s[36:39], s52 offen offset:0 sc1
    v_pk_add_f32 v[66:67], v[66:67], v[114:115]
    v_pk_add_f32 v[68:69], v[68:69], v[114:115]
    v_pk_add_f32 v[70:71], v[70:71], v[114:115]
    v_rcp_f32 v64, v64
    v_rcp_f32 v65, v65
    v_rcp_f32 v66, v66
    v_rcp_f32 v67, v67
    v_rcp_f32 v68, v68
    v_rcp_f32 v69, v69
    v_rcp_f32_e64 v70, v70
    v_rcp_f32 v71, v71
    s_nop 0
    v_pk_mul_f32 v[32:33], v[32:33], v[64:65]
    v_pk_mul_f32 v[34:35], v[34:35], v[66:67]
    v_pk_mul_f32 v[36:37], v[36:37], v[68:69]
    v_pk_mul_f32 v[38:39], v[38:39], v[70:71]
    v_cvt_pk_bf16_f32 v132, v32, v33
    v_cvt_pk_bf16_f32 v133, v34, v35
    v_cvt_pk_bf16_f32 v134, v36, v37
    v_cvt_pk_bf16_f32 v135, v38, v39
    s_lshr_b32 s73, s69, 1
    s_lshl_b32 s73, s73, 10
    s_add_u32 s73, s73, s76
    s_nop 0
    s_add_u32 s73, s73, 55296
    buffer_store_dwordx4 v[132:135], v18, s[36:39], s73 offen sc1
    v_pk_fma_f32 v[32:33], v[224:225], v[202:203], v[56:57] op_sel_hi:[1,0,1] neg_lo:[0,1,0] neg_hi:[0,1,0]
    v_pk_fma_f32 v[34:35], v[226:227], v[202:203], v[58:59] op_sel_hi:[1,0,1] neg_lo:[0,1,0] neg_hi:[0,1,0]
    v_pk_fma_f32 v[36:37], v[228:229], v[202:203], v[60:61] op_sel_hi:[1,0,1] neg_lo:[0,1,0] neg_hi:[0,1,0]
    buffer_load_dwordx4 a[24:27], v14, s[36:39], s52 offen offset:1024 sc1
    v_pk_fma_f32 v[38:39], v[230:231], v[202:203], v[62:63] op_sel_hi:[1,0,1] neg_lo:[0,1,0] neg_hi:[0,1,0]
    v_pk_fma_f32 v[32:33], v[164:165], v[202:203], v[32:33] op_sel:[0,1,0] op_sel_hi:[1,1,1]
    v_pk_fma_f32 v[34:35], v[166:167], v[202:203], v[34:35] op_sel:[0,1,0] op_sel_hi:[1,1,1]
    v_pk_fma_f32 v[36:37], v[180:181], v[202:203], v[36:37] op_sel:[0,1,0] op_sel_hi:[1,1,1]
    v_pk_fma_f32 v[38:39], v[182:183], v[202:203], v[38:39] op_sel:[0,1,0] op_sel_hi:[1,1,1]
    v_pk_fma_f32 v[48:49], v[32:33], v[32:33], s[74:75]
    v_pk_fma_f32 v[50:51], v[34:35], v[34:35], s[74:75]
    v_pk_fma_f32 v[52:53], v[36:37], v[36:37], s[74:75]
    v_pk_fma_f32 v[54:55], v[38:39], v[38:39], s[74:75]
    v_pk_fma_f32 v[48:49], v[48:49], v[32:33], v[112:113] neg_lo:[0,1,0] neg_hi:[0,1,0]
    v_pk_fma_f32 v[50:51], v[50:51], v[34:35], v[112:113] neg_lo:[0,1,0] neg_hi:[0,1,0]
    v_pk_fma_f32 v[52:53], v[52:53], v[36:37], v[112:113] neg_lo:[0,1,0] neg_hi:[0,1,0]
    v_pk_fma_f32 v[54:55], v[54:55], v[38:39], v[112:113] neg_lo:[0,1,0] neg_hi:[0,1,0]
    v_exp_f32 v64, v48
    v_exp_f32 v65, v49
    v_exp_f32 v66, v50
    v_exp_f32 v67, v51
    v_exp_f32 v68, v52
    v_exp_f32 v69, v53
    v_exp_f32 v70, v54
    v_exp_f32 v71, v55
    v_pk_add_f32 v[64:65], v[64:65], v[114:115]
    buffer_load_dwordx4 a[28:31], v14, s[36:39], s52 offen offset:2048 sc1
    v_pk_add_f32 v[66:67], v[66:67], v[114:115]
    v_pk_add_f32 v[68:69], v[68:69], v[114:115]
    v_pk_add_f32 v[70:71], v[70:71], v[114:115]
    v_rcp_f32 v64, v64
    v_rcp_f32 v65, v65
    v_rcp_f32 v66, v66
    v_rcp_f32 v67, v67
    v_rcp_f32 v68, v68
    v_rcp_f32 v69, v69
    v_rcp_f32_e64 v70, v70
    v_rcp_f32 v71, v71
    s_nop 0
    v_pk_mul_f32 v[32:33], v[32:33], v[64:65]
    v_pk_mul_f32 v[34:35], v[34:35], v[66:67]
    v_pk_mul_f32 v[36:37], v[36:37], v[68:69]
    v_pk_mul_f32 v[38:39], v[38:39], v[70:71]
    v_cvt_pk_bf16_f32 v164, v32, v33
    v_cvt_pk_bf16_f32 v165, v34, v35
    v_cvt_pk_bf16_f32 v166, v36, v37
    v_cvt_pk_bf16_f32 v167, v38, v39
    s_lshr_b32 s73, s71, 1
    s_lshl_b32 s73, s73, 10
    s_add_u32 s73, s73, s76
    s_nop 0
    s_add_u32 s73, s73, 55296
    buffer_store_dwordx4 v[164:167], v18, s[36:39], s73 offen sc1
    v_pk_fma_f32 v[32:33], v[216:217], v[204:205], v[40:41] op_sel_hi:[1,0,1] neg_lo:[0,1,0] neg_hi:[0,1,0]
    v_pk_fma_f32 v[34:35], v[218:219], v[204:205], v[42:43] op_sel_hi:[1,0,1] neg_lo:[0,1,0] neg_hi:[0,1,0]
    v_pk_fma_f32 v[36:37], v[220:221], v[204:205], v[44:45] op_sel_hi:[1,0,1] neg_lo:[0,1,0] neg_hi:[0,1,0]
    buffer_load_dwordx4 a[32:35], v14, s[36:39], s52 offen offset:3072 sc1
    v_pk_fma_f32 v[38:39], v[222:223], v[204:205], v[46:47] op_sel_hi:[1,0,1] neg_lo:[0,1,0] neg_hi:[0,1,0]
    v_pk_fma_f32 v[32:33], v[136:137], v[204:205], v[32:33] op_sel:[0,1,0] op_sel_hi:[1,1,1]
    v_pk_fma_f32 v[34:35], v[138:139], v[204:205], v[34:35] op_sel:[0,1,0] op_sel_hi:[1,1,1]
    v_pk_fma_f32 v[36:37], v[152:153], v[204:205], v[36:37] op_sel:[0,1,0] op_sel_hi:[1,1,1]
    v_pk_fma_f32 v[38:39], v[154:155], v[204:205], v[38:39] op_sel:[0,1,0] op_sel_hi:[1,1,1]
    v_pk_fma_f32 v[48:49], v[32:33], v[32:33], s[74:75]
    v_pk_fma_f32 v[50:51], v[34:35], v[34:35], s[74:75]
    v_pk_fma_f32 v[52:53], v[36:37], v[36:37], s[74:75]
    v_pk_fma_f32 v[54:55], v[38:39], v[38:39], s[74:75]
    v_pk_fma_f32 v[48:49], v[48:49], v[32:33], v[112:113] neg_lo:[0,1,0] neg_hi:[0,1,0]
    v_pk_fma_f32 v[50:51], v[50:51], v[34:35], v[112:113] neg_lo:[0,1,0] neg_hi:[0,1,0]
    v_pk_fma_f32 v[52:53], v[52:53], v[36:37], v[112:113] neg_lo:[0,1,0] neg_hi:[0,1,0]
    v_pk_fma_f32 v[54:55], v[54:55], v[38:39], v[112:113] neg_lo:[0,1,0] neg_hi:[0,1,0]
    v_exp_f32 v64, v48
    v_exp_f32 v65, v49
    v_exp_f32 v66, v50
    v_exp_f32 v67, v51
    v_exp_f32 v68, v52
    v_exp_f32 v69, v53
    v_exp_f32 v70, v54
    v_exp_f32 v71, v55
    v_pk_add_f32 v[64:65], v[64:65], v[114:115]
    buffer_load_dwordx4 a[36:39], v15, s[36:39], s52 offen offset:0 sc1
    s_add_u32 s52, s52, 5120
    v_pk_add_f32 v[66:67], v[66:67], v[114:115]
    v_pk_add_f32 v[68:69], v[68:69], v[114:115]
    v_pk_add_f32 v[70:71], v[70:71], v[114:115]
    v_rcp_f32 v64, v64
    v_rcp_f32 v65, v65
    v_rcp_f32 v66, v66
    v_rcp_f32 v67, v67
    v_rcp_f32 v68, v68
    v_rcp_f32 v69, v69
    v_rcp_f32_e64 v70, v70
    v_rcp_f32 v71, v71
    s_nop 0
    v_pk_mul_f32 v[32:33], v[32:33], v[64:65]
    v_pk_mul_f32 v[34:35], v[34:35], v[66:67]
    v_pk_mul_f32 v[36:37], v[36:37], v[68:69]
    v_pk_mul_f32 v[38:39], v[38:39], v[70:71]
    v_cvt_pk_bf16_f32 v136, v32, v33
    v_cvt_pk_bf16_f32 v137, v34, v35
    v_cvt_pk_bf16_f32 v138, v36, v37
    v_cvt_pk_bf16_f32 v139, v38, v39
    s_lshr_b32 s73, s69, 1
    s_lshl_b32 s73, s73, 10
    s_add_u32 s73, s73, s76
    s_nop 0
    s_add_u32 s73, s73, 110592
    buffer_store_dwordx4 v[136:139], v18, s[36:39], s73 offen sc1
    v_pk_fma_f32 v[32:33], v[224:225], v[204:205], v[56:57] op_sel_hi:[1,0,1] neg_lo:[0,1,0] neg_hi:[0,1,0]
    v_pk_fma_f32 v[34:35], v[226:227], v[204:205], v[58:59] op_sel_hi:[1,0,1] neg_lo:[0,1,0] neg_hi:[0,1,0]
    v_pk_fma_f32 v[36:37], v[228:229], v[204:205], v[60:61] op_sel_hi:[1,0,1] neg_lo:[0,1,0] neg_hi:[0,1,0]
    buffer_load_dwordx4 a[40:43], v14, s[36:39], s52 offen offset:0 sc1
    v_pk_fma_f32 v[38:39], v[230:231], v[204:205], v[62:63] op_sel_hi:[1,0,1] neg_lo:[0,1,0] neg_hi:[0,1,0]
    v_pk_fma_f32 v[32:33], v[168:169], v[204:205], v[32:33] op_sel:[0,1,0] op_sel_hi:[1,1,1]
    v_pk_fma_f32 v[34:35], v[170:171], v[204:205], v[34:35] op_sel:[0,1,0] op_sel_hi:[1,1,1]
    v_pk_fma_f32 v[36:37], v[184:185], v[204:205], v[36:37] op_sel:[0,1,0] op_sel_hi:[1,1,1]
    v_pk_fma_f32 v[38:39], v[186:187], v[204:205], v[38:39] op_sel:[0,1,0] op_sel_hi:[1,1,1]
    v_pk_fma_f32 v[48:49], v[32:33], v[32:33], s[74:75]
    v_pk_fma_f32 v[50:51], v[34:35], v[34:35], s[74:75]
    v_pk_fma_f32 v[52:53], v[36:37], v[36:37], s[74:75]
    v_pk_fma_f32 v[54:55], v[38:39], v[38:39], s[74:75]
    v_pk_fma_f32 v[48:49], v[48:49], v[32:33], v[112:113] neg_lo:[0,1,0] neg_hi:[0,1,0]
    v_pk_fma_f32 v[50:51], v[50:51], v[34:35], v[112:113] neg_lo:[0,1,0] neg_hi:[0,1,0]
    v_pk_fma_f32 v[52:53], v[52:53], v[36:37], v[112:113] neg_lo:[0,1,0] neg_hi:[0,1,0]
    v_pk_fma_f32 v[54:55], v[54:55], v[38:39], v[112:113] neg_lo:[0,1,0] neg_hi:[0,1,0]
    v_exp_f32 v64, v48
    v_exp_f32 v65, v49
    v_exp_f32 v66, v50
    v_exp_f32 v67, v51
    v_exp_f32 v68, v52
    v_exp_f32 v69, v53
    v_exp_f32 v70, v54
    v_exp_f32 v71, v55
    v_pk_add_f32 v[64:65], v[64:65], v[114:115]
    buffer_load_dwordx4 a[44:47], v14, s[36:39], s52 offen offset:1024 sc1
    v_pk_add_f32 v[66:67], v[66:67], v[114:115]
    v_pk_add_f32 v[68:69], v[68:69], v[114:115]
    v_pk_add_f32 v[70:71], v[70:71], v[114:115]
    v_rcp_f32 v64, v64
    v_rcp_f32 v65, v65
    v_rcp_f32 v66, v66
    v_rcp_f32 v67, v67
    v_rcp_f32 v68, v68
    v_rcp_f32 v69, v69
    v_rcp_f32_e64 v70, v70
    v_rcp_f32 v71, v71
    s_nop 0
    v_pk_mul_f32 v[32:33], v[32:33], v[64:65]
    v_pk_mul_f32 v[34:35], v[34:35], v[66:67]
    v_pk_mul_f32 v[36:37], v[36:37], v[68:69]
    v_pk_mul_f32 v[38:39], v[38:39], v[70:71]
    v_cvt_pk_bf16_f32 v168, v32, v33
    v_cvt_pk_bf16_f32 v169, v34, v35
    v_cvt_pk_bf16_f32 v170, v36, v37
    v_cvt_pk_bf16_f32 v171, v38, v39
    s_lshr_b32 s73, s71, 1
    s_lshl_b32 s73, s73, 10
    s_add_u32 s73, s73, s76
    s_nop 0
    s_add_u32 s73, s73, 110592
    buffer_store_dwordx4 v[168:171], v18, s[36:39], s73 offen sc1
    v_pk_fma_f32 v[32:33], v[216:217], v[206:207], v[40:41] op_sel_hi:[1,0,1] neg_lo:[0,1,0] neg_hi:[0,1,0]
    v_pk_fma_f32 v[34:35], v[218:219], v[206:207], v[42:43] op_sel_hi:[1,0,1] neg_lo:[0,1,0] neg_hi:[0,1,0]
    v_pk_fma_f32 v[36:37], v[220:221], v[206:207], v[44:45] op_sel_hi:[1,0,1] neg_lo:[0,1,0] neg_hi:[0,1,0]
    buffer_load_dwordx4 a[48:51], v14, s[36:39], s52 offen offset:2048 sc1
    v_pk_fma_f32 v[38:39], v[222:223], v[206:207], v[46:47] op_sel_hi:[1,0,1] neg_lo:[0,1,0] neg_hi:[0,1,0]
    v_pk_fma_f32 v[32:33], v[140:141], v[206:207], v[32:33] op_sel:[0,1,0] op_sel_hi:[1,1,1]
    v_pk_fma_f32 v[34:35], v[142:143], v[206:207], v[34:35] op_sel:[0,1,0] op_sel_hi:[1,1,1]
    v_pk_fma_f32 v[36:37], v[156:157], v[206:207], v[36:37] op_sel:[0,1,0] op_sel_hi:[1,1,1]
    v_pk_fma_f32 v[38:39], v[158:159], v[206:207], v[38:39] op_sel:[0,1,0] op_sel_hi:[1,1,1]
    v_pk_fma_f32 v[48:49], v[32:33], v[32:33], s[74:75]
    v_pk_fma_f32 v[50:51], v[34:35], v[34:35], s[74:75]
    v_pk_fma_f32 v[52:53], v[36:37], v[36:37], s[74:75]
    v_pk_fma_f32 v[54:55], v[38:39], v[38:39], s[74:75]
    v_pk_fma_f32 v[48:49], v[48:49], v[32:33], v[112:113] neg_lo:[0,1,0] neg_hi:[0,1,0]
    v_pk_fma_f32 v[50:51], v[50:51], v[34:35], v[112:113] neg_lo:[0,1,0] neg_hi:[0,1,0]
    v_pk_fma_f32 v[52:53], v[52:53], v[36:37], v[112:113] neg_lo:[0,1,0] neg_hi:[0,1,0]
    v_pk_fma_f32 v[54:55], v[54:55], v[38:39], v[112:113] neg_lo:[0,1,0] neg_hi:[0,1,0]
    v_exp_f32 v64, v48
    v_exp_f32 v65, v49
    v_exp_f32 v66, v50
    v_exp_f32 v67, v51
    v_exp_f32 v68, v52
    v_exp_f32 v69, v53
    v_exp_f32 v70, v54
    v_exp_f32 v71, v55
    v_pk_add_f32 v[64:65], v[64:65], v[114:115]
    buffer_load_dwordx4 a[52:55], v14, s[36:39], s52 offen offset:3072 sc1
    v_pk_add_f32 v[66:67], v[66:67], v[114:115]
    v_pk_add_f32 v[68:69], v[68:69], v[114:115]
    v_pk_add_f32 v[70:71], v[70:71], v[114:115]
    v_rcp_f32 v64, v64
    v_rcp_f32 v65, v65
    v_rcp_f32 v66, v66
    v_rcp_f32 v67, v67
    v_rcp_f32 v68, v68
    v_rcp_f32 v69, v69
    v_rcp_f32_e64 v70, v70
    v_rcp_f32 v71, v71
    s_nop 0
    v_pk_mul_f32 v[32:33], v[32:33], v[64:65]
    v_pk_mul_f32 v[34:35], v[34:35], v[66:67]
    v_pk_mul_f32 v[36:37], v[36:37], v[68:69]
    v_pk_mul_f32 v[38:39], v[38:39], v[70:71]
    v_cvt_pk_bf16_f32 v140, v32, v33
    v_cvt_pk_bf16_f32 v141, v34, v35
    v_cvt_pk_bf16_f32 v142, v36, v37
    v_cvt_pk_bf16_f32 v143, v38, v39
    s_lshr_b32 s73, s69, 1
    s_lshl_b32 s73, s73, 10
    s_add_u32 s73, s73, s76
    s_nop 0
    s_add_u32 s73, s73, 165888
    buffer_store_dwordx4 v[140:143], v18, s[36:39], s73 offen sc1
    v_pk_fma_f32 v[32:33], v[224:225], v[206:207], v[56:57] op_sel_hi:[1,0,1] neg_lo:[0,1,0] neg_hi:[0,1,0]
    v_pk_fma_f32 v[34:35], v[226:227], v[206:207], v[58:59] op_sel_hi:[1,0,1] neg_lo:[0,1,0] neg_hi:[0,1,0]
    v_pk_fma_f32 v[36:37], v[228:229], v[206:207], v[60:61] op_sel_hi:[1,0,1] neg_lo:[0,1,0] neg_hi:[0,1,0]
    buffer_load_dwordx4 a[56:59], v15, s[36:39], s52 offen offset:0 sc1
    s_add_u32 s52, s52, 5120
    v_pk_fma_f32 v[38:39], v[230:231], v[206:207], v[62:63] op_sel_hi:[1,0,1] neg_lo:[0,1,0] neg_hi:[0,1,0]
    v_pk_fma_f32 v[32:33], v[172:173], v[206:207], v[32:33] op_sel:[0,1,0] op_sel_hi:[1,1,1]
    v_pk_fma_f32 v[34:35], v[174:175], v[206:207], v[34:35] op_sel:[0,1,0] op_sel_hi:[1,1,1]
    v_pk_fma_f32 v[36:37], v[188:189], v[206:207], v[36:37] op_sel:[0,1,0] op_sel_hi:[1,1,1]
    v_pk_fma_f32 v[38:39], v[190:191], v[206:207], v[38:39] op_sel:[0,1,0] op_sel_hi:[1,1,1]
    v_pk_fma_f32 v[48:49], v[32:33], v[32:33], s[74:75]
    v_pk_fma_f32 v[50:51], v[34:35], v[34:35], s[74:75]
    v_pk_fma_f32 v[52:53], v[36:37], v[36:37], s[74:75]
    v_pk_fma_f32 v[54:55], v[38:39], v[38:39], s[74:75]
    v_pk_fma_f32 v[48:49], v[48:49], v[32:33], v[112:113] neg_lo:[0,1,0] neg_hi:[0,1,0]
    v_pk_fma_f32 v[50:51], v[50:51], v[34:35], v[112:113] neg_lo:[0,1,0] neg_hi:[0,1,0]
    v_pk_fma_f32 v[52:53], v[52:53], v[36:37], v[112:113] neg_lo:[0,1,0] neg_hi:[0,1,0]
    v_pk_fma_f32 v[54:55], v[54:55], v[38:39], v[112:113] neg_lo:[0,1,0] neg_hi:[0,1,0]
    v_exp_f32 v64, v48
    v_exp_f32 v65, v49
    v_exp_f32 v66, v50
    v_exp_f32 v67, v51
    v_exp_f32 v68, v52
    v_exp_f32 v69, v53
    v_exp_f32 v70, v54
    v_exp_f32 v71, v55
    v_pk_add_f32 v[64:65], v[64:65], v[114:115]
    buffer_load_dwordx4 a[60:63], v14, s[36:39], s52 offen offset:0 sc1
    v_pk_add_f32 v[66:67], v[66:67], v[114:115]
    v_pk_add_f32 v[68:69], v[68:69], v[114:115]
    v_pk_add_f32 v[70:71], v[70:71], v[114:115]
    v_rcp_f32 v64, v64
    v_rcp_f32 v65, v65
    v_rcp_f32 v66, v66
    v_rcp_f32 v67, v67
    v_rcp_f32 v68, v68
    v_rcp_f32 v69, v69
    v_rcp_f32_e64 v70, v70
    v_rcp_f32 v71, v71
    s_nop 0
    v_pk_mul_f32 v[32:33], v[32:33], v[64:65]
    v_pk_mul_f32 v[34:35], v[34:35], v[66:67]
    v_pk_mul_f32 v[36:37], v[36:37], v[68:69]
    v_pk_mul_f32 v[38:39], v[38:39], v[70:71]
    v_cvt_pk_bf16_f32 v172, v32, v33
    v_cvt_pk_bf16_f32 v173, v34, v35
    v_cvt_pk_bf16_f32 v174, v36, v37
    v_cvt_pk_bf16_f32 v175, v38, v39
    s_lshr_b32 s73, s71, 1
    s_lshl_b32 s73, s73, 10
    s_add_u32 s73, s73, s76
    s_add_u32 s73, s73, 165888
    buffer_store_dwordx4 v[172:175], v18, s[36:39], s73 offen sc1
    s_lshl_b32 s48, s63, 4
    s_add_u32 s48, s48, s64
    s_lshl_b32 s48, s48, 6
    s_add_u32 s48, s48, 229376
    s_cmp_eq_u32 s3, 0
    s_cselect_b32 s48, s48, 17563648
    s_mov_b32 s50, 1
    s_lshr_b32 s78, s68, 1
    s_lshl_b32 s78, s78, 10
    s_add_u32 s29, s76, s78
C4JOIN:
    s_lshr_b32 s49, s53, 1
    s_lshl_b32 s49, s49, 10
    s_add_u32 s49, s49, 229376
    s_mul_i32 s79, s53, 216
    s_add_u32 s79, s79, s55
    s_lshl_b32 s79, s79, 10
    s_add_u32 s79, s79, 10485760
    s_add_u32 s61, s79, 14336
    s_cmp_ge_u32 s3, 2
    s_cselect_b32 s62, s79, 1
    s_lshl_b32 s60, s28, 10
    s_add_u32 s60, s60, s79
    s_add_u32 s78, s3, 0
    s_and_b32 s78, s78, 3
    s_mul_i32 s78, s78, 55296
    v_add_u32 v24, s78, v14
    s_add_u32 s78, s3, 1
    s_and_b32 s78, s78, 3
    s_mul_i32 s78, s78, 55296
    v_add_u32 v25, s78, v14
    s_add_u32 s78, s3, 2
    s_and_b32 s78, s78, 3
    s_mul_i32 s78, s78, 55296
    v_add_u32 v26, s78, v14
    s_add_u32 s78, s3, 3
    s_and_b32 s78, s78, 3
    s_mul_i32 s78, s78, 55296
    v_add_u32 v27, s78, v14
    s_mul_i32 s68, s54, 160
    v_min_u32 v18, 13, v0
    v_lshlrev_b32 v18, 6, v18
    s_waitcnt vmcnt(24) lgkmcnt(0)
    v_mov_b32_dpp v107, v100 wave_rol:1 row_mask:0xf bank_mask:0xf
    v_mov_b32_dpp v112, v101 wave_rol:1 row_mask:0xf bank_mask:0xf
    v_mov_b32_dpp v111, v116 wave_rol:1 row_mask:0xf bank_mask:0xf
    v_mov_b32_dpp v113, v117 wave_rol:1 row_mask:0xf bank_mask:0xf
    v_mov_b32 v104, v97
    v_mov_b32 v105, v98
    v_mov_b32 v106, v99
    v_mov_b32 v108, v101
    v_mov_b32 v109, v102
    v_mov_b32 v110, v103
    v_mov_b32_dpp v107, v96 wave_shl:1 row_mask:0xf bank_mask:0xf
    v_mov_b32_dpp v112, v97 wave_shl:1 row_mask:0xf bank_mask:0xf
    v_mov_b32_dpp v111, v100 wave_shl:1 row_mask:0xf bank_mask:0xf
    v_mov_b32_dpp v113, v101 wave_shl:1 row_mask:0xf bank_mask:0xf
    s_nop 1
    v_lshlrev_b32 v1, 4, v0
    v_add_u32 v5, s86, v1
    s_cmp_lg_u32 s87, 0
    s_cbranch_scc1 CV_NOPRE_7
    v_mov_b32 v20, 0
    v_mov_b32 v21, 0
    v_mov_b32 v22, 0
    v_mov_b32 v23, 0
    v_lshrrev_b32 v4, 1, v0
    v_mul_u32_u24 v4, 4160, v4
    v_and_b32 v6, 1, v0
    v_lshl_add_u32 v4, v6, 4, v4
    v_add_u32 v4, s86, v4
    s_mov_b32 exec_lo, 0xff
    s_mov_b32 exec_hi, 0
    ds_write_b128 v4, v[20:23]
    s_mov_b32 exec_lo, -1
    ds_write_b128 v5, v[20:23] offset:16640
    v_lshlrev_b32 v12, 16, v96
    v_alignbit_b32 v13, v104, v96, 16
    s_mov_b32 exec_lo, 1
    ds_write_b32 v5, v12 offset:4188
    ds_write_b32 v5, v96 offset:8348
    ds_write_b64 v5, v[12:13] offset:12504
    s_mov_b64 exec, -1
CV_NOPRE_7:
    s_lshl_b32 s78, s87, 11
    v_add_u32_e64 v5, s78, v5
    v_alignbit_b32 v32, v104, v96, 16
    v_alignbit_b32 v36, v105, v104, 16
    v_alignbit_b32 v33, v105, v97, 16
    v_alignbit_b32 v37, v106, v105, 16
    v_alignbit_b32 v34, v106, v98, 16
    v_alignbit_b32 v38, v107, v106, 16
    v_alignbit_b32 v35, v107, v99, 16
    v_alignbit_b32 v39, v112, v107, 16
    buffer_load_dwordx4 a[64:67], v14, s[36:39], s52 offen offset:1024 sc1
    buffer_load_dwordx4 a[68:71], v14, s[36:39], s52 offen offset:2048 sc1
    ds_write_b128 v5, v[96:99] offset:32
    ds_write_b128 v5, v[32:35] offset:4192
    buffer_load_dwordx4 a[72:75], v14, s[36:39], s52 offen offset:3072 sc1
    buffer_load_dwordx4 a[76:79], v15, s[36:39], s52 offen offset:0 sc1
    s_add_u32 s52, s52, 5120
    ds_write_b128 v5, v[104:107] offset:8352
    ds_write_b128 v5, v[36:39] offset:12512
    ds_write_b128 v5, v[120:123] offset:17152
    buffer_load_dwordx4 a[80:83], v14, s[36:39], s52 offen offset:0 sc1
    v_alignbit_b32 v40, v108, v100, 16
    v_alignbit_b32 v44, v109, v108, 16
    v_alignbit_b32 v41, v109, v101, 16
    v_alignbit_b32 v45, v110, v109, 16
    v_alignbit_b32 v42, v110, v102, 16
    v_alignbit_b32 v46, v111, v110, 16
    v_alignbit_b32 v43, v111, v103, 16
    v_alignbit_b32 v47, v113, v111, 16
    buffer_load_dwordx4 a[84:87], v14, s[36:39], s52 offen offset:1024 sc1
    ds_write_b128 v5, v[100:103] offset:1056
    ds_write_b128 v5, v[40:43] offset:5216
    buffer_load_dwordx4 a[88:91], v14, s[36:39], s52 offen offset:2048 sc1
    ds_write_b128 v5, v[108:111] offset:9376
    ds_write_b128 v5, v[44:47] offset:13536
    ds_write_b128 v5, v[124:127] offset:18176
    buffer_load_dwordx4 a[92:95], v14, s[36:39], s52 offen offset:3072 sc1
    v_and_b32 v6, 15, v0
    v_lshrrev_b32 v7, 4, v0
    v_add_u32 v8, 1, v6
    v_and_b32 v9, 3, v8
    v_and_b32_e64 v8, 28, v8
    v_mul_u32_u24 v9, 4160, v9
    v_lshl_add_u32 v9, v8, 1, v9
    v_lshl_add_u32 v9, v7, 4, v9
    v_add_u32 v2, s86, v9
    v_lshlrev_b32 v8, 1, v6
    v_sub_u32 v8, v8, v7
    v_lshlrev_b32 v8, 4, v8
    v_add_u32 v8, 16720, v8
    v_add_u32 v3, s86, v8
    s_lshl_b32 s78, s87, 8
    v_add_u32 v2, s78, v2
    v_subrev_u32 v3, s78, v3
    buffer_load_dwordx4 a[96:99], v15, s[36:39], s52 offen offset:0 sc1
    s_add_u32 s52, s52, 5120
    v_sub_u32 v8, 15, v6
    v_lshrrev_b32 v9, 3, v8
    v_cmp_eq_u32 s[80:81], v9, v7
    v_bfe_u32 v9, v8, 1, 2
    v_and_b32 v10, 1, v8
    v_lshlrev_b32 v10, 4, v10
    s_and_b32 s78, s84, 1
    s_lshl_b32 s78, s78, 4
    s_lshr_b32 s77, s77, s78
    s_and_b32 s77, s77, 0xffff
    s_cmp_eq_u32 s87, 0
    s_cselect_b32 s77, s77, 0
    buffer_load_dwordx4 a[100:103], v14, s[36:39], s52 offen offset:0 sc1
    v_mov_b32 v11, s77
    v_lshlrev_b32 v11, v10, v11
    v_cndmask_b32 v11, 0, v11, s[80:81]
    v_cmp_eq_u32 vcc, 0, v9
    s_nop 1
    v_cndmask_b32 v192, 0, v11, vcc
    v_cmp_eq_u32 vcc, 1, v9
    s_nop 1
    v_cndmask_b32 v193, 0, v11, vcc
    buffer_load_dwordx4 a[104:107], v14, s[36:39], s52 offen offset:1024 sc1
    v_cmp_eq_u32 vcc, 2, v9
    s_nop 1
    v_cndmask_b32 v194, 0, v11, vcc
    v_cmp_eq_u32 vcc, 3, v9
    s_nop 1
    v_cndmask_b32_e64 v195, 0, v11, vcc
    buffer_load_dwordx4 a[108:111], v14, s[36:39], s52 offen offset:2048 sc1
    buffer_load_dwordx4 a[112:115], v14, s[36:39], s52 offen offset:3072 sc1
    s_waitcnt vmcnt(13) lgkmcnt(0)
    s_barrier
    v_mov_b32 v16, s56
    v_lshlrev_b32 v17, 6, v0
    s_mov_b32 exec_lo, s50
    s_mov_b32 exec_hi, 0
    buffer_store_dword v16, v17, s[36:39], s48 offen sc1
    s_mov_b64 exec, -1
    s_nop 0
    ds_read_b128 v[64:67], v3 offset:448
    ds_read_b64 v[32:33], v2 offset:0
    ds_read_b64 v[34:35], v2 offset:8
    ds_read_b128 v[68:71], v3 offset:960
    ds_read_b64 v[36:37], v2 offset:512
    ds_read_b64 v[38:39], v2 offset:520
    ds_read_b128 v[72:75], v3 offset:1472
    ds_read_b64 v[40:41], v2 offset:1024
    ds_read_b64 v[42:43], v2 offset:1032
    ds_read_b128 v[76:79], v3 offset:1984
    ds_read_b64 v[44:45], v2 offset:1536
    ds_read_b64 v[46:47], v2 offset:1544
    ds_read_b128 v[80:83], v3 offset:2496
    ds_read_b64 v[48:49], v2 offset:2048
    ds_read_b64 v[50:51], v2 offset:2056
    ds_read_b128 v[84:87], v3 offset:3008
    ds_read_b64 v[52:53], v2 offset:2560
    ds_read_b64 v[54:55], v2 offset:2568
    ds_read_b128 v[88:91], v3 offset:3520
    ds_read_b64 v[56:57], v2 offset:3072
    ds_read_b64 v[58:59], v2 offset:3080
    ds_read_b128 v[92:95], v3 offset:4032
    ds_read_b64 v[60:61], v2 offset:3584
    ds_read_b64 v[62:63], v2 offset:3592
    s_waitcnt lgkmcnt(15)
    s_nop 0
    v_mfma_f32_16x16x32_bf16 v[160:163], v[192:195], v[64:67], 0
    ds_read_b128 v[128:131], v3 offset:384
    v_mfma_f32_16x16x32_bf16 v[164:167], v[192:195], v[68:71], 0
    ds_read_b64 v[96:97], v2 offset:64
    v_mfma_f32_16x16x32_bf16 v[168:171], v[192:195], v[72:75], 0
    ds_read_b64 v[98:99], v2 offset:72
    buffer_load_dwordx4 a[116:119], v15, s[36:39], s52 offen offset:0 sc1
    s_add_u32 s52, s52, 5120
    s_waitcnt lgkmcnt(15)
    v_mfma_f32_16x16x32_bf16 v[172:175], v[192:195], v[76:79], 0
    ds_read_b128 v[132:135], v3 offset:896
    s_waitcnt lgkmcnt(15)
    v_mfma_f32_16x16x32_bf16 v[176:179], v[192:195], v[80:83], 0
    ds_read_b64 v[100:101], v2 offset:576
    s_waitcnt lgkmcnt(13)
    v_mfma_f32_16x16x32_bf16 v[180:183], v[192:195], v[84:87], 0
    ds_read_b64 v[102:103], v2 offset:584
    s_waitcnt lgkmcnt(11)
    v_mfma_f32_16x16x32_bf16 v[184:187], v[192:195], v[88:91], 0
    ds_read_b128 v[136:139], v3 offset:1408
    s_waitcnt lgkmcnt(9)
    v_mfma_f32_16x16x32_bf16 v[188:191], v[192:195], v[92:95], 0
    ds_read_b64 v[104:105], v2 offset:1088
    buffer_load_dwordx4 a[120:123], v14, s[36:39], s52 offen offset:0 sc1
    s_waitcnt lgkmcnt(8)
    v_mfma_f32_16x16x32_bf16 v[160:163], v[32:35], v[64:67], v[160:163]
    ds_read_b64 v[106:107], v2 offset:1096
    v_mfma_f32_16x16x32_bf16 v[164:167], v[32:35], v[68:71], v[164:167]
    ds_read_b128 v[140:143], v3 offset:1920
    v_mfma_f32_16x16x32_bf16 v[168:171], v[32:35], v[72:75], v[168:171]
    ds_read_b64 v[108:109], v2 offset:1600
    v_mfma_f32_16x16x32_bf16 v[172:175], v[32:35], v[76:79], v[172:175]
    ds_read_b64 v[110:111], v2 offset:1608
    v_mfma_f32_16x16x32_bf16 v[176:179], v[32:35], v[80:83], v[176:179]
    ds_read_b128 v[144:147], v3 offset:2432
    buffer_load_dwordx4 a[124:127], v14, s[36:39], s52 offen offset:1024 sc1
    v_mfma_f32_16x16x32_bf16 v[180:183], v[32:35], v[84:87], v[180:183]
    ds_read_b64 v[112:113], v2 offset:2112
    v_mfma_f32_16x16x32_bf16 v[184:187], v[32:35], v[88:91], v[184:187]
    ds_read_b64 v[114:115], v2 offset:2120
    v_mfma_f32_16x16x32_bf16 v[188:191], v[32:35], v[92:95], v[188:191]
    ds_read_b128 v[148:151], v3 offset:2944
    v_mfma_f32_16x16x32_bf16 v[164:167], v[36:39], v[64:67], v[164:167]
    ds_read_b64 v[116:117], v2 offset:2624
    v_mfma_f32_16x16x32_bf16 v[168:171], v[36:39], v[68:71], v[168:171]
    ds_read_b64 v[118:119], v2 offset:2632
    buffer_load_dwordx4 a[128:131], v14, s[36:39], s52 offen offset:2048 sc1
    v_mfma_f32_16x16x32_bf16 v[172:175], v[36:39], v[72:75], v[172:175]
    ds_read_b128 v[152:155], v3 offset:3456
    v_mfma_f32_16x16x32_bf16 v[176:179], v[36:39], v[76:79], v[176:179]
    ds_read_b64 v[120:121], v2 offset:3136
    v_mfma_f32_16x16x32_bf16 v[180:183], v[36:39], v[80:83], v[180:183]
    ds_read_b64 v[122:123], v2 offset:3144
    v_mfma_f32_16x16x32_bf16 v[184:187], v[36:39], v[84:87], v[184:187]
    ds_read_b128 v[156:159], v3 offset:3968
    v_mfma_f32_16x16x32_bf16 v[188:191], v[36:39], v[88:91], v[188:191]
    ds_read_b64 v[124:125], v2 offset:3648
    buffer_load_dwordx4 a[132:135], v14, s[36:39], s52 offen offset:3072 sc1
    v_mfma_f32_16x16x32_bf16 v[168:171], v[40:43], v[64:67], v[168:171]
    ds_read_b64 v[126:127], v2 offset:3656
    v_mfma_f32_16x16x32_bf16 v[172:175], v[40:43], v[68:71], v[172:175]
    v_mfma_f32_16x16x32_bf16 v[176:179], v[40:43], v[72:75], v[176:179]
    v_mfma_f32_16x16x32_bf16 v[180:183], v[40:43], v[76:79], v[180:183]
    buffer_load_dwordx4 a[136:139], v15, s[36:39], s52 offen offset:0 sc1
    s_add_u32 s52, s52, 5120
    v_mfma_f32_16x16x32_bf16 v[184:187], v[40:43], v[80:83], v[184:187]
    v_mfma_f32_16x16x32_bf16 v[188:191], v[40:43], v[84:87], v[188:191]
    v_mfma_f32_16x16x32_bf16 v[172:175], v[44:47], v[64:67], v[172:175]
    v_mfma_f32_16x16x32_bf16 v[176:179], v[44:47], v[68:71], v[176:179]
    v_mfma_f32_16x16x32_bf16 v[180:183], v[44:47], v[72:75], v[180:183]
    buffer_load_dwordx4 a[140:143], v14, s[36:39], s52 offen offset:0 sc1
    v_mfma_f32_16x16x32_bf16 v[184:187], v[44:47], v[76:79], v[184:187]
    v_mfma_f32_16x16x32_bf16 v[188:191], v[44:47], v[80:83], v[188:191]
    v_mfma_f32_16x16x32_bf16 v[176:179], v[48:51], v[64:67], v[176:179]
    v_mfma_f32_16x16x32_bf16 v[180:183], v[48:51], v[68:71], v[180:183]
    v_mfma_f32_16x16x32_bf16 v[184:187], v[48:51], v[72:75], v[184:187]
    buffer_load_dwordx4 a[144:147], v14, s[36:39], s52 offen offset:1024 sc1
    v_mfma_f32_16x16x32_bf16 v[188:191], v[48:51], v[76:79], v[188:191]
    v_mfma_f32_16x16x32_bf16 v[180:183], v[52:55], v[64:67], v[180:183]
    v_mfma_f32_16x16x32_bf16 v[184:187], v[52:55], v[68:71], v[184:187]
    v_mfma_f32_16x16x32_bf16 v[188:191], v[52:55], v[72:75], v[188:191]
    v_mfma_f32_16x16x32_bf16 v[184:187], v[56:59], v[64:67], v[184:187]
    buffer_load_dwordx4 a[148:151], v14, s[36:39], s52 offen offset:2048 sc1
PAGE4:
    s_cbranch_execz VISIT_RET
    v_mfma_f32_16x16x32_bf16 v[188:191], v[56:59], v[68:71], v[188:191]
    v_mfma_f32_16x16x32_bf16 v[188:191], v[60:63], v[64:67], v[188:191]
    s_waitcnt lgkmcnt(0)
    v_mfma_f32_16x16x32_bf16 v[160:163], v[96:99], v[128:131], v[160:163]
    ds_read_b128 v[64:67], v3 offset:320
    v_and_b32_e64 v20, 15, v0
    v_mfma_f32_16x16x32_bf16 v[164:167], v[96:99], v[132:135], v[164:167]
    ds_read_b64 v[32:33], v2 offset:128
    buffer_load_dwordx4 a[152:155], v14, s[36:39], s52 offen offset:3072 sc1
    v_mfma_f32_16x16x32_bf16 v[168:171], v[96:99], v[136:139], v[168:171]
    ds_read_b64 v[34:35], v2 offset:136
    v_mfma_f32_16x16x32_bf16 v[172:175], v[96:99], v[140:143], v[172:175]
    ds_read_b128 v[68:71], v3 offset:832
    v_mfma_f32_16x16x32_bf16 v[176:179], v[96:99], v[144:147], v[176:179]
    ds_read_b64 v[36:37], v2 offset:640
    v_lshrrev_b32_e64 v21, 4, v0
    v_mfma_f32_16x16x32_bf16 v[180:183], v[96:99], v[148:151], v[180:183]
    ds_read_b64 v[38:39], v2 offset:648
    buffer_load_dwordx4 a[156:159], v15, s[36:39], s52 offen offset:0 sc1
    s_add_u32 s52, s52, 5120
    v_mfma_f32_16x16x32_bf16 v[184:187], v[96:99], v[152:155], v[184:187]
    ds_read_b128 v[72:75], v3 offset:1344
    v_mfma_f32_16x16x32_bf16 v[188:191], v[96:99], v[156:159], v[188:191]
    ds_read_b64 v[40:41], v2 offset:1152
    v_mfma_f32_16x16x32_bf16 v[164:167], v[100:103], v[128:131], v[164:167]
    ds_read_b64 v[42:43], v2 offset:1160
    v_mfma_f32_16x16x32_bf16 v[168:171], v[100:103], v[132:135], v[168:171]
    ds_read_b128 v[76:79], v3 offset:1856
    buffer_load_dwordx4 a[160:163], v14, s[36:39], s52 offen offset:0 sc1
    v_mfma_f32_16x16x32_bf16 v[172:175], v[100:103], v[136:139], v[172:175]
    ds_read_b64 v[44:45], v2 offset:1664
    s_lshl_b32 s69, s53, 6
    s_nop 0
    v_mfma_f32_16x16x32_bf16 v[176:179], v[100:103], v[140:143], v[176:179]
    ds_read_b64 v[46:47], v2 offset:1672
    v_mfma_f32_16x16x32_bf16 v[180:183], v[100:103], v[144:147], v[180:183]
    ds_read_b128 v[80:83], v3 offset:2368
    buffer_load_dwordx4 a[164:167], v14, s[36:39], s52 offen offset:1024 sc1
    v_mfma_f32_16x16x32_bf16 v[184:187], v[100:103], v[148:151], v[184:187]
    ds_read_b64 v[48:49], v2 offset:2176
    v_mfma_f32_16x16x32_bf16 v[188:191], v[100:103], v[152:155], v[188:191]
    ds_read_b64 v[50:51], v2 offset:2184
    v_mfma_f32_16x16x32_bf16 v[168:171], v[104:107], v[128:131], v[168:171]
    ds_read_b128 v[84:87], v3 offset:2880
    s_lshl_b32 s70, s3, 4
    s_nop 0
    v_mfma_f32_16x16x32_bf16 v[172:175], v[104:107], v[132:135], v[172:175]
    ds_read_b64 v[52:53], v2 offset:2688
    buffer_load_dwordx4 a[168:171], v14, s[36:39], s52 offen offset:2048 sc1
    v_mfma_f32_16x16x32_bf16 v[176:179], v[104:107], v[136:139], v[176:179]
    ds_read_b64 v[54:55], v2 offset:2696
    v_mfma_f32_16x16x32_bf16 v[180:183], v[104:107], v[140:143], v[180:183]
    ds_read_b128 v[88:91], v3 offset:3392
    v_mfma_f32_16x16x32_bf16 v[184:187], v[104:107], v[144:147], v[184:187]
    ds_read_b64 v[56:57], v2 offset:3200
    buffer_load_dwordx4 a[172:175], v14, s[36:39], s52 offen offset:3072 sc1
    v_mfma_f32_16x16x32_bf16 v[188:191], v[104:107], v[148:151], v[188:191]
    ds_read_b64 v[58:59], v2 offset:3208
    v_mfma_f32_16x16x32_bf16 v[172:175], v[108:111], v[128:131], v[172:175]
    ds_read_b128 v[92:95], v3 offset:3904
    s_add_u32 s70, s70, s69
    v_mfma_f32_16x16x32_bf16 v[176:179], v[108:111], v[132:135], v[176:179]
    ds_read_b64 v[60:61], v2 offset:3712
    v_mfma_f32_16x16x32_bf16 v[180:183], v[108:111], v[136:139], v[180:183]
    ds_read_b64 v[62:63], v2 offset:3720
    buffer_load_dwordx4 a[176:179], v15, s[36:39], s52 offen offset:0 sc1
    s_add_u32 s52, s52, 5120
    v_mfma_f32_16x16x32_bf16 v[184:187], v[108:111], v[140:143], v[184:187]
    v_mfma_f32_16x16x32_bf16 v[188:191], v[108:111], v[144:147], v[188:191]
    v_add_u32 v22, s70, v20
    v_mfma_f32_16x16x32_bf16 v[176:179], v[112:115], v[128:131], v[176:179]
    v_mul_u32_u24 v28, 1280, v22
    v_mfma_f32_16x16x32_bf16 v[180:183], v[112:115], v[132:135], v[180:183]
    buffer_load_dwordx4 a[180:183], v14, s[36:39], s52 offen offset:0 sc1
    v_mfma_f32_16x16x32_bf16 v[184:187], v[112:115], v[136:139], v[184:187]
    v_mfma_f32_16x16x32_bf16 v[188:191], v[112:115], v[140:143], v[188:191]
    v_lshl_add_u32 v29, v21, 3, v28
    v_mfma_f32_16x16x32_bf16 v[180:183], v[116:119], v[128:131], v[180:183]
    buffer_load_dwordx4 a[184:187], v14, s[36:39], s52 offen offset:1024 sc1
    v_mfma_f32_16x16x32_bf16 v[184:187], v[116:119], v[132:135], v[184:187]
    v_lshl_add_u32 v28, v21, 4, v28
    v_mfma_f32_16x16x32_bf16 v[188:191], v[116:119], v[136:139], v[188:191]
    v_mfma_f32_16x16x32_bf16 v[184:187], v[120:123], v[128:131], v[184:187]
    v_lshlrev_b32 v22, 3, v22
    v_mfma_f32_16x16x32_bf16 v[188:191], v[120:123], v[132:135], v[188:191]
    buffer_load_dwordx4 a[188:191], v14, s[36:39], s52 offen offset:2048 sc1
    v_mfma_f32_16x16x32_bf16 v[188:191], v[124:127], v[128:131], v[188:191]
    s_waitcnt lgkmcnt(0)
    v_mfma_f32_16x16x32_bf16 v[160:163], v[32:35], v[64:67], v[160:163]
    ds_read_b128 v[128:131], v3 offset:256
    v_mfma_f32_16x16x32_bf16 v[164:167], v[32:35], v[68:71], v[164:167]
    ds_read_b64 v[96:97], v2 offset:192
    buffer_load_dwordx4 a[192:195], v14, s[36:39], s52 offen offset:3072 sc1
    v_mfma_f32_16x16x32_bf16 v[168:171], v[32:35], v[72:75], v[168:171]
    ds_read_b64 v[98:99], v2 offset:200
    v_mfma_f32_16x16x32_bf16 v[172:175], v[32:35], v[76:79], v[172:175]
    ds_read_b128 v[132:135], v3 offset:768
    v_mfma_f32_16x16x32_bf16 v[176:179], v[32:35], v[80:83], v[176:179]
    ds_read_b64 v[100:101], v2 offset:704
    buffer_load_dwordx4 a[196:199], v15, s[36:39], s52 offen offset:0 sc1
    s_add_u32 s52, s52, 5120
    v_mfma_f32_16x16x32_bf16 v[180:183], v[32:35], v[84:87], v[180:183]
    ds_read_b64 v[102:103], v2 offset:712
    v_mfma_f32_16x16x32_bf16 v[184:187], v[32:35], v[88:91], v[184:187]
    ds_read_b128 v[136:139], v3 offset:1280
    v_mfma_f32_16x16x32_bf16 v[188:191], v[32:35], v[92:95], v[188:191]
    ds_read_b64 v[104:105], v2 offset:1216
    v_mfma_f32_16x16x32_bf16 v[164:167], v[36:39], v[64:67], v[164:167]
    ds_read_b64 v[106:107], v2 offset:1224
    buffer_load_dwordx4 a[200:203], v14, s[36:39], s52 offen offset:0 sc1
    v_mfma_f32_16x16x32_bf16 v[168:171], v[36:39], v[68:71], v[168:171]
    ds_read_b128 v[140:143], v3 offset:1792
    v_mfma_f32_16x16x32_bf16 v[172:175], v[36:39], v[72:75], v[172:175]
    ds_read_b64 v[108:109], v2 offset:1728
    v_mfma_f32_16x16x32_bf16 v[176:179], v[36:39], v[76:79], v[176:179]
    ds_read_b64 v[110:111], v2 offset:1736
    buffer_load_dwordx4 a[204:207], v14, s[36:39], s52 offen offset:1024 sc1
    v_mfma_f32_16x16x32_bf16 v[180:183], v[36:39], v[80:83], v[180:183]
    ds_read_b128 v[144:147], v3 offset:2304
    v_mfma_f32_16x16x32_bf16 v[184:187], v[36:39], v[84:87], v[184:187]
    ds_read_b64 v[112:113], v2 offset:2240
    v_mfma_f32_16x16x32_bf16 v[188:191], v[36:39], v[88:91], v[188:191]
    ds_read_b64 v[114:115], v2 offset:2248
    buffer_load_dwordx4 a[208:211], v14, s[36:39], s52 offen offset:2048 sc1
    v_mfma_f32_16x16x32_bf16 v[168:171], v[40:43], v[64:67], v[168:171]
    ds_read_b128 v[148:151], v3 offset:2816
    v_mfma_f32_16x16x32_bf16 v[172:175], v[40:43], v[68:71], v[172:175]
    ds_read_b64 v[116:117], v2 offset:2752
    v_mfma_f32_16x16x32_bf16 v[176:179], v[40:43], v[72:75], v[176:179]
    ds_read_b64 v[118:119], v2 offset:2760
    v_mfma_f32_16x16x32_bf16 v[180:183], v[40:43], v[76:79], v[180:183]
    ds_read_b128 v[152:155], v3 offset:3328
    buffer_load_dwordx4 a[212:215], v14, s[36:39], s52 offen offset:3072 sc1
    v_mfma_f32_16x16x32_bf16 v[184:187], v[40:43], v[80:83], v[184:187]
    ds_read_b64 v[120:121], v2 offset:3264
    v_mfma_f32_16x16x32_bf16 v[188:191], v[40:43], v[84:87], v[188:191]
    ds_read_b64 v[122:123], v2 offset:3272
    v_mfma_f32_16x16x32_bf16 v[172:175], v[44:47], v[64:67], v[172:175]
    ds_read_b128 v[156:159], v3 offset:3840
    buffer_load_dwordx4 a[216:219], v15, s[36:39], s52 offen offset:0 sc1
    s_add_u32 s52, s52, 5120
    v_mfma_f32_16x16x32_bf16 v[176:179], v[44:47], v[68:71], v[176:179]
    ds_read_b64 v[124:125], v2 offset:3776
    v_mfma_f32_16x16x32_bf16 v[180:183], v[44:47], v[72:75], v[180:183]
    ds_read_b64 v[126:127], v2 offset:3784
    v_mfma_f32_16x16x32_bf16 v[184:187], v[44:47], v[76:79], v[184:187]
    buffer_load_dwordx4 a[220:223], v14, s[36:39], s52 offen offset:0 sc1
    v_mfma_f32_16x16x32_bf16 v[188:191], v[44:47], v[80:83], v[188:191]
    v_mfma_f32_16x16x32_bf16 v[176:179], v[48:51], v[64:67], v[176:179]
    v_mfma_f32_16x16x32_bf16 v[180:183], v[48:51], v[68:71], v[180:183]
    buffer_load_dwordx4 a[224:227], v14, s[36:39], s52 offen offset:1024 sc1
    v_mfma_f32_16x16x32_bf16 v[184:187], v[48:51], v[72:75], v[184:187]
    v_mfma_f32_16x16x32_bf16 v[188:191], v[48:51], v[76:79], v[188:191]
    v_mfma_f32_16x16x32_bf16 v[180:183], v[52:55], v[64:67], v[180:183]
    v_mfma_f32_16x16x32_bf16 v[184:187], v[52:55], v[68:71], v[184:187]
    buffer_load_dwordx4 a[228:231], v14, s[36:39], s52 offen offset:2048 sc1
    v_mfma_f32_16x16x32_bf16 v[188:191], v[52:55], v[72:75], v[188:191]
    v_mfma_f32_16x16x32_bf16 v[184:187], v[56:59], v[64:67], v[184:187]
    v_mfma_f32_16x16x32_bf16 v[188:191], v[56:59], v[68:71], v[188:191]
    buffer_load_dwordx4 a[232:235], v14, s[36:39], s52 offen offset:3072 sc1
    v_mfma_f32_16x16x32_bf16 v[188:191], v[60:63], v[64:67], v[188:191]
    s_waitcnt lgkmcnt(0)
    s_nop 0
    v_mfma_f32_16x16x32_bf16 v[160:163], v[96:99], v[128:131], v[160:163]
    v_mfma_f32_16x16x32_bf16 v[164:167], v[96:99], v[132:135], v[164:167]
    buffer_load_dwordx4 a[236:239], v15, s[36:39], s52 offen offset:0 sc1
    s_add_u32 s52, s52, 5120
    v_mfma_f32_16x16x32_bf16 v[168:171], v[96:99], v[136:139], v[168:171]
    v_mfma_f32_16x16x32_bf16 v[172:175], v[96:99], v[140:143], v[172:175]
    v_mfma_f32_16x16x32_bf16 v[176:179], v[96:99], v[144:147], v[176:179]
    buffer_load_dwordx4 v[196:199], v14, s[36:39], s52 offen offset:0 sc1
    v_mfma_f32_16x16x32_bf16 v[180:183], v[96:99], v[148:151], v[180:183]
    v_mfma_f32_16x16x32_bf16 v[184:187], v[96:99], v[152:155], v[184:187]
    v_mfma_f32_16x16x32_bf16 v[188:191], v[96:99], v[156:159], v[188:191]
    v_mfma_f32_16x16x32_bf16 v[164:167], v[100:103], v[128:131], v[164:167]
    buffer_load_dwordx4 v[200:203], v14, s[36:39], s52 offen offset:1024 sc1
    v_mfma_f32_16x16x32_bf16 v[168:171], v[100:103], v[132:135], v[168:171]
    v_mfma_f32_16x16x32_bf16 v[172:175], v[100:103], v[136:139], v[172:175]
    buffer_load_dword v19, v18, s[36:39], s49 offen sc1
    v_mfma_f32_16x16x32_bf16 v[176:179], v[100:103], v[140:143], v[176:179]
    buffer_load_dwordx4 v[204:207], v14, s[36:39], s52 offen offset:2048 sc1
    v_mfma_f32_16x16x32_bf16 v[180:183], v[100:103], v[144:147], v[180:183]
    v_mfma_f32_16x16x32_bf16 v[184:187], v[100:103], v[148:151], v[184:187]
    v_mfma_f32_16x16x32_bf16 v[188:191], v[100:103], v[152:155], v[188:191]
    buffer_load_dwordx4 v[208:211], v14, s[36:39], s52 offen offset:3072 sc1
    v_mfma_f32_16x16x32_bf16 v[168:171], v[104:107], v[128:131], v[168:171]
    v_mfma_f32_16x16x32_bf16 v[172:175], v[104:107], v[132:135], v[172:175]
    v_mfma_f32_16x16x32_bf16 v[176:179], v[104:107], v[136:139], v[176:179]
    v_mfma_f32_16x16x32_bf16 v[180:183], v[104:107], v[140:143], v[180:183]
    buffer_load_dwordx4 v[212:215], v15, s[36:39], s52 offen offset:0 sc1
    s_add_u32 s52, s52, 5120
    v_mfma_f32_16x16x32_bf16 v[184:187], v[104:107], v[144:147], v[184:187]
    v_mfma_f32_16x16x32_bf16 v[188:191], v[104:107], v[148:151], v[188:191]
    v_mfma_f32_16x16x32_bf16 v[172:175], v[108:111], v[128:131], v[172:175]
    buffer_load_dwordx4 v[216:219], v14, s[36:39], s52 offen offset:0 sc1
    v_mfma_f32_16x16x32_bf16 v[176:179], v[108:111], v[132:135], v[176:179]
    v_mfma_f32_16x16x32_bf16 v[180:183], v[108:111], v[136:139], v[180:183]
    v_mfma_f32_16x16x32_bf16 v[184:187], v[108:111], v[140:143], v[184:187]
    buffer_load_dwordx4 v[220:223], v14, s[36:39], s52 offen offset:1024 sc1
    v_mfma_f32_16x16x32_bf16 v[188:191], v[108:111], v[144:147], v[188:191]
    v_mfma_f32_16x16x32_bf16 v[176:179], v[112:115], v[128:131], v[176:179]
    v_mfma_f32_16x16x32_bf16 v[180:183], v[112:115], v[132:135], v[180:183]
    buffer_load_dwordx4 v[224:227], v14, s[36:39], s52 offen offset:2048 sc1
    v_mfma_f32_16x16x32_bf16 v[184:187], v[112:115], v[136:139], v[184:187]
    v_mfma_f32_16x16x32_bf16 v[188:191], v[112:115], v[140:143], v[188:191]
    v_mfma_f32_16x16x32_bf16 v[180:183], v[116:119], v[128:131], v[180:183]
    v_mfma_f32_16x16x32_bf16 v[184:187], v[116:119], v[132:135], v[184:187]
    buffer_load_dwordx4 v[228:231], v14, s[36:39], s52 offen offset:3072 sc1
    v_mfma_f32_16x16x32_bf16 v[188:191], v[116:119], v[136:139], v[188:191]
    v_mfma_f32_16x16x32_bf16 v[184:187], v[120:123], v[128:131], v[184:187]
    v_mfma_f32_16x16x32_bf16 v[188:191], v[120:123], v[132:135], v[188:191]
    buffer_load_dwordx4 v[232:235], v15, s[36:39], s52 offen offset:0 sc1
    v_mfma_f32_16x16x32_bf16 v[188:191], v[124:127], v[128:131], v[188:191]
    s_nop 3
    s_waitcnt vmcnt(8)
    v_cmp_ne_u32 vcc, s56, v19
    s_mov_b64 s[82:83], vcc
    s_cmp_eq_u64 s[82:83], 0
    s_cbranch_scc0 FH_RETRY_8
FH_DONE_9:
    s_mov_b32 s71, 65536
    buffer_load_dwordx2 v[254:255], v22, s[36:39], s71 offen sc1
    s_cmp_eq_u32 s60, s62
    s_cselect_b32 s63, 17563648, s60
    buffer_load_dwordx4 v[48:51], v24, s[36:39], s63 offen offset:0 sc1
    v_lshlrev_b32 v9, 4, v0
    buffer_load_dwordx4 v[52:55], v25, s[36:39], s63 offen offset:0 sc1
    s_lshl_b32 s78, s3, 12
    buffer_load_dwordx4 v[56:59], v26, s[36:39], s63 offen offset:0 sc1
    s_add_u32 s78, s78, 84992
    v_add_u32 v10, s78, v9
    buffer_load_dwordx4 v[60:63], v27, s[36:39], s63 offen offset:0 sc1
    s_xor_b32 s78, s3, 1
    buffer_load_dwordx4 v[64:67], v24, s[36:39], s60 offen offset:1024 sc1
    s_lshl_b32 s78, s78, 12
    s_add_u32 s78, s78, 84992
    buffer_load_dwordx4 v[68:71], v25, s[36:39], s60 offen offset:1024 sc1
    v_add_u32 v11, s78, v9
    buffer_load_dwordx4 v[72:75], v26, s[36:39], s60 offen offset:1024 sc1
    s_cmp_lg_u32 s87, 0
    s_cselect_b32 s78, -1, 0
    buffer_load_dwordx4 v[76:79], v27, s[36:39], s60 offen offset:1024 sc1
    s_mov_b32 exec_lo, s78
    s_mov_b32 exec_hi, s78
    v_swap_b32 v160, v176
    v_swap_b32 v161, v177
    v_swap_b32 v162, v178
    v_swap_b32 v163, v179
    s_mov_b64 exec, -1
    ds_write_b128 v10, v[176:179] offset:0
    buffer_load_dwordx4 v[80:83], v24, s[36:39], s60 offen offset:2048 sc1
    s_mov_b32 exec_lo, s78
    s_mov_b32 exec_hi, s78
    v_swap_b32 v164, v180
    v_swap_b32 v165, v181
    v_swap_b32 v166, v182
    v_swap_b32 v167, v183
    s_mov_b64 exec, -1
    buffer_load_dwordx4 v[84:87], v25, s[36:39], s60 offen offset:2048 sc1
    ds_write_b128 v10, v[180:183] offset:1024
    s_mov_b32 exec_lo, s78
    s_mov_b32 exec_hi, s78
    v_swap_b32 v168, v184
    v_swap_b32 v169, v185
    v_swap_b32 v170, v186
    v_swap_b32 v171, v187
    s_mov_b64 exec, -1
    buffer_load_dwordx4 v[88:91], v26, s[36:39], s60 offen offset:2048 sc1
    ds_write_b128 v10, v[184:187] offset:2048
    buffer_load_dwordx4 v[92:95], v27, s[36:39], s60 offen offset:2048 sc1
    s_mov_b32 exec_lo, s78
    s_mov_b32 exec_hi, s78
    v_swap_b32 v172, v188
    v_swap_b32 v173, v189
    v_swap_b32 v174, v190
    v_swap_b32 v175, v191
    s_mov_b64 exec, -1
    ds_write_b128 v10, v[188:191] offset:3072
    s_waitcnt lgkmcnt(0)
    s_barrier
    s_nop 0
    buffer_load_dwordx4 v[96:99], v24, s[36:39], s60 offen offset:3072 sc1
    ds_read_b128 v[32:35], v11 offset:0
    ds_read_b128 v[36:39], v11 offset:1024
    ds_read_b128 v[40:43], v11 offset:2048
    ds_read_b128 v[44:47], v11 offset:3072
    s_waitcnt lgkmcnt(0)
    s_nop 0
    v_pk_add_f32 v[160:161], v[160:161], v[32:33]
    v_pk_add_f32 v[162:163], v[162:163], v[34:35]
    v_pk_add_f32 v[164:165], v[164:165], v[36:37]
    buffer_load_dwordx4 v[100:103], v25, s[36:39], s60 offen offset:3072 sc1
    v_pk_add_f32 v[166:167], v[166:167], v[38:39]
    v_pk_add_f32 v[168:169], v[168:169], v[40:41]
    v_pk_add_f32 v[170:171], v[170:171], v[42:43]
    v_pk_add_f32 v[172:173], v[172:173], v[44:45]
    v_pk_add_f32 v[174:175], v[174:175], v[46:47]
    s_lshl_b32 s79, s87, 11
    s_add_u32 s79, s79, s85
    s_add_u32 s79, s79, 7340032
    v_bfe_u32 v8, v0, 4, 1
    buffer_load_dwordx4 v[236:239], v26, s[36:39], s60 offen offset:3072 sc1
    v_lshlrev_b32 v8, 9, v8
    v_and_b32 v9, 15, v0
    v_lshl_add_u32 v8, v9, 5, v8
    v_lshrrev_b32_e64 v9, 5, v0
    v_lshl_add_u32 v8, v9, 4, v8
    v_cvt_pk_bf16_f32 v32, v160, v161
    v_cvt_pk_bf16_f32 v33, v162, v163
    v_cvt_pk_bf16_f32 v34, v164, v165
    v_cvt_pk_bf16_f32 v35, v166, v167
    buffer_load_dwordx4 v[240:243], v27, s[36:39], s60 offen offset:3072 sc1
    s_add_u32 s60, s60, 4096
    v_cvt_pk_bf16_f32 v36, v168, v169
    v_cvt_pk_bf16_f32 v37, v170, v171
    v_cvt_pk_bf16_f32 v38, v172, v173
    v_cvt_pk_bf16_f32 v39, v174, v175
    s_nop 1
    v_permlane16_swap_b32 v32, v34
    v_permlane16_swap_b32 v33, v35
    v_permlane16_swap_b32 v36, v38
    v_permlane16_swap_b32 v37, v39
    buffer_store_dwordx4 v[32:35], v8, s[36:39], s79 offen offset:0 sc1
    buffer_store_dwordx4 v[36:39], v8, s[36:39], s79 offen offset:1024 sc1
G2_START:
    s_lshr_b32 s72, s84, 1
    s_lshl_b32 s72, s72, 6
    s_add_u32 s72, s72, 262144
    s_cmp_eq_u32 s3, 0
    s_cselect_b32 s72, s72, 17563648
    s_mul_i32 s59, s54, 2560
    s_add_u32 s59, s59, 262144
    v_min_u32 v18, 39, v0
    v_lshlrev_b32 v18, 6, v18
    v_accvgpr_read_b32 v105, a240
    v_accvgpr_read_b32 v107, a241
    v_accvgpr_read_b32 v109, a242
    v_accvgpr_read_b32 v111, a243
    v_accvgpr_read_b32 v113, a244
    v_accvgpr_read_b32 v115, a245
    v_accvgpr_read_b32 v117, a246
    v_accvgpr_read_b32 v119, a247
    v_accvgpr_read_b32 v121, a248
    v_accvgpr_read_b32 v123, a249
    v_lshlrev_b32 v104, 16, v105
    v_and_b32 v105, 0xffff0000, v105
    v_lshlrev_b32 v106, 16, v107
    v_and_b32 v107, 0xffff0000, v107
    v_lshlrev_b32 v108, 16, v109
    v_and_b32 v109, 0xffff0000, v109
    v_lshlrev_b32 v110, 16, v111
    v_and_b32 v111, 0xffff0000, v111
    v_lshlrev_b32 v112, 16, v113
    v_and_b32 v113, 0xffff0000, v113
    v_lshlrev_b32 v114, 16, v115
    v_and_b32 v115, 0xffff0000, v115
    v_lshlrev_b32 v116, 16, v117
    v_and_b32 v117, 0xffff0000, v117
    v_lshlrev_b32 v118, 16, v119
    v_and_b32 v119, 0xffff0000, v119
    v_lshlrev_b32 v120, 16, v121
    v_and_b32 v121, 0xffff0000, v121
    v_lshlrev_b32 v122, 16, v123
    v_and_b32 v123, 0xffff0000, v123
    s_waitcnt vmcnt(14)
    v_mfma_f32_16x16x32_bf16 v[104:107], a[0:3], v[48:51], v[104:107]
    v_mfma_f32_16x16x32_bf16 v[124:127], a[0:3], v[52:55], 0
    buffer_load_dwordx4 v[32:35], v24, s[36:39], s60 offen offset:0 sc1
    v_mfma_f32_16x16x32_bf16 v[144:147], a[0:3], v[56:59], 0
    v_mfma_f32_16x16x32_bf16 v[164:167], a[0:3], v[60:63], 0
    v_mfma_f32_16x16x32_bf16 v[108:111], a[4:7], v[48:51], v[108:111]
    v_mfma_f32_16x16x32_bf16 v[128:131], a[4:7], v[52:55], 0
    buffer_load_dwordx4 v[36:39], v25, s[36:39], s60 offen offset:0 sc1
    v_mfma_f32_16x16x32_bf16 v[148:151], a[4:7], v[56:59], 0
    v_mfma_f32_16x16x32_bf16 v[168:171], a[4:7], v[60:63], 0
    v_mfma_f32_16x16x32_bf16 v[112:115], a[8:11], v[48:51], v[112:115]
    v_mfma_f32_16x16x32_bf16 v[132:135], a[8:11], v[52:55], 0
    buffer_load_dwordx4 v[40:43], v26, s[36:39], s60 offen offset:0 sc1
    v_mfma_f32_16x16x32_bf16 v[152:155], a[8:11], v[56:59], 0
    v_mfma_f32_16x16x32_bf16 v[172:175], a[8:11], v[60:63], 0
    v_mfma_f32_16x16x32_bf16 v[116:119], a[12:15], v[48:51], v[116:119]
    v_mfma_f32_16x16x32_bf16 v[136:139], a[12:15], v[52:55], 0
    buffer_load_dwordx4 v[44:47], v27, s[36:39], s60 offen offset:0 sc1
    v_mfma_f32_16x16x32_bf16 v[156:159], a[12:15], v[56:59], 0
    v_mfma_f32_16x16x32_bf16 v[176:179], a[12:15], v[60:63], 0
    v_mfma_f32_16x16x32_bf16 v[120:123], a[16:19], v[48:51], v[120:123]
    v_mfma_f32_16x16x32_bf16 v[140:143], a[16:19], v[52:55], 0
    v_mfma_f32_16x16x32_bf16 v[160:163], a[16:19], v[56:59], 0
    v_mfma_f32_16x16x32_bf16 v[180:183], a[16:19], v[60:63], 0
    s_waitcnt vmcnt(14)
    v_mfma_f32_16x16x32_bf16 v[104:107], a[20:23], v[64:67], v[104:107]
    v_mfma_f32_16x16x32_bf16 v[124:127], a[20:23], v[68:71], v[124:127]
    buffer_load_dwordx4 v[48:51], v24, s[36:39], s60 offen offset:1024 sc1
    v_mfma_f32_16x16x32_bf16 v[144:147], a[20:23], v[72:75], v[144:147]
    v_mfma_f32_16x16x32_bf16 v[164:167], a[20:23], v[76:79], v[164:167]
    v_mfma_f32_16x16x32_bf16 v[108:111], a[24:27], v[64:67], v[108:111]
    v_mfma_f32_16x16x32_bf16 v[128:131], a[24:27], v[68:71], v[128:131]
    buffer_load_dwordx4 v[52:55], v25, s[36:39], s60 offen offset:1024 sc1
    v_mfma_f32_16x16x32_bf16 v[148:151], a[24:27], v[72:75], v[148:151]
    v_mfma_f32_16x16x32_bf16 v[168:171], a[24:27], v[76:79], v[168:171]
    v_mfma_f32_16x16x32_bf16 v[112:115], a[28:31], v[64:67], v[112:115]
    v_mfma_f32_16x16x32_bf16 v[132:135], a[28:31], v[68:71], v[132:135]
    buffer_load_dwordx4 v[56:59], v26, s[36:39], s60 offen offset:1024 sc1
    v_mfma_f32_16x16x32_bf16 v[152:155], a[28:31], v[72:75], v[152:155]
    v_mfma_f32_16x16x32_bf16 v[172:175], a[28:31], v[76:79], v[172:175]
    v_mfma_f32_16x16x32_bf16 v[116:119], a[32:35], v[64:67], v[116:119]
    v_mfma_f32_16x16x32_bf16 v[136:139], a[32:35], v[68:71], v[136:139]
    buffer_load_dwordx4 v[60:63], v27, s[36:39], s60 offen offset:1024 sc1
    v_mfma_f32_16x16x32_bf16 v[156:159], a[32:35], v[72:75], v[156:159]
    v_mfma_f32_16x16x32_bf16 v[176:179], a[32:35], v[76:79], v[176:179]
    v_mfma_f32_16x16x32_bf16 v[120:123], a[36:39], v[64:67], v[120:123]
    v_mfma_f32_16x16x32_bf16 v[140:143], a[36:39], v[68:71], v[140:143]
    v_mfma_f32_16x16x32_bf16 v[160:163], a[36:39], v[72:75], v[160:163]
    v_mfma_f32_16x16x32_bf16 v[180:183], a[36:39], v[76:79], v[180:183]
    s_waitcnt vmcnt(14)
    v_mfma_f32_16x16x32_bf16 v[104:107], a[40:43], v[80:83], v[104:107]
    v_mfma_f32_16x16x32_bf16 v[124:127], a[40:43], v[84:87], v[124:127]
    buffer_load_dwordx4 v[64:67], v24, s[36:39], s60 offen offset:2048 sc1
    v_mfma_f32_16x16x32_bf16 v[144:147], a[40:43], v[88:91], v[144:147]
    v_lshrrev_b32 v4, 4, v0
    v_mfma_f32_16x16x32_bf16 v[164:167], a[40:43], v[92:95], v[164:167]
    v_mfma_f32_16x16x32_bf16 v[108:111], a[44:47], v[80:83], v[108:111]
    v_mfma_f32_16x16x32_bf16 v[128:131], a[44:47], v[84:87], v[128:131]
    buffer_load_dwordx4 v[68:71], v25, s[36:39], s60 offen offset:2048 sc1
    v_mfma_f32_16x16x32_bf16 v[148:151], a[44:47], v[88:91], v[148:151]
    v_mfma_f32_16x16x32_bf16 v[168:171], a[44:47], v[92:95], v[168:171]
    v_mfma_f32_16x16x32_bf16 v[112:115], a[48:51], v[80:83], v[112:115]
    v_mfma_f32_16x16x32_bf16 v[132:135], a[48:51], v[84:87], v[132:135]
    buffer_load_dwordx4 v[72:75], v26, s[36:39], s60 offen offset:2048 sc1
    v_mfma_f32_16x16x32_bf16 v[152:155], a[48:51], v[88:91], v[152:155]
    v_mfma_f32_16x16x32_bf16 v[172:175], a[48:51], v[92:95], v[172:175]
    v_mfma_f32_16x16x32_bf16 v[116:119], a[52:55], v[80:83], v[116:119]
    v_mfma_f32_16x16x32_bf16 v[136:139], a[52:55], v[84:87], v[136:139]
    buffer_load_dwordx4 v[76:79], v27, s[36:39], s60 offen offset:2048 sc1
    v_mfma_f32_16x16x32_bf16 v[156:159], a[52:55], v[88:91], v[156:159]
    v_mfma_f32_16x16x32_bf16 v[176:179], a[52:55], v[92:95], v[176:179]
    v_mfma_f32_16x16x32_bf16 v[120:123], a[56:59], v[80:83], v[120:123]
    v_mfma_f32_16x16x32_bf16 v[140:143], a[56:59], v[84:87], v[140:143]
    v_mfma_f32_16x16x32_bf16 v[160:163], a[56:59], v[88:91], v[160:163]
    v_mfma_f32_16x16x32_bf16 v[180:183], a[56:59], v[92:95], v[180:183]
    s_waitcnt vmcnt(12)
    s_barrier
    v_mov_b32 v16, s56
    v_lshlrev_b32 v17, 2, v0
    s_mov_b32 exec_lo, 1
    s_mov_b32 exec_hi, 0
    buffer_store_dword v16, v17, s[36:39], s72 offen sc1
    s_mov_b64 exec, -1
    s_nop 0
    v_mfma_f32_16x16x32_bf16 v[104:107], a[60:63], v[96:99], v[104:107]
    v_mfma_f32_16x16x32_bf16 v[124:127], a[60:63], v[100:103], v[124:127]
    buffer_load_dwordx4 v[80:83], v24, s[36:39], s60 offen offset:3072 sc1
    v_mfma_f32_16x16x32_bf16 v[144:147], a[60:63], v[236:239], v[144:147]
    v_mfma_f32_16x16x32_bf16 v[164:167], a[60:63], v[240:243], v[164:167]
    v_mfma_f32_16x16x32_bf16 v[108:111], a[64:67], v[96:99], v[108:111]
    v_mfma_f32_16x16x32_bf16 v[128:131], a[64:67], v[100:103], v[128:131]
    buffer_load_dwordx4 v[84:87], v25, s[36:39], s60 offen offset:3072 sc1
    v_mfma_f32_16x16x32_bf16 v[148:151], a[64:67], v[236:239], v[148:151]
    v_mfma_f32_16x16x32_bf16 v[168:171], a[64:67], v[240:243], v[168:171]
    v_mfma_f32_16x16x32_bf16 v[112:115], a[68:71], v[96:99], v[112:115]
    v_mfma_f32_16x16x32_bf16 v[132:135], a[68:71], v[100:103], v[132:135]
    buffer_load_dwordx4 v[88:91], v26, s[36:39], s60 offen offset:3072 sc1
    v_mfma_f32_16x16x32_bf16 v[152:155], a[68:71], v[236:239], v[152:155]
    v_mfma_f32_16x16x32_bf16 v[172:175], a[68:71], v[240:243], v[172:175]
    v_mfma_f32_16x16x32_bf16 v[116:119], a[72:75], v[96:99], v[116:119]
    v_mfma_f32_16x16x32_bf16 v[136:139], a[72:75], v[100:103], v[136:139]
    buffer_load_dwordx4 v[92:95], v27, s[36:39], s60 offen offset:3072 sc1
    s_add_u32 s60, s60, 4096
    v_mfma_f32_16x16x32_bf16 v[156:159], a[72:75], v[236:239], v[156:159]
    v_mfma_f32_16x16x32_bf16 v[176:179], a[72:75], v[240:243], v[176:179]
    v_mfma_f32_16x16x32_bf16 v[120:123], a[76:79], v[96:99], v[120:123]
    v_mfma_f32_16x16x32_bf16 v[140:143], a[76:79], v[100:103], v[140:143]
    v_mfma_f32_16x16x32_bf16 v[160:163], a[76:79], v[236:239], v[160:163]
    v_mfma_f32_16x16x32_bf16 v[180:183], a[76:79], v[240:243], v[180:183]
    s_waitcnt vmcnt(13)
    v_mfma_f32_16x16x32_bf16 v[104:107], a[80:83], v[32:35], v[104:107]
    v_mfma_f32_16x16x32_bf16 v[124:127], a[80:83], v[36:39], v[124:127]
    buffer_load_dwordx4 v[96:99], v24, s[36:39], s60 offen offset:0 sc1
    v_mfma_f32_16x16x32_bf16 v[144:147], a[80:83], v[40:43], v[144:147]
    v_mfma_f32_16x16x32_bf16 v[164:167], a[80:83], v[44:47], v[164:167]
    v_mfma_f32_16x16x32_bf16 v[108:111], a[84:87], v[32:35], v[108:111]
    v_mfma_f32_16x16x32_bf16 v[128:131], a[84:87], v[36:39], v[128:131]
    buffer_load_dwordx4 v[100:103], v25, s[36:39], s60 offen offset:0 sc1
    v_mfma_f32_16x16x32_bf16 v[148:151], a[84:87], v[40:43], v[148:151]
    v_mfma_f32_16x16x32_bf16 v[168:171], a[84:87], v[44:47], v[168:171]
    v_mfma_f32_16x16x32_bf16 v[112:115], a[88:91], v[32:35], v[112:115]
    v_mfma_f32_16x16x32_bf16 v[132:135], a[88:91], v[36:39], v[132:135]
    buffer_load_dwordx4 v[236:239], v26, s[36:39], s60 offen offset:0 sc1
    v_mfma_f32_16x16x32_bf16 v[152:155], a[88:91], v[40:43], v[152:155]
    v_mfma_f32_16x16x32_bf16 v[172:175], a[88:91], v[44:47], v[172:175]
    v_mfma_f32_16x16x32_bf16 v[116:119], a[92:95], v[32:35], v[116:119]
    v_mfma_f32_16x16x32_bf16 v[136:139], a[92:95], v[36:39], v[136:139]
    buffer_load_dwordx4 v[240:243], v27, s[36:39], s60 offen offset:0 sc1
    v_mfma_f32_16x16x32_bf16 v[156:159], a[92:95], v[40:43], v[156:159]
    v_mfma_f32_16x16x32_bf16 v[176:179], a[92:95], v[44:47], v[176:179]
    v_mfma_f32_16x16x32_bf16 v[120:123], a[96:99], v[32:35], v[120:123]
    v_mfma_f32_16x16x32_bf16 v[140:143], a[96:99], v[36:39], v[140:143]
    v_mfma_f32_16x16x32_bf16 v[160:163], a[96:99], v[40:43], v[160:163]
    v_mfma_f32_16x16x32_bf16 v[180:183], a[96:99], v[44:47], v[180:183]
    s_waitcnt vmcnt(13)
    v_mfma_f32_16x16x32_bf16 v[104:107], a[100:103], v[48:51], v[104:107]
    s_mul_i32 s65, s54, 327680
    s_lshl_b32 s66, s53, 7
    v_mfma_f32_16x16x32_bf16 v[124:127], a[100:103], v[52:55], v[124:127]
    buffer_load_dwordx4 v[32:35], v24, s[36:39], s60 offen offset:1024 sc1
    v_mfma_f32_16x16x32_bf16 v[144:147], a[100:103], v[56:59], v[144:147]
    s_add_u32 s65, s65, s66
    s_add_u32 s65, s65, 7340032
    v_mfma_f32_16x16x32_bf16 v[164:167], a[100:103], v[60:63], v[164:167]
    s_add_u32 s66, s65, 0x20000
    v_mfma_f32_16x16x32_bf16 v[108:111], a[104:107], v[48:51], v[108:111]
    s_add_u32 s67, s65, 0x40000
    v_mfma_f32_16x16x32_bf16 v[128:131], a[104:107], v[52:55], v[128:131]
    buffer_load_dwordx4 v[36:39], v25, s[36:39], s60 offen offset:1024 sc1
    s_cmp_ge_u32 s3, 2
    s_cselect_b32 s67, 17563648, s67
    v_mfma_f32_16x16x32_bf16 v[148:151], a[104:107], v[56:59], v[148:151]
    v_mfma_f32_16x16x32_bf16 v[168:171], a[104:107], v[60:63], v[168:171]
    s_lshl_b32 s79, s3, 3
    v_mfma_f32_16x16x32_bf16 v[112:115], a[108:111], v[48:51], v[112:115]
    v_lshrrev_b32 v10, 3, v0
    v_mfma_f32_16x16x32_bf16 v[132:135], a[108:111], v[52:55], v[132:135]
    buffer_load_dwordx4 v[40:43], v26, s[36:39], s60 offen offset:1024 sc1
    v_add_u32 v10, s79, v10
    v_mfma_f32_16x16x32_bf16 v[152:155], a[108:111], v[56:59], v[152:155]
    v_and_b32 v11, 7, v0
    v_mfma_f32_16x16x32_bf16 v[172:175], a[108:111], v[60:63], v[172:175]
    v_lshlrev_b32 v13, 12, v10
    v_mfma_f32_16x16x32_bf16 v[116:119], a[112:115], v[48:51], v[116:119]
    v_lshl_add_u32 v13, v11, 4, v13
    v_and_b32 v12, 2, v10
    v_mfma_f32_16x16x32_bf16 v[136:139], a[112:115], v[52:55], v[136:139]
    buffer_load_dwordx4 v[44:47], v27, s[36:39], s60 offen offset:1024 sc1
    v_mfma_f32_16x16x32_bf16 v[156:159], a[112:115], v[56:59], v[156:159]
    v_xor_b32 v11, v11, v12
    v_mfma_f32_16x16x32_bf16 v[176:179], a[112:115], v[60:63], v[176:179]
    v_lshrrev_b32 v12, 1, v10
    v_and_b32 v12, 4, v12
    v_mfma_f32_16x16x32_bf16 v[120:123], a[116:119], v[48:51], v[120:123]
    v_xor_b32 v11, v11, v12
    v_mfma_f32_16x16x32_bf16 v[140:143], a[116:119], v[52:55], v[140:143]
    v_lshlrev_b32 v10, 7, v10
    v_mfma_f32_16x16x32_bf16 v[160:163], a[116:119], v[56:59], v[160:163]
    v_lshl_add_u32 v10, v11, 4, v10
    v_mfma_f32_16x16x32_bf16 v[180:183], a[116:119], v[60:63], v[180:183]
    v_add_u32 v10, 120832, v10
    s_waitcnt vmcnt(13)
    v_mfma_f32_16x16x32_bf16 v[104:107], a[120:123], v[64:67], v[104:107]
    v_mfma_f32_16x16x32_bf16 v[124:127], a[120:123], v[68:71], v[124:127]
    buffer_load_dwordx4 v[48:51], v24, s[36:39], s60 offen offset:2048 sc1
    v_mfma_f32_16x16x32_bf16 v[144:147], a[120:123], v[72:75], v[144:147]
    s_add_u32 s69, s3, 1
    v_mfma_f32_16x16x32_bf16 v[164:167], a[120:123], v[76:79], v[164:167]
    s_and_b32 s69, s69, 3
    v_mfma_f32_16x16x32_bf16 v[108:111], a[124:127], v[64:67], v[108:111]
    s_mul_i32 s69, s69, 15360
    v_mfma_f32_16x16x32_bf16 v[128:131], a[124:127], v[68:71], v[128:131]
    buffer_load_dwordx4 v[52:55], v25, s[36:39], s60 offen offset:2048 sc1
    s_add_u32 s69, s69, 0
    v_mfma_f32_16x16x32_bf16 v[148:151], a[124:127], v[72:75], v[148:151]
    v_add_u32 v7, s69, v14
    v_mfma_f32_16x16x32_bf16 v[168:171], a[124:127], v[76:79], v[168:171]
    v_mfma_f32_16x16x32_bf16 v[112:115], a[128:131], v[64:67], v[112:115]
    s_add_u32 s69, s3, 2
    v_mfma_f32_16x16x32_bf16 v[132:135], a[128:131], v[68:71], v[132:135]
    buffer_load_dwordx4 v[56:59], v26, s[36:39], s60 offen offset:2048 sc1
    s_and_b32 s69, s69, 3
    v_mfma_f32_16x16x32_bf16 v[152:155], a[128:131], v[72:75], v[152:155]
    s_mul_i32 s69, s69, 15360
    v_mfma_f32_16x16x32_bf16 v[172:175], a[128:131], v[76:79], v[172:175]
    s_add_u32 s69, s69, 5120
    v_mfma_f32_16x16x32_bf16 v[116:119], a[132:135], v[64:67], v[116:119]
    v_add_u32 v8, s69, v14
PAGE5:
    s_cbranch_execz PAGE6
    v_mfma_f32_16x16x32_bf16 v[136:139], a[132:135], v[68:71], v[136:139]
    buffer_load_dwordx4 v[60:63], v27, s[36:39], s60 offen offset:2048 sc1
    v_mfma_f32_16x16x32_bf16 v[156:159], a[132:135], v[72:75], v[156:159]
    s_add_u32 s69, s3, 3
    v_mfma_f32_16x16x32_bf16 v[176:179], a[132:135], v[76:79], v[176:179]
    s_and_b32 s69, s69, 3
    v_mfma_f32_16x16x32_bf16 v[120:123], a[136:139], v[64:67], v[120:123]
    s_mul_i32 s69, s69, 15360
    v_mfma_f32_16x16x32_bf16 v[140:143], a[136:139], v[68:71], v[140:143]
    s_add_u32 s69, s69, 10240
    v_mfma_f32_16x16x32_bf16 v[160:163], a[136:139], v[72:75], v[160:163]
    v_add_u32 v9, s69, v14
    v_mfma_f32_16x16x32_bf16 v[180:183], a[136:139], v[76:79], v[180:183]
    s_waitcnt vmcnt(12)
    v_mfma_f32_16x16x32_bf16 v[104:107], a[140:143], v[80:83], v[104:107]
    v_and_b32 v2, 15, v0
    v_mfma_f32_16x16x32_bf16 v[124:127], a[140:143], v[84:87], v[124:127]
    buffer_load_dwordx4 v[64:67], v24, s[36:39], s60 offen offset:3072 sc1
    v_mfma_f32_16x16x32_bf16 v[144:147], a[140:143], v[88:91], v[144:147]
    v_lshrrev_b32_e64 v3, 4, v0
    v_mfma_f32_16x16x32_bf16 v[164:167], a[140:143], v[92:95], v[164:167]
    v_lshl_add_u32 v2, v2, 2, v3
    v_mfma_f32_16x16x32_bf16 v[108:111], a[144:147], v[80:83], v[108:111]
    v_mfma_f32_16x16x32_bf16 v[128:131], a[144:147], v[84:87], v[128:131]
    buffer_load_dwordx4 v[68:71], v25, s[36:39], s60 offen offset:3072 sc1
    v_mfma_f32_16x16x32_bf16 v[148:151], a[144:147], v[88:91], v[148:151]
    v_lshlrev_b32 v2, 2, v2
    v_mfma_f32_16x16x32_bf16 v[168:171], a[144:147], v[92:95], v[168:171]
    v_and_b32 v3, 3, v0
    v_mfma_f32_16x16x32_bf16 v[112:115], a[148:151], v[80:83], v[112:115]
    v_mfma_f32_16x16x32_bf16 v[132:135], a[148:151], v[84:87], v[132:135]
    buffer_load_dwordx4 v[72:75], v26, s[36:39], s60 offen offset:3072 sc1
    v_lshlrev_b32 v3, 6, v3
    v_mfma_f32_16x16x32_bf16 v[152:155], a[148:151], v[88:91], v[152:155]
    v_mfma_f32_16x16x32_bf16 v[172:175], a[148:151], v[92:95], v[172:175]
    v_and_b32 v11, 60, v0
    v_mfma_f32_16x16x32_bf16 v[116:119], a[152:155], v[80:83], v[116:119]
    v_mfma_f32_16x16x32_bf16 v[136:139], a[152:155], v[84:87], v[136:139]
    buffer_load_dwordx4 v[76:79], v27, s[36:39], s60 offen offset:3072 sc1
    s_add_u32 s60, s60, 4096
    v_mfma_f32_16x16x32_bf16 v[156:159], a[152:155], v[88:91], v[156:159]
    v_or_b32 v3, v3, v11
    v_mfma_f32_16x16x32_bf16 v[176:179], a[152:155], v[92:95], v[176:179]
    v_mfma_f32_16x16x32_bf16 v[120:123], a[156:159], v[80:83], v[120:123]
    v_mfma_f32_16x16x32_bf16 v[140:143], a[156:159], v[84:87], v[140:143]
    v_mfma_f32_16x16x32_bf16 v[160:163], a[156:159], v[88:91], v[160:163]
    buffer_load_dword v20, v18, s[36:39], s59 offen sc1
    v_mfma_f32_16x16x32_bf16 v[180:183], a[156:159], v[92:95], v[180:183]
    s_waitcnt vmcnt(13)
    v_mfma_f32_16x16x32_bf16 v[104:107], a[160:163], v[96:99], v[104:107]
    v_mfma_f32_16x16x32_bf16 v[124:127], a[160:163], v[100:103], v[124:127]
    buffer_load_dwordx4 v[80:83], v24, s[36:39], s60 offen offset:0 sc1
    v_mfma_f32_16x16x32_bf16 v[144:147], a[160:163], v[236:239], v[144:147]
    ds_bpermute_b32 v244, v2, v244
    v_mfma_f32_16x16x32_bf16 v[164:167], a[160:163], v[240:243], v[164:167]
    ds_bpermute_b32 v245, v2, v245
    v_mfma_f32_16x16x32_bf16 v[108:111], a[164:167], v[96:99], v[108:111]
    v_mfma_f32_16x16x32_bf16 v[128:131], a[164:167], v[100:103], v[128:131]
    buffer_load_dwordx4 v[84:87], v25, s[36:39], s60 offen offset:0 sc1
    ds_bpermute_b32 v246, v2, v246
    v_mfma_f32_16x16x32_bf16 v[148:151], a[164:167], v[236:239], v[148:151]
    v_mfma_f32_16x16x32_bf16 v[168:171], a[164:167], v[240:243], v[168:171]
    ds_bpermute_b32 v247, v2, v247
    v_mfma_f32_16x16x32_bf16 v[112:115], a[168:171], v[96:99], v[112:115]
    v_mfma_f32_16x16x32_bf16 v[132:135], a[168:171], v[100:103], v[132:135]
    buffer_load_dwordx4 v[88:91], v26, s[36:39], s60 offen offset:0 sc1
    ds_bpermute_b32 v248, v2, v248
    v_mfma_f32_16x16x32_bf16 v[152:155], a[168:171], v[236:239], v[152:155]
    v_mfma_f32_16x16x32_bf16 v[172:175], a[168:171], v[240:243], v[172:175]
    ds_bpermute_b32 v249, v2, v249
    v_mfma_f32_16x16x32_bf16 v[116:119], a[172:175], v[96:99], v[116:119]
    ds_bpermute_b32 v250, v2, v250
    v_mfma_f32_16x16x32_bf16 v[136:139], a[172:175], v[100:103], v[136:139]
    buffer_load_dwordx4 v[92:95], v27, s[36:39], s60 offen offset:0 sc1
    v_mfma_f32_16x16x32_bf16 v[156:159], a[172:175], v[236:239], v[156:159]
    v_mfma_f32_16x16x32_bf16 v[176:179], a[172:175], v[240:243], v[176:179]
    ds_bpermute_b32 v251, v2, v251
    v_mfma_f32_16x16x32_bf16 v[120:123], a[176:179], v[96:99], v[120:123]
    ds_bpermute_b32 v252, v2, v252
    v_mfma_f32_16x16x32_bf16 v[140:143], a[176:179], v[100:103], v[140:143]
    v_mfma_f32_16x16x32_bf16 v[160:163], a[176:179], v[236:239], v[160:163]
    ds_bpermute_b32 v253, v2, v253
    v_mfma_f32_16x16x32_bf16 v[180:183], a[176:179], v[240:243], v[180:183]
    s_waitcnt vmcnt(13)
    v_mfma_f32_16x16x32_bf16 v[104:107], a[180:183], v[32:35], v[104:107]
    v_mfma_f32_16x16x32_bf16 v[124:127], a[180:183], v[36:39], v[124:127]
    buffer_load_dwordx4 v[100:103], v25, s[36:39], s60 offen offset:1024 sc1
    v_mfma_f32_16x16x32_bf16 v[144:147], a[180:183], v[40:43], v[144:147]
    s_mov_b32 s48, s26
    v_mfma_f32_16x16x32_bf16 v[164:167], a[180:183], v[44:47], v[164:167]
    v_mfma_f32_16x16x32_bf16 v[108:111], a[184:187], v[32:35], v[108:111]
    s_mov_b32 s49, s27
    s_nop 0
    v_mfma_f32_16x16x32_bf16 v[128:131], a[184:187], v[36:39], v[128:131]
    buffer_load_dwordx4 v[236:239], v26, s[36:39], s60 offen offset:1024 sc1
    v_mfma_f32_16x16x32_bf16 v[148:151], a[184:187], v[40:43], v[148:151]
    v_mfma_f32_16x16x32_bf16 v[168:171], a[184:187], v[44:47], v[168:171]
    s_mov_b32 s50, 2621440
    v_mfma_f32_16x16x32_bf16 v[112:115], a[188:191], v[32:35], v[112:115]
    v_mfma_f32_16x16x32_bf16 v[132:135], a[188:191], v[36:39], v[132:135]
    buffer_load_dwordx4 v[240:243], v27, s[36:39], s60 offen offset:1024 sc1
    v_mfma_f32_16x16x32_bf16 v[152:155], a[188:191], v[40:43], v[152:155]
    s_mov_b32 s51, 0x20000
    v_mfma_f32_16x16x32_bf16 v[172:175], a[188:191], v[44:47], v[172:175]
    v_mfma_f32_16x16x32_bf16 v[116:119], a[192:195], v[32:35], v[116:119]
    v_mfma_f32_16x16x32_bf16 v[136:139], a[192:195], v[36:39], v[136:139]
    buffer_load_dwordx4 v[96:99], v24, s[36:39], s60 offen offset:1024 sc1
    v_mfma_f32_16x16x32_bf16 v[156:159], a[192:195], v[40:43], v[156:159]
    v_mfma_f32_16x16x32_bf16 v[176:179], a[192:195], v[44:47], v[176:179]
    v_mfma_f32_16x16x32_bf16 v[120:123], a[196:199], v[32:35], v[120:123]
    v_mfma_f32_16x16x32_bf16 v[140:143], a[196:199], v[36:39], v[140:143]
    v_mfma_f32_16x16x32_bf16 v[160:163], a[196:199], v[40:43], v[160:163]
    v_mfma_f32_16x16x32_bf16 v[180:183], a[196:199], v[44:47], v[180:183]
    s_waitcnt vmcnt(13)
    v_mfma_f32_16x16x32_bf16 v[104:107], a[200:203], v[48:51], v[104:107]
    s_waitcnt vmcnt(8)
    v_cmp_ne_u32 vcc, s56, v20
    v_mfma_f32_16x16x32_bf16 v[124:127], a[200:203], v[52:55], v[124:127]
    s_mov_b64 s[82:83], vcc
    s_cmp_eq_u64 s[82:83], 0
    s_cbranch_scc0 FY_RETRY_11
FY_DONE_12:
    v_mfma_f32_16x16x32_bf16 v[144:147], a[200:203], v[56:59], v[144:147]
    buffer_load_dwordx4 v[184:187], v13, s[36:39], s65 offen sc1
    v_mfma_f32_16x16x32_bf16 v[164:167], a[200:203], v[60:63], v[164:167]
    buffer_load_dwordx4 v[188:191], v13, s[36:39], s66 offen sc1
    v_mfma_f32_16x16x32_bf16 v[108:111], a[204:207], v[48:51], v[108:111]
    buffer_load_dwordx4 v[192:195], v13, s[36:39], s67 offen sc1
    v_mfma_f32_16x16x32_bf16 v[128:131], a[204:207], v[52:55], v[128:131]
    s_lshl_b32 s76, s3, 12
    s_add_u32 s76, s76, 131072
    s_cmp_eq_u32 s2, 0
    s_cselect_b32 s76, s76, 17563648
    v_mfma_f32_16x16x32_bf16 v[148:151], a[204:207], v[56:59], v[148:151]
    v_lshlrev_b32_e64 v16, 6, v0
    v_mfma_f32_16x16x32_bf16 v[168:171], a[204:207], v[60:63], v[168:171]
    buffer_load_dword v24, v16, s[36:39], s76 offen sc1
    s_mul_i32 s79, s3, 15360
    v_mfma_f32_16x16x32_bf16 v[112:115], a[208:211], v[48:51], v[112:115]
    v_add_u32 v26, s79, v14
    v_bfe_u32 v17, v0, 2, 2
    v_and_b32 v18, 3, v0
    v_mfma_f32_16x16x32_bf16 v[132:135], a[208:211], v[52:55], v[132:135]
    v_lshrrev_b32 v19, 1, v18
    s_lshl_b32 s78, s3, 1
    v_mfma_f32_16x16x32_bf16 v[152:155], a[208:211], v[56:59], v[152:155]
    v_or_b32 v19, s78, v19
    v_and_b32 v18, 1, v18
    v_mfma_f32_16x16x32_bf16 v[172:175], a[208:211], v[60:63], v[172:175]
    v_lshlrev_b32 v18, 3, v18
    v_add_u32 v18, 120832, v18
    v_and_b32 v27, 2, v17
    v_mfma_f32_16x16x32_bf16 v[116:119], a[212:215], v[48:51], v[116:119]
    v_and_b32 v20, 1, v4
    v_lshl_or_b32 v27, v20, 2, v27
    v_mfma_f32_16x16x32_bf16 v[136:139], a[212:215], v[52:55], v[136:139]
    v_xor_b32 v27, v27, v19
    v_lshl_add_u32 v27, v27, 4, v18
    v_mfma_f32_16x16x32_bf16 v[156:159], a[212:215], v[56:59], v[156:159]
    v_lshl_add_u32 v20, v4, 3, v17
    v_lshl_add_u32 v27, v20, 7, v27
    v_lshl_add_u32 v20, v4, 2, v17
    v_mfma_f32_16x16x32_bf16 v[176:179], a[212:215], v[60:63], v[176:179]
    v_and_b32 v23, 2, v20
    v_lshrrev_b32 v21, 1, v20
    v_mfma_f32_16x16x32_bf16 v[120:123], a[216:219], v[48:51], v[120:123]
    v_and_b32 v21, 4, v21
    v_or_b32 v23, v23, v21
    v_mfma_f32_16x16x32_bf16 v[140:143], a[216:219], v[52:55], v[140:143]
    v_xor_b32_e64 v23, v23, v19
    v_lshl_add_u32 v23, v23, 4, v18
    v_lshl_add_u32 v23, v20, 7, v23
    v_mfma_f32_16x16x32_bf16 v[160:163], a[216:219], v[56:59], v[160:163]
    s_mov_b32 s74, 0xbfb8aa3b
    s_mov_b32 s75, 0xbfb8aa3b
    v_mfma_f32_16x16x32_bf16 v[180:183], a[216:219], v[60:63], v[180:183]
    v_mov_b32 v30, 1.0
    v_mov_b32 v31, 1.0
    s_waitcnt vmcnt(8) lgkmcnt(0)
    v_mfma_f32_16x16x32_bf16 v[124:127], a[220:223], v[68:71], v[124:127]
    v_lshlrev_b32 v32, 16, v244
    v_and_b32 v33, 0xffff0000, v244
    v_mfma_f32_16x16x32_bf16 v[128:131], a[224:227], v[68:71], v[128:131]
    v_lshlrev_b32 v34, 16, v245
    v_mfma_f32_16x16x32_bf16 v[124:127], v[196:199], v[84:87], v[124:127]
    v_and_b32 v35, 0xffff0000, v245
    v_mfma_f32_16x16x32_bf16 v[128:131], v[200:203], v[84:87], v[128:131]
    s_waitcnt vmcnt(7)
    v_lshlrev_b32 v36, 16, v246
    v_mfma_f32_16x16x32_bf16 v[124:127], v[216:219], v[100:103], v[124:127]
    v_and_b32 v37, 0xffff0000, v246
    v_mfma_f32_16x16x32_bf16 v[128:131], v[220:223], v[100:103], v[128:131]
    v_lshlrev_b32 v38, 16, v247
    v_mfma_f32_16x16x32_bf16 v[132:135], a[228:231], v[68:71], v[132:135]
    v_and_b32 v39, 0xffff0000, v247
    v_lshlrev_b32_e64 v40, 16, v248
    v_mfma_f32_16x16x32_bf16 v[136:139], a[232:235], v[68:71], v[136:139]
    v_and_b32 v41, 0xffff0000, v248
    v_mfma_f32_16x16x32_bf16 v[132:135], v[204:207], v[84:87], v[132:135]
    ds_write_b128 v7, v[124:127] offset:0
    v_mfma_f32_16x16x32_bf16 v[136:139], v[208:211], v[84:87], v[136:139]
    v_lshlrev_b32_e64 v42, 16, v249
    v_mfma_f32_16x16x32_bf16 v[132:135], v[224:227], v[100:103], v[132:135]
    v_and_b32 v43, 0xffff0000, v249
    v_mfma_f32_16x16x32_bf16 v[136:139], v[228:231], v[100:103], v[136:139]
    ds_write_b128 v7, v[128:131] offset:1024
    v_mfma_f32_16x16x32_bf16 v[140:143], a[236:239], v[68:71], v[140:143]
    v_lshlrev_b32 v44, 16, v250
    v_mfma_f32_16x16x32_bf16 v[144:147], a[220:223], v[72:75], v[144:147]
    v_and_b32 v45, 0xffff0000, v250
    v_mfma_f32_16x16x32_bf16 v[140:143], v[212:215], v[84:87], v[140:143]
    v_lshlrev_b32 v46, 16, v251
    v_and_b32 v47, 0xffff0000, v251
    v_mfma_f32_16x16x32_bf16 v[144:147], v[196:199], v[88:91], v[144:147]
    ds_write_b128 v7, v[132:135] offset:2048
    v_mfma_f32_16x16x32_bf16 v[140:143], v[232:235], v[100:103], v[140:143]
    s_waitcnt vmcnt(6)
    v_lshlrev_b32 v48, 16, v252
    v_mfma_f32_16x16x32_bf16 v[144:147], v[216:219], v[236:239], v[144:147]
    v_and_b32 v49, 0xffff0000, v252
    v_mfma_f32_16x16x32_bf16 v[148:151], a[224:227], v[72:75], v[148:151]
    ds_write_b128 v7, v[136:139] offset:3072
    v_mfma_f32_16x16x32_bf16 v[152:155], a[228:231], v[72:75], v[152:155]
    v_lshlrev_b32_e64 v50, 16, v253
    v_mfma_f32_16x16x32_bf16 v[148:151], v[200:203], v[88:91], v[148:151]
    v_and_b32 v51, 0xffff0000, v253
    v_mfma_f32_16x16x32_bf16 v[152:155], v[204:207], v[88:91], v[152:155]
    ds_write_b128 v7, v[140:143] offset:4096
    v_mfma_f32_16x16x32_bf16 v[148:151], v[220:223], v[236:239], v[148:151]
    v_mul_f32 v254, v254, v255
    v_mfma_f32_16x16x32_bf16 v[152:155], v[224:227], v[236:239], v[152:155]
    v_sub_f32 v254, 0, v254
    v_fma_f32 v52, v32, v255, v254
    v_mfma_f32_16x16x32_bf16 v[156:159], a[232:235], v[72:75], v[156:159]
    ds_write_b128 v8, v[144:147] offset:0
    v_mfma_f32_16x16x32_bf16 v[160:163], a[236:239], v[72:75], v[160:163]
    v_fma_f32 v53, v33, v255, v254
    v_mfma_f32_16x16x32_bf16 v[156:159], v[208:211], v[88:91], v[156:159]
    v_fma_f32 v54, v34, v255, v254
    v_mfma_f32_16x16x32_bf16 v[160:163], v[212:215], v[88:91], v[160:163]
    ds_write_b128 v8, v[148:151] offset:1024
    v_mfma_f32_16x16x32_bf16 v[156:159], v[228:231], v[236:239], v[156:159]
    v_fma_f32 v55, v35, v255, v254
    v_mfma_f32_16x16x32_bf16 v[160:163], v[232:235], v[236:239], v[160:163]
    v_fma_f32 v56, v36, v255, v254
    v_mfma_f32_16x16x32_bf16 v[164:167], a[220:223], v[76:79], v[164:167]
    ds_write_b128 v8, v[152:155] offset:2048
    v_mfma_f32_16x16x32_bf16 v[168:171], a[224:227], v[76:79], v[168:171]
    v_fma_f32 v57, v37, v255, v254
    v_mfma_f32_16x16x32_bf16 v[164:167], v[196:199], v[92:95], v[164:167]
    v_fma_f32 v58, v38, v255, v254
    v_fma_f32 v59, v39, v255, v254
    v_mfma_f32_16x16x32_bf16 v[168:171], v[200:203], v[92:95], v[168:171]
    ds_write_b128 v8, v[156:159] offset:3072
    s_waitcnt vmcnt(5)
    s_nop 0
    v_mfma_f32_16x16x32_bf16 v[164:167], v[216:219], v[240:243], v[164:167]
    v_fma_f32 v60, v40, v255, v254
    v_mfma_f32_16x16x32_bf16 v[168:171], v[220:223], v[240:243], v[168:171]
    v_fma_f32 v61, v41, v255, v254
    v_mfma_f32_16x16x32_bf16 v[172:175], a[228:231], v[76:79], v[172:175]
    ds_write_b128 v8, v[160:163] offset:4096
    v_mfma_f32_16x16x32_bf16 v[176:179], a[232:235], v[76:79], v[176:179]
    v_fma_f32 v62, v42, v255, v254
    v_mfma_f32_16x16x32_bf16 v[172:175], v[204:207], v[92:95], v[172:175]
    v_fma_f32 v63, v43, v255, v254
    v_mfma_f32_16x16x32_bf16 v[176:179], v[208:211], v[92:95], v[176:179]
    ds_write_b128 v9, v[164:167] offset:0
    v_mfma_f32_16x16x32_bf16 v[172:175], v[224:227], v[240:243], v[172:175]
    v_fma_f32 v244, v44, v255, v254
    v_mfma_f32_16x16x32_bf16 v[176:179], v[228:231], v[240:243], v[176:179]
    v_fma_f32 v245, v45, v255, v254
    v_fma_f32 v246, v46, v255, v254
    v_mfma_f32_16x16x32_bf16 v[180:183], a[236:239], v[76:79], v[180:183]
    ds_write_b128 v9, v[168:171] offset:1024
    v_mfma_f32_16x16x32_bf16 v[104:107], a[220:223], v[64:67], v[104:107]
    v_fma_f32 v247, v47, v255, v254
    v_mfma_f32_16x16x32_bf16 v[180:183], v[212:215], v[92:95], v[180:183]
    v_fma_f32 v248, v48, v255, v254
    v_mfma_f32_16x16x32_bf16 v[104:107], v[196:199], v[80:83], v[104:107]
    ds_write_b128 v9, v[172:175] offset:2048
    v_mfma_f32_16x16x32_bf16 v[180:183], v[232:235], v[240:243], v[180:183]
    s_waitcnt vmcnt(4)
    s_nop 0
    v_fma_f32 v249, v49, v255, v254
    v_mfma_f32_16x16x32_bf16 v[104:107], v[216:219], v[96:99], v[104:107]
    v_fma_f32 v250, v50, v255, v254
    v_mfma_f32_16x16x32_bf16 v[108:111], a[224:227], v[64:67], v[108:111]
    ds_write_b128 v9, v[176:179] offset:3072
    v_mfma_f32_16x16x32_bf16 v[112:115], a[228:231], v[64:67], v[112:115]
    v_fma_f32 v251, v51, v255, v254
    v_mfma_f32_16x16x32_bf16 v[108:111], v[200:203], v[80:83], v[108:111]
    v_mfma_f32_16x16x32_bf16 v[112:115], v[204:207], v[80:83], v[112:115]
    ds_write_b128 v9, v[180:183] offset:4096
    v_mfma_f32_16x16x32_bf16 v[108:111], v[220:223], v[96:99], v[108:111]
    v_mfma_f32_16x16x32_bf16 v[112:115], v[224:227], v[96:99], v[112:115]
    v_mfma_f32_16x16x32_bf16 v[116:119], a[232:235], v[64:67], v[116:119]
    s_waitcnt vmcnt(1)
    ds_write_b128 v10, v[184:187] offset:0
    v_mfma_f32_16x16x32_bf16 v[120:123], a[236:239], v[64:67], v[120:123]
    v_mfma_f32_16x16x32_bf16 v[116:119], v[208:211], v[80:83], v[116:119]
    ds_write_b128 v10, v[188:191] offset:4096
    v_mfma_f32_16x16x32_bf16 v[120:123], v[212:215], v[80:83], v[120:123]
    v_mfma_f32_16x16x32_bf16 v[116:119], v[228:231], v[96:99], v[116:119]
    ds_write_b128 v10, v[192:195] offset:8192
    v_mfma_f32_16x16x32_bf16 v[120:123], v[232:235], v[96:99], v[120:123]
    s_cmp_eq_u32 s2, 0
    s_cbranch_scc1 EP_CHECK
EP_BACK:
    s_or_b32 s73, s2, s3
    s_cmp_eq_u32 s73, 0
    s_waitcnt lgkmcnt(0)
    s_barrier
    s_cbranch_scc1 EP_STORE
EP_STORED:
    ds_read_b64_tr_b16 v[220:221], v27 offset:0
    ds_read_b64_tr_b16 v[222:223], v27 offset:512
    ds_read_b64_tr_b16 v[224:225], v27 offset:4096
    ds_read_b64_tr_b16 v[226:227], v27 offset:4608
    ds_read_b64_tr_b16 v[228:229], v23 offset:8192
    ds_read_b128 v[124:127], v26 offset:0
    ds_read_b128 v[144:147], v26 offset:5120
    ds_read_b128 v[164:167], v26 offset:10240
    ds_read_b128 v[128:131], v26 offset:1024
    ds_read_b128 v[148:151], v26 offset:6144
    ds_read_b128 v[168:171], v26 offset:11264
    ds_read_b128 v[132:135], v26 offset:2048
    ds_read_b128 v[152:155], v26 offset:7168
    ds_read_b128 v[172:175], v26 offset:12288
    ds_read_b128 v[136:139], v26 offset:3072
    ds_read_b128 v[156:159], v26 offset:8192
    ds_read_b128 v[176:179], v26 offset:13312
    ds_read_b128 v[140:143], v26 offset:4096
    ds_read_b128 v[160:163], v26 offset:9216
    ds_read_b128 v[180:183], v26 offset:14336
    s_waitcnt lgkmcnt(15)
    v_lshlrev_b32 v92, 16, v220
    v_and_b32 v93, 0xffff0000, v220
    v_lshlrev_b32 v94, 16, v221
    v_and_b32 v95, 0xffff0000, v221
    v_lshlrev_b32 v96, 16, v222
    v_and_b32 v97, 0xffff0000, v222
    v_lshlrev_b32_e64 v98, 16, v223
    v_and_b32 v99, 0xffff0000, v223
    v_pk_mul_f32 v[52:53], v[52:53], v[92:93]
    v_pk_mul_f32 v[54:55], v[54:55], v[94:95]
    v_pk_mul_f32 v[56:57], v[56:57], v[96:97]
    v_pk_mul_f32 v[58:59], v[58:59], v[98:99]
    s_waitcnt lgkmcnt(9)
    s_nop 0
    v_pk_add_f32 v[104:105], v[104:105], v[124:125]
    v_pk_add_f32 v[106:107], v[106:107], v[126:127]
    v_pk_add_f32 v[108:109], v[108:109], v[128:129]
    v_pk_add_f32 v[110:111], v[110:111], v[130:131]
    v_pk_add_f32 v[104:105], v[104:105], v[144:145]
    v_pk_add_f32 v[106:107], v[106:107], v[146:147]
    v_pk_add_f32 v[108:109], v[108:109], v[148:149]
    v_pk_add_f32 v[110:111], v[110:111], v[150:151]
    v_pk_add_f32 v[104:105], v[104:105], v[164:165]
    v_pk_add_f32 v[106:107], v[106:107], v[166:167]
    v_pk_add_f32 v[108:109], v[108:109], v[168:169]
    v_pk_add_f32 v[110:111], v[110:111], v[170:171]
    v_pk_mul_f32 v[72:73], v[104:105], s[74:75]
    v_pk_mul_f32 v[74:75], v[106:107], s[74:75]
    v_pk_mul_f32 v[76:77], v[108:109], s[74:75]
    v_pk_mul_f32 v[78:79], v[110:111], s[74:75]
    v_exp_f32 v72, v72
    v_exp_f32 v73, v73
    v_exp_f32 v74, v74
    v_exp_f32 v75, v75
    v_exp_f32 v76, v76
    v_exp_f32 v77, v77
    v_exp_f32 v78, v78
    v_exp_f32 v79, v79
    v_lshlrev_b32 v100, 16, v224
    v_and_b32 v101, 0xffff0000, v224
    v_lshlrev_b32 v102, 16, v225
    v_and_b32 v103, 0xffff0000, v225
    v_lshlrev_b32 v230, 16, v226
    v_and_b32 v231, 0xffff0000, v226
    v_lshlrev_b32 v232, 16, v227
    v_and_b32 v233, 0xffff0000, v227
    v_pk_add_f32 v[72:73], v[72:73], v[30:31]
    v_pk_add_f32 v[74:75], v[74:75], v[30:31]
    v_pk_add_f32 v[76:77], v[76:77], v[30:31]
    v_pk_add_f32 v[78:79], v[78:79], v[30:31]
    v_rcp_f32 v72, v72
    v_rcp_f32 v73, v73
    v_rcp_f32 v74, v74
    v_rcp_f32 v75, v75
    v_rcp_f32 v76, v76
    v_rcp_f32 v77, v77
    v_rcp_f32 v78, v78
    v_rcp_f32 v79, v79
    v_pk_mul_f32 v[60:61], v[60:61], v[100:101]
    v_pk_mul_f32 v[62:63], v[62:63], v[102:103]
    v_pk_mul_f32 v[244:245], v[244:245], v[230:231]
    v_pk_mul_f32 v[246:247], v[246:247], v[232:233]
    v_pk_mul_f32 v[72:73], v[72:73], v[104:105]
    v_pk_mul_f32 v[74:75], v[74:75], v[106:107]
    v_pk_mul_f32 v[76:77], v[76:77], v[108:109]
    v_pk_mul_f32 v[78:79], v[78:79], v[110:111]
    v_pk_fma_f32 v[72:73], v[72:73], v[52:53], v[32:33]
    v_pk_fma_f32 v[74:75], v[74:75], v[54:55], v[34:35]
    v_pk_fma_f32 v[76:77], v[76:77], v[56:57], v[36:37]
    v_pk_fma_f32 v[78:79], v[78:79], v[58:59], v[38:39]
    v_cvt_pk_bf16_f32 v184, v72, v73
    v_cvt_pk_bf16_f32 v185, v74, v75
    v_cvt_pk_bf16_f32 v186, v76, v77
    v_cvt_pk_bf16_f32 v187, v78, v79
    buffer_store_dwordx4 v[184:187], v28, s[48:51], s68 offen offset:0
    s_waitcnt lgkmcnt(3)
    s_nop 0
    v_pk_add_f32 v[112:113], v[112:113], v[132:133]
    v_pk_add_f32 v[114:115], v[114:115], v[134:135]
    v_pk_add_f32 v[116:117], v[116:117], v[136:137]
    v_pk_add_f32 v[118:119], v[118:119], v[138:139]
    v_pk_add_f32 v[112:113], v[112:113], v[152:153]
    v_pk_add_f32 v[114:115], v[114:115], v[154:155]
    v_pk_add_f32 v[116:117], v[116:117], v[156:157]
    v_pk_add_f32 v[118:119], v[118:119], v[158:159]
    v_pk_add_f32 v[112:113], v[112:113], v[172:173]
    v_pk_add_f32 v[114:115], v[114:115], v[174:175]
    v_pk_add_f32 v[116:117], v[116:117], v[176:177]
    v_pk_add_f32 v[118:119], v[118:119], v[178:179]
    v_pk_mul_f32 v[80:81], v[112:113], s[74:75]
    v_pk_mul_f32 v[82:83], v[114:115], s[74:75]
    v_pk_mul_f32 v[84:85], v[116:117], s[74:75]
    v_pk_mul_f32 v[86:87], v[118:119], s[74:75]
    v_exp_f32 v80, v80
    v_exp_f32 v81, v81
    v_exp_f32 v82, v82
    v_exp_f32 v83, v83
    v_exp_f32 v84, v84
    v_exp_f32 v85, v85
    v_exp_f32 v86, v86
    v_exp_f32 v87, v87
    v_lshlrev_b32 v234, 16, v228
    v_and_b32 v235, 0xffff0000, v228
    v_lshlrev_b32 v236, 16, v229
    v_and_b32 v237, 0xffff0000, v229
    v_pk_add_f32 v[80:81], v[80:81], v[30:31]
    v_pk_add_f32 v[82:83], v[82:83], v[30:31]
    v_pk_add_f32 v[84:85], v[84:85], v[30:31]
    v_pk_add_f32 v[86:87], v[86:87], v[30:31]
    v_rcp_f32 v80, v80
    v_rcp_f32 v81, v81
    v_rcp_f32 v82, v82
    v_rcp_f32 v83, v83
    v_rcp_f32 v84, v84
    v_rcp_f32 v85, v85
    v_rcp_f32 v86, v86
    v_rcp_f32 v87, v87
    v_pk_mul_f32 v[248:249], v[248:249], v[234:235]
    v_pk_mul_f32 v[250:251], v[250:251], v[236:237]
    v_pk_mul_f32 v[80:81], v[80:81], v[112:113]
    v_pk_mul_f32 v[82:83], v[82:83], v[114:115]
    v_pk_mul_f32 v[84:85], v[84:85], v[116:117]
    v_pk_mul_f32 v[86:87], v[86:87], v[118:119]
    v_pk_fma_f32 v[80:81], v[80:81], v[60:61], v[40:41]
    v_pk_fma_f32 v[82:83], v[82:83], v[62:63], v[42:43]
    v_pk_fma_f32 v[84:85], v[84:85], v[244:245], v[44:45]
    v_pk_fma_f32 v[86:87], v[86:87], v[246:247], v[46:47]
    v_cvt_pk_bf16_f32 v188, v80, v81
    v_cvt_pk_bf16_f32 v189, v82, v83
    v_cvt_pk_bf16_f32 v190, v84, v85
    v_cvt_pk_bf16_f32 v191, v86, v87
    buffer_store_dwordx4 v[188:191], v28, s[48:51], s68 offen offset:64
    s_waitcnt lgkmcnt(0)
    s_nop 0
    v_pk_add_f32 v[120:121], v[120:121], v[140:141]
    v_pk_add_f32 v[122:123], v[122:123], v[142:143]
    v_pk_add_f32 v[120:121], v[120:121], v[160:161]
    v_pk_add_f32 v[122:123], v[122:123], v[162:163]
    v_pk_add_f32 v[120:121], v[120:121], v[180:181]
    v_pk_add_f32 v[122:123], v[122:123], v[182:183]
    v_pk_mul_f32 v[88:89], v[120:121], s[74:75]
    v_pk_mul_f32 v[90:91], v[122:123], s[74:75]
    v_exp_f32 v88, v88
    v_exp_f32 v89, v89
    v_exp_f32_e64 v90, v90
    v_exp_f32 v91, v91
    s_nop 0
    v_pk_add_f32 v[88:89], v[88:89], v[30:31]
    v_pk_add_f32 v[90:91], v[90:91], v[30:31]
    v_rcp_f32 v88, v88
    v_rcp_f32 v89, v89
    v_rcp_f32_e64 v90, v90
    v_rcp_f32 v91, v91
    s_nop 0
    v_pk_mul_f32 v[88:89], v[88:89], v[120:121]
    v_pk_mul_f32 v[90:91], v[90:91], v[122:123]
    v_pk_fma_f32 v[88:89], v[88:89], v[248:249], v[48:49]
    v_pk_fma_f32 v[90:91], v[90:91], v[250:251], v[50:51]
    v_cvt_pk_bf16_f32 v192, v88, v89
    v_cvt_pk_bf16_f32 v193, v90, v91
    buffer_store_dwordx2 v[192:193], v29, s[48:51], s68 offen offset:128
    s_branch DONE
IDLE:
    v_add_u32 v15, 0xfffff100, v14
    v_add_u32 v16, 0xfffff600, v14
    v_add_u32 v17, 0xfffffb00, v14
    s_mov_b32 s42, 1
    s_mov_b64 exec, 0
    s_cmp_eq_u32 s3, 0
    s_cbranch_scc1 PAGE1
    s_cmp_eq_u32 s3, 1
    s_cbranch_scc1 PAGE3
    s_cmp_eq_u32 s3, 2
    s_cbranch_scc1 PAGE5
    s_branch PAGE7
VISIT_RET_I:
    s_mov_b64 exec, -1
    s_lshl_b32 s80, s76, 7
    s_add_u32 s59, s80, 2883584
    s_lshl_b32 s68, s76, 6
    s_add_u32 s68, s68, 145408
    s_and_b32 s76, s58, 7
    s_lshl_b32 s77, s57, 2
    s_lshr_b32 s78, s58, 3
    s_add_u32 s77, s77, s78
    s_mul_i32 s78, s77, 40960
    s_mul_i32 s79, s76, 160
    s_add_u32 s78, s78, s79
    s_add_u32 s79, s78, 1310720
    s_cmp_lt_u32 s77, 22
    s_cselect_b32 s79, s79, 2211840
    s_lshl_b32 s80, s3, 6
    v_add_u32_e64 v24, s80, v0
    v_cmp_gt_u32 vcc, 320, v24
    v_subrev_u32 v25, 320, v24
    v_mov_b32 v26, s79
    v_mov_b32 v27, s78
    v_cndmask_b32 v25, v25, v24, vcc
    v_cndmask_b32 v26, v26, v27, vcc
    v_mul_u32_u24 v27, 6554, v25
    v_lshrrev_b32 v27, 16, v27
    v_mul_u32_u24 v28, 10, v27
    v_sub_u32_e64 v28, v25, v28
    v_mul_u32_u24 v27, 1280, v27
    v_lshl_add_u32 v27, v28, 4, v27
    v_add_u32 v80, v27, v26
    v_add_u32 v24, s80, v0
    v_add_u32 v24, 256, v24
    v_cmp_gt_u32 vcc, 320, v24
    v_subrev_u32 v25, 320, v24
    v_mov_b32 v26, s79
    v_mov_b32 v27, s78
    v_cndmask_b32 v25, v25, v24, vcc
    v_cndmask_b32 v26, v26, v27, vcc
    v_mul_u32_u24 v27, 6554, v25
    v_lshrrev_b32 v27, 16, v27
    v_mul_u32_u24 v28, 10, v27
    v_sub_u32_e64 v28, v25, v28
    v_mul_u32_u24 v27, 1280, v27
    v_lshl_add_u32 v27, v28, 4, v27
    v_add_u32 v81, v27, v26
    v_add_u32 v24, s80, v0
    v_add_u32 v24, 512, v24
    v_cmp_gt_u32 vcc, 320, v24
    v_subrev_u32 v25, 320, v24
    v_mov_b32 v26, s79
    v_mov_b32 v27, s78
    v_cndmask_b32 v25, v25, v24, vcc
    v_cndmask_b32 v26, v26, v27, vcc
    v_mul_u32_u24 v27, 6554, v25
    v_lshrrev_b32 v27, 16, v27
    v_mul_u32_u24 v28, 10, v27
    v_sub_u32_e64 v28, v25, v28
    v_mul_u32_u24 v27, 1280, v27
    v_lshl_add_u32 v27, v28, 4, v27
    v_add_u32_e64 v82, v27, v26
    v_mov_b32 v26, 2211840
    v_cmp_gt_u32 vcc, 640, v24
    s_nop 1
    v_cndmask_b32 v82, v26, v82, vcc
    v_and_b32 v203, 15, v0
    v_lshrrev_b32 v204, 5, v0
    s_lshl_b32 s78, s3, 1
    v_add_u32 v204, s78, v204
    v_xor_b32 v204, v204, v203
    v_and_b32 v204, 7, v204
    v_lshlrev_b32_e64 v204, 4, v204
    v_lshl_add_u32 v203, v203, 9, v204
    v_bfe_u32 v204, v0, 4, 1
    v_xor_b32_e64 v204, 1, v204
    v_lshl_add_u32 v203, v204, 3, v203
    v_add_u32 v203, 131584, v203
    s_lshl_b32 s78, s3, 6
    v_add_u32 v205, s78, v0
    v_lshrrev_b32 v206, 3, v205
    v_lshrrev_b32 v204, 5, v205
    v_xor_b32 v204, v204, v205
    v_and_b32 v204, 7, v204
    v_lshlrev_b32_e64 v204, 4, v204
    v_lshl_add_u32 v204, v206, 7, v204
    v_add_u32 v204, 131584, v204
    v_and_b32 v205, 7, v205
    v_lshlrev_b32 v205, 4, v205
    v_lshl_add_u32 v205, v206, 12, v205
    v_add_u32 v206, 0x20000, v205
    s_movk_i32 s79, 1024
    s_movk_i32 s80, 4096
    v_add_u32 v22, s79, v14
    v_add_u32 v23, s79, v15
    v_add_u32 v24, s79, v16
    v_add_u32 v25, s79, v17
    buffer_load_dwordx2 v[126:127], v23, s[44:47], 0 offen nt
PAGE6:
    s_cbranch_execz VISIT_RET
    s_nop 0
    buffer_load_dwordx2 v[128:129], v24, s[44:47], 0 offen nt
    buffer_load_dwordx2 v[130:131], v25, s[44:47], 0 offen nt
    buffer_load_dwordx2 v[132:133], v22, s[44:47], 0 offen offset:0 nt
    buffer_load_dwordx2 v[134:135], v22, s[44:47], 0 offen offset:1280 nt
    buffer_load_dwordx2 v[136:137], v22, s[44:47], 0 offen offset:2560 nt
    buffer_load_dwordx2 v[138:139], v22, s[44:47], 0 offen offset:3840 nt
    buffer_load_dwordx4 v[148:151], v18, s[52:55], s80 offen
    buffer_load_dwordx4 v[152:155], v18, s[52:55], s80 offen offset:16
    buffer_load_dwordx2 v[140:141], v22, s[48:51], 0 offen offset:0 nt
    buffer_load_dwordx2 v[142:143], v22, s[48:51], 0 offen offset:1280 nt
    buffer_load_dwordx2 v[144:145], v22, s[48:51], 0 offen offset:2560 nt
    buffer_load_dwordx2 v[146:147], v22, s[48:51], 0 offen offset:3840 nt
    s_waitcnt vmcnt(17)
    v_lshlrev_b32 v224, 16, v118
    v_and_b32 v228, 0xffff0000, v118
    v_lshlrev_b32 v225, 16, v122
    v_and_b32 v229, 0xffff0000, v122
    v_lshlrev_b32 v226, 16, v120
    v_and_b32 v230, 0xffff0000, v120
    v_lshlrev_b32 v227, 16, v124
    v_and_b32 v231, 0xffff0000, v124
    v_lshlrev_b32 v232, 16, v119
    v_and_b32 v236, 0xffff0000, v119
    v_lshlrev_b32 v233, 16, v123
    v_and_b32 v237, 0xffff0000, v123
    v_lshlrev_b32 v234, 16, v121
    v_and_b32 v238, 0xffff0000, v121
    v_lshlrev_b32 v235, 16, v125
    v_and_b32 v239, 0xffff0000, v125
    v_lshlrev_b32 v208, 16, v96
    v_and_b32 v96, 0xffff0000, v96
    v_lshlrev_b32 v209, 16, v97
    v_and_b32 v97, 0xffff0000, v97
    v_lshlrev_b32 v210, 16, v98
    v_and_b32 v98, 0xffff0000, v98
    v_lshlrev_b32 v211, 16, v99
    v_and_b32 v99, 0xffff0000, v99
    v_lshlrev_b32 v212, 16, v100
    v_and_b32 v100, 0xffff0000, v100
    v_lshlrev_b32 v213, 16, v101
    v_and_b32 v101, 0xffff0000, v101
    v_lshlrev_b32 v214, 16, v102
    v_and_b32 v102, 0xffff0000, v102
    v_lshlrev_b32 v215, 16, v103
    v_and_b32 v103, 0xffff0000, v103
    v_lshlrev_b32 v216, 16, v104
    v_and_b32 v104, 0xffff0000, v104
    v_lshlrev_b32 v217, 16, v105
    v_and_b32 v105, 0xffff0000, v105
    v_lshlrev_b32 v218, 16, v106
    v_and_b32 v106, 0xffff0000, v106
    v_lshlrev_b32 v219, 16, v107
    v_and_b32 v107, 0xffff0000, v107
    v_lshlrev_b32 v220, 16, v108
    v_and_b32 v108, 0xffff0000, v108
    v_lshlrev_b32_e64 v221, 16, v109
    v_and_b32 v109, 0xffff0000, v109
    v_pk_mul_f32 v[240:241], v[214:215], v[224:225]
    v_pk_mul_f32 v[242:243], v[102:103], v[226:227]
    v_pk_mul_f32 v[244:245], v[216:217], v[224:225]
    v_pk_mul_f32 v[246:247], v[104:105], v[226:227]
    v_pk_mul_f32 v[248:249], v[218:219], v[224:225]
    v_pk_mul_f32 v[250:251], v[106:107], v[226:227]
    v_pk_mul_f32 v[252:253], v[220:221], v[224:225]
    v_pk_mul_f32 v[254:255], v[108:109], v[226:227]
    v_pk_fma_f32 v[240:241], v[212:213], v[228:229], v[240:241]
    v_pk_fma_f32 v[242:243], v[100:101], v[230:231], v[242:243]
    v_pk_fma_f32 v[244:245], v[214:215], v[228:229], v[244:245]
    v_pk_fma_f32 v[246:247], v[102:103], v[230:231], v[246:247]
    v_pk_fma_f32 v[248:249], v[216:217], v[228:229], v[248:249]
    v_pk_fma_f32 v[250:251], v[104:105], v[230:231], v[250:251]
    v_pk_fma_f32 v[252:253], v[218:219], v[228:229], v[252:253]
    v_pk_fma_f32 v[254:255], v[106:107], v[230:231], v[254:255]
    v_pk_fma_f32 v[240:241], v[210:211], v[232:233], v[240:241]
    v_pk_fma_f32 v[242:243], v[98:99], v[234:235], v[242:243]
    v_pk_fma_f32 v[244:245], v[212:213], v[232:233], v[244:245]
    v_pk_fma_f32 v[246:247], v[100:101], v[234:235], v[246:247]
    v_pk_fma_f32 v[248:249], v[214:215], v[232:233], v[248:249]
    v_pk_fma_f32 v[250:251], v[102:103], v[234:235], v[250:251]
    v_pk_fma_f32 v[252:253], v[216:217], v[232:233], v[252:253]
    v_pk_fma_f32 v[254:255], v[104:105], v[234:235], v[254:255]
    v_pk_fma_f32 v[240:241], v[208:209], v[236:237], v[240:241]
    v_pk_fma_f32 v[242:243], v[96:97], v[238:239], v[242:243]
    v_pk_fma_f32 v[244:245], v[210:211], v[236:237], v[244:245]
    v_pk_fma_f32 v[246:247], v[98:99], v[238:239], v[246:247]
    v_pk_fma_f32 v[248:249], v[212:213], v[236:237], v[248:249]
    v_pk_fma_f32 v[250:251], v[100:101], v[238:239], v[250:251]
    v_pk_fma_f32 v[252:253], v[214:215], v[236:237], v[252:253]
    v_pk_fma_f32 v[254:255], v[102:103], v[238:239], v[254:255]
    s_waitcnt vmcnt(13)
    v_lshlrev_b32 v208, 16, v110
    v_and_b32 v110, 0xffff0000, v110
    v_lshlrev_b32 v209, 16, v111
    v_and_b32 v111, 0xffff0000, v111
    v_lshlrev_b32 v210, 16, v112
    v_and_b32 v112, 0xffff0000, v112
    v_lshlrev_b32 v211, 16, v113
    v_and_b32 v113, 0xffff0000, v113
    v_lshlrev_b32 v212, 16, v114
    v_and_b32 v114, 0xffff0000, v114
    v_lshlrev_b32 v213, 16, v115
    v_and_b32 v115, 0xffff0000, v115
    v_lshlrev_b32 v214, 16, v116
    v_and_b32 v116, 0xffff0000, v116
    v_lshlrev_b32_e64 v215, 16, v117
    v_and_b32 v117, 0xffff0000, v117
    v_pk_mul_f32 v[240:241], v[240:241], v[208:209]
    v_pk_mul_f32 v[242:243], v[242:243], v[110:111]
    v_pk_mul_f32 v[244:245], v[244:245], v[210:211]
    v_pk_mul_f32 v[246:247], v[246:247], v[112:113]
    v_pk_mul_f32 v[248:249], v[248:249], v[212:213]
    v_pk_mul_f32 v[250:251], v[250:251], v[114:115]
    v_pk_mul_f32 v[252:253], v[252:253], v[214:215]
    v_pk_mul_f32 v[254:255], v[254:255], v[116:117]
    v_cvt_pk_bf16_f32 v224, v252, v248
    v_cvt_pk_bf16_f32 v225, v244, v240
    v_cvt_pk_bf16_f32 v226, v254, v250
    v_cvt_pk_bf16_f32 v227, v246, v242
    v_cvt_pk_bf16_f32 v228, v253, v249
    v_cvt_pk_bf16_f32 v229, v245, v241
    v_cvt_pk_bf16_f32 v230, v255, v251
    v_cvt_pk_bf16_f32 v231, v247, v243
    ds_write_b64 v203, v[224:225] offset:0
    ds_write_b64 v203, v[226:227] offset:128
    ds_write_b64 v203, v[228:229] offset:256
    ds_write_b64 v203, v[230:231] offset:384
    s_movk_i32 s79, 1152
    s_movk_i32 s80, 4608
    v_add_u32 v22, s79, v14
    v_add_u32 v23, s79, v15
    v_add_u32 v24, s79, v16
    v_add_u32 v25, s79, v17
    buffer_load_dwordx2 v[156:157], v23, s[44:47], 0 offen nt
    buffer_load_dwordx2 v[158:159], v24, s[44:47], 0 offen nt
    buffer_load_dwordx2 v[160:161], v25, s[44:47], 0 offen nt
    buffer_load_dwordx2 v[162:163], v22, s[44:47], 0 offen offset:0 nt
    buffer_load_dwordx2 v[164:165], v22, s[44:47], 0 offen offset:1280 nt
    buffer_load_dwordx2 v[166:167], v22, s[44:47], 0 offen offset:2560 nt
    buffer_load_dwordx2 v[168:169], v22, s[44:47], 0 offen offset:3840 nt
    buffer_load_dwordx4 v[178:181], v18, s[52:55], s80 offen
    buffer_load_dwordx4 v[182:185], v18, s[52:55], s80 offen offset:16
    buffer_load_dwordx2 v[170:171], v22, s[48:51], 0 offen offset:0 nt
    buffer_load_dwordx2 v[172:173], v22, s[48:51], 0 offen offset:1280 nt
    buffer_load_dwordx2 v[174:175], v22, s[48:51], 0 offen offset:2560 nt
    buffer_load_dwordx2 v[176:177], v22, s[48:51], 0 offen offset:3840 nt
    s_mov_b32 s36, s30
    s_mov_b32 s37, s31
    s_mov_b32 s38, 17563648
    s_mov_b32 s39, 0x20000
    v_mov_b32 v30, 17563648
    s_cmp_eq_u32 s3, 0
    s_cselect_b32 s80, s68, 17563648
    v_writelane_b32 v30, s80, 1
    s_lshl_b32 s77, s57, 1
    s_lshr_b32 s78, s58, 4
    s_add_u32 s77, s77, s78
    s_lshl_b32 s77, s77, 4
    s_and_b32 s78, s58, 15
    s_add_u32 s77, s77, s78
    s_lshl_b32 s77, s77, 6
    s_add_u32 s77, s77, 196608
    s_cmp_eq_u32 s3, 0
    s_cselect_b32 s77, s77, 17563648
    v_writelane_b32 v30, s77, 0
    s_and_b32 s77, s58, 7
    s_lshl_b32 s77, s77, 5
    s_lshl_b32 s78, s57, 2
    s_lshr_b32 s79, s58, 3
    s_add_u32 s78, s78, s79
    s_add_u32 s77, s77, s78
    s_lshl_b32 s77, s77, 6
    s_add_u32 s77, s77, 163840
    s_cmp_eq_u32 s3, 0
    s_cselect_b32 s77, s77, 17563648
    v_writelane_b32 v30, s77, 2
    s_waitcnt lgkmcnt(0)
    s_add_u32 s56, s56, 2654435769
    v_mov_b32 v31, s56
    s_waitcnt vmcnt(17)
    v_lshlrev_b32 v224, 16, v148
    v_and_b32 v228, 0xffff0000, v148
    v_lshlrev_b32 v225, 16, v152
    v_and_b32 v229, 0xffff0000, v152
    v_lshlrev_b32 v226, 16, v150
    v_and_b32 v230, 0xffff0000, v150
    v_lshlrev_b32 v227, 16, v154
    v_and_b32 v231, 0xffff0000, v154
    v_lshlrev_b32 v232, 16, v149
    v_and_b32 v236, 0xffff0000, v149
    v_lshlrev_b32 v233, 16, v153
    v_and_b32 v237, 0xffff0000, v153
    v_lshlrev_b32 v234, 16, v151
    v_and_b32 v238, 0xffff0000, v151
    v_lshlrev_b32 v235, 16, v155
    v_and_b32 v239, 0xffff0000, v155
    v_lshlrev_b32 v208, 16, v126
    v_and_b32 v126, 0xffff0000, v126
    v_lshlrev_b32 v209, 16, v127
    v_and_b32 v127, 0xffff0000, v127
    v_lshlrev_b32 v210, 16, v128
    v_and_b32 v128, 0xffff0000, v128
    v_lshlrev_b32 v211, 16, v129
    v_and_b32 v129, 0xffff0000, v129
    v_lshlrev_b32 v212, 16, v130
    v_and_b32 v130, 0xffff0000, v130
    v_lshlrev_b32 v213, 16, v131
    v_and_b32 v131, 0xffff0000, v131
    v_lshlrev_b32 v214, 16, v132
    v_and_b32 v132, 0xffff0000, v132
    v_lshlrev_b32 v215, 16, v133
    v_and_b32 v133, 0xffff0000, v133
    v_lshlrev_b32 v216, 16, v134
    v_and_b32 v134, 0xffff0000, v134
    v_lshlrev_b32 v217, 16, v135
    v_and_b32 v135, 0xffff0000, v135
    v_lshlrev_b32 v218, 16, v136
    v_and_b32 v136, 0xffff0000, v136
    v_lshlrev_b32 v219, 16, v137
    v_and_b32 v137, 0xffff0000, v137
    v_lshlrev_b32 v220, 16, v138
    v_and_b32 v138, 0xffff0000, v138
    v_lshlrev_b32 v221, 16, v139
    v_and_b32 v139, 0xffff0000, v139
    v_pk_mul_f32 v[240:241], v[214:215], v[224:225]
    v_pk_mul_f32 v[242:243], v[132:133], v[226:227]
    v_pk_mul_f32 v[244:245], v[216:217], v[224:225]
    v_pk_mul_f32 v[246:247], v[134:135], v[226:227]
    v_pk_mul_f32 v[248:249], v[218:219], v[224:225]
    v_pk_mul_f32 v[250:251], v[136:137], v[226:227]
    v_pk_mul_f32 v[252:253], v[220:221], v[224:225]
    v_pk_mul_f32 v[254:255], v[138:139], v[226:227]
    v_pk_fma_f32 v[240:241], v[212:213], v[228:229], v[240:241]
    v_pk_fma_f32 v[242:243], v[130:131], v[230:231], v[242:243]
    v_pk_fma_f32 v[244:245], v[214:215], v[228:229], v[244:245]
    v_pk_fma_f32 v[246:247], v[132:133], v[230:231], v[246:247]
    v_pk_fma_f32 v[248:249], v[216:217], v[228:229], v[248:249]
    v_pk_fma_f32 v[250:251], v[134:135], v[230:231], v[250:251]
    v_pk_fma_f32 v[252:253], v[218:219], v[228:229], v[252:253]
    v_pk_fma_f32 v[254:255], v[136:137], v[230:231], v[254:255]
    v_pk_fma_f32 v[240:241], v[210:211], v[232:233], v[240:241]
    v_pk_fma_f32 v[242:243], v[128:129], v[234:235], v[242:243]
    v_pk_fma_f32 v[244:245], v[212:213], v[232:233], v[244:245]
    v_pk_fma_f32 v[246:247], v[130:131], v[234:235], v[246:247]
    v_pk_fma_f32 v[248:249], v[214:215], v[232:233], v[248:249]
    v_pk_fma_f32 v[250:251], v[132:133], v[234:235], v[250:251]
    v_pk_fma_f32 v[252:253], v[216:217], v[232:233], v[252:253]
    v_pk_fma_f32 v[254:255], v[134:135], v[234:235], v[254:255]
    v_pk_fma_f32 v[240:241], v[208:209], v[236:237], v[240:241]
    v_pk_fma_f32 v[242:243], v[126:127], v[238:239], v[242:243]
    v_pk_fma_f32 v[244:245], v[210:211], v[236:237], v[244:245]
    v_pk_fma_f32 v[246:247], v[128:129], v[238:239], v[246:247]
    v_pk_fma_f32 v[248:249], v[212:213], v[236:237], v[248:249]
    v_pk_fma_f32 v[250:251], v[130:131], v[238:239], v[250:251]
    v_pk_fma_f32 v[252:253], v[214:215], v[236:237], v[252:253]
    v_pk_fma_f32 v[254:255], v[132:133], v[238:239], v[254:255]
    s_waitcnt vmcnt(13)
    v_lshlrev_b32 v208, 16, v140
    v_and_b32 v140, 0xffff0000, v140
    v_lshlrev_b32 v209, 16, v141
    v_and_b32 v141, 0xffff0000, v141
    v_lshlrev_b32 v210, 16, v142
    v_and_b32 v142, 0xffff0000, v142
    v_lshlrev_b32 v211, 16, v143
    v_and_b32 v143, 0xffff0000, v143
    v_lshlrev_b32 v212, 16, v144
    v_and_b32 v144, 0xffff0000, v144
    v_lshlrev_b32 v213, 16, v145
    v_and_b32 v145, 0xffff0000, v145
    v_lshlrev_b32 v214, 16, v146
    v_and_b32 v146, 0xffff0000, v146
    v_lshlrev_b32_e64 v215, 16, v147
    v_and_b32 v147, 0xffff0000, v147
    v_pk_mul_f32 v[240:241], v[240:241], v[208:209]
    v_pk_mul_f32 v[242:243], v[242:243], v[140:141]
    v_pk_mul_f32 v[244:245], v[244:245], v[210:211]
    v_pk_mul_f32 v[246:247], v[246:247], v[142:143]
    v_pk_mul_f32 v[248:249], v[248:249], v[212:213]
    v_pk_mul_f32 v[250:251], v[250:251], v[144:145]
    v_pk_mul_f32 v[252:253], v[252:253], v[214:215]
    v_pk_mul_f32 v[254:255], v[254:255], v[146:147]
    v_cvt_pk_bf16_f32 v224, v252, v248
    v_cvt_pk_bf16_f32 v225, v244, v240
    v_cvt_pk_bf16_f32 v226, v254, v250
    v_cvt_pk_bf16_f32 v227, v246, v242
    v_cvt_pk_bf16_f32 v228, v253, v249
    v_cvt_pk_bf16_f32 v229, v245, v241
    v_cvt_pk_bf16_f32 v230, v255, v251
    v_cvt_pk_bf16_f32 v231, v247, v243
    ds_write_b64 v203, v[224:225] offset:8192
    ds_write_b64 v203, v[226:227] offset:8320
    ds_write_b64 v203, v[228:229] offset:8448
    ds_write_b64 v203, v[230:231] offset:8576
    s_mul_i32 s84, s57, 24
    s_sub_u32 s78, s58, 28
    s_mul_i32 s78, s78, 6
    s_add_u32 s84, s84, s78
    s_add_u32 s84, s84, 448
    s_add_u32 s84, s84, s3
    s_mul_i32 s86, s3, 21248
    s_lshl_b32 s85, s84, 12
    s_add_u32 s44, s12, s85
    s_addc_u32 s45, s13, 0
    s_mov_b32 s46, 4096
    s_mov_b32 s47, 0x20000
    s_add_u32 s88, s85, 1048576
    v_lshlrev_b32_e64 v1, 4, v0
    buffer_load_dwordx4 v[32:35], v1, s[44:47], 0 offen offset:0 nt
    buffer_load_dwordx4 v[36:39], v1, s[44:47], 0 offen offset:1024 nt
    buffer_load_dwordx4 v[40:43], v1, s[44:47], 0 offen offset:2048 nt
    buffer_load_dwordx4 v[44:47], v1, s[44:47], 0 offen offset:3072 nt
    s_lshl_b32 s78, s57, 8
    s_lshl_b32 s79, s58, 3
    s_add_u32 s78, s78, s79
    s_lshl_b32 s79, s3, 1
    s_add_u32 s78, s78, s79
    v_lshrrev_b32 v196, 5, v0
    v_add_u32 v196, s78, v196
    v_and_b32 v197, 31, v0
    v_lshlrev_b32 v197, 3, v197
    v_mad_u32_u24 v197, v196, s73, v197
    v_lshlrev_b32 v196, 3, v196
    buffer_load_dwordx2 v[186:187], v197, s[32:35], 0 offen offset:0
    buffer_load_dwordx2 v[188:189], v197, s[32:35], 0 offen offset:256
    buffer_load_dwordx2 v[190:191], v197, s[32:35], 0 offen offset:512
    buffer_load_dwordx2 v[192:193], v197, s[32:35], 0 offen offset:768
    buffer_load_dwordx2 v[194:195], v197, s[32:35], 0 offen offset:1024
    s_mov_b32 s52, s22
    s_mov_b32 s53, s23
    s_mov_b32 s54, 2211840
    s_mov_b32 s55, 0x20000
    s_and_b32 s77, s58, 7
    s_lshl_b32 s78, s57, 2
    s_lshr_b32 s79, s58, 3
    s_add_u32 s78, s78, s79
    s_mul_i32 s77, s77, 54
    s_add_u32 s77, s77, s78
    s_mul_i32 s77, s77, 5120
    s_add_u32 s77, s77, 4194304
    v_lshrrev_b32_e64 v24, 4, v0
    v_bfe_u32 v25, v0, 2, 2
    v_lshl_add_u32 v24, v24, 2, v25
    v_mul_u32_u24 v24, 160, v24
    v_and_b32 v25, 3, v0
    s_add_u32 s79, s3, 0
    s_cmp_ge_u32 s79, 5
    s_cselect_b32 s80, 1, 0
    s_mul_i32 s81, s80, 5
    s_sub_u32 s79, s79, s81
    s_mul_i32 s81, s80, 163840
    s_add_u32 s81, s81, s77
    s_lshl_b32 s82, s79, 10
    s_add_u32 s81, s81, s82
    s_cmp_ge_u32 s78, 22
    s_cselect_b32 s82, s80, 0
    s_cmp_ge_u32 s79, 5
    s_cselect_b32 s82, 1, s82
    s_cmp_lg_u32 s82, 0
    s_cselect_b32 s74, 17563648, s81
    s_min_u32 s79, s79, 4
    s_and_b32 s82, s79, 1
    s_lshl_b32 s82, s82, 3
    s_lshr_b32 s83, s79, 1
    s_lshl_b32 s83, s83, 6
    s_add_u32 s82, s82, s83
    s_mul_i32 s83, s80, 5120
    s_add_u32 s82, s82, s83
    s_add_u32 s82, s82, 114688
    s_cmp_eq_u32 s79, 4
    s_cselect_b32 s83, 3, 4
    v_lshlrev_b32 v200, s83, v25
    v_add3_u32 v200, v200, v24, s82
    s_add_u32 s79, s3, 4
    s_cmp_ge_u32 s79, 5
    s_cselect_b32 s80, 1, 0
    s_mul_i32 s81, s80, 5
    s_sub_u32 s79, s79, s81
    s_mul_i32 s81, s80, 163840
    s_add_u32 s81, s81, s77
    s_lshl_b32 s82, s79, 10
    s_add_u32 s81, s81, s82
    s_cmp_ge_u32 s78, 22
    s_cselect_b32 s82, s80, 0
    s_cmp_ge_u32 s79, 5
    s_cselect_b32 s82, 1, s82
    s_cmp_lg_u32 s82, 0
    s_cselect_b32 s75, 17563648, s81
    s_min_u32 s79, s79, 4
    s_and_b32 s82, s79, 1
    s_lshl_b32 s82, s82, 3
    s_lshr_b32 s83, s79, 1
    s_lshl_b32 s83, s83, 6
    s_add_u32 s82, s82, s83
    s_mul_i32 s83, s80, 5120
    s_add_u32 s82, s82, s83
    s_add_u32 s82, s82, 114688
    s_cmp_eq_u32 s79, 4
    s_cselect_b32 s83, 3, 4
    v_lshlrev_b32 v201, s83, v25
    v_add3_u32 v201, v201, v24, s82
    s_add_u32 s79, s3, 8
    s_cmp_ge_u32 s79, 5
    s_cselect_b32 s80, 1, 0
    s_mul_i32 s81, s80, 5
    s_sub_u32 s79, s79, s81
    s_mul_i32 s81, s80, 163840
    s_add_u32 s81, s81, s77
    s_lshl_b32 s82, s79, 10
    s_add_u32 s81, s81, s82
    s_cmp_ge_u32 s78, 22
    s_cselect_b32 s82, s80, 0
    s_cmp_ge_u32 s79, 5
    s_cselect_b32 s82, 1, s82
    s_cmp_lg_u32 s82, 0
    s_cselect_b32 s76, 17563648, s81
    s_min_u32 s79, s79, 4
    s_and_b32 s82, s79, 1
    s_lshl_b32 s82, s82, 3
    s_lshr_b32 s83, s79, 1
    s_lshl_b32 s83, s83, 6
    s_add_u32 s82, s82, s83
    s_mul_i32 s83, s80, 5120
    s_add_u32 s82, s82, s83
    s_add_u32 s82, s82, 114688
    s_cmp_eq_u32 s79, 4
    s_cselect_b32 s83, 3, 4
    v_lshlrev_b32 v202, s83, v25
    v_add3_u32 v202, v202, v24, s82
    s_waitcnt vmcnt(13)
    v_lshlrev_b32 v224, 16, v178
    v_and_b32 v228, 0xffff0000, v178
    v_lshlrev_b32 v225, 16, v182
    v_and_b32 v229, 0xffff0000, v182
    v_lshlrev_b32 v226, 16, v180
    v_and_b32 v230, 0xffff0000, v180
    v_lshlrev_b32 v227, 16, v184
    v_and_b32 v231, 0xffff0000, v184
    v_lshlrev_b32 v232, 16, v179
    v_and_b32 v236, 0xffff0000, v179
    v_lshlrev_b32 v233, 16, v183
    v_and_b32 v237, 0xffff0000, v183
    v_lshlrev_b32 v234, 16, v181
    v_and_b32 v238, 0xffff0000, v181
    v_lshlrev_b32 v235, 16, v185
    v_and_b32 v239, 0xffff0000, v185
    v_lshlrev_b32 v208, 16, v156
    v_and_b32 v156, 0xffff0000, v156
    v_lshlrev_b32 v209, 16, v157
    v_and_b32 v157, 0xffff0000, v157
    v_lshlrev_b32 v210, 16, v158
    v_and_b32 v158, 0xffff0000, v158
    v_lshlrev_b32 v211, 16, v159
    v_and_b32 v159, 0xffff0000, v159
    v_lshlrev_b32 v212, 16, v160
    v_and_b32 v160, 0xffff0000, v160
    v_lshlrev_b32 v213, 16, v161
    v_and_b32 v161, 0xffff0000, v161
    v_lshlrev_b32 v214, 16, v162
    v_and_b32 v162, 0xffff0000, v162
    v_lshlrev_b32 v215, 16, v163
    v_and_b32 v163, 0xffff0000, v163
    v_lshlrev_b32 v216, 16, v164
    v_and_b32 v164, 0xffff0000, v164
    v_lshlrev_b32 v217, 16, v165
    v_and_b32 v165, 0xffff0000, v165
    v_lshlrev_b32 v218, 16, v166
    v_and_b32 v166, 0xffff0000, v166
    v_lshlrev_b32 v219, 16, v167
    v_and_b32 v167, 0xffff0000, v167
    v_lshlrev_b32 v220, 16, v168
    v_and_b32 v168, 0xffff0000, v168
    v_lshlrev_b32_e64 v221, 16, v169
    v_and_b32 v169, 0xffff0000, v169
    v_pk_mul_f32 v[240:241], v[214:215], v[224:225]
    v_pk_mul_f32 v[242:243], v[162:163], v[226:227]
    v_pk_mul_f32 v[244:245], v[216:217], v[224:225]
    v_pk_mul_f32 v[246:247], v[164:165], v[226:227]
    v_pk_mul_f32 v[248:249], v[218:219], v[224:225]
    v_pk_mul_f32 v[250:251], v[166:167], v[226:227]
    v_pk_mul_f32 v[252:253], v[220:221], v[224:225]
    v_pk_mul_f32 v[254:255], v[168:169], v[226:227]
    v_pk_fma_f32 v[240:241], v[212:213], v[228:229], v[240:241]
    v_pk_fma_f32 v[242:243], v[160:161], v[230:231], v[242:243]
    v_pk_fma_f32 v[244:245], v[214:215], v[228:229], v[244:245]
    v_pk_fma_f32 v[246:247], v[162:163], v[230:231], v[246:247]
    v_pk_fma_f32 v[248:249], v[216:217], v[228:229], v[248:249]
    v_pk_fma_f32 v[250:251], v[164:165], v[230:231], v[250:251]
    v_pk_fma_f32 v[252:253], v[218:219], v[228:229], v[252:253]
    v_pk_fma_f32 v[254:255], v[166:167], v[230:231], v[254:255]
    v_pk_fma_f32 v[240:241], v[210:211], v[232:233], v[240:241]
    v_pk_fma_f32 v[242:243], v[158:159], v[234:235], v[242:243]
    v_pk_fma_f32 v[244:245], v[212:213], v[232:233], v[244:245]
    v_pk_fma_f32 v[246:247], v[160:161], v[234:235], v[246:247]
    v_pk_fma_f32 v[248:249], v[214:215], v[232:233], v[248:249]
    v_pk_fma_f32 v[250:251], v[162:163], v[234:235], v[250:251]
    v_pk_fma_f32 v[252:253], v[216:217], v[232:233], v[252:253]
    v_pk_fma_f32 v[254:255], v[164:165], v[234:235], v[254:255]
    v_pk_fma_f32 v[240:241], v[208:209], v[236:237], v[240:241]
    v_pk_fma_f32 v[242:243], v[156:157], v[238:239], v[242:243]
    v_pk_fma_f32 v[244:245], v[210:211], v[236:237], v[244:245]
    v_pk_fma_f32 v[246:247], v[158:159], v[238:239], v[246:247]
    v_pk_fma_f32 v[248:249], v[212:213], v[236:237], v[248:249]
    v_pk_fma_f32 v[250:251], v[160:161], v[238:239], v[250:251]
    v_pk_fma_f32 v[252:253], v[214:215], v[236:237], v[252:253]
    v_pk_fma_f32 v[254:255], v[162:163], v[238:239], v[254:255]
    s_waitcnt vmcnt(9)
    v_lshlrev_b32 v208, 16, v170
    v_and_b32 v170, 0xffff0000, v170
    v_lshlrev_b32 v209, 16, v171
    v_and_b32 v171, 0xffff0000, v171
    v_lshlrev_b32 v210, 16, v172
    v_and_b32 v172, 0xffff0000, v172
    v_lshlrev_b32 v211, 16, v173
    v_and_b32 v173, 0xffff0000, v173
    v_lshlrev_b32 v212, 16, v174
    v_and_b32 v174, 0xffff0000, v174
    v_lshlrev_b32 v213, 16, v175
    v_and_b32 v175, 0xffff0000, v175
    v_lshlrev_b32 v214, 16, v176
    v_and_b32 v176, 0xffff0000, v176
    v_lshlrev_b32_e64 v215, 16, v177
    v_and_b32 v177, 0xffff0000, v177
    v_pk_mul_f32 v[240:241], v[240:241], v[208:209]
    v_pk_mul_f32 v[242:243], v[242:243], v[170:171]
    v_pk_mul_f32 v[244:245], v[244:245], v[210:211]
    v_pk_mul_f32 v[246:247], v[246:247], v[172:173]
    v_pk_mul_f32 v[248:249], v[248:249], v[212:213]
    v_pk_mul_f32 v[250:251], v[250:251], v[174:175]
    v_pk_mul_f32 v[252:253], v[252:253], v[214:215]
    v_pk_mul_f32 v[254:255], v[254:255], v[176:177]
    v_cvt_pk_bf16_f32 v224, v252, v248
    v_cvt_pk_bf16_f32 v225, v244, v240
    v_cvt_pk_bf16_f32 v226, v254, v250
    v_cvt_pk_bf16_f32 v227, v246, v242
    v_cvt_pk_bf16_f32 v228, v253, v249
    v_cvt_pk_bf16_f32 v229, v245, v241
    v_cvt_pk_bf16_f32 v230, v255, v251
    v_cvt_pk_bf16_f32 v231, v247, v243
    ds_write_b64 v203, v[224:225] offset:16384
    ds_write_b64 v203, v[226:227] offset:16512
    ds_write_b64 v203, v[228:229] offset:16640
    ds_write_b64 v203, v[230:231] offset:16768
    s_waitcnt lgkmcnt(0)
    s_barrier
    ds_read_b128 v[208:211], v204 offset:0
    ds_read_b128 v[212:215], v204 offset:4096
    ds_read_b128 v[216:219], v204 offset:8192
    ds_read_b128 v[220:223], v204 offset:12288
    ds_read_b128 v[224:227], v204 offset:16384
    ds_read_b128 v[228:231], v204 offset:20480
    s_waitcnt lgkmcnt(4)
    buffer_store_dwordx4 v[208:211], v205, s[36:39], s59 offen sc1
    buffer_store_dwordx4 v[212:215], v206, s[36:39], s59 offen sc1
    s_add_u32 s59, s59, 262144
    s_waitcnt lgkmcnt(2)
    buffer_store_dwordx4 v[216:219], v205, s[36:39], s59 offen sc1
    buffer_store_dwordx4 v[220:223], v206, s[36:39], s59 offen sc1
    s_add_u32 s59, s59, 262144
    s_waitcnt lgkmcnt(0)
    buffer_store_dwordx4 v[224:227], v205, s[36:39], s59 offen sc1
    buffer_store_dwordx4 v[228:231], v206, s[36:39], s59 offen sc1
    s_add_u32 s59, s59, 262144
    s_lshl_b32 s81, s3, 10
    s_add_u32 m0, s81, 114688
    s_nop 0
    buffer_load_dwordx4 v80, s[52:55], 0 offen nt lds
    s_add_u32 m0, s81, 118784
    s_nop 0
    buffer_load_dwordx4 v81, s[52:55], 0 offen nt lds
    s_add_u32 m0, s81, 122880
    s_nop 0
    buffer_load_dwordx4 v82, s[52:55], 0 offen nt lds
    s_waitcnt vmcnt(9)
    s_mov_b32 s78, 0x3f803f80
    v_mov_b32_e64 v232, 0
    v_mov_b32 v233, 0
    v_dot2c_f32_bf16 v232, s78, v186
    v_dot2c_f32_bf16 v233, v186, v186
    v_dot2c_f32_bf16 v232, s78, v187
    v_dot2c_f32_bf16 v233, v187, v187
    v_dot2c_f32_bf16 v232, s78, v188
    v_dot2c_f32_bf16 v233, v188, v188
    v_dot2c_f32_bf16 v232, s78, v189
    v_dot2c_f32_bf16 v233, v189, v189
    v_dot2c_f32_bf16 v232, s78, v190
    v_dot2c_f32_bf16 v233, v190, v190
    v_dot2c_f32_bf16 v232, s78, v191
    v_dot2c_f32_bf16 v233, v191, v191
    v_dot2c_f32_bf16 v232, s78, v192
    v_dot2c_f32_bf16 v233, v192, v192
    v_dot2c_f32_bf16 v232, s78, v193
    v_dot2c_f32_bf16 v233, v193, v193
    v_dot2c_f32_bf16 v232, s78, v194
    v_dot2c_f32_bf16 v233, v194, v194
    v_dot2c_f32_bf16 v232, s78, v195
    v_dot2c_f32_bf16 v233, v195, v195
    s_nop 1
    v_add_f32_dpp v232, v232, v232 row_ror:8 row_mask:0xf bank_mask:0xf
    v_add_f32_dpp v233, v233, v233 row_ror:8 row_mask:0xf bank_mask:0xf
    s_nop 1
    v_add_f32_dpp v232, v232, v232 row_ror:4 row_mask:0xf bank_mask:0xf
    v_add_f32_dpp v233, v233, v233 row_ror:4 row_mask:0xf bank_mask:0xf
    s_nop 1
    v_add_f32_dpp v232, v232, v232 row_ror:2 row_mask:0xf bank_mask:0xf
    v_add_f32_dpp v233, v233, v233 row_ror:2 row_mask:0xf bank_mask:0xf
    s_nop 1
    v_add_f32_dpp v232, v232, v232 row_ror:1 row_mask:0xf bank_mask:0xf
    v_add_f32_dpp v233, v233, v233 row_ror:1 row_mask:0xf bank_mask:0xf
    s_nop 1
    v_add_f32_dpp v232, v232, v232 row_bcast:15 row_mask:0xa bank_mask:0xf
    v_add_f32_dpp v233, v233, v233 row_bcast:15 row_mask:0xa bank_mask:0xf
    s_nop 0
    v_mul_f32 v234, 0x3acccccd, v232
    v_mul_f32 v233, 0x3acccccd, v233
    v_fma_f32 v233, -v234, v234, v233
    v_max_f32 v233, 0, v233
    v_add_f32 v233, 0x3727c5ac, v233
    v_rsq_f32_e64 v235, v233
    s_mov_b32 s78, 65536
    s_mov_b32 exec_lo, 0x10000
    s_mov_b32 exec_hi, 0x10000
    buffer_store_dwordx2 v[234:235], v196, s[36:39], s78 offen sc1
    s_mov_b64 exec, -1
    s_waitcnt vmcnt(4)
    s_barrier
    s_mov_b32 exec_lo, 2
    s_mov_b32 exec_hi, 0
    buffer_store_dword v31, v30, s[36:39], 0 offen sc1
    s_mov_b64 exec, -1
    s_waitcnt vmcnt(16)
I_LATE:
    s_nop 0
    v_mov_b32_dpp v51, v36 wave_rol:1 row_mask:0xf bank_mask:0xf
    v_mov_b32_dpp v64, v37 wave_rol:1 row_mask:0xf bank_mask:0xf
    v_mov_b32_dpp v55, v40 wave_rol:1 row_mask:0xf bank_mask:0xf
    v_mov_b32_dpp v65, v41 wave_rol:1 row_mask:0xf bank_mask:0xf
    v_mov_b32_dpp v59, v44 wave_rol:1 row_mask:0xf bank_mask:0xf
    v_mov_b32_dpp v66, v45 wave_rol:1 row_mask:0xf bank_mask:0xf
    v_mov_b32 v48, v33
    v_mov_b32 v49, v34
    v_mov_b32 v50, v35
    v_mov_b32 v52, v37
    v_mov_b32 v53, v38
    v_mov_b32 v54, v39
    v_mov_b32 v56, v41
    v_mov_b32 v57, v42
    v_mov_b32 v58, v43
    v_mov_b32 v60, v45
PAGE7:
    s_cbranch_execz PAGE8
    v_mov_b32 v61, v46
    v_mov_b32_e64 v62, v47
    v_mov_b32_dpp v51, v32 wave_shl:1 row_mask:0xf bank_mask:0xf
    v_mov_b32_dpp v64, v33 wave_shl:1 row_mask:0xf bank_mask:0xf
    v_mov_b32_dpp v55, v36 wave_shl:1 row_mask:0xf bank_mask:0xf
    v_mov_b32_dpp v65, v37 wave_shl:1 row_mask:0xf bank_mask:0xf
    v_mov_b32_dpp v59, v40 wave_shl:1 row_mask:0xf bank_mask:0xf
    v_mov_b32_dpp v66, v41 wave_shl:1 row_mask:0xf bank_mask:0xf
    v_mov_b32_dpp v63, v44 wave_shl:1 row_mask:0xf bank_mask:0xf bound_ctrl:0
    v_mov_b32_dpp v67, v45 wave_shl:1 row_mask:0xf bank_mask:0xf bound_ctrl:0
    s_nop 1
    v_lshlrev_b32 v1, 4, v0
    v_add_u32 v5, s86, v1
    v_mov_b32 v20, 0
    v_mov_b32 v21, 0
    v_mov_b32 v22, 0
    v_mov_b32 v23, 0
    v_lshrrev_b32 v4, 1, v0
    v_mul_u32_u24 v4, 4160, v4
    v_and_b32 v6, 1, v0
    v_lshl_add_u32 v4, v6, 4, v4
    v_add_u32 v4, s86, v4
    s_mov_b32 exec_lo, 0xff
    s_mov_b32 exec_hi, 0
    ds_write_b128 v4, v[20:23]
    s_mov_b32 exec_lo, -1
    ds_write_b128 v5, v[20:23] offset:16640
    v_lshlrev_b32 v12, 16, v32
    v_alignbit_b32 v13, v48, v32, 16
    s_mov_b32 exec_lo, 1
    ds_write_b32 v5, v12 offset:4188
    ds_write_b32 v5, v32 offset:8348
    ds_write_b64 v5, v[12:13] offset:12504
    s_mov_b64 exec, -1
    s_nop 0
    v_alignbit_b32 v96, v48, v32, 16
    v_alignbit_b32 v100, v49, v48, 16
    v_alignbit_b32 v97, v49, v33, 16
    v_alignbit_b32 v101, v50, v49, 16
    v_alignbit_b32 v98, v50, v34, 16
    v_alignbit_b32 v102, v51, v50, 16
    v_alignbit_b32 v99, v51, v35, 16
    v_alignbit_b32 v103, v64, v51, 16
    ds_write_b128 v5, v[32:35] offset:32
    ds_write_b128 v5, v[96:99] offset:4192
    ds_write_b128 v5, v[48:51] offset:8352
    ds_write_b128 v5, v[100:103] offset:12512
    v_alignbit_b32 v104, v52, v36, 16
    v_alignbit_b32 v108, v53, v52, 16
    v_alignbit_b32 v105, v53, v37, 16
    v_alignbit_b32 v109, v54, v53, 16
    v_alignbit_b32 v106, v54, v38, 16
    v_alignbit_b32 v110, v55, v54, 16
    v_alignbit_b32 v107, v55, v39, 16
    v_alignbit_b32 v111, v65, v55, 16
    ds_write_b128 v5, v[36:39] offset:1056
    ds_write_b128 v5, v[104:107] offset:5216
    ds_write_b128 v5, v[52:55] offset:9376
    ds_write_b128 v5, v[108:111] offset:13536
    v_alignbit_b32 v112, v56, v40, 16
    v_alignbit_b32 v116, v57, v56, 16
    v_alignbit_b32 v113, v57, v41, 16
    v_alignbit_b32 v117, v58, v57, 16
    v_alignbit_b32 v114, v58, v42, 16
    v_alignbit_b32 v118, v59, v58, 16
    v_alignbit_b32 v115, v59, v43, 16
    v_alignbit_b32 v119, v66, v59, 16
    ds_write_b128 v5, v[40:43] offset:2080
    ds_write_b128 v5, v[112:115] offset:6240
    ds_write_b128 v5, v[56:59] offset:10400
    ds_write_b128 v5, v[116:119] offset:14560
    v_and_b32 v28, 31, v0
    v_lshlrev_b32 v28, 6, v28
    v_add_u32 v28, 145408, v28
    buffer_load_dword v25, v28, s[36:39], 0 offen sc1
    v_alignbit_b32 v120, v60, v44, 16
    v_alignbit_b32 v124, v61, v60, 16
    v_alignbit_b32 v121, v61, v45, 16
    v_alignbit_b32 v125, v62, v61, 16
    v_alignbit_b32 v122, v62, v46, 16
    v_alignbit_b32 v126, v63, v62, 16
    v_alignbit_b32 v123, v63, v47, 16
    v_alignbit_b32 v127, v67, v63, 16
    ds_write_b128 v5, v[44:47] offset:3104
    ds_write_b128 v5, v[120:123] offset:7264
    ds_write_b128 v5, v[60:63] offset:11424
    ds_write_b128 v5, v[124:127] offset:15584
    s_lshl_b32 s78, s84, 1
    s_and_b32 s78, s78, -4
    s_load_dword s77, s[14:15], s78
    s_waitcnt vmcnt(2)
    s_barrier
    s_mov_b32 exec_lo, 1
    s_mov_b32 exec_hi, 0
    buffer_store_dword v31, v30, s[36:39], 0 offen sc1
    s_mov_b64 exec, -1
    s_nop 0
    ds_read_b64_tr_b16 v[236:237], v200 offset:0
    ds_read_b64_tr_b16 v[238:239], v200 offset:2560
    ds_read_b64_tr_b16 v[240:241], v201 offset:0
    ds_read_b64_tr_b16 v[242:243], v201 offset:2560
    ds_read_b64_tr_b16 v[244:245], v202 offset:0
    ds_read_b64_tr_b16 v[246:247], v202 offset:2560
    v_lshlrev_b32 v26, 4, v0
    s_waitcnt lgkmcnt(0)
    buffer_store_dwordx4 v[236:239], v26, s[36:39], s74 offen sc1
    buffer_store_dwordx4 v[240:243], v26, s[36:39], s75 offen sc1
    buffer_store_dwordx4 v[244:247], v26, s[36:39], s76 offen sc1
    s_waitcnt vmcnt(4)
    v_cmp_ne_u32 vcc, s56, v25
    s_mov_b64 s[82:83], vcc
    s_cmp_eq_u64 s[82:83], 0
    s_cbranch_scc0 FAI_RETRY_17
FAI_DONE_18:
    v_lshlrev_b32 v1, 4, v0
    buffer_load_dwordx4 v[80:83], v1, s[36:39], s88 offen offset:0 sc1
    buffer_load_dwordx4 v[84:87], v1, s[36:39], s88 offen offset:1024 sc1
    buffer_load_dwordx4 v[88:91], v1, s[36:39], s88 offen offset:2048 sc1
    buffer_load_dwordx4 v[92:95], v1, s[36:39], s88 offen offset:3072 sc1
    s_lshr_b32 s78, s57, 1
    s_lshl_b32 s78, s78, 3
    s_and_b32 s79, s58, 7
    s_add_u32 s53, s78, s79
    s_mul_i32 s28, s79, 7
    s_and_b32 s78, s57, 1
    s_lshl_b32 s78, s78, 2
    s_lshr_b32 s79, s58, 3
    s_add_u32 s54, s78, s79
    s_mul_i32 s79, s79, 14
    s_add_u32 s28, s28, s79
    s_lshr_b32 s28, s28, 2
    s_cmp_ge_u32 s28, 14
    s_cselect_b32 s79, 14, 0
    s_sub_u32 s28, s28, s79
    s_mov_b32 s28, 0
    s_mul_i32 s55, s3, 14
    s_sub_u32 s79, s3, 1
    s_cmp_ge_u32 s3, 2
    s_cselect_b32 s79, s79, 0
    s_sub_u32 s55, s55, s79
    s_mul_i32 s79, s54, 54
    s_add_u32 s79, s79, s55
    s_mul_i32 s79, s79, 5120
    s_add_u32 s79, s79, 4194304
    s_add_u32 s16, s79, 71680
    s_mul_i32 s52, s28, 5120
    s_add_u32 s52, s52, s79
    v_lshlrev_b32 v14, 4, v0
    v_add_u32 v15, 4096, v14
    s_mov_b32 s40, s24
    s_mov_b32 s41, s25
    s_mov_b32 s42, 1280
    s_mov_b32 s43, 0x20000
    v_lshrrev_b32 v16, 4, v0
    s_mul_i32 s78, s54, 160
    v_lshlrev_b32 v17, 4, v16
    v_lshlrev_b32 v18, 3, v16
    buffer_load_dwordx4 a[240:243], v17, s[40:43], s78 offen
    buffer_load_dwordx4 a[244:247], v17, s[40:43], s78 offen offset:64
    buffer_load_dwordx2 a[248:249], v18, s[40:43], s78 offen offset:128
    s_mov_b32 s68, 7
    v_and_b32 v27, 31, v0
    v_lshlrev_b32 v27, 6, v27
    s_lshl_b32 s73, s68, 11
    s_add_u32 s73, s73, 131072
    s_lshl_b32 s78, s54, 11
    s_add_u32 s78, s78, 163840
    v_mov_b32 v16, s73
    v_mov_b32 v18, s78
    v_and_b32 v19, 32, v0
    v_cmp_eq_u32 vcc, 0, v19
    s_nop 1
    v_cndmask_b32 v16, v18, v16, vcc
    v_add_u32 v27, v16, v27
    s_waitcnt lgkmcnt(0)
    v_and_b32 v6, 15, v0
    v_lshrrev_b32 v7, 4, v0
    v_add_u32 v8, 1, v6
    v_and_b32 v9, 3, v8
    v_and_b32 v8, 28, v8
    v_mul_u32_u24 v9, 4160, v9
    v_lshl_add_u32 v9, v8, 1, v9
    v_lshl_add_u32 v9, v7, 4, v9
    v_add_u32 v2, s86, v9
    v_lshlrev_b32 v8, 1, v6
    v_sub_u32 v8, v8, v7
    v_lshlrev_b32 v8, 4, v8
    v_add_u32 v8, 16720, v8
    v_add_u32 v3, s86, v8
    v_sub_u32 v8, 15, v6
    v_lshrrev_b32_e64 v9, 3, v8
    v_cmp_eq_u32 s[80:81], v9, v7
    v_bfe_u32 v9, v8, 1, 2
    v_and_b32 v10, 1, v8
    v_lshlrev_b32 v10, 4, v10
    s_and_b32 s78, s84, 1
    s_lshl_b32 s78, s78, 4
    s_lshr_b32 s77, s77, s78
    s_and_b32 s77, s77, 0xffff
    v_mov_b32 v11, s77
    v_lshlrev_b32 v11, v10, v11
    v_cndmask_b32 v11, 0, v11, s[80:81]
    v_cmp_eq_u32 vcc, 0, v9
    s_nop 1
    v_cndmask_b32 v192, 0, v11, vcc
    v_cmp_eq_u32 vcc, 1, v9
    s_nop 1
    v_cndmask_b32 v193, 0, v11, vcc
    v_cmp_eq_u32 vcc, 2, v9
    s_nop 1
    v_cndmask_b32 v194, 0, v11, vcc
    v_cmp_eq_u32 vcc, 3, v9
    s_nop 1
    v_cndmask_b32 v195, 0, v11, vcc
    s_waitcnt vmcnt(7)
    s_barrier
    s_mov_b32 exec_lo, 4
    s_mov_b32 exec_hi, 0
    buffer_store_dword v31, v30, s[36:39], 0 offen sc1
    s_mov_b64 exec, -1
    s_waitcnt vmcnt(4)
    v_lshlrev_b32 v1, 4, v0
    v_add_u32_e64 v5, s86, v1
    ds_write_b128 v5, v[80:83] offset:17152
    ds_write_b128 v5, v[84:87] offset:18176
    ds_write_b128 v5, v[88:91] offset:19200
    ds_write_b128 v5, v[92:95] offset:20224
    s_add_u32 s18, s85, 7340032
    s_sub_u32 s84, s84, s3
    s_lshl_b32 s48, s84, 5
    s_add_u32 s48, s48, 262144
    s_cmp_eq_u32 s3, 0
    s_cselect_b32 s48, s48, 17563648
    s_mov_b32 s50, 3
    s_add_u32 s84, s84, 4
    s_lshr_b32 s78, s3, 1
    s_add_u32 s84, s84, s78
    s_and_b32 s87, s3, 1
    s_mul_i32 s86, s78, 21248
    s_lshl_b32 s85, s84, 12
    s_add_u32 s44, s12, s85
    s_addc_u32 s45, s13, 0
    s_mov_b32 s46, 4096
    s_mov_b32 s47, 0x20000
    s_lshl_b32 s89, s87, 11
    s_add_u32 s88, s85, s89
    s_add_u32 s88, s88, 1048576
    s_lshl_b32 s78, s84, 1
    s_and_b32 s78, s78, -4
    s_load_dword s77, s[14:15], s78
    s_waitcnt lgkmcnt(0)
    ds_read_b128 v[64:67], v3 offset:448
    ds_read_b64 v[32:33], v2 offset:0
    ds_read_b64 v[34:35], v2 offset:8
    ds_read_b128 v[68:71], v3 offset:960
    ds_read_b64 v[36:37], v2 offset:512
    ds_read_b64 v[38:39], v2 offset:520
    ds_read_b128 v[72:75], v3 offset:1472
    ds_read_b64 v[40:41], v2 offset:1024
    ds_read_b64 v[42:43], v2 offset:1032
    ds_read_b128 v[76:79], v3 offset:1984
    ds_read_b64 v[44:45], v2 offset:1536
    ds_read_b64 v[46:47], v2 offset:1544
    ds_read_b128 v[80:83], v3 offset:2496
    ds_read_b64 v[48:49], v2 offset:2048
    ds_read_b64 v[50:51], v2 offset:2056
    ds_read_b128 v[84:87], v3 offset:3008
    ds_read_b64 v[52:53], v2 offset:2560
    ds_read_b64 v[54:55], v2 offset:2568
    ds_read_b128 v[88:91], v3 offset:3520
    ds_read_b64 v[56:57], v2 offset:3072
    ds_read_b64 v[58:59], v2 offset:3080
    ds_read_b128 v[92:95], v3 offset:4032
    ds_read_b64 v[60:61], v2 offset:3584
    ds_read_b64 v[62:63], v2 offset:3592
    s_waitcnt lgkmcnt(15)
    v_mfma_f32_16x16x32_bf16 v[160:163], v[192:195], v[64:67], 0
    ds_read_b128 v[128:131], v3 offset:384
    v_mfma_f32_16x16x32_bf16 v[164:167], v[192:195], v[68:71], 0
    ds_read_b64 v[96:97], v2 offset:64
    v_mfma_f32_16x16x32_bf16 v[168:171], v[192:195], v[72:75], 0
    ds_read_b64 v[98:99], v2 offset:72
    s_waitcnt lgkmcnt(15)
    v_mfma_f32_16x16x32_bf16 v[172:175], v[192:195], v[76:79], 0
    ds_read_b128 v[132:135], v3 offset:896
    s_waitcnt lgkmcnt(15)
    v_mfma_f32_16x16x32_bf16 v[176:179], v[192:195], v[80:83], 0
    ds_read_b64 v[100:101], v2 offset:576
    buffer_load_dwordx4 v[200:203], v14, s[44:47], s89 offen offset:0 nt
    s_waitcnt lgkmcnt(13)
    v_mfma_f32_16x16x32_bf16 v[180:183], v[192:195], v[84:87], 0
    ds_read_b64 v[102:103], v2 offset:584
    s_waitcnt lgkmcnt(11)
    v_mfma_f32_16x16x32_bf16 v[184:187], v[192:195], v[88:91], 0
    ds_read_b128 v[136:139], v3 offset:1408
    s_waitcnt lgkmcnt(9)
    v_mfma_f32_16x16x32_bf16 v[188:191], v[192:195], v[92:95], 0
    ds_read_b64 v[104:105], v2 offset:1088
    s_waitcnt lgkmcnt(8)
    s_nop 0
    v_mfma_f32_16x16x32_bf16 v[160:163], v[32:35], v[64:67], v[160:163]
    ds_read_b64 v[106:107], v2 offset:1096
    v_mfma_f32_16x16x32_bf16 v[164:167], v[32:35], v[68:71], v[164:167]
    ds_read_b128 v[140:143], v3 offset:1920
    v_mfma_f32_16x16x32_bf16 v[168:171], v[32:35], v[72:75], v[168:171]
    ds_read_b64 v[108:109], v2 offset:1600
    v_mfma_f32_16x16x32_bf16 v[172:175], v[32:35], v[76:79], v[172:175]
    ds_read_b64 v[110:111], v2 offset:1608
    v_mfma_f32_16x16x32_bf16 v[176:179], v[32:35], v[80:83], v[176:179]
    ds_read_b128 v[144:147], v3 offset:2432
    v_mfma_f32_16x16x32_bf16 v[180:183], v[32:35], v[84:87], v[180:183]
    ds_read_b64 v[112:113], v2 offset:2112
    buffer_load_dwordx4 v[204:207], v14, s[44:47], s89 offen offset:1024 nt
    v_mfma_f32_16x16x32_bf16 v[184:187], v[32:35], v[88:91], v[184:187]
    ds_read_b64 v[114:115], v2 offset:2120
    v_mfma_f32_16x16x32_bf16 v[188:191], v[32:35], v[92:95], v[188:191]
    ds_read_b128 v[148:151], v3 offset:2944
    v_mfma_f32_16x16x32_bf16 v[164:167], v[36:39], v[64:67], v[164:167]
    ds_read_b64 v[116:117], v2 offset:2624
    v_mfma_f32_16x16x32_bf16 v[168:171], v[36:39], v[68:71], v[168:171]
    ds_read_b64 v[118:119], v2 offset:2632
    v_mfma_f32_16x16x32_bf16 v[172:175], v[36:39], v[72:75], v[172:175]
    ds_read_b128 v[152:155], v3 offset:3456
    v_mfma_f32_16x16x32_bf16 v[176:179], v[36:39], v[76:79], v[176:179]
    ds_read_b64 v[120:121], v2 offset:3136
    v_mfma_f32_16x16x32_bf16 v[180:183], v[36:39], v[80:83], v[180:183]
    ds_read_b64 v[122:123], v2 offset:3144
    v_mfma_f32_16x16x32_bf16 v[184:187], v[36:39], v[84:87], v[184:187]
    ds_read_b128 v[156:159], v3 offset:3968
    v_mfma_f32_16x16x32_bf16 v[188:191], v[36:39], v[88:91], v[188:191]
    ds_read_b64 v[124:125], v2 offset:3648
    buffer_load_dwordx2 v[220:221], v14, s[44:47], s89 offen offset:2048 nt
    v_mfma_f32_16x16x32_bf16 v[168:171], v[40:43], v[64:67], v[168:171]
    ds_read_b64 v[126:127], v2 offset:3656
    v_mfma_f32_16x16x32_bf16 v[172:175], v[40:43], v[68:71], v[172:175]
    v_mfma_f32_16x16x32_bf16 v[176:179], v[40:43], v[72:75], v[176:179]
    v_mfma_f32_16x16x32_bf16 v[180:183], v[40:43], v[76:79], v[180:183]
    v_mfma_f32_16x16x32_bf16 v[184:187], v[40:43], v[80:83], v[184:187]
    v_mfma_f32_16x16x32_bf16 v[188:191], v[40:43], v[84:87], v[188:191]
    v_mfma_f32_16x16x32_bf16 v[172:175], v[44:47], v[64:67], v[172:175]
    v_mfma_f32_16x16x32_bf16 v[176:179], v[44:47], v[68:71], v[176:179]
    buffer_load_dwordx4 v[224:227], v14, s[36:39], s88 offen offset:0 sc1
    v_mfma_f32_16x16x32_bf16 v[180:183], v[44:47], v[72:75], v[180:183]
    v_mfma_f32_16x16x32_bf16 v[184:187], v[44:47], v[76:79], v[184:187]
    v_mfma_f32_16x16x32_bf16 v[188:191], v[44:47], v[80:83], v[188:191]
    v_mfma_f32_16x16x32_bf16 v[176:179], v[48:51], v[64:67], v[176:179]
    v_mfma_f32_16x16x32_bf16 v[180:183], v[48:51], v[68:71], v[180:183]
    v_mfma_f32_16x16x32_bf16 v[184:187], v[48:51], v[72:75], v[184:187]
    v_mfma_f32_16x16x32_bf16 v[188:191], v[48:51], v[76:79], v[188:191]
    v_mfma_f32_16x16x32_bf16 v[180:183], v[52:55], v[64:67], v[180:183]
    v_mfma_f32_16x16x32_bf16 v[184:187], v[52:55], v[68:71], v[184:187]
    buffer_load_dwordx4 v[228:231], v14, s[36:39], s88 offen offset:1024 sc1
    v_mfma_f32_16x16x32_bf16 v[188:191], v[52:55], v[72:75], v[188:191]
    v_mfma_f32_16x16x32_bf16 v[184:187], v[56:59], v[64:67], v[184:187]
    v_mfma_f32_16x16x32_bf16 v[188:191], v[56:59], v[68:71], v[188:191]
    v_mfma_f32_16x16x32_bf16 v[188:191], v[60:63], v[64:67], v[188:191]
    s_waitcnt lgkmcnt(0)
    s_nop 0
    v_mfma_f32_16x16x32_bf16 v[160:163], v[96:99], v[128:131], v[160:163]
    ds_read_b128 v[64:67], v3 offset:320
    v_mfma_f32_16x16x32_bf16 v[164:167], v[96:99], v[132:135], v[164:167]
    ds_read_b64 v[32:33], v2 offset:128
    v_mfma_f32_16x16x32_bf16 v[168:171], v[96:99], v[136:139], v[168:171]
    ds_read_b64 v[34:35], v2 offset:136
    v_mfma_f32_16x16x32_bf16 v[172:175], v[96:99], v[140:143], v[172:175]
    ds_read_b128 v[68:71], v3 offset:832
    v_mfma_f32_16x16x32_bf16 v[176:179], v[96:99], v[144:147], v[176:179]
    ds_read_b64 v[36:37], v2 offset:640
    v_mfma_f32_16x16x32_bf16 v[180:183], v[96:99], v[148:151], v[180:183]
    ds_read_b64 v[38:39], v2 offset:648
    v_mfma_f32_16x16x32_bf16 v[184:187], v[96:99], v[152:155], v[184:187]
    ds_read_b128 v[72:75], v3 offset:1344
    v_mfma_f32_16x16x32_bf16 v[188:191], v[96:99], v[156:159], v[188:191]
    ds_read_b64 v[40:41], v2 offset:1152
    v_mfma_f32_16x16x32_bf16 v[164:167], v[100:103], v[128:131], v[164:167]
    ds_read_b64 v[42:43], v2 offset:1160
    v_mfma_f32_16x16x32_bf16 v[168:171], v[100:103], v[132:135], v[168:171]
    ds_read_b128 v[76:79], v3 offset:1856
    v_mfma_f32_16x16x32_bf16 v[172:175], v[100:103], v[136:139], v[172:175]
    ds_read_b64 v[44:45], v2 offset:1664
    v_mfma_f32_16x16x32_bf16 v[176:179], v[100:103], v[140:143], v[176:179]
    ds_read_b64 v[46:47], v2 offset:1672
    v_mfma_f32_16x16x32_bf16 v[180:183], v[100:103], v[144:147], v[180:183]
    ds_read_b128 v[80:83], v3 offset:2368
    v_mfma_f32_16x16x32_bf16 v[184:187], v[100:103], v[148:151], v[184:187]
    ds_read_b64 v[48:49], v2 offset:2176
    v_mfma_f32_16x16x32_bf16 v[188:191], v[100:103], v[152:155], v[188:191]
    ds_read_b64 v[50:51], v2 offset:2184
    v_mfma_f32_16x16x32_bf16 v[168:171], v[104:107], v[128:131], v[168:171]
    ds_read_b128 v[84:87], v3 offset:2880
    v_mfma_f32_16x16x32_bf16 v[172:175], v[104:107], v[132:135], v[172:175]
    ds_read_b64 v[52:53], v2 offset:2688
    v_mfma_f32_16x16x32_bf16 v[176:179], v[104:107], v[136:139], v[176:179]
    ds_read_b64 v[54:55], v2 offset:2696
    v_mfma_f32_16x16x32_bf16 v[180:183], v[104:107], v[140:143], v[180:183]
    ds_read_b128 v[88:91], v3 offset:3392
    v_mfma_f32_16x16x32_bf16 v[184:187], v[104:107], v[144:147], v[184:187]
    ds_read_b64 v[56:57], v2 offset:3200
    v_mfma_f32_16x16x32_bf16 v[188:191], v[104:107], v[148:151], v[188:191]
    ds_read_b64 v[58:59], v2 offset:3208
    v_mfma_f32_16x16x32_bf16 v[172:175], v[108:111], v[128:131], v[172:175]
    ds_read_b128 v[92:95], v3 offset:3904
    v_mfma_f32_16x16x32_bf16 v[176:179], v[108:111], v[132:135], v[176:179]
    ds_read_b64 v[60:61], v2 offset:3712
    v_mfma_f32_16x16x32_bf16 v[180:183], v[108:111], v[136:139], v[180:183]
    ds_read_b64 v[62:63], v2 offset:3720
    v_mfma_f32_16x16x32_bf16 v[184:187], v[108:111], v[140:143], v[184:187]
    v_mfma_f32_16x16x32_bf16 v[188:191], v[108:111], v[144:147], v[188:191]
    v_mfma_f32_16x16x32_bf16 v[176:179], v[112:115], v[128:131], v[176:179]
    v_mfma_f32_16x16x32_bf16 v[180:183], v[112:115], v[132:135], v[180:183]
    v_mfma_f32_16x16x32_bf16 v[184:187], v[112:115], v[136:139], v[184:187]
    v_mfma_f32_16x16x32_bf16 v[188:191], v[112:115], v[140:143], v[188:191]
    v_mfma_f32_16x16x32_bf16 v[180:183], v[116:119], v[128:131], v[180:183]
    v_mfma_f32_16x16x32_bf16 v[184:187], v[116:119], v[132:135], v[184:187]
    v_mfma_f32_16x16x32_bf16 v[188:191], v[116:119], v[136:139], v[188:191]
    v_mfma_f32_16x16x32_bf16 v[184:187], v[120:123], v[128:131], v[184:187]
    v_mfma_f32_16x16x32_bf16 v[188:191], v[120:123], v[132:135], v[188:191]
    v_mfma_f32_16x16x32_bf16 v[188:191], v[124:127], v[128:131], v[188:191]
    s_waitcnt lgkmcnt(0)
    s_nop 0
    v_mfma_f32_16x16x32_bf16 v[160:163], v[32:35], v[64:67], v[160:163]
    ds_read_b128 v[128:131], v3 offset:256
    v_mfma_f32_16x16x32_bf16 v[164:167], v[32:35], v[68:71], v[164:167]
    ds_read_b64 v[96:97], v2 offset:192
    v_mfma_f32_16x16x32_bf16 v[168:171], v[32:35], v[72:75], v[168:171]
    ds_read_b64 v[98:99], v2 offset:200
    v_mfma_f32_16x16x32_bf16 v[172:175], v[32:35], v[76:79], v[172:175]
    ds_read_b128 v[132:135], v3 offset:768
    v_mfma_f32_16x16x32_bf16 v[176:179], v[32:35], v[80:83], v[176:179]
    ds_read_b64 v[100:101], v2 offset:704
    v_mfma_f32_16x16x32_bf16 v[180:183], v[32:35], v[84:87], v[180:183]
    ds_read_b64 v[102:103], v2 offset:712
    v_mfma_f32_16x16x32_bf16 v[184:187], v[32:35], v[88:91], v[184:187]
    ds_read_b128 v[136:139], v3 offset:1280
    v_mfma_f32_16x16x32_bf16 v[188:191], v[32:35], v[92:95], v[188:191]
    ds_read_b64 v[104:105], v2 offset:1216
    v_mfma_f32_16x16x32_bf16 v[164:167], v[36:39], v[64:67], v[164:167]
    ds_read_b64 v[106:107], v2 offset:1224
    v_mfma_f32_16x16x32_bf16 v[168:171], v[36:39], v[68:71], v[168:171]
    ds_read_b128 v[140:143], v3 offset:1792
    v_mfma_f32_16x16x32_bf16 v[172:175], v[36:39], v[72:75], v[172:175]
    ds_read_b64 v[108:109], v2 offset:1728
    v_mfma_f32_16x16x32_bf16 v[176:179], v[36:39], v[76:79], v[176:179]
    ds_read_b64 v[110:111], v2 offset:1736
    v_mfma_f32_16x16x32_bf16 v[180:183], v[36:39], v[80:83], v[180:183]
    ds_read_b128 v[144:147], v3 offset:2304
    v_mfma_f32_16x16x32_bf16 v[184:187], v[36:39], v[84:87], v[184:187]
    ds_read_b64 v[112:113], v2 offset:2240
    v_mfma_f32_16x16x32_bf16 v[188:191], v[36:39], v[88:91], v[188:191]
    ds_read_b64 v[114:115], v2 offset:2248
    v_mfma_f32_16x16x32_bf16 v[168:171], v[40:43], v[64:67], v[168:171]
    ds_read_b128 v[148:151], v3 offset:2816
    v_mfma_f32_16x16x32_bf16 v[172:175], v[40:43], v[68:71], v[172:175]
    ds_read_b64 v[116:117], v2 offset:2752
    v_mfma_f32_16x16x32_bf16 v[176:179], v[40:43], v[72:75], v[176:179]
    ds_read_b64 v[118:119], v2 offset:2760
    v_mfma_f32_16x16x32_bf16 v[180:183], v[40:43], v[76:79], v[180:183]
    ds_read_b128 v[152:155], v3 offset:3328
    v_mfma_f32_16x16x32_bf16 v[184:187], v[40:43], v[80:83], v[184:187]
    ds_read_b64 v[120:121], v2 offset:3264
    v_mfma_f32_16x16x32_bf16 v[188:191], v[40:43], v[84:87], v[188:191]
    ds_read_b64 v[122:123], v2 offset:3272
    v_mfma_f32_16x16x32_bf16 v[172:175], v[44:47], v[64:67], v[172:175]
    ds_read_b128 v[156:159], v3 offset:3840
    v_mfma_f32_16x16x32_bf16 v[176:179], v[44:47], v[68:71], v[176:179]
    ds_read_b64 v[124:125], v2 offset:3776
    v_mfma_f32_16x16x32_bf16 v[180:183], v[44:47], v[72:75], v[180:183]
    ds_read_b64 v[126:127], v2 offset:3784
    v_mfma_f32_16x16x32_bf16 v[184:187], v[44:47], v[76:79], v[184:187]
    v_mfma_f32_16x16x32_bf16 v[188:191], v[44:47], v[80:83], v[188:191]
    v_mfma_f32_16x16x32_bf16 v[176:179], v[48:51], v[64:67], v[176:179]
    v_mfma_f32_16x16x32_bf16 v[180:183], v[48:51], v[68:71], v[180:183]
    v_mfma_f32_16x16x32_bf16 v[184:187], v[48:51], v[72:75], v[184:187]
    v_mfma_f32_16x16x32_bf16 v[188:191], v[48:51], v[76:79], v[188:191]
    v_mfma_f32_16x16x32_bf16 v[180:183], v[52:55], v[64:67], v[180:183]
    v_mfma_f32_16x16x32_bf16 v[184:187], v[52:55], v[68:71], v[184:187]
    v_mfma_f32_16x16x32_bf16 v[188:191], v[52:55], v[72:75], v[188:191]
    v_mfma_f32_16x16x32_bf16 v[184:187], v[56:59], v[64:67], v[184:187]
    v_mfma_f32_16x16x32_bf16 v[188:191], v[56:59], v[68:71], v[188:191]
    v_mfma_f32_16x16x32_bf16 v[188:191], v[60:63], v[64:67], v[188:191]
    s_waitcnt lgkmcnt(0)
    s_nop 0
    v_mfma_f32_16x16x32_bf16 v[160:163], v[96:99], v[128:131], v[160:163]
    ds_read_b128 v[64:67], v3 offset:192
    v_mfma_f32_16x16x32_bf16 v[164:167], v[96:99], v[132:135], v[164:167]
    ds_read_b64 v[32:33], v2 offset:256
    v_mfma_f32_16x16x32_bf16 v[168:171], v[96:99], v[136:139], v[168:171]
    ds_read_b64 v[34:35], v2 offset:264
    v_mfma_f32_16x16x32_bf16 v[172:175], v[96:99], v[140:143], v[172:175]
    ds_read_b128 v[68:71], v3 offset:704
    v_mfma_f32_16x16x32_bf16 v[176:179], v[96:99], v[144:147], v[176:179]
    ds_read_b64 v[36:37], v2 offset:768
    v_mfma_f32_16x16x32_bf16 v[180:183], v[96:99], v[148:151], v[180:183]
    ds_read_b64 v[38:39], v2 offset:776
    v_mfma_f32_16x16x32_bf16 v[184:187], v[96:99], v[152:155], v[184:187]
    ds_read_b128 v[72:75], v3 offset:1216
    v_mfma_f32_16x16x32_bf16 v[188:191], v[96:99], v[156:159], v[188:191]
    ds_read_b64 v[40:41], v2 offset:1280
    v_mfma_f32_16x16x32_bf16 v[164:167], v[100:103], v[128:131], v[164:167]
    ds_read_b64 v[42:43], v2 offset:1288
    v_mfma_f32_16x16x32_bf16 v[168:171], v[100:103], v[132:135], v[168:171]
    ds_read_b128 v[76:79], v3 offset:1728
    v_mfma_f32_16x16x32_bf16 v[172:175], v[100:103], v[136:139], v[172:175]
    ds_read_b64 v[44:45], v2 offset:1792
    v_mfma_f32_16x16x32_bf16 v[176:179], v[100:103], v[140:143], v[176:179]
    ds_read_b64 v[46:47], v2 offset:1800
    v_mfma_f32_16x16x32_bf16 v[180:183], v[100:103], v[144:147], v[180:183]
    ds_read_b128 v[80:83], v3 offset:2240
    v_mfma_f32_16x16x32_bf16 v[184:187], v[100:103], v[148:151], v[184:187]
    ds_read_b64 v[48:49], v2 offset:2304
    v_mfma_f32_16x16x32_bf16 v[188:191], v[100:103], v[152:155], v[188:191]
    ds_read_b64 v[50:51], v2 offset:2312
    v_mfma_f32_16x16x32_bf16 v[168:171], v[104:107], v[128:131], v[168:171]
    ds_read_b128 v[84:87], v3 offset:2752
    v_mfma_f32_16x16x32_bf16 v[172:175], v[104:107], v[132:135], v[172:175]
    ds_read_b64 v[52:53], v2 offset:2816
    v_mfma_f32_16x16x32_bf16 v[176:179], v[104:107], v[136:139], v[176:179]
    ds_read_b64 v[54:55], v2 offset:2824
    v_mfma_f32_16x16x32_bf16 v[180:183], v[104:107], v[140:143], v[180:183]
    ds_read_b128 v[88:91], v3 offset:3264
    v_mfma_f32_16x16x32_bf16 v[184:187], v[104:107], v[144:147], v[184:187]
    ds_read_b64 v[56:57], v2 offset:3328
    v_mfma_f32_16x16x32_bf16 v[188:191], v[104:107], v[148:151], v[188:191]
    ds_read_b64 v[58:59], v2 offset:3336
    v_mfma_f32_16x16x32_bf16 v[172:175], v[108:111], v[128:131], v[172:175]
    ds_read_b128 v[92:95], v3 offset:3776
    v_mfma_f32_16x16x32_bf16 v[176:179], v[108:111], v[132:135], v[176:179]
    ds_read_b64 v[60:61], v2 offset:3840
    v_mfma_f32_16x16x32_bf16 v[180:183], v[108:111], v[136:139], v[180:183]
    ds_read_b64 v[62:63], v2 offset:3848
    v_mfma_f32_16x16x32_bf16 v[184:187], v[108:111], v[140:143], v[184:187]
    v_mfma_f32_16x16x32_bf16 v[188:191], v[108:111], v[144:147], v[188:191]
    v_mfma_f32_16x16x32_bf16 v[176:179], v[112:115], v[128:131], v[176:179]
    v_mfma_f32_16x16x32_bf16 v[180:183], v[112:115], v[132:135], v[180:183]
    v_mfma_f32_16x16x32_bf16 v[184:187], v[112:115], v[136:139], v[184:187]
    v_mfma_f32_16x16x32_bf16 v[188:191], v[112:115], v[140:143], v[188:191]
    v_mfma_f32_16x16x32_bf16 v[180:183], v[116:119], v[128:131], v[180:183]
    v_mfma_f32_16x16x32_bf16 v[184:187], v[116:119], v[132:135], v[184:187]
    v_mfma_f32_16x16x32_bf16 v[188:191], v[116:119], v[136:139], v[188:191]
    v_mfma_f32_16x16x32_bf16 v[184:187], v[120:123], v[128:131], v[184:187]
    v_mfma_f32_16x16x32_bf16 v[188:191], v[120:123], v[132:135], v[188:191]
    v_mfma_f32_16x16x32_bf16 v[188:191], v[124:127], v[128:131], v[188:191]
    s_waitcnt lgkmcnt(0)
    s_nop 0
    v_mfma_f32_16x16x32_bf16 v[160:163], v[32:35], v[64:67], v[160:163]
    ds_read_b128 v[128:131], v3 offset:128
    v_mfma_f32_16x16x32_bf16 v[164:167], v[32:35], v[68:71], v[164:167]
    ds_read_b64 v[96:97], v2 offset:320
    v_mfma_f32_16x16x32_bf16 v[168:171], v[32:35], v[72:75], v[168:171]
    ds_read_b64 v[98:99], v2 offset:328
    v_mfma_f32_16x16x32_bf16 v[172:175], v[32:35], v[76:79], v[172:175]
    ds_read_b128 v[132:135], v3 offset:640
    v_mfma_f32_16x16x32_bf16 v[176:179], v[32:35], v[80:83], v[176:179]
    ds_read_b64 v[100:101], v2 offset:832
    v_mfma_f32_16x16x32_bf16 v[180:183], v[32:35], v[84:87], v[180:183]
    ds_read_b64 v[102:103], v2 offset:840
    v_mfma_f32_16x16x32_bf16 v[184:187], v[32:35], v[88:91], v[184:187]
    ds_read_b128 v[136:139], v3 offset:1152
    v_mfma_f32_16x16x32_bf16 v[188:191], v[32:35], v[92:95], v[188:191]
    ds_read_b64 v[104:105], v2 offset:1344
    v_mfma_f32_16x16x32_bf16 v[164:167], v[36:39], v[64:67], v[164:167]
    ds_read_b64 v[106:107], v2 offset:1352
    v_mfma_f32_16x16x32_bf16 v[168:171], v[36:39], v[68:71], v[168:171]
    ds_read_b128 v[140:143], v3 offset:1664
    v_mfma_f32_16x16x32_bf16 v[172:175], v[36:39], v[72:75], v[172:175]
    ds_read_b64 v[108:109], v2 offset:1856
    v_mfma_f32_16x16x32_bf16 v[176:179], v[36:39], v[76:79], v[176:179]
    ds_read_b64 v[110:111], v2 offset:1864
    v_mfma_f32_16x16x32_bf16 v[180:183], v[36:39], v[80:83], v[180:183]
    ds_read_b128 v[144:147], v3 offset:2176
    v_mfma_f32_16x16x32_bf16 v[184:187], v[36:39], v[84:87], v[184:187]
    ds_read_b64 v[112:113], v2 offset:2368
    v_mfma_f32_16x16x32_bf16 v[188:191], v[36:39], v[88:91], v[188:191]
    ds_read_b64 v[114:115], v2 offset:2376
    v_mfma_f32_16x16x32_bf16 v[168:171], v[40:43], v[64:67], v[168:171]
    ds_read_b128 v[148:151], v3 offset:2688
    v_mfma_f32_16x16x32_bf16 v[172:175], v[40:43], v[68:71], v[172:175]
    ds_read_b64 v[116:117], v2 offset:2880
    v_mfma_f32_16x16x32_bf16 v[176:179], v[40:43], v[72:75], v[176:179]
    ds_read_b64 v[118:119], v2 offset:2888
    v_mfma_f32_16x16x32_bf16 v[180:183], v[40:43], v[76:79], v[180:183]
    ds_read_b128 v[152:155], v3 offset:3200
    buffer_load_dword v24, v27, s[36:39], 0 offen sc1
    v_mfma_f32_16x16x32_bf16 v[184:187], v[40:43], v[80:83], v[184:187]
    ds_read_b64 v[120:121], v2 offset:3392
    v_mfma_f32_16x16x32_bf16 v[188:191], v[40:43], v[84:87], v[188:191]
PAGE8:
    s_cbranch_execz VISIT_RET
    ds_read_b64 v[122:123], v2 offset:3400
    v_mfma_f32_16x16x32_bf16 v[172:175], v[44:47], v[64:67], v[172:175]
    ds_read_b128 v[156:159], v3 offset:3712
    v_mfma_f32_16x16x32_bf16 v[176:179], v[44:47], v[68:71], v[176:179]
    ds_read_b64 v[124:125], v2 offset:3904
    v_mfma_f32_16x16x32_bf16 v[180:183], v[44:47], v[72:75], v[180:183]
    ds_read_b64 v[126:127], v2 offset:3912
    v_mfma_f32_16x16x32_bf16 v[184:187], v[44:47], v[76:79], v[184:187]
    v_mfma_f32_16x16x32_bf16 v[188:191], v[44:47], v[80:83], v[188:191]
    v_mfma_f32_16x16x32_bf16 v[176:179], v[48:51], v[64:67], v[176:179]
    v_mfma_f32_16x16x32_bf16 v[180:183], v[48:51], v[68:71], v[180:183]
    v_mfma_f32_16x16x32_bf16 v[184:187], v[48:51], v[72:75], v[184:187]
    v_mfma_f32_16x16x32_bf16 v[188:191], v[48:51], v[76:79], v[188:191]
    v_mfma_f32_16x16x32_bf16 v[180:183], v[52:55], v[64:67], v[180:183]
    v_mfma_f32_16x16x32_bf16 v[184:187], v[52:55], v[68:71], v[184:187]
    v_mfma_f32_16x16x32_bf16 v[188:191], v[52:55], v[72:75], v[188:191]
    v_mfma_f32_16x16x32_bf16 v[184:187], v[56:59], v[64:67], v[184:187]
    v_mfma_f32_16x16x32_bf16 v[188:191], v[56:59], v[68:71], v[188:191]
    v_mfma_f32_16x16x32_bf16 v[188:191], v[60:63], v[64:67], v[188:191]
    s_waitcnt lgkmcnt(0)
    v_mfma_f32_16x16x32_bf16 v[160:163], v[96:99], v[128:131], v[160:163]
    ds_read_b128 v[64:67], v3 offset:64
    v_mfma_f32_16x16x32_bf16 v[164:167], v[96:99], v[132:135], v[164:167]
    ds_read_b64 v[32:33], v2 offset:384
    s_lshl_b32 s79, s53, 6
    s_lshl_b32 s80, s3, 4
    s_add_u32 s79, s79, s80
    v_lshrrev_b32 v236, 2, v0
    v_add_u32_e64 v236, s79, v236
    v_mfma_f32_16x16x32_bf16 v[168:171], v[96:99], v[136:139], v[168:171]
    ds_read_b64 v[34:35], v2 offset:392
    v_mul_u32_u24 v236, 1280, v236
    s_mul_i32 s80, s54, 160
    v_add_u32 v236, s80, v236
    v_mfma_f32_16x16x32_bf16 v[172:175], v[96:99], v[140:143], v[172:175]
    ds_read_b128 v[68:71], v3 offset:576
    v_and_b32 v237, 3, v0
    v_mfma_f32_16x16x32_bf16 v[176:179], v[96:99], v[144:147], v[176:179]
    ds_read_b64 v[36:37], v2 offset:896
    v_lshl_add_u32 v238, v237, 4, v236
    v_mfma_f32_16x16x32_bf16 v[180:183], v[96:99], v[148:151], v[180:183]
    ds_read_b64 v[38:39], v2 offset:904
    v_lshl_add_u32 v239, v237, 3, v236
    v_mfma_f32_16x16x32_bf16 v[184:187], v[96:99], v[152:155], v[184:187]
    ds_read_b128 v[72:75], v3 offset:1088
    buffer_load_dwordx4 v[244:247], v238, s[32:35], 0 offen
    v_mfma_f32_16x16x32_bf16 v[188:191], v[96:99], v[156:159], v[188:191]
    ds_read_b64 v[40:41], v2 offset:1408
    v_mfma_f32_16x16x32_bf16 v[164:167], v[100:103], v[128:131], v[164:167]
    ds_read_b64 v[42:43], v2 offset:1416
    v_mfma_f32_16x16x32_bf16 v[168:171], v[100:103], v[132:135], v[168:171]
    ds_read_b128 v[76:79], v3 offset:1600
    v_mfma_f32_16x16x32_bf16 v[172:175], v[100:103], v[136:139], v[172:175]
    ds_read_b64 v[44:45], v2 offset:1920
    v_mfma_f32_16x16x32_bf16 v[176:179], v[100:103], v[140:143], v[176:179]
    ds_read_b64 v[46:47], v2 offset:1928
    v_mfma_f32_16x16x32_bf16 v[180:183], v[100:103], v[144:147], v[180:183]
    ds_read_b128 v[80:83], v3 offset:2112
    v_mfma_f32_16x16x32_bf16 v[184:187], v[100:103], v[148:151], v[184:187]
    ds_read_b64 v[48:49], v2 offset:2432
    v_mfma_f32_16x16x32_bf16 v[188:191], v[100:103], v[152:155], v[188:191]
    ds_read_b64 v[50:51], v2 offset:2440
    v_mfma_f32_16x16x32_bf16 v[168:171], v[104:107], v[128:131], v[168:171]
    ds_read_b128 v[84:87], v3 offset:2624
    v_mfma_f32_16x16x32_bf16 v[172:175], v[104:107], v[132:135], v[172:175]
    ds_read_b64 v[52:53], v2 offset:2944
    v_mfma_f32_16x16x32_bf16 v[176:179], v[104:107], v[136:139], v[176:179]
    ds_read_b64 v[54:55], v2 offset:2952
    v_mfma_f32_16x16x32_bf16 v[180:183], v[104:107], v[140:143], v[180:183]
    ds_read_b128 v[88:91], v3 offset:3136
    buffer_load_dwordx4 v[248:251], v238, s[32:35], 0 offen offset:64
    v_mfma_f32_16x16x32_bf16 v[184:187], v[104:107], v[144:147], v[184:187]
    ds_read_b64 v[56:57], v2 offset:3456
    v_mfma_f32_16x16x32_bf16 v[188:191], v[104:107], v[148:151], v[188:191]
    ds_read_b64 v[58:59], v2 offset:3464
    v_mfma_f32_16x16x32_bf16 v[172:175], v[108:111], v[128:131], v[172:175]
    ds_read_b128 v[92:95], v3 offset:3648
    v_mfma_f32_16x16x32_bf16 v[176:179], v[108:111], v[132:135], v[176:179]
    ds_read_b64 v[60:61], v2 offset:3968
    v_mfma_f32_16x16x32_bf16 v[180:183], v[108:111], v[136:139], v[180:183]
    ds_read_b64 v[62:63], v2 offset:3976
    v_mfma_f32_16x16x32_bf16 v[184:187], v[108:111], v[140:143], v[184:187]
    v_mfma_f32_16x16x32_bf16 v[188:191], v[108:111], v[144:147], v[188:191]
    v_mfma_f32_16x16x32_bf16 v[176:179], v[112:115], v[128:131], v[176:179]
    v_mfma_f32_16x16x32_bf16 v[180:183], v[112:115], v[132:135], v[180:183]
    v_mfma_f32_16x16x32_bf16 v[184:187], v[112:115], v[136:139], v[184:187]
    v_mfma_f32_16x16x32_bf16 v[188:191], v[112:115], v[140:143], v[188:191]
    v_mfma_f32_16x16x32_bf16 v[180:183], v[116:119], v[128:131], v[180:183]
    buffer_load_dwordx2 v[252:253], v239, s[32:35], 0 offen offset:128
    v_mfma_f32_16x16x32_bf16 v[184:187], v[116:119], v[132:135], v[184:187]
    v_mfma_f32_16x16x32_bf16 v[188:191], v[116:119], v[136:139], v[188:191]
    v_mfma_f32_16x16x32_bf16 v[184:187], v[120:123], v[128:131], v[184:187]
    v_mfma_f32_16x16x32_bf16 v[188:191], v[120:123], v[132:135], v[188:191]
    v_mfma_f32_16x16x32_bf16 v[188:191], v[124:127], v[128:131], v[188:191]
    s_waitcnt lgkmcnt(0)
    s_waitcnt vmcnt(3)
    v_cmp_ne_u32 vcc, s56, v24
    s_mov_b64 s[82:83], vcc
    s_cmp_eq_u64 s[82:83], 0
    s_cbranch_scc0 P2I_RETRY_20
P2I_DONE_21:
    v_mfma_f32_16x16x32_bf16 v[160:163], v[32:35], v[64:67], v[160:163]
    ds_read_b128 v[128:131], v3 offset:0
    v_mfma_f32_16x16x32_bf16 v[164:167], v[32:35], v[68:71], v[164:167]
    ds_read_b64 v[96:97], v2 offset:448
    v_mfma_f32_16x16x32_bf16 v[168:171], v[32:35], v[72:75], v[168:171]
    ds_read_b64 v[98:99], v2 offset:456
    buffer_load_dwordx4 a[0:3], v14, s[36:39], s52 offen offset:0 sc1
    v_mfma_f32_16x16x32_bf16 v[172:175], v[32:35], v[76:79], v[172:175]
    ds_read_b128 v[132:135], v3 offset:512
    v_mfma_f32_16x16x32_bf16 v[176:179], v[32:35], v[80:83], v[176:179]
    ds_read_b64 v[100:101], v2 offset:960
    v_mfma_f32_16x16x32_bf16 v[180:183], v[32:35], v[84:87], v[180:183]
    ds_read_b64 v[102:103], v2 offset:968
    v_mfma_f32_16x16x32_bf16 v[184:187], v[32:35], v[88:91], v[184:187]
    ds_read_b128 v[136:139], v3 offset:1024
    buffer_load_dwordx4 a[4:7], v14, s[36:39], s52 offen offset:1024 sc1
    v_mfma_f32_16x16x32_bf16 v[188:191], v[32:35], v[92:95], v[188:191]
    ds_read_b64 v[104:105], v2 offset:1472
    v_mfma_f32_16x16x32_bf16 v[164:167], v[36:39], v[64:67], v[164:167]
    ds_read_b64 v[106:107], v2 offset:1480
    v_mfma_f32_16x16x32_bf16 v[168:171], v[36:39], v[68:71], v[168:171]
    ds_read_b128 v[140:143], v3 offset:1536
    v_mfma_f32_16x16x32_bf16 v[172:175], v[36:39], v[72:75], v[172:175]
    ds_read_b64 v[108:109], v2 offset:1984
    v_mfma_f32_16x16x32_bf16 v[176:179], v[36:39], v[76:79], v[176:179]
    ds_read_b64 v[110:111], v2 offset:1992
    buffer_load_dwordx4 a[8:11], v14, s[36:39], s52 offen offset:2048 sc1
    v_mfma_f32_16x16x32_bf16 v[180:183], v[36:39], v[80:83], v[180:183]
    ds_read_b128 v[144:147], v3 offset:2048
    v_mfma_f32_16x16x32_bf16 v[184:187], v[36:39], v[84:87], v[184:187]
    ds_read_b64 v[112:113], v2 offset:2496
    v_mfma_f32_16x16x32_bf16 v[188:191], v[36:39], v[88:91], v[188:191]
    ds_read_b64 v[114:115], v2 offset:2504
    v_mfma_f32_16x16x32_bf16 v[168:171], v[40:43], v[64:67], v[168:171]
    ds_read_b128 v[148:151], v3 offset:2560
    buffer_load_dwordx4 a[12:15], v14, s[36:39], s52 offen offset:3072 sc1
    v_mfma_f32_16x16x32_bf16 v[172:175], v[40:43], v[68:71], v[172:175]
    ds_read_b64 v[116:117], v2 offset:3008
    v_mfma_f32_16x16x32_bf16 v[176:179], v[40:43], v[72:75], v[176:179]
    ds_read_b64 v[118:119], v2 offset:3016
    v_mfma_f32_16x16x32_bf16 v[180:183], v[40:43], v[76:79], v[180:183]
    ds_read_b128 v[152:155], v3 offset:3072
    v_mfma_f32_16x16x32_bf16 v[184:187], v[40:43], v[80:83], v[184:187]
    ds_read_b64 v[120:121], v2 offset:3520
    v_mfma_f32_16x16x32_bf16 v[188:191], v[40:43], v[84:87], v[188:191]
    ds_read_b64 v[122:123], v2 offset:3528
    buffer_load_dwordx4 a[16:19], v15, s[36:39], s52 offen offset:0 sc1
    s_add_u32 s52, s52, 5120
    v_mfma_f32_16x16x32_bf16 v[172:175], v[44:47], v[64:67], v[172:175]
    ds_read_b128 v[156:159], v3 offset:3584
    v_mfma_f32_16x16x32_bf16 v[176:179], v[44:47], v[68:71], v[176:179]
    ds_read_b64 v[124:125], v2 offset:4032
    v_mfma_f32_16x16x32_bf16 v[180:183], v[44:47], v[72:75], v[180:183]
    ds_read_b64 v[126:127], v2 offset:4040
    v_mfma_f32_16x16x32_bf16 v[184:187], v[44:47], v[76:79], v[184:187]
    buffer_load_dwordx4 a[20:23], v14, s[36:39], s52 offen offset:0 sc1
    v_mfma_f32_16x16x32_bf16 v[188:191], v[44:47], v[80:83], v[188:191]
    v_mfma_f32_16x16x32_bf16 v[176:179], v[48:51], v[64:67], v[176:179]
    v_mfma_f32_16x16x32_bf16 v[180:183], v[48:51], v[68:71], v[180:183]
    v_mfma_f32_16x16x32_bf16 v[184:187], v[48:51], v[72:75], v[184:187]
    v_mfma_f32_16x16x32_bf16 v[188:191], v[48:51], v[76:79], v[188:191]
    buffer_load_dwordx4 a[24:27], v14, s[36:39], s52 offen offset:1024 sc1
    v_mfma_f32_16x16x32_bf16 v[180:183], v[52:55], v[64:67], v[180:183]
    v_mfma_f32_16x16x32_bf16 v[184:187], v[52:55], v[68:71], v[184:187]
    v_mfma_f32_16x16x32_bf16 v[188:191], v[52:55], v[72:75], v[188:191]
    v_mfma_f32_16x16x32_bf16 v[184:187], v[56:59], v[64:67], v[184:187]
    buffer_load_dwordx4 a[28:31], v14, s[36:39], s52 offen offset:2048 sc1
    v_mfma_f32_16x16x32_bf16 v[188:191], v[56:59], v[68:71], v[188:191]
    v_mfma_f32_16x16x32_bf16 v[188:191], v[60:63], v[64:67], v[188:191]
    s_waitcnt lgkmcnt(0)
    s_nop 0
    v_mfma_f32_16x16x32_bf16 v[160:163], v[96:99], v[128:131], v[160:163]
    v_mfma_f32_16x16x32_bf16 v[164:167], v[96:99], v[132:135], v[164:167]
    v_mfma_f32_16x16x32_bf16 v[168:171], v[96:99], v[136:139], v[168:171]
    buffer_load_dwordx4 a[32:35], v14, s[36:39], s52 offen offset:3072 sc1
    v_mfma_f32_16x16x32_bf16 v[172:175], v[96:99], v[140:143], v[172:175]
    v_mfma_f32_16x16x32_bf16 v[176:179], v[96:99], v[144:147], v[176:179]
    v_mfma_f32_16x16x32_bf16 v[180:183], v[96:99], v[148:151], v[180:183]
    v_mfma_f32_16x16x32_bf16 v[184:187], v[96:99], v[152:155], v[184:187]
    buffer_load_dwordx4 a[36:39], v15, s[36:39], s52 offen offset:0 sc1
    s_add_u32 s52, s52, 5120
    v_mfma_f32_16x16x32_bf16 v[188:191], v[96:99], v[156:159], v[188:191]
    v_mfma_f32_16x16x32_bf16 v[164:167], v[100:103], v[128:131], v[164:167]
    v_mfma_f32_16x16x32_bf16 v[168:171], v[100:103], v[132:135], v[168:171]
    v_mfma_f32_16x16x32_bf16 v[172:175], v[100:103], v[136:139], v[172:175]
    v_mfma_f32_16x16x32_bf16 v[176:179], v[100:103], v[140:143], v[176:179]
    buffer_load_dwordx4 a[40:43], v14, s[36:39], s52 offen offset:0 sc1
    v_mfma_f32_16x16x32_bf16 v[180:183], v[100:103], v[144:147], v[180:183]
    v_mfma_f32_16x16x32_bf16 v[184:187], v[100:103], v[148:151], v[184:187]
    v_mfma_f32_16x16x32_bf16 v[188:191], v[100:103], v[152:155], v[188:191]
    v_mfma_f32_16x16x32_bf16 v[168:171], v[104:107], v[128:131], v[168:171]
    buffer_load_dwordx4 a[44:47], v14, s[36:39], s52 offen offset:1024 sc1
    v_mfma_f32_16x16x32_bf16 v[172:175], v[104:107], v[132:135], v[172:175]
    v_mfma_f32_16x16x32_bf16 v[176:179], v[104:107], v[136:139], v[176:179]
    v_mfma_f32_16x16x32_bf16 v[180:183], v[104:107], v[140:143], v[180:183]
    v_mfma_f32_16x16x32_bf16 v[184:187], v[104:107], v[144:147], v[184:187]
    v_mfma_f32_16x16x32_bf16 v[188:191], v[104:107], v[148:151], v[188:191]
    buffer_load_dwordx4 a[48:51], v14, s[36:39], s52 offen offset:2048 sc1
    v_mfma_f32_16x16x32_bf16 v[172:175], v[108:111], v[128:131], v[172:175]
    v_mfma_f32_16x16x32_bf16 v[176:179], v[108:111], v[132:135], v[176:179]
    v_mfma_f32_16x16x32_bf16 v[180:183], v[108:111], v[136:139], v[180:183]
    v_mfma_f32_16x16x32_bf16 v[184:187], v[108:111], v[140:143], v[184:187]
    buffer_load_dwordx4 a[52:55], v14, s[36:39], s52 offen offset:3072 sc1
    v_mfma_f32_16x16x32_bf16 v[188:191], v[108:111], v[144:147], v[188:191]
    v_mfma_f32_16x16x32_bf16 v[176:179], v[112:115], v[128:131], v[176:179]
    v_mfma_f32_16x16x32_bf16 v[180:183], v[112:115], v[132:135], v[180:183]
    v_mfma_f32_16x16x32_bf16 v[184:187], v[112:115], v[136:139], v[184:187]
    v_mfma_f32_16x16x32_bf16 v[188:191], v[112:115], v[140:143], v[188:191]
    buffer_load_dwordx4 a[56:59], v15, s[36:39], s52 offen offset:0 sc1
    s_add_u32 s52, s52, 5120
    v_mfma_f32_16x16x32_bf16 v[180:183], v[116:119], v[128:131], v[180:183]
    v_mfma_f32_16x16x32_bf16 v[184:187], v[116:119], v[132:135], v[184:187]
    v_mfma_f32_16x16x32_bf16 v[188:191], v[116:119], v[136:139], v[188:191]
    v_mfma_f32_16x16x32_bf16 v[184:187], v[120:123], v[128:131], v[184:187]
    buffer_load_dwordx4 a[60:63], v14, s[36:39], s52 offen offset:0 sc1
    v_mfma_f32_16x16x32_bf16 v[188:191], v[120:123], v[132:135], v[188:191]
    v_mfma_f32_16x16x32_bf16 v[188:191], v[124:127], v[128:131], v[188:191]
    s_nop 7
    v_bfe_u32 v8, v0, 4, 1
    v_lshlrev_b32 v8, 9, v8
    v_and_b32 v9, 15, v0
    v_lshl_add_u32 v8, v9, 5, v8
    v_lshrrev_b32 v9, 5, v0
    v_lshl_add_u32 v8, v9, 4, v8
    v_cvt_pk_bf16_f32 v32, v160, v161
    v_cvt_pk_bf16_f32 v33, v162, v163
    v_cvt_pk_bf16_f32 v34, v164, v165
    v_cvt_pk_bf16_f32 v35, v166, v167
    v_cvt_pk_bf16_f32 v36, v168, v169
    v_cvt_pk_bf16_f32 v37, v170, v171
    v_cvt_pk_bf16_f32 v38, v172, v173
    v_cvt_pk_bf16_f32 v39, v174, v175
    v_cvt_pk_bf16_f32 v40, v176, v177
    v_cvt_pk_bf16_f32 v41, v178, v179
    v_cvt_pk_bf16_f32 v42, v180, v181
    v_cvt_pk_bf16_f32 v43, v182, v183
    v_cvt_pk_bf16_f32 v44, v184, v185
    v_cvt_pk_bf16_f32 v45, v186, v187
    v_cvt_pk_bf16_f32 v46, v188, v189
    v_cvt_pk_bf16_f32 v47, v190, v191
    s_nop 1
    v_permlane16_swap_b32 v32, v34
    v_permlane16_swap_b32 v33, v35
    v_permlane16_swap_b32 v36, v38
    v_permlane16_swap_b32 v37, v39
    v_permlane16_swap_b32 v40, v42
    v_permlane16_swap_b32 v41, v43
    v_permlane16_swap_b32 v44, v46
    v_permlane16_swap_b32 v45, v47
    buffer_store_dwordx4 v[32:35], v8, s[36:39], s18 offen offset:0 sc1
    buffer_store_dwordx4 v[36:39], v8, s[36:39], s18 offen offset:1024 sc1
    buffer_store_dwordx4 v[40:43], v8, s[36:39], s18 offen offset:2048 sc1
    buffer_store_dwordx4 v[44:47], v8, s[36:39], s18 offen offset:3072 sc1
    s_waitcnt vmcnt(24)
    v_mov_b32 v96, v200
    v_mov_b32 v97, v201
    v_mov_b32 v98, v202
    v_mov_b32 v99, v203
    v_mov_b32 v100, v204
    v_mov_b32 v101, v205
    v_mov_b32 v102, v206
    v_mov_b32 v103, v207
    v_mov_b32 v104, v208
    v_mov_b32 v105, v209
    v_mov_b32 v106, v210
    v_mov_b32 v107, v211
    v_mov_b32 v108, v212
    v_mov_b32 v109, v213
    v_mov_b32 v110, v214
    v_mov_b32 v111, v215
    v_mov_b32 v112, v216
    v_mov_b32 v113, v217
    v_mov_b32 v114, v218
    v_mov_b32 v115, v219
    v_mov_b32 v116, v220
    v_mov_b32 v117, v221
    v_mov_b32 v118, v222
    v_mov_b32 v119, v223
    v_mov_b32 v120, v224
    v_mov_b32 v121, v225
    v_mov_b32 v122, v226
    v_mov_b32 v123, v227
    v_mov_b32 v124, v228
    v_mov_b32 v125, v229
    v_mov_b32 v126, v230
    v_mov_b32 v127, v231
    s_mov_b32 s29, 17563648
    s_barrier
    s_branch C4JOIN
DONE:
EXIT:
    s_endpgm
P1_RETRY_1:
    s_mov_b32 s81, 0x40000
P1_LOOP_3:
    buffer_load_dword v29, v28, s[36:39], 0 offen sc1
    s_waitcnt vmcnt(0)
    v_cmp_ne_u32 vcc, s56, v29
    s_mov_b64 s[82:83], vcc
    s_cmp_eq_u64 s[82:83], 0
    s_cbranch_scc1 P1_DONE_2
    s_sub_u32 s81, s81, 1
    s_cmp_lg_u32 s81, 0
    s_cbranch_scc1 P1_LOOP_3
    s_branch P1_DONE_2
P2_RETRY_4:
    s_mov_b32 s81, 0x40000
P2_LOOP_6:
    buffer_load_dword v24, v27, s[36:39], 0 offen sc1
    s_waitcnt vmcnt(0)
    v_cmp_ne_u32 vcc, s56, v24
    s_mov_b64 s[82:83], vcc
    s_cmp_eq_u64 s[82:83], 0
    s_cbranch_scc1 P2_DONE_5
    s_sub_u32 s81, s81, 1
    s_cmp_lg_u32 s81, 0
    s_cbranch_scc1 P2_LOOP_6
    s_branch P2_DONE_5
FH_RETRY_8:
    s_mov_b32 s81, 0x40000
FH_LOOP_10:
    buffer_load_dword v19, v18, s[36:39], s49 offen sc1
    s_waitcnt vmcnt(0)
    v_cmp_ne_u32 vcc, s56, v19
    s_mov_b64 s[82:83], vcc
    s_cmp_eq_u64 s[82:83], 0
    s_cbranch_scc1 FH_DONE_9
    s_sub_u32 s81, s81, 1
    s_cmp_lg_u32 s81, 0
    s_cbranch_scc1 FH_LOOP_10
    s_branch FH_DONE_9
FY_RETRY_11:
    s_mov_b32 s81, 0x40000
FY_LOOP_13:
    buffer_load_dword v20, v18, s[36:39], s59 offen sc1
    s_waitcnt vmcnt(0)
    v_cmp_ne_u32 vcc, s56, v20
    s_mov_b64 s[82:83], vcc
    s_cmp_eq_u64 s[82:83], 0
    s_cbranch_scc1 FY_DONE_12
    s_sub_u32 s81, s81, 1
    s_cmp_lg_u32 s81, 0
    s_cbranch_scc1 FY_LOOP_13
    s_branch FY_DONE_12
EP_RETRY_14:
    s_mov_b32 s81, 0x40000
EP_LOOP_16:
    buffer_load_dword v24, v16, s[36:39], s76 offen sc1
    s_waitcnt vmcnt(0)
    v_cmp_ne_u32 vcc, s56, v24
    s_mov_b64 s[82:83], vcc
    s_cmp_eq_u64 s[82:83], 0
    s_cbranch_scc1 EP_DONE_15
    s_sub_u32 s81, s81, 1
    s_cmp_lg_u32 s81, 0
    s_cbranch_scc1 EP_LOOP_16
    s_branch EP_DONE_15
EP_CHECK:
    s_waitcnt vmcnt(0)
    v_cmp_ne_u32 vcc, s56, v24
    s_mov_b64 s[82:83], vcc
    s_cmp_eq_u64 s[82:83], 0
    s_cbranch_scc0 EP_RETRY_14
EP_DONE_15:
    s_branch EP_BACK
EP_STORE:
    s_sub_u32 s73, s56, 2654435768
    v_mov_b32 v16, s73
    v_mov_b32 v17, 0
    s_mov_b32 exec_lo, 1
    s_mov_b32 exec_hi, 0
    buffer_store_dword v16, v17, s[36:39], 0 offen sc1
    s_mov_b64 exec, -1
    s_branch EP_STORED
FAI_RETRY_17:
    s_mov_b32 s81, 0x40000
FAI_LOOP_19:
    buffer_load_dword v25, v28, s[36:39], 0 offen sc1
    s_waitcnt vmcnt(0)
    v_cmp_ne_u32 vcc, s56, v25
    s_mov_b64 s[82:83], vcc
    s_cmp_eq_u64 s[82:83], 0
    s_cbranch_scc1 FAI_DONE_18
    s_sub_u32 s81, s81, 1
    s_cmp_lg_u32 s81, 0
    s_cbranch_scc1 FAI_LOOP_19
    s_branch FAI_DONE_18
P2I_RETRY_20:
    s_mov_b32 s81, 0x40000
P2I_LOOP_22:
    buffer_load_dword v24, v27, s[36:39], 0 offen sc1
    s_waitcnt vmcnt(0)
    v_cmp_ne_u32 vcc, s56, v24
    s_mov_b64 s[82:83], vcc
    s_cmp_eq_u64 s[82:83], 0
    s_cbranch_scc1 P2I_DONE_21
    s_sub_u32 s81, s81, 1
    s_cmp_lg_u32 s81, 0
    s_cbranch_scc1 P2I_LOOP_22
    s_branch P2I_DONE_21
CODE_END:
.section .rodata,"a"
.p2align 6
.amdhsa_kernel recurrent_scan__ssm_conv_h3__dense_activation_gelu__prompt_kernel
  .amdhsa_next_free_vgpr 512
  .amdhsa_next_free_sgpr 102
  .amdhsa_accum_offset 256
  .amdhsa_group_segment_fixed_size 0
  .amdhsa_kernarg_size 112
  .amdhsa_user_sgpr_count 2
  .amdhsa_user_sgpr_kernarg_segment_ptr 1
  .amdhsa_system_sgpr_workgroup_id_x 1
.end_amdhsa_kernel
```
